```python
import torch

def _softmax(x, axis=-1):
    return torch.softmax(x, dim=axis)
def _gelu(x):
    return torch.nn.functional.gelu(x, approximate="tanh")
def _silu(x):
    return torch.nn.functional.silu(x)
def _sigmoid(x):
    return torch.sigmoid(x)
def _layernorm(x, axis=-1, eps=1e-5):
    m = x.mean(dim=axis, keepdim=True)
    v = x.var(dim=axis, keepdim=True, unbiased=False)
    return (x - m) / torch.sqrt(v + eps)
def _scatter_add(tgt, idx, src, axis=0):
    return tgt.clone().index_add_(axis, idx, src)
def _segment_sum(src, seg, n):
    out = torch.zeros((n,) + src.shape[1:], dtype=src.dtype)
    return out.index_add_(0, seg, src)
def _pad(x, pw):
    flat = tuple(v for pair in reversed(pw) for v in pair)
    return torch.nn.functional.pad(x, flat)

kernel_name = 'recurrent_scan__ssm_conv_s4d__moe_arch_mod__prompt'

def setup_inputs():

    _w = (lambda a: (lambda t: t.to(torch.bfloat16) if t.is_floating_point() else t)(torch.as_tensor(a)))
    def _A_setup():
        Bsz, L, D, N = 1, 2048, 1024, 128
        return {
            "u": _w((lambda *s: torch.randn(*s, dtype=torch.bfloat16) * 0.05)(Bsz, L, D)),
            "log_A_real": _w((lambda *s: torch.randn(*s, dtype=torch.bfloat16) * 6.4)(D, N) * 0.5),
            "A_imag": _w((lambda *s: torch.randn(*s, dtype=torch.bfloat16) * 0.05)(D, N) * 3.14),
            "C_real": _w((lambda *s: torch.randn(*s, dtype=torch.bfloat16) * 0.05)(D, N) / N ** 0.5),
            "C_imag": _w((lambda *s: torch.randn(*s, dtype=torch.bfloat16) * 0.05)(D, N) / N ** 0.5),
            "log_dt": _w((lambda *s: torch.randn(*s, dtype=torch.bfloat16) * 0.05)(D) * 0.5 - 4.0),
            "D_skip": _w((lambda *s: torch.randn(*s, dtype=torch.bfloat16) * 0.05)(D)),
        }
    _A_in = _A_setup()

    def _B_setup():
        B, S, D, F, C = 1, 2048, 1024, 3584, 2
        return {
            "x": _w((lambda *s: torch.randn(*s, dtype=torch.bfloat16) * 0.05)(B, S, D)),
            "w_r": _w((lambda *s: torch.randn(*s, dtype=torch.bfloat16) * 0.05)(D)),
            "w_gate": _w((lambda *s: torch.randn(*s, dtype=torch.bfloat16) * 0.05)(D, F)),
            "w_up": _w((lambda *s: torch.randn(*s, dtype=torch.bfloat16) * 0.05)(D, F)),
            "w_down": _w((lambda *s: torch.randn(*s, dtype=torch.bfloat16) * 0.05)(F, D)),
        }
    _B_in = _B_setup()

    return {
        "A_u": _A_in["u"],
        "A_log_A_real": _A_in["log_A_real"],
        "A_A_imag": _A_in["A_imag"],
        "A_C_real": _A_in["C_real"],
        "A_C_imag": _A_in["C_imag"],
        "A_log_dt": _A_in["log_dt"],
        "A_D_skip": _A_in["D_skip"],
        "B_x": _B_in["x"],
        "B_w_r": _B_in["w_r"],
        "B_w_gate": _B_in["w_gate"],
        "B_w_up": _B_in["w_up"],
        "B_w_down": _B_in["w_down"],
    }

def reference(A_u, A_log_A_real, A_A_imag, A_C_real, A_C_imag, A_log_dt, A_D_skip, B_x, B_w_r, B_w_gate, B_w_up, B_w_down):
    def _A_ref(u, log_A_real, A_imag, C_real, C_imag, log_dt, D_skip):
        L = u.shape[1]
        dt = torch.exp(log_dt)
        A = -torch.exp(log_A_real) + 1j * A_imag
        C = (C_real + 1j * C_imag) * dt[:, None]
        pos = (lambda x, dt: x.to(dt))(torch.arange(L), log_dt.dtype)
        P = torch.exp((A * dt[:, None])[:, :, None] * pos[None, None, :])
        K = 2.0 * torch.einsum("dn,dnl->dl", C, P).real
        L2 = 2 * L
        u_t = (lambda x, *d: x.permute(*d))(u, 0, 2, 1)
        Kf = (lambda x, *a, **k: torch.fft.rfft(x.float(), *a, **k))(K, L2)
        Uf = (lambda x, *a, **k: torch.fft.rfft(x.float(), *a, **k))(u_t, L2)
        y = (lambda x, *a, **k: torch.fft.irfft(x, *a, **k).to(torch.bfloat16))(Uf * Kf[None, :, :], L2)[:, :, :L]
        y = (lambda x, *d: x.permute(*d))(y, 0, 2, 1)
        return y + u * D_skip[None, None, :]

    def _B_ref(x, w_r, w_gate, w_up, w_down):
        B, S, D = x.shape
        C = 2
        r = x @ w_r
        idx = torch.argsort(-r, axis=-1)[:, :C]
        idx_e = (lambda x, n, axis: torch.repeat_interleave(x, n, dim=axis))(idx.reshape(B, C, 1), D, axis=2)
        x_sel = (lambda x, i, axis: torch.take_along_dim(x, i, dim=axis))(x, idx_e, axis=1)
        g = _silu(x_sel @ w_gate)
        u = x_sel @ w_up
        y = (g * u) @ w_down
        r_sel = _sigmoid((lambda x, i, axis: torch.take_along_dim(x, i, dim=axis))(r, idx, axis=1))
        y = y * r_sel.reshape(B, C, 1)
        b_off = (torch.arange(B) * S).reshape(B, 1)
        flat_idx = (idx + b_off).reshape(B * C)
        zero = (x * 0.0).reshape(B * S, D)
        upd = _scatter_add(zero, flat_idx, y.reshape(B * C, D), axis=0)
        return x + upd.reshape(B, S, D)

    x = A_u
    xn = _layernorm(x, axis=-1)
    s = _A_ref(xn, A_log_A_real, A_A_imag, A_C_real, A_C_imag, A_log_dt, A_D_skip)
    g = _silu(_B_ref(xn, B_w_r, B_w_gate, B_w_up, B_w_down))
    return x + s * g
```

```asm
; @launch grid=(256,1,1) block=(1024,1,1) lds=161152
.amdgcn_target "amdgcn-amd-amdhsa--gfx950"
.text
.globl recurrent_scan__ssm_conv_s4d__moe_arch_mod__prompt_kernel
.p2align 12
.p2align 8
.type recurrent_scan__ssm_conv_s4d__moe_arch_mod__prompt_kernel,@function
recurrent_scan__ssm_conv_s4d__moe_arch_mod__prompt_kernel:
    s_cmp_ge_u32 s2, 256
    s_cbranch_scc1 L_end
    s_load_dwordx16 s[4:19], s[0:1], 0
    s_load_dwordx8 s[20:27], s[0:1], 64
    s_load_dwordx4 s[28:31], s[0:1], 96
    s_load_dwordx2 s[32:33], s[0:1], 112
    v_readfirstlane_b32 s3, v0
    v_and_b32 v1, 63, v0
    v_mov_b32 v3, 0
    v_lshlrev_b32 v2, 4, v1
    s_and_b32 s35, s2, 7
    s_lshr_b32 s36, s2, 3
    s_lshr_b32 s3, s3, 6
    s_and_b32 s40, s36, 15
    s_lshl4_add_u32 s37, s35, s40
    s_lshr_b32 s38, s36, 4
    s_and_b32 s34, s3, 3
    s_cmp_ge_u32 s3, 4
    s_cbranch_scc1 L_p1
    s_setprio 3
    s_lshl_b32 s40, s2, 14
    s_lshl_b32 s41, s34, 9
    v_lshrrev_b32 v118, 3, v1
    v_and_b32 v113, 112, v2
    v_add_u32 v113, s41, v113
    v_lshl_add_u32 v112, v118, 11, v113
    v_add_u32 v112, s40, v112
    s_waitcnt lgkmcnt(0)
    s_load_dword s47, s[32:33], 0
    global_load_dwordx4 v[32:35], v113, s[20:21] offset:0
    global_load_dwordx4 v[36:39], v113, s[20:21] offset:128
    global_load_dwordx4 v[40:43], v113, s[20:21] offset:256
    global_load_dwordx4 v[44:47], v113, s[20:21] offset:384
    global_load_dwordx4 v[16:19], v112, s[4:5] offset:0
    global_load_dwordx4 v[20:23], v112, s[4:5] offset:128
    global_load_dwordx4 v[24:27], v112, s[4:5] offset:256
    global_load_dwordx4 v[28:31], v112, s[4:5] offset:384
    s_barrier
    s_branch L_tok
L_p1:
    s_cmp_ge_u32 s3, 8
    s_cbranch_scc1 L_p2
    s_getpc_b64 s[48:49]
L_pc:
    s_and_b32 s40, s36, 3
    s_lshl2_add_u32 s40, s40, s34
    s_lshl_b32 s40, s40, 11
    v_and_b32 v4, 15, v1
    v_lshl_add_u32 v4, v4, 7, s40
    v_min_u32 v4, L_codeend-L_pc-4, v4
    global_load_dword v31, v4, s[48:49]
    s_lshl_b32 s40, s34, 7
    s_add_u32 s40, s40, 256
    v_cmp_gt_u32 vcc, 32, v1
    v_mov_b32 v4, s40
    v_lshl_add_u32 v5, v1, 2, -16
    v_cndmask_b32 v4, 0, v4, vcc
    v_cndmask_b32 v6, 0, -1, vcc
    v_add_u32 v4, v4, v5
    v_subrev_u32 v4, 112, v4
    ds_write_b32 v4, v6
    s_waitcnt lgkmcnt(0)
    s_barrier
    s_branch L_exp
L_p2:
    s_sub_u32 s34, s3, 8
    s_lshl3_add_u32 s42, s37, s34
    s_lshl_b32 s40, s42, 8
    v_lshl_add_u32 v6, v1, 2, s40
    v_and_b32 v4, 15, v1
    v_lshrrev_b32 v5, 4, v1
    s_and_b32 s40, s34, 3
    s_lshl_b32 s40, s40, 3
    s_lshr_b32 s41, 0x34332d32, s40
    s_and_b32 s41, s41, 255
    s_lshr_b32 s43, 0x9070305, s40
    s_bfm_b32 s43, s43, 0
    v_lshl_add_u32 v16, v5, 3, v4
    v_sub_u32 v16, s41, v16
    s_mov_b32 s44, 0
    s_mov_b32 s45, s43
    v_lshrrev_b64 v[16:17], v16, s[44:45]
    s_mov_b32 s44, 0xffff
    v_bfe_i32 v12, v16, 0, 1
    v_bfe_i32 v17, v16, 1, 1
    v_bfi_b32 v12, s44, v12, v17
    v_and_b32 v12, 0x3c003c00, v12
    v_bfe_i32 v13, v16, 2, 1
    v_bfe_i32 v17, v16, 3, 1
    v_bfi_b32 v13, s44, v13, v17
    v_and_b32 v13, 0x3c003c00, v13
    v_bfe_i32 v14, v16, 4, 1
    v_bfe_i32 v17, v16, 5, 1
    v_bfi_b32 v14, s44, v14, v17
    v_and_b32 v14, 0x3c003c00, v14
    v_bfe_i32 v15, v16, 6, 1
    v_bfe_i32 v17, v16, 7, 1
    v_bfi_b32 v15, s44, v15, v17
    v_and_b32 v15, 0x3c003c00, v15
    s_lshl_b32 s40, s40, 7
    v_add_u32 v7, s40, v2
    ds_write_b128 v7, v[12:15] offset:4736
    s_lshr_b32 s40, s42, 1
    s_lshl_b32 s40, s40, 2
    s_waitcnt lgkmcnt(0)
    s_load_dword s48, s[14:15], s40
    s_load_dword s49, s[16:17], s40
    s_barrier
    global_load_dword v8, v6, s[6:7]
    global_load_dword v9, v6, s[8:9]
    global_load_dword v10, v6, s[10:11]
    global_load_dword v11, v6, s[12:13]
    s_branch L_cnv
L_tok:
    s_cmp_ge_u32 s34, 2
    s_cselect_b32 s40, 4, 0
    s_add_u32 s40, s40, s34
    s_add_u32 s41, s34, 2
    s_cmp_eq_u32 s38, 0
    s_cselect_b32 s42, s40, s41
    s_cselect_b32 s43, s41, s40
    s_mov_b32 s20, s42
    s_mov_b32 s21, s43
    s_mov_b32 s30, 0x3f803f80
    s_mov_b32 s31, 0xffff0000
    s_lshl_b32 s40, s2, 7
    s_add_u32 s41, s40, 65536
    s_add_u32 s58, s32, s41
    s_addc_u32 s59, s33, 0
    s_lshl_b32 s41, s34, 20
    s_add_u32 s40, s40, s41
    s_add_u32 s40, s40, 2097152
    s_add_u32 s52, s32, s40
    s_addc_u32 s53, s33, 0
    s_lshl_b32 s40, s35, 11
    s_lshl_b32 s41, s36, 6
    s_add_u32 s40, s40, s41
    s_add_u32 s40, s40, 4096
    s_add_u32 s48, s32, s40
    s_addc_u32 s49, s33, 0
    s_add_u32 s50, s32, 32768
    s_addc_u32 s51, s33, 0
    s_lshl_b32 s40, s2, 6
    s_add_u32 s62, s50, s40
    s_addc_u32 s63, s51, 0
    s_lshl_b32 s41, s37, 15
    s_add_u32 s41, s41, 2097152
    s_lshl_b32 s40, s20, 12
    s_add_u32 s40, s40, s41
    s_add_u32 s54, s32, s40
    s_addc_u32 s55, s33, 0
    s_lshl_b32 s40, s21, 12
    s_add_u32 s40, s40, s41
    s_add_u32 s56, s32, s40
    s_addc_u32 s57, s33, 0
    s_mov_b64 s[60:61], s[4:5]
    s_lshl_b32 s40, s20, 19
    s_lshl4_add_u32 s40, s37, s40
    s_add_u32 s40, s40, 4096
    s_add_u32 s28, s28, s40
    s_addc_u32 s29, s29, 0
    s_waitcnt lgkmcnt(0)
    s_add_u32 s39, s47, 1
    s_mul_i32 s39, s39, 0x9e3779b1
    v_mov_b32 v53, 1
    v_mov_b32 v52, s39
    s_mov_b64 exec, 1
    ds_write_b64 v3, v[52:53] offset:40
    s_mov_b64 exec, -1
    s_cmp_lg_u32 s34, 3
    s_cbranch_scc1 L_warm_1
    s_load_dword s64, s[58:59], 0 glc
L_warm_1:
    v_and_b32 v52, 7, v1
    v_and_b32 v53, 15, v1
    v_lshrrev_b32 v54, 4, v1
    s_lshl_b32 s40, s20, 9
    s_add_u32 s40, s40, 9360
    s_lshl_b32 s41, s21, 9
    s_add_u32 s41, s41, 9360
    v_mul_u32_u24 v55, 4624, v118
    v_lshl_add_u32 v55, v52, 4, v55
    v_add_u32 v114, s40, v55
    v_mul_u32_u24 v55, 4624, v52
    v_lshl_add_u32 v55, v118, 4, v55
    v_add_u32 v8, s40, v55
    v_add_u32 v9, s41, v55
    v_bfe_u32 v55, v1, 2, 2
    v_mul_u32_u24 v55, 4624, v55
    v_lshl_add_u32 v55, v54, 7, v55
    v_bfe_u32 v56, v1, 1, 1
    v_lshl_add_u32 v55, v56, 6, v55
    v_and_b32 v56, 1, v1
    v_lshl_add_u32 v55, v56, 3, v55
    v_add_u32 v115, s40, v55
    v_lshlrev_b32 v116, 17, v118
    v_lshl_add_u32 v116, v52, 4, v116
    v_lshlrev_b32 v117, 4, v118
    v_lshl_add_u32 v55, v53, 2, v54
    v_lshl_add_u32 v6, v55, 3, s40
    v_lshlrev_b32 v4, 13, v55
    s_lshl_b32 s40, s20, 11
    v_lshl_add_u32 v7, v55, 5, s40
    s_lshl_b32 s40, s34, 10
    s_add_u32 s40, s40, 51968
    v_add_u32 v5, s40, v2
    v_add_u32 v11, 57664, v5
    s_lshr_b32 s40, s35, 1
    s_lshl2_add_u32 s40, s40, s34
    s_lshl_b32 s40, s40, 7
    v_and_b32 v56, 3, v1
    v_lshl_add_u32 v55, v54, 2, v56
    v_lshl_add_u32 v10, v55, 3, s40
    v_lshlrev_b32 v53, 3, v56
    v_lshrrev_b32 v55, v53, s39
    v_and_b32 v55, 0xfe, v55
    s_and_b32 s40, s39, 1
    v_or_b32 v55, s40, v55
    v_bfe_u32 v12, v55, 0, 1
    v_bfe_u32 v56, v55, 1, 1
    v_lshl_or_b32 v12, v56, 16, v12
    v_bfe_u32 v13, v55, 2, 1
    v_bfe_u32 v56, v55, 3, 1
    v_lshl_or_b32 v13, v56, 16, v13
    v_bfe_u32 v14, v55, 4, 1
    v_bfe_u32 v56, v55, 5, 1
    v_lshl_or_b32 v14, v56, 16, v14
    v_bfe_u32 v15, v55, 6, 1
    v_bfe_u32 v56, v55, 7, 1
    v_lshl_or_b32 v15, v56, 16, v15
    s_and_b32 s40, s39, 0xffff
    v_mov_b32 v119, s40
    s_lshl_b32 s40, s34, 7
    v_add_u32 v120, s40, v117
    v_lshlrev_b32 v118, 3, v118
    s_waitcnt vmcnt(4)
    v_dot2_f32_bf16 v51, v32, s30, 0
    v_dot2_f32_bf16 v52, v33, s30, 0
    v_dot2_f32_bf16 v51, v34, s30, v51
    v_dot2_f32_bf16 v52, v35, s30, v52
    v_dot2_f32_bf16 v51, v36, s30, v51
    v_dot2_f32_bf16 v52, v37, s30, v52
    v_dot2_f32_bf16 v51, v38, s30, v51
    v_dot2_f32_bf16 v52, v39, s30, v52
    v_dot2_f32_bf16 v51, v40, s30, v51
    v_dot2_f32_bf16 v52, v41, s30, v52
    v_dot2_f32_bf16 v51, v42, s30, v51
    v_dot2_f32_bf16 v52, v43, s30, v52
    v_dot2_f32_bf16 v51, v44, s30, v51
    v_dot2_f32_bf16 v52, v45, s30, v52
    v_dot2_f32_bf16 v51, v46, s30, v51
    v_dot2_f32_bf16 v52, v47, s30, v52
    s_waitcnt vmcnt(3)
    v_dot2_f32_bf16 v49, v16, v16, 0
    v_dot2_f32_bf16 v48, v16, s30, 0
    v_dot2_f32_bf16 v50, v16, v32, 0
    v_dot2_f32_bf16 v49, v17, v17, v49
    v_dot2_f32_bf16 v48, v17, s30, v48
    v_dot2_f32_bf16 v50, v17, v33, v50
    v_dot2_f32_bf16 v49, v18, v18, v49
    v_dot2_f32_bf16 v48, v18, s30, v48
    v_dot2_f32_bf16 v50, v18, v34, v50
    v_dot2_f32_bf16 v49, v19, v19, v49
    v_dot2_f32_bf16 v48, v19, s30, v48
    v_dot2_f32_bf16 v50, v19, v35, v50
    v_add_f32 v51, v51, v52
    s_waitcnt vmcnt(2)
    v_dot2_f32_bf16 v49, v20, v20, v49
    v_dot2_f32_bf16 v48, v20, s30, v48
    v_dot2_f32_bf16 v50, v20, v36, v50
    v_dot2_f32_bf16 v49, v21, v21, v49
    v_dot2_f32_bf16 v48, v21, s30, v48
    v_dot2_f32_bf16 v50, v21, v37, v50
    v_dot2_f32_bf16 v49, v22, v22, v49
    v_dot2_f32_bf16 v48, v22, s30, v48
    v_dot2_f32_bf16 v50, v22, v38, v50
    v_dot2_f32_bf16 v49, v23, v23, v49
    v_dot2_f32_bf16 v48, v23, s30, v48
    v_dot2_f32_bf16 v50, v23, v39, v50
    s_waitcnt vmcnt(1)
    v_dot2_f32_bf16 v49, v24, v24, v49
    v_dot2_f32_bf16 v48, v24, s30, v48
    v_dot2_f32_bf16 v50, v24, v40, v50
    v_dot2_f32_bf16 v49, v25, v25, v49
    v_dot2_f32_bf16 v48, v25, s30, v48
    v_dot2_f32_bf16 v50, v25, v41, v50
    v_dot2_f32_bf16 v49, v26, v26, v49
    v_dot2_f32_bf16 v48, v26, s30, v48
    v_dot2_f32_bf16 v50, v26, v42, v50
    v_dot2_f32_bf16 v49, v27, v27, v49
    v_dot2_f32_bf16 v48, v27, s30, v48
    v_dot2_f32_bf16 v50, v27, v43, v50
    s_waitcnt vmcnt(0)
    v_dot2_f32_bf16 v49, v28, v28, v49
    v_dot2_f32_bf16 v48, v28, s30, v48
    v_dot2_f32_bf16 v50, v28, v44, v50
    v_dot2_f32_bf16 v49, v29, v29, v49
    v_dot2_f32_bf16 v48, v29, s30, v48
    v_dot2_f32_bf16 v50, v29, v45, v50
    v_dot2_f32_bf16 v49, v30, v30, v49
    v_dot2_f32_bf16 v48, v30, s30, v48
    v_dot2_f32_bf16 v50, v30, v46, v50
    v_dot2_f32_bf16 v49, v31, v31, v49
    v_dot2_f32_bf16 v48, v31, s30, v48
    v_dot2_f32_bf16 v50, v31, v47, v50
    v_add_f32_dpp v51, v51, v51 quad_perm:[1,0,3,2] row_mask:0xf bank_mask:0xf
    v_add_f32_dpp v49, v49, v49 quad_perm:[1,0,3,2] row_mask:0xf bank_mask:0xf
    v_add_f32_dpp v48, v48, v48 quad_perm:[1,0,3,2] row_mask:0xf bank_mask:0xf
    v_add_f32_dpp v50, v50, v50 quad_perm:[1,0,3,2] row_mask:0xf bank_mask:0xf
    v_add_f32_dpp v51, v51, v51 quad_perm:[2,3,0,1] row_mask:0xf bank_mask:0xf
    v_add_f32_dpp v49, v49, v49 quad_perm:[2,3,0,1] row_mask:0xf bank_mask:0xf
    v_add_f32_dpp v48, v48, v48 quad_perm:[2,3,0,1] row_mask:0xf bank_mask:0xf
    v_add_f32_dpp v50, v50, v50 quad_perm:[2,3,0,1] row_mask:0xf bank_mask:0xf
    v_add_f32_dpp v51, v51, v51 row_half_mirror row_mask:0xf bank_mask:0xf
    v_add_f32_dpp v49, v49, v49 row_half_mirror row_mask:0xf bank_mask:0xf
    v_add_f32_dpp v48, v48, v48 row_half_mirror row_mask:0xf bank_mask:0xf
    v_add_f32_dpp v50, v50, v50 row_half_mirror row_mask:0xf bank_mask:0xf
    v_and_b32 v49, 0x7fffffff, v49
    s_mov_b32 exec_lo, 0x01010101
    s_mov_b32 exec_hi, 0x01010101
    ds_write_b128 v120, v[48:51] offset:128
    s_mov_b64 exec, -1
    s_mov_b32 s46, 0
    ds_read_b128 v[60:63], v117 offset:128
    ds_read_b128 v[64:67], v117 offset:256
    ds_read_b128 v[68:71], v117 offset:384
    ds_read_b128 v[72:75], v117 offset:512
    v_lshlrev_b32 v80, 16, v16
    v_and_b32 v81, 0xffff0000, v16
    v_lshlrev_b32 v82, 16, v17
    v_and_b32 v83, 0xffff0000, v17
    v_lshlrev_b32 v84, 16, v18
    v_and_b32 v85, 0xffff0000, v18
    v_lshlrev_b32 v86, 16, v19
    v_and_b32 v87, 0xffff0000, v19
    v_lshlrev_b32 v88, 16, v20
    v_and_b32 v89, 0xffff0000, v20
    v_lshlrev_b32 v90, 16, v21
    v_and_b32 v91, 0xffff0000, v21
    v_lshlrev_b32 v92, 16, v22
    v_and_b32 v93, 0xffff0000, v22
    s_branch L_spc_4
L_sp_2:
    ds_read_b128 v[60:63], v117 offset:128
    ds_read_b128 v[64:67], v117 offset:256
    ds_read_b128 v[68:71], v117 offset:384
    ds_read_b128 v[72:75], v117 offset:512
L_spc_4:
    s_waitcnt lgkmcnt(0)
    v_or3_b32 v52, v61, v65, v69
    v_or_b32 v52, v52, v73
    v_cmp_gt_i32 vcc, 0, v52
    s_cbranch_vccz L_spd_3
    s_add_u32 s46, s46, 1
    s_cmp_lt_u32 s46, 400000
    s_cbranch_scc1 L_sp_2
    s_branch L_end
L_spd_3:
    v_pk_add_f32 v[60:61], v[60:61], v[64:65]
    v_pk_add_f32 v[68:69], v[68:69], v[72:73]
    v_pk_add_f32 v[62:63], v[62:63], v[66:67]
    v_pk_add_f32 v[70:71], v[70:71], v[74:75]
    v_pk_add_f32 v[60:61], v[60:61], v[68:69]
    v_pk_add_f32 v[62:63], v[62:63], v[70:71]
    v_mul_f32 v48, 0x3a800000, v60
    v_mul_f32 v49, 0x3a800000, v61
    v_fma_f32 v49, -v48, v48, v49
    v_max_f32 v49, 0, v49
    v_cvt_pk_bf16_f32 v54, v48, v49
    v_and_b32 v49, 0xffff0000, v54
    v_add_f32 v49, 0x3727c5ac, v49
    v_cvt_pk_bf16_f32 v49, v49, v49
    v_and_b32 v49, 0xffff0000, v49
    v_sqrt_f32 v49, v49
    v_lshlrev_b32 v54, 16, v54
    v_cvt_pk_bf16_f32 v52, v48, v49
    v_and_b32 v49, 0xffff0000, v52
    v_rcp_f32 v55, v49
    v_fma_f32 v53, -v54, v63, v62
    s_cmp_lg_u32 s34, 0
    s_cbranch_scc1 L_nohdr_5
    v_mul_f32 v53, v53, v55
    s_brev_b32 s40, 1
    v_cvt_pk_bf16_f32 v53, v53, v53
    v_ashrrev_i32 v49, 31, v53
    v_bitop3_b32 v53, v53, v49, s40 bitop3:0x1e
    v_and_or_b32 v53, v53, s31, v119
    s_mov_b32 exec_lo, 0x01010101
    s_mov_b32 exec_hi, 0x01010101
    global_store_dwordx2 v118, v[52:53], s[48:49]
    global_store_dwordx2 v118, v[52:53], s[62:63] sc1
    s_mov_b64 exec, -1
L_nohdr_5:
    v_mul_f32 v56, 0xbfb8aa3b, v55
    v_lshlrev_b32 v94, 16, v23
    v_and_b32 v95, 0xffff0000, v23
    v_mul_f32 v58, -v54, v56
    v_lshlrev_b32 v96, 16, v24
    v_and_b32 v97, 0xffff0000, v24
    v_lshlrev_b32 v98, 16, v25
    v_and_b32 v99, 0xffff0000, v25
    v_lshlrev_b32 v100, 16, v26
    v_and_b32 v101, 0xffff0000, v26
    v_lshlrev_b32 v102, 16, v27
    v_and_b32 v103, 0xffff0000, v27
    v_lshlrev_b32 v104, 16, v28
    v_and_b32 v105, 0xffff0000, v28
    v_lshlrev_b32 v106, 16, v29
    v_and_b32 v107, 0xffff0000, v29
    v_lshlrev_b32 v108, 16, v30
    v_and_b32 v109, 0xffff0000, v30
    v_lshlrev_b32 v110, 16, v31
    v_and_b32 v111, 0xffff0000, v31
    v_pk_fma_f32 v[80:81], v[80:81], v[56:57], v[58:59] op_sel_hi:[1,0,0]
    v_pk_fma_f32 v[82:83], v[82:83], v[56:57], v[58:59] op_sel_hi:[1,0,0]
    v_pk_fma_f32 v[84:85], v[84:85], v[56:57], v[58:59] op_sel_hi:[1,0,0]
    v_pk_fma_f32 v[86:87], v[86:87], v[56:57], v[58:59] op_sel_hi:[1,0,0]
    v_cvt_pk_f16_f32 v16, v80, v81
    v_cvt_pk_f16_f32 v17, v82, v83
    v_cvt_pk_f16_f32 v18, v84, v85
    v_cvt_pk_f16_f32 v19, v86, v87
    ds_write_b128 v114, v[16:19] offset:0
    v_pk_fma_f32 v[88:89], v[88:89], v[56:57], v[58:59] op_sel_hi:[1,0,0]
    v_pk_fma_f32 v[90:91], v[90:91], v[56:57], v[58:59] op_sel_hi:[1,0,0]
    v_pk_fma_f32 v[92:93], v[92:93], v[56:57], v[58:59] op_sel_hi:[1,0,0]
    v_pk_fma_f32 v[94:95], v[94:95], v[56:57], v[58:59] op_sel_hi:[1,0,0]
    v_cvt_pk_f16_f32 v20, v88, v89
    v_cvt_pk_f16_f32 v21, v90, v91
    v_cvt_pk_f16_f32 v22, v92, v93
    v_cvt_pk_f16_f32 v23, v94, v95
    ds_write_b128 v114, v[20:23] offset:128
    v_pk_fma_f32 v[96:97], v[96:97], v[56:57], v[58:59] op_sel_hi:[1,0,0]
    v_pk_fma_f32 v[98:99], v[98:99], v[56:57], v[58:59] op_sel_hi:[1,0,0]
    v_pk_fma_f32 v[100:101], v[100:101], v[56:57], v[58:59] op_sel_hi:[1,0,0]
    v_pk_fma_f32 v[102:103], v[102:103], v[56:57], v[58:59] op_sel_hi:[1,0,0]
    v_cvt_pk_f16_f32 v24, v96, v97
    v_cvt_pk_f16_f32 v25, v98, v99
    v_cvt_pk_f16_f32 v26, v100, v101
    v_cvt_pk_f16_f32 v27, v102, v103
    ds_write_b128 v114, v[24:27] offset:256
    v_pk_fma_f32 v[104:105], v[104:105], v[56:57], v[58:59] op_sel_hi:[1,0,0]
    v_pk_fma_f32 v[106:107], v[106:107], v[56:57], v[58:59] op_sel_hi:[1,0,0]
    v_pk_fma_f32 v[108:109], v[108:109], v[56:57], v[58:59] op_sel_hi:[1,0,0]
    v_pk_fma_f32 v[110:111], v[110:111], v[56:57], v[58:59] op_sel_hi:[1,0,0]
    v_cvt_pk_f16_f32 v28, v104, v105
    v_cvt_pk_f16_f32 v29, v106, v107
    v_cvt_pk_f16_f32 v30, v108, v109
    v_cvt_pk_f16_f32 v31, v110, v111
    ds_write_b128 v114, v[28:31] offset:384
    ds_read_b64_tr_b16 v[32:33], v115 offset:0
    ds_read_b64_tr_b16 v[34:35], v115 offset:18496
    ds_read_b64_tr_b16 v[36:37], v115 offset:16
    ds_read_b64_tr_b16 v[38:39], v115 offset:18512
    ds_read_b64_tr_b16 v[40:41], v115 offset:32
    ds_read_b64_tr_b16 v[42:43], v115 offset:18528
    ds_read_b64_tr_b16 v[44:45], v115 offset:48
    ds_read_b64_tr_b16 v[46:47], v115 offset:18544
    s_mov_b32 s22, 0x00010001
    s_cmp_lt_u32 s36, 28
    s_cbranch_scc1 L_nold_6
    s_mov_b32 s46, 0
L_sp_7:
    ds_read_b32 v59, v3 offset:60
    s_waitcnt lgkmcnt(0)
    v_cmp_gt_u32 vcc, 4, v59
    s_cbranch_vccz L_spd_8
    s_add_u32 s46, s46, 1
    s_sleep 1
    s_cmp_lt_u32 s46, 400000
    s_cbranch_scc1 L_sp_7
    s_branch L_end
L_spd_8:
L_nold_6:
    s_waitcnt lgkmcnt(6)
    v_bfi_b32 v32, s22, v12, v32
    v_bfi_b32 v33, s22, v13, v33
    v_bfi_b32 v34, s22, v14, v34
    v_bfi_b32 v35, s22, v15, v35
    global_store_dwordx4 v116, v[32:35], s[52:53] sc1
    s_add_u32 s52, s52, 32768
    s_addc_u32 s53, s53, 0
    s_waitcnt lgkmcnt(4)
    v_bfi_b32 v36, s22, v12, v36
    v_bfi_b32 v37, s22, v13, v37
    v_bfi_b32 v38, s22, v14, v38
    v_bfi_b32 v39, s22, v15, v39
    global_store_dwordx4 v116, v[36:39], s[52:53] sc1
    s_add_u32 s52, s52, 32768
    s_addc_u32 s53, s53, 0
    s_waitcnt lgkmcnt(2)
    v_bfi_b32 v40, s22, v12, v40
    v_bfi_b32 v41, s22, v13, v41
    v_bfi_b32 v42, s22, v14, v42
    v_bfi_b32 v43, s22, v15, v43
    global_store_dwordx4 v116, v[40:43], s[52:53] sc1
    s_add_u32 s52, s52, 32768
    s_addc_u32 s53, s53, 0
    s_waitcnt lgkmcnt(0)
    v_bfi_b32 v44, s22, v12, v44
    v_bfi_b32 v45, s22, v13, v45
    v_bfi_b32 v46, s22, v14, v46
    v_bfi_b32 v47, s22, v15, v47
    global_store_dwordx4 v116, v[44:47], s[52:53] sc1
    s_cmp_lg_u32 s34, 3
    s_cbranch_scc1 L_nomb_9
    s_mov_b32 s46, 0
L_mb_11:
    s_load_dwordx16 s[4:19], s[58:59], 0 glc
    s_load_dwordx16 s[64:79], s[58:59], 64 glc
    s_add_u32 s46, s46, 1
    s_cmp_gt_u32 s46, 50000
    s_cbranch_scc1 L_end
    s_waitcnt lgkmcnt(0)
    s_xor_b32 s40, s6, s39
    s_xor_b32 s41, s10, s39
    s_or_b32 s40, s40, s41
    s_xor_b32 s41, s14, s39
    s_or_b32 s40, s40, s41
    s_xor_b32 s41, s18, s39
    s_or_b32 s40, s40, s41
    s_xor_b32 s41, s66, s39
    s_or_b32 s40, s40, s41
    s_xor_b32 s41, s70, s39
    s_or_b32 s40, s40, s41
    s_xor_b32 s41, s74, s39
    s_or_b32 s40, s40, s41
    s_xor_b32 s41, s78, s39
    s_or_b32 s40, s40, s41
    s_cbranch_scc1 L_mb_11
    s_min_u32 s40, s4, s8
    s_max_u32 s4, s4, s8
    s_max_u32 s5, s5, s9
    s_max_u32 s5, s5, s40
    s_min_u32 s40, s4, s12
    s_max_u32 s4, s4, s12
    s_max_u32 s5, s5, s13
    s_max_u32 s5, s5, s40
    s_min_u32 s40, s4, s16
    s_max_u32 s4, s4, s16
    s_max_u32 s5, s5, s17
    s_max_u32 s5, s5, s40
    s_min_u32 s40, s4, s64
    s_max_u32 s4, s4, s64
    s_max_u32 s5, s5, s65
    s_max_u32 s5, s5, s40
    s_min_u32 s40, s4, s68
    s_max_u32 s4, s4, s68
    s_max_u32 s5, s5, s69
    s_max_u32 s5, s5, s40
    s_min_u32 s40, s4, s72
    s_max_u32 s4, s4, s72
    s_max_u32 s5, s5, s73
    s_max_u32 s5, s5, s40
    s_min_u32 s40, s4, s76
    s_max_u32 s4, s4, s76
    s_max_u32 s5, s5, s77
    s_max_u32 s5, s5, s40
    v_mov_b32 v48, s4
    v_mov_b32 v49, s5
    s_mov_b64 exec, 1
    ds_write_b64 v3, v[48:49] offset:32
    s_mov_b64 exec, -1
    s_branch L_gottop_10
L_nomb_9:
    s_mov_b32 s46, 0
L_sp_12:
    ds_read_b64 v[48:49], v3 offset:32
    s_waitcnt lgkmcnt(0)
    v_cmp_eq_u32 vcc, 0, v48
    s_cbranch_vccz L_spd_13
    s_add_u32 s46, s46, 1
    s_sleep 1
    s_cmp_lt_u32 s46, 400000
    s_cbranch_scc1 L_sp_12
    s_branch L_end
L_spd_13:
L_gottop_10:
    s_mov_b32 vcc_lo, 0xff00ff00
    s_mov_b32 vcc_hi, 0xff00ff00
    s_movk_i32 s40, 2047
    v_cndmask_b32 v54, v48, v49, vcc
    v_bfi_b32 v56, v54, 0, s40
    v_lshl_add_u32 v55, v56, 11, v10
    v_lshlrev_b32 v56, 3, v56
    global_load_dwordx2 v[50:51], v55, s[60:61]
    global_load_dwordx2 v[52:53], v56, s[50:51] sc1
    s_cmp_ge_u32 s21, 6
    s_cselect_b64 s[56:57], s[54:55], s[56:57]
    global_load_dwordx4 v[32:35], v2, s[56:57] offset:0 sc1
    global_load_dwordx4 v[36:39], v2, s[56:57] offset:1024 sc1
    global_load_dwordx4 v[40:43], v2, s[56:57] offset:2048 sc1
    global_load_dwordx4 v[44:47], v2, s[56:57] offset:3072 sc1
    global_load_dwordx4 v[16:19], v2, s[54:55] offset:0 sc1
    global_load_dwordx4 v[20:23], v2, s[54:55] offset:1024 sc1
    global_load_dwordx4 v[24:27], v2, s[54:55] offset:2048 sc1
    global_load_dwordx4 v[28:31], v2, s[54:55] offset:3072 sc1
    global_load_dwordx4 v[60:63], v7, s[50:51] offset:0 sc1
    global_load_dwordx4 v[64:67], v7, s[50:51] offset:16 sc1
    v_and_or_b32 v54, v54, s31, v119
    s_mov_b32 s46, 0
    s_waitcnt vmcnt(10)
L_xc_15:
    v_cmp_ne_u32 vcc, v54, v53
    v_and_b32 v55, 0xffff0000, v52
    s_cbranch_vccz L_xo_16
    global_load_dwordx2 v[52:53], v56, s[50:51] sc1
    s_add_u32 s46, s46, 1
    s_cmp_lt_u32 s46, 50000
    s_waitcnt vmcnt(0)
    s_cbranch_scc1 L_xc_15
    s_branch L_end
L_xo_16:
    v_rcp_f32 v55, v55
    v_lshlrev_b32 v52, 16, v52
    v_lshlrev_b32 v68, 16, v50
    v_and_b32 v69, 0xffff0000, v50
    v_mul_f32 v52, -v52, v55
    v_lshlrev_b32 v70, 16, v51
    v_and_b32 v71, 0xffff0000, v51
    v_fma_f32 v68, v68, v55, v52
    v_fma_f32 v69, v69, v55, v52
    v_fma_f32 v70, v70, v55, v52
    v_fma_f32 v71, v71, v55, v52
    s_lshl_b32 s40, s34, 10
    s_lshl_b32 s41, s34, 2
    v_cvt_pk_bf16_f32 v68, v68, v68
    v_cvt_pk_bf16_f32 v69, v69, v69
    v_cvt_pk_bf16_f32 v70, v70, v70
    v_cvt_pk_bf16_f32 v71, v71, v71
    v_add_u32 v55, s40, v2
    v_mov_b32 v72, 1
    v_mov_b32 v73, s41
    ds_write_b128 v55, v[68:71] offset:640
    s_mov_b64 exec, 1
    ds_write_b32 v73, v72 offset:80
    s_mov_b64 exec, -1
    s_mov_b32 s46, 0
L_pa_17:
    s_waitcnt vmcnt(9)
    ds_write_b128 v9, v[32:35] offset:0
    v_xor_b32 v57, v32, v12
    v_bitop3_b32 v57, v57, v33, v13 bitop3:0xf6
    v_bitop3_b32 v57, v57, v34, v14 bitop3:0xf6
    v_bitop3_b32 v57, v57, v35, v15 bitop3:0xf6
    s_waitcnt vmcnt(8)
    ds_write_b128 v9, v[36:39] offset:128
    v_bitop3_b32 v57, v57, v36, v12 bitop3:0xf6
    v_bitop3_b32 v57, v57, v37, v13 bitop3:0xf6
    v_bitop3_b32 v57, v57, v38, v14 bitop3:0xf6
    v_bitop3_b32 v57, v57, v39, v15 bitop3:0xf6
    s_waitcnt vmcnt(7)
    ds_write_b128 v9, v[40:43] offset:256
    v_bitop3_b32 v57, v57, v40, v12 bitop3:0xf6
    v_bitop3_b32 v57, v57, v41, v13 bitop3:0xf6
    v_bitop3_b32 v57, v57, v42, v14 bitop3:0xf6
    v_bitop3_b32 v57, v57, v43, v15 bitop3:0xf6
    s_waitcnt vmcnt(6)
    ds_write_b128 v9, v[44:47] offset:384
    v_bitop3_b32 v57, v57, v44, v12 bitop3:0xf6
    v_bitop3_b32 v57, v57, v45, v13 bitop3:0xf6
    v_bitop3_b32 v57, v57, v46, v14 bitop3:0xf6
    v_bitop3_b32 v57, v57, v47, v15 bitop3:0xf6
    s_waitcnt vmcnt(5)
    ds_write_b128 v8, v[16:19] offset:0
    v_bitop3_b32 v57, v57, v16, v12 bitop3:0xf6
    v_bitop3_b32 v57, v57, v17, v13 bitop3:0xf6
    v_bitop3_b32 v57, v57, v18, v14 bitop3:0xf6
    v_bitop3_b32 v57, v57, v19, v15 bitop3:0xf6
    s_waitcnt vmcnt(4)
    ds_write_b128 v8, v[20:23] offset:128
    v_bitop3_b32 v57, v57, v20, v12 bitop3:0xf6
    v_bitop3_b32 v57, v57, v21, v13 bitop3:0xf6
    v_bitop3_b32 v57, v57, v22, v14 bitop3:0xf6
    v_bitop3_b32 v57, v57, v23, v15 bitop3:0xf6
    s_waitcnt vmcnt(3)
    ds_write_b128 v8, v[24:27] offset:256
    v_bitop3_b32 v57, v57, v24, v12 bitop3:0xf6
    v_bitop3_b32 v57, v57, v25, v13 bitop3:0xf6
    v_bitop3_b32 v57, v57, v26, v14 bitop3:0xf6
    v_bitop3_b32 v57, v57, v27, v15 bitop3:0xf6
    s_waitcnt vmcnt(2)
    ds_write_b128 v8, v[28:31] offset:384
    v_bitop3_b32 v57, v57, v28, v12 bitop3:0xf6
    v_bitop3_b32 v57, v57, v29, v13 bitop3:0xf6
    v_bitop3_b32 v57, v57, v30, v14 bitop3:0xf6
    v_bitop3_b32 v57, v57, v31, v15 bitop3:0xf6
    v_and_b32 v57, 0x00010001, v57
    v_cmp_ne_u32 vcc, 0, v57
    s_cbranch_vccz L_po_18
    global_load_dwordx4 v[32:35], v2, s[56:57] offset:0 sc1
    global_load_dwordx4 v[36:39], v2, s[56:57] offset:1024 sc1
    global_load_dwordx4 v[40:43], v2, s[56:57] offset:2048 sc1
    global_load_dwordx4 v[44:47], v2, s[56:57] offset:3072 sc1
    global_load_dwordx4 v[16:19], v2, s[54:55] offset:0 sc1
    global_load_dwordx4 v[20:23], v2, s[54:55] offset:1024 sc1
    global_load_dwordx4 v[24:27], v2, s[54:55] offset:2048 sc1
    global_load_dwordx4 v[28:31], v2, s[54:55] offset:3072 sc1
    global_load_dwordx4 v[60:63], v7, s[50:51] offset:0 sc1
    global_load_dwordx4 v[64:67], v7, s[50:51] offset:16 sc1
    s_add_u32 s46, s46, 1
    s_cmp_lt_u32 s46, 50000
    s_cbranch_scc1 L_pa_17
    s_branch L_end
L_po_18:
    s_mov_b64 exec, 1
    ds_add_u32 v3, v72 offset:48
    s_mov_b64 exec, -1
    s_setprio 0
    ds_read_b64 v[112:113], v6 offset:0
    ds_read_b64 v[114:115], v6 offset:4624
    ds_read_b64 v[116:117], v6 offset:9248
    ds_read_b64 v[118:119], v6 offset:13872
    ds_read_b64 v[120:121], v6 offset:18496
    ds_read_b64 v[122:123], v6 offset:23120
    ds_read_b64 v[124:125], v6 offset:27744
    ds_read_b64 v[126:127], v6 offset:32368
    s_movk_i32 s40, 2047
    v_bfi_b32 v96, v48, 0, s40
    v_bfi_b32 v97, v49, 0, s40
    v_lshrrev_b32 v98, 3, v7
    v_sub_u32 v96, v96, v98
    v_sub_u32 v97, v97, v98
    v_cmp_ne_u32 s[4:5], 0, v96
    v_cmp_ne_u32 vcc, 0, v97
    s_and_b64 s[4:5], s[4:5], vcc
    v_cmp_ne_u32 s[6:7], 1, v96
    v_cmp_ne_u32 vcc, 1, v97
    s_and_b64 s[6:7], s[6:7], vcc
    v_cmp_ne_u32 s[8:9], 2, v96
    v_cmp_ne_u32 vcc, 2, v97
    s_and_b64 s[8:9], s[8:9], vcc
    v_cmp_ne_u32 s[10:11], 3, v96
    v_cmp_ne_u32 vcc, 3, v97
    s_and_b64 s[10:11], s[10:11], vcc
    s_and_b32 s42, s39, 0xffff
    s_mov_b32 s46, 0
L_ra_19:
    s_waitcnt vmcnt(0)
    v_xor_b32 v96, s42, v61
    v_bitop3_b32 v96, v96, v63, s42 bitop3:0xf6
    v_bitop3_b32 v96, v96, v65, s42 bitop3:0xf6
    v_bitop3_b32 v96, v96, v67, s42 bitop3:0xf6
    v_and_b32 v96, 0xffff, v96
    v_cmp_ne_u32 vcc, 0, v96
    s_cbranch_vccz L_ro_20
    global_load_dwordx4 v[60:63], v7, s[50:51] offset:0 sc1
    global_load_dwordx4 v[64:67], v7, s[50:51] offset:16 sc1
    s_add_u32 s46, s46, 1
    s_cmp_lt_u32 s46, 50000
    s_cbranch_scc1 L_ra_19
    s_branch L_end
L_ro_20:
    v_and_b32 v92, 0xffff0000, v60
    v_lshlrev_b32 v88, 16, v60
    v_mul_f32 v92, 0xbf317218, v92
    v_and_b32 v93, 0xffff0000, v62
    v_lshlrev_b32 v89, 16, v62
    v_mul_f32 v93, 0xbf317218, v93
    v_and_b32 v94, 0xffff0000, v64
    v_lshlrev_b32 v90, 16, v64
    v_mul_f32 v94, 0xbf317218, v94
    v_and_b32 v95, 0xffff0000, v66
    v_lshlrev_b32 v91, 16, v66
    v_mul_f32 v95, 0xbf317218, v95
    v_mov_b32 v10, v73
    s_mov_b32 s46, 0
L_sp_21:
    ds_read_b128 v[80:83], v3 offset:0
    ds_read_b128 v[84:87], v3 offset:16
    s_waitcnt lgkmcnt(0)
    v_min3_u32 v96, v80, v81, v82
    v_min3_u32 v96, v96, v83, v84
    v_min3_u32 v96, v96, v85, v86
    v_min_u32 v96, v96, v87
    v_cmp_eq_u32 vcc, 0, v96
    s_cbranch_vccz L_spd_22
    s_add_u32 s46, s46, 1
    s_sleep 1
    s_cmp_lt_u32 s46, 400000
    s_cbranch_scc1 L_sp_21
    s_branch L_end
L_spd_22:
    v_exp_f16 v96, v112
    v_exp_f16_sdwa v97, v112 dst_sel:DWORD dst_unused:UNUSED_PAD src0_sel:WORD_1
    v_exp_f16 v98, v113
    v_exp_f16_sdwa v99, v113 dst_sel:DWORD dst_unused:UNUSED_PAD src0_sel:WORD_1
    v_fma_mix_f32 v96, v96, v80, v80 op_sel:[0,0,0] op_sel_hi:[1,0,0]
    v_fma_mix_f32 v97, v97, v80, v80 op_sel:[0,0,0] op_sel_hi:[1,0,0]
    v_fma_mix_f32 v98, v98, v80, v80 op_sel:[0,0,0] op_sel_hi:[1,0,0]
    v_fma_mix_f32 v99, v99, v80, v80 op_sel:[0,0,0] op_sel_hi:[1,0,0]
    v_rcp_f32 v96, v96
    v_rcp_f32 v97, v97
    v_rcp_f32 v98, v98
    v_rcp_f32 v99, v99
    v_fma_mix_f32 v48, v112, v92, v88 op_sel:[0,0,0] op_sel_hi:[1,0,0]
    v_fma_mix_f32 v49, v112, v93, v89 op_sel:[1,0,0] op_sel_hi:[1,0,0]
    v_fma_mix_f32 v50, v113, v94, v90 op_sel:[0,0,0] op_sel_hi:[1,0,0]
    v_fma_mix_f32 v51, v113, v95, v91 op_sel:[1,0,0] op_sel_hi:[1,0,0]
    v_fma_mix_f32 v16, v112, v96, 0 op_sel:[0,0,0] op_sel_hi:[1,0,0]
    v_fma_mix_f32 v17, v112, v97, 0 op_sel:[1,0,0] op_sel_hi:[1,0,0]
    v_fma_mix_f32 v18, v113, v98, 0 op_sel:[0,0,0] op_sel_hi:[1,0,0]
    v_fma_mix_f32 v19, v113, v99, 0 op_sel:[1,0,0] op_sel_hi:[1,0,0]
    v_exp_f16 v96, v114
    v_exp_f16_sdwa v97, v114 dst_sel:DWORD dst_unused:UNUSED_PAD src0_sel:WORD_1
    v_exp_f16 v98, v115
    v_exp_f16_sdwa v99, v115 dst_sel:DWORD dst_unused:UNUSED_PAD src0_sel:WORD_1
    v_fma_mix_f32 v96, v96, v81, v81 op_sel:[0,0,0] op_sel_hi:[1,0,0]
    v_fma_mix_f32 v97, v97, v81, v81 op_sel:[0,0,0] op_sel_hi:[1,0,0]
    v_fma_mix_f32 v98, v98, v81, v81 op_sel:[0,0,0] op_sel_hi:[1,0,0]
    v_fma_mix_f32 v99, v99, v81, v81 op_sel:[0,0,0] op_sel_hi:[1,0,0]
    v_rcp_f32 v96, v96
    v_rcp_f32 v97, v97
    v_rcp_f32 v98, v98
    v_rcp_f32 v99, v99
    v_fma_mix_f32 v52, v114, v92, v88 op_sel:[0,0,0] op_sel_hi:[1,0,0]
    v_fma_mix_f32 v53, v114, v93, v89 op_sel:[1,0,0] op_sel_hi:[1,0,0]
    v_fma_mix_f32 v54, v115, v94, v90 op_sel:[0,0,0] op_sel_hi:[1,0,0]
    v_fma_mix_f32 v55, v115, v95, v91 op_sel:[1,0,0] op_sel_hi:[1,0,0]
    v_fma_mix_f32 v20, v114, v96, 0 op_sel:[0,0,0] op_sel_hi:[1,0,0]
    v_fma_mix_f32 v21, v114, v97, 0 op_sel:[1,0,0] op_sel_hi:[1,0,0]
    v_fma_mix_f32 v22, v115, v98, 0 op_sel:[0,0,0] op_sel_hi:[1,0,0]
    v_fma_mix_f32 v23, v115, v99, 0 op_sel:[1,0,0] op_sel_hi:[1,0,0]
    v_exp_f16 v96, v116
    v_exp_f16_sdwa v97, v116 dst_sel:DWORD dst_unused:UNUSED_PAD src0_sel:WORD_1
    v_exp_f16 v98, v117
    v_exp_f16_sdwa v99, v117 dst_sel:DWORD dst_unused:UNUSED_PAD src0_sel:WORD_1
    v_fma_mix_f32 v96, v96, v82, v82 op_sel:[0,0,0] op_sel_hi:[1,0,0]
    v_fma_mix_f32 v97, v97, v82, v82 op_sel:[0,0,0] op_sel_hi:[1,0,0]
    v_fma_mix_f32 v98, v98, v82, v82 op_sel:[0,0,0] op_sel_hi:[1,0,0]
    v_fma_mix_f32 v99, v99, v82, v82 op_sel:[0,0,0] op_sel_hi:[1,0,0]
    v_rcp_f32 v96, v96
    v_rcp_f32 v97, v97
    v_rcp_f32 v98, v98
    v_rcp_f32 v99, v99
    v_fma_mix_f32 v56, v116, v92, v88 op_sel:[0,0,0] op_sel_hi:[1,0,0]
    v_fma_mix_f32 v57, v116, v93, v89 op_sel:[1,0,0] op_sel_hi:[1,0,0]
    v_fma_mix_f32 v58, v117, v94, v90 op_sel:[0,0,0] op_sel_hi:[1,0,0]
    v_fma_mix_f32 v59, v117, v95, v91 op_sel:[1,0,0] op_sel_hi:[1,0,0]
    v_fma_mix_f32 v24, v116, v96, 0 op_sel:[0,0,0] op_sel_hi:[1,0,0]
    v_fma_mix_f32 v25, v116, v97, 0 op_sel:[1,0,0] op_sel_hi:[1,0,0]
    v_fma_mix_f32 v26, v117, v98, 0 op_sel:[0,0,0] op_sel_hi:[1,0,0]
    v_fma_mix_f32 v27, v117, v99, 0 op_sel:[1,0,0] op_sel_hi:[1,0,0]
    v_exp_f16 v96, v118
    v_exp_f16_sdwa v97, v118 dst_sel:DWORD dst_unused:UNUSED_PAD src0_sel:WORD_1
    v_exp_f16 v98, v119
    v_exp_f16_sdwa v99, v119 dst_sel:DWORD dst_unused:UNUSED_PAD src0_sel:WORD_1
    v_fma_mix_f32 v96, v96, v83, v83 op_sel:[0,0,0] op_sel_hi:[1,0,0]
    v_fma_mix_f32 v97, v97, v83, v83 op_sel:[0,0,0] op_sel_hi:[1,0,0]
    v_fma_mix_f32 v98, v98, v83, v83 op_sel:[0,0,0] op_sel_hi:[1,0,0]
    v_fma_mix_f32 v99, v99, v83, v83 op_sel:[0,0,0] op_sel_hi:[1,0,0]
    v_rcp_f32 v96, v96
    v_rcp_f32 v97, v97
    v_rcp_f32 v98, v98
    v_rcp_f32 v99, v99
    v_fma_mix_f32 v60, v118, v92, v88 op_sel:[0,0,0] op_sel_hi:[1,0,0]
    v_fma_mix_f32 v61, v118, v93, v89 op_sel:[1,0,0] op_sel_hi:[1,0,0]
    v_fma_mix_f32 v62, v119, v94, v90 op_sel:[0,0,0] op_sel_hi:[1,0,0]
    v_fma_mix_f32 v63, v119, v95, v91 op_sel:[1,0,0] op_sel_hi:[1,0,0]
    v_fma_mix_f32 v28, v118, v96, 0 op_sel:[0,0,0] op_sel_hi:[1,0,0]
    v_fma_mix_f32 v29, v118, v97, 0 op_sel:[1,0,0] op_sel_hi:[1,0,0]
    v_fma_mix_f32 v30, v119, v98, 0 op_sel:[0,0,0] op_sel_hi:[1,0,0]
    v_fma_mix_f32 v31, v119, v99, 0 op_sel:[1,0,0] op_sel_hi:[1,0,0]
    v_exp_f16 v96, v120
    v_exp_f16_sdwa v97, v120 dst_sel:DWORD dst_unused:UNUSED_PAD src0_sel:WORD_1
    v_exp_f16 v98, v121
    v_exp_f16_sdwa v99, v121 dst_sel:DWORD dst_unused:UNUSED_PAD src0_sel:WORD_1
    v_fma_mix_f32 v96, v96, v84, v84 op_sel:[0,0,0] op_sel_hi:[1,0,0]
    v_fma_mix_f32 v97, v97, v84, v84 op_sel:[0,0,0] op_sel_hi:[1,0,0]
    v_fma_mix_f32 v98, v98, v84, v84 op_sel:[0,0,0] op_sel_hi:[1,0,0]
    v_fma_mix_f32 v99, v99, v84, v84 op_sel:[0,0,0] op_sel_hi:[1,0,0]
    v_rcp_f32 v96, v96
    v_rcp_f32 v97, v97
    v_rcp_f32 v98, v98
    v_rcp_f32 v99, v99
    v_fma_mix_f32 v64, v120, v92, v88 op_sel:[0,0,0] op_sel_hi:[1,0,0]
    v_fma_mix_f32 v65, v120, v93, v89 op_sel:[1,0,0] op_sel_hi:[1,0,0]
    v_fma_mix_f32 v66, v121, v94, v90 op_sel:[0,0,0] op_sel_hi:[1,0,0]
    v_fma_mix_f32 v67, v121, v95, v91 op_sel:[1,0,0] op_sel_hi:[1,0,0]
    v_fma_mix_f32 v32, v120, v96, 0 op_sel:[0,0,0] op_sel_hi:[1,0,0]
    v_fma_mix_f32 v33, v120, v97, 0 op_sel:[1,0,0] op_sel_hi:[1,0,0]
    v_fma_mix_f32 v34, v121, v98, 0 op_sel:[0,0,0] op_sel_hi:[1,0,0]
    v_fma_mix_f32 v35, v121, v99, 0 op_sel:[1,0,0] op_sel_hi:[1,0,0]
    v_exp_f16 v96, v122
    v_exp_f16_sdwa v97, v122 dst_sel:DWORD dst_unused:UNUSED_PAD src0_sel:WORD_1
    v_exp_f16 v98, v123
    v_exp_f16_sdwa v99, v123 dst_sel:DWORD dst_unused:UNUSED_PAD src0_sel:WORD_1
    v_fma_mix_f32 v96, v96, v85, v85 op_sel:[0,0,0] op_sel_hi:[1,0,0]
    v_fma_mix_f32 v97, v97, v85, v85 op_sel:[0,0,0] op_sel_hi:[1,0,0]
    v_fma_mix_f32 v98, v98, v85, v85 op_sel:[0,0,0] op_sel_hi:[1,0,0]
    v_fma_mix_f32 v99, v99, v85, v85 op_sel:[0,0,0] op_sel_hi:[1,0,0]
    v_rcp_f32 v96, v96
    v_rcp_f32 v97, v97
    v_rcp_f32 v98, v98
    v_rcp_f32 v99, v99
    v_fma_mix_f32 v68, v122, v92, v88 op_sel:[0,0,0] op_sel_hi:[1,0,0]
    v_fma_mix_f32 v69, v122, v93, v89 op_sel:[1,0,0] op_sel_hi:[1,0,0]
    v_fma_mix_f32 v70, v123, v94, v90 op_sel:[0,0,0] op_sel_hi:[1,0,0]
    v_fma_mix_f32 v71, v123, v95, v91 op_sel:[1,0,0] op_sel_hi:[1,0,0]
    v_fma_mix_f32 v36, v122, v96, 0 op_sel:[0,0,0] op_sel_hi:[1,0,0]
    v_fma_mix_f32 v37, v122, v97, 0 op_sel:[1,0,0] op_sel_hi:[1,0,0]
    v_fma_mix_f32 v38, v123, v98, 0 op_sel:[0,0,0] op_sel_hi:[1,0,0]
    v_fma_mix_f32 v39, v123, v99, 0 op_sel:[1,0,0] op_sel_hi:[1,0,0]
    v_exp_f16 v96, v124
    v_exp_f16_sdwa v97, v124 dst_sel:DWORD dst_unused:UNUSED_PAD src0_sel:WORD_1
    v_exp_f16 v98, v125
    v_exp_f16_sdwa v99, v125 dst_sel:DWORD dst_unused:UNUSED_PAD src0_sel:WORD_1
    v_fma_mix_f32 v96, v96, v86, v86 op_sel:[0,0,0] op_sel_hi:[1,0,0]
    v_fma_mix_f32 v97, v97, v86, v86 op_sel:[0,0,0] op_sel_hi:[1,0,0]
    v_fma_mix_f32 v98, v98, v86, v86 op_sel:[0,0,0] op_sel_hi:[1,0,0]
    v_fma_mix_f32 v99, v99, v86, v86 op_sel:[0,0,0] op_sel_hi:[1,0,0]
    v_rcp_f32 v96, v96
    v_rcp_f32 v97, v97
    v_rcp_f32 v98, v98
    v_rcp_f32 v99, v99
    v_fma_mix_f32 v72, v124, v92, v88 op_sel:[0,0,0] op_sel_hi:[1,0,0]
    v_fma_mix_f32 v73, v124, v93, v89 op_sel:[1,0,0] op_sel_hi:[1,0,0]
    v_fma_mix_f32 v74, v125, v94, v90 op_sel:[0,0,0] op_sel_hi:[1,0,0]
    v_fma_mix_f32 v75, v125, v95, v91 op_sel:[1,0,0] op_sel_hi:[1,0,0]
    v_fma_mix_f32 v40, v124, v96, 0 op_sel:[0,0,0] op_sel_hi:[1,0,0]
    v_fma_mix_f32 v41, v124, v97, 0 op_sel:[1,0,0] op_sel_hi:[1,0,0]
    v_fma_mix_f32 v42, v125, v98, 0 op_sel:[0,0,0] op_sel_hi:[1,0,0]
    v_fma_mix_f32 v43, v125, v99, 0 op_sel:[1,0,0] op_sel_hi:[1,0,0]
    v_exp_f16 v96, v126
    v_exp_f16_sdwa v97, v126 dst_sel:DWORD dst_unused:UNUSED_PAD src0_sel:WORD_1
    v_exp_f16 v98, v127
    v_exp_f16_sdwa v99, v127 dst_sel:DWORD dst_unused:UNUSED_PAD src0_sel:WORD_1
    v_fma_mix_f32 v96, v96, v87, v87 op_sel:[0,0,0] op_sel_hi:[1,0,0]
    v_fma_mix_f32 v97, v97, v87, v87 op_sel:[0,0,0] op_sel_hi:[1,0,0]
    v_fma_mix_f32 v98, v98, v87, v87 op_sel:[0,0,0] op_sel_hi:[1,0,0]
    v_fma_mix_f32 v99, v99, v87, v87 op_sel:[0,0,0] op_sel_hi:[1,0,0]
    v_rcp_f32 v96, v96
    v_rcp_f32 v97, v97
    v_rcp_f32 v98, v98
    v_rcp_f32 v99, v99
    v_fma_mix_f32 v76, v126, v92, v88 op_sel:[0,0,0] op_sel_hi:[1,0,0]
    v_fma_mix_f32 v77, v126, v93, v89 op_sel:[1,0,0] op_sel_hi:[1,0,0]
    v_fma_mix_f32 v78, v127, v94, v90 op_sel:[0,0,0] op_sel_hi:[1,0,0]
    v_fma_mix_f32 v79, v127, v95, v91 op_sel:[1,0,0] op_sel_hi:[1,0,0]
    v_fma_mix_f32 v44, v126, v96, 0 op_sel:[0,0,0] op_sel_hi:[1,0,0]
    v_fma_mix_f32 v45, v126, v97, 0 op_sel:[1,0,0] op_sel_hi:[1,0,0]
    v_fma_mix_f32 v46, v127, v98, 0 op_sel:[0,0,0] op_sel_hi:[1,0,0]
    v_fma_mix_f32 v47, v127, v99, 0 op_sel:[1,0,0] op_sel_hi:[1,0,0]
    s_setprio 3
    s_mov_b32 s46, 0
L_sp_23:
    ds_read_b32 v96, v10 offset:64
    s_waitcnt lgkmcnt(0)
    v_cmp_gt_u32 vcc, 8, v96
    s_cbranch_vccz L_spd_24
    s_add_u32 s46, s46, 1
    s_sleep 1
    s_cmp_lt_u32 s46, 400000
    s_cbranch_scc1 L_sp_23
    s_branch L_end
L_spd_24:
    ds_read_b128 v[80:83], v5 offset:0
    ds_read_b128 v[84:87], v5 offset:14416
    ds_read_b128 v[88:91], v5 offset:28832
    ds_read_b128 v[92:95], v5 offset:43248
    ds_read_b128 v[96:99], v11 offset:0
    ds_read_b128 v[100:103], v11 offset:14416
    ds_read_b128 v[104:107], v11 offset:28832
    ds_read_b128 v[108:111], v11 offset:43248
    s_waitcnt lgkmcnt(6)
    v_fmac_f32 v48, v80, v16
    v_fmac_f32 v49, v81, v17
    v_fmac_f32 v50, v82, v18
    v_fmac_f32 v51, v83, v19
    v_fmac_f32 v52, v84, v20
    v_fmac_f32 v53, v85, v21
    v_fmac_f32 v54, v86, v22
    v_fmac_f32 v55, v87, v23
    v_cvt_pk_bf16_f32 v112, v48, v52
    v_cvt_pk_bf16_f32 v116, v49, v53
    v_cvt_pk_bf16_f32 v120, v50, v54
    v_cvt_pk_bf16_f32 v124, v51, v55
    s_waitcnt lgkmcnt(4)
    v_fmac_f32 v56, v88, v24
    v_fmac_f32 v57, v89, v25
    v_fmac_f32 v58, v90, v26
    v_fmac_f32 v59, v91, v27
    v_fmac_f32 v60, v92, v28
    v_fmac_f32 v61, v93, v29
    v_fmac_f32 v62, v94, v30
    v_fmac_f32 v63, v95, v31
    v_cvt_pk_bf16_f32 v113, v56, v60
    v_cvt_pk_bf16_f32 v117, v57, v61
    v_cvt_pk_bf16_f32 v121, v58, v62
    v_cvt_pk_bf16_f32 v125, v59, v63
    s_waitcnt lgkmcnt(2)
    v_fmac_f32 v64, v96, v32
    v_fmac_f32 v65, v97, v33
    v_fmac_f32 v66, v98, v34
    v_fmac_f32 v67, v99, v35
    v_fmac_f32 v68, v100, v36
    v_fmac_f32 v69, v101, v37
    v_fmac_f32 v70, v102, v38
    v_fmac_f32 v71, v103, v39
    v_cvt_pk_bf16_f32 v114, v64, v68
    v_cvt_pk_bf16_f32 v118, v65, v69
    v_cvt_pk_bf16_f32 v122, v66, v70
    v_cvt_pk_bf16_f32 v126, v67, v71
    s_waitcnt lgkmcnt(0)
    v_fmac_f32 v72, v104, v40
    v_fmac_f32 v73, v105, v41
    v_fmac_f32 v74, v106, v42
    v_fmac_f32 v75, v107, v43
    v_fmac_f32 v76, v108, v44
    v_fmac_f32 v77, v109, v45
    v_fmac_f32 v78, v110, v46
    v_fmac_f32 v79, v111, v47
    v_cvt_pk_bf16_f32 v115, v72, v76
    s_mov_b64 exec, s[4:5]
    global_store_dwordx4 v4, v[112:115], s[28:29] offset:-4096
    s_mov_b64 exec, -1
    v_cvt_pk_bf16_f32 v119, v73, v77
    s_mov_b64 exec, s[6:7]
    global_store_dwordx4 v4, v[116:119], s[28:29] offset:-2048
    s_mov_b64 exec, -1
    v_cvt_pk_bf16_f32 v123, v74, v78
    s_mov_b64 exec, s[8:9]
    global_store_dwordx4 v4, v[120:123], s[28:29] offset:0
    s_mov_b64 exec, -1
    v_cvt_pk_bf16_f32 v127, v75, v79
    s_mov_b64 exec, s[10:11]
    global_store_dwordx4 v4, v[124:127], s[28:29] offset:2048
    s_mov_b64 exec, -1
    s_or_b32 s40, s2, s3
    s_cbranch_scc1 L_fin
    s_add_u32 s40, s47, 1
    v_mov_b32 v5, s40
    s_mov_b64 exec, 1
    global_store_dword v3, v5, s[32:33]
    s_branch L_fin
L_exp:
    s_setprio 3
    v_lshrrev_b32 v16, 4, v1
    v_and_b32 v17, 240, v2
    s_lshr_b32 s40, s35, 1
    s_lshl2_add_u32 s40, s40, s34
    s_mul_i32 s40, s40, 458752
    s_lshl_b32 s41, s36, 8
    s_add_u32 s40, s40, s41
    v_mul_u32_u24 v4, 114688, v16
    v_add3_u32 v4, v4, v17, s40
    s_bitcmp1_b32 s35, 0
    s_cselect_b64 s[48:49], s[24:25], s[22:23]
    s_mov_b32 s46, 0
L_sp_25:
    ds_read_b64 v[18:19], v3 offset:40
    s_waitcnt lgkmcnt(0)
    v_cmp_eq_u32 vcc, 0, v19
    s_cbranch_vccz L_spd_26
    s_add_u32 s46, s46, 1
    s_cmp_lt_u32 s46, 400000
    s_cbranch_scc1 L_sp_25
    s_branch L_end
L_spd_26:
    v_readfirstlane_b32 s39, v18
    s_cmp_ge_u32 s36, 28
    s_cbranch_scc1 L_lead
    global_load_dwordx4 v[32:35], v4, s[48:49] nt
    s_add_u32 s48, s48, 7168
    s_addc_u32 s49, s49, 0
    global_load_dwordx4 v[36:39], v4, s[48:49] nt
    s_add_u32 s48, s48, 7168
    s_addc_u32 s49, s49, 0
    global_load_dwordx4 v[40:43], v4, s[48:49] nt
    s_add_u32 s48, s48, 7168
    s_addc_u32 s49, s49, 0
    global_load_dwordx4 v[44:47], v4, s[48:49] nt
    s_add_u32 s48, s48, 7168
    s_addc_u32 s49, s49, 0
    global_load_dwordx4 v[48:51], v4, s[48:49] nt
    s_add_u32 s48, s48, 7168
    s_addc_u32 s49, s49, 0
    global_load_dwordx4 v[52:55], v4, s[48:49] nt
    s_add_u32 s48, s48, 7168
    s_addc_u32 s49, s49, 0
    s_lshl2_add_u32 s40, s36, s34
    s_lshl_b32 s40, s40, 16
    s_lshl_b32 s41, s35, 8
    s_add_u32 s40, s40, s41
    s_add_u32 s40, s40, 4096
    s_add_u32 s50, s26, s40
    s_addc_u32 s51, s27, 0
    s_add_u32 s52, s50, 8192
    s_addc_u32 s53, s51, 0
    v_lshl_add_u32 v5, v16, 14, v17
    s_lshl_b32 s40, s2, 7
    s_add_u32 s40, s40, 98304
    s_add_u32 s54, s32, s40
    s_addc_u32 s55, s33, 0
    s_load_dword s8, s[54:55], 0 glc
    s_lshl_b32 s40, s36, 10
    s_lshl2_add_u32 s40, s35, s40
    s_add_u32 s40, s40, 98304
    s_add_u32 s56, s32, s40
    s_addc_u32 s57, s33, 0
    s_lshl_b32 s40, s2, 10
    s_add_u32 s40, s40, 131072
    s_add_u32 s58, s32, s40
    s_addc_u32 s59, s33, 0
    s_lshl_b32 s40, s36, 13
    s_lshl_b32 s41, s34, 7
    s_add_u32 s40, s40, s41
    s_add_u32 s40, s40, 135168
    s_add_u32 s60, s32, s40
    s_addc_u32 s61, s33, 0
    s_mul_i32 s40, s35, 28
    s_add_u32 s40, s40, s36
    s_lshl_b32 s40, s40, 10
    s_add_u32 s40, s40, 524288
    s_add_u32 s62, s32, s40
    s_addc_u32 s63, s33, 0
    s_lshl_b32 s40, s34, 8
    v_and_b32 v18, 128, v2
    v_add_u32 v18, s40, v18
    global_load_dword v31, v18, s[62:63]
    v_and_b32 v18, 1, v1
    v_lshlrev_b32 v18, 4, v18
    s_mov_b32 s40, 0xffff
    v_lshlrev_b32 v18, v18, s40
    v_bfe_u32 v19, v1, 1, 2
    v_cmp_eq_u32 vcc, 0, v19
    s_nop 1
    v_cndmask_b32 v6, 0, v18, vcc
    v_cmp_eq_u32 vcc, 1, v19
    s_nop 1
    v_cndmask_b32 v7, 0, v18, vcc
    v_cmp_eq_u32 vcc, 2, v19
    s_nop 1
    v_cndmask_b32 v8, 0, v18, vcc
    v_cmp_eq_u32 vcc, 3, v19
    s_nop 1
    v_cndmask_b32 v9, 0, v18, vcc
    v_lshrrev_b32 v18, 5, v1
    v_lshlrev_b32 v18, 9, v18
    v_lshl_add_u32 v18, v17, 1, v18
    v_and_b32 v19, 16, v1
    s_lshl_b32 s40, s34, 10
    v_add3_u32 v10, v18, v19, s40
    v_bfe_u32 v18, v1, 3, 1
    v_lshlrev_b32 v18, 9, v18
    v_lshl_add_u32 v18, v16, 5, v18
    v_and_b32 v19, 3, v1
    v_lshl_add_u32 v11, v19, 3, v18
    v_lshlrev_b32 v18, 3, v19
    v_lshrrev_b32 v28, v18, s39
    v_and_b32 v28, 0xfe, v28
    s_and_b32 s40, s39, 1
    v_or_b32 v28, s40, v28
    v_and_b32 v19, 1, v1
    v_lshlrev_b32 v19, 1, v19
    v_lshlrev_b32 v18, 3, v19
    v_lshrrev_b32 v29, v18, s39
    v_and_b32 v29, 0xfe, v29
    s_and_b32 s40, s39, 1
    v_or_b32 v29, s40, v29
    v_add_u32 v19, 1, v19
    v_lshlrev_b32 v18, 3, v19
    v_lshrrev_b32 v30, v18, s39
    v_and_b32 v30, 0xfe, v30
    s_and_b32 s40, s39, 1
    v_or_b32 v30, s40, v30
    s_waitcnt vmcnt(6)
    global_load_dwordx4 v[56:59], v4, s[48:49] nt
    s_add_u32 s48, s48, 7168
    s_addc_u32 s49, s49, 0
    s_waitcnt vmcnt(6)
    global_load_dwordx4 v[60:63], v4, s[48:49] nt
    s_add_u32 s48, s48, 7168
    s_addc_u32 s49, s49, 0
    s_waitcnt vmcnt(6)
    global_load_dwordx4 v[64:67], v4, s[48:49] nt
    s_add_u32 s48, s48, 7168
    s_addc_u32 s49, s49, 0
    s_waitcnt vmcnt(6)
    global_load_dwordx4 v[68:71], v4, s[48:49] nt
    s_add_u32 s48, s48, 7168
    s_addc_u32 s49, s49, 0
    s_waitcnt vmcnt(6)
    global_load_dwordx4 v[72:75], v4, s[48:49] nt
    s_add_u32 s48, s48, 7168
    s_addc_u32 s49, s49, 0
    s_waitcnt vmcnt(6)
    global_load_dwordx4 v[76:79], v4, s[48:49] nt
    s_add_u32 s48, s48, 7168
    s_addc_u32 s49, s49, 0
    s_waitcnt vmcnt(5)
    global_load_dwordx4 v[80:83], v4, s[48:49] nt
    s_add_u32 s48, s48, 7168
    s_addc_u32 s49, s49, 0
    s_waitcnt vmcnt(5)
    global_load_dwordx4 v[84:87], v4, s[48:49] nt
    s_add_u32 s48, s48, 7168
    s_addc_u32 s49, s49, 0
    s_waitcnt vmcnt(5)
    global_load_dwordx4 v[88:91], v4, s[48:49] nt
    s_add_u32 s48, s48, 7168
    s_addc_u32 s49, s49, 0
    s_waitcnt vmcnt(5)
    global_load_dwordx4 v[92:95], v4, s[48:49] nt
    s_waitcnt vmcnt(5)
    global_load_dwordx4 v[96:99], v5, s[50:51] offset:-4096 nt
    s_waitcnt vmcnt(5)
    global_load_dwordx4 v[100:103], v5, s[50:51] offset:-2048 nt
    s_lshl_b32 s40, s34, 2
    v_mov_b32 v24, s40
    s_lshl_b32 s40, s34, 10
    v_add_u32 v25, s40, v2
    s_mov_b32 s46, 0
L_sp_27:
    ds_read_b32 v26, v24 offset:80
    ds_read_b128 v[12:15], v25 offset:640
    s_waitcnt lgkmcnt(0)
    v_cmp_eq_u32 vcc, 0, v26
    s_cbranch_vccz L_spd_28
    s_add_u32 s46, s46, 1
    s_sleep 1
    s_cmp_lt_u32 s46, 400000
    s_cbranch_scc1 L_sp_27
    s_branch L_end
L_spd_28:
    global_load_dwordx4 v[104:107], v5, s[50:51] offset:0 nt
    global_load_dwordx4 v[108:111], v5, s[50:51] offset:2048 nt
    global_load_dwordx4 v[112:115], v5, s[52:53] offset:-4096 nt
    global_load_dwordx4 v[116:119], v5, s[52:53] offset:-2048 nt
    global_load_dwordx4 v[120:123], v5, s[52:53] offset:0 nt
    global_load_dwordx4 v[124:127], v5, s[52:53] offset:2048 nt
    v_and_b32_dpp v16, v12, v6 quad_perm:[0,0,0,0] row_mask:0xf bank_mask:0xf
    v_and_b32_dpp v17, v12, v7 quad_perm:[0,0,0,0] row_mask:0xf bank_mask:0xf
    v_and_b32_dpp v18, v12, v8 quad_perm:[0,0,0,0] row_mask:0xf bank_mask:0xf
    v_and_b32_dpp v19, v12, v9 quad_perm:[0,0,0,0] row_mask:0xf bank_mask:0xf
    v_and_b32_dpp v20, v13, v6 quad_perm:[0,0,0,0] row_mask:0xf bank_mask:0xf
    v_and_b32_dpp v21, v13, v7 quad_perm:[0,0,0,0] row_mask:0xf bank_mask:0xf
    v_and_b32_dpp v22, v13, v8 quad_perm:[0,0,0,0] row_mask:0xf bank_mask:0xf
    v_and_b32_dpp v23, v13, v9 quad_perm:[0,0,0,0] row_mask:0xf bank_mask:0xf
    s_waitcnt vmcnt(8)
    v_mov_b32 v0, 1
    s_mov_b64 exec, 1
    ds_add_rtn_u32 v31, v3, v0 offset:60
    s_mov_b64 exec, -1
    v_mfma_f32_16x16x32_bf16 v[24:27], v[16:19], v[32:35], 0
    v_and_b32_dpp v16, v14, v6 quad_perm:[0,0,0,0] row_mask:0xf bank_mask:0xf
    v_and_b32_dpp v17, v14, v7 quad_perm:[0,0,0,0] row_mask:0xf bank_mask:0xf
    v_and_b32_dpp v18, v14, v8 quad_perm:[0,0,0,0] row_mask:0xf bank_mask:0xf
    v_and_b32_dpp v19, v14, v9 quad_perm:[0,0,0,0] row_mask:0xf bank_mask:0xf
    v_mfma_f32_16x16x32_bf16 v[24:27], v[20:23], v[36:39], v[24:27]
    v_and_b32_dpp v20, v15, v6 quad_perm:[0,0,0,0] row_mask:0xf bank_mask:0xf
    v_and_b32_dpp v21, v15, v7 quad_perm:[0,0,0,0] row_mask:0xf bank_mask:0xf
    v_and_b32_dpp v22, v15, v8 quad_perm:[0,0,0,0] row_mask:0xf bank_mask:0xf
    v_and_b32_dpp v23, v15, v9 quad_perm:[0,0,0,0] row_mask:0xf bank_mask:0xf
    v_mfma_f32_16x16x32_bf16 v[24:27], v[16:19], v[40:43], v[24:27]
    v_and_b32_dpp v16, v12, v6 quad_perm:[1,1,1,1] row_mask:0xf bank_mask:0xf
    v_and_b32_dpp v17, v12, v7 quad_perm:[1,1,1,1] row_mask:0xf bank_mask:0xf
    v_and_b32_dpp v18, v12, v8 quad_perm:[1,1,1,1] row_mask:0xf bank_mask:0xf
    v_and_b32_dpp v19, v12, v9 quad_perm:[1,1,1,1] row_mask:0xf bank_mask:0xf
    s_waitcnt lgkmcnt(0)
    v_readfirstlane_b32 s40, v31
    s_cmp_lg_u32 s40, 3
    s_cbranch_scc1 L_ef_29
    v_mov_b32 v31, s39
    v_lshlrev_b32 v0, 7, v1
    s_mov_b64 exec, 255
    global_store_dword v0, v31, s[56:57] sc1
    s_mov_b64 exec, -1
L_ef_29:
    v_mfma_f32_16x16x32_bf16 v[24:27], v[20:23], v[44:47], v[24:27]
    v_and_b32_dpp v20, v13, v6 quad_perm:[1,1,1,1] row_mask:0xf bank_mask:0xf
    v_and_b32_dpp v21, v13, v7 quad_perm:[1,1,1,1] row_mask:0xf bank_mask:0xf
    v_and_b32_dpp v22, v13, v8 quad_perm:[1,1,1,1] row_mask:0xf bank_mask:0xf
    v_and_b32_dpp v23, v13, v9 quad_perm:[1,1,1,1] row_mask:0xf bank_mask:0xf
    v_mfma_f32_16x16x32_bf16 v[24:27], v[16:19], v[48:51], v[24:27]
    v_and_b32_dpp v16, v14, v6 quad_perm:[1,1,1,1] row_mask:0xf bank_mask:0xf
    v_and_b32_dpp v17, v14, v7 quad_perm:[1,1,1,1] row_mask:0xf bank_mask:0xf
    v_and_b32_dpp v18, v14, v8 quad_perm:[1,1,1,1] row_mask:0xf bank_mask:0xf
    v_and_b32_dpp v19, v14, v9 quad_perm:[1,1,1,1] row_mask:0xf bank_mask:0xf
    v_mfma_f32_16x16x32_bf16 v[24:27], v[20:23], v[52:55], v[24:27]
    v_and_b32_dpp v20, v15, v6 quad_perm:[1,1,1,1] row_mask:0xf bank_mask:0xf
    v_and_b32_dpp v21, v15, v7 quad_perm:[1,1,1,1] row_mask:0xf bank_mask:0xf
    v_and_b32_dpp v22, v15, v8 quad_perm:[1,1,1,1] row_mask:0xf bank_mask:0xf
    v_and_b32_dpp v23, v15, v9 quad_perm:[1,1,1,1] row_mask:0xf bank_mask:0xf
    v_mfma_f32_16x16x32_bf16 v[24:27], v[16:19], v[56:59], v[24:27]
    v_and_b32_dpp v16, v12, v6 quad_perm:[2,2,2,2] row_mask:0xf bank_mask:0xf
    v_and_b32_dpp v17, v12, v7 quad_perm:[2,2,2,2] row_mask:0xf bank_mask:0xf
    v_and_b32_dpp v18, v12, v8 quad_perm:[2,2,2,2] row_mask:0xf bank_mask:0xf
    v_and_b32_dpp v19, v12, v9 quad_perm:[2,2,2,2] row_mask:0xf bank_mask:0xf
    v_mfma_f32_16x16x32_bf16 v[24:27], v[20:23], v[60:63], v[24:27]
    v_and_b32_dpp v20, v13, v6 quad_perm:[2,2,2,2] row_mask:0xf bank_mask:0xf
    v_and_b32_dpp v21, v13, v7 quad_perm:[2,2,2,2] row_mask:0xf bank_mask:0xf
    v_and_b32_dpp v22, v13, v8 quad_perm:[2,2,2,2] row_mask:0xf bank_mask:0xf
    v_and_b32_dpp v23, v13, v9 quad_perm:[2,2,2,2] row_mask:0xf bank_mask:0xf
    v_mfma_f32_16x16x32_bf16 v[24:27], v[16:19], v[64:67], v[24:27]
    v_and_b32_dpp v16, v14, v6 quad_perm:[2,2,2,2] row_mask:0xf bank_mask:0xf
    v_and_b32_dpp v17, v14, v7 quad_perm:[2,2,2,2] row_mask:0xf bank_mask:0xf
    v_and_b32_dpp v18, v14, v8 quad_perm:[2,2,2,2] row_mask:0xf bank_mask:0xf
    v_and_b32_dpp v19, v14, v9 quad_perm:[2,2,2,2] row_mask:0xf bank_mask:0xf
    v_mfma_f32_16x16x32_bf16 v[24:27], v[20:23], v[68:71], v[24:27]
    v_and_b32_dpp v20, v15, v6 quad_perm:[2,2,2,2] row_mask:0xf bank_mask:0xf
    v_and_b32_dpp v21, v15, v7 quad_perm:[2,2,2,2] row_mask:0xf bank_mask:0xf
    v_and_b32_dpp v22, v15, v8 quad_perm:[2,2,2,2] row_mask:0xf bank_mask:0xf
    v_and_b32_dpp v23, v15, v9 quad_perm:[2,2,2,2] row_mask:0xf bank_mask:0xf
    v_mfma_f32_16x16x32_bf16 v[24:27], v[16:19], v[72:75], v[24:27]
    v_and_b32_dpp v16, v12, v6 quad_perm:[3,3,3,3] row_mask:0xf bank_mask:0xf
    v_and_b32_dpp v17, v12, v7 quad_perm:[3,3,3,3] row_mask:0xf bank_mask:0xf
    v_and_b32_dpp v18, v12, v8 quad_perm:[3,3,3,3] row_mask:0xf bank_mask:0xf
    v_and_b32_dpp v19, v12, v9 quad_perm:[3,3,3,3] row_mask:0xf bank_mask:0xf
    v_mfma_f32_16x16x32_bf16 v[24:27], v[20:23], v[76:79], v[24:27]
    v_and_b32_dpp v20, v13, v6 quad_perm:[3,3,3,3] row_mask:0xf bank_mask:0xf
    v_and_b32_dpp v21, v13, v7 quad_perm:[3,3,3,3] row_mask:0xf bank_mask:0xf
    v_and_b32_dpp v22, v13, v8 quad_perm:[3,3,3,3] row_mask:0xf bank_mask:0xf
    v_and_b32_dpp v23, v13, v9 quad_perm:[3,3,3,3] row_mask:0xf bank_mask:0xf
    v_mfma_f32_16x16x32_bf16 v[24:27], v[16:19], v[80:83], v[24:27]
    v_and_b32_dpp v16, v14, v6 quad_perm:[3,3,3,3] row_mask:0xf bank_mask:0xf
    v_and_b32_dpp v17, v14, v7 quad_perm:[3,3,3,3] row_mask:0xf bank_mask:0xf
    v_and_b32_dpp v18, v14, v8 quad_perm:[3,3,3,3] row_mask:0xf bank_mask:0xf
    v_and_b32_dpp v19, v14, v9 quad_perm:[3,3,3,3] row_mask:0xf bank_mask:0xf
    v_mfma_f32_16x16x32_bf16 v[24:27], v[20:23], v[84:87], v[24:27]
    v_and_b32_dpp v20, v15, v6 quad_perm:[3,3,3,3] row_mask:0xf bank_mask:0xf
    v_and_b32_dpp v21, v15, v7 quad_perm:[3,3,3,3] row_mask:0xf bank_mask:0xf
    v_and_b32_dpp v22, v15, v8 quad_perm:[3,3,3,3] row_mask:0xf bank_mask:0xf
    v_and_b32_dpp v23, v15, v9 quad_perm:[3,3,3,3] row_mask:0xf bank_mask:0xf
    v_mfma_f32_16x16x32_bf16 v[24:27], v[16:19], v[88:91], v[24:27]
    s_nop 0
    v_mfma_f32_16x16x32_bf16 v[24:27], v[20:23], v[92:95], v[24:27]
    v_mov_b32 v0, 1
    s_movk_i32 s6, 255
    s_nop 5
    ds_write_b128 v10, v[24:27] offset:640
    s_mov_b64 exec, 1
    ds_add_rtn_u32 v31, v3, v0 offset:52
    s_mov_b64 exec, -1
    s_waitcnt lgkmcnt(0)
    v_readfirstlane_b32 s40, v31
    s_cmp_lg_u32 s40, 3
    s_cbranch_scc1 L_ha_30
    ds_read_b128 v[48:51], v2 offset:640
    ds_read_b128 v[52:55], v2 offset:1664
    ds_read_b128 v[56:59], v2 offset:2688
    ds_read_b128 v[60:63], v2 offset:3712
    s_waitcnt lgkmcnt(2)
    v_add_f32 v48, v48, v52
    v_add_f32 v49, v49, v53
    v_add_f32 v50, v50, v54
    v_add_f32 v51, v51, v55
    s_waitcnt lgkmcnt(0)
    v_add_f32 v56, v56, v60
    v_add_f32 v57, v57, v61
    v_add_f32 v58, v58, v62
    v_add_f32 v59, v59, v63
    v_add_f32 v48, v48, v56
    v_add_f32 v49, v49, v57
    v_add_f32 v50, v50, v58
    v_add_f32 v51, v51, v59
    v_bfi_b32 v48, s6, v29, v48
    v_bfi_b32 v50, s6, v30, v50
    global_store_dwordx4 v2, v[48:51], s[58:59] sc1
L_ha_30:
    s_mov_b32 s46, 0
L_mf_31:
    s_load_dwordx8 s[8:15], s[54:55], 0 glc
    s_add_u32 s46, s46, 1
    s_cmp_gt_u32 s46, 50000
    s_cbranch_scc1 L_end
    s_waitcnt lgkmcnt(0)
    s_xor_b32 s40, s8, s39
    s_xor_b32 s41, s9, s39
    s_or_b32 s40, s40, s41
    s_xor_b32 s41, s10, s39
    s_or_b32 s40, s40, s41
    s_xor_b32 s41, s11, s39
    s_or_b32 s40, s40, s41
    s_xor_b32 s41, s12, s39
    s_or_b32 s40, s40, s41
    s_xor_b32 s41, s13, s39
    s_or_b32 s40, s40, s41
    s_xor_b32 s41, s14, s39
    s_or_b32 s40, s40, s41
    s_xor_b32 s41, s15, s39
    s_or_b32 s40, s40, s41
    s_cbranch_scc1 L_mf_31
    s_mov_b32 s46, 0
L_hp_32:
    global_load_dwordx2 v[32:33], v11, s[60:61] offset:-4096 sc1
    global_load_dwordx2 v[34:35], v11, s[60:61] offset:-3072 sc1
    global_load_dwordx2 v[36:37], v11, s[60:61] offset:-2048 sc1
    global_load_dwordx2 v[38:39], v11, s[60:61] offset:-1024 sc1
    global_load_dwordx2 v[40:41], v11, s[60:61] offset:0 sc1
    global_load_dwordx2 v[42:43], v11, s[60:61] offset:1024 sc1
    global_load_dwordx2 v[44:45], v11, s[60:61] offset:2048 sc1
    global_load_dwordx2 v[46:47], v11, s[60:61] offset:3072 sc1
    s_add_u32 s46, s46, 1
    s_cmp_gt_u32 s46, 50000
    s_cbranch_scc1 L_end
    s_waitcnt vmcnt(7)
    v_xor_b32 v31, v28, v32
    s_waitcnt vmcnt(6)
    v_bitop3_b32 v31, v31, v34, v28 bitop3:0xf6
    s_waitcnt vmcnt(5)
    v_bitop3_b32 v31, v31, v36, v28 bitop3:0xf6
    v_add_f32 v64, v32, v36
    v_add_f32 v65, v33, v37
    s_waitcnt vmcnt(4)
    v_bitop3_b32 v31, v31, v38, v28 bitop3:0xf6
    v_add_f32 v66, v34, v38
    v_add_f32 v67, v35, v39
    s_waitcnt vmcnt(3)
    v_bitop3_b32 v31, v31, v40, v28 bitop3:0xf6
    v_add_f32 v64, v64, v40
    v_add_f32 v65, v65, v41
    s_waitcnt vmcnt(2)
    v_bitop3_b32 v31, v31, v42, v28 bitop3:0xf6
    v_add_f32 v66, v66, v42
    v_add_f32 v67, v67, v43
    s_waitcnt vmcnt(1)
    v_bitop3_b32 v31, v31, v44, v28 bitop3:0xf6
    v_add_f32 v64, v64, v44
    v_add_f32 v65, v65, v45
    s_waitcnt vmcnt(0)
    v_bitop3_b32 v31, v31, v46, v28 bitop3:0xf6
    v_add_f32 v66, v66, v46
    v_add_f32 v67, v67, v47
    v_and_b32 v31, 0xff, v31
    v_cmp_ne_u32 vcc, 0, v31
    v_mul_f32 v68, 0xbfb8aa3b, v64
    v_mul_f32 v69, 0xbfb8aa3b, v65
    s_cbranch_vccnz L_hp_32
    v_exp_f32 v68, v68
    v_exp_f32 v69, v69
    v_mul_f32 v64, v64, v66
    v_mul_f32 v65, v65, v67
    v_add_f32 v68, 1.0, v68
    v_add_f32 v69, 1.0, v69
    v_rcp_f32 v68, v68
    v_rcp_f32 v69, v69
    v_mul_f32 v64, v64, v68
    v_mul_f32 v65, v65, v69
    v_cvt_pk_bf16_f32 v12, v64, v64
    v_cvt_pk_bf16_f32 v13, v65, v65
    s_nop 0
    v_and_b32_dpp v16, v12, v6 quad_perm:[0,0,0,0] row_mask:0xf bank_mask:0xf
    v_and_b32_dpp v17, v12, v7 quad_perm:[0,0,0,0] row_mask:0xf bank_mask:0xf
    v_and_b32_dpp v18, v12, v8 quad_perm:[0,0,0,0] row_mask:0xf bank_mask:0xf
    v_and_b32_dpp v19, v12, v9 quad_perm:[0,0,0,0] row_mask:0xf bank_mask:0xf
    v_and_b32_dpp v20, v13, v6 quad_perm:[0,0,0,0] row_mask:0xf bank_mask:0xf
    v_and_b32_dpp v21, v13, v7 quad_perm:[0,0,0,0] row_mask:0xf bank_mask:0xf
    v_and_b32_dpp v22, v13, v8 quad_perm:[0,0,0,0] row_mask:0xf bank_mask:0xf
    v_and_b32_dpp v23, v13, v9 quad_perm:[0,0,0,0] row_mask:0xf bank_mask:0xf
    v_mfma_f32_16x16x32_bf16 v[24:27], v[16:19], v[96:99], 0
    v_and_b32_dpp v16, v12, v6 quad_perm:[1,1,1,1] row_mask:0xf bank_mask:0xf
    v_and_b32_dpp v17, v12, v7 quad_perm:[1,1,1,1] row_mask:0xf bank_mask:0xf
    v_and_b32_dpp v18, v12, v8 quad_perm:[1,1,1,1] row_mask:0xf bank_mask:0xf
    v_and_b32_dpp v19, v12, v9 quad_perm:[1,1,1,1] row_mask:0xf bank_mask:0xf
    v_mfma_f32_16x16x32_bf16 v[24:27], v[20:23], v[100:103], v[24:27]
    v_and_b32_dpp v20, v13, v6 quad_perm:[1,1,1,1] row_mask:0xf bank_mask:0xf
    v_and_b32_dpp v21, v13, v7 quad_perm:[1,1,1,1] row_mask:0xf bank_mask:0xf
    v_and_b32_dpp v22, v13, v8 quad_perm:[1,1,1,1] row_mask:0xf bank_mask:0xf
    v_and_b32_dpp v23, v13, v9 quad_perm:[1,1,1,1] row_mask:0xf bank_mask:0xf
    v_mfma_f32_16x16x32_bf16 v[24:27], v[16:19], v[104:107], v[24:27]
    v_and_b32_dpp v16, v12, v6 quad_perm:[2,2,2,2] row_mask:0xf bank_mask:0xf
    v_and_b32_dpp v17, v12, v7 quad_perm:[2,2,2,2] row_mask:0xf bank_mask:0xf
    v_and_b32_dpp v18, v12, v8 quad_perm:[2,2,2,2] row_mask:0xf bank_mask:0xf
    v_and_b32_dpp v19, v12, v9 quad_perm:[2,2,2,2] row_mask:0xf bank_mask:0xf
    v_mfma_f32_16x16x32_bf16 v[24:27], v[20:23], v[108:111], v[24:27]
    v_and_b32_dpp v20, v13, v6 quad_perm:[2,2,2,2] row_mask:0xf bank_mask:0xf
    v_and_b32_dpp v21, v13, v7 quad_perm:[2,2,2,2] row_mask:0xf bank_mask:0xf
    v_and_b32_dpp v22, v13, v8 quad_perm:[2,2,2,2] row_mask:0xf bank_mask:0xf
    v_and_b32_dpp v23, v13, v9 quad_perm:[2,2,2,2] row_mask:0xf bank_mask:0xf
    v_mfma_f32_16x16x32_bf16 v[24:27], v[16:19], v[112:115], v[24:27]
    v_and_b32_dpp v16, v12, v6 quad_perm:[3,3,3,3] row_mask:0xf bank_mask:0xf
    v_and_b32_dpp v17, v12, v7 quad_perm:[3,3,3,3] row_mask:0xf bank_mask:0xf
    v_and_b32_dpp v18, v12, v8 quad_perm:[3,3,3,3] row_mask:0xf bank_mask:0xf
    v_and_b32_dpp v19, v12, v9 quad_perm:[3,3,3,3] row_mask:0xf bank_mask:0xf
    v_mfma_f32_16x16x32_bf16 v[24:27], v[20:23], v[116:119], v[24:27]
    v_and_b32_dpp v20, v13, v6 quad_perm:[3,3,3,3] row_mask:0xf bank_mask:0xf
    v_and_b32_dpp v21, v13, v7 quad_perm:[3,3,3,3] row_mask:0xf bank_mask:0xf
    v_and_b32_dpp v22, v13, v8 quad_perm:[3,3,3,3] row_mask:0xf bank_mask:0xf
    v_and_b32_dpp v23, v13, v9 quad_perm:[3,3,3,3] row_mask:0xf bank_mask:0xf
    v_mfma_f32_16x16x32_bf16 v[24:27], v[16:19], v[120:123], v[24:27]
    s_nop 0
    v_mfma_f32_16x16x32_bf16 v[24:27], v[20:23], v[124:127], v[24:27]
    s_add_u32 s58, s62, 262144
    s_addc_u32 s59, s63, 0
    v_mov_b32 v0, 1
    s_movk_i32 s6, 255
    s_nop 3
    ds_write_b128 v10, v[24:27] offset:640
    s_mov_b64 exec, 1
    ds_add_rtn_u32 v31, v3, v0 offset:56
    s_mov_b64 exec, -1
    s_waitcnt lgkmcnt(0)
    v_readfirstlane_b32 s40, v31
    s_cmp_lg_u32 s40, 3
    s_cbranch_scc1 L_hb_33
    ds_read_b128 v[48:51], v2 offset:640
    ds_read_b128 v[52:55], v2 offset:1664
    ds_read_b128 v[56:59], v2 offset:2688
    ds_read_b128 v[60:63], v2 offset:3712
    s_waitcnt lgkmcnt(2)
    v_add_f32 v48, v48, v52
    v_add_f32 v49, v49, v53
    v_add_f32 v50, v50, v54
    v_add_f32 v51, v51, v55
    s_waitcnt lgkmcnt(0)
    v_add_f32 v56, v56, v60
    v_add_f32 v57, v57, v61
    v_add_f32 v58, v58, v62
    v_add_f32 v59, v59, v63
    v_add_f32 v48, v48, v56
    v_add_f32 v49, v49, v57
    v_add_f32 v50, v50, v58
    v_add_f32 v51, v51, v59
    v_bfi_b32 v48, s6, v29, v48
    v_bfi_b32 v50, s6, v30, v50
    global_store_dwordx4 v2, v[48:51], s[62:63]
    global_store_dwordx4 v2, v[48:51], s[58:59] sc1
L_hb_33:
    s_branch L_routed
L_lead:
    s_lshl_b32 s40, s35, 11
    s_add_u32 s40, s40, 4096
    s_add_u32 s50, s32, s40
    s_addc_u32 s51, s33, 0
    s_lshl_b32 s40, s35, 6
    s_add_u32 s40, s40, 32768
    s_add_u32 s52, s32, s40
    s_addc_u32 s53, s33, 0
    s_sub_u32 s40, s36, 28
    s_lshl2_add_u32 s40, s40, s34
    s_lshl_b32 s40, s40, 11
    s_lshl4_add_u32 s40, s35, s40
    s_add_u32 s40, s40, 65536
    s_add_u32 s54, s32, s40
    s_addc_u32 s55, s33, 0
    v_lshrrev_b32 v45, 2, v1
    v_and_b32 v19, 3, v1
    v_lshlrev_b32 v44, 5, v45
    v_add_u32 v44, v44, v19
    s_lshl_b32 s40, s35, 3
    s_sub_u32 s40, 0xffff, s40
    v_lshlrev_b32 v40, 1, v44
    v_sub_u32 v40, s40, v40
    v_subrev_u32 v41, 1, v40
    v_subrev_u32 v42, 1024, v40
    v_subrev_u32 v43, 1025, v40
    v_lshlrev_b32 v44, 4, v44
    v_add_u32 v46, 8192, v44
    v_lshlrev_b32 v45, 7, v1
    v_lshlrev_b32 v18, 3, v19
    v_lshrrev_b32 v28, v18, s39
    v_and_b32 v28, 0xfe, v28
    s_and_b32 s40, s39, 1
    v_or_b32 v28, s40, v28
    s_and_b32 s42, s39, 0xffff
    s_mov_b32 s43, 0xffff
    s_mov_b32 s46, 0
L_la_34:
    global_load_dwordx4 v[32:35], v2, s[50:51] offset:0 sc1
    global_load_dwordx4 v[36:39], v2, s[50:51] offset:1024 sc1
L_lc_36:
    s_waitcnt vmcnt(0)
    v_xor_b32 v31, s42, v33
    v_bitop3_b32 v31, v31, v35, s42 bitop3:0xf6
    v_bitop3_b32 v31, v31, v37, s42 bitop3:0xf6
    v_bitop3_b32 v31, v31, v39, s42 bitop3:0xf6
    v_and_b32 v31, 0xffff, v31
    v_cmp_ne_u32 vcc, 0, v31
    s_cbranch_vccz L_lo_37
    s_add_u32 s46, s46, 1
    s_cmp_lt_u32 s46, 24
    s_cbranch_scc1 L_la_34
    s_cmp_gt_u32 s46, 50000
    s_cbranch_scc1 L_end
    s_sleep 2
    global_load_dwordx4 v[32:35], v44, s[52:53] sc1
    global_load_dwordx4 v[36:39], v46, s[52:53] sc1
    s_branch L_lc_36
L_lo_37:
    v_bfi_b32 v40, s43, v40, v33
    v_bfi_b32 v41, s43, v41, v35
    v_bfi_b32 v42, s43, v42, v37
    v_bfi_b32 v43, s43, v43, v39
    v_max3_u32 v48, v40, v41, v42
    v_med3_u32 v49, v40, v41, v42
    v_mov_b32 v50, s39
    v_med3_u32 v49, v48, v49, v43
    v_max_u32 v48, v48, v43
    v_mov_b32 v51, s39
    v_max_u32_dpp v53, v49, v49 quad_perm:[1,0,3,2] row_mask:0xf bank_mask:0xf
    v_min_u32_dpp v52, v48, v48 quad_perm:[1,0,3,2] row_mask:0xf bank_mask:0xf
    v_max_u32_dpp v48, v48, v48 quad_perm:[1,0,3,2] row_mask:0xf bank_mask:0xf
    v_max_u32 v49, v52, v53
    s_nop 1
    v_max_u32_dpp v53, v49, v49 quad_perm:[2,3,0,1] row_mask:0xf bank_mask:0xf
    v_min_u32_dpp v52, v48, v48 quad_perm:[2,3,0,1] row_mask:0xf bank_mask:0xf
    v_max_u32_dpp v48, v48, v48 quad_perm:[2,3,0,1] row_mask:0xf bank_mask:0xf
    v_max_u32 v49, v52, v53
    s_nop 1
    v_max_u32_dpp v53, v49, v49 row_half_mirror row_mask:0xf bank_mask:0xf
    v_min_u32_dpp v52, v48, v48 row_half_mirror row_mask:0xf bank_mask:0xf
    v_max_u32_dpp v48, v48, v48 row_half_mirror row_mask:0xf bank_mask:0xf
    v_max_u32 v49, v52, v53
    s_nop 1
    v_max_u32_dpp v53, v49, v49 row_mirror row_mask:0xf bank_mask:0xf
    v_min_u32_dpp v52, v48, v48 row_mirror row_mask:0xf bank_mask:0xf
    v_max_u32_dpp v48, v48, v48 row_mirror row_mask:0xf bank_mask:0xf
    v_max_u32 v49, v52, v53
    v_mov_b32 v52, v48
    v_mov_b32 v53, v49
    s_nop 0
    v_permlane16_swap_b32 v48, v52
    v_permlane16_swap_b32 v49, v53
    v_max_u32 v49, v49, v53
    v_med3_u32 v49, v48, v52, v49
    v_max_u32 v48, v48, v52
    v_mov_b32 v52, v48
    v_mov_b32 v53, v49
    s_nop 0
    v_permlane32_swap_b32 v48, v52
    v_permlane32_swap_b32 v49, v53
    v_max_u32 v49, v49, v53
    v_med3_u32 v49, v48, v52, v49
    v_max_u32 v48, v48, v52
    s_mov_b64 exec, 0xffff
    global_store_dwordx4 v45, v[48:51], s[54:55] sc1
    s_mov_b64 exec, -1
    v_mov_b32 v0, 1
    s_mov_b64 exec, 1
    ds_add_u32 v3, v0 offset:60
    s_mov_b64 exec, -1
L_routed:
    s_cmp_ge_u32 s34, 2
    s_cbranch_scc1 L_fin
    s_lshl_b32 s40, s34, 2
    v_mov_b32 v65, s40
    s_mov_b32 s46, 0
L_sp_38:
    ds_read_b32 v64, v65 offset:32
    s_waitcnt lgkmcnt(0)
    v_cmp_eq_u32 vcc, 0, v64
    s_cbranch_vccz L_spd_39
    s_add_u32 s46, s46, 1
    s_sleep 2
    s_cmp_lt_u32 s46, 400000
    s_cbranch_scc1 L_sp_38
    s_branch L_end
L_spd_39:
    v_readfirstlane_b32 s8, v64
    s_andn2_b32 s9, 2047, s8
    s_lshr_b32 s40, s9, 8
    s_add_u32 s41, s40, 2
    s_bfe_u32 s42, s41, 0x10002
    s_cmp_lg_u32 s42, s38
    s_cbranch_scc1 L_fin
    s_cmp_eq_u32 s38, 0
    s_cselect_b32 s10, s40, s41
    s_and_b32 s10, s10, 3
    s_mul_i32 s40, s35, 28672
    s_lshl_b32 s41, s34, 9
    s_add_u32 s40, s40, s41
    s_and_b32 s41, s36, 15
    s_lshl_b32 s41, s41, 5
    s_add_u32 s40, s40, s41
    s_add_u32 s40, s40, 524288
    s_add_u32 s48, s32, s40
    s_addc_u32 s49, s33, 0
    s_add_u32 s50, s48, 262144
    s_addc_u32 s51, s49, 0
    v_and_b32 v67, 3, v1
    v_lshrrev_b32 v64, 5, v1
    v_lshl_add_u32 v64, v67, 1, v64
    v_lshrrev_b32 v65, 2, v1
    v_lshlrev_b32 v65, 10, v65
    v_lshl_add_u32 v65, v67, 3, v65
    v_add_u32 v66, 16384, v65
    s_lshl_b32 s40, s9, 11
    s_lshl4_add_u32 s40, s37, s40
    v_lshl_add_u32 v67, v64, 1, s40
    global_load_ushort v68, v67, s[4:5]
    s_bitcmp1_b32 s8, 31
    s_brev_b32 s40, 1
    s_cselect_b32 s40, s40, -1
    s_xor_b32 s40, s40, s8
    s_and_b32 s40, s40, 0xffff0000
    v_mov_b32 v72, 0xbfb8aa3b
    v_mul_f32 v72, s40, v72
    v_exp_f32 v72, v72
    v_mov_b32 v76, v28
    v_mov_b32 v77, 0
    v_add_f32 v72, 1.0, v72
    v_rcp_f32 v72, v72
    s_lshl_b32 s40, s10, 2
    v_mov_b32 v69, s40
    v_mul_f32 v72, 0xbfb8aa3b, v72
    s_mov_b32 s46, 0
L_sp_40:
    ds_read_b32 v70, v69 offset:64
    s_waitcnt lgkmcnt(0)
    v_cmp_gt_u32 vcc, 8, v70
    s_cbranch_vccz L_spd_41
    s_add_u32 s46, s46, 1
    s_sleep 1
    s_cmp_lt_u32 s46, 400000
    s_cbranch_scc1 L_sp_40
    s_branch L_end
L_spd_41:
    s_bfe_u32 s40, s9, 0x20002
    s_bfe_u32 s41, s9, 0x40004
    s_lshl4_add_u32 s40, s40, s41
    s_and_b32 s41, s9, 3
    s_lshl2_add_u32 s40, s40, s41
    s_lshl_b32 s41, s10, 8
    s_add_u32 s40, s40, s41
    s_lshl_b32 s40, s40, 2
    s_add_u32 s40, s40, 51968
    v_mul_u32_u24 v70, 14416, v64
    v_add_u32 v70, s40, v70
    s_lshl_b32 s40, s9, 1
    v_mul_u32_u24 v69, 4624, v64
    v_add_u32 v69, s40, v69
    v_lshlrev_b32 v71, 2, v64
    ds_read_b32 v70, v70
    ds_read_u16 v69, v69 offset:9360
    ds_read_b32 v71, v71 offset:0
    s_mov_b32 s46, 0
L_ba_42:
    global_load_dwordx2 v[74:75], v65, s[48:49] sc1
    s_mov_b32 exec_hi, 0xffff
    global_load_dwordx2 v[76:77], v66, s[48:49] sc1
    s_mov_b32 exec_hi, -1
L_bc_43:
    s_waitcnt vmcnt(0) lgkmcnt(0)
    v_xor_b32 v31, v28, v74
    v_bitop3_b32 v31, v31, v76, v28 bitop3:0xf6
    v_and_b32 v31, 0xff, v31
    v_cmp_ne_u32 vcc, 0, v31
    v_add_f32 v78, v74, v76
    v_add_f32 v79, v75, v77
    s_cbranch_vccz L_bo_44
    s_add_u32 s46, s46, 1
    s_cmp_lt_u32 s46, 24
    s_cbranch_scc1 L_ba_42
    s_cmp_gt_u32 s46, 50000
    s_cbranch_scc1 L_end
    s_sleep 2
    global_load_dwordx2 v[74:75], v65, s[50:51] sc1
    s_mov_b32 exec_hi, 0xffff
    global_load_dwordx2 v[76:77], v66, s[50:51] sc1
    s_mov_b32 exec_hi, -1
    s_branch L_bc_43
L_bo_44:
    v_cvt_f32_f16 v69, v69
    v_lshlrev_b32 v68, 16, v68
    v_permlane32_swap_b32 v78, v79
    v_add_f32 v78, v78, v79
    v_mov_b32 v79, v78
    s_nop 1
    v_permlane16_swap_b32 v78, v79
    v_add_f32 v78, v78, v79
    s_nop 1
    v_add_f32_dpp v78, v78, v78 row_ror:8 row_mask:0xf bank_mask:0xf
    s_nop 1
    v_add_f32_dpp v78, v78, v78 row_ror:4 row_mask:0xf bank_mask:0xf
    v_fmac_f32 v69, v78, v72
    v_exp_f32 v78, v69
    v_mul_f32 v70, v70, v69
    v_fma_f32 v78, v78, v71, v71
    v_rcp_f32 v78, v78
    s_mov_b32 exec_lo, 15
    s_mov_b32 exec_hi, 15
    v_fmac_f32 v68, v70, v78
    v_cvt_pk_bf16_f32 v68, v68, v68
    global_store_short v67, v68, s[28:29]
    s_branch L_fin
L_cnv:
    s_mul_i32 s50, s34, 14416
    s_add_u32 s50, s50, 45824
    s_mov_b32 m0, s50
    s_mov_b32 s52, 0x3f803f80
    v_mov_b32 v88, 0
    v_mov_b32 v89, 0
    v_mov_b32 v90, 0
    v_mov_b32 v91, 0
    s_mul_i32 s40, s34, 4624
    s_add_u32 s40, s40, 8832
    v_add_u32 v85, s40, v2
    s_mov_b32 exec_lo, -1
    s_mov_b32 exec_hi, 1
    ds_write_b128 v85, v[88:91]
    s_mov_b64 exec, -1
    v_mov_b32 v86, 0x3c00
    ds_write_addtid_b32 v86
    v_lshl_add_u32 v86, v5, 3, v4
    v_sub_u32 v86, 52, v86
    s_mov_b32 s44, 0
    s_mov_b32 s45, 127
    v_lshrrev_b64 v[86:87], v86, s[44:45]
    s_mov_b32 s44, 0xffff
    v_bfe_i32 v12, v86, 0, 1
    v_bfe_i32 v87, v86, 1, 1
    v_bfi_b32 v12, s44, v12, v87
    v_and_b32 v12, 0x3c003c00, v12
    v_bfe_i32 v13, v86, 2, 1
    v_bfe_i32 v87, v86, 3, 1
    v_bfi_b32 v13, s44, v13, v87
    v_and_b32 v13, 0x3c003c00, v13
    v_bfe_i32 v14, v86, 4, 1
    v_bfe_i32 v87, v86, 5, 1
    v_bfi_b32 v14, s44, v14, v87
    v_and_b32 v14, 0x3c003c00, v14
    v_bfe_i32 v15, v86, 6, 1
    v_bfe_i32 v87, v86, 7, 1
    v_bfi_b32 v15, s44, v15, v87
    v_and_b32 v15, 0x3c003c00, v15
    v_and_b32 v31, 31, v1
    v_mov_b32 v85, 0x2113210
    v_mov_b32 v86, 0x54aa6543
    v_cmp_le_u32 vcc, 8, v31
    s_nop 1
    v_cndmask_b32 v85, v85, v86, vcc
    v_mov_b32 v86, 0x9876a987
    v_cmp_le_u32 vcc, 16, v31
    s_nop 1
    v_cndmask_b32 v85, v85, v86, vcc
    v_mov_b32 v86, 0x0
    v_cmp_le_u32 vcc, 24, v31
    s_nop 1
    v_cndmask_b32 v85, v85, v86, vcc
    v_lshlrev_b32 v86, 2, v31
    v_bfe_u32 v85, v85, v86, 4
    s_mov_b32 s41, 0xf00f0ff0
    v_bfe_u32 v86, s41, v31, 1
    v_mad_u32_u24 v85, v86, 10, v85
    v_lshrrev_b32 v86, 5, v1
    v_lshl_add_u32 v86, v86, 4, s50
    v_mul_u32_u24 v85, 272, v85
    v_add_u32 v16, v85, v86
    v_mul_u32_u24 v85, 272, v31
    v_add_u32 v17, v85, v86
    s_add_u32 s41, s50, 1072
    v_sub_u32 v18, s41, v2
    v_lshrrev_b32 v85, 1, v1
    v_and_b32 v86, 1, v1
    v_lshlrev_b32 v85, 2, v85
    s_add_u32 s41, s50, 4540
    v_sub_u32 v85, s41, v85
    v_mul_u32_u24 v87, 192, v86
    v_add_u32 v20, v85, v87
    v_lshlrev_b32 v87, 7, v86
    v_sub_u32 v21, v85, v87
    v_add_u32 v21, 512, v21
    v_cmp_eq_u32 vcc, 0, v86
    v_mov_b32 v85, 0x03020706
    v_mov_b32 v87, 0x05040100
    v_cndmask_b32 v22, v85, v87, vcc
    v_mov_b32 v85, 900
    v_cndmask_b32 v85, 0, v85, vcc
    v_lshlrev_b32 v86, 2, v5
    v_sub_u32 v86, v86, v4
    v_lshl_add_u32 v85, v86, 2, v85
    s_add_u32 s41, s50, 4412
    v_add_u32 v7, s41, v85
    v_sub_u32 v85, 3, v4
    v_and_b32 v85, 3, v85
    v_mul_u32_u24 v85, 1086, v85
    v_lshl_add_u32 v86, v5, 3, v4
    v_lshlrev_b32 v86, 1, v86
    v_sub_u32 v85, v85, v86
    s_add_u32 s41, s50, 78
    v_add_u32 v6, s41, v85
    v_cmp_gt_u32 vcc, 32, v1
    v_bfe_u32 v85, v1, 2, 2
    v_bfe_u32 v86, v1, 3, 2
    v_cndmask_b32 v86, v86, v85, vcc
    v_lshlrev_b32 v86, 2, v86
    s_mov_b32 s41, 0xb630
    v_bfe_u32 v86, s41, v86, 4
    v_lshlrev_b32 v86, 6, v86
    v_mov_b32 v87, 5248
    v_mov_b32 v19, 4352
    v_cndmask_b32 v87, v87, v19, vcc
    v_add_u32 v86, v86, v87
    v_and_b32 v87, 7, v1
    v_min_u32 v87, 4, v87
    v_and_b32 v19, 3, v1
    v_cndmask_b32 v87, v87, v19, vcc
    v_mul_u32_u24 v85, 1088, v85
    v_cmp_gt_u32 vcc, 16, v1
    s_nop 1
    v_cndmask_b32 v86, v86, v85, vcc
    v_lshl_add_u32 v19, v87, 4, v86
    v_add_u32 v19, s50, v19
    s_mov_b32 s41, 0xffff0000
    v_mov_b32 v23, 0
    v_mov_b32 v24, 0
    v_mov_b32 v25, 0
    v_writelane_b32 v24, s41, 3
    v_writelane_b32 v25, -1, 3
    v_writelane_b32 v24, -1, 7
    v_writelane_b32 v25, -1, 7
    v_writelane_b32 v23, s41, 11
    v_writelane_b32 v24, -1, 11
    v_writelane_b32 v23, -1, 15
    v_writelane_b32 v24, -1, 15
    s_waitcnt lgkmcnt(0)
    s_and_b32 s41, s34, 1
    s_lshl_b32 s41, s41, 4
    s_lshr_b32 s48, s48, s41
    s_lshl_b32 s48, s48, 16
    s_lshr_b32 s51, s49, s41
    s_lshl_b32 s51, s51, 16
    v_mov_b32 v85, 0x3fb8aa3b
    v_mul_f32 v85, s48, v85
    v_exp_f32 v85, v85
    v_mov_b32 v26, 0
    v_cvt_pk_bf16_f32 v85, v85, v85
    v_writelane_b32 v26, s51, 0
    v_and_b32 v85, 0xffff0000, v85
    s_bitset0_b32 s51, 31
    v_mul_f32 v27, 0xbfb8aa3b, v85
    v_mul_f32 v28, 0x3e22f983, v85
    v_add_f32 v29, v85, v85
    v_lshlrev_b32 v85, 1, v4
    v_sub_u32 v85, v85, v5
    s_add_u32 s40, s40, 48
    v_lshl_add_u32 v1, v85, 4, s40
    s_add_u32 s41, s50, 6144
    v_add_u32 v4, s41, v2
    v_mov_b32 v0, 1
    s_lshl_b32 s40, s34, 2
    v_mov_b32 v31, s40
    s_waitcnt vmcnt(3)
    v_lshlrev_b32 v32, 16, v8
    v_and_b32 v33, 0xffff0000, v8
    v_mul_f32 v32, 0x3fb8aa3b, v32
    v_mul_f32 v33, 0x3fb8aa3b, v33
    v_exp_f32 v32, v32
    v_exp_f32 v33, v33
    s_waitcnt vmcnt(2)
    v_lshlrev_b32 v34, 16, v9
    v_cvt_pk_bf16_f32 v33, v32, v33
    v_and_b32 v35, 0xffff0000, v9
    v_mul_f32 v34, v34, v28
    v_lshlrev_b32 v32, 16, v33
    v_and_b32 v33, 0xffff0000, v33
    v_mul_f32 v32, v32, v27
    v_mul_f32 v35, v35, v28
    v_mul_f32 v33, v33, v27
    s_waitcnt vmcnt(0)
    v_mul_f32 v38, 0x41000000, v32
    v_mul_f32 v39, 0x41000000, v34
    v_fract_f32 v39, v39
    v_and_b32 v85, 0x7fff7fff, v10
    v_exp_f32 v38, v38
    v_cos_f32 v36, v39
    v_and_b32 v86, 0x7fff7fff, v11
    v_sin_f32 v37, v39
    v_mul_f32 v36, v36, v38
    v_mul_f32 v37, v37, v38
    v_dot2_f32_bf16 v84, v85, s52, 0
    v_cvt_pk_f16_f32 v45, v36, v37
    v_mul_f32 v38, v37, v37
    v_dot2_f32_bf16 v84, v86, s52, v84
    v_mul_f32 v39, v36, v37
    v_fma_f32 v36, v36, v36, -v38
    v_add_f32 v37, v39, v39
    v_add_f32_dpp v84, v84, v84 row_shr:1 row_mask:0xf bank_mask:0xf
    v_cvt_pk_f16_f32 v46, v36, v37
    v_mul_f32 v38, v37, v37
    v_add_f32_dpp v84, v84, v84 row_shr:2 row_mask:0xf bank_mask:0xf
    v_mul_f32 v39, v36, v37
    v_fma_f32 v36, v36, v36, -v38
    v_add_f32_dpp v84, v84, v84 row_shr:4 row_mask:0xf bank_mask:0xf
    v_add_f32 v37, v39, v39
    v_cvt_pk_f16_f32 v48, v36, v37
    v_mul_f32 v38, v37, v37
    v_add_f32_dpp v84, v84, v84 row_shr:8 row_mask:0xf bank_mask:0xf
    v_mul_f32 v39, v36, v37
    v_fma_f32 v36, v36, v36, -v38
    v_add_f32_dpp v84, v84, v84 row_bcast:15 row_mask:0xa bank_mask:0xf
    v_add_f32 v37, v39, v39
    v_cvt_pk_f16_f32 v52, v36, v37
    v_mul_f32 v38, v37, v37
    v_add_f32_dpp v84, v84, v84 row_bcast:31 row_mask:0xc bank_mask:0xf
    v_mul_f32 v39, v36, v37
    v_fma_f32 v36, v36, v36, -v38
    v_fma_f32 v84, v84, v29, s51
    v_add_f32 v37, v39, v39
    v_cvt_pk_f16_f32 v60, v36, v37
    v_frexp_exp_i32_f32 v84, v84
    v_pk_mul_f16 v47, v46, v45 op_sel:[1,1] op_sel_hi:[1,0] neg_lo:[1,0]
    v_pk_fma_f16 v47, v46, v45, v47 op_sel:[0,0,0] op_sel_hi:[0,1,1]
    v_fract_f32 v43, v34
    ds_write_addtid_b32 v45 offset:272
    ds_write_addtid_b32 v46 offset:544
    v_exp_f32 v42, v32
    v_pk_mul_f16 v49, v48, v45 op_sel:[1,1] op_sel_hi:[1,0] neg_lo:[1,0]
    v_cos_f32 v40, v43
    v_pk_mul_f16 v50, v48, v46 op_sel:[1,1] op_sel_hi:[1,0] neg_lo:[1,0]
    v_pk_fma_f16 v49, v48, v45, v49 op_sel:[0,0,0] op_sel_hi:[0,1,1]
    v_sin_f32 v41, v43
    v_pk_fma_f16 v50, v48, v46, v50 op_sel:[0,0,0] op_sel_hi:[0,1,1]
    ds_write_addtid_b32 v47 offset:816
    v_readlane_b32 s40, v84, 63
    ds_write_addtid_b32 v48 offset:1088
    v_mul_f32 v40, v40, v42
    v_pk_mul_f16 v51, v48, v47 op_sel:[1,1] op_sel_hi:[1,0] neg_lo:[1,0]
    v_pk_fma_f16 v51, v48, v47, v51 op_sel:[0,0,0] op_sel_hi:[0,1,1]
    v_mul_f32 v41, v41, v42
    ds_write_addtid_b32 v49 offset:1360
    ds_write_addtid_b32 v50 offset:1632
    v_cvt_pk_f16_f32 v61, v40, v41
    v_pk_mul_f16 v53, v52, v45 op_sel:[1,1] op_sel_hi:[1,0] neg_lo:[1,0]
    v_mul_f32 v42, v41, v41
    v_pk_mul_f16 v54, v52, v46 op_sel:[1,1] op_sel_hi:[1,0] neg_lo:[1,0]
    v_pk_fma_f16 v53, v52, v45, v53 op_sel:[0,0,0] op_sel_hi:[0,1,1]
    s_sub_i32 s40, 141, s40
    v_pk_fma_f16 v54, v52, v46, v54 op_sel:[0,0,0] op_sel_hi:[0,1,1]
    ds_write_addtid_b32 v51 offset:1904
    v_mul_f32 v43, v40, v41
    ds_write_addtid_b32 v52 offset:2176
    v_fma_f32 v40, v40, v40, -v42
    v_pk_mul_f16 v55, v52, v47 op_sel:[1,1] op_sel_hi:[1,0] neg_lo:[1,0]
    v_pk_mul_f16 v56, v52, v48 op_sel:[1,1] op_sel_hi:[1,0] neg_lo:[1,0]
    v_add_f32 v41, v43, v43
    v_pk_fma_f16 v55, v52, v47, v55 op_sel:[0,0,0] op_sel_hi:[0,1,1]
    v_pk_fma_f16 v56, v52, v48, v56 op_sel:[0,0,0] op_sel_hi:[0,1,1]
    v_cvt_pk_f16_f32 v62, v40, v41
    ds_write_addtid_b32 v53 offset:2448
    s_max_i32 s40, s40, 67
    ds_write_addtid_b32 v54 offset:2720
    v_pk_mul_f16 v57, v52, v49 op_sel:[1,1] op_sel_hi:[1,0] neg_lo:[1,0]
    v_mul_f32 v42, v41, v41
    v_pk_mul_f16 v58, v52, v50 op_sel:[1,1] op_sel_hi:[1,0] neg_lo:[1,0]
    v_pk_fma_f16 v57, v52, v49, v57 op_sel:[0,0,0] op_sel_hi:[0,1,1]
    v_mul_f32 v43, v40, v41
    v_pk_fma_f16 v58, v52, v50, v58 op_sel:[0,0,0] op_sel_hi:[0,1,1]
    v_fma_f32 v40, v40, v40, -v42
    ds_write_addtid_b32 v55 offset:2992
    ds_write_addtid_b32 v56 offset:3264
    v_add_f32 v41, v43, v43
    v_pk_mul_f16 v59, v52, v51 op_sel:[1,1] op_sel_hi:[1,0] neg_lo:[1,0]
    v_pk_fma_f16 v59, v52, v51, v59 op_sel:[0,0,0] op_sel_hi:[0,1,1]
    s_min_i32 s40, s40, 187
    ds_write_addtid_b32 v57 offset:3536
    v_cvt_pk_f16_f32 v63, v40, v41
    ds_write_addtid_b32 v58 offset:3808
    v_pk_mul_f16 v80, v60, v45 op_sel:[1,1] op_sel_hi:[1,0] neg_lo:[1,0]
    v_mul_f32 v42, 0x43800000, v32
    v_pk_mul_f16 v81, v60, v46 op_sel:[1,1] op_sel_hi:[1,0] neg_lo:[1,0]
    v_pk_fma_f16 v80, v60, v45, v80 op_sel:[0,0,0] op_sel_hi:[0,1,1]
    v_mul_f32 v43, 0x43800000, v34
    v_pk_fma_f16 v81, v60, v46, v81 op_sel:[0,0,0] op_sel_hi:[0,1,1]
    v_fract_f32 v43, v43
    ds_write_addtid_b32 v59 offset:4080
    ds_write_addtid_b32 v60 offset:4352
    s_lshl_b32 s40, s40, 23
    v_pk_mul_f16 v82, v60, v47 op_sel:[1,1] op_sel_hi:[1,0] neg_lo:[1,0]
    v_pk_mul_f16 v83, v60, v48 op_sel:[1,1] op_sel_hi:[1,0] neg_lo:[1,0]
    v_exp_f32 v42, v42
    v_pk_fma_f16 v82, v60, v47, v82 op_sel:[0,0,0] op_sel_hi:[0,1,1]
    v_cos_f32 v40, v43
    v_pk_fma_f16 v83, v60, v48, v83 op_sel:[0,0,0] op_sel_hi:[0,1,1]
    ds_write_addtid_b32 v80 offset:4624
    v_sin_f32 v41, v43
    ds_write_addtid_b32 v81 offset:4896
    v_pk_mul_f16 v80, v60, v49 op_sel:[1,1] op_sel_hi:[1,0] neg_lo:[1,0]
    v_mul_f32 v40, v40, v42
    v_pk_mul_f16 v81, v60, v50 op_sel:[1,1] op_sel_hi:[1,0] neg_lo:[1,0]
    v_mul_f32 v30, s40, v29
    v_pk_fma_f16 v80, v60, v49, v80 op_sel:[0,0,0] op_sel_hi:[0,1,1]
    v_pk_fma_f16 v81, v60, v50, v81 op_sel:[0,0,0] op_sel_hi:[0,1,1]
    v_mul_f32 v41, v41, v42
    ds_write_addtid_b32 v82 offset:5168
    ds_write_addtid_b32 v83 offset:5440
    v_cvt_pk_f16_f32 v64, v40, v41
    v_pk_mul_f16 v82, v60, v51 op_sel:[1,1] op_sel_hi:[1,0] neg_lo:[1,0]
    v_mul_f32 v42, v41, v41
    v_pk_mul_f16 v83, v60, v52 op_sel:[1,1] op_sel_hi:[1,0] neg_lo:[1,0]
    v_pk_fma_f16 v82, v60, v51, v82 op_sel:[0,0,0] op_sel_hi:[0,1,1]
    v_mul_f32 v43, v40, v41
    v_pk_fma_f16 v83, v60, v52, v83 op_sel:[0,0,0] op_sel_hi:[0,1,1]
    ds_write_addtid_b32 v80 offset:5712
    v_mul_f32 v26, s40, v26
    ds_write_addtid_b32 v81 offset:5984
    v_fma_f32 v40, v40, v40, -v42
    v_pk_mul_f16 v80, v60, v53 op_sel:[1,1] op_sel_hi:[1,0] neg_lo:[1,0]
    v_pk_mul_f16 v81, v60, v54 op_sel:[1,1] op_sel_hi:[1,0] neg_lo:[1,0]
    v_add_f32 v41, v43, v43
    v_pk_fma_f16 v80, v60, v53, v80 op_sel:[0,0,0] op_sel_hi:[0,1,1]
    v_pk_fma_f16 v81, v60, v54, v81 op_sel:[0,0,0] op_sel_hi:[0,1,1]
    v_cvt_pk_f16_f32 v65, v40, v41
    ds_write_addtid_b32 v82 offset:6256
    v_mul_f32 v42, v41, v41
    ds_write_addtid_b32 v83 offset:6528
    v_pk_mul_f16 v82, v60, v55 op_sel:[1,1] op_sel_hi:[1,0] neg_lo:[1,0]
    v_mov_b32 v85, 0x40053526
    v_pk_mul_f16 v83, v60, v56 op_sel:[1,1] op_sel_hi:[1,0] neg_lo:[1,0]
    v_pk_fma_f16 v82, v60, v55, v82 op_sel:[0,0,0] op_sel_hi:[0,1,1]
    v_mul_f32 v43, v40, v41
    v_pk_fma_f16 v83, v60, v56, v83 op_sel:[0,0,0] op_sel_hi:[0,1,1]
    v_fma_f32 v40, v40, v40, -v42
    ds_write_addtid_b32 v80 offset:6800
    ds_write_addtid_b32 v81 offset:7072
    v_add_f32 v41, v43, v43
    v_pk_mul_f16 v80, v60, v57 op_sel:[1,1] op_sel_hi:[1,0] neg_lo:[1,0]
    v_pk_mul_f16 v81, v60, v58 op_sel:[1,1] op_sel_hi:[1,0] neg_lo:[1,0]
    v_cvt_pk_f16_f32 v66, v40, v41
    v_pk_fma_f16 v80, v60, v57, v80 op_sel:[0,0,0] op_sel_hi:[0,1,1]
    v_mul_f32 v85, s40, v85
    v_pk_fma_f16 v81, v60, v58, v81 op_sel:[0,0,0] op_sel_hi:[0,1,1]
    ds_write_addtid_b32 v82 offset:7344
    v_lshlrev_b32 v40, 16, v10
    ds_write_addtid_b32 v83 offset:7616
    v_pk_mul_f16 v82, v60, v59 op_sel:[1,1] op_sel_hi:[1,0] neg_lo:[1,0]
    v_lshlrev_b32 v41, 16, v11
    v_pk_fma_f16 v82, v60, v59, v82 op_sel:[0,0,0] op_sel_hi:[0,1,1]
    v_mul_f32 v40, v40, v30
    ds_write_addtid_b32 v80 offset:7888
    ds_write_addtid_b32 v81 offset:8160
    v_mul_f32 v41, -v41, v30
    ds_write_addtid_b32 v82 offset:8432
    v_cvt_pk_f16_f32 v67, v40, v41
    s_mov_b64 exec, 1
    ds_write_b32 v31, v85 offset:0
    s_mov_b64 exec, -1
    v_pk_mul_f16 v73, v67, v64 op_sel:[1,1] op_sel_hi:[1,0]
    v_pk_mul_f16 v68, v67, v61 op_sel:[1,1] op_sel_hi:[1,0]
    v_pk_fma_f16 v73, v67, v64, v73 op_sel:[0,0,0] op_sel_hi:[0,1,1] neg_hi:[0,1,0]
    v_pk_fma_f16 v68, v67, v61, v68 op_sel:[0,0,0] op_sel_hi:[0,1,1] neg_hi:[0,1,0]
    ds_write_addtid_b32 v67 offset:8704
    v_pk_mul_f16 v69, v67, v62 op_sel:[1,1] op_sel_hi:[1,0]
    v_pk_mul_f16 v71, v67, v63 op_sel:[1,1] op_sel_hi:[1,0]
    v_pk_fma_f16 v69, v67, v62, v69 op_sel:[0,0,0] op_sel_hi:[0,1,1] neg_hi:[0,1,0]
    v_pk_fma_f16 v71, v67, v63, v71 op_sel:[0,0,0] op_sel_hi:[0,1,1] neg_hi:[0,1,0]
    ds_write_addtid_b32 v73 offset:11696
    ds_write_addtid_b32 v68 offset:8976
    v_pk_mul_f16 v75, v73, v45 op_sel:[1,1] op_sel_hi:[1,0]
    v_pk_mul_f16 v70, v68, v62 op_sel:[1,1] op_sel_hi:[1,0]
    v_pk_fma_f16 v75, v73, v45, v75 op_sel:[0,0,0] op_sel_hi:[0,1,1] neg_hi:[0,1,0]
    v_pk_fma_f16 v70, v68, v62, v70 op_sel:[0,0,0] op_sel_hi:[0,1,1] neg_hi:[0,1,0]
    ds_write_addtid_b32 v69 offset:9248
    ds_write_addtid_b32 v71 offset:12240
    v_pk_mul_f16 v72, v69, v63 op_sel:[1,1] op_sel_hi:[1,0]
    v_pk_mul_f16 v74, v71, v64 op_sel:[1,1] op_sel_hi:[1,0]
    v_pk_fma_f16 v72, v69, v63, v72 op_sel:[0,0,0] op_sel_hi:[0,1,1] neg_hi:[0,1,0]
    v_pk_fma_f16 v74, v71, v64, v74 op_sel:[0,0,0] op_sel_hi:[0,1,1] neg_hi:[0,1,0]
    ds_write_addtid_b32 v75 offset:10064
    ds_write_addtid_b32 v70 offset:9520
    v_pk_mul_f16 v76, v75, v64 op_sel:[1,1] op_sel_hi:[1,0]
    v_pk_mul_f16 v77, v75, v65 op_sel:[1,1] op_sel_hi:[1,0]
    v_pk_fma_f16 v76, v75, v64, v76 op_sel:[0,0,0] op_sel_hi:[0,1,1] neg_hi:[0,1,0]
    v_pk_fma_f16 v77, v75, v65, v77 op_sel:[0,0,0] op_sel_hi:[0,1,1] neg_hi:[0,1,0]
    ds_write_addtid_b32 v72 offset:12784
    ds_write_addtid_b32 v74 offset:11424
    v_pk_mul_f16 v80, v68, v63 op_sel:[1,1] op_sel_hi:[1,0]
    v_pk_mul_f16 v81, v70, v63 op_sel:[1,1] op_sel_hi:[1,0]
    v_pk_fma_f16 v80, v68, v63, v80 op_sel:[0,0,0] op_sel_hi:[0,1,1] neg_hi:[0,1,0]
    v_pk_fma_f16 v81, v70, v63, v81 op_sel:[0,0,0] op_sel_hi:[0,1,1] neg_hi:[0,1,0]
    ds_write_addtid_b32 v76 offset:13600
    ds_write_addtid_b32 v77 offset:10608
    v_pk_mul_f16 v82, v69, v64 op_sel:[1,1] op_sel_hi:[1,0]
    v_pk_mul_f16 v83, v72, v64 op_sel:[1,1] op_sel_hi:[1,0]
    v_pk_fma_f16 v82, v69, v64, v82 op_sel:[0,0,0] op_sel_hi:[0,1,1] neg_hi:[0,1,0]
    v_pk_fma_f16 v83, v72, v64, v83 op_sel:[0,0,0] op_sel_hi:[0,1,1] neg_hi:[0,1,0]
    ds_write_addtid_b32 v80 offset:12512
    ds_write_addtid_b32 v81 offset:13056
    v_pk_mul_f16 v80, v71, v65 op_sel:[1,1] op_sel_hi:[1,0]
    v_pk_mul_f16 v81, v74, v65 op_sel:[1,1] op_sel_hi:[1,0]
    v_pk_fma_f16 v80, v71, v65, v80 op_sel:[0,0,0] op_sel_hi:[0,1,1] neg_hi:[0,1,0]
    v_pk_fma_f16 v81, v74, v65, v81 op_sel:[0,0,0] op_sel_hi:[0,1,1] neg_hi:[0,1,0]
    ds_write_addtid_b32 v82 offset:11968
    ds_write_addtid_b32 v83 offset:9792
    v_pk_mul_f16 v82, v75, v66 op_sel:[1,1] op_sel_hi:[1,0]
    v_pk_mul_f16 v83, v76, v65 op_sel:[1,1] op_sel_hi:[1,0]
    v_pk_fma_f16 v82, v75, v66, v82 op_sel:[0,0,0] op_sel_hi:[0,1,1] neg_hi:[0,1,0]
    v_pk_fma_f16 v83, v76, v65, v83 op_sel:[0,0,0] op_sel_hi:[0,1,1] neg_hi:[0,1,0]
    ds_write_addtid_b32 v80 offset:13328
    ds_write_addtid_b32 v81 offset:10336
    v_pk_mul_f16 v80, v76, v66 op_sel:[1,1] op_sel_hi:[1,0]
    v_pk_mul_f16 v81, v77, v66 op_sel:[1,1] op_sel_hi:[1,0]
    v_pk_fma_f16 v80, v76, v66, v80 op_sel:[0,0,0] op_sel_hi:[0,1,1] neg_hi:[0,1,0]
    v_pk_fma_f16 v81, v77, v66, v81 op_sel:[0,0,0] op_sel_hi:[0,1,1] neg_hi:[0,1,0]
    ds_write_addtid_b32 v82 offset:10880
    ds_write_addtid_b32 v83 offset:13872
    ds_write_addtid_b32 v80 offset:14144
    ds_write_addtid_b32 v81 offset:11152
    ds_read_b128 v[88:91], v16 offset:8704
    ds_read_b128 v[92:95], v17 offset:0
    ds_read_b128 v[96:99], v16 offset:8736
    ds_read_b128 v[100:103], v17 offset:32
    ds_read_b128 v[104:107], v16 offset:8768
    ds_read_b128 v[108:111], v17 offset:64
    v_mul_f32 v38, 0x41000000, v33
    v_fract_f32 v43, v35
    v_mul_f32 v39, 0x41000000, v35
    v_exp_f32 v42, v33
    v_fract_f32 v39, v39
    v_cos_f32 v40, v43
    v_sin_f32 v41, v43
    v_exp_f32 v38, v38
    s_waitcnt lgkmcnt(4)
    v_mfma_f32_32x32x16_f16 v[112:127], v[88:91], v[92:95], 0
    ds_read_b128 v[88:91], v16 offset:8800
    ds_read_b128 v[92:95], v17 offset:96
    v_mul_f32 v40, v40, v42
    v_cos_f32 v36, v39
    v_mul_f32 v41, v41, v42
    v_cvt_pk_f16_f32 v61, v40, v41
    v_sin_f32 v37, v39
    v_mul_f32 v42, v41, v41
    v_mul_f32 v36, v36, v38
    v_mul_f32 v43, v40, v41
    s_waitcnt lgkmcnt(4)
    v_mfma_f32_32x32x16_f16 v[112:127], v[96:99], v[100:103], v[112:127]
    ds_read_b128 v[96:99], v16 offset:8832
    ds_read_b128 v[100:103], v17 offset:128
    v_mul_f32 v37, v37, v38
    v_fma_f32 v40, v40, v40, -v42
    v_add_f32 v41, v43, v43
    v_cvt_pk_f16_f32 v45, v36, v37
    v_cvt_pk_f16_f32 v62, v40, v41
    v_mul_f32 v38, v37, v37
    v_mul_f32 v42, v41, v41
    v_mul_f32 v43, v40, v41
    s_waitcnt lgkmcnt(4)
    v_mfma_f32_32x32x16_f16 v[112:127], v[104:107], v[108:111], v[112:127]
    ds_read_b128 v[104:107], v16 offset:8864
    ds_read_b128 v[108:111], v17 offset:160
    v_mul_f32 v39, v36, v37
    v_fma_f32 v40, v40, v40, -v42
    v_fma_f32 v36, v36, v36, -v38
    v_add_f32 v41, v43, v43
    v_add_f32 v37, v39, v39
    v_cvt_pk_f16_f32 v63, v40, v41
    v_mul_f32 v42, 0x43800000, v33
    v_cvt_pk_f16_f32 v46, v36, v37
    s_waitcnt lgkmcnt(4)
    v_mfma_f32_32x32x16_f16 v[112:127], v[88:91], v[92:95], v[112:127]
    ds_read_b128 v[88:91], v16 offset:8896
    ds_read_b128 v[92:95], v17 offset:192
    v_mul_f32 v43, 0x43800000, v35
    v_mul_f32 v38, v37, v37
    v_fract_f32 v43, v43
    v_exp_f32 v42, v42
    v_mul_f32 v39, v36, v37
    v_cos_f32 v40, v43
    v_fma_f32 v36, v36, v36, -v38
    v_sin_f32 v41, v43
    s_waitcnt lgkmcnt(4)
    v_mfma_f32_32x32x16_f16 v[112:127], v[96:99], v[100:103], v[112:127]
    ds_read_b128 v[96:99], v16 offset:8928
    ds_read_b128 v[100:103], v17 offset:224
    v_mul_f32 v40, v40, v42
    v_add_f32 v37, v39, v39
    v_mul_f32 v41, v41, v42
    v_cvt_pk_f16_f32 v48, v36, v37
    v_cvt_pk_f16_f32 v64, v40, v41
    v_mul_f32 v38, v37, v37
    v_mul_f32 v42, v41, v41
    v_mul_f32 v43, v40, v41
    s_waitcnt lgkmcnt(4)
    v_mfma_f32_32x32x16_f16 v[112:127], v[104:107], v[108:111], v[112:127]
    v_mul_f32 v39, v36, v37
    v_fma_f32 v40, v40, v40, -v42
    v_fma_f32 v36, v36, v36, -v38
    v_add_f32 v41, v43, v43
    v_cvt_pk_f16_f32 v65, v40, v41
    v_add_f32 v37, v39, v39
    v_mul_f32 v42, v41, v41
    v_cvt_pk_f16_f32 v52, v36, v37
    s_waitcnt lgkmcnt(2)
    v_mfma_f32_32x32x16_f16 v[112:127], v[88:91], v[92:95], v[112:127]
    v_mul_f32 v43, v40, v41
    v_mul_f32 v38, v37, v37
    v_fma_f32 v40, v40, v40, -v42
    v_add_f32 v41, v43, v43
    v_mul_f32 v39, v36, v37
    v_cvt_pk_f16_f32 v66, v40, v41
    v_fma_f32 v36, v36, v36, -v38
    v_and_b32 v40, 0xffff0000, v10
    s_waitcnt lgkmcnt(0)
    v_mfma_f32_32x32x16_f16 v[112:127], v[96:99], v[100:103], v[112:127]
    v_and_b32 v41, 0xffff0000, v11
    v_add_f32 v37, v39, v39
    v_mul_f32 v40, v40, v30
    v_cvt_pk_f16_f32 v60, v36, v37
    v_mul_f32 v41, -v41, v30
    v_cvt_pk_f16_f32 v67, v40, v41
    v_pk_mul_f16 v47, v46, v45 op_sel:[1,1] op_sel_hi:[1,0] neg_lo:[1,0]
    v_pk_fma_f16 v47, v46, v45, v47 op_sel:[0,0,0] op_sel_hi:[0,1,1]
    ds_write_addtid_b32 v45 offset:272
    ds_write_addtid_b32 v46 offset:544
    v_pk_mul_f16 v49, v48, v45 op_sel:[1,1] op_sel_hi:[1,0] neg_lo:[1,0]
    v_pk_mul_f16 v50, v48, v46 op_sel:[1,1] op_sel_hi:[1,0] neg_lo:[1,0]
    v_pk_fma_f16 v49, v48, v45, v49 op_sel:[0,0,0] op_sel_hi:[0,1,1]
    v_pk_fma_f16 v50, v48, v46, v50 op_sel:[0,0,0] op_sel_hi:[0,1,1]
    ds_write_addtid_b32 v47 offset:816
    ds_write_addtid_b32 v48 offset:1088
    v_pk_mul_f16 v51, v48, v47 op_sel:[1,1] op_sel_hi:[1,0] neg_lo:[1,0]
    v_pk_fma_f16 v51, v48, v47, v51 op_sel:[0,0,0] op_sel_hi:[0,1,1]
    ds_write_addtid_b32 v49 offset:1360
    ds_write_addtid_b32 v50 offset:1632
    v_pk_mul_f16 v53, v52, v45 op_sel:[1,1] op_sel_hi:[1,0] neg_lo:[1,0]
    v_pk_mul_f16 v54, v52, v46 op_sel:[1,1] op_sel_hi:[1,0] neg_lo:[1,0]
    v_pk_fma_f16 v53, v52, v45, v53 op_sel:[0,0,0] op_sel_hi:[0,1,1]
    v_pk_fma_f16 v54, v52, v46, v54 op_sel:[0,0,0] op_sel_hi:[0,1,1]
    ds_write_addtid_b32 v51 offset:1904
    ds_write_addtid_b32 v52 offset:2176
    v_pk_mul_f16 v55, v52, v47 op_sel:[1,1] op_sel_hi:[1,0] neg_lo:[1,0]
    v_pk_mul_f16 v56, v52, v48 op_sel:[1,1] op_sel_hi:[1,0] neg_lo:[1,0]
    v_pk_fma_f16 v55, v52, v47, v55 op_sel:[0,0,0] op_sel_hi:[0,1,1]
    v_pk_fma_f16 v56, v52, v48, v56 op_sel:[0,0,0] op_sel_hi:[0,1,1]
    ds_write_addtid_b32 v53 offset:2448
    ds_write_addtid_b32 v54 offset:2720
    v_pk_mul_f16 v57, v52, v49 op_sel:[1,1] op_sel_hi:[1,0] neg_lo:[1,0]
    v_pk_mul_f16 v58, v52, v50 op_sel:[1,1] op_sel_hi:[1,0] neg_lo:[1,0]
    v_pk_fma_f16 v57, v52, v49, v57 op_sel:[0,0,0] op_sel_hi:[0,1,1]
    v_pk_fma_f16 v58, v52, v50, v58 op_sel:[0,0,0] op_sel_hi:[0,1,1]
    ds_write_addtid_b32 v55 offset:2992
    ds_write_addtid_b32 v56 offset:3264
    v_pk_mul_f16 v59, v52, v51 op_sel:[1,1] op_sel_hi:[1,0] neg_lo:[1,0]
    v_pk_fma_f16 v59, v52, v51, v59 op_sel:[0,0,0] op_sel_hi:[0,1,1]
    ds_write_addtid_b32 v57 offset:3536
    ds_write_addtid_b32 v58 offset:3808
    v_pk_mul_f16 v80, v60, v45 op_sel:[1,1] op_sel_hi:[1,0] neg_lo:[1,0]
    v_pk_mul_f16 v81, v60, v46 op_sel:[1,1] op_sel_hi:[1,0] neg_lo:[1,0]
    v_pk_fma_f16 v80, v60, v45, v80 op_sel:[0,0,0] op_sel_hi:[0,1,1]
    v_pk_fma_f16 v81, v60, v46, v81 op_sel:[0,0,0] op_sel_hi:[0,1,1]
    ds_write_addtid_b32 v59 offset:4080
    ds_write_addtid_b32 v60 offset:4352
    v_pk_mul_f16 v82, v60, v47 op_sel:[1,1] op_sel_hi:[1,0] neg_lo:[1,0]
    v_pk_mul_f16 v83, v60, v48 op_sel:[1,1] op_sel_hi:[1,0] neg_lo:[1,0]
    v_pk_fma_f16 v82, v60, v47, v82 op_sel:[0,0,0] op_sel_hi:[0,1,1]
    v_pk_fma_f16 v83, v60, v48, v83 op_sel:[0,0,0] op_sel_hi:[0,1,1]
    ds_write_addtid_b32 v80 offset:4624
    ds_write_addtid_b32 v81 offset:4896
    v_pk_mul_f16 v80, v60, v49 op_sel:[1,1] op_sel_hi:[1,0] neg_lo:[1,0]
    v_pk_mul_f16 v81, v60, v50 op_sel:[1,1] op_sel_hi:[1,0] neg_lo:[1,0]
    v_pk_fma_f16 v80, v60, v49, v80 op_sel:[0,0,0] op_sel_hi:[0,1,1]
    v_pk_fma_f16 v81, v60, v50, v81 op_sel:[0,0,0] op_sel_hi:[0,1,1]
    ds_write_addtid_b32 v82 offset:5168
    ds_write_addtid_b32 v83 offset:5440
    v_pk_mul_f16 v82, v60, v51 op_sel:[1,1] op_sel_hi:[1,0] neg_lo:[1,0]
    v_pk_mul_f16 v83, v60, v52 op_sel:[1,1] op_sel_hi:[1,0] neg_lo:[1,0]
    v_pk_fma_f16 v82, v60, v51, v82 op_sel:[0,0,0] op_sel_hi:[0,1,1]
    v_pk_fma_f16 v83, v60, v52, v83 op_sel:[0,0,0] op_sel_hi:[0,1,1]
    ds_write_addtid_b32 v80 offset:5712
    ds_write_addtid_b32 v81 offset:5984
    v_pk_mul_f16 v80, v60, v53 op_sel:[1,1] op_sel_hi:[1,0] neg_lo:[1,0]
    v_pk_mul_f16 v81, v60, v54 op_sel:[1,1] op_sel_hi:[1,0] neg_lo:[1,0]
    v_pk_fma_f16 v80, v60, v53, v80 op_sel:[0,0,0] op_sel_hi:[0,1,1]
    v_pk_fma_f16 v81, v60, v54, v81 op_sel:[0,0,0] op_sel_hi:[0,1,1]
    ds_write_addtid_b32 v82 offset:6256
    ds_write_addtid_b32 v83 offset:6528
    v_pk_mul_f16 v82, v60, v55 op_sel:[1,1] op_sel_hi:[1,0] neg_lo:[1,0]
    v_pk_mul_f16 v83, v60, v56 op_sel:[1,1] op_sel_hi:[1,0] neg_lo:[1,0]
    v_pk_fma_f16 v82, v60, v55, v82 op_sel:[0,0,0] op_sel_hi:[0,1,1]
    v_pk_fma_f16 v83, v60, v56, v83 op_sel:[0,0,0] op_sel_hi:[0,1,1]
    ds_write_addtid_b32 v80 offset:6800
    ds_write_addtid_b32 v81 offset:7072
    v_pk_mul_f16 v80, v60, v57 op_sel:[1,1] op_sel_hi:[1,0] neg_lo:[1,0]
    v_pk_mul_f16 v81, v60, v58 op_sel:[1,1] op_sel_hi:[1,0] neg_lo:[1,0]
    v_pk_fma_f16 v80, v60, v57, v80 op_sel:[0,0,0] op_sel_hi:[0,1,1]
    v_pk_fma_f16 v81, v60, v58, v81 op_sel:[0,0,0] op_sel_hi:[0,1,1]
    ds_write_addtid_b32 v82 offset:7344
    ds_write_addtid_b32 v83 offset:7616
    v_pk_mul_f16 v82, v60, v59 op_sel:[1,1] op_sel_hi:[1,0] neg_lo:[1,0]
    v_pk_fma_f16 v82, v60, v59, v82 op_sel:[0,0,0] op_sel_hi:[0,1,1]
    ds_write_addtid_b32 v80 offset:7888
    ds_write_addtid_b32 v81 offset:8160
    ds_write_addtid_b32 v82 offset:8432
    v_pk_mul_f16 v73, v67, v64 op_sel:[1,1] op_sel_hi:[1,0]
    v_pk_mul_f16 v68, v67, v61 op_sel:[1,1] op_sel_hi:[1,0]
    v_pk_fma_f16 v73, v67, v64, v73 op_sel:[0,0,0] op_sel_hi:[0,1,1] neg_hi:[0,1,0]
    v_pk_fma_f16 v68, v67, v61, v68 op_sel:[0,0,0] op_sel_hi:[0,1,1] neg_hi:[0,1,0]
    ds_write_addtid_b32 v67 offset:8704
    v_pk_mul_f16 v69, v67, v62 op_sel:[1,1] op_sel_hi:[1,0]
    v_pk_mul_f16 v71, v67, v63 op_sel:[1,1] op_sel_hi:[1,0]
    v_pk_fma_f16 v69, v67, v62, v69 op_sel:[0,0,0] op_sel_hi:[0,1,1] neg_hi:[0,1,0]
    v_pk_fma_f16 v71, v67, v63, v71 op_sel:[0,0,0] op_sel_hi:[0,1,1] neg_hi:[0,1,0]
    ds_write_addtid_b32 v73 offset:11696
    ds_write_addtid_b32 v68 offset:8976
    v_pk_mul_f16 v75, v73, v45 op_sel:[1,1] op_sel_hi:[1,0]
    v_pk_mul_f16 v70, v68, v62 op_sel:[1,1] op_sel_hi:[1,0]
    v_pk_fma_f16 v75, v73, v45, v75 op_sel:[0,0,0] op_sel_hi:[0,1,1] neg_hi:[0,1,0]
    v_pk_fma_f16 v70, v68, v62, v70 op_sel:[0,0,0] op_sel_hi:[0,1,1] neg_hi:[0,1,0]
    ds_write_addtid_b32 v69 offset:9248
    ds_write_addtid_b32 v71 offset:12240
    v_pk_mul_f16 v72, v69, v63 op_sel:[1,1] op_sel_hi:[1,0]
    v_pk_mul_f16 v74, v71, v64 op_sel:[1,1] op_sel_hi:[1,0]
    v_pk_fma_f16 v72, v69, v63, v72 op_sel:[0,0,0] op_sel_hi:[0,1,1] neg_hi:[0,1,0]
    v_pk_fma_f16 v74, v71, v64, v74 op_sel:[0,0,0] op_sel_hi:[0,1,1] neg_hi:[0,1,0]
    ds_write_addtid_b32 v75 offset:10064
    ds_write_addtid_b32 v70 offset:9520
    v_pk_mul_f16 v76, v75, v64 op_sel:[1,1] op_sel_hi:[1,0]
    v_pk_mul_f16 v77, v75, v65 op_sel:[1,1] op_sel_hi:[1,0]
    v_pk_fma_f16 v76, v75, v64, v76 op_sel:[0,0,0] op_sel_hi:[0,1,1] neg_hi:[0,1,0]
    v_pk_fma_f16 v77, v75, v65, v77 op_sel:[0,0,0] op_sel_hi:[0,1,1] neg_hi:[0,1,0]
    ds_write_addtid_b32 v72 offset:12784
    ds_write_addtid_b32 v74 offset:11424
    v_pk_mul_f16 v80, v68, v63 op_sel:[1,1] op_sel_hi:[1,0]
    v_pk_mul_f16 v81, v70, v63 op_sel:[1,1] op_sel_hi:[1,0]
    v_pk_fma_f16 v80, v68, v63, v80 op_sel:[0,0,0] op_sel_hi:[0,1,1] neg_hi:[0,1,0]
    v_pk_fma_f16 v81, v70, v63, v81 op_sel:[0,0,0] op_sel_hi:[0,1,1] neg_hi:[0,1,0]
    ds_write_addtid_b32 v76 offset:13600
    ds_write_addtid_b32 v77 offset:10608
    v_pk_mul_f16 v82, v69, v64 op_sel:[1,1] op_sel_hi:[1,0]
    v_pk_mul_f16 v83, v72, v64 op_sel:[1,1] op_sel_hi:[1,0]
    v_pk_fma_f16 v82, v69, v64, v82 op_sel:[0,0,0] op_sel_hi:[0,1,1] neg_hi:[0,1,0]
    v_pk_fma_f16 v83, v72, v64, v83 op_sel:[0,0,0] op_sel_hi:[0,1,1] neg_hi:[0,1,0]
    ds_write_addtid_b32 v80 offset:12512
    ds_write_addtid_b32 v81 offset:13056
    v_pk_mul_f16 v80, v71, v65 op_sel:[1,1] op_sel_hi:[1,0]
    v_pk_mul_f16 v81, v74, v65 op_sel:[1,1] op_sel_hi:[1,0]
    v_pk_fma_f16 v80, v71, v65, v80 op_sel:[0,0,0] op_sel_hi:[0,1,1] neg_hi:[0,1,0]
    v_pk_fma_f16 v81, v74, v65, v81 op_sel:[0,0,0] op_sel_hi:[0,1,1] neg_hi:[0,1,0]
    ds_write_addtid_b32 v82 offset:11968
    ds_write_addtid_b32 v83 offset:9792
    v_pk_mul_f16 v82, v75, v66 op_sel:[1,1] op_sel_hi:[1,0]
    v_pk_mul_f16 v83, v76, v65 op_sel:[1,1] op_sel_hi:[1,0]
    v_pk_fma_f16 v82, v75, v66, v82 op_sel:[0,0,0] op_sel_hi:[0,1,1] neg_hi:[0,1,0]
    v_pk_fma_f16 v83, v76, v65, v83 op_sel:[0,0,0] op_sel_hi:[0,1,1] neg_hi:[0,1,0]
    ds_write_addtid_b32 v80 offset:13328
    ds_write_addtid_b32 v81 offset:10336
    v_pk_mul_f16 v80, v76, v66 op_sel:[1,1] op_sel_hi:[1,0]
    v_pk_mul_f16 v81, v77, v66 op_sel:[1,1] op_sel_hi:[1,0]
    v_pk_fma_f16 v80, v76, v66, v80 op_sel:[0,0,0] op_sel_hi:[0,1,1] neg_hi:[0,1,0]
    v_pk_fma_f16 v81, v77, v66, v81 op_sel:[0,0,0] op_sel_hi:[0,1,1] neg_hi:[0,1,0]
    ds_write_addtid_b32 v82 offset:10880
    ds_write_addtid_b32 v83 offset:13872
    ds_write_addtid_b32 v80 offset:14144
    ds_write_addtid_b32 v81 offset:11152
    ds_read_b128 v[88:91], v16 offset:8704
    ds_read_b128 v[92:95], v17 offset:0
    ds_read_b128 v[96:99], v16 offset:8736
    ds_read_b128 v[100:103], v17 offset:32
    ds_read_b128 v[104:107], v16 offset:8768
    ds_read_b128 v[108:111], v17 offset:64
    s_waitcnt lgkmcnt(4)
    v_mfma_f32_32x32x16_f16 v[112:127], v[88:91], v[92:95], v[112:127]
    ds_read_b128 v[88:91], v16 offset:8800
    ds_read_b128 v[92:95], v17 offset:96
    s_waitcnt lgkmcnt(4)
    v_mfma_f32_32x32x16_f16 v[112:127], v[96:99], v[100:103], v[112:127]
    ds_read_b128 v[96:99], v16 offset:8832
    ds_read_b128 v[100:103], v17 offset:128
    s_waitcnt lgkmcnt(4)
    v_mfma_f32_32x32x16_f16 v[112:127], v[104:107], v[108:111], v[112:127]
    ds_read_b128 v[104:107], v16 offset:8864
    ds_read_b128 v[108:111], v17 offset:160
    s_waitcnt lgkmcnt(4)
    v_mfma_f32_32x32x16_f16 v[112:127], v[88:91], v[92:95], v[112:127]
    ds_read_b128 v[88:91], v16 offset:8896
    ds_read_b128 v[92:95], v17 offset:192
    s_waitcnt lgkmcnt(4)
    v_mfma_f32_32x32x16_f16 v[112:127], v[96:99], v[100:103], v[112:127]
    ds_read_b128 v[96:99], v16 offset:8928
    ds_read_b128 v[100:103], v17 offset:224
    s_waitcnt lgkmcnt(4)
    v_mfma_f32_32x32x16_f16 v[112:127], v[104:107], v[108:111], v[112:127]
    s_waitcnt lgkmcnt(2)
    v_mfma_f32_32x32x16_f16 v[112:127], v[88:91], v[92:95], v[112:127]
    s_waitcnt lgkmcnt(0)
    v_mfma_f32_32x32x16_f16 v[112:127], v[96:99], v[100:103], v[112:127]
    ds_read_b128 v[32:35], v2 offset:4736
    ds_read_b128 v[36:39], v2 offset:5760
    ds_read_b128 v[40:43], v2 offset:6784
    ds_read_b128 v[44:47], v2 offset:7808
    v_mov_b32 v104, 0
    s_nop 6
    v_cvt_pkrtz_f16_f32 v88, v119, v118
    v_cvt_pkrtz_f16_f32 v92, v118, v117
    v_cvt_pkrtz_f16_f32 v89, v117, v116
    v_add_f32 v112, v112, v26
    v_cvt_pkrtz_f16_f32 v108, v121, v120
    v_readlane_b32 s40, v88, 63
    v_readlane_b32 s41, v92, 63
    v_cvt_pkrtz_f16_f32 v109, v122, v123
    v_readlane_b32 s53, v108, 63
    v_cvt_pkrtz_f16_f32 v90, v115, v114
    v_cvt_pkrtz_f16_f32 v91, v113, v112
    s_pack_ll_b32_b16 s42, s40, s40
    v_mov_b32_dpp v99, v88 wave_shr:1 row_mask:0xf bank_mask:0xf bound_ctrl:0
    ds_write_b128 v18, v[88:91]
    v_and_b32 v105, s42, v23
    v_and_b32 v106, s42, v24
    v_and_b32 v107, s42, v25
    s_and_b32 s43, s53, 0xffff0000
    v_writelane_b32 v107, s40, 11
    v_writelane_b32 v107, s41, 15
    v_writelane_b32 v108, s43, 63
    v_mov_b32_dpp v111, v109 quad_perm:[1,0,3,2] row_mask:0xf bank_mask:0xf
    ds_write_b128 v19, v[104:107]
    v_perm_b32 v109, v111, v109, v22
    ds_write2_b32 v20, v108, v108 offset0:0 offset1:225
    s_pack_ll_b32_b16 s53, s53, s53
    ds_write2_b32 v21, v109, v109 offset0:0 offset1:225
    v_mov_b32_dpp v110, v89 wave_shr:1 row_mask:0xf bank_mask:0xf bound_ctrl:0
    v_cvt_pkrtz_f16_f32 v93, v116, v115
    v_cvt_pkrtz_f16_f32 v94, v114, v113
    v_alignbit_b32 v95, v99, v91, 16
    v_cvt_pkrtz_f16_f32 v96, v117, v116
    ds_write_b128 v18, v[92:95] offset:1088
    v_cvt_pkrtz_f16_f32 v97, v115, v114
    v_cvt_pkrtz_f16_f32 v98, v113, v112
    v_cvt_pkrtz_f16_f32 v100, v116, v115
    ds_write_b128 v18, v[96:99] offset:2176
    v_cvt_pkrtz_f16_f32 v101, v114, v113
    v_alignbit_b32 v102, v99, v91, 16
    v_alignbit_b32 v103, v110, v99, 16
    v_pk_mul_f16 v12, v12, s53
    v_pk_mul_f16 v13, v13, s53
    v_pk_mul_f16 v14, v14, s53
    v_pk_mul_f16 v15, v15, s53
    ds_write_b128 v18, v[100:103] offset:3264
    s_cmp_lg_u32 s38, 0
    s_cbranch_scc1 L_set1_45
    ds_read_b64 v[48:49], v7 offset:512
    ds_read_b64 v[50:51], v7 offset:520
    ds_read_b64 v[52:53], v7 offset:448
    ds_read_b64 v[54:55], v7 offset:456
    ds_read_b64 v[56:57], v7 offset:576
    ds_read_b64 v[58:59], v7 offset:584
    ds_read_b64 v[60:61], v7 offset:0
    ds_read_b64 v[62:63], v7 offset:8
    ds_read_b64 v[64:65], v7 offset:640
    ds_read_b64 v[66:67], v7 offset:648
    ds_read_b64 v[68:69], v7 offset:192
    ds_read_b64 v[70:71], v7 offset:200
    ds_read_b64 v[72:73], v7 offset:64
    ds_read_b64 v[74:75], v7 offset:72
    ds_read_b64 v[76:77], v7 offset:256
    ds_read_b64 v[78:79], v7 offset:264
    ds_read_b64 v[80:81], v7 offset:128
    ds_read_b64 v[82:83], v7 offset:136
    ds_read_b64 v[84:85], v7 offset:320
    ds_read_b64 v[86:87], v7 offset:328
    ds_read_b64 v[8:9], v6 offset:576
    ds_read_b64 v[10:11], v6 offset:584
    ds_read_b64 v[16:17], v6 offset:64
    ds_read_b64 v[18:19], v6 offset:72
    ds_read_b64 v[20:21], v6 offset:640
    ds_read_b64 v[22:23], v6 offset:648
    ds_read_b64 v[24:25], v6 offset:128
    ds_read_b64 v[26:27], v6 offset:136
    s_mov_b32 s46, 0
L_sp_46:
    ds_read_b32 v5, v3 offset:48
    s_waitcnt lgkmcnt(0)
    v_cmp_gt_u32 vcc, 4, v5
    s_cbranch_vccz L_spd_47
    s_add_u32 s46, s46, 1
    s_sleep 1
    s_cmp_lt_u32 s46, 400000
    s_cbranch_scc1 L_sp_46
    s_branch L_end
L_spd_47:
    s_setprio 3
    ds_read_b128 v[28:31], v1 offset:496
    ds_read_b128 v[88:91], v1 offset:480
    ds_read_b128 v[92:95], v1 offset:1536
    s_waitcnt lgkmcnt(2)
    v_mfma_f32_16x16x32_f16 v[96:99], v[28:31], v[40:43], 0
    ds_read_b128 v[100:103], v1 offset:2048
    s_waitcnt lgkmcnt(2)
    v_mfma_f32_16x16x32_f16 v[104:107], v[88:91], v[44:47], 0
    ds_read_b128 v[108:111], v1 offset:1008
    s_waitcnt lgkmcnt(2)
    v_mfma_f32_16x16x32_f16 v[112:115], v[12:15], v[92:95], 0
    ds_read_b128 v[116:119], v1 offset:992
    s_waitcnt lgkmcnt(2)
    v_mfma_f32_16x16x32_f16 v[120:123], v[12:15], v[100:103], 0
    ds_read_b128 v[124:127], v1 offset:1520
    s_waitcnt lgkmcnt(2)
    v_mfma_f32_16x16x32_f16 v[28:31], v[108:111], v[40:43], 0
    ds_read_b128 v[88:91], v1 offset:1504
    v_cvt_pkrtz_f16_f32 v96, v96, v104
    v_cvt_pkrtz_f16_f32 v97, v97, v105
    s_waitcnt lgkmcnt(2)
    v_mfma_f32_16x16x32_f16 v[92:95], v[116:119], v[44:47], 0
    ds_read_b128 v[12:15], v1 offset:2032
    v_cvt_pkrtz_f16_f32 v98, v98, v106
    v_cvt_pkrtz_f16_f32 v99, v99, v107
    s_nop 1
    v_mfma_f32_16x16x32_f16 v[112:115], v[96:99], v[48:51], v[112:115]
    v_mfma_f32_16x16x32_f16 v[120:123], v[96:99], v[52:55], v[120:123]
    s_waitcnt lgkmcnt(2)
    v_mfma_f32_16x16x32_f16 v[100:103], v[124:127], v[32:35], 0
    v_mfma_f32_16x16x32_f16 v[108:111], v[124:127], v[36:39], 0
    v_cvt_pkrtz_f16_f32 v28, v28, v92
    v_mfma_f32_16x16x32_f16 v[116:119], v[124:127], v[40:43], 0
    ds_read_b128 v[104:107], v1 offset:2016
    v_cvt_pkrtz_f16_f32 v29, v29, v93
    s_waitcnt lgkmcnt(2)
    v_mfma_f32_16x16x32_f16 v[52:55], v[88:91], v[44:47], 0
    v_mfma_f32_16x16x32_f16 v[96:99], v[88:91], v[32:35], 0
    v_cvt_pkrtz_f16_f32 v30, v30, v94
    v_mfma_f32_16x16x32_f16 v[124:127], v[88:91], v[36:39], 0
    ds_read_b128 v[88:91], v1 offset:2544
    v_cvt_pkrtz_f16_f32 v31, v31, v95
    ds_read_b64 v[92:93], v6 offset:704
    ds_read_b64 v[94:95], v6 offset:712
    v_mfma_f32_16x16x32_f16 v[112:115], v[28:31], v[56:59], v[112:115]
    v_mfma_f32_16x16x32_f16 v[120:123], v[28:31], v[48:51], v[120:123]
    s_waitcnt lgkmcnt(4)
    v_mfma_f32_16x16x32_f16 v[48:51], v[12:15], v[32:35], 0
    v_cvt_pkrtz_f16_f32 v100, v100, v108
    v_cvt_pkrtz_f16_f32 v101, v101, v109
    v_mfma_f32_16x16x32_f16 v[28:31], v[12:15], v[36:39], 0
    v_cvt_pkrtz_f16_f32 v102, v102, v110
    v_cvt_pkrtz_f16_f32 v103, v103, v111
    v_mfma_f32_16x16x32_f16 v[108:111], v[12:15], v[40:43], 0
    ds_read_b128 v[40:43], v1 offset:2528
    v_cvt_pkrtz_f16_f32 v116, v116, v52
    v_cvt_pkrtz_f16_f32 v117, v117, v53
    s_waitcnt lgkmcnt(4)
    v_mfma_f32_16x16x32_f16 v[12:15], v[104:107], v[44:47], 0
    v_cvt_pkrtz_f16_f32 v118, v118, v54
    v_cvt_pkrtz_f16_f32 v119, v119, v55
    v_mfma_f32_16x16x32_f16 v[44:47], v[104:107], v[32:35], 0
    v_cvt_pkrtz_f16_f32 v96, v96, v124
    v_cvt_pkrtz_f16_f32 v97, v97, v125
    v_mfma_f32_16x16x32_f16 v[52:55], v[104:107], v[36:39], 0
    ds_read_b128 v[104:107], v1 offset:3056
    v_cvt_pkrtz_f16_f32 v98, v98, v126
    v_cvt_pkrtz_f16_f32 v99, v99, v127
    ds_read_b64 v[124:125], v6 offset:192
    ds_read_b64 v[126:127], v6 offset:200
    v_mfma_f32_16x16x32_f16 v[112:115], v[100:103], v[60:63], v[112:115]
    ds_read_b64 v[100:101], v6 offset:768
    ds_read_b64 v[102:103], v6 offset:776
    v_mfma_f32_16x16x32_f16 v[112:115], v[116:119], v[64:67], v[112:115]
    v_mfma_f32_16x16x32_f16 v[120:123], v[116:119], v[56:59], v[120:123]
    ds_read_b64 v[56:57], v6 offset:256
    ds_read_b64 v[58:59], v6 offset:264
    v_mfma_f32_16x16x32_f16 v[112:115], v[96:99], v[68:71], v[112:115]
    s_waitcnt lgkmcnt(10)
    v_mfma_f32_16x16x32_f16 v[116:119], v[88:91], v[32:35], 0
    v_cvt_pkrtz_f16_f32 v48, v48, v28
    v_cvt_pkrtz_f16_f32 v49, v49, v29
    v_cvt_pkrtz_f16_f32 v50, v50, v30
    v_mfma_f32_16x16x32_f16 v[96:99], v[88:91], v[36:39], 0
    ds_read_b128 v[88:91], v1 offset:3040
    v_cvt_pkrtz_f16_f32 v51, v51, v31
    v_cvt_pkrtz_f16_f32 v108, v108, v12
    v_cvt_pkrtz_f16_f32 v109, v109, v13
    s_waitcnt lgkmcnt(8)
    v_mfma_f32_16x16x32_f16 v[28:31], v[40:43], v[32:35], 0
    v_cvt_pkrtz_f16_f32 v110, v110, v14
    v_cvt_pkrtz_f16_f32 v111, v111, v15
    v_cvt_pkrtz_f16_f32 v44, v44, v52
    v_mfma_f32_16x16x32_f16 v[12:15], v[40:43], v[36:39], 0
    ds_read_b128 v[40:43], v1 offset:48
    v_cvt_pkrtz_f16_f32 v45, v45, v53
    v_cvt_pkrtz_f16_f32 v46, v46, v54
    v_cvt_pkrtz_f16_f32 v47, v47, v55
    ds_read_b64 v[52:53], v6 offset:832
    ds_read_b64 v[54:55], v6 offset:840
    v_mfma_f32_16x16x32_f16 v[112:115], v[48:51], v[72:75], v[112:115]
    v_mfma_f32_16x16x32_f16 v[120:123], v[48:51], v[60:63], v[120:123]
    ds_read_b64 v[60:61], v6 offset:320
    ds_read_b64 v[62:63], v6 offset:328
    ds_read_b64 v[48:49], v6 offset:896
    ds_read_b64 v[50:51], v6 offset:904
    v_mfma_f32_16x16x32_f16 v[120:123], v[108:111], v[64:67], v[120:123]
    ds_read_b64 v[64:65], v6 offset:384
    ds_read_b64 v[66:67], v6 offset:392
    ds_read_b64 v[108:109], v6 offset:960
    ds_read_b64 v[110:111], v6 offset:968
    v_mfma_f32_16x16x32_f16 v[112:115], v[44:47], v[76:79], v[112:115]
    v_mfma_f32_16x16x32_f16 v[120:123], v[44:47], v[68:71], v[120:123]
    s_waitcnt lgkmcnt(15)
    v_mfma_f32_16x16x32_f16 v[68:71], v[104:107], v[32:35], 0
    v_cvt_pkrtz_f16_f32 v116, v116, v96
    v_cvt_pkrtz_f16_f32 v117, v117, v97
    v_mfma_f32_16x16x32_f16 v[44:47], v[104:107], v[36:39], 0
    ds_read_b128 v[104:107], v1 offset:112
    v_cvt_pkrtz_f16_f32 v118, v118, v98
    v_cvt_pkrtz_f16_f32 v119, v119, v99
    s_waitcnt lgkmcnt(12)
    v_mfma_f32_16x16x32_f16 v[96:99], v[88:91], v[32:35], 0
    v_cvt_pkrtz_f16_f32 v28, v28, v12
    v_cvt_pkrtz_f16_f32 v29, v29, v13
    v_mfma_f32_16x16x32_f16 v[32:35], v[88:91], v[36:39], 0
    ds_read_b128 v[36:39], v1 offset:176
    ds_read_b64 v[88:89], v6 offset:448
    ds_read_b64 v[90:91], v6 offset:456
    v_cvt_pkrtz_f16_f32 v30, v30, v14
    v_cvt_pkrtz_f16_f32 v31, v31, v15
    ds_read_b64 v[12:13], v6 offset:1024
    ds_read_b64 v[14:15], v6 offset:1032
    v_mfma_f32_16x16x32_f16 v[112:115], v[116:119], v[80:83], v[112:115]
    v_mfma_f32_16x16x32_f16 v[120:123], v[116:119], v[72:75], v[120:123]
    ds_read_b64 v[72:73], v6 offset:512
    ds_read_b64 v[74:75], v6 offset:520
    ds_read_b64 v[116:117], v6 offset:0
    ds_read_b64 v[118:119], v6 offset:8
    v_mfma_f32_16x16x32_f16 v[112:115], v[28:31], v[84:87], v[112:115]
    v_mfma_f32_16x16x32_f16 v[120:123], v[28:31], v[76:79], v[120:123]
    s_waitcnt lgkmcnt(15)
    v_mfma_f32_16x16x32_f16 v[76:79], v[8:11], v[40:43], 0
    v_cvt_pkrtz_f16_f32 v68, v68, v44
    v_cvt_pkrtz_f16_f32 v69, v69, v45
    v_mfma_f32_16x16x32_f16 v[28:31], v[16:19], v[40:43], 0
    ds_read_b128 v[40:43], v1 offset:240
    v_cvt_pkrtz_f16_f32 v70, v70, v46
    v_cvt_pkrtz_f16_f32 v71, v71, v47
    s_waitcnt lgkmcnt(10)
    v_mfma_f32_16x16x32_f16 v[76:79], v[20:23], v[104:107], v[76:79]
    v_cvt_pkrtz_f16_f32 v96, v96, v32
    v_cvt_pkrtz_f16_f32 v97, v97, v33
    v_mfma_f32_16x16x32_f16 v[28:31], v[24:27], v[104:107], v[28:31]
    ds_read_b128 v[44:47], v1 offset:304
    v_cvt_pkrtz_f16_f32 v98, v98, v34
    v_cvt_pkrtz_f16_f32 v99, v99, v35
    v_mfma_f32_16x16x32_f16 v[120:123], v[68:71], v[80:83], v[120:123]
    s_nop 0
    v_mfma_f32_16x16x32_f16 v[120:123], v[96:99], v[84:87], v[120:123]
    s_waitcnt lgkmcnt(10)
    v_mfma_f32_16x16x32_f16 v[76:79], v[92:95], v[36:39], v[76:79]
    v_mfma_f32_16x16x32_f16 v[28:31], v[124:127], v[36:39], v[28:31]
    ds_read_b128 v[104:107], v1 offset:368
    s_waitcnt lgkmcnt(2)
    v_mfma_f32_16x16x32_f16 v[76:79], v[100:103], v[40:43], v[76:79]
    v_mfma_f32_16x16x32_f16 v[28:31], v[56:59], v[40:43], v[28:31]
    ds_read_b128 v[32:35], v1 offset:432
    s_waitcnt lgkmcnt(2)
    v_mfma_f32_16x16x32_f16 v[76:79], v[52:55], v[44:47], v[76:79]
    v_mfma_f32_16x16x32_f16 v[28:31], v[60:63], v[44:47], v[28:31]
    ds_read_b128 v[80:83], v1 offset:496
    s_waitcnt lgkmcnt(2)
    v_mfma_f32_16x16x32_f16 v[76:79], v[48:51], v[104:107], v[76:79]
    v_mfma_f32_16x16x32_f16 v[28:31], v[64:67], v[104:107], v[28:31]
    ds_read_b128 v[68:71], v1 offset:560
    s_waitcnt lgkmcnt(2)
    v_mfma_f32_16x16x32_f16 v[76:79], v[108:111], v[32:35], v[76:79]
    v_mfma_f32_16x16x32_f16 v[28:31], v[88:91], v[32:35], v[28:31]
    ds_read_b128 v[84:87], v1 offset:624
    s_waitcnt lgkmcnt(2)
    v_mfma_f32_16x16x32_f16 v[76:79], v[12:15], v[80:83], v[76:79]
    v_mfma_f32_16x16x32_f16 v[28:31], v[72:75], v[80:83], v[28:31]
    ds_read_b128 v[96:99], v1 offset:688
    s_waitcnt lgkmcnt(2)
    v_mfma_f32_16x16x32_f16 v[28:31], v[8:11], v[68:71], v[28:31]
    ds_read_b128 v[36:39], v1 offset:752
    s_waitcnt lgkmcnt(2)
    v_mfma_f32_16x16x32_f16 v[28:31], v[20:23], v[84:87], v[28:31]
    ds_read_b128 v[40:43], v1 offset:816
    s_waitcnt lgkmcnt(2)
    v_mfma_f32_16x16x32_f16 v[28:31], v[92:95], v[96:99], v[28:31]
    ds_read_b128 v[44:47], v1 offset:880
    ds_write_b128 v4, v[76:79] offset:0
    s_mov_b64 exec, 1
    ds_add_u32 v3, v0 offset:64
    s_mov_b64 exec, -1
    s_setprio 2
    s_waitcnt lgkmcnt(4)
    v_mfma_f32_16x16x32_f16 v[28:31], v[100:103], v[36:39], v[28:31]
    ds_read_b128 v[104:107], v1 offset:944
    s_waitcnt lgkmcnt(4)
    v_mfma_f32_16x16x32_f16 v[28:31], v[52:55], v[40:43], v[28:31]
    ds_read_b128 v[32:35], v1 offset:1008
    s_waitcnt lgkmcnt(4)
    v_mfma_f32_16x16x32_f16 v[28:31], v[48:51], v[44:47], v[28:31]
    ds_read_b128 v[80:83], v1 offset:2544
    s_waitcnt lgkmcnt(2)
    v_mfma_f32_16x16x32_f16 v[28:31], v[108:111], v[104:107], v[28:31]
    ds_read_b128 v[68:71], v1 offset:2608
    s_waitcnt lgkmcnt(2)
    v_mfma_f32_16x16x32_f16 v[28:31], v[12:15], v[32:35], v[28:31]
    ds_read_b128 v[84:87], v1 offset:2672
    s_waitcnt lgkmcnt(2)
    v_mfma_f32_16x16x32_f16 v[112:115], v[116:119], v[80:83], v[112:115]
    ds_read_b128 v[96:99], v1 offset:2736
    s_waitcnt lgkmcnt(2)
    v_mfma_f32_16x16x32_f16 v[112:115], v[16:19], v[68:71], v[112:115]
    ds_read_b128 v[76:79], v1 offset:2800
    s_waitcnt lgkmcnt(2)
    v_mfma_f32_16x16x32_f16 v[112:115], v[24:27], v[84:87], v[112:115]
    ds_read_b128 v[36:39], v1 offset:2864
    ds_write_b128 v4, v[28:31] offset:1024
    s_mov_b64 exec, 1
    ds_add_u32 v3, v0 offset:68
    s_mov_b64 exec, -1
    s_setprio 1
    s_waitcnt lgkmcnt(4)
    v_mfma_f32_16x16x32_f16 v[112:115], v[124:127], v[96:99], v[112:115]
    ds_read_b128 v[40:43], v1 offset:2928
    s_waitcnt lgkmcnt(4)
    v_mfma_f32_16x16x32_f16 v[112:115], v[56:59], v[76:79], v[112:115]
    ds_read_b128 v[44:47], v1 offset:2992
    s_waitcnt lgkmcnt(4)
    v_mfma_f32_16x16x32_f16 v[112:115], v[60:63], v[36:39], v[112:115]
    ds_read_b128 v[104:107], v1 offset:3056
    s_waitcnt lgkmcnt(2)
    v_mfma_f32_16x16x32_f16 v[112:115], v[64:67], v[40:43], v[112:115]
    ds_read_b128 v[32:35], v1 offset:3120
    s_waitcnt lgkmcnt(2)
    v_mfma_f32_16x16x32_f16 v[112:115], v[88:91], v[44:47], v[112:115]
    ds_read_b128 v[80:83], v1 offset:3184
    s_waitcnt lgkmcnt(2)
    v_mfma_f32_16x16x32_f16 v[112:115], v[72:75], v[104:107], v[112:115]
    v_mfma_f32_16x16x32_f16 v[120:123], v[116:119], v[104:107], v[120:123]
    ds_read_b128 v[68:71], v1 offset:3248
    s_waitcnt lgkmcnt(2)
    v_mfma_f32_16x16x32_f16 v[112:115], v[8:11], v[32:35], v[112:115]
    v_mfma_f32_16x16x32_f16 v[120:123], v[16:19], v[32:35], v[120:123]
    ds_read_b128 v[84:87], v1 offset:3312
    s_waitcnt lgkmcnt(2)
    v_mfma_f32_16x16x32_f16 v[112:115], v[20:23], v[80:83], v[112:115]
    v_mfma_f32_16x16x32_f16 v[120:123], v[24:27], v[80:83], v[120:123]
    ds_read_b128 v[28:31], v1 offset:3376
    s_waitcnt lgkmcnt(2)
    v_mfma_f32_16x16x32_f16 v[112:115], v[92:95], v[68:71], v[112:115]
    v_mfma_f32_16x16x32_f16 v[120:123], v[124:127], v[68:71], v[120:123]
    ds_read_b128 v[96:99], v1 offset:3440
    s_waitcnt lgkmcnt(2)
    v_mfma_f32_16x16x32_f16 v[112:115], v[100:103], v[84:87], v[112:115]
    v_mfma_f32_16x16x32_f16 v[120:123], v[56:59], v[84:87], v[120:123]
    ds_read_b128 v[76:79], v1 offset:3504
    s_waitcnt lgkmcnt(2)
    v_mfma_f32_16x16x32_f16 v[112:115], v[52:55], v[28:31], v[112:115]
    v_mfma_f32_16x16x32_f16 v[120:123], v[60:63], v[28:31], v[120:123]
    ds_read_b128 v[36:39], v1 offset:3568
    s_waitcnt lgkmcnt(2)
    v_mfma_f32_16x16x32_f16 v[112:115], v[48:51], v[96:99], v[112:115]
    v_mfma_f32_16x16x32_f16 v[120:123], v[64:67], v[96:99], v[120:123]
    ds_read_b128 v[40:43], v1 offset:3632
    s_waitcnt lgkmcnt(2)
    v_mfma_f32_16x16x32_f16 v[112:115], v[108:111], v[76:79], v[112:115]
    v_mfma_f32_16x16x32_f16 v[120:123], v[88:91], v[76:79], v[120:123]
    ds_read_b128 v[44:47], v1 offset:3696
    s_waitcnt lgkmcnt(2)
    v_mfma_f32_16x16x32_f16 v[112:115], v[12:15], v[36:39], v[112:115]
    v_mfma_f32_16x16x32_f16 v[120:123], v[72:75], v[36:39], v[120:123]
    ds_read_b128 v[116:119], v1 offset:3760
    s_waitcnt lgkmcnt(2)
    v_mfma_f32_16x16x32_f16 v[120:123], v[8:11], v[40:43], v[120:123]
    ds_read_b128 v[104:107], v1 offset:3824
    s_waitcnt lgkmcnt(2)
    v_mfma_f32_16x16x32_f16 v[120:123], v[20:23], v[44:47], v[120:123]
    ds_read_b128 v[16:19], v1 offset:3888
    s_waitcnt lgkmcnt(2)
    v_mfma_f32_16x16x32_f16 v[120:123], v[92:95], v[116:119], v[120:123]
    ds_read_b128 v[32:35], v1 offset:3952
    ds_write_b128 v4, v[112:115] offset:2048
    s_mov_b64 exec, 1
    ds_add_u32 v3, v0 offset:72
    s_mov_b64 exec, -1
    s_setprio 0
    s_waitcnt lgkmcnt(4)
    v_mfma_f32_16x16x32_f16 v[120:123], v[100:103], v[104:107], v[120:123]
    ds_read_b128 v[24:27], v1 offset:4016
    s_waitcnt lgkmcnt(4)
    v_mfma_f32_16x16x32_f16 v[120:123], v[52:55], v[16:19], v[120:123]
    ds_read_b128 v[80:83], v1 offset:4080
    s_waitcnt lgkmcnt(4)
    v_mfma_f32_16x16x32_f16 v[120:123], v[48:51], v[32:35], v[120:123]
    s_waitcnt lgkmcnt(1)
    v_mfma_f32_16x16x32_f16 v[120:123], v[108:111], v[24:27], v[120:123]
    s_waitcnt lgkmcnt(0)
    v_mfma_f32_16x16x32_f16 v[120:123], v[12:15], v[80:83], v[120:123]
    s_nop 7
    ds_write_b128 v4, v[120:123] offset:3072
    s_mov_b64 exec, 1
    ds_add_u32 v3, v0 offset:76
    s_mov_b64 exec, -1
    s_branch L_fin
L_set1_45:
    ds_read_b64 v[48:49], v7 offset:128
    ds_read_b64 v[50:51], v7 offset:136
    ds_read_b64 v[52:53], v7 offset:64
    ds_read_b64 v[54:55], v7 offset:72
    ds_read_b64 v[56:57], v7 offset:0
    ds_read_b64 v[58:59], v7 offset:8
    ds_read_b64 v[60:61], v7 offset:640
    ds_read_b64 v[62:63], v7 offset:648
    ds_read_b64 v[64:65], v7 offset:576
    ds_read_b64 v[66:67], v7 offset:584
    ds_read_b64 v[68:69], v7 offset:320
    ds_read_b64 v[70:71], v7 offset:328
    ds_read_b64 v[72:73], v7 offset:256
    ds_read_b64 v[74:75], v7 offset:264
    ds_read_b64 v[76:77], v7 offset:192
    ds_read_b64 v[78:79], v7 offset:200
    ds_read_b64 v[80:81], v6 offset:0
    ds_read_b64 v[82:83], v6 offset:8
    ds_read_b64 v[84:85], v6 offset:64
    ds_read_b64 v[86:87], v6 offset:72
    ds_read_b64 v[8:9], v6 offset:128
    ds_read_b64 v[10:11], v6 offset:136
    ds_read_b64 v[16:17], v6 offset:192
    ds_read_b64 v[18:19], v6 offset:200
    s_mov_b32 s46, 0
L_sp_48:
    ds_read_b32 v5, v3 offset:48
    s_waitcnt lgkmcnt(0)
    v_cmp_gt_u32 vcc, 4, v5
    s_cbranch_vccz L_spd_49
    s_add_u32 s46, s46, 1
    s_sleep 1
    s_cmp_lt_u32 s46, 400000
    s_cbranch_scc1 L_sp_48
    s_branch L_end
L_spd_49:
    s_setprio 3
    ds_read_b128 v[20:23], v1 offset:496
    ds_read_b128 v[24:27], v1 offset:480
    ds_read_b128 v[28:31], v1 offset:0
    s_waitcnt lgkmcnt(2)
    v_mfma_f32_16x16x32_f16 v[88:91], v[20:23], v[32:35], 0
    v_mfma_f32_16x16x32_f16 v[92:95], v[20:23], v[36:39], 0
    v_mfma_f32_16x16x32_f16 v[96:99], v[20:23], v[40:43], 0
    ds_read_b128 v[100:103], v1 offset:512
    s_waitcnt lgkmcnt(2)
    v_mfma_f32_16x16x32_f16 v[104:107], v[24:27], v[44:47], 0
    v_mfma_f32_16x16x32_f16 v[108:111], v[24:27], v[32:35], 0
    v_mfma_f32_16x16x32_f16 v[112:115], v[24:27], v[36:39], 0
    ds_read_b128 v[116:119], v1 offset:1024
    s_waitcnt lgkmcnt(2)
    v_mfma_f32_16x16x32_f16 v[120:123], v[12:15], v[28:31], 0
    ds_read_b128 v[124:127], v1 offset:1008
    s_waitcnt lgkmcnt(2)
    v_mfma_f32_16x16x32_f16 v[20:23], v[12:15], v[100:103], 0
    ds_read_b128 v[24:27], v1 offset:992
    s_waitcnt lgkmcnt(2)
    v_mfma_f32_16x16x32_f16 v[28:31], v[12:15], v[116:119], 0
    ds_read_b128 v[100:103], v1 offset:1520
    s_waitcnt lgkmcnt(2)
    v_mfma_f32_16x16x32_f16 v[12:15], v[124:127], v[32:35], 0
    v_cvt_pkrtz_f16_f32 v88, v88, v92
    v_cvt_pkrtz_f16_f32 v89, v89, v93
    v_mfma_f32_16x16x32_f16 v[116:119], v[124:127], v[36:39], 0
    v_cvt_pkrtz_f16_f32 v90, v90, v94
    v_cvt_pkrtz_f16_f32 v91, v91, v95
    v_mfma_f32_16x16x32_f16 v[92:95], v[124:127], v[40:43], 0
    ds_read_b128 v[40:43], v1 offset:1504
    v_cvt_pkrtz_f16_f32 v96, v96, v104
    v_cvt_pkrtz_f16_f32 v97, v97, v105
    s_waitcnt lgkmcnt(2)
    v_mfma_f32_16x16x32_f16 v[124:127], v[24:27], v[44:47], 0
    v_cvt_pkrtz_f16_f32 v98, v98, v106
    v_cvt_pkrtz_f16_f32 v99, v99, v107
    v_mfma_f32_16x16x32_f16 v[44:47], v[24:27], v[32:35], 0
    v_cvt_pkrtz_f16_f32 v108, v108, v112
    v_cvt_pkrtz_f16_f32 v109, v109, v113
    v_mfma_f32_16x16x32_f16 v[104:107], v[24:27], v[36:39], 0
    ds_read_b128 v[24:27], v1 offset:2032
    v_cvt_pkrtz_f16_f32 v110, v110, v114
    v_cvt_pkrtz_f16_f32 v111, v111, v115
    v_mfma_f32_16x16x32_f16 v[112:115], v[88:91], v[48:51], 0
    v_mfma_f32_16x16x32_f16 v[120:123], v[88:91], v[52:55], v[120:123]
    v_mfma_f32_16x16x32_f16 v[20:23], v[88:91], v[56:59], v[20:23]
    ds_read_b64 v[88:89], v6 offset:256
    ds_read_b64 v[90:91], v6 offset:264
    v_mfma_f32_16x16x32_f16 v[20:23], v[96:99], v[60:63], v[20:23]
    v_mfma_f32_16x16x32_f16 v[28:31], v[96:99], v[64:67], v[28:31]
    ds_read_b64 v[64:65], v6 offset:320
    ds_read_b64 v[66:67], v6 offset:328
    v_mfma_f32_16x16x32_f16 v[112:115], v[108:111], v[68:71], v[112:115]
    v_mfma_f32_16x16x32_f16 v[120:123], v[108:111], v[72:75], v[120:123]
    v_mfma_f32_16x16x32_f16 v[20:23], v[108:111], v[76:79], v[20:23]
    s_waitcnt lgkmcnt(6)
    v_mfma_f32_16x16x32_f16 v[96:99], v[100:103], v[32:35], 0
    v_cvt_pkrtz_f16_f32 v12, v12, v116
    v_cvt_pkrtz_f16_f32 v13, v13, v117
    v_cvt_pkrtz_f16_f32 v14, v14, v118
    v_mfma_f32_16x16x32_f16 v[108:111], v[100:103], v[36:39], 0
    ds_read_b128 v[100:103], v1 offset:2016
    v_cvt_pkrtz_f16_f32 v15, v15, v119
    v_cvt_pkrtz_f16_f32 v92, v92, v124
    v_cvt_pkrtz_f16_f32 v93, v93, v125
    s_waitcnt lgkmcnt(6)
    v_mfma_f32_16x16x32_f16 v[116:119], v[40:43], v[32:35], 0
    v_cvt_pkrtz_f16_f32 v94, v94, v126
    v_cvt_pkrtz_f16_f32 v95, v95, v127
    v_cvt_pkrtz_f16_f32 v44, v44, v104
    v_mfma_f32_16x16x32_f16 v[124:127], v[40:43], v[36:39], 0
    ds_read_b128 v[40:43], v1 offset:496
    v_cvt_pkrtz_f16_f32 v45, v45, v105
    v_cvt_pkrtz_f16_f32 v46, v46, v106
    v_cvt_pkrtz_f16_f32 v47, v47, v107
    ds_read_b64 v[104:105], v6 offset:384
    ds_read_b64 v[106:107], v6 offset:392
    v_mfma_f32_16x16x32_f16 v[120:123], v[12:15], v[48:51], v[120:123]
    v_mfma_f32_16x16x32_f16 v[20:23], v[12:15], v[52:55], v[20:23]
    v_mfma_f32_16x16x32_f16 v[28:31], v[12:15], v[56:59], v[28:31]
    ds_read_b64 v[56:57], v6 offset:448
    ds_read_b64 v[58:59], v6 offset:456
    ds_read_b64 v[12:13], v6 offset:512
    ds_read_b64 v[14:15], v6 offset:520
    v_mfma_f32_16x16x32_f16 v[28:31], v[92:95], v[60:63], v[28:31]
    ds_read_b64 v[60:61], v6 offset:576
    ds_read_b64 v[62:63], v6 offset:584
    ds_read_b64 v[92:93], v6 offset:640
    ds_read_b64 v[94:95], v6 offset:648
    v_mfma_f32_16x16x32_f16 v[120:123], v[44:47], v[68:71], v[120:123]
    v_mfma_f32_16x16x32_f16 v[20:23], v[44:47], v[72:75], v[20:23]
    v_mfma_f32_16x16x32_f16 v[28:31], v[44:47], v[76:79], v[28:31]
    s_waitcnt lgkmcnt(15)
    v_mfma_f32_16x16x32_f16 v[76:79], v[24:27], v[32:35], 0
    v_cvt_pkrtz_f16_f32 v96, v96, v108
    v_cvt_pkrtz_f16_f32 v97, v97, v109
    v_mfma_f32_16x16x32_f16 v[44:47], v[24:27], v[36:39], 0
    ds_read_b128 v[24:27], v1 offset:560
    v_cvt_pkrtz_f16_f32 v98, v98, v110
    v_cvt_pkrtz_f16_f32 v99, v99, v111
    s_waitcnt lgkmcnt(12)
    v_mfma_f32_16x16x32_f16 v[108:111], v[100:103], v[32:35], 0
    v_cvt_pkrtz_f16_f32 v116, v116, v124
    v_cvt_pkrtz_f16_f32 v117, v117, v125
    v_mfma_f32_16x16x32_f16 v[32:35], v[100:103], v[36:39], 0
    ds_read_b128 v[36:39], v1 offset:624
    ds_read_b64 v[100:101], v6 offset:704
    ds_read_b64 v[102:103], v6 offset:712
    v_cvt_pkrtz_f16_f32 v118, v118, v126
    v_cvt_pkrtz_f16_f32 v119, v119, v127
    ds_read_b64 v[124:125], v6 offset:768
    ds_read_b64 v[126:127], v6 offset:776
    v_mfma_f32_16x16x32_f16 v[20:23], v[96:99], v[48:51], v[20:23]
    v_mfma_f32_16x16x32_f16 v[28:31], v[96:99], v[52:55], v[28:31]
    ds_read_b64 v[52:53], v6 offset:832
    ds_read_b64 v[54:55], v6 offset:840
    ds_read_b64 v[96:97], v6 offset:896
    ds_read_b64 v[98:99], v6 offset:904
    v_mfma_f32_16x16x32_f16 v[20:23], v[116:119], v[68:71], v[20:23]
    v_mfma_f32_16x16x32_f16 v[28:31], v[116:119], v[72:75], v[28:31]
    ds_read_b64 v[72:73], v6 offset:960
    ds_read_b64 v[74:75], v6 offset:968
    ds_read_b64 v[116:117], v6 offset:1024
    ds_read_b64 v[118:119], v6 offset:1032
    s_waitcnt lgkmcnt(15)
    v_mfma_f32_16x16x32_f16 v[112:115], v[80:83], v[40:43], v[112:115]
    ds_read_b128 v[40:43], v1 offset:688
    v_cvt_pkrtz_f16_f32 v76, v76, v44
    v_cvt_pkrtz_f16_f32 v77, v77, v45
    s_waitcnt lgkmcnt(14)
    v_mfma_f32_16x16x32_f16 v[112:115], v[84:87], v[24:27], v[112:115]
    ds_read_b128 v[24:27], v1 offset:752
    v_cvt_pkrtz_f16_f32 v78, v78, v46
    v_cvt_pkrtz_f16_f32 v79, v79, v47
    s_waitcnt lgkmcnt(14)
    v_mfma_f32_16x16x32_f16 v[112:115], v[8:11], v[36:39], v[112:115]
    ds_read_b128 v[44:47], v1 offset:816
    v_cvt_pkrtz_f16_f32 v108, v108, v32
    v_cvt_pkrtz_f16_f32 v109, v109, v33
    s_waitcnt lgkmcnt(2)
    v_mfma_f32_16x16x32_f16 v[112:115], v[16:19], v[40:43], v[112:115]
    ds_read_b128 v[36:39], v1 offset:880
    v_cvt_pkrtz_f16_f32 v110, v110, v34
    v_cvt_pkrtz_f16_f32 v111, v111, v35
    v_mfma_f32_16x16x32_f16 v[28:31], v[76:79], v[48:51], v[28:31]
    s_nop 0
    v_mfma_f32_16x16x32_f16 v[28:31], v[108:111], v[68:71], v[28:31]
    s_waitcnt lgkmcnt(2)
    v_mfma_f32_16x16x32_f16 v[112:115], v[88:91], v[24:27], v[112:115]
    ds_read_b128 v[40:43], v1 offset:944
    s_waitcnt lgkmcnt(2)
    v_mfma_f32_16x16x32_f16 v[112:115], v[64:67], v[44:47], v[112:115]
    ds_read_b128 v[32:35], v1 offset:1008
    s_waitcnt lgkmcnt(2)
    v_mfma_f32_16x16x32_f16 v[112:115], v[104:107], v[36:39], v[112:115]
    ds_read_b128 v[48:51], v1 offset:1072
    s_waitcnt lgkmcnt(2)
    v_mfma_f32_16x16x32_f16 v[112:115], v[56:59], v[40:43], v[112:115]
    ds_read_b128 v[76:79], v1 offset:1136
    s_waitcnt lgkmcnt(2)
    v_mfma_f32_16x16x32_f16 v[112:115], v[12:15], v[32:35], v[112:115]
    v_mfma_f32_16x16x32_f16 v[120:123], v[80:83], v[32:35], v[120:123]
    ds_read_b128 v[68:71], v1 offset:1200
    s_waitcnt lgkmcnt(2)
    v_mfma_f32_16x16x32_f16 v[112:115], v[60:63], v[48:51], v[112:115]
    v_mfma_f32_16x16x32_f16 v[120:123], v[84:87], v[48:51], v[120:123]
    ds_read_b128 v[108:111], v1 offset:1264
    s_waitcnt lgkmcnt(2)
    v_mfma_f32_16x16x32_f16 v[112:115], v[92:95], v[76:79], v[112:115]
    v_mfma_f32_16x16x32_f16 v[120:123], v[8:11], v[76:79], v[120:123]
    ds_read_b128 v[24:27], v1 offset:1328
    s_waitcnt lgkmcnt(2)
    v_mfma_f32_16x16x32_f16 v[112:115], v[100:103], v[68:71], v[112:115]
    v_mfma_f32_16x16x32_f16 v[120:123], v[16:19], v[68:71], v[120:123]
    ds_read_b128 v[44:47], v1 offset:1392
    s_waitcnt lgkmcnt(2)
    v_mfma_f32_16x16x32_f16 v[112:115], v[124:127], v[108:111], v[112:115]
    v_mfma_f32_16x16x32_f16 v[120:123], v[88:91], v[108:111], v[120:123]
    ds_read_b128 v[36:39], v1 offset:1456
    s_waitcnt lgkmcnt(2)
    v_mfma_f32_16x16x32_f16 v[112:115], v[52:55], v[24:27], v[112:115]
    v_mfma_f32_16x16x32_f16 v[120:123], v[64:67], v[24:27], v[120:123]
    ds_read_b128 v[40:43], v1 offset:1520
    s_waitcnt lgkmcnt(2)
    v_mfma_f32_16x16x32_f16 v[112:115], v[96:99], v[44:47], v[112:115]
    v_mfma_f32_16x16x32_f16 v[120:123], v[104:107], v[44:47], v[120:123]
    ds_read_b128 v[32:35], v1 offset:1584
    s_waitcnt lgkmcnt(2)
    v_mfma_f32_16x16x32_f16 v[112:115], v[72:75], v[36:39], v[112:115]
    v_mfma_f32_16x16x32_f16 v[120:123], v[56:59], v[36:39], v[120:123]
    ds_read_b128 v[48:51], v1 offset:1648
    s_waitcnt lgkmcnt(2)
    v_mfma_f32_16x16x32_f16 v[112:115], v[116:119], v[40:43], v[112:115]
    v_mfma_f32_16x16x32_f16 v[120:123], v[12:15], v[40:43], v[120:123]
    v_mfma_f32_16x16x32_f16 v[20:23], v[80:83], v[40:43], v[20:23]
    ds_read_b128 v[76:79], v1 offset:1712
    s_waitcnt lgkmcnt(2)
    v_mfma_f32_16x16x32_f16 v[120:123], v[60:63], v[32:35], v[120:123]
    v_mfma_f32_16x16x32_f16 v[20:23], v[84:87], v[32:35], v[20:23]
    ds_read_b128 v[68:71], v1 offset:1776
    s_waitcnt lgkmcnt(2)
    v_mfma_f32_16x16x32_f16 v[120:123], v[92:95], v[48:51], v[120:123]
    ds_write_b128 v4, v[112:115] offset:0
    s_mov_b64 exec, 1
    ds_add_u32 v3, v0 offset:64
    s_mov_b64 exec, -1
    s_setprio 2
    v_mfma_f32_16x16x32_f16 v[20:23], v[8:11], v[48:51], v[20:23]
    ds_read_b128 v[108:111], v1 offset:1840
    s_waitcnt lgkmcnt(4)
    v_mfma_f32_16x16x32_f16 v[120:123], v[100:103], v[76:79], v[120:123]
    v_mfma_f32_16x16x32_f16 v[20:23], v[16:19], v[76:79], v[20:23]
    ds_read_b128 v[24:27], v1 offset:1904
    s_waitcnt lgkmcnt(4)
    v_mfma_f32_16x16x32_f16 v[120:123], v[124:127], v[68:71], v[120:123]
    v_mfma_f32_16x16x32_f16 v[20:23], v[88:91], v[68:71], v[20:23]
    ds_read_b128 v[44:47], v1 offset:1968
    s_waitcnt lgkmcnt(2)
    v_mfma_f32_16x16x32_f16 v[120:123], v[52:55], v[108:111], v[120:123]
    v_mfma_f32_16x16x32_f16 v[20:23], v[64:67], v[108:111], v[20:23]
    ds_read_b128 v[36:39], v1 offset:2032
    s_waitcnt lgkmcnt(2)
    v_mfma_f32_16x16x32_f16 v[120:123], v[96:99], v[24:27], v[120:123]
    v_mfma_f32_16x16x32_f16 v[20:23], v[104:107], v[24:27], v[20:23]
    ds_read_b128 v[40:43], v1 offset:2096
    s_waitcnt lgkmcnt(2)
    v_mfma_f32_16x16x32_f16 v[120:123], v[72:75], v[44:47], v[120:123]
    v_mfma_f32_16x16x32_f16 v[20:23], v[56:59], v[44:47], v[20:23]
    ds_read_b128 v[32:35], v1 offset:2160
    s_waitcnt lgkmcnt(2)
    v_mfma_f32_16x16x32_f16 v[120:123], v[116:119], v[36:39], v[120:123]
    v_mfma_f32_16x16x32_f16 v[20:23], v[12:15], v[36:39], v[20:23]
    v_mfma_f32_16x16x32_f16 v[28:31], v[80:83], v[36:39], v[28:31]
    ds_read_b128 v[112:115], v1 offset:2224
    s_waitcnt lgkmcnt(2)
    v_mfma_f32_16x16x32_f16 v[20:23], v[60:63], v[40:43], v[20:23]
    v_mfma_f32_16x16x32_f16 v[28:31], v[84:87], v[40:43], v[28:31]
    ds_read_b128 v[48:51], v1 offset:2288
    s_waitcnt lgkmcnt(2)
    v_mfma_f32_16x16x32_f16 v[20:23], v[92:95], v[32:35], v[20:23]
    ds_write_b128 v4, v[120:123] offset:1024
    s_mov_b64 exec, 1
    ds_add_u32 v3, v0 offset:68
    s_mov_b64 exec, -1
    s_setprio 1
    v_mfma_f32_16x16x32_f16 v[28:31], v[8:11], v[32:35], v[28:31]
    ds_read_b128 v[76:79], v1 offset:2352
    s_waitcnt lgkmcnt(4)
    v_mfma_f32_16x16x32_f16 v[20:23], v[100:103], v[112:115], v[20:23]
    v_mfma_f32_16x16x32_f16 v[28:31], v[16:19], v[112:115], v[28:31]
    ds_read_b128 v[68:71], v1 offset:2416
    s_waitcnt lgkmcnt(4)
    v_mfma_f32_16x16x32_f16 v[20:23], v[124:127], v[48:51], v[20:23]
    v_mfma_f32_16x16x32_f16 v[28:31], v[88:91], v[48:51], v[28:31]
    ds_read_b128 v[108:111], v1 offset:2480
    s_waitcnt lgkmcnt(2)
    v_mfma_f32_16x16x32_f16 v[20:23], v[52:55], v[76:79], v[20:23]
    v_mfma_f32_16x16x32_f16 v[28:31], v[64:67], v[76:79], v[28:31]
    ds_read_b128 v[24:27], v1 offset:2544
    s_waitcnt lgkmcnt(2)
    v_mfma_f32_16x16x32_f16 v[20:23], v[96:99], v[68:71], v[20:23]
    v_mfma_f32_16x16x32_f16 v[28:31], v[104:107], v[68:71], v[28:31]
    ds_read_b128 v[44:47], v1 offset:2608
    s_waitcnt lgkmcnt(2)
    v_mfma_f32_16x16x32_f16 v[20:23], v[72:75], v[108:111], v[20:23]
    v_mfma_f32_16x16x32_f16 v[28:31], v[56:59], v[108:111], v[28:31]
    ds_read_b128 v[80:83], v1 offset:2672
    s_waitcnt lgkmcnt(2)
    v_mfma_f32_16x16x32_f16 v[20:23], v[116:119], v[24:27], v[20:23]
    v_mfma_f32_16x16x32_f16 v[28:31], v[12:15], v[24:27], v[28:31]
    ds_read_b128 v[36:39], v1 offset:2736
    s_waitcnt lgkmcnt(2)
    v_mfma_f32_16x16x32_f16 v[28:31], v[60:63], v[44:47], v[28:31]
    ds_read_b128 v[84:87], v1 offset:2800
    s_waitcnt lgkmcnt(2)
    v_mfma_f32_16x16x32_f16 v[28:31], v[92:95], v[80:83], v[28:31]
    ds_read_b128 v[40:43], v1 offset:2864
    s_waitcnt lgkmcnt(2)
    v_mfma_f32_16x16x32_f16 v[28:31], v[100:103], v[36:39], v[28:31]
    ds_read_b128 v[120:123], v1 offset:2928
    ds_write_b128 v4, v[20:23] offset:2048
    s_mov_b64 exec, 1
    ds_add_u32 v3, v0 offset:72
    s_mov_b64 exec, -1
    s_setprio 0
    s_waitcnt lgkmcnt(4)
    v_mfma_f32_16x16x32_f16 v[28:31], v[124:127], v[84:87], v[28:31]
    ds_read_b128 v[8:11], v1 offset:2992
    s_waitcnt lgkmcnt(4)
    v_mfma_f32_16x16x32_f16 v[28:31], v[52:55], v[40:43], v[28:31]
    ds_read_b128 v[32:35], v1 offset:3056
    s_waitcnt lgkmcnt(4)
    v_mfma_f32_16x16x32_f16 v[28:31], v[96:99], v[120:123], v[28:31]
    s_waitcnt lgkmcnt(1)
    v_mfma_f32_16x16x32_f16 v[28:31], v[72:75], v[8:11], v[28:31]
    s_waitcnt lgkmcnt(0)
    v_mfma_f32_16x16x32_f16 v[28:31], v[116:119], v[32:35], v[28:31]
    s_nop 7
    ds_write_b128 v4, v[28:31] offset:3072
    s_mov_b64 exec, 1
    ds_add_u32 v3, v0 offset:76
    s_mov_b64 exec, -1
L_fin:
L_end:
    s_endpgm
L_codeend:
.section .rodata,"a"
.p2align 6
.amdhsa_kernel recurrent_scan__ssm_conv_s4d__moe_arch_mod__prompt_kernel
  .amdhsa_next_free_vgpr 128
  .amdhsa_next_free_sgpr 102
  .amdhsa_accum_offset 128
  .amdhsa_group_segment_fixed_size 0
  .amdhsa_kernarg_size 120
  .amdhsa_user_sgpr_count 2
  .amdhsa_user_sgpr_kernarg_segment_ptr 1
  .amdhsa_system_sgpr_workgroup_id_x 1
  .amdhsa_float_denorm_mode_32 3
.end_amdhsa_kernel
```

```asm
; @launch grid=(256,1,1) block=(1024,1,1) lds=161280
.amdgcn_target "amdgcn-amd-amdhsa--gfx950"
.text
.globl recurrent_scan__ssm_conv_s4d__moe_arch_mod__prompt_kernel
.p2align 12
.p2align 8
.type recurrent_scan__ssm_conv_s4d__moe_arch_mod__prompt_kernel,@function
recurrent_scan__ssm_conv_s4d__moe_arch_mod__prompt_kernel:
    s_cmp_ge_u32 s2, 256
    s_nop 0
    s_cbranch_scc1 L_end
    s_load_dwordx16 s[4:19], s[0:1], 0
    s_load_dwordx8 s[20:27], s[0:1], 64
    s_load_dwordx4 s[28:31], s[0:1], 96
    s_load_dwordx2 s[32:33], s[0:1], 112
    s_getpc_b64 s[62:63]
L_pc:
    v_readfirstlane_b32 s3, v0
    v_and_b32 v1, 63, v0
    v_mov_b32 v3, 0
    v_lshlrev_b32 v2, 4, v1
    s_and_b32 s35, s2, 7
    s_lshr_b32 s36, s2, 3
    s_lshr_b32 s3, s3, 6
    s_and_b32 s40, s36, 15
    s_lshl4_add_u32 s37, s35, s40
    s_lshr_b32 s38, s36, 4
    s_xor_b32 s38, s38, 1
    s_and_b32 s34, s3, 3
    s_cmp_ge_u32 s3, 4
    s_cbranch_scc1 L_p1
    s_setprio 3
    s_lshl_b32 s40, s2, 14
    s_lshl_b32 s41, s34, 9
    v_lshrrev_b32_e64 v118, 3, v1
    v_and_b32 v113, 112, v2
    v_add_u32_e64 v113, s41, v113
    v_lshl_add_u32 v112, v118, 11, v113
    v_add_u32 v112, s40, v112
    s_waitcnt lgkmcnt(0)
    s_load_dword s47, s[32:33], 0
    global_load_dwordx4 v[32:35], v113, s[20:21] offset:0
    global_load_dwordx4 v[36:39], v113, s[20:21] offset:128
    global_load_dwordx4 v[40:43], v113, s[20:21] offset:256
    global_load_dwordx4 v[44:47], v113, s[20:21] offset:384
    global_load_dwordx4 v[16:19], v112, s[4:5] offset:0 nt
    global_load_dwordx4 v[20:23], v112, s[4:5] offset:128 nt
    global_load_dwordx4 v[24:27], v112, s[4:5] offset:256 nt
    global_load_dwordx4 v[28:31], v112, s[4:5] offset:384 nt
    s_barrier
    s_branch L_tok
    s_nop 0
L_p1:
    s_cmp_ge_u32 s3, 8
    s_cbranch_scc1 L_p2
    s_and_b32 s40, s36, 3
    s_lshl2_add_u32 s40, s40, s34
    s_lshl_b32 s40, s40, 11
    v_and_b32 v0, 15, v1
    v_lshl_add_u32 v0, v0, 7, s40
    v_cmp_gt_u32 vcc, L_codeend-L_pc-4, v0
    s_nop 1
    v_cndmask_b32 v0, v3, v0, vcc
    global_load_dword v31, v0, s[62:63]
    s_lshl_b32 s40, s34, 7
    s_and_b32 s41, s40, 128
    s_add_u32 s40, s40, 384
    v_cmp_gt_u32 vcc, 32, v1
    v_mov_b32 v32, s40
    v_mov_b32 v33, s41
    v_cndmask_b32 v32, v33, v32, vcc
    v_cndmask_b32 v34, 0, -1, vcc
    v_lshl_add_u32 v32, v1, 2, v32
    v_subrev_u32 v32, 128, v32
    ds_write_b32 v32, v34
    s_waitcnt lgkmcnt(0)
    s_barrier
    s_branch L_exp
L_p2:
    s_sub_u32 s34, s3, 8
    v_and_b32 v32, 15, v1
    v_lshrrev_b32 v33, 4, v1
    s_cmp_ge_u32 s34, 5
    s_cbranch_scc1 L_q5
    s_lshl_b32 s40, s34, 2
    s_lshr_b32 s41, 0xccb5a, s40
    s_and_b32 s41, s41, 15
    s_add_u32 s41, s41, 40
    s_lshr_b32 s45, 0x29735, s40
    s_and_b32 s45, s45, 15
    s_bfm_b32 s45, s45, 0
    s_mov_b32 s44, 0
    v_lshl_add_u32 v86, v33, 3, v32
    v_sub_u32_e64 v86, s41, v86
    v_lshrrev_b64 v[86:87], v86, s[44:45]
    s_mov_b32 s43, 0xffff
    v_bfe_i32 v36, v86, 0, 1
    v_bfe_i32 v87, v86, 1, 1
    v_bfi_b32 v36, s43, v36, v87
    v_and_b32 v36, 0x3c003c00, v36
    v_bfe_i32 v37, v86, 2, 1
    v_bfe_i32 v87, v86, 3, 1
    v_bfi_b32 v37, s43, v37, v87
    v_and_b32 v37, 0x3c003c00, v37
    v_bfe_i32 v38, v86, 4, 1
    v_bfe_i32 v87, v86, 5, 1
    v_bfi_b32 v38, s43, v38, v87
    v_and_b32 v38, 0x3c003c00, v38
    v_bfe_i32 v39, v86, 6, 1
    v_bfe_i32 v87, v86, 7, 1
    v_bfi_b32 v39, s43, v39, v87
    v_and_b32 v39, 0x3c003c00, v39
    s_branch L_qw
    s_nop 0
L_q5:
    s_cmp_ge_u32 s34, 6
    s_cbranch_scc1 L_q6
    v_lshlrev_b32 v85, 1, v32
    v_sub_u32 v85, v85, v33
    v_lshl_add_u32 v36, v85, 4, 48
    v_and_b32 v86, 1, v1
    v_cmp_eq_u32 vcc, 0, v86
    v_mov_b32 v85, 0x03020706
    v_mov_b32 v87, 0x05040100
    v_cndmask_b32_e64 v37, v85, v87, vcc
    v_mov_b32 v85, 4412
    v_mov_b32 v87, 5312
    v_cndmask_b32 v85, v85, v87, vcc
    v_lshlrev_b32 v86, 2, v33
    v_sub_u32 v86, v86, v32
    v_lshl_add_u32 v39, v86, 2, v85
    v_sub_u32 v85, 3, v32
    v_and_b32_e64 v85, 3, v85
    v_mul_u32_u24 v85, 1086, v85
    v_lshl_add_u32 v86, v33, 3, v32
    v_sub_u32_e64 v86, 39, v86
    v_lshl_add_u32 v38, v86, 1, v85
    s_branch L_qw
L_q6:
    s_cmp_ge_u32 s34, 7
    s_cbranch_scc1 L_q7
    v_and_b32 v31, 31, v1
    v_mov_b32 v85, 0
    v_cmp_gt_u32 vcc, 24, v31
    v_mov_b32 v86, 0x9876a987
    s_nop 0
    v_cndmask_b32 v85, v85, v86, vcc
    v_cmp_gt_u32 vcc, 16, v31
    v_mov_b32 v86, 0x54aa6543
    s_nop 0
    v_cndmask_b32 v85, v85, v86, vcc
    v_cmp_gt_u32 vcc, 8, v31
    v_mov_b32 v86, 0x2113210
    s_nop 0
    v_cndmask_b32 v85, v85, v86, vcc
    v_lshlrev_b32_e64 v86, 2, v31
    v_bfe_u32 v85, v85, v86, 4
    s_mov_b32 s41, 0xf00f0ff0
    v_bfe_u32 v86, s41, v31, 1
    v_mad_u32_u24 v85, v86, 10, v85
    v_lshrrev_b32 v86, 5, v1
    v_mad_u32_u24 v85, v85, 17, v86
    v_lshlrev_b32 v36, 4, v85
    v_mad_u32_u24 v85, v31, 17, v86
    v_lshlrev_b32 v37, 4, v85
    v_lshrrev_b32 v85, 1, v1
    v_and_b32_e64 v86, 1, v1
    v_sub_u32 v85, 1135, v85
    v_mad_u32_u24 v87, v86, 48, v85
    v_lshlrev_b32 v38, 2, v87
    v_lshlrev_b32 v86, 5, v86
    v_sub_u32 v85, v85, v86
    v_add_u32 v85, 128, v85
    v_lshlrev_b32 v39, 2, v85
    s_branch L_qw
L_q7:
    v_cmp_gt_u32 vcc, 32, v1
    v_bfe_u32 v85, v1, 2, 2
    v_bfe_u32 v86, v1, 3, 2
    v_cndmask_b32 v86, v86, v85, vcc
    v_lshlrev_b32 v86, 2, v86
    s_mov_b32 s41, 0xb630
    v_bfe_u32 v86, s41, v86, 4
    v_mov_b32 v87, 5248
    v_mov_b32 v36, 4352
    v_cndmask_b32 v87, v87, v36, vcc
    v_lshl_add_u32 v86, v86, 6, v87
    v_and_b32 v87, 7, v1
    v_min_u32 v87, 4, v87
    v_and_b32 v36, 3, v1
    v_cndmask_b32 v87, v87, v36, vcc
    v_cmp_gt_u32 vcc, 16, v1
    v_mul_u32_u24 v85, 1088, v85
    s_mov_b32 s41, 0xffff0000
    v_cndmask_b32 v86, v86, v85, vcc
    v_lshl_add_u32 v36, v87, 4, v86
    v_mov_b32 v37, 0
    v_mov_b32_e64 v38, 0
    v_mov_b32_e64 v39, 0
    v_writelane_b32 v38, s41, 3
    v_writelane_b32 v39, -1, 3
    v_writelane_b32 v38, -1, 7
    v_writelane_b32 v39, -1, 7
    v_writelane_b32 v37, s41, 11
    v_writelane_b32 v38, -1, 11
    v_writelane_b32 v37, -1, 15
    v_writelane_b32 v38, -1, 15
L_qw:
    s_lshl_b32 s58, s38, 10
    s_sub_u32 s58, 10512, s58
    s_sub_u32 s40, s34, 4
    s_mul_i32 s40, s40, 4624
    s_add_u32 s40, s40, s58
    s_lshl_b32 s41, s34, 10
    s_add_u32 s41, s41, 4864
    s_cmp_lt_u32 s34, 4
    s_cselect_b32 s40, s41, s40
    v_add_u32_e64 v85, s40, v2
    ds_write_b128 v85, v[36:39]
    s_lshl3_add_u32 s42, s37, s34
    s_lshl_b32 s40, s42, 8
    v_lshl_add_u32 v24, v1, 2, s40
    s_lshr_b32 s40, s42, 1
    s_lshl_b32 s40, s40, 2
    s_waitcnt lgkmcnt(0)
    s_load_dword s48, s[14:15], s40
    s_load_dword s49, s[16:17], s40
    s_barrier
    global_load_dword v8, v24, s[6:7]
    global_load_dword v9, v24, s[8:9]
    global_load_dword v10, v24, s[10:11]
    global_load_dword v11, v24, s[12:13]
    s_branch L_cnv
    s_nop 0
L_tok:
    s_setprio 3
    s_cmp_ge_u32 s34, 2
    s_cselect_b32 s40, 4, 0
    s_add_u32 s40, s40, s34
    s_add_u32 s41, s34, 2
    s_cmp_eq_u32 s38, 0
    s_cselect_b32 s20, s40, s41
    s_cselect_b32 s21, s41, s40
    s_mov_b32 s30, 0x3f803f80
    s_mov_b32 s31, 0xffff0000
    s_lshl_b32 s40, s2, 7
    s_lshl_b32 s41, s34, 20
    s_add_u32 s40, s40, s41
    s_add_u32 s40, s40, 2097152
    s_add_u32 s52, s32, s40
    s_addc_u32 s53, s33, 0
    s_add_u32 s50, s32, 32768
    s_addc_u32 s51, s33, 0
    s_lshl_b32 s40, s2, 6
    s_add_u32 s58, s50, s40
    s_addc_u32 s59, s51, 0
    s_lshl_b32 s40, s21, 11
    s_add_u32 s60, s50, s40
    s_addc_u32 s61, s51, 0
    s_nop 0
    s_lshl_b32 s41, s37, 15
    s_add_u32 s41, s41, 2097152
    s_lshl_b32 s40, s20, 12
    s_add_u32 s40, s40, s41
    s_add_u32 s54, s32, s40
    s_addc_u32 s55, s33, 0
    s_lshl_b32 s40, s21, 12
    s_add_u32 s40, s40, s41
    s_add_u32 s56, s32, s40
    s_addc_u32 s57, s33, 0
    s_lshl_b32 s40, s20, 19
    s_lshl4_add_u32 s40, s37, s40
    s_add_u32 s40, s40, 4096
    s_add_u32 s28, s28, s40
    s_addc_u32 s29, s29, 0
    s_lshl_b32 s40, s20, 9
    s_add_u32 s40, s40, 9488
    s_lshl_b32 s41, s21, 9
    s_add_u32 s41, s41, 9488
    s_nop 0
    s_lshl_b32 s42, s34, 9
    s_add_u32 s42, s42, 52096
    v_lshl_add_u32 v5, v1, 3, s42
    v_add_u32 v11, 57664, v5
    s_lshl_b32 s42, s34, 2
    v_mov_b32 v10, s42
    v_and_b32 v58, 112, v2
    v_lshrrev_b32_e64 v59, 4, v1
    v_mul_u32_u24 v56, 4624, v118
    v_add3_u32 v114, v56, v58, s40
    v_mul_u32_u24 v56, 289, v58
    v_lshlrev_b32_e64 v117, 4, v118
    v_add3_u32 v8, v56, v117, s40
    v_add3_u32 v9, v56, v117, s41
    v_lshl_add_u32 v116, v118, 17, v58
    v_bfe_u32 v56, v1, 2, 2
    v_mul_u32_u24 v56, 4624, v56
    v_lshl_add_u32 v56, v59, 7, v56
    v_and_b32 v57, 2, v1
    v_lshl_add_u32 v56, v57, 5, v56
    v_and_b32 v57, 1, v1
    v_lshl_add_u32 v56, v57, 3, v56
    v_add_u32 v115, s40, v56
    v_and_b32 v57, 15, v1
    v_lshl_add_u32 v56, v57, 2, v59
    v_lshl_add_u32 v6, v56, 3, s40
    v_lshlrev_b32 v4, 13, v56
    s_lshl_b32 s40, s20, 11
    v_lshl_add_u32 v7, v56, 5, s40
    s_lshl_b32 s40, s34, 7
    v_add_u32 v120, s40, v117
    v_lshlrev_b32 v118, 3, v118
    v_mov_b32 v53, 1
    s_waitcnt lgkmcnt(0)
    s_add_u32 s39, s47, 1
    s_mul_i32 s39, s39, 0x9e3779b1
    v_mov_b32 v52, s39
    s_mov_b64 exec, 1
    ds_write_b64 v3, v[52:53] offset:40
    s_mov_b64 exec, -1
    v_lshlrev_b32 v57, 3, v1
    v_and_b32 v119, 0xffff, v52
    s_and_b32 s42, s39, 1
    s_mul_i32 s42, s42, 0x01010101
    s_and_b32 s43, s39, 0xfefefefe
    s_or_b32 s43, s43, s42
    v_bfe_u32 v56, s43, v57, 8
    v_lshl_or_b32 v12, v56, 14, v56
    v_lshrrev_b32 v14, 4, v12
    s_waitcnt vmcnt(4)
    v_dot2_f32_bf16 v51, v32, s30, 0
    v_dot2_f32_bf16 v52, v33, s30, 0
    v_dot2_f32_bf16 v51, v34, s30, v51
    v_dot2_f32_bf16 v52, v35, s30, v52
    v_dot2_f32_bf16 v51, v36, s30, v51
    v_dot2_f32_bf16 v52, v37, s30, v52
    v_dot2_f32_bf16 v51, v38, s30, v51
    v_dot2_f32_bf16 v52, v39, s30, v52
    v_dot2_f32_bf16 v51, v40, s30, v51
    v_dot2_f32_bf16 v52, v41, s30, v52
    v_dot2_f32_bf16 v51, v42, s30, v51
    v_dot2_f32_bf16 v52, v43, s30, v52
    v_dot2_f32_bf16 v51, v44, s30, v51
    v_dot2_f32_bf16 v52, v45, s30, v52
    v_dot2_f32_bf16 v51, v46, s30, v51
    v_dot2_f32_bf16 v52, v47, s30, v52
    s_waitcnt vmcnt(3)
    s_nop 0
    v_dot2_f32_bf16 v49, v16, v16, 0
    v_dot2_f32_bf16 v48, v16, s30, 0
    v_dot2_f32_bf16 v50, v16, v32, 0
    v_dot2_f32_bf16 v49, v17, v17, v49
    v_dot2_f32_bf16 v48, v17, s30, v48
    v_dot2_f32_bf16 v50, v17, v33, v50
    v_dot2_f32_bf16 v49, v18, v18, v49
    v_dot2_f32_bf16 v48, v18, s30, v48
    v_dot2_f32_bf16 v50, v18, v34, v50
    v_dot2_f32_bf16 v49, v19, v19, v49
    v_dot2_f32_bf16 v48, v19, s30, v48
    v_dot2_f32_bf16 v50, v19, v35, v50
    v_add_f32 v51, v51, v52
    s_waitcnt vmcnt(2)
    v_dot2_f32_bf16 v49, v20, v20, v49
    v_dot2_f32_bf16 v48, v20, s30, v48
    v_dot2_f32_bf16 v50, v20, v36, v50
    v_dot2_f32_bf16 v49, v21, v21, v49
    v_dot2_f32_bf16 v48, v21, s30, v48
    v_dot2_f32_bf16 v50, v21, v37, v50
    v_dot2_f32_bf16 v49, v22, v22, v49
    v_dot2_f32_bf16 v48, v22, s30, v48
    v_dot2_f32_bf16 v50, v22, v38, v50
    v_dot2_f32_bf16 v49, v23, v23, v49
    v_dot2_f32_bf16 v48, v23, s30, v48
    v_dot2_f32_bf16 v50, v23, v39, v50
    s_waitcnt vmcnt(1)
    s_nop 0
    v_dot2_f32_bf16 v49, v24, v24, v49
    v_dot2_f32_bf16 v48, v24, s30, v48
    v_dot2_f32_bf16 v50, v24, v40, v50
    v_dot2_f32_bf16 v49, v25, v25, v49
    v_dot2_f32_bf16 v48, v25, s30, v48
    v_dot2_f32_bf16 v50, v25, v41, v50
    v_dot2_f32_bf16 v49, v26, v26, v49
    v_dot2_f32_bf16 v48, v26, s30, v48
    v_dot2_f32_bf16 v50, v26, v42, v50
    v_dot2_f32_bf16 v49, v27, v27, v49
    v_dot2_f32_bf16 v48, v27, s30, v48
    v_dot2_f32_bf16 v50, v27, v43, v50
    s_nop 0
    s_waitcnt vmcnt(0)
    v_dot2_f32_bf16 v49, v28, v28, v49
    v_dot2_f32_bf16 v48, v28, s30, v48
    v_dot2_f32_bf16 v50, v28, v44, v50
    v_dot2_f32_bf16 v49, v29, v29, v49
    v_dot2_f32_bf16 v48, v29, s30, v48
    v_dot2_f32_bf16 v50, v29, v45, v50
    v_dot2_f32_bf16 v49, v30, v30, v49
    v_dot2_f32_bf16 v48, v30, s30, v48
    v_dot2_f32_bf16 v50, v30, v46, v50
    v_dot2_f32_bf16 v49, v31, v31, v49
    v_dot2_f32_bf16 v48, v31, s30, v48
    v_dot2_f32_bf16 v50, v31, v47, v50
    v_add_f32_dpp v51, v51, v51 quad_perm:[1,0,3,2] row_mask:0xf bank_mask:0xf
    v_add_f32_dpp v49, v49, v49 quad_perm:[1,0,3,2] row_mask:0xf bank_mask:0xf
    v_add_f32_dpp v48, v48, v48 quad_perm:[1,0,3,2] row_mask:0xf bank_mask:0xf
    v_add_f32_dpp v50, v50, v50 quad_perm:[1,0,3,2] row_mask:0xf bank_mask:0xf
    v_add_f32_dpp v51, v51, v51 quad_perm:[2,3,0,1] row_mask:0xf bank_mask:0xf
    v_add_f32_dpp v49, v49, v49 quad_perm:[2,3,0,1] row_mask:0xf bank_mask:0xf
    v_add_f32_dpp v48, v48, v48 quad_perm:[2,3,0,1] row_mask:0xf bank_mask:0xf
    v_add_f32_dpp v50, v50, v50 quad_perm:[2,3,0,1] row_mask:0xf bank_mask:0xf
    v_add_f32_dpp v51, v51, v51 row_half_mirror row_mask:0xf bank_mask:0xf
    v_add_f32_dpp v49, v49, v49 row_half_mirror row_mask:0xf bank_mask:0xf
    v_add_f32_dpp v48, v48, v48 row_half_mirror row_mask:0xf bank_mask:0xf
    v_add_f32_dpp v50, v50, v50 row_half_mirror row_mask:0xf bank_mask:0xf
    v_and_b32 v49, 0x7fffffff, v49
    s_mov_b32 exec_lo, 0x01010101
    s_mov_b32 exec_hi, 0x01010101
    ds_write_b128 v120, v[48:51] offset:256
    s_mov_b64 exec, -1
    s_mov_b32 s46, 0
    ds_read_b128 v[60:63], v117 offset:256
    ds_read_b128 v[64:67], v117 offset:384
    ds_read_b128 v[68:71], v117 offset:512
    ds_read_b128 v[72:75], v117 offset:640
    v_lshlrev_b32_e64 v80, 16, v16
    v_and_b32 v81, 0xffff0000, v16
    v_lshlrev_b32_e64 v82, 16, v17
    v_and_b32 v83, 0xffff0000, v17
    v_lshlrev_b32_e64 v84, 16, v18
    v_and_b32 v85, 0xffff0000, v18
    v_lshlrev_b32_e64 v86, 16, v19
    v_and_b32 v87, 0xffff0000, v19
    v_lshlrev_b32_e64 v88, 16, v20
    v_and_b32 v89, 0xffff0000, v20
    v_lshlrev_b32_e64 v90, 16, v21
    v_and_b32 v91, 0xffff0000, v21
    v_lshlrev_b32_e64 v92, 16, v22
    v_and_b32 v93, 0xffff0000, v22
    s_branch L_spc_3
    s_nop 0
L_sp_1:
    ds_read_b128 v[60:63], v117 offset:256
    ds_read_b128 v[64:67], v117 offset:384
    ds_read_b128 v[68:71], v117 offset:512
    ds_read_b128 v[72:75], v117 offset:640
L_spc_3:
    s_waitcnt lgkmcnt(0)
    v_or3_b32 v52, v61, v65, v69
    v_or_b32 v52, v52, v73
    v_cmp_gt_i32_e64 vcc, 0, v52
    s_cbranch_vccz L_spd_2
    s_add_u32 s46, s46, 1
    s_cmp_lt_u32 s46, 400000
    s_cbranch_scc1 L_sp_1
    s_branch L_end
L_spd_2:
    v_pk_add_f32 v[60:61], v[60:61], v[64:65]
    v_pk_add_f32 v[68:69], v[68:69], v[72:73]
    v_pk_add_f32 v[62:63], v[62:63], v[66:67]
    v_pk_add_f32 v[70:71], v[70:71], v[74:75]
    v_pk_add_f32 v[60:61], v[60:61], v[68:69]
    v_pk_add_f32 v[62:63], v[62:63], v[70:71]
    v_mul_f32 v48, 0x3a800000, v60
    v_mul_f32 v49, 0x3a800000, v61
    v_fma_f32 v49, -v48, v48, v49
    v_max_f32_e64 v49, 0, v49
    v_cvt_pk_bf16_f32 v54, v48, v49
    v_and_b32 v49, 0xffff0000, v54
    v_add_f32 v49, 0x3727c5ac, v49
    v_cvt_pk_bf16_f32 v49, v49, v49
    v_and_b32 v49, 0xffff0000, v49
    v_sqrt_f32_e64 v49, v49
    v_lshlrev_b32_e64 v54, 16, v54
    v_cvt_pk_bf16_f32 v52, v48, v49
    v_and_b32 v49, 0xffff0000, v52
    v_rcp_f32_e64 v55, v49
    v_fma_f32 v53, -v54, v63, v62
    s_cmp_lg_u32 s34, 0
    s_cbranch_scc1 L_nohdr_4
    v_mul_f32 v53, v53, v55
    s_brev_b32 s40, 1
    v_cvt_pk_bf16_f32 v53, v53, v53
    v_ashrrev_i32_e64 v49, 31, v53
    v_bitop3_b32 v53, v53, v49, s40 bitop3:0x1e
    v_and_or_b32 v53, v53, s31, v119
    s_mov_b32 exec_lo, 0x01010101
    s_mov_b32 exec_hi, 0x01010101
    global_store_dwordx2 v118, v[52:53], s[58:59] sc1
    s_mov_b64 exec, -1
L_nohdr_4:
    v_mul_f32 v56, 0xbfb8aa3b, v55
    v_lshlrev_b32 v94, 16, v23
    v_and_b32 v95, 0xffff0000, v23
    v_mul_f32 v58, -v54, v56
    v_lshlrev_b32_e64 v96, 16, v24
    v_and_b32 v97, 0xffff0000, v24
    v_lshlrev_b32_e64 v98, 16, v25
    v_and_b32 v99, 0xffff0000, v25
    v_lshlrev_b32_e64 v100, 16, v26
    v_and_b32 v101, 0xffff0000, v26
    v_lshlrev_b32_e64 v102, 16, v27
    v_and_b32 v103, 0xffff0000, v27
    v_lshlrev_b32_e64 v104, 16, v28
    v_and_b32 v105, 0xffff0000, v28
    v_lshlrev_b32_e64 v106, 16, v29
    v_and_b32 v107, 0xffff0000, v29
    v_lshlrev_b32_e64 v108, 16, v30
    v_and_b32 v109, 0xffff0000, v30
    v_lshlrev_b32_e64 v110, 16, v31
    v_and_b32 v111, 0xffff0000, v31
    v_pk_fma_f32 v[80:81], v[80:81], v[56:57], v[58:59] op_sel_hi:[1,0,0]
    v_pk_fma_f32 v[82:83], v[82:83], v[56:57], v[58:59] op_sel_hi:[1,0,0]
    v_pk_fma_f32 v[84:85], v[84:85], v[56:57], v[58:59] op_sel_hi:[1,0,0]
    v_pk_fma_f32 v[86:87], v[86:87], v[56:57], v[58:59] op_sel_hi:[1,0,0]
    v_cvt_pk_f16_f32 v16, v80, v81
    v_cvt_pk_f16_f32 v17, v82, v83
    v_cvt_pk_f16_f32 v18, v84, v85
    v_cvt_pk_f16_f32 v19, v86, v87
    ds_write_b128 v114, v[16:19] offset:0
    v_pk_fma_f32 v[88:89], v[88:89], v[56:57], v[58:59] op_sel_hi:[1,0,0]
    v_pk_fma_f32 v[90:91], v[90:91], v[56:57], v[58:59] op_sel_hi:[1,0,0]
    v_pk_fma_f32 v[92:93], v[92:93], v[56:57], v[58:59] op_sel_hi:[1,0,0]
    v_pk_fma_f32 v[94:95], v[94:95], v[56:57], v[58:59] op_sel_hi:[1,0,0]
    v_cvt_pk_f16_f32 v20, v88, v89
    v_cvt_pk_f16_f32 v21, v90, v91
    v_cvt_pk_f16_f32 v22, v92, v93
    v_cvt_pk_f16_f32 v23, v94, v95
    ds_write_b128 v114, v[20:23] offset:128
    v_pk_fma_f32 v[96:97], v[96:97], v[56:57], v[58:59] op_sel_hi:[1,0,0]
    v_pk_fma_f32 v[98:99], v[98:99], v[56:57], v[58:59] op_sel_hi:[1,0,0]
    v_pk_fma_f32 v[100:101], v[100:101], v[56:57], v[58:59] op_sel_hi:[1,0,0]
    v_pk_fma_f32 v[102:103], v[102:103], v[56:57], v[58:59] op_sel_hi:[1,0,0]
    v_cvt_pk_f16_f32 v24, v96, v97
    v_cvt_pk_f16_f32 v25, v98, v99
    v_cvt_pk_f16_f32 v26, v100, v101
    v_cvt_pk_f16_f32 v27, v102, v103
    ds_write_b128 v114, v[24:27] offset:256
    v_pk_fma_f32 v[104:105], v[104:105], v[56:57], v[58:59] op_sel_hi:[1,0,0]
    v_pk_fma_f32 v[106:107], v[106:107], v[56:57], v[58:59] op_sel_hi:[1,0,0]
    v_pk_fma_f32 v[108:109], v[108:109], v[56:57], v[58:59] op_sel_hi:[1,0,0]
    v_pk_fma_f32 v[110:111], v[110:111], v[56:57], v[58:59] op_sel_hi:[1,0,0]
    v_cvt_pk_f16_f32 v28, v104, v105
    v_cvt_pk_f16_f32 v29, v106, v107
    v_cvt_pk_f16_f32 v30, v108, v109
    v_cvt_pk_f16_f32 v31, v110, v111
    ds_write_b128 v114, v[28:31] offset:384
    ds_read_b64_tr_b16 v[32:33], v115 offset:0
    ds_read_b64_tr_b16 v[34:35], v115 offset:18496
    ds_read_b64_tr_b16 v[36:37], v115 offset:16
    ds_read_b64_tr_b16 v[38:39], v115 offset:18512
    ds_read_b64_tr_b16 v[40:41], v115 offset:32
    ds_read_b64_tr_b16 v[42:43], v115 offset:18528
    ds_read_b64_tr_b16 v[44:45], v115 offset:48
    ds_read_b64_tr_b16 v[46:47], v115 offset:18544
    s_mov_b32 s22, 0x00030003
    s_nop 0
    s_waitcnt lgkmcnt(6)
    v_bfi_b32 v32, s22, v12, v32
    v_bfi_b32 v34, s22, v14, v34
    global_store_dwordx4 v116, v[32:35], s[52:53] offset:0 sc1
    s_add_u32 s52, s52, 32768
    s_addc_u32 s53, s53, 0
    s_waitcnt lgkmcnt(4)
    v_bfi_b32 v36, s22, v12, v36
    v_bfi_b32 v38, s22, v14, v38
    global_store_dwordx4 v116, v[36:39], s[52:53] offset:0 sc1
    s_add_u32 s52, s52, 32768
    s_addc_u32 s53, s53, 0
    s_waitcnt lgkmcnt(2)
    v_bfi_b32 v40, s22, v12, v40
    v_bfi_b32 v42, s22, v14, v42
    global_store_dwordx4 v116, v[40:43], s[52:53] offset:0 sc1
    s_add_u32 s52, s52, 32768
    s_addc_u32 s53, s53, 0
    s_waitcnt lgkmcnt(0)
    v_bfi_b32 v44, s22, v12, v44
    v_bfi_b32 v46, s22, v14, v46
    global_store_dwordx4 v116, v[44:47], s[52:53] offset:0 sc1
    v_lshrrev_b32 v80, 3, v7
    v_sub_u32 v80, 0xffff, v80
    s_lshl_b32 s40, s21, 8
    s_sub_u32 s40, 0xffff, s40
    v_lshlrev_b32 v84, 1, v1
    v_sub_u32 v84, s40, v84
    v_subrev_u32 v81, 1, v80
    v_subrev_u32 v85, 1, v84
    v_subrev_u32_e64 v82, 2, v80
    v_subrev_u32 v86, 128, v84
    v_subrev_u32_e64 v83, 3, v80
    v_subrev_u32 v87, 129, v84
    v_mov_b32 v76, 1
    v_lshrrev_b32 v52, 4, v1
    v_add_u32_e64 v52, v52, v10
    v_lshlrev_b32_e64 v52, 3, v52
    s_mov_b32 s46, 0
L_sp_5:
    ds_read_b32 v48, v3 offset:80
    s_waitcnt lgkmcnt(0)
    v_cmp_gt_u32 vcc, 4, v48
    s_cbranch_vccz L_spd_6
    s_add_u32 s46, s46, 1
    s_sleep 2
    s_cmp_lt_u32 s46, 400000
    s_cbranch_scc1 L_sp_5
    s_branch L_end
L_spd_6:
    global_load_dwordx4 v[60:63], v7, s[50:51] offset:0
    global_load_dwordx4 v[64:67], v7, s[50:51] offset:16
    global_load_dwordx4 v[68:71], v2, s[60:61] offset:0
    global_load_dwordx4 v[72:75], v2, s[60:61] offset:1024
    s_mov_b32 s46, 0
L_sp_7:
    ds_read_b32 v48, v3 offset:84
    s_waitcnt lgkmcnt(0)
    v_cmp_gt_u32 vcc, 4, v48
    s_cbranch_vccz L_spd_8
    s_add_u32 s46, s46, 1
    s_sleep 2
    s_cmp_lt_u32 s46, 400000
    s_cbranch_scc1 L_sp_7
    s_branch L_end
L_spd_8:
    s_cmp_ge_u32 s21, 6
    s_cbranch_scc1 L_nob_9
    global_load_dwordx4 v[32:35], v2, s[56:57] offset:0 sc1
    global_load_dwordx4 v[36:39], v2, s[56:57] offset:1024 sc1
    global_load_dwordx4 v[40:43], v2, s[56:57] offset:2048 sc1
    global_load_dwordx4 v[44:47], v2, s[56:57] offset:3072 sc1
L_nob_9:
    global_load_dwordx4 v[16:19], v2, s[54:55] offset:0 sc1
    global_load_dwordx4 v[20:23], v2, s[54:55] offset:1024 sc1
    global_load_dwordx4 v[24:27], v2, s[54:55] offset:2048 sc1
    global_load_dwordx4 v[28:31], v2, s[54:55] offset:3072 sc1
    s_mov_b32 s46, 0
    s_cmp_ge_u32 s21, 6
    s_cbranch_scc1 L_nob_12
    s_waitcnt vmcnt(8)
    s_branch L_rc_10
    s_nop 0
L_nob_12:
    s_waitcnt vmcnt(4)
L_rc_10:
    v_xor_b32 v50, v119, v61
    v_bitop3_b32 v50, v50, v63, v119 bitop3:0xf6
    v_bitop3_b32 v50, v50, v65, v119 bitop3:0xf6
    v_bitop3_b32 v50, v50, v67, v119 bitop3:0xf6
    v_bitop3_b32 v50, v50, v69, v119 bitop3:0xf6
    v_bitop3_b32 v50, v50, v71, v119 bitop3:0xf6
    v_bitop3_b32 v50, v50, v73, v119 bitop3:0xf6
    v_bitop3_b32 v50, v50, v75, v119 bitop3:0xf6
    v_and_b32 v50, 0xffff, v50
    v_cmp_ne_u32 vcc, 0, v50
    s_cbranch_vccz L_ro_11
    global_load_dwordx4 v[60:63], v7, s[50:51] offset:0 sc1
    global_load_dwordx4 v[64:67], v7, s[50:51] offset:16 sc1
    global_load_dwordx4 v[68:71], v2, s[60:61] offset:0 sc1
    global_load_dwordx4 v[72:75], v2, s[60:61] offset:1024 sc1
    s_add_u32 s46, s46, 1
    s_cmp_lt_u32 s46, 50000
    s_waitcnt vmcnt(0)
    s_cbranch_scc1 L_rc_10
    s_branch L_end
L_ro_11:
    v_and_or_b32 v80, v61, s31, v80
    v_and_or_b32 v81, v63, s31, v81
    v_and_or_b32 v82, v65, s31, v82
    v_and_or_b32 v83, v67, s31, v83
    v_and_or_b32 v84, v69, s31, v84
    v_and_or_b32 v85, v71, s31, v85
    v_and_or_b32 v86, v73, s31, v86
    v_and_or_b32 v87, v75, s31, v87
    v_max3_u32 v48, v80, v81, v82
    v_med3_u32 v49, v80, v81, v82
    v_med3_u32 v49, v48, v49, v83
    v_max_u32 v48, v48, v83
    v_med3_u32 v49, v48, v49, v84
    v_max_u32 v48, v48, v84
    v_med3_u32 v49, v48, v49, v85
    v_max_u32_e64 v48, v48, v85
    v_med3_u32 v49, v48, v49, v86
    v_max_u32_e64 v48, v48, v86
    v_med3_u32 v49, v48, v49, v87
    v_max_u32 v48, v48, v87
    s_nop 0
    v_max_u32_dpp v51, v49, v49 quad_perm:[1,0,3,2] row_mask:0xf bank_mask:0xf
    v_min_u32_dpp v50, v48, v48 quad_perm:[1,0,3,2] row_mask:0xf bank_mask:0xf
    v_max_u32 v49, v50, v51
    v_max_u32_dpp v48, v48, v48 quad_perm:[1,0,3,2] row_mask:0xf bank_mask:0xf
    s_nop 0
    v_max_u32_dpp v51, v49, v49 quad_perm:[2,3,0,1] row_mask:0xf bank_mask:0xf
    v_min_u32_dpp v50, v48, v48 quad_perm:[2,3,0,1] row_mask:0xf bank_mask:0xf
    v_max_u32 v49, v50, v51
    v_max_u32_dpp v48, v48, v48 quad_perm:[2,3,0,1] row_mask:0xf bank_mask:0xf
    s_nop 0
    v_max_u32_dpp v51, v49, v49 row_half_mirror row_mask:0xf bank_mask:0xf
    v_min_u32_dpp v50, v48, v48 row_half_mirror row_mask:0xf bank_mask:0xf
    v_max_u32 v49, v50, v51
    v_max_u32_dpp v48, v48, v48 row_half_mirror row_mask:0xf bank_mask:0xf
    s_nop 0
    v_max_u32_dpp v51, v49, v49 row_mirror row_mask:0xf bank_mask:0xf
    v_min_u32_dpp v50, v48, v48 row_mirror row_mask:0xf bank_mask:0xf
    v_max_u32_e64 v49, v50, v51
    v_max_u32_dpp v48, v48, v48 row_mirror row_mask:0xf bank_mask:0xf
    s_mov_b32 exec_lo, 0x00010001
    s_mov_b32 exec_hi, 0x00010001
    ds_write_b64 v52, v[48:49] offset:128
    s_mov_b64 exec, -1
    v_and_b32 v92, 0xffff0000, v60
    v_lshlrev_b32 v88, 16, v60
    v_mul_f32 v92, 0xbf317218, v92
    v_and_b32 v93, 0xffff0000, v62
    v_lshlrev_b32_e64 v89, 16, v62
    v_mul_f32 v93, 0xbf317218, v93
    v_and_b32 v94, 0xffff0000, v64
    v_lshlrev_b32_e64 v90, 16, v64
    v_mul_f32 v94, 0xbf317218, v94
    v_and_b32 v95, 0xffff0000, v66
    v_lshlrev_b32_e64 v91, 16, v66
    v_mul_f32 v95, 0xbf317218, v95
    s_mov_b32 s46, 0
L_sp_13:
    ds_read_b128 v[80:83], v3 offset:0
    ds_read_b128 v[84:87], v3 offset:16
    s_waitcnt lgkmcnt(0)
    v_min3_u32 v96, v80, v81, v82
    v_min3_u32 v96, v96, v83, v84
    v_min3_u32 v96, v96, v85, v86
    v_min_u32_e64 v96, v96, v87
    v_cmp_eq_u32 vcc, 0, v96
    s_cbranch_vccz L_spd_14
    s_add_u32 s46, s46, 1
    s_sleep 1
    s_cmp_lt_u32 s46, 400000
    s_cbranch_scc1 L_sp_13
    s_branch L_end
    s_nop 0
L_spd_14:
    s_mov_b32 s46, 0
L_pa_15:
    v_mov_b32 v57, 0
    s_cmp_ge_u32 s21, 6
    s_cbranch_scc1 L_nob_17
    s_waitcnt vmcnt(7)
    ds_write_b128 v9, v[32:35] offset:0
    v_bitop3_b32 v57, v57, v32, v12 bitop3:0xf6
    v_bitop3_b32 v57, v57, v34, v14 bitop3:0xf6
    s_waitcnt vmcnt(6)
    ds_write_b128 v9, v[36:39] offset:128
    v_bitop3_b32 v57, v57, v36, v12 bitop3:0xf6
    v_bitop3_b32 v57, v57, v38, v14 bitop3:0xf6
    s_waitcnt vmcnt(5)
    ds_write_b128 v9, v[40:43] offset:256
    v_bitop3_b32 v57, v57, v40, v12 bitop3:0xf6
    v_bitop3_b32 v57, v57, v42, v14 bitop3:0xf6
    s_waitcnt vmcnt(4)
    ds_write_b128 v9, v[44:47] offset:384
    v_bitop3_b32 v57, v57, v44, v12 bitop3:0xf6
    v_bitop3_b32 v57, v57, v46, v14 bitop3:0xf6
L_nob_17:
    s_waitcnt vmcnt(3)
    ds_write_b128 v8, v[16:19] offset:0
    v_bitop3_b32 v57, v57, v16, v12 bitop3:0xf6
    v_bitop3_b32 v57, v57, v18, v14 bitop3:0xf6
    s_waitcnt vmcnt(2)
    ds_write_b128 v8, v[20:23] offset:128
    v_bitop3_b32 v57, v57, v20, v12 bitop3:0xf6
    v_bitop3_b32 v57, v57, v22, v14 bitop3:0xf6
    s_waitcnt vmcnt(1)
    ds_write_b128 v8, v[24:27] offset:256
    v_bitop3_b32 v57, v57, v24, v12 bitop3:0xf6
    v_bitop3_b32 v57, v57, v26, v14 bitop3:0xf6
    s_nop 0
    s_waitcnt vmcnt(0)
    ds_write_b128 v8, v[28:31] offset:384
    v_bitop3_b32 v57, v57, v28, v12 bitop3:0xf6
    v_bitop3_b32 v57, v57, v30, v14 bitop3:0xf6
    v_and_b32 v57, 0x00030003, v57
    v_cmp_ne_u32 vcc, 0, v57
    s_cbranch_vccz L_po_16
    s_cmp_ge_u32 s21, 6
    s_cbranch_scc1 L_nob_18
    global_load_dwordx4 v[32:35], v2, s[56:57] offset:0 sc1
    global_load_dwordx4 v[36:39], v2, s[56:57] offset:1024 sc1
    global_load_dwordx4 v[40:43], v2, s[56:57] offset:2048 sc1
    global_load_dwordx4 v[44:47], v2, s[56:57] offset:3072 sc1
L_nob_18:
    global_load_dwordx4 v[16:19], v2, s[54:55] offset:0 sc1
    global_load_dwordx4 v[20:23], v2, s[54:55] offset:1024 sc1
    global_load_dwordx4 v[24:27], v2, s[54:55] offset:2048 sc1
    global_load_dwordx4 v[28:31], v2, s[54:55] offset:3072 sc1
    s_add_u32 s46, s46, 1
    s_cmp_lt_u32 s46, 50000
    s_cbranch_scc1 L_pa_15
    s_branch L_end
L_po_16:
    s_mov_b64 exec, 1
    ds_add_u32 v3, v76 offset:48
    s_mov_b64 exec, -1
    s_setprio 0
    ds_read_b64 v[112:113], v6 offset:0
    ds_read_b64 v[114:115], v6 offset:4624
    ds_read_b64 v[116:117], v6 offset:9248
    ds_read_b64 v[118:119], v6 offset:13872
    ds_read_b64 v[120:121], v6 offset:18496
    ds_read_b64 v[122:123], v6 offset:23120
    ds_read_b64 v[124:125], v6 offset:27744
    ds_read_b64 v[126:127], v6 offset:32368
    s_waitcnt lgkmcnt(7)
    v_exp_f16 v96, v112
    v_exp_f16_sdwa v97, v112 dst_sel:DWORD dst_unused:UNUSED_PAD src0_sel:WORD_1
    v_exp_f16_e64 v98, v113
    v_exp_f16_sdwa v99, v113 dst_sel:DWORD dst_unused:UNUSED_PAD src0_sel:WORD_1
    v_fma_mix_f32 v96, v96, v80, v80 op_sel:[0,0,0] op_sel_hi:[1,0,0]
    v_fma_mix_f32 v97, v97, v80, v80 op_sel:[0,0,0] op_sel_hi:[1,0,0]
    v_fma_mix_f32 v98, v98, v80, v80 op_sel:[0,0,0] op_sel_hi:[1,0,0]
    v_fma_mix_f32 v99, v99, v80, v80 op_sel:[0,0,0] op_sel_hi:[1,0,0]
    v_rcp_f32 v16, v96
    v_rcp_f32 v17, v97
    v_rcp_f32 v18, v98
    v_rcp_f32 v19, v99
    s_waitcnt lgkmcnt(0)
    v_exp_f16 v96, v114
    v_exp_f16_sdwa v97, v114 dst_sel:DWORD dst_unused:UNUSED_PAD src0_sel:WORD_1
    v_exp_f16_e64 v98, v115
    v_exp_f16_sdwa v99, v115 dst_sel:DWORD dst_unused:UNUSED_PAD src0_sel:WORD_1
    v_fma_mix_f32 v96, v96, v81, v81 op_sel:[0,0,0] op_sel_hi:[1,0,0]
    v_fma_mix_f32 v97, v97, v81, v81 op_sel:[0,0,0] op_sel_hi:[1,0,0]
    v_fma_mix_f32 v98, v98, v81, v81 op_sel:[0,0,0] op_sel_hi:[1,0,0]
    v_fma_mix_f32 v99, v99, v81, v81 op_sel:[0,0,0] op_sel_hi:[1,0,0]
    v_rcp_f32 v20, v96
    v_rcp_f32 v21, v97
    v_rcp_f32 v22, v98
    v_rcp_f32 v23, v99
    v_exp_f16_e64 v96, v116
    v_exp_f16_sdwa v97, v116 dst_sel:DWORD dst_unused:UNUSED_PAD src0_sel:WORD_1
    v_exp_f16_e64 v98, v117
    v_exp_f16_sdwa v99, v117 dst_sel:DWORD dst_unused:UNUSED_PAD src0_sel:WORD_1
    v_fma_mix_f32 v96, v96, v82, v82 op_sel:[0,0,0] op_sel_hi:[1,0,0]
    v_fma_mix_f32 v97, v97, v82, v82 op_sel:[0,0,0] op_sel_hi:[1,0,0]
    v_fma_mix_f32 v98, v98, v82, v82 op_sel:[0,0,0] op_sel_hi:[1,0,0]
    v_fma_mix_f32 v99, v99, v82, v82 op_sel:[0,0,0] op_sel_hi:[1,0,0]
    v_rcp_f32 v24, v96
    v_rcp_f32 v25, v97
    v_rcp_f32 v26, v98
    v_rcp_f32 v27, v99
    v_exp_f16_e64 v96, v118
    v_exp_f16_sdwa v97, v118 dst_sel:DWORD dst_unused:UNUSED_PAD src0_sel:WORD_1
    v_exp_f16_e64 v98, v119
    v_exp_f16_sdwa v99, v119 dst_sel:DWORD dst_unused:UNUSED_PAD src0_sel:WORD_1
    v_fma_mix_f32 v96, v96, v83, v83 op_sel:[0,0,0] op_sel_hi:[1,0,0]
    v_fma_mix_f32 v97, v97, v83, v83 op_sel:[0,0,0] op_sel_hi:[1,0,0]
    v_fma_mix_f32 v98, v98, v83, v83 op_sel:[0,0,0] op_sel_hi:[1,0,0]
    v_fma_mix_f32 v99, v99, v83, v83 op_sel:[0,0,0] op_sel_hi:[1,0,0]
    v_rcp_f32 v28, v96
    v_rcp_f32 v29, v97
    v_rcp_f32 v30, v98
    v_rcp_f32 v31, v99
    v_exp_f16_e64 v96, v120
    v_exp_f16_sdwa v97, v120 dst_sel:DWORD dst_unused:UNUSED_PAD src0_sel:WORD_1
    v_exp_f16_e64 v98, v121
    v_exp_f16_sdwa v99, v121 dst_sel:DWORD dst_unused:UNUSED_PAD src0_sel:WORD_1
    v_fma_mix_f32 v96, v96, v84, v84 op_sel:[0,0,0] op_sel_hi:[1,0,0]
    v_fma_mix_f32 v97, v97, v84, v84 op_sel:[0,0,0] op_sel_hi:[1,0,0]
    v_fma_mix_f32 v98, v98, v84, v84 op_sel:[0,0,0] op_sel_hi:[1,0,0]
    v_fma_mix_f32 v99, v99, v84, v84 op_sel:[0,0,0] op_sel_hi:[1,0,0]
    v_rcp_f32 v32, v96
    v_rcp_f32 v33, v97
    v_rcp_f32 v34, v98
    v_rcp_f32 v35, v99
    v_exp_f16_e64 v96, v122
    v_exp_f16_sdwa v97, v122 dst_sel:DWORD dst_unused:UNUSED_PAD src0_sel:WORD_1
    v_exp_f16_e64 v98, v123
    v_exp_f16_sdwa v99, v123 dst_sel:DWORD dst_unused:UNUSED_PAD src0_sel:WORD_1
    v_fma_mix_f32 v96, v96, v85, v85 op_sel:[0,0,0] op_sel_hi:[1,0,0]
    v_fma_mix_f32 v97, v97, v85, v85 op_sel:[0,0,0] op_sel_hi:[1,0,0]
    v_fma_mix_f32 v98, v98, v85, v85 op_sel:[0,0,0] op_sel_hi:[1,0,0]
    v_fma_mix_f32 v99, v99, v85, v85 op_sel:[0,0,0] op_sel_hi:[1,0,0]
    v_rcp_f32 v36, v96
    v_rcp_f32 v37, v97
    v_rcp_f32 v38, v98
    v_rcp_f32 v39, v99
    v_exp_f16_e64 v96, v124
    v_exp_f16_sdwa v97, v124 dst_sel:DWORD dst_unused:UNUSED_PAD src0_sel:WORD_1
    v_exp_f16_e64 v98, v125
    v_exp_f16_sdwa v99, v125 dst_sel:DWORD dst_unused:UNUSED_PAD src0_sel:WORD_1
    v_fma_mix_f32 v96, v96, v86, v86 op_sel:[0,0,0] op_sel_hi:[1,0,0]
    v_fma_mix_f32 v97, v97, v86, v86 op_sel:[0,0,0] op_sel_hi:[1,0,0]
    v_fma_mix_f32 v98, v98, v86, v86 op_sel:[0,0,0] op_sel_hi:[1,0,0]
    v_fma_mix_f32 v99, v99, v86, v86 op_sel:[0,0,0] op_sel_hi:[1,0,0]
    v_rcp_f32 v40, v96
    v_rcp_f32 v41, v97
    v_rcp_f32 v42, v98
    v_rcp_f32 v43, v99
    v_exp_f16_e64 v96, v126
    v_exp_f16_sdwa v97, v126 dst_sel:DWORD dst_unused:UNUSED_PAD src0_sel:WORD_1
    v_exp_f16_e64 v98, v127
    v_exp_f16_sdwa v99, v127 dst_sel:DWORD dst_unused:UNUSED_PAD src0_sel:WORD_1
    v_fma_mix_f32 v96, v96, v87, v87 op_sel:[0,0,0] op_sel_hi:[1,0,0]
    v_fma_mix_f32 v97, v97, v87, v87 op_sel:[0,0,0] op_sel_hi:[1,0,0]
    v_fma_mix_f32 v98, v98, v87, v87 op_sel:[0,0,0] op_sel_hi:[1,0,0]
    v_fma_mix_f32 v99, v99, v87, v87 op_sel:[0,0,0] op_sel_hi:[1,0,0]
    v_rcp_f32 v44, v96
    v_rcp_f32 v45, v97
    v_rcp_f32_e64 v46, v98
    v_rcp_f32_e64 v47, v99
    s_mov_b32 s46, 0
L_sp_19:
    ds_read_b64 v[100:101], v3 offset:32
    s_waitcnt lgkmcnt(0)
    v_cmp_eq_u32 vcc, 0, v100
    s_cbranch_vccz L_spd_20
    s_add_u32 s46, s46, 1
    s_sleep 1
    s_cmp_lt_u32 s46, 400000
    s_cbranch_scc1 L_sp_19
    s_branch L_end
L_spd_20:
    s_mov_b64 s[4:5], -1
    s_mov_b64 s[6:7], -1
    s_mov_b64 s[8:9], -1
    s_mov_b64 s[10:11], -1
    v_readfirstlane_b32 s40, v100
    s_andn2_b32 s40, 2047, s40
    s_lshr_b32 s41, s40, 8
    s_cmp_lg_u32 s41, s20
    s_cbranch_scc1 L_nomk_21
    s_bfe_u32 s41, s40, 0x20002
    s_bfe_u32 s42, s40, 0x40004
    s_lshl4_add_u32 s41, s41, s42
    s_lshl_b64 s[42:43], 1, s41
    s_and_b32 s40, s40, 3
    s_cmp_eq_u32 s40, 0
    s_cselect_b64 s[44:45], s[42:43], 0
    s_andn2_b64 s[4:5], s[4:5], s[44:45]
    s_cmp_eq_u32 s40, 1
    s_cselect_b64 s[44:45], s[42:43], 0
    s_andn2_b64 s[6:7], s[6:7], s[44:45]
    s_cmp_eq_u32 s40, 2
    s_cselect_b64 s[44:45], s[42:43], 0
    s_andn2_b64 s[8:9], s[8:9], s[44:45]
    s_cmp_eq_u32 s40, 3
    s_cselect_b64 s[44:45], s[42:43], 0
    s_andn2_b64 s[10:11], s[10:11], s[44:45]
L_nomk_21:
    v_readfirstlane_b32 s40, v101
    s_andn2_b32 s40, 2047, s40
    s_lshr_b32 s41, s40, 8
    s_cmp_lg_u32 s41, s20
    s_cbranch_scc1 L_nomk_22
    s_bfe_u32 s41, s40, 0x20002
    s_bfe_u32 s42, s40, 0x40004
    s_lshl4_add_u32 s41, s41, s42
    s_lshl_b64 s[42:43], 1, s41
    s_and_b32 s40, s40, 3
    s_cmp_eq_u32 s40, 0
    s_cselect_b64 s[44:45], s[42:43], 0
    s_andn2_b64 s[4:5], s[4:5], s[44:45]
    s_cmp_eq_u32 s40, 1
    s_cselect_b64 s[44:45], s[42:43], 0
    s_andn2_b64 s[6:7], s[6:7], s[44:45]
    s_cmp_eq_u32 s40, 2
    s_cselect_b64 s[44:45], s[42:43], 0
    s_andn2_b64 s[8:9], s[8:9], s[44:45]
    s_cmp_eq_u32 s40, 3
    s_cselect_b64 s[44:45], s[42:43], 0
    s_andn2_b64 s[10:11], s[10:11], s[44:45]
L_nomk_22:
    s_setprio 1
    s_mov_b32 s46, 0
L_sp_23:
    ds_read_b32 v96, v10 offset:64
    s_waitcnt lgkmcnt(0)
    v_cmp_gt_u32 vcc, 8, v96
    s_cbranch_vccz L_spd_24
    s_add_u32 s46, s46, 1
    s_sleep 1
    s_cmp_lt_u32 s46, 400000
    s_cbranch_scc1 L_sp_23
    s_branch L_end
    s_nop 0
L_spd_24:
    ds_read_b64 v[48:49], v5 offset:0
    ds_read_b64 v[50:51], v5 offset:14416
    ds_read_b64 v[52:53], v5 offset:28832
    ds_read_b64 v[54:55], v5 offset:43248
    ds_read_b64 v[56:57], v11 offset:0
    ds_read_b64 v[58:59], v11 offset:14416
    ds_read_b64 v[60:61], v11 offset:28832
    ds_read_b64 v[62:63], v11 offset:43248
    s_waitcnt lgkmcnt(6)
    v_fma_mix_f32 v16, v48, v16, v92 op_sel:[0,0,0] op_sel_hi:[1,0,0]
    v_fma_mix_f32 v20, v50, v20, v92 op_sel:[0,0,0] op_sel_hi:[1,0,0]
    s_waitcnt lgkmcnt(4)
    v_fma_mix_f32 v24, v52, v24, v92 op_sel:[0,0,0] op_sel_hi:[1,0,0]
    v_fma_mix_f32 v28, v54, v28, v92 op_sel:[0,0,0] op_sel_hi:[1,0,0]
    s_waitcnt lgkmcnt(2)
    v_fma_mix_f32 v32, v56, v32, v92 op_sel:[0,0,0] op_sel_hi:[1,0,0]
    v_fma_mix_f32 v36, v58, v36, v92 op_sel:[0,0,0] op_sel_hi:[1,0,0]
    s_waitcnt lgkmcnt(0)
    v_fma_mix_f32 v40, v60, v40, v92 op_sel:[0,0,0] op_sel_hi:[1,0,0]
    v_fma_mix_f32 v44, v62, v44, v92 op_sel:[0,0,0] op_sel_hi:[1,0,0]
    v_fma_mix_f32 v16, v112, v16, v88 op_sel:[0,0,0] op_sel_hi:[1,0,0]
    v_fma_mix_f32 v20, v114, v20, v88 op_sel:[0,0,0] op_sel_hi:[1,0,0]
    v_fma_mix_f32 v24, v116, v24, v88 op_sel:[0,0,0] op_sel_hi:[1,0,0]
    v_fma_mix_f32 v28, v118, v28, v88 op_sel:[0,0,0] op_sel_hi:[1,0,0]
    v_fma_mix_f32 v32, v120, v32, v88 op_sel:[0,0,0] op_sel_hi:[1,0,0]
    v_fma_mix_f32 v36, v122, v36, v88 op_sel:[0,0,0] op_sel_hi:[1,0,0]
    v_fma_mix_f32 v40, v124, v40, v88 op_sel:[0,0,0] op_sel_hi:[1,0,0]
    v_fma_mix_f32 v44, v126, v44, v88 op_sel:[0,0,0] op_sel_hi:[1,0,0]
    v_cvt_pk_bf16_f32 v64, v16, v20
    v_cvt_pk_bf16_f32 v65, v24, v28
    v_cvt_pk_bf16_f32 v66, v32, v36
    v_cvt_pk_bf16_f32 v67, v40, v44
    s_mov_b64 exec, s[4:5]
    global_store_dwordx4 v4, v[64:67], s[28:29] offset:-4096
    s_mov_b64 exec, -1
    v_fma_mix_f32 v17, v48, v17, v93 op_sel:[1,0,0] op_sel_hi:[1,0,0]
    v_fma_mix_f32 v21, v50, v21, v93 op_sel:[1,0,0] op_sel_hi:[1,0,0]
    v_fma_mix_f32 v25, v52, v25, v93 op_sel:[1,0,0] op_sel_hi:[1,0,0]
    v_fma_mix_f32 v29, v54, v29, v93 op_sel:[1,0,0] op_sel_hi:[1,0,0]
    v_fma_mix_f32 v33, v56, v33, v93 op_sel:[1,0,0] op_sel_hi:[1,0,0]
    v_fma_mix_f32 v37, v58, v37, v93 op_sel:[1,0,0] op_sel_hi:[1,0,0]
    v_fma_mix_f32 v41, v60, v41, v93 op_sel:[1,0,0] op_sel_hi:[1,0,0]
    v_fma_mix_f32 v45, v62, v45, v93 op_sel:[1,0,0] op_sel_hi:[1,0,0]
    v_fma_mix_f32 v17, v112, v17, v89 op_sel:[1,0,0] op_sel_hi:[1,0,0]
    v_fma_mix_f32 v21, v114, v21, v89 op_sel:[1,0,0] op_sel_hi:[1,0,0]
    v_fma_mix_f32 v25, v116, v25, v89 op_sel:[1,0,0] op_sel_hi:[1,0,0]
    v_fma_mix_f32 v29, v118, v29, v89 op_sel:[1,0,0] op_sel_hi:[1,0,0]
    v_fma_mix_f32 v33, v120, v33, v89 op_sel:[1,0,0] op_sel_hi:[1,0,0]
    v_fma_mix_f32 v37, v122, v37, v89 op_sel:[1,0,0] op_sel_hi:[1,0,0]
    v_fma_mix_f32 v41, v124, v41, v89 op_sel:[1,0,0] op_sel_hi:[1,0,0]
    v_fma_mix_f32 v45, v126, v45, v89 op_sel:[1,0,0] op_sel_hi:[1,0,0]
    v_cvt_pk_bf16_f32 v68, v17, v21
    v_cvt_pk_bf16_f32 v69, v25, v29
    v_cvt_pk_bf16_f32 v70, v33, v37
    v_cvt_pk_bf16_f32 v71, v41, v45
    s_mov_b64 exec, s[6:7]
    global_store_dwordx4 v4, v[68:71], s[28:29] offset:-2048
    s_mov_b64 exec, -1
    v_fma_mix_f32 v18, v49, v18, v94 op_sel:[0,0,0] op_sel_hi:[1,0,0]
    v_fma_mix_f32 v22, v51, v22, v94 op_sel:[0,0,0] op_sel_hi:[1,0,0]
    v_fma_mix_f32 v26, v53, v26, v94 op_sel:[0,0,0] op_sel_hi:[1,0,0]
    v_fma_mix_f32 v30, v55, v30, v94 op_sel:[0,0,0] op_sel_hi:[1,0,0]
    v_fma_mix_f32 v34, v57, v34, v94 op_sel:[0,0,0] op_sel_hi:[1,0,0]
    v_fma_mix_f32 v38, v59, v38, v94 op_sel:[0,0,0] op_sel_hi:[1,0,0]
    v_fma_mix_f32 v42, v61, v42, v94 op_sel:[0,0,0] op_sel_hi:[1,0,0]
    v_fma_mix_f32 v46, v63, v46, v94 op_sel:[0,0,0] op_sel_hi:[1,0,0]
    v_fma_mix_f32 v18, v113, v18, v90 op_sel:[0,0,0] op_sel_hi:[1,0,0]
    v_fma_mix_f32 v22, v115, v22, v90 op_sel:[0,0,0] op_sel_hi:[1,0,0]
    v_fma_mix_f32 v26, v117, v26, v90 op_sel:[0,0,0] op_sel_hi:[1,0,0]
    v_fma_mix_f32 v30, v119, v30, v90 op_sel:[0,0,0] op_sel_hi:[1,0,0]
    v_fma_mix_f32 v34, v121, v34, v90 op_sel:[0,0,0] op_sel_hi:[1,0,0]
    v_fma_mix_f32 v38, v123, v38, v90 op_sel:[0,0,0] op_sel_hi:[1,0,0]
    v_fma_mix_f32 v42, v125, v42, v90 op_sel:[0,0,0] op_sel_hi:[1,0,0]
    v_fma_mix_f32 v46, v127, v46, v90 op_sel:[0,0,0] op_sel_hi:[1,0,0]
    v_cvt_pk_bf16_f32 v72, v18, v22
    v_cvt_pk_bf16_f32 v73, v26, v30
    v_cvt_pk_bf16_f32 v74, v34, v38
    v_cvt_pk_bf16_f32 v75, v42, v46
    s_mov_b64 exec, s[8:9]
    global_store_dwordx4 v4, v[72:75], s[28:29] offset:0
    s_mov_b64 exec, -1
    v_fma_mix_f32 v19, v49, v19, v95 op_sel:[1,0,0] op_sel_hi:[1,0,0]
    v_fma_mix_f32 v23, v51, v23, v95 op_sel:[1,0,0] op_sel_hi:[1,0,0]
    v_fma_mix_f32 v27, v53, v27, v95 op_sel:[1,0,0] op_sel_hi:[1,0,0]
    v_fma_mix_f32 v31, v55, v31, v95 op_sel:[1,0,0] op_sel_hi:[1,0,0]
    v_fma_mix_f32 v35, v57, v35, v95 op_sel:[1,0,0] op_sel_hi:[1,0,0]
    v_fma_mix_f32 v39, v59, v39, v95 op_sel:[1,0,0] op_sel_hi:[1,0,0]
    v_fma_mix_f32 v43, v61, v43, v95 op_sel:[1,0,0] op_sel_hi:[1,0,0]
    v_fma_mix_f32 v47, v63, v47, v95 op_sel:[1,0,0] op_sel_hi:[1,0,0]
    v_fma_mix_f32 v19, v113, v19, v91 op_sel:[1,0,0] op_sel_hi:[1,0,0]
    v_fma_mix_f32 v23, v115, v23, v91 op_sel:[1,0,0] op_sel_hi:[1,0,0]
    v_fma_mix_f32 v27, v117, v27, v91 op_sel:[1,0,0] op_sel_hi:[1,0,0]
    v_fma_mix_f32 v31, v119, v31, v91 op_sel:[1,0,0] op_sel_hi:[1,0,0]
    v_fma_mix_f32 v35, v121, v35, v91 op_sel:[1,0,0] op_sel_hi:[1,0,0]
    v_fma_mix_f32 v39, v123, v39, v91 op_sel:[1,0,0] op_sel_hi:[1,0,0]
    v_fma_mix_f32 v43, v125, v43, v91 op_sel:[1,0,0] op_sel_hi:[1,0,0]
    v_fma_mix_f32 v47, v127, v47, v91 op_sel:[1,0,0] op_sel_hi:[1,0,0]
    v_cvt_pk_bf16_f32 v76, v19, v23
    v_cvt_pk_bf16_f32 v77, v27, v31
    v_cvt_pk_bf16_f32 v78, v35, v39
    v_cvt_pk_bf16_f32 v79, v43, v47
    s_mov_b64 exec, s[10:11]
    global_store_dwordx4 v4, v[76:79], s[28:29] offset:2048
    s_mov_b64 exec, -1
    s_or_b32 s40, s2, s3
    s_cbranch_scc1 L_fin
    s_add_u32 s40, s47, 1
    v_mov_b32 v5, s40
    s_mov_b64 exec, 1
    global_store_dword v3, v5, s[32:33]
    s_branch L_fin
    s_nop 0
L_exp:
    v_lshrrev_b32 v20, 4, v1
    v_and_b32 v21, 240, v2
    v_lshrrev_b32 v22, 5, v1
    v_and_b32 v23, 1, v20
    v_lshl_add_u32 v4, v22, 4, v23
    v_mul_u32_u24 v4, 7168, v4
    v_add_u32_e64 v4, v4, v21
    v_lshl_add_u32 v5, v22, 3, v23
    v_lshl_add_u32 v5, v5, 11, v21
    v_lshrrev_b32 v19, 1, v21
    v_and_b32 v23, 3, v1
    v_mul_u32_u24 v14, 0x5555, v23
    v_lshlrev_b32 v23, 3, v23
    v_lshl_add_u32 v17, v20, 5, v23
    v_and_b32 v22, 8, v1
    v_lshl_add_u32 v11, v22, 6, v17
    v_bfe_i32 v9, v1, 2, 1
    v_lshrrev_b32 v7, 16, v9
    v_lshlrev_b32 v9, 16, v9
    v_xor_b32 v6, 0xffff, v7
    v_xor_b32 v8, 0xffff0000, v9
    v_and_b32 v23, 512, v2
    v_lshl_add_u32 v23, v21, 1, v23
    v_and_b32_e64 v22, 16, v1
    s_lshl_b32 s40, s34, 10
    v_add3_u32 v10, v22, v23, s40
    s_bitcmp1_b32 s35, 0
    s_cselect_b64 s[48:49], s[24:25], s[22:23]
    s_lshr_b32 s40, s35, 1
    s_lshl2_add_u32 s40, s40, s34
    s_lshl_b32 s41, s40, 7
    v_add_u32 v17, s41, v17
    s_mul_i32 s40, s40, 458752
    s_mul_i32 s41, s36, 37
    s_lshr_b32 s41, s41, 8
    s_mul_i32 s42, s41, 7
    s_sub_u32 s7, s36, s42
    s_lshl_b32 s41, s41, 2
    s_lshr_b32 s41, 0x2031, s41
    s_and_b32 s41, s41, 3
    s_lshl2_add_u32 s7, s7, s41
    s_lshl_b32 s41, s7, 8
    s_add_u32 s40, s40, s41
    s_add_u32 s48, s48, s40
    s_addc_u32 s49, s49, 0
    s_add_u32 s10, s48, 229376
    s_addc_u32 s11, s49, 0
    s_add_u32 s30, s32, 32768
    s_addc_u32 s31, s33, 0
    s_lshl2_add_u32 s40, s7, s34
    s_lshl_b32 s40, s40, 16
    s_lshl_b32 s41, s35, 8
    s_add_u32 s40, s40, s41
    s_add_u32 s40, s40, 4096
    s_add_u32 s50, s26, s40
    s_addc_u32 s51, s27, 0
    s_add_u32 s52, s50, 32768
    s_addc_u32 s53, s51, 0
    s_add_u32 s12, s50, 8192
    s_addc_u32 s13, s51, 0
    s_add_u32 s14, s52, 8192
    s_addc_u32 s15, s53, 0
    s_lshl_b32 s40, s2, 7
    s_add_u32 s40, s40, 98304
    s_add_u32 s54, s32, s40
    s_addc_u32 s55, s33, 0
    s_lshl_b32 s40, s36, 10
    s_lshl2_add_u32 s40, s35, s40
    s_add_u32 s40, s40, 98304
    s_add_u32 s56, s32, s40
    s_addc_u32 s57, s33, 0
    s_lshl_b32 s40, s2, 10
    s_add_u32 s40, s40, 131072
    s_add_u32 s58, s32, s40
    s_addc_u32 s59, s33, 0
    s_lshl_b32 s40, s36, 13
    s_lshl_b32 s41, s34, 7
    s_add_u32 s40, s40, s41
    s_add_u32 s40, s40, 135168
    s_add_u32 s60, s32, s40
    s_addc_u32 s61, s33, 0
    s_mul_i32 s40, s35, 28
    s_add_u32 s40, s40, s36
    s_lshl_b32 s40, s40, 10
    s_add_u32 s40, s40, 524288
    s_add_u32 s62, s32, s40
    s_addc_u32 s63, s33, 0
    s_setprio 3
    s_lshl_b32 s40, s34, 7
    v_mov_b32 v16, s40
    s_mov_b32 s46, 0
L_sp_25:
    ds_read_b64 v[22:23], v3 offset:40
    s_waitcnt lgkmcnt(0)
    v_cmp_eq_u32_e64 vcc, 0, v23
    s_cbranch_vccz L_spd_26
    s_add_u32 s46, s46, 1
    s_cmp_lt_u32 s46, 400000
    s_cbranch_scc1 L_sp_25
    s_branch L_end
L_spd_26:
    v_readfirstlane_b32 s39, v22
    s_and_b32 s40, s39, 1
    s_mul_i32 s40, s40, 0x01010101
    s_and_b32 s41, s39, 0xfefefefe
    s_or_b32 s41, s41, s40
    v_bfe_u32 v28, s41, v11, 8
    v_lshrrev_b32 v29, v2, s41
    v_lshrrev_b32 v30, 8, v29
    s_cmp_ge_u32 s36, 28
    s_cbranch_scc1 L_noexp
    global_load_dwordx4 v[32:35], v4, s[48:49] nt
    s_add_u32 s48, s48, 14336
    s_addc_u32 s49, s49, 0
    global_load_dwordx4 v[36:39], v4, s[10:11] nt
    s_add_u32 s10, s10, 14336
    s_addc_u32 s11, s11, 0
    global_load_dwordx4 v[40:43], v4, s[48:49] nt
    s_add_u32 s48, s48, 14336
    s_addc_u32 s49, s49, 0
    global_load_dwordx4 v[44:47], v4, s[10:11] nt
    s_add_u32 s10, s10, 14336
    s_addc_u32 s11, s11, 0
    s_cmp_lg_u32 s34, 0
    s_cbranch_scc1 L_warm_27
    s_load_dword s8, s[54:55], 0 glc
L_warm_27:
    v_and_b32 v18, 128, v2
    v_lshl_add_u32 v18, v16, 1, v18
    global_load_dword v31, v18, s[62:63]
    s_waitcnt vmcnt(4)
    s_nop 0
    global_load_dwordx4 v[48:51], v4, s[48:49] nt
    s_add_u32 s48, s48, 14336
    s_addc_u32 s49, s49, 0
    s_waitcnt vmcnt(4)
    global_load_dwordx4 v[52:55], v4, s[10:11] nt
    s_add_u32 s10, s10, 14336
    s_addc_u32 s11, s11, 0
    s_waitcnt vmcnt(4)
    global_load_dwordx4 v[56:59], v4, s[48:49] nt
    s_add_u32 s48, s48, 14336
    s_addc_u32 s49, s49, 0
    s_waitcnt vmcnt(4)
    global_load_dwordx4 v[60:63], v4, s[10:11] nt
    s_add_u32 s10, s10, 14336
    s_addc_u32 s11, s11, 0
    s_waitcnt vmcnt(3)
    global_load_dwordx4 v[64:67], v4, s[48:49] nt
    s_add_u32 s48, s48, 14336
    s_addc_u32 s49, s49, 0
    s_waitcnt vmcnt(3)
    global_load_dwordx4 v[68:71], v4, s[10:11] nt
    s_add_u32 s10, s10, 14336
    s_addc_u32 s11, s11, 0
    s_waitcnt vmcnt(3)
    global_load_dwordx4 v[72:75], v4, s[48:49] nt
    s_add_u32 s48, s48, 14336
    s_addc_u32 s49, s49, 0
    s_waitcnt vmcnt(3)
    global_load_dwordx4 v[76:79], v4, s[10:11] nt
    s_add_u32 s10, s10, 14336
    s_addc_u32 s11, s11, 0
    s_waitcnt vmcnt(4)
    global_load_dwordx4 v[80:83], v4, s[48:49] nt
    s_add_u32 s48, s48, 14336
    s_addc_u32 s49, s49, 0
    s_waitcnt vmcnt(5)
    global_load_dwordx4 v[84:87], v4, s[10:11] nt
    s_add_u32 s10, s10, 14336
    s_addc_u32 s11, s11, 0
    s_waitcnt vmcnt(6)
    global_load_dwordx4 v[88:91], v4, s[48:49] nt
    s_waitcnt vmcnt(7)
    global_load_dwordx4 v[92:95], v4, s[10:11] nt
    s_mov_b32 s46, 0
L_sp_28:
    ds_read_b64 v[24:25], v19 offset:128
    s_waitcnt lgkmcnt(0)
    v_cmp_eq_u32 vcc, 0, v24
    s_cbranch_vccz L_spd_29
    s_add_u32 s46, s46, 1
    s_sleep 1
    s_cmp_lt_u32 s46, 400000
    s_cbranch_scc1 L_sp_28
    s_branch L_end
    s_nop 0
L_spd_29:
    v_max_u32_dpp v27, v25, v25 quad_perm:[1,0,3,2] row_mask:0xf bank_mask:0xf
    v_min_u32_dpp v26, v24, v24 quad_perm:[1,0,3,2] row_mask:0xf bank_mask:0xf
    v_max_u32 v25, v26, v27
    v_max_u32_dpp v24, v24, v24 quad_perm:[1,0,3,2] row_mask:0xf bank_mask:0xf
    s_nop 0
    v_max_u32_dpp v27, v25, v25 quad_perm:[2,3,0,1] row_mask:0xf bank_mask:0xf
    v_min_u32_dpp v26, v24, v24 quad_perm:[2,3,0,1] row_mask:0xf bank_mask:0xf
    v_max_u32 v25, v26, v27
    v_max_u32_dpp v24, v24, v24 quad_perm:[2,3,0,1] row_mask:0xf bank_mask:0xf
    s_nop 0
    v_max_u32_dpp v27, v25, v25 row_half_mirror row_mask:0xf bank_mask:0xf
    v_min_u32_dpp v26, v24, v24 row_half_mirror row_mask:0xf bank_mask:0xf
    v_max_u32 v25, v26, v27
    v_max_u32_dpp v24, v24, v24 row_half_mirror row_mask:0xf bank_mask:0xf
    s_nop 0
    v_max_u32_dpp v27, v25, v25 row_mirror row_mask:0xf bank_mask:0xf
    v_min_u32_dpp v26, v24, v24 row_mirror row_mask:0xf bank_mask:0xf
    v_max_u32_e64 v25, v26, v27
    v_max_u32_dpp v24, v24, v24 row_mirror row_mask:0xf bank_mask:0xf
    s_mov_b32 vcc_lo, 0xff00ff00
    s_mov_b32 vcc_hi, 0xff00ff00
    s_movk_i32 s40, 2047
    v_cndmask_b32 v16, v24, v25, vcc
    v_bfi_b32 v18, v16, 0, s40
    v_lshl_add_u32 v17, v18, 11, v17
    v_lshlrev_b32_e64 v18, 3, v18
    global_load_dwordx2 v[20:21], v17, s[4:5]
    global_load_dword v22, v18, s[30:31] sc1
    global_load_dwordx4 v[96:99], v5, s[50:51] offset:-4096 nt
    global_load_dwordx4 v[100:103], v5, s[52:53] offset:-4096 nt
    s_mov_b64 exec, 1
    ds_write_b64 v3, v[24:25] offset:32
    s_mov_b64 exec, -1
    v_readfirstlane_b32 s16, v24
    v_readfirstlane_b32 s17, v25
    s_cmp_eq_u32 s34, 0
    s_cselect_b32 s16, s16, s17
    s_andn2_b32 s17, 2047, s16
    s_lshr_b32 s40, s17, 8
    s_add_u32 s41, s40, 2
    s_bfe_u32 s19, s41, 0x10002
    s_xor_b32 s19, s19, s38
    s_and_b32 s42, s34, 2
    s_or_b32 s19, s19, s42
    s_cmp_eq_u32 s38, 0
    s_cselect_b32 s18, s40, s41
    s_and_b32 s18, s18, 3
    s_mul_i32 s40, s35, 28672
    s_and_b32 s41, s34, 1
    s_lshl_b32 s41, s41, 9
    s_add_u32 s40, s40, s41
    s_and_b32 s41, s36, 15
    s_lshl_b32 s41, s41, 5
    s_add_u32 s40, s40, s41
    s_add_u32 s40, s40, 524288
    s_add_u32 s22, s32, s40
    s_addc_u32 s23, s33, 0
    s_add_u32 s24, s22, 262144
    s_nop 0
    s_addc_u32 s25, s23, 0
    s_bfe_u32 s40, s17, 0x20002
    s_bfe_u32 s41, s17, 0x40004
    s_lshl4_add_u32 s40, s40, s41
    s_and_b32 s41, s17, 3
    s_lshl2_add_u32 s40, s40, s41
    s_lshl_b32 s41, s18, 8
    s_add_u32 s40, s40, s41
    s_lshl_b32 s40, s40, 1
    s_add_u32 s20, s40, 52096
    s_bitcmp1_b32 s16, 31
    s_brev_b32 s40, 1
    s_cselect_b32 s40, s40, -1
    s_xor_b32 s40, s40, s16
    s_and_b32 s21, s40, 0xffff0000
    v_mov_b32 v0, 1
    s_waitcnt vmcnt(2)
    v_and_b32 v17, 0xffff0000, v22
    v_rcp_f32 v17, v17
    v_lshlrev_b32 v22, 16, v22
    v_lshlrev_b32_e64 v24, 16, v20
    v_and_b32 v25, 0xffff0000, v20
    v_mul_f32 v22, -v22, v17
    v_lshlrev_b32_e64 v26, 16, v21
    v_and_b32 v27, 0xffff0000, v21
    v_fma_f32 v24, v24, v17, v22
    v_fma_f32 v25, v25, v17, v22
    v_fma_f32 v26, v26, v17, v22
    v_fma_f32 v27, v27, v17, v22
    v_cvt_pk_bf16_f32 v12, v24, v25
    v_cvt_pk_bf16_f32 v13, v26, v27
    v_mov_b32 v24, 0
    v_mov_b32 v25, 0
    v_mov_b32 v26, 0
    v_mov_b32 v27, 0
    v_and_b32_dpp v16, v12, v6 quad_perm:[0,0,0,0] row_mask:0xf bank_mask:0xf
    v_and_b32_dpp v17, v12, v7 quad_perm:[0,0,0,0] row_mask:0xf bank_mask:0xf
    v_and_b32_dpp v18, v12, v8 quad_perm:[0,0,0,0] row_mask:0xf bank_mask:0xf
    v_and_b32_dpp v19, v12, v9 quad_perm:[0,0,0,0] row_mask:0xf bank_mask:0xf
    v_and_b32_dpp v20, v13, v6 quad_perm:[0,0,0,0] row_mask:0xf bank_mask:0xf
    v_and_b32_dpp v21, v13, v7 quad_perm:[0,0,0,0] row_mask:0xf bank_mask:0xf
    v_and_b32_dpp v22, v13, v8 quad_perm:[0,0,0,0] row_mask:0xf bank_mask:0xf
    v_and_b32_dpp v23, v13, v9 quad_perm:[0,0,0,0] row_mask:0xf bank_mask:0xf
    v_smfmac_f32_16x16x64_bf16 v[24:27], v[16:19], v[32:39], v14
    v_and_b32_dpp v16, v12, v6 quad_perm:[1,1,1,1] row_mask:0xf bank_mask:0xf
    v_and_b32_dpp v17, v12, v7 quad_perm:[1,1,1,1] row_mask:0xf bank_mask:0xf
    v_and_b32_dpp v18, v12, v8 quad_perm:[1,1,1,1] row_mask:0xf bank_mask:0xf
    v_and_b32_dpp v19, v12, v9 quad_perm:[1,1,1,1] row_mask:0xf bank_mask:0xf
    v_smfmac_f32_16x16x64_bf16 v[24:27], v[20:23], v[40:47], v14
    global_load_dwordx4 v[104:107], v5, s[50:51] offset:0 nt
    v_and_b32_dpp v20, v13, v6 quad_perm:[1,1,1,1] row_mask:0xf bank_mask:0xf
    v_and_b32_dpp v21, v13, v7 quad_perm:[1,1,1,1] row_mask:0xf bank_mask:0xf
    v_and_b32_dpp v22, v13, v8 quad_perm:[1,1,1,1] row_mask:0xf bank_mask:0xf
    v_and_b32_dpp v23, v13, v9 quad_perm:[1,1,1,1] row_mask:0xf bank_mask:0xf
    s_mov_b64 exec, 1
    ds_add_rtn_u32 v31, v3, v0 offset:60
    s_mov_b64 exec, -1
    v_smfmac_f32_16x16x64_bf16 v[24:27], v[16:19], v[48:55], v14
    global_load_dwordx4 v[108:111], v5, s[52:53] offset:0 nt
    v_and_b32_dpp v16, v12, v6 quad_perm:[2,2,2,2] row_mask:0xf bank_mask:0xf
    v_and_b32_dpp v17, v12, v7 quad_perm:[2,2,2,2] row_mask:0xf bank_mask:0xf
    v_and_b32_dpp v18, v12, v8 quad_perm:[2,2,2,2] row_mask:0xf bank_mask:0xf
    v_and_b32_dpp v19, v12, v9 quad_perm:[2,2,2,2] row_mask:0xf bank_mask:0xf
    v_smfmac_f32_16x16x64_bf16 v[24:27], v[20:23], v[56:63], v14
    global_load_dwordx4 v[112:115], v5, s[12:13] offset:-4096 nt
    v_and_b32_dpp v20, v13, v6 quad_perm:[2,2,2,2] row_mask:0xf bank_mask:0xf
    v_and_b32_dpp v21, v13, v7 quad_perm:[2,2,2,2] row_mask:0xf bank_mask:0xf
    v_and_b32_dpp v22, v13, v8 quad_perm:[2,2,2,2] row_mask:0xf bank_mask:0xf
    v_and_b32_dpp v23, v13, v9 quad_perm:[2,2,2,2] row_mask:0xf bank_mask:0xf
    v_smfmac_f32_16x16x64_bf16 v[24:27], v[16:19], v[64:71], v14
    global_load_dwordx4 v[116:119], v5, s[14:15] offset:-4096 nt
    v_and_b32_dpp v16, v12, v6 quad_perm:[3,3,3,3] row_mask:0xf bank_mask:0xf
    v_and_b32_dpp v17, v12, v7 quad_perm:[3,3,3,3] row_mask:0xf bank_mask:0xf
    v_and_b32_dpp v18, v12, v8 quad_perm:[3,3,3,3] row_mask:0xf bank_mask:0xf
    v_and_b32_dpp v19, v12, v9 quad_perm:[3,3,3,3] row_mask:0xf bank_mask:0xf
    s_waitcnt lgkmcnt(0)
    v_readfirstlane_b32 s40, v31
    s_cmp_lg_u32 s40, 3
    s_cbranch_scc1 L_ef_30
    v_mov_b32 v31, s39
    v_lshlrev_b32_e64 v0, 7, v1
    s_mov_b64 exec, 255
    global_store_dword v0, v31, s[56:57] sc1
    s_mov_b64 exec, -1
L_ef_30:
    v_smfmac_f32_16x16x64_bf16 v[24:27], v[20:23], v[72:79], v14
    global_load_dwordx4 v[120:123], v5, s[12:13] offset:0 nt
    v_and_b32_dpp v20, v13, v6 quad_perm:[3,3,3,3] row_mask:0xf bank_mask:0xf
    v_and_b32_dpp v21, v13, v7 quad_perm:[3,3,3,3] row_mask:0xf bank_mask:0xf
    v_and_b32_dpp v22, v13, v8 quad_perm:[3,3,3,3] row_mask:0xf bank_mask:0xf
    v_and_b32_dpp v23, v13, v9 quad_perm:[3,3,3,3] row_mask:0xf bank_mask:0xf
    v_smfmac_f32_16x16x64_bf16 v[24:27], v[16:19], v[80:87], v14
    global_load_dwordx4 v[124:127], v5, s[14:15] offset:0 nt
    v_smfmac_f32_16x16x64_bf16 v[24:27], v[20:23], v[88:95], v14
    v_mov_b32_e64 v0, 1
    s_movk_i32 s6, 255
    s_nop 5
    ds_write_b128 v10, v[24:27] offset:768
    s_mov_b64 exec, 1
    ds_add_rtn_u32 v31, v3, v0 offset:52
    s_mov_b64 exec, -1
    ds_read_b128 v[48:51], v2 offset:768
    ds_read_b128 v[52:55], v2 offset:1792
    ds_read_b128 v[56:59], v2 offset:2816
    ds_read_b128 v[60:63], v2 offset:3840
    s_waitcnt lgkmcnt(4)
    v_readfirstlane_b32 s40, v31
    s_cmp_lg_u32 s40, 3
    s_cbranch_scc1 L_ha_31
    s_waitcnt lgkmcnt(2)
    v_add_f32 v48, v48, v52
    v_add_f32 v49, v49, v53
    v_add_f32 v50, v50, v54
    v_add_f32 v51, v51, v55
    s_waitcnt lgkmcnt(0)
    v_add_f32 v56, v56, v60
    v_add_f32 v57, v57, v61
    v_add_f32 v58, v58, v62
    v_add_f32 v59, v59, v63
    v_add_f32 v48, v48, v56
    v_add_f32 v49, v49, v57
    v_add_f32 v50, v50, v58
    v_add_f32 v51, v51, v59
    v_bfi_b32 v48, s6, v29, v48
    v_bfi_b32 v50, s6, v30, v50
    global_store_dwordx4 v2, v[48:51], s[58:59] sc1
L_ha_31:
    v_mov_b32 v24, 0
    v_mov_b32 v25, 0
    v_mov_b32 v26, 0
    v_mov_b32 v27, 0
    s_cmp_lg_u32 s19, 0
    s_cbranch_scc1 L_nort_32
    v_and_b32 v75, 3, v1
    v_lshrrev_b32 v72, 5, v1
    v_lshl_add_u32 v72, v75, 1, v72
    v_lshrrev_b32 v73, 2, v1
    v_lshlrev_b32 v73, 10, v73
    v_lshl_add_u32 v73, v75, 3, v73
    v_add_u32 v74, 16384, v73
    s_lshl_b32 s40, s17, 11
    s_lshl4_add_u32 s40, s37, s40
    v_lshl_add_u32 v75, v72, 1, s40
    global_load_ushort v76, v75, s[4:5]
    v_mov_b32 v80, 0xbfb8aa3b
    v_mul_f32 v80, s21, v80
    v_exp_f32 v80, v80
    v_mov_b32 v84, v28
    v_mov_b32 v85, 0
    v_add_f32 v80, 1.0, v80
    v_rcp_f32_e64 v80, v80
    s_lshl_b32 s40, s18, 2
    v_mov_b32_e64 v81, s40
    v_mul_f32 v80, 0xbfb8aa3b, v80
    v_mul_u32_u24 v78, 14416, v72
    v_add_u32 v78, s20, v78
    s_lshl_b32 s40, s17, 1
    v_mul_u32_u24 v77, 4624, v72
    v_add_u32_e64 v77, s40, v77
    v_lshlrev_b32 v79, 2, v72
L_nort_32:
    s_mov_b32 s46, 0
L_mf_33:
    s_load_dwordx8 s[8:15], s[54:55], 0 glc
    s_add_u32 s46, s46, 1
    s_cmp_gt_u32 s46, 50000
    s_cbranch_scc1 L_end
    s_waitcnt lgkmcnt(0)
    s_xor_b32 s40, s8, s39
    s_xor_b32 s41, s9, s39
    s_or_b32 s40, s40, s41
    s_xor_b32 s41, s10, s39
    s_or_b32 s40, s40, s41
    s_xor_b32 s41, s11, s39
    s_or_b32 s40, s40, s41
    s_xor_b32 s41, s12, s39
    s_or_b32 s40, s40, s41
    s_xor_b32 s41, s13, s39
    s_or_b32 s40, s40, s41
    s_xor_b32 s41, s14, s39
    s_or_b32 s40, s40, s41
    s_xor_b32 s41, s15, s39
    s_or_b32 s40, s40, s41
    s_cbranch_scc1 L_mf_33
    s_mov_b32 s46, 0
L_hp_34:
    global_load_dwordx2 v[32:33], v11, s[60:61] offset:-4096 sc1
    global_load_dwordx2 v[34:35], v11, s[60:61] offset:-3072 sc1
    global_load_dwordx2 v[36:37], v11, s[60:61] offset:-2048 sc1
    global_load_dwordx2 v[38:39], v11, s[60:61] offset:-1024 sc1
    global_load_dwordx2 v[40:41], v11, s[60:61] offset:0 sc1
    global_load_dwordx2 v[42:43], v11, s[60:61] offset:1024 sc1
    global_load_dwordx2 v[44:45], v11, s[60:61] offset:2048 sc1
    global_load_dwordx2 v[46:47], v11, s[60:61] offset:3072 sc1
    s_add_u32 s46, s46, 1
    s_cmp_gt_u32 s46, 50000
    s_cbranch_scc1 L_end
    s_waitcnt vmcnt(7)
    v_xor_b32 v31, v28, v32
    s_waitcnt vmcnt(6)
    v_bitop3_b32 v31, v31, v34, v28 bitop3:0xf6
    s_waitcnt vmcnt(5)
    v_bitop3_b32 v31, v31, v36, v28 bitop3:0xf6
    v_add_f32 v64, v32, v36
    v_add_f32 v65, v33, v37
    s_waitcnt vmcnt(4)
    v_bitop3_b32 v31, v31, v38, v28 bitop3:0xf6
    v_add_f32 v66, v34, v38
    v_add_f32 v67, v35, v39
    s_waitcnt vmcnt(3)
    v_bitop3_b32 v31, v31, v40, v28 bitop3:0xf6
    v_add_f32 v64, v64, v40
    v_add_f32_e64 v65, v65, v41
    s_waitcnt vmcnt(2)
    v_bitop3_b32 v31, v31, v42, v28 bitop3:0xf6
    v_add_f32 v66, v66, v42
    v_add_f32 v67, v67, v43
    s_waitcnt vmcnt(1)
    v_bitop3_b32 v31, v31, v44, v28 bitop3:0xf6
    v_add_f32 v64, v64, v44
    v_add_f32 v65, v65, v45
    s_waitcnt vmcnt(0)
    v_bitop3_b32 v31, v31, v46, v28 bitop3:0xf6
    v_add_f32 v66, v66, v46
    v_add_f32 v67, v67, v47
    v_and_b32 v31, 0xff, v31
    v_cmp_ne_u32_e64 vcc, 0, v31
    v_mul_f32 v68, 0xbfb8aa3b, v64
    v_mul_f32 v69, 0xbfb8aa3b, v65
    s_cbranch_vccnz L_hp_34
    v_exp_f32 v68, v68
    v_exp_f32 v69, v69
    v_mul_f32 v64, v64, v66
    v_mul_f32 v65, v65, v67
    v_add_f32 v68, 1.0, v68
    v_add_f32 v69, 1.0, v69
    v_rcp_f32 v68, v68
    v_rcp_f32 v69, v69
    v_mul_f32 v64, v64, v68
    v_mul_f32 v65, v65, v69
    v_cvt_pk_bf16_f32 v12, v64, v65
    s_nop 1
    v_and_b32_dpp v16, v12, v6 quad_perm:[0,0,0,0] row_mask:0xf bank_mask:0xf
    v_and_b32_dpp v17, v12, v7 quad_perm:[0,0,0,0] row_mask:0xf bank_mask:0xf
    v_and_b32_dpp v18, v12, v8 quad_perm:[0,0,0,0] row_mask:0xf bank_mask:0xf
    v_and_b32_dpp v19, v12, v9 quad_perm:[0,0,0,0] row_mask:0xf bank_mask:0xf
    v_and_b32_dpp v20, v12, v6 quad_perm:[1,1,1,1] row_mask:0xf bank_mask:0xf
    v_and_b32_dpp v21, v12, v7 quad_perm:[1,1,1,1] row_mask:0xf bank_mask:0xf
    v_and_b32_dpp v22, v12, v8 quad_perm:[1,1,1,1] row_mask:0xf bank_mask:0xf
    v_and_b32_dpp v23, v12, v9 quad_perm:[1,1,1,1] row_mask:0xf bank_mask:0xf
    v_smfmac_f32_16x16x64_bf16 v[24:27], v[16:19], v[96:103], v14
    v_and_b32_dpp v16, v12, v6 quad_perm:[2,2,2,2] row_mask:0xf bank_mask:0xf
    v_and_b32_dpp v17, v12, v7 quad_perm:[2,2,2,2] row_mask:0xf bank_mask:0xf
    v_and_b32_dpp v18, v12, v8 quad_perm:[2,2,2,2] row_mask:0xf bank_mask:0xf
    v_and_b32_dpp v19, v12, v9 quad_perm:[2,2,2,2] row_mask:0xf bank_mask:0xf
    v_smfmac_f32_16x16x64_bf16 v[24:27], v[20:23], v[104:111], v14
    v_and_b32_dpp v20, v12, v6 quad_perm:[3,3,3,3] row_mask:0xf bank_mask:0xf
    v_and_b32_dpp v21, v12, v7 quad_perm:[3,3,3,3] row_mask:0xf bank_mask:0xf
    v_and_b32_dpp v22, v12, v8 quad_perm:[3,3,3,3] row_mask:0xf bank_mask:0xf
    v_and_b32_dpp v23, v12, v9 quad_perm:[3,3,3,3] row_mask:0xf bank_mask:0xf
    v_smfmac_f32_16x16x64_bf16 v[24:27], v[16:19], v[112:119], v14
    s_nop 0
    v_smfmac_f32_16x16x64_bf16 v[24:27], v[20:23], v[120:127], v14
    s_add_u32 s58, s62, 262144
    s_addc_u32 s59, s63, 0
    v_mov_b32_e64 v0, 1
    s_movk_i32 s6, 255
    s_nop 3
    ds_write_b128 v10, v[24:27] offset:768
    s_mov_b64 exec, 1
    ds_add_rtn_u32 v31, v3, v0 offset:56
    s_mov_b64 exec, -1
    ds_read_b128 v[48:51], v2 offset:768
    ds_read_b128 v[52:55], v2 offset:1792
    ds_read_b128 v[56:59], v2 offset:2816
    ds_read_b128 v[60:63], v2 offset:3840
    s_waitcnt lgkmcnt(4)
    v_readfirstlane_b32 s40, v31
    s_cmp_lg_u32 s40, 3
    s_cbranch_scc1 L_hb_35
    s_waitcnt lgkmcnt(2)
    v_add_f32 v48, v48, v52
    v_add_f32 v49, v49, v53
    v_add_f32 v50, v50, v54
    v_add_f32 v51, v51, v55
    s_waitcnt lgkmcnt(0)
    v_add_f32 v56, v56, v60
    v_add_f32 v57, v57, v61
    v_add_f32 v58, v58, v62
    v_add_f32 v59, v59, v63
    v_add_f32 v48, v48, v56
    v_add_f32 v49, v49, v57
    v_add_f32_e64 v50, v50, v58
    v_add_f32_e64 v51, v51, v59
    v_bfi_b32 v48, s6, v29, v48
    v_bfi_b32 v50, s6, v30, v50
    global_store_dwordx4 v2, v[48:51], s[62:63]
    global_store_dwordx4 v2, v[48:51], s[58:59] sc1
L_hb_35:
    s_branch L_routed
    s_nop 0
L_noexp:
    s_mov_b32 s46, 0
L_sp_36:
    ds_read_b64 v[24:25], v19 offset:128
    s_waitcnt lgkmcnt(0)
    v_cmp_eq_u32 vcc, 0, v24
    s_cbranch_vccz L_spd_37
    s_add_u32 s46, s46, 1
    s_sleep 2
    s_cmp_lt_u32 s46, 400000
    s_cbranch_scc1 L_sp_36
    s_branch L_end
L_spd_37:
    v_max_u32_dpp v27, v25, v25 quad_perm:[1,0,3,2] row_mask:0xf bank_mask:0xf
    v_min_u32_dpp v26, v24, v24 quad_perm:[1,0,3,2] row_mask:0xf bank_mask:0xf
    v_max_u32 v25, v26, v27
    v_max_u32_dpp v24, v24, v24 quad_perm:[1,0,3,2] row_mask:0xf bank_mask:0xf
    s_nop 0
    v_max_u32_dpp v27, v25, v25 quad_perm:[2,3,0,1] row_mask:0xf bank_mask:0xf
    v_min_u32_dpp v26, v24, v24 quad_perm:[2,3,0,1] row_mask:0xf bank_mask:0xf
    v_max_u32 v25, v26, v27
    v_max_u32_dpp v24, v24, v24 quad_perm:[2,3,0,1] row_mask:0xf bank_mask:0xf
    s_nop 0
    v_max_u32_dpp v27, v25, v25 row_half_mirror row_mask:0xf bank_mask:0xf
    v_min_u32_dpp v26, v24, v24 row_half_mirror row_mask:0xf bank_mask:0xf
    v_max_u32 v25, v26, v27
    v_max_u32_dpp v24, v24, v24 row_half_mirror row_mask:0xf bank_mask:0xf
    s_nop 0
    v_max_u32_dpp v27, v25, v25 row_mirror row_mask:0xf bank_mask:0xf
    v_min_u32_dpp v26, v24, v24 row_mirror row_mask:0xf bank_mask:0xf
    v_max_u32_e64 v25, v26, v27
    v_max_u32_dpp v24, v24, v24 row_mirror row_mask:0xf bank_mask:0xf
    s_mov_b64 exec, 1
    ds_write_b64 v3, v[24:25] offset:32
    s_mov_b64 exec, -1
    v_readfirstlane_b32 s16, v24
    v_readfirstlane_b32 s17, v25
    s_cmp_eq_u32 s34, 0
    s_cselect_b32 s16, s16, s17
    s_andn2_b32 s17, 2047, s16
    s_lshr_b32 s40, s17, 8
    s_add_u32 s41, s40, 2
    s_bfe_u32 s19, s41, 0x10002
    s_xor_b32 s19, s19, s38
    s_and_b32 s42, s34, 2
    s_or_b32 s19, s19, s42
    s_cmp_eq_u32 s38, 0
    s_cselect_b32 s18, s40, s41
    s_and_b32 s18, s18, 3
    s_mul_i32 s40, s35, 28672
    s_and_b32 s41, s34, 1
    s_lshl_b32 s41, s41, 9
    s_add_u32 s40, s40, s41
    s_and_b32 s41, s36, 15
    s_lshl_b32 s41, s41, 5
    s_add_u32 s40, s40, s41
    s_add_u32 s40, s40, 524288
    s_add_u32 s22, s32, s40
    s_addc_u32 s23, s33, 0
    s_add_u32 s24, s22, 262144
    s_nop 0
    s_addc_u32 s25, s23, 0
    s_bfe_u32 s40, s17, 0x20002
    s_bfe_u32 s41, s17, 0x40004
    s_lshl4_add_u32 s40, s40, s41
    s_and_b32 s41, s17, 3
    s_lshl2_add_u32 s40, s40, s41
    s_lshl_b32 s41, s18, 8
    s_add_u32 s40, s40, s41
    s_lshl_b32 s40, s40, 1
    s_add_u32 s20, s40, 52096
    s_bitcmp1_b32 s16, 31
    s_brev_b32 s40, 1
    s_cselect_b32 s40, s40, -1
    s_xor_b32 s40, s40, s16
    s_and_b32 s21, s40, 0xffff0000
    s_cmp_lg_u32 s19, 0
    s_cbranch_scc1 L_fin
    v_and_b32 v75, 3, v1
    v_lshrrev_b32 v72, 5, v1
    v_lshl_add_u32 v72, v75, 1, v72
    v_lshrrev_b32 v73, 2, v1
    v_lshlrev_b32 v73, 10, v73
    v_lshl_add_u32 v73, v75, 3, v73
    v_add_u32 v74, 16384, v73
    s_lshl_b32 s40, s17, 11
    s_lshl4_add_u32 s40, s37, s40
    v_lshl_add_u32 v75, v72, 1, s40
    global_load_ushort v76, v75, s[4:5]
    v_mov_b32 v80, 0xbfb8aa3b
    v_mul_f32 v80, s21, v80
    v_exp_f32 v80, v80
    v_mov_b32 v84, v28
    v_mov_b32 v85, 0
    v_add_f32 v80, 1.0, v80
    v_rcp_f32 v80, v80
    s_lshl_b32 s40, s18, 2
    v_mov_b32 v81, s40
    v_mul_f32 v80, 0xbfb8aa3b, v80
    v_mul_u32_u24 v78, 14416, v72
    v_add_u32 v78, s20, v78
    s_lshl_b32 s40, s17, 1
    v_mul_u32_u24 v77, 4624, v72
    v_add_u32 v77, s40, v77
    v_lshlrev_b32 v79, 2, v72
L_nort_38:
    s_mov_b32 s46, 0
L_sp_39:
    ds_read_b32 v72, v3 offset:64
    s_waitcnt lgkmcnt(0)
    v_cmp_gt_u32 vcc, 8, v72
    s_cbranch_vccz L_spd_40
    s_add_u32 s46, s46, 1
    s_sleep 4
    s_cmp_lt_u32 s46, 400000
    s_cbranch_scc1 L_sp_39
    s_branch L_end
    s_nop 0
L_spd_40:
L_routed:
    s_cmp_lg_u32 s19, 0
    s_cbranch_scc1 L_fin
    s_mov_b32 s46, 0
L_ba_41:
    global_load_dwordx2 v[82:83], v73, s[22:23] sc1
    s_mov_b32 exec_hi, 0xffff
    global_load_dwordx2 v[84:85], v74, s[22:23] sc1
    s_mov_b32 exec_hi, -1
L_bc_42:
    s_waitcnt vmcnt(0)
    v_xor_b32_e64 v31, v28, v82
    v_bitop3_b32 v31, v31, v84, v28 bitop3:0xf6
    v_and_b32 v31, 0xff, v31
    v_cmp_ne_u32 vcc, 0, v31
    v_add_f32 v86, v82, v84
    v_add_f32_e64 v87, v83, v85
    s_cbranch_vccz L_bo_43
    s_add_u32 s46, s46, 1
    s_cmp_lt_u32 s46, 24
    s_cbranch_scc1 L_ba_41
    s_cmp_gt_u32 s46, 50000
    s_cbranch_scc1 L_end
    s_sleep 2
    global_load_dwordx2 v[82:83], v73, s[24:25] sc1
    s_mov_b32 exec_hi, 0xffff
    global_load_dwordx2 v[84:85], v74, s[24:25] sc1
    s_mov_b32 exec_hi, -1
    s_branch L_bc_42
    s_nop 0
L_bo_43:
    v_lshlrev_b32 v76, 16, v76
    s_nop 0
    v_permlane32_swap_b32 v86, v87
    v_add_f32_e64 v86, v86, v87
    v_mov_b32 v87, v86
    s_mov_b32 s46, 0
    ds_read_b32 v72, v81 offset:64
    ds_read_u16 v82, v78
    ds_read_u16 v83, v77 offset:9488
    ds_read_b32 v84, v79 offset:0
    v_permlane16_swap_b32 v86, v87
    v_add_f32 v86, v86, v87
    s_nop 1
    v_add_f32_dpp v86, v86, v86 row_ror:8 row_mask:0xf bank_mask:0xf
    s_nop 1
    v_add_f32_dpp v86, v86, v86 row_ror:4 row_mask:0xf bank_mask:0xf
    s_branch L_spc_46
    s_nop 0
L_sp_44:
    ds_read_b32 v72, v81 offset:64
    ds_read_u16 v82, v78
    ds_read_u16 v83, v77 offset:9488
    ds_read_b32 v84, v79 offset:0
L_spc_46:
    s_waitcnt lgkmcnt(0)
    v_cmp_gt_u32 vcc, 8, v72
    s_cbranch_vccz L_spd_45
    s_add_u32 s46, s46, 1
    s_sleep 1
    s_cmp_lt_u32 s46, 400000
    s_cbranch_scc1 L_sp_44
    s_branch L_end
L_spd_45:
    v_fma_mix_f32 v77, v86, v80, v83 op_sel_hi:[0,0,1]
    v_exp_f32 v86, v77
    v_fma_mix_f32 v82, v82, v77, 0 op_sel_hi:[1,0,0]
    v_fma_f32 v86, v86, v84, v84
    v_rcp_f32 v86, v86
    s_mov_b32 exec_lo, 15
    s_mov_b32 exec_hi, 15
    v_fmac_f32 v76, v82, v86
    v_cvt_pk_bf16_f32 v76, v76, v76
    global_store_short v75, v76, s[28:29]
    s_branch L_fin
    s_nop 0
L_cnv:
    v_add_u32_e64 v85, s58, v2
    ds_read_b128 v[12:15], v85 offset:0
    ds_read_b128 v[4:7], v85 offset:4624
    ds_read_b128 v[16:19], v85 offset:9248
    ds_read_b128 v[20:23], v85 offset:13872
    s_mul_i32 s50, s34, 14416
    s_add_u32 s50, s50, 45952
    s_mov_b32 m0, s50
    s_mov_b32 s52, 0x3f803f80
    s_mov_b32 s54, 0x41000000
    s_mov_b32 s56, 0x43800000
    s_mov_b32 s55, 0
    s_mov_b32 s57, 0
    v_mov_b32 v88, 0
    v_mov_b32 v89, 0
    v_mov_b32 v90, 0
    v_mov_b32_e64 v91, 0
    s_mul_i32 s40, s34, 4624
    s_add_u32 s40, s40, 8960
    v_add_u32 v85, s40, v2
    s_mov_b32 exec_lo, -1
    s_mov_b32 exec_hi, 1
    ds_write_b128 v85, v[88:91]
    s_mov_b64 exec, -1
    v_mov_b32 v86, 0x3c00
    ds_write_addtid_b32 v86
    s_waitcnt lgkmcnt(0)
    s_and_b32 s41, s34, 1
    s_lshl_b32 s41, s41, 4
    s_lshr_b32 s48, s48, s41
    s_lshl_b32 s48, s48, 16
    s_lshr_b32 s51, s49, s41
    s_lshl_b32 s51, s51, 16
    v_mov_b32 v85, 0x3fb8aa3b
    v_mul_f32 v85, s48, v85
    v_exp_f32_e64 v85, v85
    v_mov_b32_e64 v26, 0
    v_cvt_pk_bf16_f32 v85, v85, v85
    v_writelane_b32 v26, s51, 0
    v_and_b32 v85, 0xffff0000, v85
    s_bitset0_b32 s51, 31
    v_mul_f32 v27, 0xbfb8aa3b, v85
    v_mul_f32 v28, 0x3e22f983, v85
    v_add_f32 v29, v85, v85
    v_mov_b32 v0, 1
    s_lshl_b32 s41, s34, 2
    v_mov_b32 v31, s41
    v_add_u32 v4, s40, v4
    v_add_u32 v16, s50, v16
    v_add_u32 v17, s50, v17
    s_sub_u32 s41, s50, s40
    s_add_u32 s41, s41, 8912
    s_and_b32 s41, s41, 255
    s_add_u32 s41, s41, s40
    s_sub_u32 s41, s41, 8704
    s_mov_b32 exec_lo, 0x0f000000
    s_mov_b32 exec_hi, 0x0f000000
    v_mov_b32 v16, s41
    s_sub_u32 s41, s50, s40
    s_add_u32 s41, s41, 8816
    s_and_b32 s41, s41, 255
    s_add_u32 s41, s41, s40
    s_sub_u32 s41, s41, 8704
    s_mov_b32 exec_lo, 0xf0000000
    s_mov_b32 exec_hi, 0xf0000000
    v_mov_b32 v16, s41
    s_mov_b64 exec, -1
    s_setprio 3
    s_waitcnt vmcnt(3)
    v_lshlrev_b32_e64 v32, 16, v8
    v_and_b32 v33, 0xffff0000, v8
    v_mul_f32 v32, 0x3fb8aa3b, v32
    v_mul_f32 v33, 0x3fb8aa3b, v33
    v_exp_f32 v32, v32
    v_exp_f32 v33, v33
    s_waitcnt vmcnt(2)
    v_lshlrev_b32 v34, 16, v9
    v_cvt_pk_bf16_f32 v33, v32, v33
    v_and_b32 v35, 0xffff0000, v9
    v_pk_mul_f32 v[34:35], v[34:35], v[28:29] op_sel_hi:[1,0]
    v_lshlrev_b32 v32, 16, v33
    v_and_b32 v33, 0xffff0000, v33
    v_pk_mul_f32 v[32:33], v[32:33], v[26:27] op_sel:[0,1] op_sel_hi:[1,1]
    s_waitcnt vmcnt(0)
    v_pk_mul_f32 v[94:95], v[34:35], s[54:55] op_sel_hi:[1,0]
    v_pk_mul_f32 v[92:93], v[32:33], s[54:55] op_sel_hi:[1,0]
    v_exp_f32 v92, v92
    v_and_b32 v85, 0x7fff7fff, v10
    v_exp_f32 v93, v93
    v_cos_f32 v88, v94
    v_cos_f32 v89, v95
    v_and_b32 v86, 0x7fff7fff, v11
    v_sin_f32 v90, v94
    v_sin_f32 v91, v95
    v_pk_mul_f32 v[88:89], v[88:89], v[92:93]
    v_dot2_f32_bf16 v84, v85, s52, 0
    v_pk_mul_f32 v[90:91], v[90:91], v[92:93]
    v_cvt_pk_f16_f32 v45, v88, v90
    v_cvt_pk_f16_f32 v36, v89, v91
    v_dot2_f32_bf16 v84, v86, s52, v84
    v_pk_mul_f32 v[92:93], v[90:91], v[90:91]
    v_pk_mul_f32 v[94:95], v[88:89], v[90:91]
    v_pk_fma_f32 v[88:89], v[88:89], v[88:89], v[92:93] neg_lo:[0,0,1] neg_hi:[0,0,1]
    v_add_f32_dpp v84, v84, v84 row_shr:1 row_mask:0xf bank_mask:0xf
    v_pk_add_f32 v[90:91], v[94:95], v[94:95]
    v_cvt_pk_f16_f32 v46, v88, v90
    v_cvt_pk_f16_f32 v37, v89, v91
    v_add_f32_dpp v84, v84, v84 row_shr:2 row_mask:0xf bank_mask:0xf
    v_pk_mul_f32 v[92:93], v[90:91], v[90:91]
    v_pk_mul_f32 v[94:95], v[88:89], v[90:91]
    v_pk_fma_f32 v[88:89], v[88:89], v[88:89], v[92:93] neg_lo:[0,0,1] neg_hi:[0,0,1]
    v_add_f32_dpp v84, v84, v84 row_shr:4 row_mask:0xf bank_mask:0xf
    v_pk_add_f32 v[90:91], v[94:95], v[94:95]
    v_cvt_pk_f16_f32 v48, v88, v90
    v_cvt_pk_f16_f32 v38, v89, v91
    v_add_f32_dpp v84, v84, v84 row_shr:8 row_mask:0xf bank_mask:0xf
    v_pk_mul_f32 v[92:93], v[90:91], v[90:91]
    v_pk_mul_f32 v[94:95], v[88:89], v[90:91]
    v_pk_fma_f32 v[88:89], v[88:89], v[88:89], v[92:93] neg_lo:[0,0,1] neg_hi:[0,0,1]
    v_add_f32_dpp v84, v84, v84 row_bcast:15 row_mask:0xa bank_mask:0xf
    v_pk_add_f32 v[90:91], v[94:95], v[94:95]
    v_cvt_pk_f16_f32 v52, v88, v90
    v_cvt_pk_f16_f32 v39, v89, v91
    v_add_f32_dpp v84, v84, v84 row_bcast:31 row_mask:0xc bank_mask:0xf
    v_pk_mul_f32 v[92:93], v[90:91], v[90:91]
    v_pk_mul_f32 v[94:95], v[88:89], v[90:91]
    v_pk_fma_f32 v[88:89], v[88:89], v[88:89], v[92:93] neg_lo:[0,0,1] neg_hi:[0,0,1]
    v_fma_f32 v84, v84, v29, s51
    v_pk_add_f32 v[90:91], v[94:95], v[94:95]
    v_cvt_pk_f16_f32 v60, v88, v90
    v_cvt_pk_f16_f32 v40, v89, v91
    v_frexp_exp_i32_f32_e64 v84, v84
    v_pk_mul_f16 v47, v46, v45 op_sel:[1,1] op_sel_hi:[1,0] neg_lo:[1,0]
    v_pk_fma_f16 v47, v46, v45, v47 op_sel:[0,0,0] op_sel_hi:[0,1,1]
    v_exp_f32_e64 v100, v32
    ds_write_addtid_b32 v45 offset:272
    ds_write_addtid_b32 v46 offset:544
    v_exp_f32_e64 v101, v33
    v_pk_mul_f16 v49, v48, v45 op_sel:[1,1] op_sel_hi:[1,0] neg_lo:[1,0]
    v_pk_mul_f16 v50, v48, v46 op_sel:[1,1] op_sel_hi:[1,0] neg_lo:[1,0]
    v_cos_f32_e64 v96, v34
    v_pk_fma_f16 v49, v48, v45, v49 op_sel:[0,0,0] op_sel_hi:[0,1,1]
    v_pk_fma_f16 v50, v48, v46, v50 op_sel:[0,0,0] op_sel_hi:[0,1,1]
    v_cos_f32_e64 v97, v35
    ds_write_addtid_b32 v47 offset:816
    ds_write_addtid_b32 v48 offset:1088
    v_readlane_b32 s40, v84, 63
    v_pk_mul_f16 v51, v48, v47 op_sel:[1,1] op_sel_hi:[1,0] neg_lo:[1,0]
    v_pk_fma_f16 v51, v48, v47, v51 op_sel:[0,0,0] op_sel_hi:[0,1,1]
    v_sin_f32 v98, v34
    ds_write_addtid_b32 v49 offset:1360
    v_sin_f32 v99, v35
    ds_write_addtid_b32 v50 offset:1632
    v_pk_mul_f16 v53, v52, v45 op_sel:[1,1] op_sel_hi:[1,0] neg_lo:[1,0]
    v_pk_mul_f32 v[96:97], v[96:97], v[100:101]
    v_pk_mul_f16 v54, v52, v46 op_sel:[1,1] op_sel_hi:[1,0] neg_lo:[1,0]
    v_pk_fma_f16 v53, v52, v45, v53 op_sel:[0,0,0] op_sel_hi:[0,1,1]
    s_sub_i32 s40, 126, s40
    v_pk_fma_f16 v54, v52, v46, v54 op_sel:[0,0,0] op_sel_hi:[0,1,1]
    ds_write_addtid_b32 v51 offset:1904
    v_pk_mul_f32 v[98:99], v[98:99], v[100:101]
    ds_write_addtid_b32 v52 offset:2176
    v_pk_mul_f16 v55, v52, v47 op_sel:[1,1] op_sel_hi:[1,0] neg_lo:[1,0]
    v_cvt_pk_f16_f32 v61, v96, v98
    v_pk_mul_f16 v56, v52, v48 op_sel:[1,1] op_sel_hi:[1,0] neg_lo:[1,0]
    v_pk_fma_f16 v55, v52, v47, v55 op_sel:[0,0,0] op_sel_hi:[0,1,1]
    v_cvt_pk_f16_f32 v41, v97, v99
    v_pk_fma_f16 v56, v52, v48, v56 op_sel:[0,0,0] op_sel_hi:[0,1,1]
    s_max_i32 s40, s40, 67
    ds_write_addtid_b32 v53 offset:2448
    ds_write_addtid_b32 v54 offset:2720
    v_pk_mul_f32 v[100:101], v[98:99], v[98:99]
    v_pk_mul_f16 v57, v52, v49 op_sel:[1,1] op_sel_hi:[1,0] neg_lo:[1,0]
    v_pk_mul_f16 v58, v52, v50 op_sel:[1,1] op_sel_hi:[1,0] neg_lo:[1,0]
    v_pk_mul_f32 v[102:103], v[96:97], v[98:99]
    v_pk_fma_f16 v57, v52, v49, v57 op_sel:[0,0,0] op_sel_hi:[0,1,1]
    v_pk_fma_f16 v58, v52, v50, v58 op_sel:[0,0,0] op_sel_hi:[0,1,1]
    v_pk_fma_f32 v[96:97], v[96:97], v[96:97], v[100:101] neg_lo:[0,0,1] neg_hi:[0,0,1]
    ds_write_addtid_b32 v55 offset:2992
    ds_write_addtid_b32 v56 offset:3264
    s_min_i32 s40, s40, 187
    v_pk_mul_f16 v59, v52, v51 op_sel:[1,1] op_sel_hi:[1,0] neg_lo:[1,0]
    v_pk_fma_f16 v59, v52, v51, v59 op_sel:[0,0,0] op_sel_hi:[0,1,1]
    v_pk_add_f32 v[98:99], v[102:103], v[102:103]
    ds_write_addtid_b32 v57 offset:3536
    ds_write_addtid_b32 v58 offset:3808
    v_cvt_pk_f16_f32 v62, v96, v98
    v_pk_mul_f16 v80, v60, v45 op_sel:[1,1] op_sel_hi:[1,0] neg_lo:[1,0]
    v_cvt_pk_f16_f32 v42, v97, v99
    v_pk_mul_f16 v81, v60, v46 op_sel:[1,1] op_sel_hi:[1,0] neg_lo:[1,0]
    v_pk_fma_f16 v80, v60, v45, v80 op_sel:[0,0,0] op_sel_hi:[0,1,1]
    s_nop 0
    s_lshl_b32 s40, s40, 23
    v_pk_fma_f16 v81, v60, v46, v81 op_sel:[0,0,0] op_sel_hi:[0,1,1]
    ds_write_addtid_b32 v59 offset:4080
    v_pk_mul_f32 v[92:93], v[90:91], v[90:91]
    ds_write_addtid_b32 v60 offset:4352
    v_pk_mul_f16 v82, v60, v47 op_sel:[1,1] op_sel_hi:[1,0] neg_lo:[1,0]
    v_pk_mul_f32 v[94:95], v[88:89], v[90:91]
    v_pk_mul_f16 v83, v60, v48 op_sel:[1,1] op_sel_hi:[1,0] neg_lo:[1,0]
    v_pk_fma_f16 v82, v60, v47, v82 op_sel:[0,0,0] op_sel_hi:[0,1,1]
    v_pk_fma_f32 v[88:89], v[88:89], v[88:89], v[92:93] neg_lo:[0,0,1] neg_hi:[0,0,1]
    v_pk_fma_f16 v83, v60, v48, v83 op_sel:[0,0,0] op_sel_hi:[0,1,1]
    ds_write_addtid_b32 v80 offset:4624
    v_mul_f32_e64 v30, s40, v29
    ds_write_addtid_b32 v81 offset:4896
    v_pk_add_f32 v[90:91], v[94:95], v[94:95]
    v_pk_mul_f16 v80, v60, v49 op_sel:[1,1] op_sel_hi:[1,0] neg_lo:[1,0]
    v_pk_mul_f16 v81, v60, v50 op_sel:[1,1] op_sel_hi:[1,0] neg_lo:[1,0]
    v_cvt_pk_f16_f32 v64, v88, v90
    v_pk_fma_f16 v80, v60, v49, v80 op_sel:[0,0,0] op_sel_hi:[0,1,1]
    v_pk_fma_f16 v81, v60, v50, v81 op_sel:[0,0,0] op_sel_hi:[0,1,1]
    v_cvt_pk_f16_f32 v44, v89, v91
    ds_write_addtid_b32 v82 offset:5168
    ds_write_addtid_b32 v83 offset:5440
    v_mul_f32_e64 v26, s40, v26
    v_pk_mul_f16 v82, v60, v51 op_sel:[1,1] op_sel_hi:[1,0] neg_lo:[1,0]
    v_pk_mul_f16 v83, v60, v52 op_sel:[1,1] op_sel_hi:[1,0] neg_lo:[1,0]
    v_pk_mul_f32 v[92:93], v[90:91], v[90:91]
    v_pk_fma_f16 v82, v60, v51, v82 op_sel:[0,0,0] op_sel_hi:[0,1,1]
    v_pk_fma_f16 v83, v60, v52, v83 op_sel:[0,0,0] op_sel_hi:[0,1,1]
    v_pk_mul_f32 v[94:95], v[88:89], v[90:91]
    ds_write_addtid_b32 v80 offset:5712
    ds_write_addtid_b32 v81 offset:5984
    v_pk_fma_f32 v[88:89], v[88:89], v[88:89], v[92:93] neg_lo:[0,0,1] neg_hi:[0,0,1]
    v_pk_mul_f16 v80, v60, v53 op_sel:[1,1] op_sel_hi:[1,0] neg_lo:[1,0]
    v_mov_b32 v85, 0x40053526
    v_pk_mul_f16 v81, v60, v54 op_sel:[1,1] op_sel_hi:[1,0] neg_lo:[1,0]
    v_pk_fma_f16 v80, v60, v53, v80 op_sel:[0,0,0] op_sel_hi:[0,1,1]
    v_pk_add_f32 v[90:91], v[94:95], v[94:95]
    v_pk_fma_f16 v81, v60, v54, v81 op_sel:[0,0,0] op_sel_hi:[0,1,1]
    ds_write_addtid_b32 v82 offset:6256
    v_cvt_pk_f16_f32 v65, v88, v90
    ds_write_addtid_b32 v83 offset:6528
    v_pk_mul_f16 v82, v60, v55 op_sel:[1,1] op_sel_hi:[1,0] neg_lo:[1,0]
    v_cvt_pk_f16_f32 v78, v89, v91
    v_pk_mul_f16 v83, v60, v56 op_sel:[1,1] op_sel_hi:[1,0] neg_lo:[1,0]
    v_pk_fma_f16 v82, v60, v55, v82 op_sel:[0,0,0] op_sel_hi:[0,1,1]
    v_mul_f32_e64 v85, s40, v85
    v_pk_fma_f16 v83, v60, v56, v83 op_sel:[0,0,0] op_sel_hi:[0,1,1]
    ds_write_addtid_b32 v80 offset:6800
    v_lshlrev_b32 v104, 16, v10
    ds_write_addtid_b32 v81 offset:7072
    v_lshlrev_b32 v106, 16, v11
    v_pk_mul_f16 v80, v60, v57 op_sel:[1,1] op_sel_hi:[1,0] neg_lo:[1,0]
    v_pk_mul_f16 v81, v60, v58 op_sel:[1,1] op_sel_hi:[1,0] neg_lo:[1,0]
    v_and_b32 v105, 0xffff0000, v10
    v_pk_fma_f16 v80, v60, v57, v80 op_sel:[0,0,0] op_sel_hi:[0,1,1]
    v_pk_fma_f16 v81, v60, v58, v81 op_sel:[0,0,0] op_sel_hi:[0,1,1]
    v_and_b32 v107, 0xffff0000, v11
    ds_write_addtid_b32 v82 offset:7344
    ds_write_addtid_b32 v83 offset:7616
    v_pk_mul_f32 v[104:105], v[104:105], v[30:31] op_sel_hi:[1,0]
    v_pk_mul_f16 v82, v60, v59 op_sel:[1,1] op_sel_hi:[1,0] neg_lo:[1,0]
    v_pk_fma_f16 v82, v60, v59, v82 op_sel:[0,0,0] op_sel_hi:[0,1,1]
    v_pk_mul_f32 v[106:107], v[106:107], v[30:31] op_sel_hi:[1,0] neg_lo:[1,0] neg_hi:[1,0]
    ds_write_addtid_b32 v80 offset:7888
    ds_write_addtid_b32 v81 offset:8160
    v_cvt_pk_f16_f32 v67, v104, v106
    ds_write_addtid_b32 v82 offset:8432
    v_cvt_pk_f16_f32 v24, v105, v107
    s_mov_b64 exec, 1
    ds_write_b32 v31, v85 offset:0
    s_mov_b64 exec, -1
    v_pk_mul_f16 v73, v67, v64 op_sel:[1,1] op_sel_hi:[1,0]
    v_pk_mul_f16 v68, v67, v61 op_sel:[1,1] op_sel_hi:[1,0]
    v_pk_fma_f16 v73, v67, v64, v73 op_sel:[0,0,0] op_sel_hi:[0,1,1] neg_hi:[0,1,0]
    v_pk_fma_f16 v68, v67, v61, v68 op_sel:[0,0,0] op_sel_hi:[0,1,1] neg_hi:[0,1,0]
    ds_write_addtid_b32 v67 offset:8704
    v_pk_mul_f16 v69, v67, v62 op_sel:[1,1] op_sel_hi:[1,0]
    v_pk_mul_f16 v75, v73, v45 op_sel:[1,1] op_sel_hi:[1,0]
    v_pk_fma_f16 v69, v67, v62, v69 op_sel:[0,0,0] op_sel_hi:[0,1,1] neg_hi:[0,1,0]
    v_pk_fma_f16 v75, v73, v45, v75 op_sel:[0,0,0] op_sel_hi:[0,1,1] neg_hi:[0,1,0]
    ds_write_addtid_b32 v73 offset:11696
    ds_write_addtid_b32 v68 offset:8976
    v_pk_mul_f16 v70, v68, v62 op_sel:[1,1] op_sel_hi:[1,0]
    v_pk_mul_f16 v71, v69, v62 op_sel:[1,1] op_sel_hi:[1,0]
    v_pk_fma_f16 v70, v68, v62, v70 op_sel:[0,0,0] op_sel_hi:[0,1,1] neg_hi:[0,1,0]
    v_pk_fma_f16 v71, v69, v62, v71 op_sel:[0,0,0] op_sel_hi:[0,1,1] neg_hi:[0,1,0]
    ds_write_addtid_b32 v69 offset:9248
    ds_write_addtid_b32 v75 offset:10064
    v_pk_mul_f16 v76, v75, v64 op_sel:[1,1] op_sel_hi:[1,0]
    v_pk_mul_f16 v77, v75, v65 op_sel:[1,1] op_sel_hi:[1,0]
    v_pk_fma_f16 v76, v75, v64, v76 op_sel:[0,0,0] op_sel_hi:[0,1,1] neg_hi:[0,1,0]
    v_pk_fma_f16 v77, v75, v65, v77 op_sel:[0,0,0] op_sel_hi:[0,1,1] neg_hi:[0,1,0]
    ds_write_addtid_b32 v70 offset:9520
    ds_write_addtid_b32 v71 offset:12240
    v_pk_mul_f16 v63, v70, v62 op_sel:[1,1] op_sel_hi:[1,0]
    v_pk_mul_f16 v72, v71, v62 op_sel:[1,1] op_sel_hi:[1,0]
    v_pk_fma_f16 v63, v70, v62, v63 op_sel:[0,0,0] op_sel_hi:[0,1,1] neg_hi:[0,1,0]
    v_pk_fma_f16 v72, v71, v62, v72 op_sel:[0,0,0] op_sel_hi:[0,1,1] neg_hi:[0,1,0]
    ds_write_addtid_b32 v76 offset:13600
    ds_write_addtid_b32 v77 offset:10608
    v_pk_mul_f16 v74, v71, v64 op_sel:[1,1] op_sel_hi:[1,0]
    v_pk_mul_f16 v66, v76, v65 op_sel:[1,1] op_sel_hi:[1,0]
    v_pk_fma_f16 v74, v71, v64, v74 op_sel:[0,0,0] op_sel_hi:[0,1,1] neg_hi:[0,1,0]
    v_pk_fma_f16 v66, v76, v65, v66 op_sel:[0,0,0] op_sel_hi:[0,1,1] neg_hi:[0,1,0]
    ds_write_addtid_b32 v63 offset:12512
    ds_write_addtid_b32 v72 offset:12784
    v_pk_mul_f16 v43, v77, v65 op_sel:[1,1] op_sel_hi:[1,0]
    v_pk_mul_f16 v80, v63, v62 op_sel:[1,1] op_sel_hi:[1,0]
    v_pk_fma_f16 v43, v77, v65, v43 op_sel:[0,0,0] op_sel_hi:[0,1,1] neg_hi:[0,1,0]
    v_pk_fma_f16 v80, v63, v62, v80 op_sel:[0,0,0] op_sel_hi:[0,1,1] neg_hi:[0,1,0]
    ds_write_addtid_b32 v74 offset:11424
    ds_write_addtid_b32 v66 offset:13872
    v_pk_mul_f16 v81, v69, v64 op_sel:[1,1] op_sel_hi:[1,0]
    v_pk_mul_f16 v82, v72, v64 op_sel:[1,1] op_sel_hi:[1,0]
    v_pk_fma_f16 v81, v69, v64, v81 op_sel:[0,0,0] op_sel_hi:[0,1,1] neg_hi:[0,1,0]
    v_pk_fma_f16 v82, v72, v64, v82 op_sel:[0,0,0] op_sel_hi:[0,1,1] neg_hi:[0,1,0]
    ds_write_addtid_b32 v43 offset:10880
    ds_write_addtid_b32 v80 offset:13056
    v_pk_mul_f16 v83, v71, v65 op_sel:[1,1] op_sel_hi:[1,0]
    v_pk_mul_f16 v80, v74, v65 op_sel:[1,1] op_sel_hi:[1,0]
    v_pk_fma_f16 v83, v71, v65, v83 op_sel:[0,0,0] op_sel_hi:[0,1,1] neg_hi:[0,1,0]
    v_pk_fma_f16 v80, v74, v65, v80 op_sel:[0,0,0] op_sel_hi:[0,1,1] neg_hi:[0,1,0]
    ds_write_addtid_b32 v81 offset:11968
    ds_write_addtid_b32 v82 offset:9792
    v_pk_mul_f16 v81, v66, v65 op_sel:[1,1] op_sel_hi:[1,0]
    v_pk_mul_f16 v82, v43, v65 op_sel:[1,1] op_sel_hi:[1,0]
    v_pk_fma_f16 v81, v66, v65, v81 op_sel:[0,0,0] op_sel_hi:[0,1,1] neg_hi:[0,1,0]
    v_pk_fma_f16 v82, v43, v65, v82 op_sel:[0,0,0] op_sel_hi:[0,1,1] neg_hi:[0,1,0]
    ds_write_addtid_b32 v83 offset:13328
    ds_write_addtid_b32 v80 offset:10336
    ds_write_addtid_b32 v81 offset:14144
    ds_write_addtid_b32 v82 offset:11152
    s_mov_b64 exec, 1
    ds_add_u32 v3, v0 offset:80
    s_mov_b64 exec, -1
    ds_read_b128 v[88:91], v16 offset:8704
    ds_read_b128 v[92:95], v17 offset:0
    ds_read_b128 v[96:99], v16 offset:8736
    ds_read_b128 v[100:103], v17 offset:32
    ds_read_b128 v[104:107], v16 offset:8768
    ds_read_b128 v[108:111], v17 offset:64
    ds_read_b128 v[62:65], v16 offset:8800
    ds_read_b128 v[66:69], v17 offset:96
    ds_read_b128 v[70:73], v16 offset:8832
    ds_read_b128 v[74:77], v17 offset:128
    v_pk_mul_f16 v47, v37, v36 op_sel:[1,1] op_sel_hi:[1,0] neg_lo:[1,0]
    v_pk_fma_f16 v47, v37, v36, v47 op_sel:[0,0,0] op_sel_hi:[0,1,1]
    v_pk_mul_f16 v49, v38, v36 op_sel:[1,1] op_sel_hi:[1,0] neg_lo:[1,0]
    s_nop 0
    s_waitcnt lgkmcnt(8)
    v_mfma_f32_32x32x16_f16 v[112:127], v[88:91], v[92:95], 0
    ds_read_b128 v[88:91], v16 offset:8864
    ds_read_b128 v[92:95], v17 offset:160
    v_pk_mul_f16 v50, v38, v37 op_sel:[1,1] op_sel_hi:[1,0] neg_lo:[1,0]
    v_pk_fma_f16 v49, v38, v36, v49 op_sel:[0,0,0] op_sel_hi:[0,1,1]
    v_pk_fma_f16 v50, v38, v37, v50 op_sel:[0,0,0] op_sel_hi:[0,1,1]
    s_waitcnt lgkmcnt(8)
    s_nop 0
    v_mfma_f32_32x32x16_f16 v[112:127], v[96:99], v[100:103], v[112:127]
    ds_read_b128 v[96:99], v16 offset:8896
    ds_read_b128 v[100:103], v17 offset:192
    v_pk_mul_f16 v51, v38, v47 op_sel:[1,1] op_sel_hi:[1,0] neg_lo:[1,0]
    v_pk_fma_f16 v51, v38, v47, v51 op_sel:[0,0,0] op_sel_hi:[0,1,1]
    v_pk_mul_f16 v53, v39, v36 op_sel:[1,1] op_sel_hi:[1,0] neg_lo:[1,0]
    s_nop 0
    s_waitcnt lgkmcnt(8)
    v_mfma_f32_32x32x16_f16 v[112:127], v[104:107], v[108:111], v[112:127]
    ds_read_b128 v[104:107], v16 offset:8928
    ds_read_b128 v[108:111], v17 offset:224
    v_pk_mul_f16 v54, v39, v37 op_sel:[1,1] op_sel_hi:[1,0] neg_lo:[1,0]
    v_pk_fma_f16 v53, v39, v36, v53 op_sel:[0,0,0] op_sel_hi:[0,1,1]
    v_pk_fma_f16 v54, v39, v37, v54 op_sel:[0,0,0] op_sel_hi:[0,1,1]
    s_waitcnt lgkmcnt(8)
    v_mfma_f32_32x32x16_f16 v[112:127], v[62:65], v[66:69], v[112:127]
    v_pk_mul_f16 v55, v39, v47 op_sel:[1,1] op_sel_hi:[1,0] neg_lo:[1,0]
    v_pk_mul_f16 v56, v39, v38 op_sel:[1,1] op_sel_hi:[1,0] neg_lo:[1,0]
    v_pk_fma_f16 v55, v39, v47, v55 op_sel:[0,0,0] op_sel_hi:[0,1,1]
    s_waitcnt lgkmcnt(6)
    v_mfma_f32_32x32x16_f16 v[112:127], v[70:73], v[74:77], v[112:127]
    v_pk_fma_f16 v56, v39, v38, v56 op_sel:[0,0,0] op_sel_hi:[0,1,1]
    v_pk_mul_f16 v57, v39, v49 op_sel:[1,1] op_sel_hi:[1,0] neg_lo:[1,0]
    v_pk_mul_f16 v58, v39, v50 op_sel:[1,1] op_sel_hi:[1,0] neg_lo:[1,0]
    s_nop 0
    s_waitcnt lgkmcnt(4)
    v_mfma_f32_32x32x16_f16 v[112:127], v[88:91], v[92:95], v[112:127]
    v_pk_fma_f16 v57, v39, v49, v57 op_sel:[0,0,0] op_sel_hi:[0,1,1]
    v_pk_fma_f16 v58, v39, v50, v58 op_sel:[0,0,0] op_sel_hi:[0,1,1]
    v_pk_mul_f16 v59, v39, v51 op_sel:[1,1] op_sel_hi:[1,0] neg_lo:[1,0]
    s_waitcnt lgkmcnt(2)
    v_mfma_f32_32x32x16_f16 v[112:127], v[96:99], v[100:103], v[112:127]
    v_pk_fma_f16 v59, v39, v51, v59 op_sel:[0,0,0] op_sel_hi:[0,1,1]
    s_waitcnt lgkmcnt(0)
    v_mfma_f32_32x32x16_f16 v[112:127], v[104:107], v[108:111], v[112:127]
    ds_write_addtid_b32 v36 offset:272
    ds_write_addtid_b32 v37 offset:544
    ds_write_addtid_b32 v47 offset:816
    ds_write_addtid_b32 v38 offset:1088
    ds_write_addtid_b32 v49 offset:1360
    ds_write_addtid_b32 v50 offset:1632
    ds_write_addtid_b32 v51 offset:1904
    ds_write_addtid_b32 v39 offset:2176
    ds_write_addtid_b32 v53 offset:2448
    ds_write_addtid_b32 v54 offset:2720
    ds_write_addtid_b32 v55 offset:2992
    ds_write_addtid_b32 v56 offset:3264
    ds_write_addtid_b32 v57 offset:3536
    ds_write_addtid_b32 v58 offset:3808
    v_pk_mul_f16 v80, v40, v36 op_sel:[1,1] op_sel_hi:[1,0] neg_lo:[1,0]
    v_pk_mul_f16 v81, v40, v37 op_sel:[1,1] op_sel_hi:[1,0] neg_lo:[1,0]
    v_pk_fma_f16 v80, v40, v36, v80 op_sel:[0,0,0] op_sel_hi:[0,1,1]
    v_pk_fma_f16 v81, v40, v37, v81 op_sel:[0,0,0] op_sel_hi:[0,1,1]
    ds_write_addtid_b32 v59 offset:4080
    ds_write_addtid_b32 v40 offset:4352
    v_pk_mul_f16 v82, v40, v47 op_sel:[1,1] op_sel_hi:[1,0] neg_lo:[1,0]
    v_pk_mul_f16 v83, v40, v38 op_sel:[1,1] op_sel_hi:[1,0] neg_lo:[1,0]
    v_pk_fma_f16 v82, v40, v47, v82 op_sel:[0,0,0] op_sel_hi:[0,1,1]
    v_pk_fma_f16 v83, v40, v38, v83 op_sel:[0,0,0] op_sel_hi:[0,1,1]
    ds_write_addtid_b32 v80 offset:4624
    ds_write_addtid_b32 v81 offset:4896
    v_pk_mul_f16 v80, v40, v49 op_sel:[1,1] op_sel_hi:[1,0] neg_lo:[1,0]
    v_pk_mul_f16 v81, v40, v50 op_sel:[1,1] op_sel_hi:[1,0] neg_lo:[1,0]
    v_pk_fma_f16 v80, v40, v49, v80 op_sel:[0,0,0] op_sel_hi:[0,1,1]
    v_pk_fma_f16 v81, v40, v50, v81 op_sel:[0,0,0] op_sel_hi:[0,1,1]
    ds_write_addtid_b32 v82 offset:5168
    ds_write_addtid_b32 v83 offset:5440
    v_pk_mul_f16 v82, v40, v51 op_sel:[1,1] op_sel_hi:[1,0] neg_lo:[1,0]
    v_pk_mul_f16 v83, v40, v39 op_sel:[1,1] op_sel_hi:[1,0] neg_lo:[1,0]
    v_pk_fma_f16 v82, v40, v51, v82 op_sel:[0,0,0] op_sel_hi:[0,1,1]
    v_pk_fma_f16 v83, v40, v39, v83 op_sel:[0,0,0] op_sel_hi:[0,1,1]
    ds_write_addtid_b32 v80 offset:5712
    ds_write_addtid_b32 v81 offset:5984
    v_pk_mul_f16 v80, v40, v53 op_sel:[1,1] op_sel_hi:[1,0] neg_lo:[1,0]
    v_pk_mul_f16 v81, v40, v54 op_sel:[1,1] op_sel_hi:[1,0] neg_lo:[1,0]
    v_pk_fma_f16 v80, v40, v53, v80 op_sel:[0,0,0] op_sel_hi:[0,1,1]
    v_pk_fma_f16 v81, v40, v54, v81 op_sel:[0,0,0] op_sel_hi:[0,1,1]
    ds_write_addtid_b32 v82 offset:6256
    ds_write_addtid_b32 v83 offset:6528
    v_pk_mul_f16 v82, v40, v55 op_sel:[1,1] op_sel_hi:[1,0] neg_lo:[1,0]
    v_pk_mul_f16 v83, v40, v56 op_sel:[1,1] op_sel_hi:[1,0] neg_lo:[1,0]
    v_pk_fma_f16 v82, v40, v55, v82 op_sel:[0,0,0] op_sel_hi:[0,1,1]
    v_pk_fma_f16 v83, v40, v56, v83 op_sel:[0,0,0] op_sel_hi:[0,1,1]
    ds_write_addtid_b32 v80 offset:6800
    ds_write_addtid_b32 v81 offset:7072
    v_pk_mul_f16 v80, v40, v57 op_sel:[1,1] op_sel_hi:[1,0] neg_lo:[1,0]
    v_pk_mul_f16 v81, v40, v58 op_sel:[1,1] op_sel_hi:[1,0] neg_lo:[1,0]
    v_pk_fma_f16 v80, v40, v57, v80 op_sel:[0,0,0] op_sel_hi:[0,1,1]
    v_pk_fma_f16 v81, v40, v58, v81 op_sel:[0,0,0] op_sel_hi:[0,1,1]
    ds_write_addtid_b32 v82 offset:7344
    ds_write_addtid_b32 v83 offset:7616
    v_pk_mul_f16 v82, v40, v59 op_sel:[1,1] op_sel_hi:[1,0] neg_lo:[1,0]
    v_pk_fma_f16 v82, v40, v59, v82 op_sel:[0,0,0] op_sel_hi:[0,1,1]
    ds_write_addtid_b32 v80 offset:7888
    ds_write_addtid_b32 v81 offset:8160
    ds_write_addtid_b32 v82 offset:8432
    v_pk_mul_f16 v73, v24, v44 op_sel:[1,1] op_sel_hi:[1,0]
    v_pk_mul_f16 v68, v24, v41 op_sel:[1,1] op_sel_hi:[1,0]
    v_pk_fma_f16 v73, v24, v44, v73 op_sel:[0,0,0] op_sel_hi:[0,1,1] neg_hi:[0,1,0]
    v_pk_fma_f16 v68, v24, v41, v68 op_sel:[0,0,0] op_sel_hi:[0,1,1] neg_hi:[0,1,0]
    ds_write_addtid_b32 v24 offset:8704
    v_pk_mul_f16 v69, v24, v42 op_sel:[1,1] op_sel_hi:[1,0]
    v_pk_mul_f16 v75, v73, v36 op_sel:[1,1] op_sel_hi:[1,0]
    v_pk_fma_f16 v69, v24, v42, v69 op_sel:[0,0,0] op_sel_hi:[0,1,1] neg_hi:[0,1,0]
    v_pk_fma_f16 v75, v73, v36, v75 op_sel:[0,0,0] op_sel_hi:[0,1,1] neg_hi:[0,1,0]
    ds_write_addtid_b32 v73 offset:11696
    ds_write_addtid_b32 v68 offset:8976
    v_pk_mul_f16 v70, v68, v42 op_sel:[1,1] op_sel_hi:[1,0]
    v_pk_mul_f16 v71, v69, v42 op_sel:[1,1] op_sel_hi:[1,0]
    v_pk_fma_f16 v70, v68, v42, v70 op_sel:[0,0,0] op_sel_hi:[0,1,1] neg_hi:[0,1,0]
    v_pk_fma_f16 v71, v69, v42, v71 op_sel:[0,0,0] op_sel_hi:[0,1,1] neg_hi:[0,1,0]
    ds_write_addtid_b32 v69 offset:9248
    ds_write_addtid_b32 v75 offset:10064
    v_pk_mul_f16 v76, v75, v44 op_sel:[1,1] op_sel_hi:[1,0]
    v_pk_mul_f16 v77, v75, v78 op_sel:[1,1] op_sel_hi:[1,0]
    v_pk_fma_f16 v76, v75, v44, v76 op_sel:[0,0,0] op_sel_hi:[0,1,1] neg_hi:[0,1,0]
    v_pk_fma_f16 v77, v75, v78, v77 op_sel:[0,0,0] op_sel_hi:[0,1,1] neg_hi:[0,1,0]
    ds_write_addtid_b32 v70 offset:9520
    ds_write_addtid_b32 v71 offset:12240
    v_pk_mul_f16 v63, v70, v42 op_sel:[1,1] op_sel_hi:[1,0]
    v_pk_mul_f16 v72, v71, v42 op_sel:[1,1] op_sel_hi:[1,0]
    v_pk_fma_f16 v63, v70, v42, v63 op_sel:[0,0,0] op_sel_hi:[0,1,1] neg_hi:[0,1,0]
    v_pk_fma_f16 v72, v71, v42, v72 op_sel:[0,0,0] op_sel_hi:[0,1,1] neg_hi:[0,1,0]
    ds_write_addtid_b32 v76 offset:13600
    ds_write_addtid_b32 v77 offset:10608
    v_pk_mul_f16 v74, v71, v44 op_sel:[1,1] op_sel_hi:[1,0]
    v_pk_mul_f16 v66, v76, v78 op_sel:[1,1] op_sel_hi:[1,0]
    v_pk_fma_f16 v74, v71, v44, v74 op_sel:[0,0,0] op_sel_hi:[0,1,1] neg_hi:[0,1,0]
    v_pk_fma_f16 v66, v76, v78, v66 op_sel:[0,0,0] op_sel_hi:[0,1,1] neg_hi:[0,1,0]
    ds_write_addtid_b32 v63 offset:12512
    ds_write_addtid_b32 v72 offset:12784
    v_pk_mul_f16 v43, v77, v78 op_sel:[1,1] op_sel_hi:[1,0]
    v_pk_mul_f16 v80, v63, v42 op_sel:[1,1] op_sel_hi:[1,0]
    v_pk_fma_f16 v43, v77, v78, v43 op_sel:[0,0,0] op_sel_hi:[0,1,1] neg_hi:[0,1,0]
    v_pk_fma_f16 v80, v63, v42, v80 op_sel:[0,0,0] op_sel_hi:[0,1,1] neg_hi:[0,1,0]
    ds_write_addtid_b32 v74 offset:11424
    ds_write_addtid_b32 v66 offset:13872
    v_pk_mul_f16 v81, v69, v44 op_sel:[1,1] op_sel_hi:[1,0]
    v_pk_mul_f16 v82, v72, v44 op_sel:[1,1] op_sel_hi:[1,0]
    v_pk_fma_f16 v81, v69, v44, v81 op_sel:[0,0,0] op_sel_hi:[0,1,1] neg_hi:[0,1,0]
    v_pk_fma_f16 v82, v72, v44, v82 op_sel:[0,0,0] op_sel_hi:[0,1,1] neg_hi:[0,1,0]
    ds_write_addtid_b32 v43 offset:10880
    ds_write_addtid_b32 v80 offset:13056
    v_pk_mul_f16 v83, v71, v78 op_sel:[1,1] op_sel_hi:[1,0]
    v_pk_mul_f16 v80, v74, v78 op_sel:[1,1] op_sel_hi:[1,0]
    v_pk_fma_f16 v83, v71, v78, v83 op_sel:[0,0,0] op_sel_hi:[0,1,1] neg_hi:[0,1,0]
    v_pk_fma_f16 v80, v74, v78, v80 op_sel:[0,0,0] op_sel_hi:[0,1,1] neg_hi:[0,1,0]
    ds_write_addtid_b32 v81 offset:11968
    ds_write_addtid_b32 v82 offset:9792
    v_pk_mul_f16 v81, v66, v78 op_sel:[1,1] op_sel_hi:[1,0]
    v_pk_mul_f16 v82, v43, v78 op_sel:[1,1] op_sel_hi:[1,0]
    v_pk_fma_f16 v81, v66, v78, v81 op_sel:[0,0,0] op_sel_hi:[0,1,1] neg_hi:[0,1,0]
    v_pk_fma_f16 v82, v43, v78, v82 op_sel:[0,0,0] op_sel_hi:[0,1,1] neg_hi:[0,1,0]
    ds_write_addtid_b32 v83 offset:13328
    ds_write_addtid_b32 v80 offset:10336
    ds_write_addtid_b32 v81 offset:14144
    ds_write_addtid_b32 v82 offset:11152
    s_mov_b64 exec, 1
    ds_add_u32 v3, v0 offset:84
    s_mov_b64 exec, -1
    ds_read_b128 v[88:91], v16 offset:8704
    ds_read_b128 v[92:95], v17 offset:0
    ds_read_b128 v[96:99], v16 offset:8736
    ds_read_b128 v[100:103], v17 offset:32
    ds_read_b128 v[104:107], v16 offset:8768
    ds_read_b128 v[108:111], v17 offset:64
    ds_read_b128 v[32:35], v16 offset:8800
    ds_read_b128 v[36:39], v17 offset:96
    ds_read_b128 v[40:43], v16 offset:8832
    ds_read_b128 v[44:47], v17 offset:128
    ds_read_b128 v[48:51], v16 offset:8864
    ds_read_b128 v[52:55], v17 offset:160
    ds_read_b128 v[56:59], v16 offset:8896
    ds_read_b128 v[60:63], v17 offset:192
    v_add_u32 v6, s50, v6
    s_waitcnt lgkmcnt(12)
    v_mfma_f32_32x32x16_f16 v[112:127], v[88:91], v[92:95], v[112:127]
    ds_read_b128 v[88:91], v16 offset:8928
    ds_read_b128 v[92:95], v17 offset:224
    v_add_u32 v7, s50, v7
    s_waitcnt lgkmcnt(12)
    v_mfma_f32_32x32x16_f16 v[112:127], v[96:99], v[100:103], v[112:127]
    v_add_u32 v20, s50, v20
    s_waitcnt lgkmcnt(10)
    v_mfma_f32_32x32x16_f16 v[112:127], v[104:107], v[108:111], v[112:127]
    v_add_u32 v18, s50, v18
    s_waitcnt lgkmcnt(8)
    v_mfma_f32_32x32x16_f16 v[112:127], v[32:35], v[36:39], v[112:127]
    v_add_u32 v19, s50, v19
    s_waitcnt lgkmcnt(6)
    v_mfma_f32_32x32x16_f16 v[112:127], v[40:43], v[44:47], v[112:127]
    s_add_u32 s41, s50, 6144
    s_waitcnt lgkmcnt(4)
    v_mfma_f32_32x32x16_f16 v[112:127], v[48:51], v[52:55], v[112:127]
    v_lshl_add_u32 v1, v1, 3, s41
    s_waitcnt lgkmcnt(2)
    v_mfma_f32_32x32x16_f16 v[112:127], v[56:59], v[60:63], v[112:127]
    s_add_u32 s41, s50, 1072
    s_waitcnt lgkmcnt(0)
    v_mfma_f32_32x32x16_f16 v[112:127], v[88:91], v[92:95], v[112:127]
    v_sub_u32 v25, s41, v2
    ds_read_b128 v[32:35], v2 offset:4864
    ds_read_b128 v[36:39], v2 offset:5888
    ds_read_b128 v[40:43], v2 offset:6912
    ds_read_b128 v[44:47], v2 offset:7936
    v_mov_b32 v104, 0
    s_nop 5
    v_cvt_pkrtz_f16_f32 v88, v119, v118
    v_cvt_pkrtz_f16_f32 v92, v118, v117
    v_cvt_pkrtz_f16_f32 v89, v117, v116
    v_add_f32_e64 v112, v112, v26
    v_cvt_pkrtz_f16_f32 v108, v121, v120
    v_readlane_b32 s40, v88, 63
    v_readlane_b32 s41, v92, 63
    v_cvt_pkrtz_f16_f32 v109, v122, v123
    v_readlane_b32 s53, v108, 63
    v_cvt_pkrtz_f16_f32 v90, v115, v114
    v_cvt_pkrtz_f16_f32 v91, v113, v112
    s_pack_ll_b32_b16 s42, s40, s40
    v_mov_b32_dpp v99, v88 wave_shr:1 row_mask:0xf bank_mask:0xf bound_ctrl:0
    ds_write_b128 v25, v[88:91]
    v_and_b32 v105, s42, v21
    v_and_b32_e64 v106, s42, v22
    v_and_b32_e64 v107, s42, v23
    v_writelane_b32 v107, s40, 11
    v_writelane_b32 v107, s41, 15
    v_mov_b32_dpp v111, v109 quad_perm:[1,0,3,2] row_mask:0xf bank_mask:0xf
    ds_write_b128 v20, v[104:107]
    v_perm_b32 v109, v111, v109, v5
    ds_write2_b32 v18, v108, v108 offset0:0 offset1:225
    s_nop 0
    s_pack_ll_b32_b16 s53, s53, s53
    ds_write2_b32 v19, v109, v109 offset0:0 offset1:225
    v_mov_b32_dpp v110, v89 wave_shr:1 row_mask:0xf bank_mask:0xf bound_ctrl:0
    v_cvt_pkrtz_f16_f32 v93, v116, v115
    v_cvt_pkrtz_f16_f32 v94, v114, v113
    v_alignbit_b32 v95, v99, v91, 16
    v_cvt_pkrtz_f16_f32 v96, v117, v116
    ds_write_b128 v25, v[92:95] offset:1088
    v_cvt_pkrtz_f16_f32 v97, v115, v114
    v_cvt_pkrtz_f16_f32 v98, v113, v112
    v_cvt_pkrtz_f16_f32 v100, v116, v115
    ds_write_b128 v25, v[96:99] offset:2176
    v_cvt_pkrtz_f16_f32 v101, v114, v113
    v_alignbit_b32 v102, v99, v91, 16
    v_alignbit_b32 v103, v110, v99, 16
    v_pk_mul_f16 v12, v12, s53
    v_pk_mul_f16 v13, v13, s53
    v_pk_mul_f16 v14, v14, s53
    v_pk_mul_f16 v15, v15, s53
    ds_write_b128 v25, v[100:103] offset:3264
    s_cmp_lg_u32 s38, 0
    s_cbranch_scc1 L_set1_47
    ds_read_b64 v[48:49], v6 offset:576
    ds_read_b64 v[50:51], v6 offset:584
    ds_read_b64 v[52:53], v6 offset:64
    ds_read_b64 v[54:55], v6 offset:72
    ds_read_b64 v[56:57], v6 offset:640
    ds_read_b64 v[58:59], v6 offset:648
    ds_read_b64 v[60:61], v6 offset:128
    ds_read_b64 v[62:63], v6 offset:136
    ds_read_b64 v[64:65], v6 offset:704
    ds_read_b64 v[66:67], v6 offset:712
    ds_read_b64 v[68:69], v6 offset:192
    ds_read_b64 v[70:71], v6 offset:200
    ds_read_b64 v[72:73], v6 offset:768
    ds_read_b64 v[74:75], v6 offset:776
    ds_read_b64 v[76:77], v6 offset:256
    ds_read_b64 v[78:79], v6 offset:264
    ds_read_b64 v[80:81], v6 offset:832
    ds_read_b64 v[82:83], v6 offset:840
    ds_read_b64 v[84:85], v6 offset:320
    ds_read_b64 v[86:87], v6 offset:328
    ds_read_b64 v[8:9], v6 offset:896
    ds_read_b64 v[10:11], v6 offset:904
    ds_read_b64 v[16:17], v6 offset:384
    ds_read_b64 v[18:19], v6 offset:392
    ds_read_b64 v[20:21], v6 offset:960
    ds_read_b64 v[22:23], v6 offset:968
    ds_read_b64 v[24:25], v6 offset:448
    ds_read_b64 v[26:27], v6 offset:456
    ds_read_b64 v[28:29], v6 offset:1024
    ds_read_b64 v[30:31], v6 offset:1032
    s_mov_b32 s46, 0
L_sp_48:
    ds_read_b32 v5, v3 offset:48
    s_waitcnt lgkmcnt(0)
    v_cmp_gt_u32_e64 vcc, 4, v5
    s_cbranch_vccz L_spd_49
    s_add_u32 s46, s46, 1
    s_sleep 2
    s_cmp_lt_u32 s46, 400000
    s_cbranch_scc1 L_sp_48
    s_nop 0
    s_branch L_end
    s_nop 0
L_spd_49:
    s_setprio 2
    ds_read_b128 v[88:91], v4 offset:48
    ds_read_b128 v[92:95], v4 offset:112
    ds_read_b128 v[96:99], v4 offset:176
    s_waitcnt lgkmcnt(2)
    v_mfma_f32_16x16x32_f16 v[104:107], v[48:51], v[88:91], 0
    ds_read_b128 v[100:103], v4 offset:240
    v_mfma_f32_16x16x32_f16 v[112:115], v[52:55], v[88:91], 0
    ds_read_b128 v[116:119], v4 offset:304
    s_waitcnt lgkmcnt(3)
    v_mfma_f32_16x16x32_f16 v[104:107], v[56:59], v[92:95], v[104:107]
    ds_read_b64 v[108:109], v6 offset:512
    v_mfma_f32_16x16x32_f16 v[112:115], v[60:63], v[92:95], v[112:115]
    ds_read_b128 v[120:123], v4 offset:368
    s_waitcnt lgkmcnt(4)
    v_mfma_f32_16x16x32_f16 v[104:107], v[64:67], v[96:99], v[104:107]
    ds_read_b64 v[110:111], v6 offset:520
    v_mfma_f32_16x16x32_f16 v[112:115], v[68:71], v[96:99], v[112:115]
    ds_read_b128 v[124:127], v4 offset:432
    s_waitcnt lgkmcnt(5)
    v_mfma_f32_16x16x32_f16 v[104:107], v[72:75], v[100:103], v[104:107]
    v_mfma_f32_16x16x32_f16 v[112:115], v[76:79], v[100:103], v[112:115]
    ds_read_b128 v[52:55], v4 offset:496
    s_waitcnt lgkmcnt(5)
    v_mfma_f32_16x16x32_f16 v[104:107], v[80:83], v[116:119], v[104:107]
    v_mfma_f32_16x16x32_f16 v[112:115], v[84:87], v[116:119], v[112:115]
    ds_read_b128 v[88:91], v4 offset:560
    s_waitcnt lgkmcnt(4)
    v_mfma_f32_16x16x32_f16 v[104:107], v[8:11], v[120:123], v[104:107]
    ds_read_b128 v[60:63], v4 offset:624
    v_mfma_f32_16x16x32_f16 v[112:115], v[16:19], v[120:123], v[112:115]
    ds_read_b128 v[92:95], v4 offset:688
    s_waitcnt lgkmcnt(4)
    s_nop 0
    v_mfma_f32_16x16x32_f16 v[104:107], v[20:23], v[124:127], v[104:107]
    ds_read_b128 v[68:71], v4 offset:752
    v_mfma_f32_16x16x32_f16 v[112:115], v[24:27], v[124:127], v[112:115]
    ds_read_b128 v[96:99], v4 offset:816
    s_nop 0
    s_waitcnt lgkmcnt(5)
    v_mfma_f32_16x16x32_f16 v[104:107], v[28:31], v[52:55], v[104:107]
    ds_read_b128 v[76:79], v4 offset:880
    v_mfma_f32_16x16x32_f16 v[112:115], v[108:111], v[52:55], v[112:115]
    ds_read_b128 v[100:103], v4 offset:944
    s_waitcnt lgkmcnt(6)
    v_mfma_f32_16x16x32_f16 v[112:115], v[48:51], v[88:91], v[112:115]
    ds_read_b128 v[116:119], v4 offset:1008
    s_waitcnt lgkmcnt(6)
    v_mfma_f32_16x16x32_f16 v[112:115], v[56:59], v[60:63], v[112:115]
    ds_read_b64 v[84:85], v7 offset:512
    v_cvt_pk_f16_f32 v104, v104, v105
    v_cvt_pk_f16_f32 v105, v106, v107
    ds_write_b64 v1, v[104:105] offset:0
    s_mov_b64 exec, 1
    ds_add_u32 v3, v0 offset:64
    s_mov_b64 exec, -1
    s_setprio 1
    s_waitcnt lgkmcnt(8)
    v_mfma_f32_16x16x32_f16 v[112:115], v[64:67], v[92:95], v[112:115]
    ds_read_b128 v[120:123], v4 offset:496
    s_waitcnt lgkmcnt(8)
    v_mfma_f32_16x16x32_f16 v[112:115], v[72:75], v[68:71], v[112:115]
    ds_read_b128 v[24:27], v4 offset:480
    s_waitcnt lgkmcnt(8)
    v_mfma_f32_16x16x32_f16 v[112:115], v[80:83], v[96:99], v[112:115]
    ds_read_b128 v[124:127], v4 offset:1536
    s_waitcnt lgkmcnt(8)
    v_mfma_f32_16x16x32_f16 v[112:115], v[8:11], v[76:79], v[112:115]
    ds_read_b128 v[108:111], v4 offset:2048
    s_waitcnt lgkmcnt(8)
    v_mfma_f32_16x16x32_f16 v[112:115], v[20:23], v[100:103], v[112:115]
    ds_read_b128 v[52:55], v4 offset:1008
    s_waitcnt lgkmcnt(8)
    v_mfma_f32_16x16x32_f16 v[112:115], v[28:31], v[116:119], v[112:115]
    ds_read_b128 v[88:91], v4 offset:992
    s_waitcnt lgkmcnt(5)
    v_mfma_f32_16x16x32_f16 v[104:107], v[120:123], v[40:43], 0
    ds_read_b64 v[86:87], v7 offset:520
    s_waitcnt lgkmcnt(5)
    v_mfma_f32_16x16x32_f16 v[92:95], v[24:27], v[44:47], 0
    ds_read_b64 v[16:17], v7 offset:448
    s_waitcnt lgkmcnt(5)
    v_mfma_f32_16x16x32_f16 v[96:99], v[12:15], v[124:127], 0
    ds_read_b64 v[18:19], v7 offset:456
    v_cvt_pk_f16_f32 v112, v112, v113
    v_cvt_pk_f16_f32 v113, v114, v115
    ds_write_b64 v1, v[112:113] offset:512
    s_mov_b64 exec, 1
    ds_add_u32 v3, v0 offset:68
    s_mov_b64 exec, -1
    s_setprio 1
    s_waitcnt lgkmcnt(7)
    v_mfma_f32_16x16x32_f16 v[76:79], v[12:15], v[108:111], 0
    ds_read_b128 v[68:71], v4 offset:1520
    s_waitcnt lgkmcnt(7)
    v_mfma_f32_16x16x32_f16 v[100:103], v[52:55], v[40:43], 0
    ds_read_b64 v[60:61], v7 offset:576
    v_cvt_pkrtz_f16_f32 v104, v104, v92
    v_cvt_pkrtz_f16_f32 v105, v105, v93
    s_waitcnt lgkmcnt(7)
    v_mfma_f32_16x16x32_f16 v[120:123], v[88:91], v[44:47], 0
    ds_read_b128 v[116:119], v4 offset:1504
    v_cvt_pkrtz_f16_f32 v106, v106, v94
    v_cvt_pkrtz_f16_f32 v107, v107, v95
    s_waitcnt lgkmcnt(7)
    s_nop 0
    v_mfma_f32_16x16x32_f16 v[96:99], v[104:107], v[84:87], v[96:99]
    ds_read_b64 v[62:63], v7 offset:584
    s_waitcnt lgkmcnt(6)
    v_mfma_f32_16x16x32_f16 v[76:79], v[104:107], v[16:19], v[76:79]
    ds_read_b64 v[24:25], v7 offset:0
    s_waitcnt lgkmcnt(4)
    v_mfma_f32_16x16x32_f16 v[124:127], v[68:71], v[32:35], 0
    ds_read_b64 v[26:27], v7 offset:8
    v_mfma_f32_16x16x32_f16 v[12:15], v[68:71], v[36:39], 0
    ds_read_b64 v[112:113], v7 offset:640
    v_cvt_pkrtz_f16_f32 v100, v100, v120
    v_mfma_f32_16x16x32_f16 v[52:55], v[68:71], v[40:43], 0
    ds_read_b128 v[108:111], v4 offset:2032
    v_cvt_pkrtz_f16_f32 v101, v101, v121
    s_waitcnt lgkmcnt(5)
    s_nop 0
    v_mfma_f32_16x16x32_f16 v[92:95], v[116:119], v[44:47], 0
    ds_read_b64 v[114:115], v7 offset:648
    v_mfma_f32_16x16x32_f16 v[16:19], v[116:119], v[32:35], 0
    ds_read_b64 v[88:89], v7 offset:192
    v_cvt_pkrtz_f16_f32 v102, v102, v122
    v_mfma_f32_16x16x32_f16 v[68:71], v[116:119], v[36:39], 0
    ds_read_b128 v[104:107], v4 offset:2016
    v_cvt_pkrtz_f16_f32 v103, v103, v123
    s_waitcnt lgkmcnt(7)
    s_nop 0
    v_mfma_f32_16x16x32_f16 v[96:99], v[100:103], v[60:63], v[96:99]
    ds_read_b64 v[90:91], v7 offset:200
    v_mfma_f32_16x16x32_f16 v[76:79], v[100:103], v[84:87], v[76:79]
    ds_read_b64 v[116:117], v7 offset:64
    s_waitcnt lgkmcnt(5)
    s_nop 0
    v_mfma_f32_16x16x32_f16 v[120:123], v[108:111], v[32:35], 0
    ds_read_b64 v[118:119], v7 offset:72
    v_cvt_pkrtz_f16_f32 v124, v124, v12
    v_cvt_pkrtz_f16_f32 v125, v125, v13
    v_mfma_f32_16x16x32_f16 v[84:87], v[108:111], v[36:39], 0
    v_cvt_pkrtz_f16_f32 v126, v126, v14
    v_cvt_pkrtz_f16_f32 v127, v127, v15
    v_mfma_f32_16x16x32_f16 v[100:103], v[108:111], v[40:43], 0
    v_cvt_pkrtz_f16_f32 v52, v52, v92
    v_cvt_pkrtz_f16_f32 v53, v53, v93
    s_nop 0
    s_waitcnt lgkmcnt(3)
    v_mfma_f32_16x16x32_f16 v[40:43], v[104:107], v[44:47], 0
    ds_read_b64 v[12:13], v7 offset:256
    v_cvt_pkrtz_f16_f32 v54, v54, v94
    v_cvt_pkrtz_f16_f32 v55, v55, v95
    v_mfma_f32_16x16x32_f16 v[44:47], v[104:107], v[32:35], 0
    ds_read_b128 v[108:111], v4 offset:2544
    v_cvt_pkrtz_f16_f32 v16, v16, v68
    v_cvt_pkrtz_f16_f32 v17, v17, v69
    v_mfma_f32_16x16x32_f16 v[92:95], v[104:107], v[36:39], 0
    ds_read_b64 v[14:15], v7 offset:264
    v_cvt_pkrtz_f16_f32 v18, v18, v70
    v_cvt_pkrtz_f16_f32 v19, v19, v71
    v_mfma_f32_16x16x32_f16 v[96:99], v[124:127], v[24:27], v[96:99]
    ds_read_b128 v[68:71], v4 offset:2528
    v_mfma_f32_16x16x32_f16 v[96:99], v[52:55], v[112:115], v[96:99]
    ds_read_b64 v[104:105], v6 offset:0
    v_mfma_f32_16x16x32_f16 v[76:79], v[52:55], v[60:63], v[76:79]
    ds_read_b64 v[106:107], v6 offset:8
    s_waitcnt lgkmcnt(8)
    v_mfma_f32_16x16x32_f16 v[96:99], v[16:19], v[88:91], v[96:99]
    ds_read_b64 v[124:125], v6 offset:64
    s_waitcnt lgkmcnt(5)
    v_mfma_f32_16x16x32_f16 v[52:55], v[108:111], v[32:35], 0
    ds_read_b64 v[126:127], v6 offset:72
    v_cvt_pkrtz_f16_f32 v120, v120, v84
    v_cvt_pkrtz_f16_f32 v121, v121, v85
    v_cvt_pkrtz_f16_f32 v122, v122, v86
    v_mfma_f32_16x16x32_f16 v[16:19], v[108:111], v[36:39], 0
    ds_read_b64 v[60:61], v6 offset:128
    v_cvt_pkrtz_f16_f32 v123, v123, v87
    v_cvt_pkrtz_f16_f32 v100, v100, v40
    v_cvt_pkrtz_f16_f32 v101, v101, v41
    s_nop 0
    s_waitcnt lgkmcnt(5)
    v_mfma_f32_16x16x32_f16 v[108:111], v[68:71], v[32:35], 0
    ds_read_b64 v[62:63], v6 offset:136
    v_cvt_pkrtz_f16_f32 v102, v102, v42
    v_cvt_pkrtz_f16_f32 v103, v103, v43
    v_cvt_pkrtz_f16_f32 v44, v44, v92
    v_mfma_f32_16x16x32_f16 v[40:43], v[68:71], v[36:39], 0
    ds_read_b128 v[84:87], v4 offset:2544
    v_cvt_pkrtz_f16_f32 v45, v45, v93
    v_cvt_pkrtz_f16_f32 v46, v46, v94
    v_cvt_pkrtz_f16_f32 v47, v47, v95
    v_mfma_f32_16x16x32_f16 v[96:99], v[120:123], v[116:119], v[96:99]
    ds_read_b128 v[68:71], v4 offset:2608
    v_mfma_f32_16x16x32_f16 v[76:79], v[120:123], v[24:27], v[76:79]
    ds_read_b128 v[92:95], v4 offset:2672
    ds_read_b128 v[24:27], v4 offset:2736
    v_mfma_f32_16x16x32_f16 v[76:79], v[100:103], v[112:115], v[76:79]
    ds_read_b64 v[120:121], v6 offset:192
    ds_read_b64 v[122:123], v6 offset:200
    v_mfma_f32_16x16x32_f16 v[96:99], v[44:47], v[12:15], v[96:99]
    ds_read_b64 v[112:113], v7 offset:128
    v_mfma_f32_16x16x32_f16 v[76:79], v[44:47], v[88:91], v[76:79]
    ds_read_b64 v[114:115], v7 offset:136
    ds_read_b64 v[100:101], v7 offset:320
    s_waitcnt lgkmcnt(13)
    s_waitcnt lgkmcnt(8)
    v_mfma_f32_16x16x32_f16 v[96:99], v[104:107], v[84:87], v[96:99]
    ds_read_b64 v[102:103], v7 offset:328
    ds_read_b64 v[88:89], v6 offset:256
    v_cvt_pkrtz_f16_f32 v52, v52, v16
    v_cvt_pkrtz_f16_f32 v53, v53, v17
    s_nop 0
    s_waitcnt lgkmcnt(9)
    v_mfma_f32_16x16x32_f16 v[96:99], v[124:127], v[68:71], v[96:99]
    ds_read_b64 v[90:91], v6 offset:264
    ds_read_b64 v[44:45], v6 offset:320
    v_cvt_pkrtz_f16_f32 v54, v54, v18
    v_cvt_pkrtz_f16_f32 v55, v55, v19
    s_nop 0
    s_waitcnt lgkmcnt(10)
    v_mfma_f32_16x16x32_f16 v[96:99], v[60:63], v[92:95], v[96:99]
    ds_read_b128 v[16:19], v4 offset:2800
    ds_read_b64 v[46:47], v6 offset:328
    v_cvt_pkrtz_f16_f32 v108, v108, v40
    v_cvt_pkrtz_f16_f32 v109, v109, v41
    s_nop 0
    s_waitcnt lgkmcnt(9)
    v_mfma_f32_16x16x32_f16 v[96:99], v[120:123], v[24:27], v[96:99]
    ds_read_b128 v[92:95], v4 offset:2864
    ds_read_b64 v[84:85], v6 offset:384
    v_cvt_pkrtz_f16_f32 v110, v110, v42
    v_cvt_pkrtz_f16_f32 v111, v111, v43
    s_nop 0
    s_waitcnt lgkmcnt(9)
    v_mfma_f32_16x16x32_f16 v[96:99], v[52:55], v[112:115], v[96:99]
    ds_read_b64 v[86:87], v6 offset:392
    ds_read_b128 v[24:27], v4 offset:2928
    ds_read_b64 v[68:69], v6 offset:448
    v_mfma_f32_16x16x32_f16 v[76:79], v[52:55], v[116:119], v[76:79]
    ds_read_b64 v[70:71], v6 offset:456
    ds_read_b128 v[40:43], v4 offset:2992
    ds_read_b128 v[116:119], v4 offset:3056
    s_waitcnt lgkmcnt(13)
    s_nop 0
    v_mfma_f32_16x16x32_f16 v[96:99], v[108:111], v[100:103], v[96:99]
    ds_read_b64 v[52:53], v6 offset:512
    v_mfma_f32_16x16x32_f16 v[76:79], v[108:111], v[12:15], v[76:79]
    ds_read_b64 v[54:55], v6 offset:520
    s_waitcnt lgkmcnt(13)
    s_waitcnt lgkmcnt(11)
    v_mfma_f32_16x16x32_f16 v[96:99], v[88:91], v[16:19], v[96:99]
    ds_read_b128 v[12:15], v4 offset:3120
    s_waitcnt lgkmcnt(11)
    s_waitcnt lgkmcnt(10)
    v_mfma_f32_16x16x32_f16 v[96:99], v[44:47], v[92:95], v[96:99]
    ds_read_b128 v[108:111], v4 offset:3184
    s_waitcnt lgkmcnt(9)
    s_waitcnt lgkmcnt(8)
    v_mfma_f32_16x16x32_f16 v[96:99], v[84:87], v[24:27], v[96:99]
    s_waitcnt lgkmcnt(6)
    s_waitcnt lgkmcnt(5)
    v_mfma_f32_16x16x32_f16 v[96:99], v[68:71], v[40:43], v[96:99]
    ds_read_b128 v[16:19], v4 offset:3248
    s_waitcnt lgkmcnt(3)
    v_mfma_f32_16x16x32_f16 v[96:99], v[52:55], v[116:119], v[96:99]
    v_mfma_f32_16x16x32_f16 v[76:79], v[104:107], v[116:119], v[76:79]
    ds_read_b128 v[92:95], v4 offset:3312
    s_waitcnt lgkmcnt(3)
    v_mfma_f32_16x16x32_f16 v[96:99], v[48:51], v[12:15], v[96:99]
    v_mfma_f32_16x16x32_f16 v[76:79], v[124:127], v[12:15], v[76:79]
    ds_read_b128 v[24:27], v4 offset:3376
    s_waitcnt lgkmcnt(3)
    v_mfma_f32_16x16x32_f16 v[96:99], v[56:59], v[108:111], v[96:99]
    v_mfma_f32_16x16x32_f16 v[76:79], v[60:63], v[108:111], v[76:79]
    ds_read_b128 v[40:43], v4 offset:3440
    s_waitcnt lgkmcnt(3)
    v_mfma_f32_16x16x32_f16 v[96:99], v[64:67], v[16:19], v[96:99]
    v_mfma_f32_16x16x32_f16 v[76:79], v[120:123], v[16:19], v[76:79]
    ds_read_b128 v[104:107], v4 offset:3504
    s_waitcnt lgkmcnt(3)
    v_mfma_f32_16x16x32_f16 v[96:99], v[72:75], v[92:95], v[96:99]
    v_mfma_f32_16x16x32_f16 v[76:79], v[88:91], v[92:95], v[76:79]
    ds_read_b128 v[116:119], v4 offset:3568
    s_waitcnt lgkmcnt(3)
    v_mfma_f32_16x16x32_f16 v[96:99], v[80:83], v[24:27], v[96:99]
    v_mfma_f32_16x16x32_f16 v[76:79], v[44:47], v[24:27], v[76:79]
    ds_read_b128 v[124:127], v4 offset:3632
    s_waitcnt lgkmcnt(3)
    v_mfma_f32_16x16x32_f16 v[96:99], v[8:11], v[40:43], v[96:99]
    ds_read_b128 v[12:15], v4 offset:3696
    v_mfma_f32_16x16x32_f16 v[76:79], v[84:87], v[40:43], v[76:79]
    ds_read_b128 v[60:63], v4 offset:3056
    s_waitcnt lgkmcnt(4)
    v_mfma_f32_16x16x32_f16 v[96:99], v[20:23], v[104:107], v[96:99]
    v_mfma_f32_16x16x32_f16 v[76:79], v[68:71], v[104:107], v[76:79]
    ds_read_b128 v[108:111], v4 offset:3040
    s_waitcnt lgkmcnt(4)
    v_mfma_f32_16x16x32_f16 v[96:99], v[28:31], v[116:119], v[96:99]
    v_mfma_f32_16x16x32_f16 v[76:79], v[52:55], v[116:119], v[76:79]
    ds_read_b128 v[120:123], v4 offset:3760
    s_waitcnt lgkmcnt(4)
    v_mfma_f32_16x16x32_f16 v[76:79], v[48:51], v[124:127], v[76:79]
    ds_read_b128 v[16:19], v4 offset:3824
    s_waitcnt lgkmcnt(4)
    v_mfma_f32_16x16x32_f16 v[76:79], v[56:59], v[12:15], v[76:79]
    s_nop 0
    v_cvt_pk_f16_f32 v96, v96, v97
    v_cvt_pk_f16_f32 v97, v98, v99
    ds_write_b64 v1, v[96:97] offset:1024
    s_mov_b64 exec, 1
    ds_add_u32 v3, v0 offset:72
    s_mov_b64 exec, -1
    s_setprio 1
    s_waitcnt lgkmcnt(5)
    v_mfma_f32_16x16x32_f16 v[92:95], v[60:63], v[32:35], 0
    ds_read_b128 v[88:91], v4 offset:3888
    v_mfma_f32_16x16x32_f16 v[24:27], v[60:63], v[36:39], 0
    ds_read_b128 v[44:47], v4 offset:3952
    s_nop 0
    s_waitcnt lgkmcnt(6)
    v_mfma_f32_16x16x32_f16 v[40:43], v[108:111], v[32:35], 0
    ds_read_b128 v[84:87], v4 offset:4016
    v_mfma_f32_16x16x32_f16 v[104:107], v[108:111], v[36:39], 0
    ds_read_b128 v[68:71], v4 offset:4080
    s_waitcnt lgkmcnt(7)
    v_mfma_f32_16x16x32_f16 v[76:79], v[64:67], v[120:123], v[76:79]
    s_waitcnt lgkmcnt(6)
    v_mfma_f32_16x16x32_f16 v[76:79], v[72:75], v[16:19], v[76:79]
    s_waitcnt lgkmcnt(3)
    v_mfma_f32_16x16x32_f16 v[76:79], v[80:83], v[88:91], v[76:79]
    v_cvt_pkrtz_f16_f32 v92, v92, v24
    v_cvt_pkrtz_f16_f32 v93, v93, v25
    s_waitcnt lgkmcnt(2)
    v_mfma_f32_16x16x32_f16 v[76:79], v[8:11], v[44:47], v[76:79]
    v_cvt_pkrtz_f16_f32 v94, v94, v26
    v_cvt_pkrtz_f16_f32 v95, v95, v27
    s_waitcnt lgkmcnt(1)
    v_mfma_f32_16x16x32_f16 v[76:79], v[20:23], v[84:87], v[76:79]
    v_cvt_pkrtz_f16_f32 v40, v40, v104
    v_cvt_pkrtz_f16_f32 v41, v41, v105
    s_waitcnt lgkmcnt(0)
    v_mfma_f32_16x16x32_f16 v[76:79], v[28:31], v[68:71], v[76:79]
    v_cvt_pkrtz_f16_f32 v42, v42, v106
    v_cvt_pkrtz_f16_f32 v43, v43, v107
    v_mfma_f32_16x16x32_f16 v[76:79], v[92:95], v[112:115], v[76:79]
    s_nop 0
    v_mfma_f32_16x16x32_f16 v[76:79], v[40:43], v[100:103], v[76:79]
    s_nop 7
    v_cvt_pk_f16_f32 v76, v76, v77
    v_cvt_pk_f16_f32 v77, v78, v79
    ds_write_b64 v1, v[76:77] offset:1536
    s_mov_b64 exec, 1
    ds_add_u32 v3, v0 offset:76
    s_mov_b64 exec, -1
    s_branch L_fin
    s_nop 0
L_set1_47:
    ds_read_b64 v[48:49], v7 offset:128
    ds_read_b64 v[50:51], v7 offset:136
    ds_read_b64 v[52:53], v7 offset:64
    ds_read_b64 v[54:55], v7 offset:72
    ds_read_b64 v[56:57], v7 offset:0
    ds_read_b64 v[58:59], v7 offset:8
    ds_read_b64 v[60:61], v7 offset:640
    ds_read_b64 v[62:63], v7 offset:648
    ds_read_b64 v[64:65], v7 offset:576
    ds_read_b64 v[66:67], v7 offset:584
    ds_read_b64 v[68:69], v7 offset:320
    ds_read_b64 v[70:71], v7 offset:328
    ds_read_b64 v[72:73], v7 offset:256
    ds_read_b64 v[74:75], v7 offset:264
    ds_read_b64 v[76:77], v7 offset:192
    ds_read_b64 v[78:79], v7 offset:200
    s_mov_b32 s46, 0
L_sp_50:
    ds_read_b32 v5, v3 offset:48
    s_waitcnt lgkmcnt(0)
    v_cmp_gt_u32 vcc, 4, v5
    s_cbranch_vccz L_spd_51
    s_add_u32 s46, s46, 1
    s_sleep 2
    s_cmp_lt_u32 s46, 400000
    s_cbranch_scc1 L_sp_50
    s_branch L_end
L_spd_51:
    s_setprio 2
    ds_read_b128 v[80:83], v4 offset:496
    ds_read_b128 v[84:87], v4 offset:480
    s_waitcnt lgkmcnt(1)
    v_mfma_f32_16x16x32_f16 v[16:19], v[80:83], v[32:35], 0
    ds_read_b128 v[8:11], v4 offset:512
    v_mfma_f32_16x16x32_f16 v[24:27], v[80:83], v[36:39], 0
    ds_read_b128 v[20:23], v4 offset:1024
    v_mfma_f32_16x16x32_f16 v[88:91], v[80:83], v[40:43], 0
    ds_read_b128 v[28:31], v4 offset:1008
    s_nop 0
    s_waitcnt lgkmcnt(3)
    v_mfma_f32_16x16x32_f16 v[92:95], v[84:87], v[44:47], 0
    v_mfma_f32_16x16x32_f16 v[96:99], v[84:87], v[32:35], 0
    ds_read_b128 v[100:103], v4 offset:992
    v_mfma_f32_16x16x32_f16 v[104:107], v[84:87], v[36:39], 0
    s_waitcnt lgkmcnt(3)
    v_mfma_f32_16x16x32_f16 v[108:111], v[12:15], v[8:11], 0
    s_waitcnt lgkmcnt(2)
    v_mfma_f32_16x16x32_f16 v[112:115], v[12:15], v[20:23], 0
    ds_read_b64 v[116:117], v6 offset:0
    s_waitcnt lgkmcnt(2)
    s_nop 0
    v_mfma_f32_16x16x32_f16 v[120:123], v[28:31], v[32:35], 0
    ds_read_b64 v[118:119], v6 offset:8
    v_cvt_pkrtz_f16_f32 v16, v16, v24
    v_cvt_pkrtz_f16_f32 v17, v17, v25
    v_mfma_f32_16x16x32_f16 v[80:83], v[28:31], v[36:39], 0
    ds_read_b64 v[124:125], v6 offset:64
    v_cvt_pkrtz_f16_f32 v18, v18, v26
    v_cvt_pkrtz_f16_f32 v19, v19, v27
    v_mfma_f32_16x16x32_f16 v[8:11], v[28:31], v[40:43], 0
    ds_read_b64 v[126:127], v6 offset:72
    v_cvt_pkrtz_f16_f32 v88, v88, v92
    v_cvt_pkrtz_f16_f32 v89, v89, v93
    s_nop 0
    s_waitcnt lgkmcnt(4)
    v_mfma_f32_16x16x32_f16 v[20:23], v[100:103], v[44:47], 0
    ds_read_b64 v[84:85], v6 offset:128
    v_cvt_pkrtz_f16_f32 v90, v90, v94
    v_cvt_pkrtz_f16_f32 v91, v91, v95
    v_mfma_f32_16x16x32_f16 v[24:27], v[100:103], v[32:35], 0
    ds_read_b64 v[86:87], v6 offset:136
    v_cvt_pkrtz_f16_f32 v96, v96, v104
    v_cvt_pkrtz_f16_f32 v97, v97, v105
    v_mfma_f32_16x16x32_f16 v[40:43], v[100:103], v[36:39], 0
    ds_read_b64 v[12:13], v6 offset:192
    v_cvt_pkrtz_f16_f32 v98, v98, v106
    v_cvt_pkrtz_f16_f32 v99, v99, v107
    v_mfma_f32_16x16x32_f16 v[28:31], v[16:19], v[48:51], 0
    ds_read_b64 v[14:15], v6 offset:200
    v_mfma_f32_16x16x32_f16 v[44:47], v[16:19], v[52:55], 0
    ds_read_b128 v[92:95], v4 offset:496
    v_mfma_f32_16x16x32_f16 v[108:111], v[16:19], v[56:59], v[108:111]
    ds_read_b128 v[100:103], v4 offset:560
    v_mfma_f32_16x16x32_f16 v[108:111], v[88:91], v[60:63], v[108:111]
    ds_read_b128 v[104:107], v4 offset:624
    v_mfma_f32_16x16x32_f16 v[112:115], v[88:91], v[64:67], v[112:115]
    ds_read_b128 v[16:19], v4 offset:688
    v_mfma_f32_16x16x32_f16 v[28:31], v[96:99], v[68:71], v[28:31]
    ds_read_b64 v[64:65], v6 offset:256
    v_mfma_f32_16x16x32_f16 v[44:47], v[96:99], v[72:75], v[44:47]
    ds_read_b64 v[66:67], v6 offset:264
    v_mfma_f32_16x16x32_f16 v[108:111], v[96:99], v[76:79], v[108:111]
    ds_read_b64 v[88:89], v6 offset:320
    s_waitcnt lgkmcnt(13)
    s_waitcnt lgkmcnt(6)
    v_mfma_f32_16x16x32_f16 v[28:31], v[116:119], v[92:95], v[28:31]
    ds_read_b64 v[90:91], v6 offset:328
    v_cvt_pkrtz_f16_f32 v120, v120, v80
    v_cvt_pkrtz_f16_f32 v121, v121, v81
    v_cvt_pkrtz_f16_f32 v122, v122, v82
    s_waitcnt lgkmcnt(6)
    v_mfma_f32_16x16x32_f16 v[28:31], v[124:127], v[100:103], v[28:31]
    ds_read_b64 v[96:97], v6 offset:384
    v_cvt_pkrtz_f16_f32 v123, v123, v83
    v_cvt_pkrtz_f16_f32 v8, v8, v20
    v_cvt_pkrtz_f16_f32 v9, v9, v21
    s_waitcnt lgkmcnt(6)
    v_mfma_f32_16x16x32_f16 v[28:31], v[84:87], v[104:107], v[28:31]
    ds_read_b64 v[98:99], v6 offset:392
    v_cvt_pkrtz_f16_f32 v10, v10, v22
    v_cvt_pkrtz_f16_f32 v11, v11, v23
    v_cvt_pkrtz_f16_f32 v24, v24, v40
    s_nop 0
    s_waitcnt lgkmcnt(6)
    v_mfma_f32_16x16x32_f16 v[28:31], v[12:15], v[16:19], v[28:31]
    ds_read_b64 v[92:93], v6 offset:448
    v_cvt_pkrtz_f16_f32 v25, v25, v41
    v_cvt_pkrtz_f16_f32 v26, v26, v42
    v_cvt_pkrtz_f16_f32 v27, v27, v43
    v_mfma_f32_16x16x32_f16 v[44:47], v[120:123], v[48:51], v[44:47]
    ds_read_b128 v[104:107], v4 offset:752
    v_mfma_f32_16x16x32_f16 v[108:111], v[120:123], v[52:55], v[108:111]
    ds_read_b128 v[16:19], v4 offset:816
    v_mfma_f32_16x16x32_f16 v[112:115], v[120:123], v[56:59], v[112:115]
    ds_read_b128 v[40:43], v4 offset:880
    v_mfma_f32_16x16x32_f16 v[112:115], v[8:11], v[60:63], v[112:115]
    ds_read_b64 v[94:95], v6 offset:456
    v_mfma_f32_16x16x32_f16 v[44:47], v[24:27], v[68:71], v[44:47]
    ds_read_b128 v[120:123], v4 offset:944
    ds_read_b64 v[100:101], v6 offset:512
    v_mfma_f32_16x16x32_f16 v[108:111], v[24:27], v[72:75], v[108:111]
    ds_read_b64 v[102:103], v6 offset:520
    v_mfma_f32_16x16x32_f16 v[112:115], v[24:27], v[76:79], v[112:115]
    ds_read_b128 v[60:63], v4 offset:1008
    ds_read_b64 v[80:81], v6 offset:576
    s_waitcnt lgkmcnt(14)
    s_waitcnt lgkmcnt(8)
    v_mfma_f32_16x16x32_f16 v[28:31], v[64:67], v[104:107], v[28:31]
    ds_read_b64 v[82:83], v6 offset:584
    s_waitcnt lgkmcnt(8)
    v_mfma_f32_16x16x32_f16 v[28:31], v[88:91], v[16:19], v[28:31]
    ds_read_b128 v[76:79], v4 offset:1072
    ds_read_b64 v[20:21], v6 offset:640
    s_waitcnt lgkmcnt(9)
    v_mfma_f32_16x16x32_f16 v[28:31], v[96:99], v[40:43], v[28:31]
    ds_read_b64 v[22:23], v6 offset:648
    s_waitcnt lgkmcnt(9)
    s_waitcnt lgkmcnt(8)
    v_mfma_f32_16x16x32_f16 v[28:31], v[92:95], v[120:123], v[28:31]
    ds_read_b128 v[104:107], v4 offset:1136
    ds_read_b64 v[56:57], v6 offset:704
    s_waitcnt lgkmcnt(8)
    s_waitcnt lgkmcnt(7)
    v_mfma_f32_16x16x32_f16 v[28:31], v[100:103], v[60:63], v[28:31]
    ds_read_b64 v[58:59], v6 offset:712
    v_mfma_f32_16x16x32_f16 v[44:47], v[116:119], v[60:63], v[44:47]
    ds_read_b128 v[40:43], v4 offset:1200
    ds_read_b64 v[8:9], v6 offset:768
    s_waitcnt lgkmcnt(8)
    s_waitcnt lgkmcnt(7)
    v_mfma_f32_16x16x32_f16 v[28:31], v[80:83], v[76:79], v[28:31]
    ds_read_b64 v[10:11], v6 offset:776
    v_mfma_f32_16x16x32_f16 v[44:47], v[124:127], v[76:79], v[44:47]
    ds_read_b128 v[60:63], v4 offset:1264
    ds_read_b64 v[24:25], v6 offset:832
    s_waitcnt lgkmcnt(8)
    s_waitcnt lgkmcnt(7)
    v_mfma_f32_16x16x32_f16 v[28:31], v[20:23], v[104:107], v[28:31]
    ds_read_b64 v[26:27], v6 offset:840
    v_mfma_f32_16x16x32_f16 v[44:47], v[84:87], v[104:107], v[44:47]
    ds_read_b128 v[76:79], v4 offset:1328
    ds_read_b64 v[16:17], v6 offset:896
    s_waitcnt lgkmcnt(8)
    s_waitcnt lgkmcnt(7)
    v_mfma_f32_16x16x32_f16 v[28:31], v[56:59], v[40:43], v[28:31]
    ds_read_b64 v[18:19], v6 offset:904
    v_mfma_f32_16x16x32_f16 v[44:47], v[12:15], v[40:43], v[44:47]
    ds_read_b128 v[104:107], v4 offset:1392
    ds_read_b64 v[120:121], v6 offset:960
    s_waitcnt lgkmcnt(8)
    s_waitcnt lgkmcnt(7)
    v_mfma_f32_16x16x32_f16 v[28:31], v[8:11], v[60:63], v[28:31]
    ds_read_b64 v[122:123], v6 offset:968
    v_mfma_f32_16x16x32_f16 v[44:47], v[64:67], v[60:63], v[44:47]
    ds_read_b128 v[40:43], v4 offset:1456
    s_waitcnt lgkmcnt(7)
    s_waitcnt lgkmcnt(6)
    v_mfma_f32_16x16x32_f16 v[28:31], v[24:27], v[76:79], v[28:31]
    ds_read_b128 v[60:63], v4 offset:1520
    v_mfma_f32_16x16x32_f16 v[44:47], v[88:91], v[76:79], v[44:47]
    ds_read_b64 v[76:77], v6 offset:1024
    ds_read_b64 v[78:79], v6 offset:1032
    s_waitcnt lgkmcnt(7)
    s_waitcnt lgkmcnt(6)
    v_mfma_f32_16x16x32_f16 v[28:31], v[16:19], v[104:107], v[28:31]
    v_mfma_f32_16x16x32_f16 v[44:47], v[96:99], v[104:107], v[44:47]
    ds_read_b128 v[104:107], v4 offset:1584
    s_waitcnt lgkmcnt(5)
    s_waitcnt lgkmcnt(4)
    v_mfma_f32_16x16x32_f16 v[28:31], v[120:123], v[40:43], v[28:31]
    v_mfma_f32_16x16x32_f16 v[44:47], v[92:95], v[40:43], v[44:47]
    ds_read_b128 v[40:43], v4 offset:1648
    s_nop 0
    s_waitcnt lgkmcnt(2)
    v_mfma_f32_16x16x32_f16 v[28:31], v[76:79], v[60:63], v[28:31]
    v_mfma_f32_16x16x32_f16 v[44:47], v[100:103], v[60:63], v[44:47]
    v_mfma_f32_16x16x32_f16 v[108:111], v[116:119], v[60:63], v[108:111]
    ds_read_b128 v[60:63], v4 offset:1712
    s_waitcnt lgkmcnt(2)
    v_mfma_f32_16x16x32_f16 v[44:47], v[80:83], v[104:107], v[44:47]
    s_nop 2
    v_cvt_pk_f16_f32 v28, v28, v29
    v_cvt_pk_f16_f32 v29, v30, v31
    ds_write_b64 v1, v[28:29] offset:0
    s_mov_b64 exec, 1
    ds_add_u32 v3, v0 offset:64
    s_mov_b64 exec, -1
    s_setprio 1
    v_mfma_f32_16x16x32_f16 v[108:111], v[124:127], v[104:107], v[108:111]
    ds_read_b128 v[28:31], v4 offset:1776
    s_waitcnt lgkmcnt(4)
    v_mfma_f32_16x16x32_f16 v[44:47], v[20:23], v[40:43], v[44:47]
    ds_read_b128 v[104:107], v4 offset:1840
    v_mfma_f32_16x16x32_f16 v[108:111], v[84:87], v[40:43], v[108:111]
    ds_read_b128 v[40:43], v4 offset:1904
    s_waitcnt lgkmcnt(5)
    v_mfma_f32_16x16x32_f16 v[44:47], v[56:59], v[60:63], v[44:47]
    v_mfma_f32_16x16x32_f16 v[108:111], v[12:15], v[60:63], v[108:111]
    ds_read_b128 v[60:63], v4 offset:1968
    s_waitcnt lgkmcnt(3)
    v_mfma_f32_16x16x32_f16 v[44:47], v[8:11], v[28:31], v[44:47]
    v_mfma_f32_16x16x32_f16 v[108:111], v[64:67], v[28:31], v[108:111]
    ds_read_b128 v[28:31], v4 offset:2032
    s_waitcnt lgkmcnt(3)
    v_mfma_f32_16x16x32_f16 v[44:47], v[24:27], v[104:107], v[44:47]
    v_mfma_f32_16x16x32_f16 v[108:111], v[88:91], v[104:107], v[108:111]
    s_waitcnt lgkmcnt(2)
    v_mfma_f32_16x16x32_f16 v[44:47], v[16:19], v[40:43], v[44:47]
    ds_read_b128 v[104:107], v4 offset:2096
    v_mfma_f32_16x16x32_f16 v[108:111], v[96:99], v[40:43], v[108:111]
    s_waitcnt lgkmcnt(2)
    v_mfma_f32_16x16x32_f16 v[44:47], v[120:123], v[60:63], v[44:47]
    ds_read_b128 v[40:43], v4 offset:2160
    v_mfma_f32_16x16x32_f16 v[108:111], v[92:95], v[60:63], v[108:111]
    s_waitcnt lgkmcnt(2)
    v_mfma_f32_16x16x32_f16 v[44:47], v[76:79], v[28:31], v[44:47]
    ds_read_b128 v[60:63], v4 offset:2224
    v_mfma_f32_16x16x32_f16 v[108:111], v[100:103], v[28:31], v[108:111]
    v_mfma_f32_16x16x32_f16 v[112:115], v[116:119], v[28:31], v[112:115]
    ds_read_b128 v[116:119], v4 offset:1520
    s_waitcnt lgkmcnt(3)
    v_mfma_f32_16x16x32_f16 v[108:111], v[80:83], v[104:107], v[108:111]
    s_nop 1
    v_cvt_pk_f16_f32 v44, v44, v45
    v_cvt_pk_f16_f32 v45, v46, v47
    ds_write_b64 v1, v[44:45] offset:512
    s_nop 0
    s_mov_b64 exec, 1
    ds_add_u32 v3, v0 offset:68
    s_mov_b64 exec, -1
    s_setprio 1
    v_mfma_f32_16x16x32_f16 v[112:115], v[124:127], v[104:107], v[112:115]
    ds_read_b128 v[28:31], v4 offset:1504
    s_waitcnt lgkmcnt(5)
    v_mfma_f32_16x16x32_f16 v[108:111], v[20:23], v[40:43], v[108:111]
    v_mfma_f32_16x16x32_f16 v[112:115], v[84:87], v[40:43], v[112:115]
    ds_read_b128 v[44:47], v4 offset:2288
    s_waitcnt lgkmcnt(5)
    v_mfma_f32_16x16x32_f16 v[108:111], v[56:59], v[60:63], v[108:111]
    v_mfma_f32_16x16x32_f16 v[112:115], v[12:15], v[60:63], v[112:115]
    ds_read_b128 v[124:127], v4 offset:2352
    s_waitcnt lgkmcnt(5)
    v_mfma_f32_16x16x32_f16 v[104:107], v[116:119], v[32:35], 0
    v_mfma_f32_16x16x32_f16 v[84:87], v[116:119], v[36:39], 0
    ds_read_b128 v[40:43], v4 offset:2416
    s_waitcnt lgkmcnt(3)
    v_mfma_f32_16x16x32_f16 v[12:15], v[28:31], v[32:35], 0
    v_mfma_f32_16x16x32_f16 v[60:63], v[28:31], v[36:39], 0
    ds_read_b128 v[116:119], v4 offset:2480
    s_waitcnt lgkmcnt(3)
    v_mfma_f32_16x16x32_f16 v[108:111], v[8:11], v[44:47], v[108:111]
    v_mfma_f32_16x16x32_f16 v[112:115], v[64:67], v[44:47], v[112:115]
    ds_read_b128 v[28:31], v4 offset:2544
    s_waitcnt lgkmcnt(3)
    v_mfma_f32_16x16x32_f16 v[108:111], v[24:27], v[124:127], v[108:111]
    v_cvt_pkrtz_f16_f32 v104, v104, v84
    v_cvt_pkrtz_f16_f32 v105, v105, v85
    v_mfma_f32_16x16x32_f16 v[112:115], v[88:91], v[124:127], v[112:115]
    v_cvt_pkrtz_f16_f32 v106, v106, v86
    v_cvt_pkrtz_f16_f32 v107, v107, v87
    s_waitcnt lgkmcnt(2)
    s_nop 0
    v_mfma_f32_16x16x32_f16 v[108:111], v[16:19], v[40:43], v[108:111]
    v_cvt_pkrtz_f16_f32 v12, v12, v60
    v_cvt_pkrtz_f16_f32 v13, v13, v61
    v_mfma_f32_16x16x32_f16 v[112:115], v[96:99], v[40:43], v[112:115]
    v_cvt_pkrtz_f16_f32 v14, v14, v62
    v_cvt_pkrtz_f16_f32 v15, v15, v63
    s_nop 0
    s_waitcnt lgkmcnt(1)
    v_mfma_f32_16x16x32_f16 v[108:111], v[120:123], v[116:119], v[108:111]
    v_mfma_f32_16x16x32_f16 v[112:115], v[92:95], v[116:119], v[112:115]
    ds_read_b128 v[64:67], v4 offset:2608
    s_nop 0
    s_waitcnt lgkmcnt(1)
    v_mfma_f32_16x16x32_f16 v[108:111], v[76:79], v[28:31], v[108:111]
    ds_read_b128 v[44:47], v4 offset:2672
    v_mfma_f32_16x16x32_f16 v[112:115], v[100:103], v[28:31], v[112:115]
    ds_read_b128 v[88:91], v4 offset:2032
    v_mfma_f32_16x16x32_f16 v[108:111], v[104:107], v[48:51], v[108:111]
    v_mfma_f32_16x16x32_f16 v[112:115], v[104:107], v[52:55], v[112:115]
    ds_read_b128 v[124:127], v4 offset:2016
    v_mfma_f32_16x16x32_f16 v[108:111], v[12:15], v[68:71], v[108:111]
    v_mfma_f32_16x16x32_f16 v[112:115], v[12:15], v[72:75], v[112:115]
    ds_read_b128 v[84:87], v4 offset:2736
    s_waitcnt lgkmcnt(4)
    v_mfma_f32_16x16x32_f16 v[112:115], v[80:83], v[64:67], v[112:115]
    ds_read_b128 v[96:99], v4 offset:2800
    s_waitcnt lgkmcnt(4)
    v_mfma_f32_16x16x32_f16 v[112:115], v[20:23], v[44:47], v[112:115]
    s_nop 0
    s_nop 0
    v_cvt_pk_f16_f32 v108, v108, v109
    v_cvt_pk_f16_f32 v109, v110, v111
    ds_write_b64 v1, v[108:109] offset:1024
    s_mov_b64 exec, 1
    ds_add_u32 v3, v0 offset:72
    s_mov_b64 exec, -1
    s_setprio 1
    s_waitcnt lgkmcnt(5)
    v_mfma_f32_16x16x32_f16 v[60:63], v[88:91], v[32:35], 0
    ds_read_b128 v[40:43], v4 offset:2864
    v_mfma_f32_16x16x32_f16 v[116:119], v[88:91], v[36:39], 0
    ds_read_b128 v[92:95], v4 offset:2928
    s_nop 0
    s_waitcnt lgkmcnt(6)
    v_mfma_f32_16x16x32_f16 v[28:31], v[124:127], v[32:35], 0
    ds_read_b128 v[100:103], v4 offset:2992
    v_mfma_f32_16x16x32_f16 v[104:107], v[124:127], v[36:39], 0
    ds_read_b128 v[52:55], v4 offset:3056
    s_waitcnt lgkmcnt(7)
    v_mfma_f32_16x16x32_f16 v[112:115], v[56:59], v[84:87], v[112:115]
    s_waitcnt lgkmcnt(6)
    v_mfma_f32_16x16x32_f16 v[112:115], v[8:11], v[96:99], v[112:115]
    s_waitcnt lgkmcnt(3)
    v_mfma_f32_16x16x32_f16 v[112:115], v[24:27], v[40:43], v[112:115]
    v_cvt_pkrtz_f16_f32 v60, v60, v116
    v_cvt_pkrtz_f16_f32 v61, v61, v117
    s_waitcnt lgkmcnt(2)
    v_mfma_f32_16x16x32_f16 v[112:115], v[16:19], v[92:95], v[112:115]
    v_cvt_pkrtz_f16_f32 v62, v62, v118
    v_cvt_pkrtz_f16_f32 v63, v63, v119
    s_waitcnt lgkmcnt(1)
    v_mfma_f32_16x16x32_f16 v[112:115], v[120:123], v[100:103], v[112:115]
    v_cvt_pkrtz_f16_f32 v28, v28, v104
    v_cvt_pkrtz_f16_f32 v29, v29, v105
    s_waitcnt lgkmcnt(0)
    v_mfma_f32_16x16x32_f16 v[112:115], v[76:79], v[52:55], v[112:115]
    v_cvt_pkrtz_f16_f32 v30, v30, v106
    v_cvt_pkrtz_f16_f32 v31, v31, v107
    v_mfma_f32_16x16x32_f16 v[112:115], v[60:63], v[48:51], v[112:115]
    s_nop 0
    v_mfma_f32_16x16x32_f16 v[112:115], v[28:31], v[68:71], v[112:115]
    s_nop 7
    v_cvt_pk_f16_f32 v112, v112, v113
    v_cvt_pk_f16_f32 v113, v114, v115
    ds_write_b64 v1, v[112:113] offset:1536
    s_mov_b64 exec, 1
    ds_add_u32 v3, v0 offset:76
    s_mov_b64 exec, -1
L_fin:
L_end:
    s_endpgm
L_codeend:
.section .rodata,"a"
.p2align 6
.amdhsa_kernel recurrent_scan__ssm_conv_s4d__moe_arch_mod__prompt_kernel
  .amdhsa_next_free_vgpr 128
  .amdhsa_next_free_sgpr 102
  .amdhsa_accum_offset 128
  .amdhsa_group_segment_fixed_size 0
  .amdhsa_kernarg_size 120
  .amdhsa_user_sgpr_count 2
  .amdhsa_user_sgpr_kernarg_segment_ptr 1
  .amdhsa_system_sgpr_workgroup_id_x 1
  .amdhsa_float_denorm_mode_32 3
.end_amdhsa_kernel
```

```asm
; @launch grid=(256,1,1) block=(1024,1,1) lds=161280
.amdgcn_target "amdgcn-amd-amdhsa--gfx950"
.text
.globl recurrent_scan__ssm_conv_s4d__moe_arch_mod__prompt_kernel
.p2align 12
.p2align 8
.type recurrent_scan__ssm_conv_s4d__moe_arch_mod__prompt_kernel,@function
recurrent_scan__ssm_conv_s4d__moe_arch_mod__prompt_kernel:
    s_cmp_ge_u32 s2, 256
    s_nop 0
    s_cbranch_scc1 L_end
    s_load_dwordx16 s[4:19], s[0:1], 0
    s_load_dwordx8 s[20:27], s[0:1], 64
    s_load_dwordx4 s[28:31], s[0:1], 96
    s_load_dwordx2 s[32:33], s[0:1], 112
    s_getpc_b64 s[62:63]
L_pc:
    v_readfirstlane_b32 s3, v0
    v_and_b32 v1, 63, v0
    v_mov_b32 v3, 0
    v_lshlrev_b32 v2, 4, v1
    s_and_b32 s35, s2, 7
    s_lshr_b32 s36, s2, 3
    s_lshr_b32 s3, s3, 6
    s_and_b32 s40, s36, 15
    s_lshl4_add_u32 s37, s35, s40
    s_lshr_b32 s38, s36, 4
    s_xor_b32 s38, s38, 1
    s_and_b32 s34, s3, 3
    s_cmp_ge_u32 s3, 4
    s_cbranch_scc1 L_p1
    s_setprio 3
    s_lshl_b32 s40, s2, 14
    s_lshl_b32 s41, s34, 9
    v_lshrrev_b32_e64 v118, 3, v1
    v_and_b32 v113, 112, v2
    v_add_u32_e64 v113, s41, v113
    v_lshl_add_u32 v112, v118, 11, v113
    v_add_u32 v112, s40, v112
    s_waitcnt lgkmcnt(0)
    s_load_dword s47, s[32:33], 0
    global_load_dwordx4 v[32:35], v113, s[20:21] offset:0
    global_load_dwordx4 v[36:39], v113, s[20:21] offset:128
    global_load_dwordx4 v[40:43], v113, s[20:21] offset:256
    global_load_dwordx4 v[44:47], v113, s[20:21] offset:384
    global_load_dwordx4 v[16:19], v112, s[4:5] offset:0 nt
    global_load_dwordx4 v[20:23], v112, s[4:5] offset:128 nt
    global_load_dwordx4 v[24:27], v112, s[4:5] offset:256 nt
    global_load_dwordx4 v[28:31], v112, s[4:5] offset:384 nt
    s_barrier
    s_branch L_tok
    s_nop 0
L_p1:
    s_cmp_ge_u32 s3, 8
    s_cbranch_scc1 L_p2
    s_and_b32 s40, s36, 3
    s_lshl2_add_u32 s40, s40, s34
    s_lshl_b32 s40, s40, 11
    v_and_b32 v0, 15, v1
    v_lshl_add_u32 v0, v0, 7, s40
    v_cmp_gt_u32 vcc, L_codeend-L_pc-4, v0
    s_nop 1
    v_cndmask_b32 v0, v3, v0, vcc
    global_load_dword v31, v0, s[62:63]
    s_lshl_b32 s40, s34, 7
    s_and_b32 s41, s40, 128
    s_add_u32 s40, s40, 384
    v_cmp_gt_u32 vcc, 32, v1
    v_mov_b32 v32, s40
    v_mov_b32 v33, s41
    v_cndmask_b32 v32, v33, v32, vcc
    v_cndmask_b32 v34, 0, -1, vcc
    v_lshl_add_u32 v32, v1, 2, v32
    v_subrev_u32 v32, 128, v32
    ds_write_b32 v32, v34
    s_waitcnt lgkmcnt(0)
    s_barrier
    s_branch L_exp
L_p2:
    s_lshl2_add_u32 s60, s38, s34
    s_bfe_u32 s59, s3, 0x10002
    s_lshl_b32 s40, s59, 2
    s_xor_b32 s34, s60, s40
    v_and_b32 v32, 15, v1
    v_lshrrev_b32 v33, 4, v1
    s_cmp_ge_u32 s34, 5
    s_cbranch_scc1 L_q5
    s_lshl_b32 s40, s34, 2
    s_lshr_b32 s41, 0xccb5a, s40
    s_and_b32 s41, s41, 15
    s_add_u32 s41, s41, 40
    s_lshr_b32 s45, 0x29735, s40
    s_and_b32 s45, s45, 15
    s_bfm_b32 s45, s45, 0
    s_mov_b32 s44, 0
    v_lshl_add_u32 v86, v33, 3, v32
    v_sub_u32_e64 v86, s41, v86
    v_lshrrev_b64 v[86:87], v86, s[44:45]
    s_mov_b32 s43, 0xffff
    v_bfe_i32 v36, v86, 0, 1
    v_bfe_i32 v87, v86, 1, 1
    v_bfi_b32 v36, s43, v36, v87
    v_and_b32 v36, 0x3c003c00, v36
    v_bfe_i32 v37, v86, 2, 1
    v_bfe_i32 v87, v86, 3, 1
    v_bfi_b32 v37, s43, v37, v87
    v_and_b32 v37, 0x3c003c00, v37
    v_bfe_i32 v38, v86, 4, 1
    v_bfe_i32 v87, v86, 5, 1
    v_bfi_b32 v38, s43, v38, v87
    v_and_b32 v38, 0x3c003c00, v38
    v_bfe_i32 v39, v86, 6, 1
    v_bfe_i32 v87, v86, 7, 1
    v_bfi_b32 v39, s43, v39, v87
    v_and_b32 v39, 0x3c003c00, v39
    s_branch L_qw
    s_nop 0
L_q5:
    s_cmp_ge_u32 s34, 6
    s_cbranch_scc1 L_q6
    v_lshlrev_b32 v85, 1, v32
    v_sub_u32 v85, v85, v33
    v_lshl_add_u32 v36, v85, 4, 48
    v_and_b32 v86, 1, v1
    v_cmp_eq_u32 vcc, 0, v86
    v_mov_b32 v85, 0x03020706
    v_mov_b32 v87, 0x05040100
    v_cndmask_b32_e64 v37, v85, v87, vcc
    v_mov_b32 v85, 4412
    v_mov_b32 v87, 5312
    v_cndmask_b32 v85, v85, v87, vcc
    v_lshlrev_b32 v86, 2, v33
    v_sub_u32 v86, v86, v32
    v_lshl_add_u32 v39, v86, 2, v85
    v_sub_u32 v85, 3, v32
    v_and_b32_e64 v85, 3, v85
    v_mul_u32_u24 v85, 1086, v85
    v_lshl_add_u32 v86, v33, 3, v32
    v_sub_u32_e64 v86, 39, v86
    v_lshl_add_u32 v38, v86, 1, v85
    s_branch L_qw
L_q6:
    s_cmp_ge_u32 s34, 7
    s_cbranch_scc1 L_q7
    v_and_b32 v31, 31, v1
    v_mov_b32 v85, 0
    v_cmp_gt_u32 vcc, 24, v31
    v_mov_b32 v86, 0x9876a987
    s_nop 0
    v_cndmask_b32 v85, v85, v86, vcc
    v_cmp_gt_u32 vcc, 16, v31
    v_mov_b32 v86, 0x54aa6543
    s_nop 0
    v_cndmask_b32 v85, v85, v86, vcc
    v_cmp_gt_u32 vcc, 8, v31
    v_mov_b32 v86, 0x2113210
    s_nop 0
    v_cndmask_b32 v85, v85, v86, vcc
    v_lshlrev_b32_e64 v86, 2, v31
    v_bfe_u32 v85, v85, v86, 4
    s_mov_b32 s41, 0xf00f0ff0
    v_bfe_u32 v86, s41, v31, 1
    v_mad_u32_u24 v85, v86, 10, v85
    v_lshrrev_b32 v86, 5, v1
    v_mad_u32_u24 v85, v85, 17, v86
    v_lshlrev_b32 v36, 4, v85
    v_mad_u32_u24 v85, v31, 17, v86
    v_lshlrev_b32 v37, 4, v85
    v_lshrrev_b32 v85, 1, v1
    v_and_b32_e64 v86, 1, v1
    v_sub_u32 v85, 1135, v85
    v_mad_u32_u24 v87, v86, 48, v85
    v_lshlrev_b32 v38, 2, v87
    v_lshlrev_b32 v86, 5, v86
    v_sub_u32 v85, v85, v86
    v_add_u32 v85, 128, v85
    v_lshlrev_b32 v39, 2, v85
    s_branch L_qw
L_q7:
    v_cmp_gt_u32 vcc, 32, v1
    v_bfe_u32 v85, v1, 2, 2
    v_bfe_u32 v86, v1, 3, 2
    v_cndmask_b32 v86, v86, v85, vcc
    v_lshlrev_b32 v86, 2, v86
    s_mov_b32 s41, 0xb630
    v_bfe_u32 v86, s41, v86, 4
    v_mov_b32 v87, 5248
    v_mov_b32 v36, 4352
    v_cndmask_b32 v87, v87, v36, vcc
    v_lshl_add_u32 v86, v86, 6, v87
    v_and_b32 v87, 7, v1
    v_min_u32 v87, 4, v87
    v_and_b32 v36, 3, v1
    v_cndmask_b32 v87, v87, v36, vcc
    v_cmp_gt_u32 vcc, 16, v1
    v_mul_u32_u24 v85, 1088, v85
    s_mov_b32 s41, 0xffff0000
    v_cndmask_b32 v86, v86, v85, vcc
    v_lshl_add_u32 v36, v87, 4, v86
    v_mov_b32 v37, 0
    v_mov_b32_e64 v38, 0
    v_mov_b32_e64 v39, 0
    v_writelane_b32 v38, s41, 3
    v_writelane_b32 v39, -1, 3
    v_writelane_b32 v38, -1, 7
    v_writelane_b32 v39, -1, 7
    v_writelane_b32 v37, s41, 11
    v_writelane_b32 v38, -1, 11
    v_writelane_b32 v37, -1, 15
    v_writelane_b32 v38, -1, 15
L_qw:
    s_lshl_b32 s58, s38, 10
    s_sub_u32 s58, 10512, s58
    s_sub_u32 s40, s34, 4
    s_mul_i32 s40, s40, 4624
    s_add_u32 s40, s40, s58
    s_lshl_b32 s41, s34, 10
    s_add_u32 s41, s41, 4864
    s_cmp_lt_u32 s34, 4
    s_cselect_b32 s40, s41, s40
    v_add_u32_e64 v85, s40, v2
    ds_write_b128 v85, v[36:39]
    s_lshl3_add_u32 s42, s37, s60
    s_lshl_b32 s40, s42, 8
    v_lshl_add_u32 v24, v1, 2, s40
    s_lshr_b32 s40, s42, 1
    s_lshl_b32 s40, s40, 2
    s_waitcnt lgkmcnt(0)
    s_load_dword s48, s[14:15], s40
    s_load_dword s49, s[16:17], s40
    s_barrier
    global_load_dword v8, v24, s[6:7]
    global_load_dword v9, v24, s[8:9]
    global_load_dword v10, v24, s[10:11]
    global_load_dword v11, v24, s[12:13]
    s_branch L_cnv
    s_nop 0
L_tok:
    s_setprio 3
    s_cmp_ge_u32 s34, 2
    s_cselect_b32 s40, 4, 0
    s_add_u32 s40, s40, s34
    s_add_u32 s41, s34, 2
    s_cmp_eq_u32 s38, 0
    s_cselect_b32 s20, s40, s41
    s_cselect_b32 s21, s41, s40
    s_mov_b32 s30, 0x3f803f80
    s_mov_b32 s31, 0xffff0000
    s_lshl_b32 s40, s2, 7
    s_lshl_b32 s41, s34, 20
    s_add_u32 s40, s40, s41
    s_add_u32 s40, s40, 2097152
    s_add_u32 s52, s32, s40
    s_addc_u32 s53, s33, 0
    s_add_u32 s50, s32, 32768
    s_addc_u32 s51, s33, 0
    s_lshl_b32 s40, s2, 6
    s_add_u32 s58, s50, s40
    s_addc_u32 s59, s51, 0
    s_lshl_b32 s40, s21, 11
    s_add_u32 s60, s50, s40
    s_addc_u32 s61, s51, 0
    s_nop 0
    s_lshl_b32 s41, s37, 15
    s_add_u32 s41, s41, 2097152
    s_lshl_b32 s40, s20, 12
    s_add_u32 s40, s40, s41
    s_add_u32 s54, s32, s40
    s_addc_u32 s55, s33, 0
    s_lshl_b32 s40, s21, 12
    s_add_u32 s40, s40, s41
    s_add_u32 s56, s32, s40
    s_addc_u32 s57, s33, 0
    s_lshl_b32 s40, s20, 19
    s_lshl4_add_u32 s40, s37, s40
    s_add_u32 s40, s40, 4096
    s_add_u32 s28, s28, s40
    s_addc_u32 s29, s29, 0
    s_lshl_b32 s40, s20, 9
    s_add_u32 s40, s40, 9488
    s_lshl_b32 s41, s21, 9
    s_add_u32 s41, s41, 9488
    s_nop 0
    s_lshl_b32 s42, s34, 9
    s_add_u32 s42, s42, 52096
    v_lshl_add_u32 v5, v1, 3, s42
    v_add_u32 v11, 57664, v5
    s_lshl_b32 s42, s34, 2
    v_mov_b32 v10, s42
    v_and_b32 v58, 112, v2
    v_lshrrev_b32_e64 v59, 4, v1
    v_mul_u32_u24 v56, 4624, v118
    v_add3_u32 v114, v56, v58, s40
    v_mul_u32_u24 v56, 289, v58
    v_lshlrev_b32_e64 v117, 4, v118
    v_add3_u32 v8, v56, v117, s40
    v_add3_u32 v9, v56, v117, s41
    v_lshl_add_u32 v116, v118, 17, v58
    v_bfe_u32 v56, v1, 2, 2
    v_mul_u32_u24 v56, 4624, v56
    v_lshl_add_u32 v56, v59, 7, v56
    v_and_b32 v57, 2, v1
    v_lshl_add_u32 v56, v57, 5, v56
    v_and_b32 v57, 1, v1
    v_lshl_add_u32 v56, v57, 3, v56
    v_add_u32 v115, s40, v56
    v_and_b32 v57, 15, v1
    v_lshl_add_u32 v56, v57, 2, v59
    v_lshl_add_u32 v6, v56, 3, s40
    v_lshlrev_b32 v4, 13, v56
    s_lshl_b32 s40, s20, 11
    v_lshl_add_u32 v7, v56, 5, s40
    s_lshl_b32 s40, s34, 7
    v_add_u32 v120, s40, v117
    v_lshlrev_b32 v118, 3, v118
    v_mov_b32 v53, 1
    s_waitcnt lgkmcnt(0)
    s_add_u32 s39, s47, 1
    s_mul_i32 s39, s39, 0x9e3779b1
    v_mov_b32 v52, s39
    s_mov_b64 exec, 1
    ds_write_b64 v3, v[52:53] offset:40
    s_mov_b64 exec, -1
    v_lshlrev_b32 v57, 3, v1
    v_and_b32 v119, 0xffff, v52
    s_and_b32 s42, s39, 1
    s_mul_i32 s42, s42, 0x01010101
    s_and_b32 s43, s39, 0xfefefefe
    s_or_b32 s43, s43, s42
    v_bfe_u32 v56, s43, v57, 8
    v_lshl_or_b32 v12, v56, 14, v56
    v_lshrrev_b32 v14, 4, v12
    s_waitcnt vmcnt(4)
    v_dot2_f32_bf16 v51, v32, s30, 0
    v_dot2_f32_bf16 v52, v33, s30, 0
    v_dot2_f32_bf16 v51, v34, s30, v51
    v_dot2_f32_bf16 v52, v35, s30, v52
    v_dot2_f32_bf16 v51, v36, s30, v51
    v_dot2_f32_bf16 v52, v37, s30, v52
    v_dot2_f32_bf16 v51, v38, s30, v51
    v_dot2_f32_bf16 v52, v39, s30, v52
    v_dot2_f32_bf16 v51, v40, s30, v51
    v_dot2_f32_bf16 v52, v41, s30, v52
    v_dot2_f32_bf16 v51, v42, s30, v51
    v_dot2_f32_bf16 v52, v43, s30, v52
    v_dot2_f32_bf16 v51, v44, s30, v51
    v_dot2_f32_bf16 v52, v45, s30, v52
    v_dot2_f32_bf16 v51, v46, s30, v51
    v_dot2_f32_bf16 v52, v47, s30, v52
    s_waitcnt vmcnt(3)
    s_nop 0
    v_dot2_f32_bf16 v49, v16, v16, 0
    v_dot2_f32_bf16 v48, v16, s30, 0
    v_dot2_f32_bf16 v50, v16, v32, 0
    v_dot2_f32_bf16 v49, v17, v17, v49
    v_dot2_f32_bf16 v48, v17, s30, v48
    v_dot2_f32_bf16 v50, v17, v33, v50
    v_dot2_f32_bf16 v49, v18, v18, v49
    v_dot2_f32_bf16 v48, v18, s30, v48
    v_dot2_f32_bf16 v50, v18, v34, v50
    v_dot2_f32_bf16 v49, v19, v19, v49
    v_dot2_f32_bf16 v48, v19, s30, v48
    v_dot2_f32_bf16 v50, v19, v35, v50
    v_add_f32 v51, v51, v52
    s_waitcnt vmcnt(2)
    v_dot2_f32_bf16 v49, v20, v20, v49
    v_dot2_f32_bf16 v48, v20, s30, v48
    v_dot2_f32_bf16 v50, v20, v36, v50
    v_dot2_f32_bf16 v49, v21, v21, v49
    v_dot2_f32_bf16 v48, v21, s30, v48
    v_dot2_f32_bf16 v50, v21, v37, v50
    v_dot2_f32_bf16 v49, v22, v22, v49
    v_dot2_f32_bf16 v48, v22, s30, v48
    v_dot2_f32_bf16 v50, v22, v38, v50
    v_dot2_f32_bf16 v49, v23, v23, v49
    v_dot2_f32_bf16 v48, v23, s30, v48
    v_dot2_f32_bf16 v50, v23, v39, v50
    s_waitcnt vmcnt(1)
    s_nop 0
    v_dot2_f32_bf16 v49, v24, v24, v49
    v_dot2_f32_bf16 v48, v24, s30, v48
    v_dot2_f32_bf16 v50, v24, v40, v50
    v_dot2_f32_bf16 v49, v25, v25, v49
    v_dot2_f32_bf16 v48, v25, s30, v48
    v_dot2_f32_bf16 v50, v25, v41, v50
    v_dot2_f32_bf16 v49, v26, v26, v49
    v_dot2_f32_bf16 v48, v26, s30, v48
    v_dot2_f32_bf16 v50, v26, v42, v50
    v_dot2_f32_bf16 v49, v27, v27, v49
    v_dot2_f32_bf16 v48, v27, s30, v48
    v_dot2_f32_bf16 v50, v27, v43, v50
    s_nop 0
    s_waitcnt vmcnt(0)
    v_dot2_f32_bf16 v49, v28, v28, v49
    v_dot2_f32_bf16 v48, v28, s30, v48
    v_dot2_f32_bf16 v50, v28, v44, v50
    v_dot2_f32_bf16 v49, v29, v29, v49
    v_dot2_f32_bf16 v48, v29, s30, v48
    v_dot2_f32_bf16 v50, v29, v45, v50
    v_dot2_f32_bf16 v49, v30, v30, v49
    v_dot2_f32_bf16 v48, v30, s30, v48
    v_dot2_f32_bf16 v50, v30, v46, v50
    v_dot2_f32_bf16 v49, v31, v31, v49
    v_dot2_f32_bf16 v48, v31, s30, v48
    v_dot2_f32_bf16 v50, v31, v47, v50
    v_add_f32_dpp v51, v51, v51 quad_perm:[1,0,3,2] row_mask:0xf bank_mask:0xf
    v_add_f32_dpp v49, v49, v49 quad_perm:[1,0,3,2] row_mask:0xf bank_mask:0xf
    v_add_f32_dpp v48, v48, v48 quad_perm:[1,0,3,2] row_mask:0xf bank_mask:0xf
    v_add_f32_dpp v50, v50, v50 quad_perm:[1,0,3,2] row_mask:0xf bank_mask:0xf
    v_add_f32_dpp v51, v51, v51 quad_perm:[2,3,0,1] row_mask:0xf bank_mask:0xf
    v_add_f32_dpp v49, v49, v49 quad_perm:[2,3,0,1] row_mask:0xf bank_mask:0xf
    v_add_f32_dpp v48, v48, v48 quad_perm:[2,3,0,1] row_mask:0xf bank_mask:0xf
    v_add_f32_dpp v50, v50, v50 quad_perm:[2,3,0,1] row_mask:0xf bank_mask:0xf
    v_add_f32_dpp v51, v51, v51 row_half_mirror row_mask:0xf bank_mask:0xf
    v_add_f32_dpp v49, v49, v49 row_half_mirror row_mask:0xf bank_mask:0xf
    v_add_f32_dpp v48, v48, v48 row_half_mirror row_mask:0xf bank_mask:0xf
    v_add_f32_dpp v50, v50, v50 row_half_mirror row_mask:0xf bank_mask:0xf
    v_and_b32 v49, 0x7fffffff, v49
    s_mov_b32 exec_lo, 0x01010101
    s_mov_b32 exec_hi, 0x01010101
    ds_write_b128 v120, v[48:51] offset:256
    s_mov_b64 exec, -1
    s_mov_b32 s46, 0
    ds_read_b128 v[60:63], v117 offset:256
    ds_read_b128 v[64:67], v117 offset:384
    ds_read_b128 v[68:71], v117 offset:512
    ds_read_b128 v[72:75], v117 offset:640
    v_lshlrev_b32_e64 v80, 16, v16
    v_and_b32 v81, 0xffff0000, v16
    v_lshlrev_b32_e64 v82, 16, v17
    v_and_b32 v83, 0xffff0000, v17
    v_lshlrev_b32_e64 v84, 16, v18
    v_and_b32 v85, 0xffff0000, v18
    v_lshlrev_b32_e64 v86, 16, v19
    v_and_b32 v87, 0xffff0000, v19
    v_lshlrev_b32_e64 v88, 16, v20
    v_and_b32 v89, 0xffff0000, v20
    v_lshlrev_b32_e64 v90, 16, v21
    v_and_b32 v91, 0xffff0000, v21
    v_lshlrev_b32_e64 v92, 16, v22
    v_and_b32 v93, 0xffff0000, v22
    s_branch L_spc_3
    s_nop 0
L_sp_1:
    ds_read_b128 v[60:63], v117 offset:256
    ds_read_b128 v[64:67], v117 offset:384
    ds_read_b128 v[68:71], v117 offset:512
    ds_read_b128 v[72:75], v117 offset:640
L_spc_3:
    s_waitcnt lgkmcnt(0)
    v_or3_b32 v52, v61, v65, v69
    v_or_b32 v52, v52, v73
    v_cmp_gt_i32_e64 vcc, 0, v52
    s_cbranch_vccz L_spd_2
    s_add_u32 s46, s46, 1
    s_cmp_lt_u32 s46, 400000
    s_cbranch_scc1 L_sp_1
    s_branch L_end
L_spd_2:
    v_pk_add_f32 v[60:61], v[60:61], v[64:65]
    v_pk_add_f32 v[68:69], v[68:69], v[72:73]
    v_pk_add_f32 v[62:63], v[62:63], v[66:67]
    v_pk_add_f32 v[70:71], v[70:71], v[74:75]
    v_pk_add_f32 v[60:61], v[60:61], v[68:69]
    v_pk_add_f32 v[62:63], v[62:63], v[70:71]
    v_mul_f32 v48, 0x3a800000, v60
    v_mul_f32 v49, 0x3a800000, v61
    v_fma_f32 v49, -v48, v48, v49
    v_max_f32_e64 v49, 0, v49
    v_cvt_pk_bf16_f32 v54, v48, v49
    v_and_b32 v49, 0xffff0000, v54
    v_add_f32 v49, 0x3727c5ac, v49
    v_cvt_pk_bf16_f32 v49, v49, v49
    v_and_b32 v49, 0xffff0000, v49
    v_sqrt_f32_e64 v49, v49
    v_lshlrev_b32_e64 v54, 16, v54
    v_cvt_pk_bf16_f32 v52, v48, v49
    v_and_b32 v49, 0xffff0000, v52
    v_rcp_f32_e64 v55, v49
    v_fma_f32 v53, -v54, v63, v62
    s_cmp_lg_u32 s34, 0
    s_cbranch_scc1 L_nohdr_4
    v_mul_f32 v53, v53, v55
    s_brev_b32 s40, 1
    v_cvt_pk_bf16_f32 v53, v53, v53
    v_ashrrev_i32_e64 v49, 31, v53
    v_bitop3_b32 v53, v53, v49, s40 bitop3:0x1e
    v_and_or_b32 v53, v53, s31, v119
    s_mov_b32 exec_lo, 0x01010101
    s_mov_b32 exec_hi, 0x01010101
    global_store_dwordx2 v118, v[52:53], s[58:59] sc1
    s_mov_b64 exec, -1
L_nohdr_4:
    v_mul_f32 v56, 0xbfb8aa3b, v55
    v_lshlrev_b32 v94, 16, v23
    v_and_b32 v95, 0xffff0000, v23
    v_mul_f32 v58, -v54, v56
    v_lshlrev_b32_e64 v96, 16, v24
    v_and_b32 v97, 0xffff0000, v24
    v_lshlrev_b32_e64 v98, 16, v25
    v_and_b32 v99, 0xffff0000, v25
    v_lshlrev_b32_e64 v100, 16, v26
    v_and_b32 v101, 0xffff0000, v26
    v_lshlrev_b32_e64 v102, 16, v27
    v_and_b32 v103, 0xffff0000, v27
    v_lshlrev_b32_e64 v104, 16, v28
    v_and_b32 v105, 0xffff0000, v28
    v_lshlrev_b32_e64 v106, 16, v29
    v_and_b32 v107, 0xffff0000, v29
    v_lshlrev_b32_e64 v108, 16, v30
    v_and_b32 v109, 0xffff0000, v30
    v_lshlrev_b32_e64 v110, 16, v31
    v_and_b32 v111, 0xffff0000, v31
    v_pk_fma_f32 v[80:81], v[80:81], v[56:57], v[58:59] op_sel_hi:[1,0,0]
    v_pk_fma_f32 v[82:83], v[82:83], v[56:57], v[58:59] op_sel_hi:[1,0,0]
    v_pk_fma_f32 v[84:85], v[84:85], v[56:57], v[58:59] op_sel_hi:[1,0,0]
    v_pk_fma_f32 v[86:87], v[86:87], v[56:57], v[58:59] op_sel_hi:[1,0,0]
    v_cvt_pk_f16_f32 v16, v80, v81
    v_cvt_pk_f16_f32 v17, v82, v83
    v_cvt_pk_f16_f32 v18, v84, v85
    v_cvt_pk_f16_f32 v19, v86, v87
    ds_write_b128 v114, v[16:19] offset:0
    v_pk_fma_f32 v[88:89], v[88:89], v[56:57], v[58:59] op_sel_hi:[1,0,0]
    v_pk_fma_f32 v[90:91], v[90:91], v[56:57], v[58:59] op_sel_hi:[1,0,0]
    v_pk_fma_f32 v[92:93], v[92:93], v[56:57], v[58:59] op_sel_hi:[1,0,0]
    v_pk_fma_f32 v[94:95], v[94:95], v[56:57], v[58:59] op_sel_hi:[1,0,0]
    v_cvt_pk_f16_f32 v20, v88, v89
    v_cvt_pk_f16_f32 v21, v90, v91
    v_cvt_pk_f16_f32 v22, v92, v93
    v_cvt_pk_f16_f32 v23, v94, v95
    ds_write_b128 v114, v[20:23] offset:128
    v_pk_fma_f32 v[96:97], v[96:97], v[56:57], v[58:59] op_sel_hi:[1,0,0]
    v_pk_fma_f32 v[98:99], v[98:99], v[56:57], v[58:59] op_sel_hi:[1,0,0]
    v_pk_fma_f32 v[100:101], v[100:101], v[56:57], v[58:59] op_sel_hi:[1,0,0]
    v_pk_fma_f32 v[102:103], v[102:103], v[56:57], v[58:59] op_sel_hi:[1,0,0]
    v_cvt_pk_f16_f32 v24, v96, v97
    v_cvt_pk_f16_f32 v25, v98, v99
    v_cvt_pk_f16_f32 v26, v100, v101
    v_cvt_pk_f16_f32 v27, v102, v103
    ds_write_b128 v114, v[24:27] offset:256
    v_pk_fma_f32 v[104:105], v[104:105], v[56:57], v[58:59] op_sel_hi:[1,0,0]
    v_pk_fma_f32 v[106:107], v[106:107], v[56:57], v[58:59] op_sel_hi:[1,0,0]
    v_pk_fma_f32 v[108:109], v[108:109], v[56:57], v[58:59] op_sel_hi:[1,0,0]
    v_pk_fma_f32 v[110:111], v[110:111], v[56:57], v[58:59] op_sel_hi:[1,0,0]
    v_cvt_pk_f16_f32 v28, v104, v105
    v_cvt_pk_f16_f32 v29, v106, v107
    v_cvt_pk_f16_f32 v30, v108, v109
    v_cvt_pk_f16_f32 v31, v110, v111
    ds_write_b128 v114, v[28:31] offset:384
    ds_read_b64_tr_b16 v[32:33], v115 offset:0
    ds_read_b64_tr_b16 v[34:35], v115 offset:18496
    ds_read_b64_tr_b16 v[36:37], v115 offset:16
    ds_read_b64_tr_b16 v[38:39], v115 offset:18512
    ds_read_b64_tr_b16 v[40:41], v115 offset:32
    ds_read_b64_tr_b16 v[42:43], v115 offset:18528
    ds_read_b64_tr_b16 v[44:45], v115 offset:48
    ds_read_b64_tr_b16 v[46:47], v115 offset:18544
    s_mov_b32 s22, 0x00030003
    s_nop 0
    s_waitcnt lgkmcnt(6)
    v_bfi_b32 v32, s22, v12, v32
    v_bfi_b32 v34, s22, v14, v34
    global_store_dwordx4 v116, v[32:35], s[52:53] offset:0 sc1
    s_add_u32 s52, s52, 32768
    s_addc_u32 s53, s53, 0
    s_waitcnt lgkmcnt(4)
    v_bfi_b32 v36, s22, v12, v36
    v_bfi_b32 v38, s22, v14, v38
    global_store_dwordx4 v116, v[36:39], s[52:53] offset:0 sc1
    s_add_u32 s52, s52, 32768
    s_addc_u32 s53, s53, 0
    s_waitcnt lgkmcnt(2)
    v_bfi_b32 v40, s22, v12, v40
    v_bfi_b32 v42, s22, v14, v42
    global_store_dwordx4 v116, v[40:43], s[52:53] offset:0 sc1
    s_add_u32 s52, s52, 32768
    s_addc_u32 s53, s53, 0
    s_waitcnt lgkmcnt(0)
    v_bfi_b32 v44, s22, v12, v44
    v_bfi_b32 v46, s22, v14, v46
    global_store_dwordx4 v116, v[44:47], s[52:53] offset:0 sc1
    v_lshrrev_b32 v80, 3, v7
    v_sub_u32 v80, 0xffff, v80
    s_lshl_b32 s40, s21, 8
    s_sub_u32 s40, 0xffff, s40
    v_lshlrev_b32 v84, 1, v1
    v_sub_u32 v84, s40, v84
    v_subrev_u32 v81, 1, v80
    v_subrev_u32 v85, 1, v84
    v_subrev_u32_e64 v82, 2, v80
    v_subrev_u32 v86, 128, v84
    v_subrev_u32_e64 v83, 3, v80
    v_subrev_u32 v87, 129, v84
    v_mov_b32 v76, 1
    v_lshrrev_b32 v52, 4, v1
    v_add_u32_e64 v52, v52, v10
    v_lshlrev_b32_e64 v52, 3, v52
    s_mov_b32 s46, 0
L_sp_5:
    ds_read_b32 v48, v3 offset:80
    s_waitcnt lgkmcnt(0)
    v_cmp_gt_u32_e64 vcc, 4, v48
    s_cbranch_vccz L_spd_6
    s_add_u32 s46, s46, 1
    s_sleep 2
    s_cmp_lt_u32 s46, 400000
    s_cbranch_scc1 L_sp_5
    s_branch L_end
    s_nop 0
L_spd_6:
    global_load_dwordx4 v[60:63], v7, s[50:51] offset:0
    global_load_dwordx4 v[64:67], v7, s[50:51] offset:16
    global_load_dwordx4 v[68:71], v2, s[60:61] offset:0
    global_load_dwordx4 v[72:75], v2, s[60:61] offset:1024
    s_cmp_ge_u32 s34, 2
    s_cbranch_scc1 L_late_9
    s_mov_b32 s46, 0
L_sp_10:
    ds_read_b32 v48, v3 offset:84
    s_waitcnt lgkmcnt(0)
    v_cmp_gt_u32 vcc, 4, v48
    s_cbranch_vccz L_spd_11
    s_add_u32 s46, s46, 1
    s_sleep 2
    s_cmp_lt_u32 s46, 400000
    s_cbranch_scc1 L_sp_10
    s_branch L_end
L_spd_11:
    s_cmp_ge_u32 s21, 6
    s_cbranch_scc1 L_nob_12
    global_load_dwordx4 v[32:35], v2, s[56:57] offset:0 sc1
    global_load_dwordx4 v[36:39], v2, s[56:57] offset:1024 sc1
    global_load_dwordx4 v[40:43], v2, s[56:57] offset:2048 sc1
    global_load_dwordx4 v[44:47], v2, s[56:57] offset:3072 sc1
L_nob_12:
    global_load_dwordx4 v[16:19], v2, s[54:55] offset:0 sc1
    global_load_dwordx4 v[20:23], v2, s[54:55] offset:1024 sc1
    global_load_dwordx4 v[24:27], v2, s[54:55] offset:2048 sc1
    global_load_dwordx4 v[28:31], v2, s[54:55] offset:3072 sc1
    s_mov_b32 s46, 0
    s_waitcnt vmcnt(8)
    s_branch L_rc_7
    s_nop 0
L_late_9:
    s_mov_b32 s46, 0
    s_waitcnt vmcnt(0)
L_rc_7:
    v_xor_b32_e64 v50, v119, v61
    v_bitop3_b32 v50, v50, v63, v119 bitop3:0xf6
    v_bitop3_b32 v50, v50, v65, v119 bitop3:0xf6
    v_bitop3_b32 v50, v50, v67, v119 bitop3:0xf6
    v_bitop3_b32 v50, v50, v69, v119 bitop3:0xf6
    v_bitop3_b32 v50, v50, v71, v119 bitop3:0xf6
    v_bitop3_b32 v50, v50, v73, v119 bitop3:0xf6
    v_bitop3_b32 v50, v50, v75, v119 bitop3:0xf6
    v_and_b32 v50, 0xffff, v50
    v_cmp_ne_u32 vcc, 0, v50
    s_cbranch_vccz L_ro_8
    global_load_dwordx4 v[60:63], v7, s[50:51] offset:0 sc1
    global_load_dwordx4 v[64:67], v7, s[50:51] offset:16 sc1
    global_load_dwordx4 v[68:71], v2, s[60:61] offset:0 sc1
    global_load_dwordx4 v[72:75], v2, s[60:61] offset:1024 sc1
    s_add_u32 s46, s46, 1
    s_cmp_lt_u32 s46, 50000
    s_waitcnt vmcnt(0)
    s_cbranch_scc1 L_rc_7
    s_branch L_end
L_ro_8:
    v_and_or_b32 v80, v61, s31, v80
    v_and_or_b32 v81, v63, s31, v81
    v_and_or_b32 v82, v65, s31, v82
    v_and_or_b32 v83, v67, s31, v83
    v_and_or_b32 v84, v69, s31, v84
    v_and_or_b32 v85, v71, s31, v85
    v_and_or_b32 v86, v73, s31, v86
    v_and_or_b32 v87, v75, s31, v87
    v_max3_u32 v48, v80, v81, v82
    v_med3_u32 v49, v80, v81, v82
    v_med3_u32 v49, v48, v49, v83
    v_max_u32 v48, v48, v83
    v_med3_u32 v49, v48, v49, v84
    v_max_u32 v48, v48, v84
    v_med3_u32 v49, v48, v49, v85
    v_max_u32_e64 v48, v48, v85
    v_med3_u32 v49, v48, v49, v86
    v_max_u32_e64 v48, v48, v86
    v_med3_u32 v49, v48, v49, v87
    v_max_u32 v48, v48, v87
    s_nop 0
    v_max_u32_dpp v51, v49, v49 quad_perm:[1,0,3,2] row_mask:0xf bank_mask:0xf
    v_min_u32_dpp v50, v48, v48 quad_perm:[1,0,3,2] row_mask:0xf bank_mask:0xf
    v_max_u32 v49, v50, v51
    v_max_u32_dpp v48, v48, v48 quad_perm:[1,0,3,2] row_mask:0xf bank_mask:0xf
    s_nop 0
    v_max_u32_dpp v51, v49, v49 quad_perm:[2,3,0,1] row_mask:0xf bank_mask:0xf
    v_min_u32_dpp v50, v48, v48 quad_perm:[2,3,0,1] row_mask:0xf bank_mask:0xf
    v_max_u32 v49, v50, v51
    v_max_u32_dpp v48, v48, v48 quad_perm:[2,3,0,1] row_mask:0xf bank_mask:0xf
    s_nop 0
    v_max_u32_dpp v51, v49, v49 row_half_mirror row_mask:0xf bank_mask:0xf
    v_min_u32_dpp v50, v48, v48 row_half_mirror row_mask:0xf bank_mask:0xf
    v_max_u32 v49, v50, v51
    v_max_u32_dpp v48, v48, v48 row_half_mirror row_mask:0xf bank_mask:0xf
    s_nop 0
    v_max_u32_dpp v51, v49, v49 row_mirror row_mask:0xf bank_mask:0xf
    v_min_u32_dpp v50, v48, v48 row_mirror row_mask:0xf bank_mask:0xf
    v_max_u32_e64 v49, v50, v51
    v_max_u32_dpp v48, v48, v48 row_mirror row_mask:0xf bank_mask:0xf
    s_mov_b32 exec_lo, 0x00010001
    s_mov_b32 exec_hi, 0x00010001
    ds_write_b64 v52, v[48:49] offset:128
    s_mov_b64 exec, -1
    s_cmp_lt_u32 s34, 2
    s_cbranch_scc1 L_early_13
    s_mov_b32 s46, 0
L_sp_14:
    ds_read_b32 v48, v3 offset:92
    s_waitcnt lgkmcnt(0)
    v_cmp_gt_u32 vcc, 4, v48
    s_cbranch_vccz L_spd_15
    s_add_u32 s46, s46, 1
    s_sleep 1
    s_cmp_lt_u32 s46, 400000
    s_cbranch_scc1 L_sp_14
    s_branch L_end
    s_nop 0
L_spd_15:
    s_cmp_ge_u32 s21, 6
    s_cbranch_scc1 L_nob_16
    global_load_dwordx4 v[32:35], v2, s[56:57] offset:0 sc1
    global_load_dwordx4 v[36:39], v2, s[56:57] offset:1024 sc1
    global_load_dwordx4 v[40:43], v2, s[56:57] offset:2048 sc1
    global_load_dwordx4 v[44:47], v2, s[56:57] offset:3072 sc1
L_nob_16:
    global_load_dwordx4 v[16:19], v2, s[54:55] offset:0 sc1
    global_load_dwordx4 v[20:23], v2, s[54:55] offset:1024 sc1
    global_load_dwordx4 v[24:27], v2, s[54:55] offset:2048 sc1
    global_load_dwordx4 v[28:31], v2, s[54:55] offset:3072 sc1
L_early_13:
    v_and_b32 v92, 0xffff0000, v60
    v_lshlrev_b32_e64 v88, 16, v60
    v_mul_f32 v92, 0xbf317218, v92
    v_and_b32 v93, 0xffff0000, v62
    v_lshlrev_b32_e64 v89, 16, v62
    v_mul_f32 v93, 0xbf317218, v93
    v_and_b32 v94, 0xffff0000, v64
    v_lshlrev_b32_e64 v90, 16, v64
    v_mul_f32 v94, 0xbf317218, v94
    v_and_b32 v95, 0xffff0000, v66
    v_lshlrev_b32_e64 v91, 16, v66
    v_mul_f32 v95, 0xbf317218, v95
    s_mov_b32 s46, 0
L_pa_17:
    v_mov_b32_e64 v57, 0
    s_cmp_ge_u32 s21, 6
    s_cbranch_scc1 L_nob_19
    s_waitcnt vmcnt(7)
    ds_write_b128 v9, v[32:35] offset:0
    v_bitop3_b32 v57, v57, v32, v12 bitop3:0xf6
    v_bitop3_b32 v57, v57, v34, v14 bitop3:0xf6
    s_waitcnt vmcnt(6)
    ds_write_b128 v9, v[36:39] offset:128
    v_bitop3_b32 v57, v57, v36, v12 bitop3:0xf6
    v_bitop3_b32 v57, v57, v38, v14 bitop3:0xf6
    s_waitcnt vmcnt(5)
    ds_write_b128 v9, v[40:43] offset:256
    v_bitop3_b32 v57, v57, v40, v12 bitop3:0xf6
    v_bitop3_b32 v57, v57, v42, v14 bitop3:0xf6
    s_waitcnt vmcnt(4)
    ds_write_b128 v9, v[44:47] offset:384
    v_bitop3_b32 v57, v57, v44, v12 bitop3:0xf6
    v_bitop3_b32 v57, v57, v46, v14 bitop3:0xf6
L_nob_19:
    s_waitcnt vmcnt(3)
    ds_write_b128 v8, v[16:19] offset:0
    v_bitop3_b32 v57, v57, v16, v12 bitop3:0xf6
    v_bitop3_b32 v57, v57, v18, v14 bitop3:0xf6
    s_waitcnt vmcnt(2)
    ds_write_b128 v8, v[20:23] offset:128
    v_bitop3_b32 v57, v57, v20, v12 bitop3:0xf6
    v_bitop3_b32 v57, v57, v22, v14 bitop3:0xf6
    s_waitcnt vmcnt(1)
    ds_write_b128 v8, v[24:27] offset:256
    v_bitop3_b32 v57, v57, v24, v12 bitop3:0xf6
    v_bitop3_b32 v57, v57, v26, v14 bitop3:0xf6
    s_nop 0
    s_waitcnt vmcnt(0)
    ds_write_b128 v8, v[28:31] offset:384
    v_bitop3_b32 v57, v57, v28, v12 bitop3:0xf6
    v_bitop3_b32 v57, v57, v30, v14 bitop3:0xf6
    v_and_b32 v57, 0x00030003, v57
    v_cmp_ne_u32 vcc, 0, v57
    s_cbranch_vccz L_po_18
    s_cmp_ge_u32 s21, 6
    s_cbranch_scc1 L_nob_20
    global_load_dwordx4 v[32:35], v2, s[56:57] offset:0 sc1
    global_load_dwordx4 v[36:39], v2, s[56:57] offset:1024 sc1
    global_load_dwordx4 v[40:43], v2, s[56:57] offset:2048 sc1
    global_load_dwordx4 v[44:47], v2, s[56:57] offset:3072 sc1
L_nob_20:
    global_load_dwordx4 v[16:19], v2, s[54:55] offset:0 sc1
    global_load_dwordx4 v[20:23], v2, s[54:55] offset:1024 sc1
    global_load_dwordx4 v[24:27], v2, s[54:55] offset:2048 sc1
    global_load_dwordx4 v[28:31], v2, s[54:55] offset:3072 sc1
    s_add_u32 s46, s46, 1
    s_cmp_lt_u32 s46, 50000
    s_cbranch_scc1 L_pa_17
    s_branch L_end
    s_nop 0
L_po_18:
    v_and_b32 v57, 8, v10
    s_mov_b64 exec, 1
    ds_add_u32 v57, v76 offset:48
    s_mov_b64 exec, -1
    s_setprio 0
    ds_read_b64 v[112:113], v6 offset:0
    ds_read_b64 v[114:115], v6 offset:4624
    ds_read_b64 v[116:117], v6 offset:9248
    ds_read_b64 v[118:119], v6 offset:13872
    ds_read_b64 v[120:121], v6 offset:18496
    ds_read_b64 v[122:123], v6 offset:23120
    ds_read_b64 v[124:125], v6 offset:27744
    ds_read_b64 v[126:127], v6 offset:32368
    s_mov_b32 s46, 0
L_sp_21:
    ds_read_b128 v[80:83], v3 offset:0
    ds_read_b128 v[84:87], v3 offset:16
    s_waitcnt lgkmcnt(0)
    v_min3_u32 v96, v80, v81, v82
    v_min3_u32 v96, v96, v83, v84
    v_min3_u32 v96, v96, v85, v86
    v_min_u32 v96, v96, v87
    v_cmp_eq_u32 vcc, 0, v96
    s_cbranch_vccz L_spd_22
    s_add_u32 s46, s46, 1
    s_sleep 1
    s_cmp_lt_u32 s46, 400000
    s_cbranch_scc1 L_sp_21
    s_branch L_end
L_spd_22:
    v_exp_f16 v96, v112
    v_exp_f16_sdwa v97, v112 dst_sel:DWORD dst_unused:UNUSED_PAD src0_sel:WORD_1
    v_exp_f16_e64 v98, v113
    v_exp_f16_sdwa v99, v113 dst_sel:DWORD dst_unused:UNUSED_PAD src0_sel:WORD_1
    v_fma_mix_f32 v96, v96, v80, v80 op_sel:[0,0,0] op_sel_hi:[1,0,0]
    v_fma_mix_f32 v97, v97, v80, v80 op_sel:[0,0,0] op_sel_hi:[1,0,0]
    v_fma_mix_f32 v98, v98, v80, v80 op_sel:[0,0,0] op_sel_hi:[1,0,0]
    v_fma_mix_f32 v99, v99, v80, v80 op_sel:[0,0,0] op_sel_hi:[1,0,0]
    v_rcp_f32 v16, v96
    v_rcp_f32 v17, v97
    v_rcp_f32 v18, v98
    v_rcp_f32 v19, v99
    v_exp_f16 v96, v114
    v_exp_f16_sdwa v97, v114 dst_sel:DWORD dst_unused:UNUSED_PAD src0_sel:WORD_1
    v_exp_f16 v98, v115
    v_exp_f16_sdwa v99, v115 dst_sel:DWORD dst_unused:UNUSED_PAD src0_sel:WORD_1
    v_fma_mix_f32 v96, v96, v81, v81 op_sel:[0,0,0] op_sel_hi:[1,0,0]
    v_fma_mix_f32 v97, v97, v81, v81 op_sel:[0,0,0] op_sel_hi:[1,0,0]
    v_fma_mix_f32 v98, v98, v81, v81 op_sel:[0,0,0] op_sel_hi:[1,0,0]
    v_fma_mix_f32 v99, v99, v81, v81 op_sel:[0,0,0] op_sel_hi:[1,0,0]
    v_rcp_f32 v20, v96
    v_rcp_f32 v21, v97
    v_rcp_f32 v22, v98
    v_rcp_f32 v23, v99
    v_exp_f16_e64 v96, v116
    v_exp_f16_sdwa v97, v116 dst_sel:DWORD dst_unused:UNUSED_PAD src0_sel:WORD_1
    v_exp_f16_e64 v98, v117
    v_exp_f16_sdwa v99, v117 dst_sel:DWORD dst_unused:UNUSED_PAD src0_sel:WORD_1
    v_fma_mix_f32 v96, v96, v82, v82 op_sel:[0,0,0] op_sel_hi:[1,0,0]
    v_fma_mix_f32 v97, v97, v82, v82 op_sel:[0,0,0] op_sel_hi:[1,0,0]
    v_fma_mix_f32 v98, v98, v82, v82 op_sel:[0,0,0] op_sel_hi:[1,0,0]
    v_fma_mix_f32 v99, v99, v82, v82 op_sel:[0,0,0] op_sel_hi:[1,0,0]
    v_rcp_f32 v24, v96
    v_rcp_f32 v25, v97
    v_rcp_f32 v26, v98
    v_rcp_f32 v27, v99
    v_exp_f16_e64 v96, v118
    v_exp_f16_sdwa v97, v118 dst_sel:DWORD dst_unused:UNUSED_PAD src0_sel:WORD_1
    v_exp_f16_e64 v98, v119
    v_exp_f16_sdwa v99, v119 dst_sel:DWORD dst_unused:UNUSED_PAD src0_sel:WORD_1
    v_fma_mix_f32 v96, v96, v83, v83 op_sel:[0,0,0] op_sel_hi:[1,0,0]
    v_fma_mix_f32 v97, v97, v83, v83 op_sel:[0,0,0] op_sel_hi:[1,0,0]
    v_fma_mix_f32 v98, v98, v83, v83 op_sel:[0,0,0] op_sel_hi:[1,0,0]
    v_fma_mix_f32 v99, v99, v83, v83 op_sel:[0,0,0] op_sel_hi:[1,0,0]
    v_rcp_f32 v28, v96
    v_rcp_f32 v29, v97
    v_rcp_f32 v30, v98
    v_rcp_f32 v31, v99
    v_exp_f16_e64 v96, v120
    v_exp_f16_sdwa v97, v120 dst_sel:DWORD dst_unused:UNUSED_PAD src0_sel:WORD_1
    v_exp_f16_e64 v98, v121
    v_exp_f16_sdwa v99, v121 dst_sel:DWORD dst_unused:UNUSED_PAD src0_sel:WORD_1
    v_fma_mix_f32 v96, v96, v84, v84 op_sel:[0,0,0] op_sel_hi:[1,0,0]
    v_fma_mix_f32 v97, v97, v84, v84 op_sel:[0,0,0] op_sel_hi:[1,0,0]
    v_fma_mix_f32 v98, v98, v84, v84 op_sel:[0,0,0] op_sel_hi:[1,0,0]
    v_fma_mix_f32 v99, v99, v84, v84 op_sel:[0,0,0] op_sel_hi:[1,0,0]
    v_rcp_f32 v32, v96
    v_rcp_f32 v33, v97
    v_rcp_f32 v34, v98
    v_rcp_f32 v35, v99
    v_exp_f16_e64 v96, v122
    v_exp_f16_sdwa v97, v122 dst_sel:DWORD dst_unused:UNUSED_PAD src0_sel:WORD_1
    v_exp_f16_e64 v98, v123
    v_exp_f16_sdwa v99, v123 dst_sel:DWORD dst_unused:UNUSED_PAD src0_sel:WORD_1
    v_fma_mix_f32 v96, v96, v85, v85 op_sel:[0,0,0] op_sel_hi:[1,0,0]
    v_fma_mix_f32 v97, v97, v85, v85 op_sel:[0,0,0] op_sel_hi:[1,0,0]
    v_fma_mix_f32 v98, v98, v85, v85 op_sel:[0,0,0] op_sel_hi:[1,0,0]
    v_fma_mix_f32 v99, v99, v85, v85 op_sel:[0,0,0] op_sel_hi:[1,0,0]
    v_rcp_f32 v36, v96
    v_rcp_f32 v37, v97
    v_rcp_f32 v38, v98
    v_rcp_f32 v39, v99
    v_exp_f16_e64 v96, v124
    v_exp_f16_sdwa v97, v124 dst_sel:DWORD dst_unused:UNUSED_PAD src0_sel:WORD_1
    v_exp_f16_e64 v98, v125
    v_exp_f16_sdwa v99, v125 dst_sel:DWORD dst_unused:UNUSED_PAD src0_sel:WORD_1
    v_fma_mix_f32 v96, v96, v86, v86 op_sel:[0,0,0] op_sel_hi:[1,0,0]
    v_fma_mix_f32 v97, v97, v86, v86 op_sel:[0,0,0] op_sel_hi:[1,0,0]
    v_fma_mix_f32 v98, v98, v86, v86 op_sel:[0,0,0] op_sel_hi:[1,0,0]
    v_fma_mix_f32 v99, v99, v86, v86 op_sel:[0,0,0] op_sel_hi:[1,0,0]
    v_rcp_f32 v40, v96
    v_rcp_f32 v41, v97
    v_rcp_f32 v42, v98
    v_rcp_f32 v43, v99
    v_exp_f16_e64 v96, v126
    v_exp_f16_sdwa v97, v126 dst_sel:DWORD dst_unused:UNUSED_PAD src0_sel:WORD_1
    v_exp_f16_e64 v98, v127
    v_exp_f16_sdwa v99, v127 dst_sel:DWORD dst_unused:UNUSED_PAD src0_sel:WORD_1
    v_fma_mix_f32 v96, v96, v87, v87 op_sel:[0,0,0] op_sel_hi:[1,0,0]
    v_fma_mix_f32 v97, v97, v87, v87 op_sel:[0,0,0] op_sel_hi:[1,0,0]
    v_fma_mix_f32 v98, v98, v87, v87 op_sel:[0,0,0] op_sel_hi:[1,0,0]
    v_fma_mix_f32 v99, v99, v87, v87 op_sel:[0,0,0] op_sel_hi:[1,0,0]
    v_rcp_f32 v44, v96
    v_rcp_f32 v45, v97
    v_rcp_f32_e64 v46, v98
    v_rcp_f32_e64 v47, v99
    s_mov_b32 s46, 0
L_sp_23:
    ds_read_b64 v[100:101], v3 offset:32
    s_waitcnt lgkmcnt(0)
    v_cmp_eq_u32 vcc, 0, v100
    s_cbranch_vccz L_spd_24
    s_add_u32 s46, s46, 1
    s_sleep 1
    s_cmp_lt_u32 s46, 400000
    s_cbranch_scc1 L_sp_23
    s_branch L_end
L_spd_24:
    s_mov_b64 s[4:5], -1
    s_mov_b64 s[6:7], -1
    s_mov_b64 s[8:9], -1
    s_mov_b64 s[10:11], -1
    v_readfirstlane_b32 s40, v100
    s_andn2_b32 s40, 2047, s40
    s_lshr_b32 s41, s40, 8
    s_cmp_lg_u32 s41, s20
    s_cbranch_scc1 L_nomk_25
    s_bfe_u32 s41, s40, 0x20002
    s_bfe_u32 s42, s40, 0x40004
    s_lshl4_add_u32 s41, s41, s42
    s_lshl_b64 s[42:43], 1, s41
    s_and_b32 s40, s40, 3
    s_cmp_eq_u32 s40, 0
    s_cselect_b64 s[44:45], s[42:43], 0
    s_andn2_b64 s[4:5], s[4:5], s[44:45]
    s_cmp_eq_u32 s40, 1
    s_cselect_b64 s[44:45], s[42:43], 0
    s_andn2_b64 s[6:7], s[6:7], s[44:45]
    s_cmp_eq_u32 s40, 2
    s_cselect_b64 s[44:45], s[42:43], 0
    s_andn2_b64 s[8:9], s[8:9], s[44:45]
    s_cmp_eq_u32 s40, 3
    s_cselect_b64 s[44:45], s[42:43], 0
    s_andn2_b64 s[10:11], s[10:11], s[44:45]
L_nomk_25:
    v_readfirstlane_b32 s40, v101
    s_andn2_b32 s40, 2047, s40
    s_lshr_b32 s41, s40, 8
    s_cmp_lg_u32 s41, s20
    s_cbranch_scc1 L_nomk_26
    s_bfe_u32 s41, s40, 0x20002
    s_bfe_u32 s42, s40, 0x40004
    s_lshl4_add_u32 s41, s41, s42
    s_lshl_b64 s[42:43], 1, s41
    s_and_b32 s40, s40, 3
    s_cmp_eq_u32 s40, 0
    s_cselect_b64 s[44:45], s[42:43], 0
    s_andn2_b64 s[4:5], s[4:5], s[44:45]
    s_cmp_eq_u32 s40, 1
    s_cselect_b64 s[44:45], s[42:43], 0
    s_andn2_b64 s[6:7], s[6:7], s[44:45]
    s_cmp_eq_u32 s40, 2
    s_cselect_b64 s[44:45], s[42:43], 0
    s_andn2_b64 s[8:9], s[8:9], s[44:45]
    s_cmp_eq_u32 s40, 3
    s_cselect_b64 s[44:45], s[42:43], 0
    s_andn2_b64 s[10:11], s[10:11], s[44:45]
L_nomk_26:
    s_setprio 2
    s_mov_b32 s46, 0
L_sp_27:
    ds_read_b32 v96, v10 offset:64
    s_waitcnt lgkmcnt(0)
    v_cmp_gt_u32 vcc, 8, v96
    s_cbranch_vccz L_spd_28
    s_add_u32 s46, s46, 1
    s_sleep 1
    s_cmp_lt_u32 s46, 400000
    s_cbranch_scc1 L_sp_27
    s_branch L_end
    s_nop 0
L_spd_28:
    ds_read_b64 v[48:49], v5 offset:0
    ds_read_b64 v[50:51], v5 offset:14416
    ds_read_b64 v[52:53], v5 offset:28832
    ds_read_b64 v[54:55], v5 offset:43248
    ds_read_b64 v[56:57], v11 offset:0
    ds_read_b64 v[58:59], v11 offset:14416
    ds_read_b64 v[60:61], v11 offset:28832
    ds_read_b64 v[62:63], v11 offset:43248
    s_waitcnt lgkmcnt(6)
    v_fma_mix_f32 v16, v48, v16, v92 op_sel:[0,0,0] op_sel_hi:[1,0,0]
    v_fma_mix_f32 v20, v50, v20, v92 op_sel:[0,0,0] op_sel_hi:[1,0,0]
    s_waitcnt lgkmcnt(4)
    v_fma_mix_f32 v24, v52, v24, v92 op_sel:[0,0,0] op_sel_hi:[1,0,0]
    v_fma_mix_f32 v28, v54, v28, v92 op_sel:[0,0,0] op_sel_hi:[1,0,0]
    s_waitcnt lgkmcnt(2)
    v_fma_mix_f32 v32, v56, v32, v92 op_sel:[0,0,0] op_sel_hi:[1,0,0]
    v_fma_mix_f32 v36, v58, v36, v92 op_sel:[0,0,0] op_sel_hi:[1,0,0]
    s_waitcnt lgkmcnt(0)
    v_fma_mix_f32 v40, v60, v40, v92 op_sel:[0,0,0] op_sel_hi:[1,0,0]
    v_fma_mix_f32 v44, v62, v44, v92 op_sel:[0,0,0] op_sel_hi:[1,0,0]
    v_fma_mix_f32 v16, v112, v16, v88 op_sel:[0,0,0] op_sel_hi:[1,0,0]
    v_fma_mix_f32 v20, v114, v20, v88 op_sel:[0,0,0] op_sel_hi:[1,0,0]
    v_fma_mix_f32 v24, v116, v24, v88 op_sel:[0,0,0] op_sel_hi:[1,0,0]
    v_fma_mix_f32 v28, v118, v28, v88 op_sel:[0,0,0] op_sel_hi:[1,0,0]
    v_fma_mix_f32 v32, v120, v32, v88 op_sel:[0,0,0] op_sel_hi:[1,0,0]
    v_fma_mix_f32 v36, v122, v36, v88 op_sel:[0,0,0] op_sel_hi:[1,0,0]
    v_fma_mix_f32 v40, v124, v40, v88 op_sel:[0,0,0] op_sel_hi:[1,0,0]
    v_fma_mix_f32 v44, v126, v44, v88 op_sel:[0,0,0] op_sel_hi:[1,0,0]
    v_cvt_pk_bf16_f32 v64, v16, v20
    v_cvt_pk_bf16_f32 v65, v24, v28
    v_cvt_pk_bf16_f32 v66, v32, v36
    v_cvt_pk_bf16_f32 v67, v40, v44
    s_mov_b64 exec, s[4:5]
    global_store_dwordx4 v4, v[64:67], s[28:29] offset:-4096
    s_mov_b64 exec, -1
    v_fma_mix_f32 v17, v48, v17, v93 op_sel:[1,0,0] op_sel_hi:[1,0,0]
    v_fma_mix_f32 v21, v50, v21, v93 op_sel:[1,0,0] op_sel_hi:[1,0,0]
    v_fma_mix_f32 v25, v52, v25, v93 op_sel:[1,0,0] op_sel_hi:[1,0,0]
    v_fma_mix_f32 v29, v54, v29, v93 op_sel:[1,0,0] op_sel_hi:[1,0,0]
    v_fma_mix_f32 v33, v56, v33, v93 op_sel:[1,0,0] op_sel_hi:[1,0,0]
    v_fma_mix_f32 v37, v58, v37, v93 op_sel:[1,0,0] op_sel_hi:[1,0,0]
    v_fma_mix_f32 v41, v60, v41, v93 op_sel:[1,0,0] op_sel_hi:[1,0,0]
    v_fma_mix_f32 v45, v62, v45, v93 op_sel:[1,0,0] op_sel_hi:[1,0,0]
    v_fma_mix_f32 v17, v112, v17, v89 op_sel:[1,0,0] op_sel_hi:[1,0,0]
    v_fma_mix_f32 v21, v114, v21, v89 op_sel:[1,0,0] op_sel_hi:[1,0,0]
    v_fma_mix_f32 v25, v116, v25, v89 op_sel:[1,0,0] op_sel_hi:[1,0,0]
    v_fma_mix_f32 v29, v118, v29, v89 op_sel:[1,0,0] op_sel_hi:[1,0,0]
    v_fma_mix_f32 v33, v120, v33, v89 op_sel:[1,0,0] op_sel_hi:[1,0,0]
    v_fma_mix_f32 v37, v122, v37, v89 op_sel:[1,0,0] op_sel_hi:[1,0,0]
    v_fma_mix_f32 v41, v124, v41, v89 op_sel:[1,0,0] op_sel_hi:[1,0,0]
    v_fma_mix_f32 v45, v126, v45, v89 op_sel:[1,0,0] op_sel_hi:[1,0,0]
    v_cvt_pk_bf16_f32 v68, v17, v21
    v_cvt_pk_bf16_f32 v69, v25, v29
    v_cvt_pk_bf16_f32 v70, v33, v37
    v_cvt_pk_bf16_f32 v71, v41, v45
    s_mov_b64 exec, s[6:7]
    global_store_dwordx4 v4, v[68:71], s[28:29] offset:-2048
    s_mov_b64 exec, -1
    v_fma_mix_f32 v18, v49, v18, v94 op_sel:[0,0,0] op_sel_hi:[1,0,0]
    v_fma_mix_f32 v22, v51, v22, v94 op_sel:[0,0,0] op_sel_hi:[1,0,0]
    v_fma_mix_f32 v26, v53, v26, v94 op_sel:[0,0,0] op_sel_hi:[1,0,0]
    v_fma_mix_f32 v30, v55, v30, v94 op_sel:[0,0,0] op_sel_hi:[1,0,0]
    v_fma_mix_f32 v34, v57, v34, v94 op_sel:[0,0,0] op_sel_hi:[1,0,0]
    v_fma_mix_f32 v38, v59, v38, v94 op_sel:[0,0,0] op_sel_hi:[1,0,0]
    v_fma_mix_f32 v42, v61, v42, v94 op_sel:[0,0,0] op_sel_hi:[1,0,0]
    v_fma_mix_f32 v46, v63, v46, v94 op_sel:[0,0,0] op_sel_hi:[1,0,0]
    v_fma_mix_f32 v18, v113, v18, v90 op_sel:[0,0,0] op_sel_hi:[1,0,0]
    v_fma_mix_f32 v22, v115, v22, v90 op_sel:[0,0,0] op_sel_hi:[1,0,0]
    v_fma_mix_f32 v26, v117, v26, v90 op_sel:[0,0,0] op_sel_hi:[1,0,0]
    v_fma_mix_f32 v30, v119, v30, v90 op_sel:[0,0,0] op_sel_hi:[1,0,0]
    v_fma_mix_f32 v34, v121, v34, v90 op_sel:[0,0,0] op_sel_hi:[1,0,0]
    v_fma_mix_f32 v38, v123, v38, v90 op_sel:[0,0,0] op_sel_hi:[1,0,0]
    v_fma_mix_f32 v42, v125, v42, v90 op_sel:[0,0,0] op_sel_hi:[1,0,0]
    v_fma_mix_f32 v46, v127, v46, v90 op_sel:[0,0,0] op_sel_hi:[1,0,0]
    v_cvt_pk_bf16_f32 v72, v18, v22
    v_cvt_pk_bf16_f32 v73, v26, v30
    v_cvt_pk_bf16_f32 v74, v34, v38
    v_cvt_pk_bf16_f32 v75, v42, v46
    s_mov_b64 exec, s[8:9]
    global_store_dwordx4 v4, v[72:75], s[28:29] offset:0
    s_mov_b64 exec, -1
    v_fma_mix_f32 v19, v49, v19, v95 op_sel:[1,0,0] op_sel_hi:[1,0,0]
    v_fma_mix_f32 v23, v51, v23, v95 op_sel:[1,0,0] op_sel_hi:[1,0,0]
    v_fma_mix_f32 v27, v53, v27, v95 op_sel:[1,0,0] op_sel_hi:[1,0,0]
    v_fma_mix_f32 v31, v55, v31, v95 op_sel:[1,0,0] op_sel_hi:[1,0,0]
    v_fma_mix_f32 v35, v57, v35, v95 op_sel:[1,0,0] op_sel_hi:[1,0,0]
    v_fma_mix_f32 v39, v59, v39, v95 op_sel:[1,0,0] op_sel_hi:[1,0,0]
    v_fma_mix_f32 v43, v61, v43, v95 op_sel:[1,0,0] op_sel_hi:[1,0,0]
    v_fma_mix_f32 v47, v63, v47, v95 op_sel:[1,0,0] op_sel_hi:[1,0,0]
    v_fma_mix_f32 v19, v113, v19, v91 op_sel:[1,0,0] op_sel_hi:[1,0,0]
    v_fma_mix_f32 v23, v115, v23, v91 op_sel:[1,0,0] op_sel_hi:[1,0,0]
    v_fma_mix_f32 v27, v117, v27, v91 op_sel:[1,0,0] op_sel_hi:[1,0,0]
    v_fma_mix_f32 v31, v119, v31, v91 op_sel:[1,0,0] op_sel_hi:[1,0,0]
    v_fma_mix_f32 v35, v121, v35, v91 op_sel:[1,0,0] op_sel_hi:[1,0,0]
    v_fma_mix_f32 v39, v123, v39, v91 op_sel:[1,0,0] op_sel_hi:[1,0,0]
    v_fma_mix_f32 v43, v125, v43, v91 op_sel:[1,0,0] op_sel_hi:[1,0,0]
    v_fma_mix_f32 v47, v127, v47, v91 op_sel:[1,0,0] op_sel_hi:[1,0,0]
    v_cvt_pk_bf16_f32 v76, v19, v23
    v_cvt_pk_bf16_f32 v77, v27, v31
    v_cvt_pk_bf16_f32 v78, v35, v39
    v_cvt_pk_bf16_f32 v79, v43, v47
    s_mov_b64 exec, s[10:11]
    global_store_dwordx4 v4, v[76:79], s[28:29] offset:2048
    s_mov_b64 exec, -1
    s_or_b32 s40, s2, s3
    s_cbranch_scc1 L_fin
    s_add_u32 s40, s47, 1
    v_mov_b32 v5, s40
    s_mov_b64 exec, 1
    global_store_dword v3, v5, s[32:33]
    s_branch L_fin
    s_nop 0
L_exp:
    v_lshrrev_b32 v20, 4, v1
    v_and_b32 v21, 240, v2
    v_lshrrev_b32 v22, 5, v1
    v_and_b32 v23, 1, v20
    v_lshl_add_u32 v4, v22, 4, v23
    v_mul_u32_u24 v4, 7168, v4
    v_add_u32_e64 v4, v4, v21
    v_lshl_add_u32 v5, v22, 3, v23
    v_lshl_add_u32 v5, v5, 11, v21
    v_lshrrev_b32 v19, 1, v21
    v_and_b32 v23, 3, v1
    v_mul_u32_u24 v14, 0x5555, v23
    v_lshlrev_b32 v23, 3, v23
    v_lshl_add_u32 v17, v20, 5, v23
    v_and_b32 v22, 8, v1
    v_lshl_add_u32 v11, v22, 6, v17
    v_bfe_i32 v9, v1, 2, 1
    v_lshrrev_b32 v7, 16, v9
    v_lshlrev_b32 v9, 16, v9
    v_xor_b32 v6, 0xffff, v7
    v_xor_b32 v8, 0xffff0000, v9
    v_and_b32 v23, 512, v2
    v_lshl_add_u32 v23, v21, 1, v23
    v_and_b32_e64 v22, 16, v1
    s_lshl_b32 s40, s34, 10
    v_add3_u32 v10, v22, v23, s40
    s_bitcmp1_b32 s35, 0
    s_cselect_b64 s[48:49], s[24:25], s[22:23]
    s_lshr_b32 s40, s35, 1
    s_lshl2_add_u32 s40, s40, s34
    s_lshl_b32 s41, s40, 7
    v_add_u32 v17, s41, v17
    s_mul_i32 s40, s40, 458752
    s_mul_i32 s41, s36, 37
    s_lshr_b32 s41, s41, 8
    s_mul_i32 s42, s41, 7
    s_sub_u32 s7, s36, s42
    s_lshl_b32 s41, s41, 2
    s_lshr_b32 s41, 0x2031, s41
    s_and_b32 s41, s41, 3
    s_lshl2_add_u32 s7, s7, s41
    s_lshl_b32 s41, s7, 8
    s_add_u32 s40, s40, s41
    s_add_u32 s48, s48, s40
    s_addc_u32 s49, s49, 0
    s_add_u32 s10, s48, 229376
    s_addc_u32 s11, s49, 0
    s_add_u32 s30, s32, 32768
    s_addc_u32 s31, s33, 0
    s_lshl2_add_u32 s40, s7, s34
    s_lshl_b32 s40, s40, 16
    s_lshl_b32 s41, s35, 8
    s_add_u32 s40, s40, s41
    s_add_u32 s40, s40, 4096
    s_add_u32 s50, s26, s40
    s_addc_u32 s51, s27, 0
    s_add_u32 s52, s50, 32768
    s_addc_u32 s53, s51, 0
    s_add_u32 s12, s50, 8192
    s_addc_u32 s13, s51, 0
    s_add_u32 s14, s52, 8192
    s_addc_u32 s15, s53, 0
    s_lshl_b32 s40, s2, 7
    s_add_u32 s40, s40, 98304
    s_add_u32 s54, s32, s40
    s_addc_u32 s55, s33, 0
    s_lshl_b32 s40, s36, 10
    s_lshl2_add_u32 s40, s35, s40
    s_add_u32 s40, s40, 98304
    s_add_u32 s56, s32, s40
    s_addc_u32 s57, s33, 0
    s_lshl_b32 s40, s2, 10
    s_add_u32 s40, s40, 131072
    s_add_u32 s58, s32, s40
    s_addc_u32 s59, s33, 0
    s_lshl_b32 s40, s36, 13
    s_lshl_b32 s41, s34, 7
    s_add_u32 s40, s40, s41
    s_add_u32 s40, s40, 135168
    s_add_u32 s60, s32, s40
    s_addc_u32 s61, s33, 0
    s_mul_i32 s40, s35, 28
    s_add_u32 s40, s40, s36
    s_lshl_b32 s40, s40, 10
    s_add_u32 s40, s40, 524288
    s_add_u32 s62, s32, s40
    s_addc_u32 s63, s33, 0
    s_setprio 3
    s_lshl_b32 s40, s34, 7
    v_mov_b32 v16, s40
    s_mov_b32 s46, 0
L_sp_29:
    ds_read_b64 v[22:23], v3 offset:40
    s_waitcnt lgkmcnt(0)
    v_cmp_eq_u32_e64 vcc, 0, v23
    s_cbranch_vccz L_spd_30
    s_add_u32 s46, s46, 1
    s_cmp_lt_u32 s46, 400000
    s_cbranch_scc1 L_sp_29
    s_branch L_end
L_spd_30:
    v_readfirstlane_b32 s39, v22
    s_and_b32 s40, s39, 1
    s_mul_i32 s40, s40, 0x01010101
    s_and_b32 s41, s39, 0xfefefefe
    s_or_b32 s41, s41, s40
    v_bfe_u32 v28, s41, v11, 8
    v_lshrrev_b32 v29, v2, s41
    v_lshrrev_b32 v30, 8, v29
    s_cmp_ge_u32 s36, 28
    s_cbranch_scc1 L_noexp
    global_load_dwordx4 v[32:35], v4, s[48:49] nt
    s_add_u32 s48, s48, 14336
    s_addc_u32 s49, s49, 0
    global_load_dwordx4 v[36:39], v4, s[10:11] nt
    s_add_u32 s10, s10, 14336
    s_addc_u32 s11, s11, 0
    global_load_dwordx4 v[40:43], v4, s[48:49] nt
    s_add_u32 s48, s48, 14336
    s_addc_u32 s49, s49, 0
    global_load_dwordx4 v[44:47], v4, s[10:11] nt
    s_add_u32 s10, s10, 14336
    s_addc_u32 s11, s11, 0
    s_cmp_lg_u32 s34, 0
    s_cbranch_scc1 L_warm_31
    s_load_dword s8, s[54:55], 0 glc
L_warm_31:
    v_and_b32 v18, 128, v2
    v_lshl_add_u32 v18, v16, 1, v18
    global_load_dword v31, v18, s[62:63]
    s_waitcnt vmcnt(4)
    s_nop 0
    global_load_dwordx4 v[48:51], v4, s[48:49] nt
    s_add_u32 s48, s48, 14336
    s_addc_u32 s49, s49, 0
    s_waitcnt vmcnt(4)
    global_load_dwordx4 v[52:55], v4, s[10:11] nt
    s_add_u32 s10, s10, 14336
    s_addc_u32 s11, s11, 0
    s_waitcnt vmcnt(4)
    global_load_dwordx4 v[56:59], v4, s[48:49] nt
    s_add_u32 s48, s48, 14336
    s_addc_u32 s49, s49, 0
    s_waitcnt vmcnt(4)
    global_load_dwordx4 v[60:63], v4, s[10:11] nt
    s_add_u32 s10, s10, 14336
    s_addc_u32 s11, s11, 0
    s_waitcnt vmcnt(3)
    global_load_dwordx4 v[64:67], v4, s[48:49] nt
    s_add_u32 s48, s48, 14336
    s_addc_u32 s49, s49, 0
    s_waitcnt vmcnt(3)
    global_load_dwordx4 v[68:71], v4, s[10:11] nt
    s_add_u32 s10, s10, 14336
    s_addc_u32 s11, s11, 0
    s_waitcnt vmcnt(3)
    global_load_dwordx4 v[72:75], v4, s[48:49] nt
    s_add_u32 s48, s48, 14336
    s_addc_u32 s49, s49, 0
    s_waitcnt vmcnt(3)
    global_load_dwordx4 v[76:79], v4, s[10:11] nt
    s_add_u32 s10, s10, 14336
    s_addc_u32 s11, s11, 0
    s_waitcnt vmcnt(3)
    global_load_dwordx4 v[80:83], v4, s[48:49] nt
    s_add_u32 s48, s48, 14336
    s_addc_u32 s49, s49, 0
    s_waitcnt vmcnt(3)
    global_load_dwordx4 v[84:87], v4, s[10:11] nt
    s_add_u32 s10, s10, 14336
    s_addc_u32 s11, s11, 0
    s_waitcnt vmcnt(3)
    global_load_dwordx4 v[88:91], v4, s[48:49] nt
    s_waitcnt vmcnt(3)
    global_load_dwordx4 v[92:95], v4, s[10:11] nt
    s_mov_b32 s46, 0
L_sp_32:
    ds_read_b64 v[24:25], v19 offset:128
    s_waitcnt lgkmcnt(0)
    v_cmp_eq_u32 vcc, 0, v24
    s_cbranch_vccz L_spd_33
    s_add_u32 s46, s46, 1
    s_sleep 1
    s_cmp_lt_u32 s46, 400000
    s_cbranch_scc1 L_sp_32
    s_branch L_end
    s_nop 0
L_spd_33:
    v_max_u32_dpp v27, v25, v25 quad_perm:[1,0,3,2] row_mask:0xf bank_mask:0xf
    v_min_u32_dpp v26, v24, v24 quad_perm:[1,0,3,2] row_mask:0xf bank_mask:0xf
    v_max_u32 v25, v26, v27
    v_max_u32_dpp v24, v24, v24 quad_perm:[1,0,3,2] row_mask:0xf bank_mask:0xf
    s_nop 0
    v_max_u32_dpp v27, v25, v25 quad_perm:[2,3,0,1] row_mask:0xf bank_mask:0xf
    v_min_u32_dpp v26, v24, v24 quad_perm:[2,3,0,1] row_mask:0xf bank_mask:0xf
    v_max_u32 v25, v26, v27
    v_max_u32_dpp v24, v24, v24 quad_perm:[2,3,0,1] row_mask:0xf bank_mask:0xf
    s_nop 0
    v_max_u32_dpp v27, v25, v25 row_half_mirror row_mask:0xf bank_mask:0xf
    v_min_u32_dpp v26, v24, v24 row_half_mirror row_mask:0xf bank_mask:0xf
    v_max_u32 v25, v26, v27
    v_max_u32_dpp v24, v24, v24 row_half_mirror row_mask:0xf bank_mask:0xf
    s_nop 0
    v_max_u32_dpp v27, v25, v25 row_mirror row_mask:0xf bank_mask:0xf
    v_min_u32_dpp v26, v24, v24 row_mirror row_mask:0xf bank_mask:0xf
    v_max_u32_e64 v25, v26, v27
    v_max_u32_dpp v24, v24, v24 row_mirror row_mask:0xf bank_mask:0xf
    s_mov_b32 vcc_lo, 0xff00ff00
    s_mov_b32 vcc_hi, 0xff00ff00
    s_movk_i32 s40, 2047
    v_cndmask_b32 v16, v24, v25, vcc
    v_bfi_b32 v18, v16, 0, s40
    v_lshl_add_u32 v17, v18, 11, v17
    v_lshlrev_b32_e64 v18, 3, v18
    global_load_dwordx2 v[20:21], v17, s[4:5]
    global_load_dword v22, v18, s[30:31] sc1
    v_mov_b32 v0, 1
    s_mov_b64 exec, 1
    ds_add_u32 v3, v0 offset:92
    s_mov_b64 exec, -1
    s_mov_b64 exec, 1
    ds_write_b64 v3, v[24:25] offset:32
    s_mov_b64 exec, -1
    v_readfirstlane_b32 s16, v24
    v_readfirstlane_b32 s17, v25
    s_cmp_eq_u32 s34, 0
    s_cselect_b32 s16, s16, s17
    s_andn2_b32 s17, 2047, s16
    s_lshr_b32 s40, s17, 8
    s_add_u32 s41, s40, 2
    s_bfe_u32 s19, s41, 0x10002
    s_xor_b32 s19, s19, s38
    s_and_b32 s42, s34, 2
    s_or_b32 s19, s19, s42
    s_cmp_eq_u32 s38, 0
    s_cselect_b32 s18, s40, s41
    s_and_b32 s18, s18, 3
    s_mul_i32 s40, s35, 28672
    s_and_b32 s41, s34, 1
    s_lshl_b32 s41, s41, 9
    s_add_u32 s40, s40, s41
    s_and_b32 s41, s36, 15
    s_lshl_b32 s41, s41, 5
    s_add_u32 s40, s40, s41
    s_add_u32 s40, s40, 524288
    s_add_u32 s22, s32, s40
    s_addc_u32 s23, s33, 0
    s_add_u32 s24, s22, 262144
    s_addc_u32 s25, s23, 0
    s_bfe_u32 s40, s17, 0x20002
    s_bfe_u32 s41, s17, 0x40004
    s_lshl4_add_u32 s40, s40, s41
    s_and_b32 s41, s17, 3
    s_lshl2_add_u32 s40, s40, s41
    s_lshl_b32 s41, s18, 8
    s_add_u32 s40, s40, s41
    s_lshl_b32 s40, s40, 1
    s_add_u32 s20, s40, 52096
    s_bitcmp1_b32 s16, 31
    s_brev_b32 s40, 1
    s_cselect_b32 s40, s40, -1
    s_xor_b32 s40, s40, s16
    s_and_b32 s21, s40, 0xffff0000
    v_mov_b32 v0, 1
    s_waitcnt vmcnt(0)
    v_and_b32 v17, 0xffff0000, v22
    v_rcp_f32 v17, v17
    v_lshlrev_b32 v22, 16, v22
    v_lshlrev_b32_e64 v24, 16, v20
    v_and_b32 v25, 0xffff0000, v20
    v_mul_f32 v22, -v22, v17
    v_lshlrev_b32_e64 v26, 16, v21
    v_and_b32 v27, 0xffff0000, v21
    v_fma_f32 v24, v24, v17, v22
    v_fma_f32 v25, v25, v17, v22
    v_fma_f32 v26, v26, v17, v22
    v_fma_f32 v27, v27, v17, v22
    v_cvt_pk_bf16_f32 v12, v24, v25
    v_cvt_pk_bf16_f32 v13, v26, v27
    v_mov_b32 v24, 0
    v_mov_b32 v25, 0
    v_mov_b32 v26, 0
    v_mov_b32 v27, 0
    v_and_b32_dpp v16, v12, v6 quad_perm:[0,0,0,0] row_mask:0xf bank_mask:0xf
    v_and_b32_dpp v17, v12, v7 quad_perm:[0,0,0,0] row_mask:0xf bank_mask:0xf
    v_and_b32_dpp v18, v12, v8 quad_perm:[0,0,0,0] row_mask:0xf bank_mask:0xf
    v_and_b32_dpp v19, v12, v9 quad_perm:[0,0,0,0] row_mask:0xf bank_mask:0xf
    v_and_b32_dpp v20, v13, v6 quad_perm:[0,0,0,0] row_mask:0xf bank_mask:0xf
    v_and_b32_dpp v21, v13, v7 quad_perm:[0,0,0,0] row_mask:0xf bank_mask:0xf
    v_and_b32_dpp v22, v13, v8 quad_perm:[0,0,0,0] row_mask:0xf bank_mask:0xf
    v_and_b32_dpp v23, v13, v9 quad_perm:[0,0,0,0] row_mask:0xf bank_mask:0xf
    v_smfmac_f32_16x16x64_bf16 v[24:27], v[16:19], v[32:39], v14
    v_and_b32_dpp v16, v12, v6 quad_perm:[1,1,1,1] row_mask:0xf bank_mask:0xf
    v_and_b32_dpp v17, v12, v7 quad_perm:[1,1,1,1] row_mask:0xf bank_mask:0xf
    v_and_b32_dpp v18, v12, v8 quad_perm:[1,1,1,1] row_mask:0xf bank_mask:0xf
    v_and_b32_dpp v19, v12, v9 quad_perm:[1,1,1,1] row_mask:0xf bank_mask:0xf
    v_smfmac_f32_16x16x64_bf16 v[24:27], v[20:23], v[40:47], v14
    global_load_dwordx4 v[96:99], v5, s[50:51] offset:-4096 nt
    v_and_b32_dpp v20, v13, v6 quad_perm:[1,1,1,1] row_mask:0xf bank_mask:0xf
    v_and_b32_dpp v21, v13, v7 quad_perm:[1,1,1,1] row_mask:0xf bank_mask:0xf
    v_and_b32_dpp v22, v13, v8 quad_perm:[1,1,1,1] row_mask:0xf bank_mask:0xf
    v_and_b32_dpp v23, v13, v9 quad_perm:[1,1,1,1] row_mask:0xf bank_mask:0xf
    s_mov_b64 exec, 1
    ds_add_rtn_u32 v31, v3, v0 offset:60
    s_mov_b64 exec, -1
    v_smfmac_f32_16x16x64_bf16 v[24:27], v[16:19], v[48:55], v14
    global_load_dwordx4 v[100:103], v5, s[52:53] offset:-4096 nt
    v_and_b32_dpp v16, v12, v6 quad_perm:[2,2,2,2] row_mask:0xf bank_mask:0xf
    v_and_b32_dpp v17, v12, v7 quad_perm:[2,2,2,2] row_mask:0xf bank_mask:0xf
    v_and_b32_dpp v18, v12, v8 quad_perm:[2,2,2,2] row_mask:0xf bank_mask:0xf
    v_and_b32_dpp v19, v12, v9 quad_perm:[2,2,2,2] row_mask:0xf bank_mask:0xf
    v_smfmac_f32_16x16x64_bf16 v[24:27], v[20:23], v[56:63], v14
    global_load_dwordx4 v[104:107], v5, s[50:51] offset:0 nt
    v_and_b32_dpp v20, v13, v6 quad_perm:[2,2,2,2] row_mask:0xf bank_mask:0xf
    v_and_b32_dpp v21, v13, v7 quad_perm:[2,2,2,2] row_mask:0xf bank_mask:0xf
    v_and_b32_dpp v22, v13, v8 quad_perm:[2,2,2,2] row_mask:0xf bank_mask:0xf
    v_and_b32_dpp v23, v13, v9 quad_perm:[2,2,2,2] row_mask:0xf bank_mask:0xf
    v_smfmac_f32_16x16x64_bf16 v[24:27], v[16:19], v[64:71], v14
    global_load_dwordx4 v[108:111], v5, s[52:53] offset:0 nt
    v_and_b32_dpp v16, v12, v6 quad_perm:[3,3,3,3] row_mask:0xf bank_mask:0xf
    v_and_b32_dpp v17, v12, v7 quad_perm:[3,3,3,3] row_mask:0xf bank_mask:0xf
    v_and_b32_dpp v18, v12, v8 quad_perm:[3,3,3,3] row_mask:0xf bank_mask:0xf
    v_and_b32_dpp v19, v12, v9 quad_perm:[3,3,3,3] row_mask:0xf bank_mask:0xf
    s_waitcnt lgkmcnt(0)
    v_readfirstlane_b32 s40, v31
    s_cmp_lg_u32 s40, 3
    s_cbranch_scc1 L_ef_34
    v_mov_b32_e64 v31, s39
    v_lshlrev_b32_e64 v0, 7, v1
    s_mov_b64 exec, 255
    global_store_dword v0, v31, s[56:57] sc1
    s_mov_b64 exec, -1
L_ef_34:
    s_nop 0
    v_smfmac_f32_16x16x64_bf16 v[24:27], v[20:23], v[72:79], v14
    global_load_dwordx4 v[112:115], v5, s[12:13] offset:-4096 nt
    v_and_b32_dpp v20, v13, v6 quad_perm:[3,3,3,3] row_mask:0xf bank_mask:0xf
    v_and_b32_dpp v21, v13, v7 quad_perm:[3,3,3,3] row_mask:0xf bank_mask:0xf
    v_and_b32_dpp v22, v13, v8 quad_perm:[3,3,3,3] row_mask:0xf bank_mask:0xf
    v_and_b32_dpp v23, v13, v9 quad_perm:[3,3,3,3] row_mask:0xf bank_mask:0xf
    v_smfmac_f32_16x16x64_bf16 v[24:27], v[16:19], v[80:87], v14
    global_load_dwordx4 v[116:119], v5, s[14:15] offset:-4096 nt
    v_smfmac_f32_16x16x64_bf16 v[24:27], v[20:23], v[88:95], v14
    global_load_dwordx4 v[120:123], v5, s[12:13] offset:0 nt
    v_mov_b32_e64 v0, 1
    s_movk_i32 s6, 255
    s_nop 4
    ds_write_b128 v10, v[24:27] offset:768
    s_mov_b64 exec, 1
    ds_add_rtn_u32 v31, v3, v0 offset:52
    s_mov_b64 exec, -1
    ds_read_b128 v[48:51], v2 offset:768
    ds_read_b128 v[52:55], v2 offset:1792
    ds_read_b128 v[56:59], v2 offset:2816
    ds_read_b128 v[60:63], v2 offset:3840
    s_waitcnt lgkmcnt(4)
    v_readfirstlane_b32 s40, v31
    s_cmp_lg_u32 s40, 3
    s_cbranch_scc1 L_ha_35
    s_waitcnt lgkmcnt(2)
    v_add_f32 v48, v48, v52
    v_add_f32 v49, v49, v53
    v_add_f32 v50, v50, v54
    v_add_f32 v51, v51, v55
    s_waitcnt lgkmcnt(0)
    v_add_f32 v56, v56, v60
    v_add_f32 v57, v57, v61
    v_add_f32 v58, v58, v62
    v_add_f32 v59, v59, v63
    v_add_f32 v48, v48, v56
    v_add_f32 v49, v49, v57
    v_add_f32 v50, v50, v58
    v_add_f32 v51, v51, v59
    v_bfi_b32 v48, s6, v29, v48
    v_bfi_b32 v50, s6, v30, v50
    global_store_dwordx4 v2, v[48:51], s[58:59] sc1
L_ha_35:
    global_load_dwordx4 v[124:127], v5, s[14:15] offset:0 nt
    v_mov_b32 v24, 0
    v_mov_b32 v25, 0
    v_mov_b32 v26, 0
    v_mov_b32 v27, 0
    s_cmp_lg_u32 s19, 0
    s_cbranch_scc1 L_nort_36
    v_and_b32 v75, 3, v1
    v_lshrrev_b32 v72, 5, v1
    v_lshl_add_u32 v72, v75, 1, v72
    v_lshrrev_b32 v73, 2, v1
    v_lshlrev_b32 v73, 10, v73
    v_lshl_add_u32 v73, v75, 3, v73
    v_add_u32 v74, 16384, v73
    s_lshl_b32 s40, s17, 11
    s_lshl4_add_u32 s40, s37, s40
    v_lshl_add_u32 v75, v72, 1, s40
    global_load_ushort v76, v75, s[4:5]
    v_mov_b32 v80, 0xbfb8aa3b
    v_mul_f32 v80, s21, v80
    v_exp_f32 v80, v80
    v_mov_b32 v84, v28
    v_mov_b32 v85, 0
    v_add_f32 v80, 1.0, v80
    v_rcp_f32 v80, v80
    s_lshl_b32 s40, s18, 2
    v_mov_b32 v81, s40
    v_mul_f32 v80, 0xbfb8aa3b, v80
    v_mul_u32_u24 v78, 14416, v72
    v_add_u32 v78, s20, v78
    s_lshl_b32 s40, s17, 1
    v_mul_u32_u24 v77, 4624, v72
    v_add_u32_e64 v77, s40, v77
    v_lshlrev_b32 v79, 2, v72
L_nort_36:
    s_mov_b32 s46, 0
L_mf_37:
    s_load_dwordx8 s[8:15], s[54:55], 0 glc
    s_add_u32 s46, s46, 1
    s_cmp_gt_u32 s46, 50000
    s_cbranch_scc1 L_end
    s_waitcnt lgkmcnt(0)
    s_xor_b32 s40, s8, s39
    s_xor_b32 s41, s9, s39
    s_or_b32 s40, s40, s41
    s_xor_b32 s41, s10, s39
    s_or_b32 s40, s40, s41
    s_xor_b32 s41, s11, s39
    s_or_b32 s40, s40, s41
    s_xor_b32 s41, s12, s39
    s_or_b32 s40, s40, s41
    s_xor_b32 s41, s13, s39
    s_or_b32 s40, s40, s41
    s_xor_b32 s41, s14, s39
    s_or_b32 s40, s40, s41
    s_xor_b32 s41, s15, s39
    s_or_b32 s40, s40, s41
    s_cbranch_scc1 L_mf_37
    s_mov_b32 s46, 0
L_hp_38:
    global_load_dwordx2 v[32:33], v11, s[60:61] offset:-4096 sc1
    global_load_dwordx2 v[34:35], v11, s[60:61] offset:-3072 sc1
    global_load_dwordx2 v[36:37], v11, s[60:61] offset:-2048 sc1
    global_load_dwordx2 v[38:39], v11, s[60:61] offset:-1024 sc1
    global_load_dwordx2 v[40:41], v11, s[60:61] offset:0 sc1
    global_load_dwordx2 v[42:43], v11, s[60:61] offset:1024 sc1
    global_load_dwordx2 v[44:45], v11, s[60:61] offset:2048 sc1
    global_load_dwordx2 v[46:47], v11, s[60:61] offset:3072 sc1
    s_add_u32 s46, s46, 1
    s_cmp_gt_u32 s46, 50000
    s_cbranch_scc1 L_end
    s_waitcnt vmcnt(7)
    v_xor_b32 v31, v28, v32
    s_waitcnt vmcnt(6)
    v_bitop3_b32 v31, v31, v34, v28 bitop3:0xf6
    s_waitcnt vmcnt(5)
    v_bitop3_b32 v31, v31, v36, v28 bitop3:0xf6
    v_add_f32 v64, v32, v36
    v_add_f32 v65, v33, v37
    s_waitcnt vmcnt(4)
    v_bitop3_b32 v31, v31, v38, v28 bitop3:0xf6
    v_add_f32 v66, v34, v38
    v_add_f32 v67, v35, v39
    s_waitcnt vmcnt(3)
    v_bitop3_b32 v31, v31, v40, v28 bitop3:0xf6
    v_add_f32 v64, v64, v40
    v_add_f32_e64 v65, v65, v41
    s_waitcnt vmcnt(2)
    v_bitop3_b32 v31, v31, v42, v28 bitop3:0xf6
    v_add_f32 v66, v66, v42
    v_add_f32 v67, v67, v43
    s_waitcnt vmcnt(1)
    v_bitop3_b32 v31, v31, v44, v28 bitop3:0xf6
    v_add_f32 v64, v64, v44
    v_add_f32 v65, v65, v45
    s_waitcnt vmcnt(0)
    v_bitop3_b32 v31, v31, v46, v28 bitop3:0xf6
    v_add_f32 v66, v66, v46
    v_add_f32 v67, v67, v47
    v_and_b32 v31, 0xff, v31
    v_cmp_ne_u32_e64 vcc, 0, v31
    v_mul_f32 v68, 0xbfb8aa3b, v64
    v_mul_f32 v69, 0xbfb8aa3b, v65
    s_cbranch_vccnz L_hp_38
    v_exp_f32 v68, v68
    v_exp_f32 v69, v69
    v_mul_f32 v64, v64, v66
    v_mul_f32 v65, v65, v67
    v_add_f32 v68, 1.0, v68
    v_add_f32 v69, 1.0, v69
    v_rcp_f32 v68, v68
    v_rcp_f32 v69, v69
    v_mul_f32 v64, v64, v68
    v_mul_f32 v65, v65, v69
    v_cvt_pk_bf16_f32 v12, v64, v65
    s_nop 1
    v_and_b32_dpp v16, v12, v6 quad_perm:[0,0,0,0] row_mask:0xf bank_mask:0xf
    v_and_b32_dpp v17, v12, v7 quad_perm:[0,0,0,0] row_mask:0xf bank_mask:0xf
    v_and_b32_dpp v18, v12, v8 quad_perm:[0,0,0,0] row_mask:0xf bank_mask:0xf
    v_and_b32_dpp v19, v12, v9 quad_perm:[0,0,0,0] row_mask:0xf bank_mask:0xf
    v_and_b32_dpp v20, v12, v6 quad_perm:[1,1,1,1] row_mask:0xf bank_mask:0xf
    v_and_b32_dpp v21, v12, v7 quad_perm:[1,1,1,1] row_mask:0xf bank_mask:0xf
    v_and_b32_dpp v22, v12, v8 quad_perm:[1,1,1,1] row_mask:0xf bank_mask:0xf
    v_and_b32_dpp v23, v12, v9 quad_perm:[1,1,1,1] row_mask:0xf bank_mask:0xf
    v_smfmac_f32_16x16x64_bf16 v[24:27], v[16:19], v[96:103], v14
    v_and_b32_dpp v16, v12, v6 quad_perm:[2,2,2,2] row_mask:0xf bank_mask:0xf
    v_and_b32_dpp v17, v12, v7 quad_perm:[2,2,2,2] row_mask:0xf bank_mask:0xf
    v_and_b32_dpp v18, v12, v8 quad_perm:[2,2,2,2] row_mask:0xf bank_mask:0xf
    v_and_b32_dpp v19, v12, v9 quad_perm:[2,2,2,2] row_mask:0xf bank_mask:0xf
    v_smfmac_f32_16x16x64_bf16 v[24:27], v[20:23], v[104:111], v14
    v_and_b32_dpp v20, v12, v6 quad_perm:[3,3,3,3] row_mask:0xf bank_mask:0xf
    v_and_b32_dpp v21, v12, v7 quad_perm:[3,3,3,3] row_mask:0xf bank_mask:0xf
    v_and_b32_dpp v22, v12, v8 quad_perm:[3,3,3,3] row_mask:0xf bank_mask:0xf
    v_and_b32_dpp v23, v12, v9 quad_perm:[3,3,3,3] row_mask:0xf bank_mask:0xf
    v_smfmac_f32_16x16x64_bf16 v[24:27], v[16:19], v[112:119], v14
    s_nop 0
    v_smfmac_f32_16x16x64_bf16 v[24:27], v[20:23], v[120:127], v14
    s_add_u32 s58, s62, 262144
    s_addc_u32 s59, s63, 0
    v_mov_b32_e64 v0, 1
    s_movk_i32 s6, 255
    s_nop 3
    ds_write_b128 v10, v[24:27] offset:768
    s_mov_b64 exec, 1
    ds_add_rtn_u32 v31, v3, v0 offset:52
    s_mov_b64 exec, -1
    ds_read_b128 v[48:51], v2 offset:768
    ds_read_b128 v[52:55], v2 offset:1792
    ds_read_b128 v[56:59], v2 offset:2816
    ds_read_b128 v[60:63], v2 offset:3840
    s_waitcnt lgkmcnt(4)
    v_readfirstlane_b32 s40, v31
    s_cmp_lg_u32 s40, 7
    s_cbranch_scc1 L_hb_39
    s_waitcnt lgkmcnt(2)
    v_add_f32 v48, v48, v52
    v_add_f32 v49, v49, v53
    v_add_f32 v50, v50, v54
    v_add_f32 v51, v51, v55
    s_waitcnt lgkmcnt(0)
    v_add_f32 v56, v56, v60
    v_add_f32 v57, v57, v61
    v_add_f32 v58, v58, v62
    v_add_f32 v59, v59, v63
    v_add_f32 v48, v48, v56
    v_add_f32 v49, v49, v57
    v_add_f32_e64 v50, v50, v58
    v_add_f32_e64 v51, v51, v59
    v_bfi_b32 v48, s6, v29, v48
    v_bfi_b32 v50, s6, v30, v50
    global_store_dwordx4 v2, v[48:51], s[62:63]
    global_store_dwordx4 v2, v[48:51], s[58:59] sc1
L_hb_39:
    s_branch L_routed
    s_nop 0
L_noexp:
    s_mov_b32 s46, 0
L_sp_40:
    ds_read_b64 v[24:25], v19 offset:128
    s_waitcnt lgkmcnt(0)
    v_cmp_eq_u32 vcc, 0, v24
    s_cbranch_vccz L_spd_41
    s_add_u32 s46, s46, 1
    s_sleep 2
    s_cmp_lt_u32 s46, 400000
    s_cbranch_scc1 L_sp_40
    s_branch L_end
L_spd_41:
    v_max_u32_dpp v27, v25, v25 quad_perm:[1,0,3,2] row_mask:0xf bank_mask:0xf
    v_min_u32_dpp v26, v24, v24 quad_perm:[1,0,3,2] row_mask:0xf bank_mask:0xf
    v_max_u32 v25, v26, v27
    v_max_u32_dpp v24, v24, v24 quad_perm:[1,0,3,2] row_mask:0xf bank_mask:0xf
    s_nop 0
    v_max_u32_dpp v27, v25, v25 quad_perm:[2,3,0,1] row_mask:0xf bank_mask:0xf
    v_min_u32_dpp v26, v24, v24 quad_perm:[2,3,0,1] row_mask:0xf bank_mask:0xf
    v_max_u32 v25, v26, v27
    v_max_u32_dpp v24, v24, v24 quad_perm:[2,3,0,1] row_mask:0xf bank_mask:0xf
    s_nop 0
    v_max_u32_dpp v27, v25, v25 row_half_mirror row_mask:0xf bank_mask:0xf
    v_min_u32_dpp v26, v24, v24 row_half_mirror row_mask:0xf bank_mask:0xf
    v_max_u32 v25, v26, v27
    v_max_u32_dpp v24, v24, v24 row_half_mirror row_mask:0xf bank_mask:0xf
    s_nop 0
    v_max_u32_dpp v27, v25, v25 row_mirror row_mask:0xf bank_mask:0xf
    v_min_u32_dpp v26, v24, v24 row_mirror row_mask:0xf bank_mask:0xf
    v_max_u32_e64 v25, v26, v27
    v_max_u32_dpp v24, v24, v24 row_mirror row_mask:0xf bank_mask:0xf
    v_mov_b32 v0, 1
    s_mov_b64 exec, 1
    ds_add_u32 v3, v0 offset:92
    s_mov_b64 exec, -1
    s_mov_b64 exec, 1
    ds_write_b64 v3, v[24:25] offset:32
    s_mov_b64 exec, -1
    v_readfirstlane_b32 s16, v24
    v_readfirstlane_b32 s17, v25
    s_cmp_eq_u32 s34, 0
    s_cselect_b32 s16, s16, s17
    s_andn2_b32 s17, 2047, s16
    s_lshr_b32 s40, s17, 8
    s_add_u32 s41, s40, 2
    s_bfe_u32 s19, s41, 0x10002
    s_xor_b32 s19, s19, s38
    s_and_b32 s42, s34, 2
    s_or_b32 s19, s19, s42
    s_cmp_eq_u32 s38, 0
    s_cselect_b32 s18, s40, s41
    s_and_b32 s18, s18, 3
    s_mul_i32 s40, s35, 28672
    s_and_b32 s41, s34, 1
    s_lshl_b32 s41, s41, 9
    s_add_u32 s40, s40, s41
    s_and_b32 s41, s36, 15
    s_lshl_b32 s41, s41, 5
    s_add_u32 s40, s40, s41
    s_add_u32 s40, s40, 524288
    s_add_u32 s22, s32, s40
    s_addc_u32 s23, s33, 0
    s_add_u32 s24, s22, 262144
    s_addc_u32 s25, s23, 0
    s_bfe_u32 s40, s17, 0x20002
    s_bfe_u32 s41, s17, 0x40004
    s_lshl4_add_u32 s40, s40, s41
    s_and_b32 s41, s17, 3
    s_lshl2_add_u32 s40, s40, s41
    s_lshl_b32 s41, s18, 8
    s_add_u32 s40, s40, s41
    s_lshl_b32 s40, s40, 1
    s_add_u32 s20, s40, 52096
    s_bitcmp1_b32 s16, 31
    s_brev_b32 s40, 1
    s_cselect_b32 s40, s40, -1
    s_xor_b32 s40, s40, s16
    s_and_b32 s21, s40, 0xffff0000
    s_cmp_lg_u32 s19, 0
    s_cbranch_scc1 L_fin
    v_and_b32 v75, 3, v1
    v_lshrrev_b32 v72, 5, v1
    v_lshl_add_u32 v72, v75, 1, v72
    v_lshrrev_b32 v73, 2, v1
    v_lshlrev_b32 v73, 10, v73
    v_lshl_add_u32 v73, v75, 3, v73
    v_add_u32 v74, 16384, v73
    s_lshl_b32 s40, s17, 11
    s_lshl4_add_u32 s40, s37, s40
    v_lshl_add_u32 v75, v72, 1, s40
    global_load_ushort v76, v75, s[4:5]
    v_mov_b32 v80, 0xbfb8aa3b
    v_mul_f32 v80, s21, v80
    v_exp_f32 v80, v80
    v_mov_b32 v84, v28
    v_mov_b32 v85, 0
    v_add_f32 v80, 1.0, v80
    v_rcp_f32 v80, v80
    s_lshl_b32 s40, s18, 2
    v_mov_b32 v81, s40
    v_mul_f32 v80, 0xbfb8aa3b, v80
    v_mul_u32_u24 v78, 14416, v72
    v_add_u32 v78, s20, v78
    s_lshl_b32 s40, s17, 1
    v_mul_u32_u24 v77, 4624, v72
    v_add_u32 v77, s40, v77
    v_lshlrev_b32 v79, 2, v72
L_nort_42:
    s_mov_b32 s46, 0
L_sp_43:
    ds_read_b32 v72, v3 offset:64
    s_waitcnt lgkmcnt(0)
    v_cmp_gt_u32 vcc, 8, v72
    s_cbranch_vccz L_spd_44
    s_add_u32 s46, s46, 1
    s_sleep 4
    s_cmp_lt_u32 s46, 400000
    s_cbranch_scc1 L_sp_43
    s_branch L_end
    s_nop 0
L_spd_44:
L_routed:
    s_cmp_lg_u32 s19, 0
    s_cbranch_scc1 L_fin
    s_mov_b32 s46, 0
L_ba_45:
    global_load_dwordx2 v[82:83], v73, s[22:23] sc1
    s_mov_b32 exec_hi, 0xffff
    global_load_dwordx2 v[84:85], v74, s[22:23] sc1
    s_mov_b32 exec_hi, -1
L_bc_46:
    s_waitcnt vmcnt(0)
    v_xor_b32_e64 v31, v28, v82
    v_bitop3_b32 v31, v31, v84, v28 bitop3:0xf6
    v_and_b32 v31, 0xff, v31
    v_cmp_ne_u32 vcc, 0, v31
    v_add_f32 v86, v82, v84
    v_add_f32_e64 v87, v83, v85
    s_cbranch_vccz L_bo_47
    s_add_u32 s46, s46, 1
    s_cmp_lt_u32 s46, 24
    s_cbranch_scc1 L_ba_45
    s_cmp_gt_u32 s46, 50000
    s_cbranch_scc1 L_end
    s_sleep 2
    global_load_dwordx2 v[82:83], v73, s[24:25] sc1
    s_mov_b32 exec_hi, 0xffff
    global_load_dwordx2 v[84:85], v74, s[24:25] sc1
    s_mov_b32 exec_hi, -1
    s_branch L_bc_46
    s_nop 0
L_bo_47:
    v_lshlrev_b32 v76, 16, v76
    s_nop 0
    v_permlane32_swap_b32 v86, v87
    v_add_f32_e64 v86, v86, v87
    v_mov_b32 v87, v86
    s_mov_b32 s46, 0
    ds_read_b32 v72, v81 offset:64
    ds_read_u16 v82, v78
    ds_read_u16 v83, v77 offset:9488
    ds_read_b32 v84, v79 offset:0
    v_permlane16_swap_b32 v86, v87
    v_add_f32 v86, v86, v87
    s_nop 1
    v_add_f32_dpp v86, v86, v86 row_ror:8 row_mask:0xf bank_mask:0xf
    s_nop 1
    v_add_f32_dpp v86, v86, v86 row_ror:4 row_mask:0xf bank_mask:0xf
    s_branch L_spc_50
    s_nop 0
L_sp_48:
    ds_read_b32 v72, v81 offset:64
    ds_read_u16 v82, v78
    ds_read_u16 v83, v77 offset:9488
    ds_read_b32 v84, v79 offset:0
L_spc_50:
    s_waitcnt lgkmcnt(0)
    v_cmp_gt_u32 vcc, 8, v72
    s_cbranch_vccz L_spd_49
    s_add_u32 s46, s46, 1
    s_sleep 1
    s_cmp_lt_u32 s46, 400000
    s_cbranch_scc1 L_sp_48
    s_branch L_end
L_spd_49:
    v_fma_mix_f32 v77, v86, v80, v83 op_sel_hi:[0,0,1]
    v_exp_f32 v86, v77
    v_fma_mix_f32 v82, v82, v77, 0 op_sel_hi:[1,0,0]
    v_fma_f32 v86, v86, v84, v84
    v_rcp_f32 v86, v86
    s_mov_b32 exec_lo, 15
    s_mov_b32 exec_hi, 15
    v_fmac_f32 v76, v82, v86
    v_cvt_pk_bf16_f32 v76, v76, v76
    global_store_short v75, v76, s[28:29]
    s_branch L_fin
    s_nop 0
L_cnv:
    v_add_u32_e64 v85, s58, v2
    ds_read_b128 v[12:15], v85 offset:0
    ds_read_b128 v[4:7], v85 offset:4624
    ds_read_b128 v[16:19], v85 offset:9248
    ds_read_b128 v[20:23], v85 offset:13872
    s_mul_i32 s50, s34, 14416
    s_add_u32 s50, s50, 45952
    s_mov_b32 m0, s50
    s_mov_b32 s52, 0x3f803f80
    s_mov_b32 s54, 0x41000000
    s_mov_b32 s55, 0
    s_mul_i32 s56, s59, 0x02020000
    s_add_u32 s56, s56, 0x01000c0c
    s_lshl3_add_u32 s40, s37, s34
    s_lshl_b32 s40, s40, 11
    s_add_u32 s40, s40, 8388608
    s_add_u32 s62, s32, s40
    s_addc_u32 s63, s33, 0
    v_mov_b32 v88, 0
    v_mov_b32 v89, 0
    v_mov_b32 v90, 0
    v_mov_b32 v91, 0
    s_mul_i32 s40, s34, 4624
    s_add_u32 s40, s40, 8960
    v_add_u32 v85, s40, v2
    s_mov_b32 exec_lo, -1
    s_mov_b32 exec_hi, 1
    ds_write_b128 v85, v[88:91]
    s_mov_b64 exec, -1
    v_mov_b32 v86, 0x3c00
    ds_write_addtid_b32 v86
    s_waitcnt lgkmcnt(0)
    s_and_b32 s41, s34, 1
    s_lshl_b32 s41, s41, 4
    s_lshr_b32 s48, s48, s41
    s_lshl_b32 s48, s48, 16
    s_lshr_b32 s51, s49, s41
    s_lshl_b32 s51, s51, 16
    v_mov_b32 v85, 0x3fb8aa3b
    v_mul_f32 v85, s48, v85
    v_exp_f32 v85, v85
    v_mov_b32 v26, 0
    v_cvt_pk_bf16_f32 v85, v85, v85
    v_writelane_b32 v26, s51, 0
    v_and_b32 v85, 0xffff0000, v85
    s_bitset0_b32 s51, 31
    v_mul_f32 v28, 0xbfb8aa3b, v85
    v_mul_f32 v29, 0x3e22f983, v85
    v_add_f32 v30, v85, v85
    v_mov_b32 v0, 1
    s_lshl_b32 s41, s60, 2
    v_mov_b32 v31, s41
    v_and_b32 v24, 12, v31
    v_add_u32 v4, s40, v4
    v_add_u32 v16, s50, v16
    v_add_u32 v17, s50, v17
    v_add_u32 v6, s50, v6
    v_add_u32 v7, s50, v7
    v_add_u32 v20, s50, v20
    v_add_u32 v18, s50, v18
    v_add_u32 v19, s50, v19
    s_mov_b32 s57, s40
    s_sub_u32 s41, s50, s57
    s_add_u32 s41, s41, 8912
    s_and_b32 s41, s41, 255
    s_add_u32 s41, s41, s57
    s_sub_u32 s41, s41, 8704
    s_mov_b32 exec_lo, 0x0f000000
    s_mov_b32 exec_hi, 0x0f000000
    v_mov_b32 v16, s41
    s_sub_u32 s41, s50, s57
    s_add_u32 s41, s41, 8816
    s_and_b32 s41, s41, 255
    s_add_u32 s41, s41, s57
    s_sub_u32 s41, s41, 8704
    s_mov_b32 exec_lo, 0xf0000000
    s_mov_b32 exec_hi, 0xf0000000
    v_mov_b32 v16, s41
    s_mov_b64 exec, -1
    s_add_u32 s41, s50, 1072
    v_sub_u32 v25, s41, v2
    s_mov_b32 s46, 0
L_sp_51:
    ds_read_b64 v[42:43], v3 offset:40
    s_waitcnt lgkmcnt(0)
    v_cmp_eq_u32 vcc, 0, v43
    s_cbranch_vccz L_spd_52
    s_add_u32 s46, s46, 1
    s_sleep 1
    s_cmp_lt_u32 s46, 400000
    s_cbranch_scc1 L_sp_51
    s_branch L_end
    s_nop 0
L_spd_52:
    v_readfirstlane_b32 s39, v42
    v_lshlrev_b32_e64 v40, 2, v1
    v_alignbit_b32 v40, v42, v42, v40
    v_bfi_b32 v40, 1, v42, v40
    v_lshrrev_b32 v41, 1, v40
    v_lshrrev_b32 v42, 2, v40
    v_lshrrev_b32_e64 v43, 3, v40
    s_add_u32 s41, s50, 6144
    v_lshl_add_u32 v1, v1, 3, s41
    s_mov_b32 s61, 0x00010001
    v_lshrrev_b32 v27, 1, v2
    s_cmp_eq_u32 s38, 0
    s_mov_b32 s40, -57664
    s_cselect_b32 s40, 57664, s40
    v_add_u32 v37, s40, v17
    v_add_u32 v36, s40, v16
    s_add_u32 s40, s40, s50
    s_sub_u32 s41, s40, s57
    s_add_u32 s41, s41, 8912
    s_and_b32 s41, s41, 255
    s_add_u32 s41, s41, s57
    s_sub_u32 s41, s41, 8704
    s_mov_b32 exec_lo, 0x0f000000
    s_mov_b32 exec_hi, 0x0f000000
    v_mov_b32 v36, s41
    s_sub_u32 s41, s40, s57
    s_add_u32 s41, s41, 8816
    s_and_b32 s41, s41, 255
    s_add_u32 s41, s41, s57
    s_sub_u32 s41, s41, 8704
    s_mov_b32 exec_lo, 0xf0000000
    s_mov_b32 exec_hi, 0xf0000000
    v_mov_b32 v36, s41
    s_mov_b64 exec, -1
    s_setprio 3
    s_waitcnt vmcnt(3)
    v_perm_b32 v32, v8, v8, s56
    v_mul_f32 v32, 0x3fb8aa3b, v32
    v_exp_f32 v32, v32
    s_waitcnt vmcnt(2)
    v_perm_b32 v33, v9, v9, s56
    v_cvt_pk_bf16_f32 v32, v32, v32
    v_and_b32 v32, 0xffff0000, v32
    v_pk_mul_f32 v[32:33], v[32:33], v[28:29]
    s_cmp_lg_u32 s59, 0
    s_cbranch_scc1 L_nosc_53
    v_pk_mul_f32 v[90:91], v[32:33], s[54:55] op_sel_hi:[1,0]
    v_exp_f32_e64 v90, v90
    v_cos_f32 v88, v91
    v_sin_f32_e64 v89, v91
    s_nop 0
    v_pk_mul_f32 v[88:89], v[88:89], v[90:91] op_sel_hi:[1,0]
    v_cvt_pk_f16_f32 v45, v88, v89
    v_pk_mul_f32 v[90:91], v[88:89], v[88:89] op_sel:[1,1] op_sel_hi:[1,0] neg_lo:[1,0]
    v_pk_fma_f32 v[88:89], v[88:89], v[88:89], v[90:91] op_sel:[0,0,0] op_sel_hi:[0,1,1]
    s_waitcnt vmcnt(0)
    s_nop 0
    v_cvt_pk_f16_f32 v46, v88, v89
    v_pk_mul_f32 v[90:91], v[88:89], v[88:89] op_sel:[1,1] op_sel_hi:[1,0] neg_lo:[1,0]
    v_and_b32 v85, 0x7fff7fff, v10
    v_pk_fma_f32 v[88:89], v[88:89], v[88:89], v[90:91] op_sel:[0,0,0] op_sel_hi:[0,1,1]
    v_and_b32 v86, 0x7fff7fff, v11
    v_cvt_pk_f16_f32 v48, v88, v89
    v_pk_mul_f32 v[90:91], v[88:89], v[88:89] op_sel:[1,1] op_sel_hi:[1,0] neg_lo:[1,0]
    v_dot2_f32_bf16 v84, v85, s52, 0
    v_pk_fma_f32 v[88:89], v[88:89], v[88:89], v[90:91] op_sel:[0,0,0] op_sel_hi:[0,1,1]
    v_dot2_f32_bf16 v84, v86, s52, v84
    v_cvt_pk_f16_f32 v52, v88, v89
    s_nop 1
    s_nop 0
    v_add_f32_dpp v84, v84, v84 row_shr:1 row_mask:0xf bank_mask:0xf
    v_pk_mul_f32 v[90:91], v[88:89], v[88:89] op_sel:[1,1] op_sel_hi:[1,0] neg_lo:[1,0]
    v_pk_fma_f32 v[88:89], v[88:89], v[88:89], v[90:91] op_sel:[0,0,0] op_sel_hi:[0,1,1]
    v_add_f32_dpp v84, v84, v84 row_shr:2 row_mask:0xf bank_mask:0xf
    v_cvt_pk_f16_f32 v60, v88, v89
    s_nop 0
    v_add_f32_dpp v84, v84, v84 row_shr:4 row_mask:0xf bank_mask:0xf
    v_exp_f32 v94, v32
    v_cos_f32 v92, v33
    v_add_f32_dpp v84, v84, v84 row_shr:8 row_mask:0xf bank_mask:0xf
    v_sin_f32 v93, v33
    s_nop 0
    v_add_f32_dpp v84, v84, v84 row_bcast:15 row_mask:0xa bank_mask:0xf
    v_pk_mul_f32 v[92:93], v[92:93], v[94:95] op_sel_hi:[1,0]
    s_nop 0
    v_add_f32_dpp v84, v84, v84 row_bcast:31 row_mask:0xc bank_mask:0xf
    v_cvt_pk_f16_f32 v61, v92, v93
    v_pk_mul_f32 v[94:95], v[92:93], v[92:93] op_sel:[1,1] op_sel_hi:[1,0] neg_lo:[1,0]
    v_fma_f32 v84, v84, v30, s51
    v_pk_fma_f32 v[92:93], v[92:93], v[92:93], v[94:95] op_sel:[0,0,0] op_sel_hi:[0,1,1]
    v_frexp_exp_i32_f32_e64 v84, v84
    v_cvt_pk_f16_f32 v62, v92, v93
    v_readlane_b32 s40, v84, 63
    s_sub_i32 s40, 126, s40
    s_max_i32 s40, s40, 67
    s_min_i32 s40, s40, 187
    s_lshl_b32 s40, s40, 23
    v_mov_b32 v78, 0x40053526
    v_mul_f32 v78, s40, v78
    v_mul_f32 v26, s40, v26
    s_mov_b64 exec, 1
    ds_write_b32 v31, v78 offset:0
    s_mov_b64 exec, -1
    s_branch L_scj_54
L_nosc_53:
    v_pk_mul_f32 v[90:91], v[32:33], s[54:55] op_sel_hi:[1,0]
    v_exp_f32 v90, v90
    v_cos_f32 v88, v91
    v_exp_f32 v94, v32
    v_sin_f32 v89, v91
    s_nop 0
    v_pk_mul_f32 v[88:89], v[88:89], v[90:91] op_sel_hi:[1,0]
    v_cos_f32 v92, v33
    v_cvt_pk_f16_f32 v45, v88, v89
    v_pk_mul_f32 v[90:91], v[88:89], v[88:89] op_sel:[1,1] op_sel_hi:[1,0] neg_lo:[1,0]
    v_sin_f32_e64 v93, v33
    v_pk_fma_f32 v[88:89], v[88:89], v[88:89], v[90:91] op_sel:[0,0,0] op_sel_hi:[0,1,1]
    v_cvt_pk_f16_f32 v46, v88, v89
    v_pk_mul_f32 v[92:93], v[92:93], v[94:95] op_sel_hi:[1,0]
    v_pk_mul_f32 v[90:91], v[88:89], v[88:89] op_sel:[1,1] op_sel_hi:[1,0] neg_lo:[1,0]
    v_pk_fma_f32 v[88:89], v[88:89], v[88:89], v[90:91] op_sel:[0,0,0] op_sel_hi:[0,1,1]
    v_cvt_pk_f16_f32 v48, v88, v89
    v_cvt_pk_f16_f32 v61, v92, v93
    v_pk_mul_f32 v[90:91], v[88:89], v[88:89] op_sel:[1,1] op_sel_hi:[1,0] neg_lo:[1,0]
    v_pk_fma_f32 v[88:89], v[88:89], v[88:89], v[90:91] op_sel:[0,0,0] op_sel_hi:[0,1,1]
    v_pk_mul_f32 v[94:95], v[92:93], v[92:93] op_sel:[1,1] op_sel_hi:[1,0] neg_lo:[1,0]
    v_cvt_pk_f16_f32 v52, v88, v89
    v_pk_mul_f32 v[90:91], v[88:89], v[88:89] op_sel:[1,1] op_sel_hi:[1,0] neg_lo:[1,0]
    v_pk_fma_f32 v[92:93], v[92:93], v[92:93], v[94:95] op_sel:[0,0,0] op_sel_hi:[0,1,1]
    v_pk_fma_f32 v[88:89], v[88:89], v[88:89], v[90:91] op_sel:[0,0,0] op_sel_hi:[0,1,1]
    v_cvt_pk_f16_f32 v60, v88, v89
    v_cvt_pk_f16_f32 v62, v92, v93
L_scj_54:
    v_pk_mul_f16 v47, v46, v45 op_sel:[1,1] op_sel_hi:[1,0] neg_lo:[1,0]
    v_pk_fma_f16 v47, v46, v45, v47 op_sel:[0,0,0] op_sel_hi:[0,1,1]
    ds_write_addtid_b32 v45 offset:272
    ds_write_addtid_b32 v46 offset:544
    v_pk_mul_f16 v49, v48, v45 op_sel:[1,1] op_sel_hi:[1,0] neg_lo:[1,0]
    v_pk_mul_f16 v50, v48, v46 op_sel:[1,1] op_sel_hi:[1,0] neg_lo:[1,0]
    v_pk_fma_f16 v49, v48, v45, v49 op_sel:[0,0,0] op_sel_hi:[0,1,1]
    v_pk_fma_f16 v50, v48, v46, v50 op_sel:[0,0,0] op_sel_hi:[0,1,1]
    ds_write_addtid_b32 v47 offset:816
    ds_write_addtid_b32 v48 offset:1088
    v_pk_mul_f16 v51, v48, v47 op_sel:[1,1] op_sel_hi:[1,0] neg_lo:[1,0]
    v_pk_fma_f16 v51, v48, v47, v51 op_sel:[0,0,0] op_sel_hi:[0,1,1]
    ds_write_addtid_b32 v49 offset:1360
    ds_write_addtid_b32 v50 offset:1632
    v_pk_mul_f32 v[90:91], v[88:89], v[88:89] op_sel:[1,1] op_sel_hi:[1,0] neg_lo:[1,0]
    v_pk_mul_f16 v53, v52, v45 op_sel:[1,1] op_sel_hi:[1,0] neg_lo:[1,0]
    v_pk_mul_f16 v54, v52, v46 op_sel:[1,1] op_sel_hi:[1,0] neg_lo:[1,0]
    v_pk_fma_f16 v53, v52, v45, v53 op_sel:[0,0,0] op_sel_hi:[0,1,1]
    v_pk_fma_f16 v54, v52, v46, v54 op_sel:[0,0,0] op_sel_hi:[0,1,1]
    ds_write_addtid_b32 v51 offset:1904
    ds_write_addtid_b32 v52 offset:2176
    v_pk_mul_f16 v55, v52, v47 op_sel:[1,1] op_sel_hi:[1,0] neg_lo:[1,0]
    v_pk_mul_f16 v56, v52, v48 op_sel:[1,1] op_sel_hi:[1,0] neg_lo:[1,0]
    v_pk_fma_f16 v55, v52, v47, v55 op_sel:[0,0,0] op_sel_hi:[0,1,1]
    v_pk_fma_f16 v56, v52, v48, v56 op_sel:[0,0,0] op_sel_hi:[0,1,1]
    ds_write_addtid_b32 v53 offset:2448
    ds_write_addtid_b32 v54 offset:2720
    v_pk_mul_f16 v57, v52, v49 op_sel:[1,1] op_sel_hi:[1,0] neg_lo:[1,0]
    v_pk_mul_f16 v58, v52, v50 op_sel:[1,1] op_sel_hi:[1,0] neg_lo:[1,0]
    v_pk_fma_f32 v[88:89], v[88:89], v[88:89], v[90:91] op_sel:[0,0,0] op_sel_hi:[0,1,1]
    v_pk_fma_f16 v57, v52, v49, v57 op_sel:[0,0,0] op_sel_hi:[0,1,1]
    v_pk_fma_f16 v58, v52, v50, v58 op_sel:[0,0,0] op_sel_hi:[0,1,1]
    ds_write_addtid_b32 v55 offset:2992
    ds_write_addtid_b32 v56 offset:3264
    v_pk_mul_f16 v59, v52, v51 op_sel:[1,1] op_sel_hi:[1,0] neg_lo:[1,0]
    v_pk_fma_f16 v59, v52, v51, v59 op_sel:[0,0,0] op_sel_hi:[0,1,1]
    ds_write_addtid_b32 v57 offset:3536
    ds_write_addtid_b32 v58 offset:3808
    v_pk_mul_f16 v80, v60, v45 op_sel:[1,1] op_sel_hi:[1,0] neg_lo:[1,0]
    v_pk_mul_f16 v81, v60, v46 op_sel:[1,1] op_sel_hi:[1,0] neg_lo:[1,0]
    v_pk_fma_f16 v80, v60, v45, v80 op_sel:[0,0,0] op_sel_hi:[0,1,1]
    v_pk_fma_f16 v81, v60, v46, v81 op_sel:[0,0,0] op_sel_hi:[0,1,1]
    ds_write_addtid_b32 v59 offset:4080
    ds_write_addtid_b32 v60 offset:4352
    v_cvt_pk_f16_f32 v64, v88, v89
    v_pk_mul_f16 v82, v60, v47 op_sel:[1,1] op_sel_hi:[1,0] neg_lo:[1,0]
    v_pk_mul_f16 v83, v60, v48 op_sel:[1,1] op_sel_hi:[1,0] neg_lo:[1,0]
    v_pk_fma_f16 v82, v60, v47, v82 op_sel:[0,0,0] op_sel_hi:[0,1,1]
    v_pk_fma_f16 v83, v60, v48, v83 op_sel:[0,0,0] op_sel_hi:[0,1,1]
    ds_write_addtid_b32 v80 offset:4624
    ds_write_addtid_b32 v81 offset:4896
    v_pk_mul_f16 v80, v60, v49 op_sel:[1,1] op_sel_hi:[1,0] neg_lo:[1,0]
    v_pk_mul_f16 v81, v60, v50 op_sel:[1,1] op_sel_hi:[1,0] neg_lo:[1,0]
    v_pk_fma_f16 v80, v60, v49, v80 op_sel:[0,0,0] op_sel_hi:[0,1,1]
    v_pk_fma_f16 v81, v60, v50, v81 op_sel:[0,0,0] op_sel_hi:[0,1,1]
    ds_write_addtid_b32 v82 offset:5168
    ds_write_addtid_b32 v83 offset:5440
    v_pk_mul_f16 v82, v60, v51 op_sel:[1,1] op_sel_hi:[1,0] neg_lo:[1,0]
    v_pk_mul_f16 v83, v60, v52 op_sel:[1,1] op_sel_hi:[1,0] neg_lo:[1,0]
    v_pk_mul_f32 v[90:91], v[88:89], v[88:89] op_sel:[1,1] op_sel_hi:[1,0] neg_lo:[1,0]
    v_pk_fma_f16 v82, v60, v51, v82 op_sel:[0,0,0] op_sel_hi:[0,1,1]
    v_pk_fma_f16 v83, v60, v52, v83 op_sel:[0,0,0] op_sel_hi:[0,1,1]
    ds_write_addtid_b32 v80 offset:5712
    ds_write_addtid_b32 v81 offset:5984
    v_pk_mul_f16 v80, v60, v53 op_sel:[1,1] op_sel_hi:[1,0] neg_lo:[1,0]
    v_pk_mul_f16 v81, v60, v54 op_sel:[1,1] op_sel_hi:[1,0] neg_lo:[1,0]
    v_pk_fma_f16 v80, v60, v53, v80 op_sel:[0,0,0] op_sel_hi:[0,1,1]
    v_pk_fma_f16 v81, v60, v54, v81 op_sel:[0,0,0] op_sel_hi:[0,1,1]
    ds_write_addtid_b32 v82 offset:6256
    ds_write_addtid_b32 v83 offset:6528
    v_pk_mul_f16 v82, v60, v55 op_sel:[1,1] op_sel_hi:[1,0] neg_lo:[1,0]
    v_pk_mul_f16 v83, v60, v56 op_sel:[1,1] op_sel_hi:[1,0] neg_lo:[1,0]
    v_pk_fma_f16 v82, v60, v55, v82 op_sel:[0,0,0] op_sel_hi:[0,1,1]
    v_pk_fma_f16 v83, v60, v56, v83 op_sel:[0,0,0] op_sel_hi:[0,1,1]
    v_pk_fma_f32 v[88:89], v[88:89], v[88:89], v[90:91] op_sel:[0,0,0] op_sel_hi:[0,1,1]
    ds_write_addtid_b32 v80 offset:6800
    ds_write_addtid_b32 v81 offset:7072
    v_pk_mul_f16 v80, v60, v57 op_sel:[1,1] op_sel_hi:[1,0] neg_lo:[1,0]
    v_pk_mul_f16 v81, v60, v58 op_sel:[1,1] op_sel_hi:[1,0] neg_lo:[1,0]
    v_pk_fma_f16 v80, v60, v57, v80 op_sel:[0,0,0] op_sel_hi:[0,1,1]
    v_pk_fma_f16 v81, v60, v58, v81 op_sel:[0,0,0] op_sel_hi:[0,1,1]
    ds_write_addtid_b32 v82 offset:7344
    ds_write_addtid_b32 v83 offset:7616
    v_pk_mul_f16 v82, v60, v59 op_sel:[1,1] op_sel_hi:[1,0] neg_lo:[1,0]
    v_pk_fma_f16 v82, v60, v59, v82 op_sel:[0,0,0] op_sel_hi:[0,1,1]
    ds_write_addtid_b32 v80 offset:7888
    ds_write_addtid_b32 v81 offset:8160
    ds_write_addtid_b32 v82 offset:8432
    v_cvt_pk_f16_f32 v65, v88, v89
    s_mov_b32 s46, 0
    ds_read_b32 v78, v31 offset:0
    s_waitcnt vmcnt(0)
    v_perm_b32 v92, v10, v10, s56
    v_perm_b32 v93, v11, v11, s56
    v_mul_f32 v34, 0x3ef5fdf0, v30
    s_branch L_spc_57
    s_nop 0
L_sp_55:
    ds_read_b32 v78, v31 offset:0
L_spc_57:
    s_waitcnt lgkmcnt(0)
    v_cmp_eq_u32 vcc, 0, v78
    s_cbranch_vccz L_spd_56
    s_add_u32 s46, s46, 1
    s_sleep 1
    s_cmp_lt_u32 s46, 400000
    s_cbranch_scc1 L_sp_55
    s_branch L_end
    s_nop 0
L_spd_56:
    v_mul_f32_e64 v34, v34, v78
    v_pk_mul_f32 v[92:93], v[92:93], v[34:35] op_sel_hi:[1,0] neg_hi:[1,0]
    v_cvt_pk_f16_f32 v67, v92, v93
    v_pk_mul_f16 v73, v67, v64 op_sel:[1,1] op_sel_hi:[1,0]
    v_pk_fma_f16 v73, v67, v64, v73 op_sel:[0,0,0] op_sel_hi:[0,1,1] neg_hi:[0,1,0]
    v_pk_mul_f16 v68, v67, v61 op_sel:[1,1] op_sel_hi:[1,0]
    v_pk_mul_f16 v69, v67, v62 op_sel:[1,1] op_sel_hi:[1,0]
    v_pk_fma_f16 v68, v67, v61, v68 op_sel:[0,0,0] op_sel_hi:[0,1,1] neg_hi:[0,1,0]
    v_pk_fma_f16 v69, v67, v62, v69 op_sel:[0,0,0] op_sel_hi:[0,1,1] neg_hi:[0,1,0]
    ds_write_addtid_b32 v67 offset:8704
    ds_write_addtid_b32 v73 offset:11696
    v_pk_mul_f16 v75, v73, v45 op_sel:[1,1] op_sel_hi:[1,0]
    v_pk_mul_f16 v70, v68, v62 op_sel:[1,1] op_sel_hi:[1,0]
    v_pk_fma_f16 v75, v73, v45, v75 op_sel:[0,0,0] op_sel_hi:[0,1,1] neg_hi:[0,1,0]
    v_pk_fma_f16 v70, v68, v62, v70 op_sel:[0,0,0] op_sel_hi:[0,1,1] neg_hi:[0,1,0]
    ds_write_addtid_b32 v68 offset:8976
    ds_write_addtid_b32 v69 offset:9248
    v_pk_mul_f16 v71, v69, v62 op_sel:[1,1] op_sel_hi:[1,0]
    v_pk_mul_f16 v76, v75, v64 op_sel:[1,1] op_sel_hi:[1,0]
    v_pk_fma_f16 v71, v69, v62, v71 op_sel:[0,0,0] op_sel_hi:[0,1,1] neg_hi:[0,1,0]
    v_pk_fma_f16 v76, v75, v64, v76 op_sel:[0,0,0] op_sel_hi:[0,1,1] neg_hi:[0,1,0]
    ds_write_addtid_b32 v75 offset:10064
    ds_write_addtid_b32 v70 offset:9520
    v_pk_mul_f16 v77, v75, v65 op_sel:[1,1] op_sel_hi:[1,0]
    v_pk_mul_f16 v63, v70, v62 op_sel:[1,1] op_sel_hi:[1,0]
    v_pk_fma_f16 v77, v75, v65, v77 op_sel:[0,0,0] op_sel_hi:[0,1,1] neg_hi:[0,1,0]
    v_pk_fma_f16 v63, v70, v62, v63 op_sel:[0,0,0] op_sel_hi:[0,1,1] neg_hi:[0,1,0]
    ds_write_addtid_b32 v71 offset:12240
    ds_write_addtid_b32 v76 offset:13600
    v_pk_mul_f16 v72, v71, v62 op_sel:[1,1] op_sel_hi:[1,0]
    v_pk_mul_f16 v74, v71, v64 op_sel:[1,1] op_sel_hi:[1,0]
    v_pk_fma_f16 v72, v71, v62, v72 op_sel:[0,0,0] op_sel_hi:[0,1,1] neg_hi:[0,1,0]
    v_pk_fma_f16 v74, v71, v64, v74 op_sel:[0,0,0] op_sel_hi:[0,1,1] neg_hi:[0,1,0]
    ds_write_addtid_b32 v77 offset:10608
    ds_write_addtid_b32 v63 offset:12512
    v_pk_mul_f16 v66, v76, v65 op_sel:[1,1] op_sel_hi:[1,0]
    v_pk_mul_f16 v79, v77, v65 op_sel:[1,1] op_sel_hi:[1,0]
    v_pk_fma_f16 v66, v76, v65, v66 op_sel:[0,0,0] op_sel_hi:[0,1,1] neg_hi:[0,1,0]
    v_pk_fma_f16 v79, v77, v65, v79 op_sel:[0,0,0] op_sel_hi:[0,1,1] neg_hi:[0,1,0]
    ds_write_addtid_b32 v72 offset:12784
    ds_write_addtid_b32 v74 offset:11424
    v_pk_mul_f16 v80, v63, v62 op_sel:[1,1] op_sel_hi:[1,0]
    v_pk_mul_f16 v81, v69, v64 op_sel:[1,1] op_sel_hi:[1,0]
    v_pk_fma_f16 v80, v63, v62, v80 op_sel:[0,0,0] op_sel_hi:[0,1,1] neg_hi:[0,1,0]
    v_pk_fma_f16 v81, v69, v64, v81 op_sel:[0,0,0] op_sel_hi:[0,1,1] neg_hi:[0,1,0]
    ds_write_addtid_b32 v66 offset:13872
    ds_write_addtid_b32 v79 offset:10880
    v_pk_mul_f16 v82, v72, v64 op_sel:[1,1] op_sel_hi:[1,0]
    v_pk_mul_f16 v83, v71, v65 op_sel:[1,1] op_sel_hi:[1,0]
    v_pk_fma_f16 v82, v72, v64, v82 op_sel:[0,0,0] op_sel_hi:[0,1,1] neg_hi:[0,1,0]
    v_pk_fma_f16 v83, v71, v65, v83 op_sel:[0,0,0] op_sel_hi:[0,1,1] neg_hi:[0,1,0]
    ds_write_addtid_b32 v80 offset:13056
    ds_write_addtid_b32 v81 offset:11968
    v_pk_mul_f16 v80, v74, v65 op_sel:[1,1] op_sel_hi:[1,0]
    v_pk_mul_f16 v81, v66, v65 op_sel:[1,1] op_sel_hi:[1,0]
    v_pk_fma_f16 v80, v74, v65, v80 op_sel:[0,0,0] op_sel_hi:[0,1,1] neg_hi:[0,1,0]
    v_pk_fma_f16 v81, v66, v65, v81 op_sel:[0,0,0] op_sel_hi:[0,1,1] neg_hi:[0,1,0]
    ds_write_addtid_b32 v82 offset:9792
    ds_write_addtid_b32 v83 offset:13328
    v_pk_mul_f16 v82, v79, v65 op_sel:[1,1] op_sel_hi:[1,0]
    v_pk_fma_f16 v82, v79, v65, v82 op_sel:[0,0,0] op_sel_hi:[0,1,1] neg_hi:[0,1,0]
    ds_write_addtid_b32 v80 offset:10336
    ds_write_addtid_b32 v81 offset:14144
    ds_write_addtid_b32 v82 offset:11152
    s_mov_b64 exec, 1
    ds_add_u32 v3, v0 offset:80
    s_mov_b64 exec, -1
    s_cmp_lg_u32 s59, 0
    s_cbranch_scc1 L_recv_58
    s_nop 0
    s_setprio 2
    ds_read_b128 v[88:91], v16 offset:8704
    ds_read_b128 v[92:95], v17 offset:0
    ds_read_b128 v[96:99], v16 offset:8736
    ds_read_b128 v[100:103], v17 offset:32
    ds_read_b128 v[104:107], v16 offset:8768
    ds_read_b128 v[108:111], v17 offset:64
    ds_read_b128 v[44:47], v16 offset:8800
    ds_read_b128 v[48:51], v17 offset:96
    s_waitcnt lgkmcnt(6)
    v_mfma_f32_32x32x16_f16 v[112:127], v[88:91], v[92:95], 0
    ds_read_b128 v[88:91], v16 offset:8832
    ds_read_b128 v[92:95], v17 offset:128
    s_waitcnt lgkmcnt(6)
    v_mfma_f32_32x32x16_f16 v[112:127], v[96:99], v[100:103], v[112:127]
    ds_read_b128 v[96:99], v16 offset:8864
    ds_read_b128 v[100:103], v17 offset:160
    s_waitcnt lgkmcnt(6)
    v_mfma_f32_32x32x16_f16 v[112:127], v[104:107], v[108:111], v[112:127]
    ds_read_b128 v[104:107], v16 offset:8896
    ds_read_b128 v[108:111], v17 offset:192
    s_waitcnt lgkmcnt(6)
    v_mfma_f32_32x32x16_f16 v[112:127], v[44:47], v[48:51], v[112:127]
    ds_read_b128 v[44:47], v16 offset:8928
    ds_read_b128 v[48:51], v17 offset:224
    s_waitcnt lgkmcnt(6)
    v_mfma_f32_32x32x16_f16 v[112:127], v[88:91], v[92:95], v[112:127]
    s_waitcnt lgkmcnt(4)
    v_mfma_f32_32x32x16_f16 v[112:127], v[96:99], v[100:103], v[112:127]
    s_waitcnt lgkmcnt(2)
    v_mfma_f32_32x32x16_f16 v[112:127], v[104:107], v[108:111], v[112:127]
    s_waitcnt lgkmcnt(0)
    v_mfma_f32_32x32x16_f16 v[112:127], v[44:47], v[48:51], v[112:127]
    s_mov_b32 s46, 0
L_sp_60:
    ds_read_b32 v85, v24 offset:96
    s_waitcnt lgkmcnt(0)
    v_cmp_gt_u32 vcc, 1, v85
    s_cbranch_vccz L_spd_61
    s_add_u32 s46, s46, 1
    s_cmp_lt_u32 s46, 400000
    s_cbranch_scc1 L_sp_60
    s_branch L_end
L_spd_61:
    s_setprio 3
    ds_read_b128 v[88:91], v36 offset:8704
    ds_read_b128 v[92:95], v37 offset:0
    ds_read_b128 v[96:99], v36 offset:8736
    ds_read_b128 v[100:103], v37 offset:32
    ds_read_b128 v[104:107], v36 offset:8768
    ds_read_b128 v[108:111], v37 offset:64
    ds_read_b128 v[44:47], v36 offset:8800
    ds_read_b128 v[48:51], v37 offset:96
    s_waitcnt lgkmcnt(6)
    v_mfma_f32_32x32x16_f16 v[112:127], v[88:91], v[92:95], v[112:127]
    ds_read_b128 v[88:91], v36 offset:8832
    ds_read_b128 v[92:95], v37 offset:128
    s_waitcnt lgkmcnt(6)
    v_mfma_f32_32x32x16_f16 v[112:127], v[96:99], v[100:103], v[112:127]
    ds_read_b128 v[96:99], v36 offset:8864
    ds_read_b128 v[100:103], v37 offset:160
    s_waitcnt lgkmcnt(6)
    v_mfma_f32_32x32x16_f16 v[112:127], v[104:107], v[108:111], v[112:127]
    ds_read_b128 v[104:107], v36 offset:8896
    ds_read_b128 v[108:111], v37 offset:192
    s_waitcnt lgkmcnt(6)
    v_mfma_f32_32x32x16_f16 v[112:127], v[44:47], v[48:51], v[112:127]
    ds_read_b128 v[44:47], v36 offset:8928
    ds_read_b128 v[48:51], v37 offset:224
    s_waitcnt lgkmcnt(6)
    v_mfma_f32_32x32x16_f16 v[112:127], v[88:91], v[92:95], v[112:127]
    s_waitcnt lgkmcnt(4)
    v_mfma_f32_32x32x16_f16 v[112:127], v[96:99], v[100:103], v[112:127]
    s_waitcnt lgkmcnt(2)
    v_mfma_f32_32x32x16_f16 v[112:127], v[104:107], v[108:111], v[112:127]
    s_waitcnt lgkmcnt(0)
    v_mfma_f32_32x32x16_f16 v[112:127], v[44:47], v[48:51], v[112:127]
    s_mov_b64 exec, 1
    ds_add_u32 v3, v0 offset:84
    s_mov_b64 exec, -1
    s_mov_b64 exec, 1
    ds_write_b32 v24, v0 offset:112
    s_mov_b64 exec, -1
    v_mov_b32 v110, v78
    v_mov_b32_e64 v111, s39
    s_nop 3
    v_cvt_pkrtz_f16_f32 v109, v122, v123
    v_add_f32_e64 v112, v112, v26
    v_cvt_pkrtz_f16_f32 v88, v119, v118
    v_cvt_pkrtz_f16_f32 v89, v117, v116
    v_mov_b32_dpp v85, v109 quad_perm:[1,0,3,2] row_mask:0xf bank_mask:0xf
    v_cvt_pkrtz_f16_f32 v90, v115, v114
    v_cvt_pkrtz_f16_f32 v91, v113, v112
    v_cvt_pkrtz_f16_f32 v108, v121, v120
    v_bfi_b32 v88, s61, v40, v88
    v_bfi_b32 v89, s61, v41, v89
    v_bfi_b32 v90, s61, v42, v90
    v_bfi_b32 v91, s61, v43, v91
    v_perm_b32 v109, v85, v109, v5
    global_store_dwordx4 v2, v[88:91], s[62:63] sc1
    v_bfi_b32 v108, s61, v40, v108
    v_bfi_b32 v109, s61, v41, v109
    global_store_dwordx2 v27, v[108:109], s[62:63] offset:1024 sc1
    s_mov_b64 exec, 1
    global_store_dwordx2 v3, v[110:111], s[62:63] offset:2040 sc1
    s_mov_b64 exec, -1
    ds_read_b128 v[44:47], v2 offset:4864
    ds_read_b128 v[48:51], v2 offset:5888
    ds_read_b128 v[52:55], v2 offset:6912
    ds_read_b128 v[56:59], v2 offset:7936
    s_branch L_arr_59
    s_nop 0
L_recv_58:
    s_mov_b64 exec, 1
    ds_write_b32 v24, v0 offset:96
    s_mov_b64 exec, -1
    ds_read_b128 v[44:47], v2 offset:4864
    ds_read_b128 v[48:51], v2 offset:5888
    ds_read_b128 v[52:55], v2 offset:6912
    ds_read_b128 v[56:59], v2 offset:7936
    v_xor_b32_e64 v31, 16, v31
    s_load_dword s42, s[62:63], 2040 glc
    s_mov_b32 s46, 0
L_sp_62:
    ds_read_b32 v85, v24 offset:112
    s_waitcnt lgkmcnt(0)
    v_cmp_gt_u32 vcc, 1, v85
    s_cbranch_vccz L_spd_63
    s_add_u32 s46, s46, 1
    s_sleep 2
    s_cmp_lt_u32 s46, 400000
    s_cbranch_scc1 L_sp_62
    s_branch L_end
    s_nop 0
L_spd_63:
    s_mov_b32 s46, 0
L_km_64:
    s_load_dwordx2 s[42:43], s[62:63], 2040 glc
    s_add_u32 s46, s46, 1
    s_cmp_gt_u32 s46, 50000
    s_cbranch_scc1 L_end
    s_waitcnt lgkmcnt(0)
    s_cmp_lg_u32 s43, s39
    s_cbranch_scc1 L_km_64
    s_mov_b32 s46, 0
L_ka_65:
    global_load_dwordx4 v[88:91], v2, s[62:63] sc1
    global_load_dwordx2 v[108:109], v27, s[62:63] offset:1024 sc1
    v_mov_b32 v110, s42
    s_mov_b64 exec, 1
    ds_write_b32 v31, v110 offset:0
    s_mov_b64 exec, -1
    s_add_u32 s46, s46, 1
    s_cmp_gt_u32 s46, 50000
    s_cbranch_scc1 L_end
    s_waitcnt vmcnt(1)
    v_xor_b32_e64 v85, v88, v40
    v_bitop3_b32 v85, v85, v89, v41 bitop3:0xf6
    v_bitop3_b32 v85, v85, v90, v42 bitop3:0xf6
    v_bitop3_b32 v85, v85, v91, v43 bitop3:0xf6
    s_nop 0
    s_waitcnt vmcnt(0)
    v_bitop3_b32 v85, v85, v108, v40 bitop3:0xf6
    v_bitop3_b32 v85, v85, v109, v41 bitop3:0xf6
    v_and_b32 v85, 0x00010001, v85
    v_cmp_ne_u32 vcc, 0, v85
    s_cbranch_vccnz L_ka_65
L_arr_59:
    ds_write_b128 v25, v[88:91]
    v_alignbit_b32 v92, v89, v88, 16
    v_readlane_b32 s40, v88, 63
    v_readlane_b32 s53, v108, 63
    v_readlane_b32 s41, v92, 63
    v_mov_b32_dpp v99, v88 wave_shr:1 row_mask:0xf bank_mask:0xf bound_ctrl:0
    s_pack_ll_b32_b16 s42, s40, s40
    v_alignbit_b32 v93, v90, v89, 16
    v_alignbit_b32 v94, v91, v90, 16
    v_alignbit_b32 v95, v99, v91, 16
    v_mov_b32 v104, 0
    ds_write_b128 v25, v[92:95] offset:1088
    v_and_b32 v105, s42, v21
    v_and_b32 v106, s42, v22
    v_and_b32_e64 v107, s42, v23
    v_writelane_b32 v107, s40, 11
    v_writelane_b32 v107, s41, 15
    ds_write_b128 v20, v[104:107]
    v_mov_b32_dpp v111, v89 wave_shr:1 row_mask:0xf bank_mask:0xf bound_ctrl:0
    ds_write2_b32 v18, v108, v108 offset0:0 offset1:225
    s_pack_ll_b32_b16 s53, s53, s53
    ds_write2_b32 v19, v109, v109 offset0:0 offset1:225
    v_mov_b32 v96, v89
    v_mov_b32 v97, v90
    v_mov_b32 v98, v91
    ds_write_b128 v25, v[96:99] offset:2176
    v_mov_b32 v100, v93
    v_mov_b32 v101, v94
    v_mov_b32_e64 v102, v95
    v_alignbit_b32 v103, v111, v99, 16
    ds_write_b128 v25, v[100:103] offset:3264
    v_pk_mul_f16 v12, v12, s53
    v_pk_mul_f16 v13, v13, s53
    v_pk_mul_f16 v14, v14, s53
    v_pk_mul_f16 v15, v15, s53
    v_mov_b32_e64 v5, v24
    s_cmp_lg_u32 s38, 0
    s_cbranch_scc1 L_set1_66
    ds_read_b64 v[32:33], v7 offset:512
    ds_read_b64 v[34:35], v7 offset:520
    ds_read_b64 v[36:37], v7 offset:448
    ds_read_b64 v[38:39], v7 offset:456
    ds_read_b64 v[40:41], v6 offset:576
    ds_read_b64 v[42:43], v6 offset:584
    ds_read_b64 v[60:61], v6 offset:64
    ds_read_b64 v[62:63], v6 offset:72
    ds_read_b64 v[64:65], v7 offset:576
    ds_read_b64 v[66:67], v7 offset:584
    ds_read_b64 v[68:69], v6 offset:640
    ds_read_b64 v[70:71], v6 offset:648
    ds_read_b64 v[72:73], v6 offset:128
    ds_read_b64 v[74:75], v6 offset:136
    ds_read_b64 v[76:77], v6 offset:704
    ds_read_b64 v[78:79], v6 offset:712
    ds_read_b64 v[80:81], v6 offset:192
    ds_read_b64 v[82:83], v6 offset:200
    s_mov_b32 s46, 0
L_sp_67:
    ds_read_b32 v5, v3 offset:48
    s_waitcnt lgkmcnt(0)
    v_cmp_gt_u32 vcc, 2, v5
    s_cbranch_vccz L_spd_68
    s_add_u32 s46, s46, 1
    s_sleep 2
    s_cmp_lt_u32 s46, 400000
    s_cbranch_scc1 L_sp_67
    s_branch L_end
    s_nop 0
L_spd_68:
    s_setprio 2
    ds_read_b128 v[84:87], v4 offset:496
    ds_read_b128 v[8:11], v4 offset:480
    ds_read_b128 v[16:19], v4 offset:1536
    ds_read_b128 v[20:23], v4 offset:1008
    ds_read_b128 v[24:27], v4 offset:992
    s_waitcnt lgkmcnt(4)
    v_mfma_f32_16x16x32_f16 v[28:31], v[84:87], v[52:55], 0
    ds_read_b128 v[88:91], v4 offset:48
    s_waitcnt lgkmcnt(4)
    v_mfma_f32_16x16x32_f16 v[96:99], v[8:11], v[56:59], 0
    ds_read_b64 v[92:93], v6 offset:768
    s_waitcnt lgkmcnt(4)
    v_mfma_f32_16x16x32_f16 v[104:107], v[12:15], v[16:19], 0
    ds_read_b64 v[94:95], v6 offset:776
    s_waitcnt lgkmcnt(4)
    v_mfma_f32_16x16x32_f16 v[112:115], v[20:23], v[52:55], 0
    ds_read_b64 v[100:101], v6 offset:256
    s_nop 0
    v_cvt_pkrtz_f16_f32 v28, v28, v96
    v_cvt_pkrtz_f16_f32 v29, v29, v97
    s_waitcnt lgkmcnt(4)
    v_mfma_f32_16x16x32_f16 v[120:123], v[24:27], v[56:59], 0
    ds_read_b64 v[102:103], v6 offset:264
    v_cvt_pkrtz_f16_f32 v30, v30, v98
    v_cvt_pkrtz_f16_f32 v31, v31, v99
    s_nop 1
    v_mfma_f32_16x16x32_f16 v[104:107], v[28:31], v[32:35], v[104:107]
    ds_read_b128 v[124:127], v4 offset:112
    v_mfma_f32_16x16x32_f16 v[16:19], v[28:31], v[36:39], 0
    ds_read_b128 v[20:23], v4 offset:176
    s_waitcnt lgkmcnt(6)
    v_mfma_f32_16x16x32_f16 v[96:99], v[40:43], v[88:91], 0
    ds_read_b64 v[108:109], v6 offset:832
    v_cvt_pkrtz_f16_f32 v112, v112, v120
    v_cvt_pkrtz_f16_f32 v113, v113, v121
    v_mfma_f32_16x16x32_f16 v[28:31], v[60:63], v[88:91], 0
    ds_read_b64 v[110:111], v6 offset:840
    ds_read_b64 v[116:117], v6 offset:320
    v_cvt_pkrtz_f16_f32 v114, v114, v122
    v_cvt_pkrtz_f16_f32 v115, v115, v123
    s_nop 0
    s_nop 1
    v_mfma_f32_16x16x32_f16 v[104:107], v[112:115], v[64:67], v[104:107]
    ds_read_b128 v[60:63], v4 offset:240
    ds_read_b64 v[118:119], v6 offset:328
    ds_read_b64 v[84:85], v6 offset:896
    ds_read_b64 v[86:87], v6 offset:904
    v_mfma_f32_16x16x32_f16 v[16:19], v[112:115], v[32:35], v[16:19]
    ds_read_b128 v[32:35], v4 offset:304
    ds_read_b64 v[8:9], v6 offset:384
    s_waitcnt lgkmcnt(10)
    v_mfma_f32_16x16x32_f16 v[96:99], v[68:71], v[124:127], v[96:99]
    ds_read_b64 v[10:11], v6 offset:392
    v_mfma_f32_16x16x32_f16 v[28:31], v[72:75], v[124:127], v[28:31]
    ds_read_b128 v[112:115], v4 offset:368
    ds_read_b64 v[24:25], v6 offset:960
    s_waitcnt lgkmcnt(12)
    v_mfma_f32_16x16x32_f16 v[96:99], v[76:79], v[20:23], v[96:99]
    ds_read_b64 v[26:27], v6 offset:968
    v_mfma_f32_16x16x32_f16 v[28:31], v[80:83], v[20:23], v[28:31]
    ds_read_b128 v[72:75], v4 offset:432
    ds_read_b64 v[36:37], v6 offset:448
    s_nop 0
    s_waitcnt lgkmcnt(11)
    v_mfma_f32_16x16x32_f16 v[96:99], v[92:95], v[60:63], v[96:99]
    ds_read_b64 v[38:39], v6 offset:456
    v_mfma_f32_16x16x32_f16 v[28:31], v[100:103], v[60:63], v[28:31]
    ds_read_b64 v[88:89], v6 offset:1024
    ds_read_b64 v[90:91], v6 offset:1032
    s_waitcnt lgkmcnt(10)
    v_mfma_f32_16x16x32_f16 v[96:99], v[108:111], v[32:35], v[96:99]
    ds_read_b128 v[124:127], v4 offset:496
    v_mfma_f32_16x16x32_f16 v[28:31], v[116:119], v[32:35], v[28:31]
    ds_read_b64 v[120:121], v6 offset:512
    s_waitcnt lgkmcnt(9)
    v_mfma_f32_16x16x32_f16 v[96:99], v[84:87], v[112:115], v[96:99]
    ds_read_b64 v[122:123], v6 offset:520
    v_mfma_f32_16x16x32_f16 v[28:31], v[8:11], v[112:115], v[28:31]
    ds_read_b128 v[80:83], v4 offset:560
    s_waitcnt lgkmcnt(9)
    s_waitcnt lgkmcnt(8)
    v_mfma_f32_16x16x32_f16 v[96:99], v[24:27], v[72:75], v[96:99]
    ds_read_b128 v[20:23], v4 offset:624
    s_waitcnt lgkmcnt(7)
    v_mfma_f32_16x16x32_f16 v[28:31], v[36:39], v[72:75], v[28:31]
    ds_read_b128 v[100:103], v4 offset:688
    s_waitcnt lgkmcnt(6)
    s_waitcnt lgkmcnt(5)
    v_mfma_f32_16x16x32_f16 v[96:99], v[88:91], v[124:127], v[96:99]
    ds_read_b128 v[60:63], v4 offset:752
    s_waitcnt lgkmcnt(4)
    v_mfma_f32_16x16x32_f16 v[28:31], v[120:123], v[124:127], v[28:31]
    ds_read_b128 v[116:119], v4 offset:1520
    s_waitcnt lgkmcnt(4)
    v_mfma_f32_16x16x32_f16 v[28:31], v[40:43], v[80:83], v[28:31]
    ds_read_b128 v[32:35], v4 offset:1504
    s_waitcnt lgkmcnt(4)
    v_mfma_f32_16x16x32_f16 v[28:31], v[68:71], v[20:23], v[28:31]
    v_cvt_pk_f16_f32 v96, v96, v97
    v_cvt_pk_f16_f32 v97, v98, v99
    ds_write_b64 v1, v[96:97] offset:0
    s_mov_b64 exec, 1
    ds_add_u32 v3, v0 offset:64
    s_mov_b64 exec, -1
    s_setprio 1
    s_waitcnt lgkmcnt(5)
    v_mfma_f32_16x16x32_f16 v[28:31], v[76:79], v[100:103], v[28:31]
    s_waitcnt lgkmcnt(4)
    v_mfma_f32_16x16x32_f16 v[28:31], v[92:95], v[60:63], v[28:31]
    ds_read_b128 v[8:11], v4 offset:816
    s_waitcnt lgkmcnt(4)
    v_mfma_f32_16x16x32_f16 v[112:115], v[116:119], v[44:47], 0
    ds_read_b128 v[36:39], v4 offset:880
    v_mfma_f32_16x16x32_f16 v[72:75], v[116:119], v[48:51], 0
    ds_read_b128 v[120:123], v4 offset:944
    v_mfma_f32_16x16x32_f16 v[80:83], v[116:119], v[52:55], 0
    ds_read_b128 v[20:23], v4 offset:1008
    s_waitcnt lgkmcnt(6)
    v_mfma_f32_16x16x32_f16 v[96:99], v[32:35], v[56:59], 0
    ds_read_b128 v[100:103], v4 offset:2032
    v_mfma_f32_16x16x32_f16 v[60:63], v[32:35], v[44:47], 0
    ds_read_b64 v[124:125], v7 offset:0
    v_mfma_f32_16x16x32_f16 v[116:119], v[32:35], v[48:51], 0
    ds_read_b64 v[126:127], v7 offset:8
    s_waitcnt lgkmcnt(6)
    v_mfma_f32_16x16x32_f16 v[28:31], v[108:111], v[8:11], v[28:31]
    ds_read_b128 v[8:11], v4 offset:2016
    s_waitcnt lgkmcnt(6)
    v_mfma_f32_16x16x32_f16 v[28:31], v[84:87], v[36:39], v[28:31]
    ds_read_b64 v[32:33], v7 offset:640
    s_waitcnt lgkmcnt(6)
    v_mfma_f32_16x16x32_f16 v[28:31], v[24:27], v[120:123], v[28:31]
    ds_read_b64 v[34:35], v7 offset:648
    s_waitcnt lgkmcnt(6)
    v_mfma_f32_16x16x32_f16 v[28:31], v[88:91], v[20:23], v[28:31]
    ds_read_b64 v[36:37], v7 offset:192
    s_waitcnt lgkmcnt(6)
    v_mfma_f32_16x16x32_f16 v[120:123], v[100:103], v[44:47], 0
    ds_read_b64 v[38:39], v7 offset:200
    v_cvt_pkrtz_f16_f32 v112, v112, v72
    v_cvt_pkrtz_f16_f32 v113, v113, v73
    v_mfma_f32_16x16x32_f16 v[20:23], v[100:103], v[48:51], 0
    v_cvt_pkrtz_f16_f32 v114, v114, v74
    v_cvt_pkrtz_f16_f32 v115, v115, v75
    v_mfma_f32_16x16x32_f16 v[72:75], v[100:103], v[52:55], 0
    ds_read_b64 v[52:53], v7 offset:64
    v_cvt_pk_f16_f32 v28, v28, v29
    v_cvt_pk_f16_f32 v29, v30, v31
    ds_write_b64 v1, v[28:29] offset:512
    s_mov_b64 exec, 1
    ds_add_u32 v3, v0 offset:68
    s_mov_b64 exec, -1
    s_setprio 0
    v_cvt_pkrtz_f16_f32 v80, v80, v96
    v_cvt_pkrtz_f16_f32 v81, v81, v97
    s_waitcnt lgkmcnt(7)
    v_mfma_f32_16x16x32_f16 v[28:31], v[8:11], v[56:59], 0
    ds_read_b32 v5, v3 offset:56
    ds_read_b64 v[54:55], v7 offset:72
    v_cvt_pkrtz_f16_f32 v82, v82, v98
    v_cvt_pkrtz_f16_f32 v83, v83, v99
    v_mfma_f32_16x16x32_f16 v[56:59], v[8:11], v[44:47], 0
    ds_read_b64 v[100:101], v7 offset:256
    v_cvt_pkrtz_f16_f32 v60, v60, v116
    v_cvt_pkrtz_f16_f32 v61, v61, v117
    v_mfma_f32_16x16x32_f16 v[96:99], v[8:11], v[48:51], 0
    ds_read_b64 v[102:103], v7 offset:264
    v_cvt_pkrtz_f16_f32 v62, v62, v118
    v_cvt_pkrtz_f16_f32 v63, v63, v119
    v_mfma_f32_16x16x32_f16 v[104:107], v[112:115], v[124:127], v[104:107]
    ds_read_b64 v[8:9], v6 offset:0
    s_waitcnt lgkmcnt(10)
    v_mfma_f32_16x16x32_f16 v[104:107], v[80:83], v[32:35], v[104:107]
    ds_read_b64 v[10:11], v6 offset:8
    v_mfma_f32_16x16x32_f16 v[16:19], v[80:83], v[64:67], v[16:19]
    s_waitcnt lgkmcnt(5)
    v_cmp_gt_u32 vcc, 2, v5
    s_cbranch_vccz L_x2_69
    s_mov_b32 s46, 0
L_sp_70:
    ds_read_b32 v5, v3 offset:56
    s_waitcnt lgkmcnt(0)
    v_cmp_gt_u32 vcc, 2, v5
    s_cbranch_vccz L_spd_71
    s_add_u32 s46, s46, 1
    s_sleep 1
    s_cmp_lt_u32 s46, 400000
    s_cbranch_scc1 L_sp_70
    s_branch L_end
L_spd_71:
L_x2_69:
    ds_read_b128 v[64:67], v4 offset:2048
    v_mfma_f32_16x16x32_f16 v[104:107], v[60:63], v[36:39], v[104:107]
    ds_read_b64 v[116:117], v6 offset:64
    v_cvt_pkrtz_f16_f32 v120, v120, v20
    v_cvt_pkrtz_f16_f32 v121, v121, v21
    v_cvt_pkrtz_f16_f32 v122, v122, v22
    v_cvt_pkrtz_f16_f32 v123, v123, v23
    v_cvt_pkrtz_f16_f32 v72, v72, v28
    v_cvt_pkrtz_f16_f32 v73, v73, v29
    v_cvt_pkrtz_f16_f32 v74, v74, v30
    v_cvt_pkrtz_f16_f32 v75, v75, v31
    v_cvt_pkrtz_f16_f32 v56, v56, v96
    v_cvt_pkrtz_f16_f32 v57, v57, v97
    v_cvt_pkrtz_f16_f32 v58, v58, v98
    v_cvt_pkrtz_f16_f32 v59, v59, v99
    s_waitcnt lgkmcnt(6)
    s_nop 0
    v_mfma_f32_16x16x32_f16 v[104:107], v[120:123], v[52:55], v[104:107]
    ds_read_b128 v[60:63], v4 offset:2544
    v_mfma_f32_16x16x32_f16 v[16:19], v[120:123], v[124:127], v[16:19]
    ds_read_b64 v[118:119], v6 offset:72
    ds_read_b128 v[28:31], v4 offset:2608
    v_mfma_f32_16x16x32_f16 v[16:19], v[72:75], v[32:35], v[16:19]
    ds_read_b128 v[124:127], v4 offset:2544
    s_waitcnt lgkmcnt(8)
    s_nop 0
    v_mfma_f32_16x16x32_f16 v[104:107], v[56:59], v[100:103], v[104:107]
    ds_read_b128 v[120:123], v4 offset:2528
    ds_read_b64 v[112:113], v6 offset:128
    v_mfma_f32_16x16x32_f16 v[16:19], v[56:59], v[36:39], v[16:19]
    ds_read_b64 v[114:115], v6 offset:136
    s_waitcnt lgkmcnt(8)
    v_mfma_f32_16x16x32_f16 v[16:19], v[12:15], v[64:67], v[16:19]
    ds_read_b128 v[32:35], v4 offset:2672
    ds_read_b64 v[80:81], v6 offset:192
    s_waitcnt lgkmcnt(8)
    v_mfma_f32_16x16x32_f16 v[104:107], v[8:11], v[60:63], v[104:107]
    ds_read_b64 v[82:83], v6 offset:200
    ds_read_b128 v[72:75], v4 offset:2736
    s_waitcnt lgkmcnt(9)
    s_waitcnt lgkmcnt(8)
    v_mfma_f32_16x16x32_f16 v[104:107], v[116:119], v[28:31], v[104:107]
    ds_read_b64 v[20:21], v6 offset:256
    ds_read_b64 v[22:23], v6 offset:264
    s_nop 0
    s_waitcnt lgkmcnt(9)
    v_mfma_f32_16x16x32_f16 v[56:59], v[124:127], v[44:47], 0
    ds_read_b128 v[36:39], v4 offset:2800
    ds_read_b64 v[96:97], v6 offset:320
    v_mfma_f32_16x16x32_f16 v[64:67], v[124:127], v[48:51], 0
    ds_read_b64 v[98:99], v6 offset:328
    s_nop 0
    s_waitcnt lgkmcnt(11)
    v_mfma_f32_16x16x32_f16 v[28:31], v[120:123], v[44:47], 0
    ds_read_b128 v[12:15], v4 offset:2864
    v_mfma_f32_16x16x32_f16 v[124:127], v[120:123], v[48:51], 0
    ds_read_b128 v[60:63], v4 offset:2928
    ds_read_b64 v[120:121], v6 offset:384
    ds_read_b64 v[122:123], v6 offset:392
    s_waitcnt lgkmcnt(13)
    s_waitcnt lgkmcnt(12)
    v_mfma_f32_16x16x32_f16 v[104:107], v[112:115], v[32:35], v[104:107]
    ds_read_b128 v[32:35], v4 offset:2992
    s_waitcnt lgkmcnt(11)
    s_waitcnt lgkmcnt(10)
    v_mfma_f32_16x16x32_f16 v[104:107], v[80:83], v[72:75], v[104:107]
    ds_read_b64 v[72:73], v6 offset:448
    ds_read_b64 v[74:75], v6 offset:456
    s_waitcnt lgkmcnt(10)
    s_waitcnt lgkmcnt(9)
    v_mfma_f32_16x16x32_f16 v[104:107], v[20:23], v[36:39], v[104:107]
    ds_read_b64 v[36:37], v7 offset:128
    ds_read_b64 v[38:39], v7 offset:136
    v_cvt_pkrtz_f16_f32 v56, v56, v64
    v_cvt_pkrtz_f16_f32 v57, v57, v65
    s_waitcnt lgkmcnt(9)
    s_waitcnt lgkmcnt(8)
    v_mfma_f32_16x16x32_f16 v[104:107], v[96:99], v[12:15], v[104:107]
    ds_read_b64 v[12:13], v7 offset:320
    ds_read_b64 v[14:15], v7 offset:328
    v_cvt_pkrtz_f16_f32 v58, v58, v66
    v_cvt_pkrtz_f16_f32 v59, v59, v67
    s_nop 0
    s_waitcnt lgkmcnt(7)
    v_mfma_f32_16x16x32_f16 v[104:107], v[120:123], v[60:63], v[104:107]
    ds_read_b128 v[64:67], v4 offset:3056
    ds_read_b64 v[60:61], v6 offset:512
    v_cvt_pkrtz_f16_f32 v28, v28, v124
    v_cvt_pkrtz_f16_f32 v29, v29, v125
    s_waitcnt lgkmcnt(6)
    v_mfma_f32_16x16x32_f16 v[104:107], v[72:75], v[32:35], v[104:107]
    ds_read_b64 v[62:63], v6 offset:520
    v_cvt_pkrtz_f16_f32 v30, v30, v126
    v_cvt_pkrtz_f16_f32 v31, v31, v127
    s_waitcnt lgkmcnt(5)
    v_mfma_f32_16x16x32_f16 v[104:107], v[56:59], v[36:39], v[104:107]
    ds_read_b128 v[32:35], v4 offset:3120
    v_mfma_f32_16x16x32_f16 v[16:19], v[56:59], v[52:55], v[16:19]
    ds_read_b128 v[124:127], v4 offset:3184
    s_waitcnt lgkmcnt(5)
    v_mfma_f32_16x16x32_f16 v[104:107], v[28:31], v[12:15], v[104:107]
    v_mfma_f32_16x16x32_f16 v[16:19], v[28:31], v[100:103], v[16:19]
    ds_read_b128 v[52:55], v4 offset:3248
    s_waitcnt lgkmcnt(3)
    v_mfma_f32_16x16x32_f16 v[104:107], v[60:63], v[64:67], v[104:107]
    v_mfma_f32_16x16x32_f16 v[16:19], v[8:11], v[64:67], v[16:19]
    ds_read_b128 v[56:59], v4 offset:3312
    s_waitcnt lgkmcnt(3)
    v_mfma_f32_16x16x32_f16 v[104:107], v[40:43], v[32:35], v[104:107]
    v_mfma_f32_16x16x32_f16 v[16:19], v[116:119], v[32:35], v[16:19]
    ds_read_b128 v[100:103], v4 offset:3376
    s_waitcnt lgkmcnt(3)
    v_mfma_f32_16x16x32_f16 v[104:107], v[68:71], v[124:127], v[104:107]
    v_mfma_f32_16x16x32_f16 v[16:19], v[112:115], v[124:127], v[16:19]
    ds_read_b128 v[28:31], v4 offset:3440
    s_waitcnt lgkmcnt(3)
    v_mfma_f32_16x16x32_f16 v[104:107], v[76:79], v[52:55], v[104:107]
    v_mfma_f32_16x16x32_f16 v[16:19], v[80:83], v[52:55], v[16:19]
    ds_read_b128 v[8:11], v4 offset:3504
    s_waitcnt lgkmcnt(3)
    v_mfma_f32_16x16x32_f16 v[104:107], v[92:95], v[56:59], v[104:107]
    v_mfma_f32_16x16x32_f16 v[16:19], v[20:23], v[56:59], v[16:19]
    ds_read_b128 v[64:67], v4 offset:3568
    s_waitcnt lgkmcnt(3)
    v_mfma_f32_16x16x32_f16 v[104:107], v[108:111], v[100:103], v[104:107]
    v_mfma_f32_16x16x32_f16 v[16:19], v[96:99], v[100:103], v[16:19]
    ds_read_b128 v[116:119], v4 offset:3632
    s_waitcnt lgkmcnt(3)
    v_mfma_f32_16x16x32_f16 v[104:107], v[84:87], v[28:31], v[104:107]
    ds_read_b128 v[32:35], v4 offset:3696
    v_mfma_f32_16x16x32_f16 v[16:19], v[120:123], v[28:31], v[16:19]
    ds_read_b128 v[112:115], v4 offset:3056
    s_waitcnt lgkmcnt(4)
    v_mfma_f32_16x16x32_f16 v[104:107], v[24:27], v[8:11], v[104:107]
    v_mfma_f32_16x16x32_f16 v[16:19], v[72:75], v[8:11], v[16:19]
    ds_read_b128 v[124:127], v4 offset:3040
    s_waitcnt lgkmcnt(4)
    v_mfma_f32_16x16x32_f16 v[104:107], v[88:91], v[64:67], v[104:107]
    v_mfma_f32_16x16x32_f16 v[16:19], v[60:63], v[64:67], v[16:19]
    ds_read_b128 v[80:83], v4 offset:3760
    s_waitcnt lgkmcnt(4)
    v_mfma_f32_16x16x32_f16 v[16:19], v[40:43], v[116:119], v[16:19]
    ds_read_b128 v[52:55], v4 offset:3824
    s_waitcnt lgkmcnt(4)
    v_mfma_f32_16x16x32_f16 v[16:19], v[68:71], v[32:35], v[16:19]
    s_nop 0
    s_nop 0
    v_cvt_pk_f16_f32 v104, v104, v105
    v_cvt_pk_f16_f32 v105, v106, v107
    ds_write_b64 v1, v[104:105] offset:1024
    s_mov_b64 exec, 1
    ds_add_u32 v3, v0 offset:72
    s_mov_b64 exec, -1
    s_setprio 0
    s_waitcnt lgkmcnt(5)
    v_mfma_f32_16x16x32_f16 v[56:59], v[112:115], v[44:47], 0
    ds_read_b128 v[20:23], v4 offset:3888
    v_mfma_f32_16x16x32_f16 v[100:103], v[112:115], v[48:51], 0
    ds_read_b128 v[96:99], v4 offset:3952
    s_nop 0
    s_waitcnt lgkmcnt(6)
    v_mfma_f32_16x16x32_f16 v[28:31], v[124:127], v[44:47], 0
    ds_read_b128 v[120:123], v4 offset:4016
    v_mfma_f32_16x16x32_f16 v[8:11], v[124:127], v[48:51], 0
    ds_read_b128 v[72:75], v4 offset:4080
    s_waitcnt lgkmcnt(7)
    v_mfma_f32_16x16x32_f16 v[16:19], v[76:79], v[80:83], v[16:19]
    s_waitcnt lgkmcnt(6)
    v_mfma_f32_16x16x32_f16 v[16:19], v[92:95], v[52:55], v[16:19]
    s_waitcnt lgkmcnt(3)
    v_mfma_f32_16x16x32_f16 v[16:19], v[108:111], v[20:23], v[16:19]
    v_cvt_pkrtz_f16_f32 v56, v56, v100
    v_cvt_pkrtz_f16_f32 v57, v57, v101
    s_waitcnt lgkmcnt(2)
    v_mfma_f32_16x16x32_f16 v[16:19], v[84:87], v[96:99], v[16:19]
    v_cvt_pkrtz_f16_f32 v58, v58, v102
    v_cvt_pkrtz_f16_f32 v59, v59, v103
    s_waitcnt lgkmcnt(1)
    v_mfma_f32_16x16x32_f16 v[16:19], v[24:27], v[120:123], v[16:19]
    v_cvt_pkrtz_f16_f32 v28, v28, v8
    v_cvt_pkrtz_f16_f32 v29, v29, v9
    s_waitcnt lgkmcnt(0)
    v_mfma_f32_16x16x32_f16 v[16:19], v[88:91], v[72:75], v[16:19]
    v_cvt_pkrtz_f16_f32 v30, v30, v10
    v_cvt_pkrtz_f16_f32 v31, v31, v11
    v_mfma_f32_16x16x32_f16 v[16:19], v[56:59], v[36:39], v[16:19]
    s_nop 0
    v_mfma_f32_16x16x32_f16 v[16:19], v[28:31], v[12:15], v[16:19]
    s_nop 7
    v_cvt_pk_f16_f32 v16, v16, v17
    v_cvt_pk_f16_f32 v17, v18, v19
    ds_write_b64 v1, v[16:17] offset:1536
    s_mov_b64 exec, 1
    ds_add_u32 v3, v0 offset:76
    s_mov_b64 exec, -1
    s_branch L_fin
    s_nop 0
L_set1_66:
    ds_read_b64 v[32:33], v7 offset:128
    ds_read_b64 v[34:35], v7 offset:136
    ds_read_b64 v[36:37], v7 offset:64
    ds_read_b64 v[38:39], v7 offset:72
    ds_read_b64 v[40:41], v7 offset:0
    ds_read_b64 v[42:43], v7 offset:8
    ds_read_b64 v[60:61], v7 offset:640
    ds_read_b64 v[62:63], v7 offset:648
    s_mov_b32 s46, 0
L_sp_72:
    ds_read_b32 v5, v3 offset:48
    s_waitcnt lgkmcnt(0)
    v_cmp_gt_u32_e64 vcc, 2, v5
    s_cbranch_vccz L_spd_73
    s_add_u32 s46, s46, 1
    s_sleep 2
    s_cmp_lt_u32 s46, 400000
    s_cbranch_scc1 L_sp_72
    s_branch L_end
    s_nop 0
L_spd_73:
    s_setprio 2
    ds_read_b128 v[64:67], v4 offset:496
    ds_read_b128 v[68:71], v4 offset:480
    s_waitcnt lgkmcnt(1)
    v_mfma_f32_16x16x32_f16 v[76:79], v[64:67], v[44:47], 0
    ds_read_b128 v[72:75], v4 offset:512
    v_mfma_f32_16x16x32_f16 v[84:87], v[64:67], v[48:51], 0
    ds_read_b128 v[80:83], v4 offset:1024
    v_mfma_f32_16x16x32_f16 v[16:19], v[64:67], v[52:55], 0
    ds_read_b128 v[8:11], v4 offset:1008
    s_waitcnt lgkmcnt(3)
    s_nop 0
    v_mfma_f32_16x16x32_f16 v[20:23], v[68:71], v[56:59], 0
    ds_read_b64 v[24:25], v7 offset:576
    v_mfma_f32_16x16x32_f16 v[28:31], v[68:71], v[44:47], 0
    ds_read_b128 v[88:91], v4 offset:992
    v_mfma_f32_16x16x32_f16 v[96:99], v[68:71], v[48:51], 0
    ds_read_b64 v[26:27], v7 offset:584
    s_waitcnt lgkmcnt(5)
    v_mfma_f32_16x16x32_f16 v[104:107], v[12:15], v[72:75], 0
    ds_read_b64 v[92:93], v7 offset:320
    s_waitcnt lgkmcnt(5)
    v_mfma_f32_16x16x32_f16 v[112:115], v[12:15], v[80:83], 0
    ds_read_b64 v[94:95], v7 offset:328
    s_waitcnt lgkmcnt(5)
    s_nop 0
    v_mfma_f32_16x16x32_f16 v[120:123], v[8:11], v[44:47], 0
    ds_read_b64 v[100:101], v7 offset:256
    v_cvt_pkrtz_f16_f32 v76, v76, v84
    v_cvt_pkrtz_f16_f32 v77, v77, v85
    v_mfma_f32_16x16x32_f16 v[64:67], v[8:11], v[48:51], 0
    ds_read_b64 v[102:103], v7 offset:264
    v_cvt_pkrtz_f16_f32 v78, v78, v86
    v_cvt_pkrtz_f16_f32 v79, v79, v87
    v_mfma_f32_16x16x32_f16 v[72:75], v[8:11], v[52:55], 0
    ds_read_b64 v[108:109], v7 offset:192
    v_cvt_pkrtz_f16_f32 v16, v16, v20
    v_cvt_pkrtz_f16_f32 v17, v17, v21
    s_nop 0
    s_waitcnt lgkmcnt(6)
    v_mfma_f32_16x16x32_f16 v[80:83], v[88:91], v[56:59], 0
    ds_read_b64 v[110:111], v7 offset:200
    v_cvt_pkrtz_f16_f32 v18, v18, v22
    v_cvt_pkrtz_f16_f32 v19, v19, v23
    v_mfma_f32_16x16x32_f16 v[84:87], v[88:91], v[44:47], 0
    ds_read_b64 v[116:117], v6 offset:0
    v_cvt_pkrtz_f16_f32 v28, v28, v96
    v_cvt_pkrtz_f16_f32 v29, v29, v97
    v_mfma_f32_16x16x32_f16 v[52:55], v[88:91], v[48:51], 0
    ds_read_b64 v[118:119], v6 offset:8
    v_cvt_pkrtz_f16_f32 v30, v30, v98
    v_cvt_pkrtz_f16_f32 v31, v31, v99
    v_mfma_f32_16x16x32_f16 v[8:11], v[76:79], v[32:35], 0
    ds_read_b64 v[124:125], v6 offset:64
    v_mfma_f32_16x16x32_f16 v[56:59], v[76:79], v[36:39], 0
    ds_read_b128 v[20:23], v4 offset:496
    v_mfma_f32_16x16x32_f16 v[104:107], v[76:79], v[40:43], v[104:107]
    ds_read_b64 v[126:127], v6 offset:72
    ds_read_b128 v[88:91], v4 offset:560
    v_mfma_f32_16x16x32_f16 v[104:107], v[16:19], v[60:63], v[104:107]
    ds_read_b64 v[68:69], v6 offset:128
    ds_read_b64 v[70:71], v6 offset:136
    s_waitcnt lgkmcnt(14)
    v_mfma_f32_16x16x32_f16 v[112:115], v[16:19], v[24:27], v[112:115]
    ds_read_b128 v[96:99], v4 offset:624
    ds_read_b64 v[12:13], v6 offset:192
    s_waitcnt lgkmcnt(14)
    v_mfma_f32_16x16x32_f16 v[8:11], v[28:31], v[92:95], v[8:11]
    ds_read_b64 v[14:15], v6 offset:200
    s_waitcnt lgkmcnt(13)
    v_mfma_f32_16x16x32_f16 v[56:59], v[28:31], v[100:103], v[56:59]
    ds_read_b128 v[76:79], v4 offset:688
    s_waitcnt lgkmcnt(12)
    v_mfma_f32_16x16x32_f16 v[104:107], v[28:31], v[108:111], v[104:107]
    ds_read_b64 v[16:17], v6 offset:256
    s_waitcnt lgkmcnt(11)
    s_waitcnt lgkmcnt(9)
    v_mfma_f32_16x16x32_f16 v[8:11], v[116:119], v[20:23], v[8:11]
    ds_read_b64 v[18:19], v6 offset:264
    v_cvt_pkrtz_f16_f32 v120, v120, v64
    v_cvt_pkrtz_f16_f32 v121, v121, v65
    v_cvt_pkrtz_f16_f32 v122, v122, v66
    s_waitcnt lgkmcnt(9)
    s_waitcnt lgkmcnt(8)
    v_mfma_f32_16x16x32_f16 v[8:11], v[124:127], v[88:91], v[8:11]
    ds_read_b64 v[24:25], v6 offset:320
    v_cvt_pkrtz_f16_f32 v123, v123, v67
    v_cvt_pkrtz_f16_f32 v72, v72, v80
    v_cvt_pkrtz_f16_f32 v73, v73, v81
    s_waitcnt lgkmcnt(7)
    s_waitcnt lgkmcnt(6)
    v_mfma_f32_16x16x32_f16 v[8:11], v[68:71], v[96:99], v[8:11]
    ds_read_b64 v[26:27], v6 offset:328
    v_cvt_pkrtz_f16_f32 v74, v74, v82
    v_cvt_pkrtz_f16_f32 v75, v75, v83
    v_cvt_pkrtz_f16_f32 v84, v84, v52
    s_waitcnt lgkmcnt(5)
    s_waitcnt lgkmcnt(4)
    v_mfma_f32_16x16x32_f16 v[8:11], v[12:15], v[76:79], v[8:11]
    ds_read_b64 v[28:29], v6 offset:384
    v_cvt_pkrtz_f16_f32 v85, v85, v53
    v_cvt_pkrtz_f16_f32 v86, v86, v54
    v_cvt_pkrtz_f16_f32 v87, v87, v55
    v_mfma_f32_16x16x32_f16 v[56:59], v[120:123], v[32:35], v[56:59]
    ds_read_b128 v[96:99], v4 offset:752
    v_mfma_f32_16x16x32_f16 v[104:107], v[120:123], v[36:39], v[104:107]
    ds_read_b128 v[76:79], v4 offset:816
    v_mfma_f32_16x16x32_f16 v[112:115], v[120:123], v[40:43], v[112:115]
    ds_read_b64 v[30:31], v6 offset:392
    ds_read_b128 v[52:55], v4 offset:880
    v_mfma_f32_16x16x32_f16 v[112:115], v[72:75], v[60:63], v[112:115]
    ds_read_b64 v[20:21], v6 offset:448
    ds_read_b64 v[22:23], v6 offset:456
    v_mfma_f32_16x16x32_f16 v[56:59], v[84:87], v[92:95], v[56:59]
    ds_read_b128 v[120:123], v4 offset:944
    ds_read_b64 v[88:89], v6 offset:512
    v_mfma_f32_16x16x32_f16 v[104:107], v[84:87], v[100:103], v[104:107]
    ds_read_b64 v[90:91], v6 offset:520
    v_mfma_f32_16x16x32_f16 v[112:115], v[84:87], v[108:111], v[112:115]
    ds_read_b128 v[60:63], v4 offset:1008
    ds_read_b64 v[64:65], v6 offset:576
    s_waitcnt lgkmcnt(14)
    s_waitcnt lgkmcnt(10)
    v_mfma_f32_16x16x32_f16 v[8:11], v[16:19], v[96:99], v[8:11]
    ds_read_b64 v[66:67], v6 offset:584
    s_waitcnt lgkmcnt(10)
    s_nop 0
    v_mfma_f32_16x16x32_f16 v[8:11], v[24:27], v[76:79], v[8:11]
    ds_read_b128 v[108:111], v4 offset:1072
    ds_read_b64 v[80:81], v6 offset:640
    s_waitcnt lgkmcnt(11)
    s_waitcnt lgkmcnt(10)
    v_mfma_f32_16x16x32_f16 v[8:11], v[28:31], v[52:55], v[8:11]
    ds_read_b64 v[82:83], v6 offset:648
    s_waitcnt lgkmcnt(9)
    s_waitcnt lgkmcnt(8)
    v_mfma_f32_16x16x32_f16 v[8:11], v[20:23], v[120:123], v[8:11]
    ds_read_b128 v[96:99], v4 offset:1136
    ds_read_b64 v[40:41], v6 offset:704
    s_waitcnt lgkmcnt(8)
    s_waitcnt lgkmcnt(7)
    v_mfma_f32_16x16x32_f16 v[8:11], v[88:91], v[60:63], v[8:11]
    ds_read_b64 v[42:43], v6 offset:712
    v_mfma_f32_16x16x32_f16 v[56:59], v[116:119], v[60:63], v[56:59]
    ds_read_b128 v[52:55], v4 offset:1200
    ds_read_b64 v[72:73], v6 offset:768
    s_waitcnt lgkmcnt(8)
    s_waitcnt lgkmcnt(7)
    v_mfma_f32_16x16x32_f16 v[8:11], v[64:67], v[108:111], v[8:11]
    ds_read_b64 v[74:75], v6 offset:776
    v_mfma_f32_16x16x32_f16 v[56:59], v[124:127], v[108:111], v[56:59]
    ds_read_b128 v[60:63], v4 offset:1264
    ds_read_b64 v[84:85], v6 offset:832
    s_waitcnt lgkmcnt(8)
    s_waitcnt lgkmcnt(7)
    v_mfma_f32_16x16x32_f16 v[8:11], v[80:83], v[96:99], v[8:11]
    ds_read_b64 v[86:87], v6 offset:840
    v_mfma_f32_16x16x32_f16 v[56:59], v[68:71], v[96:99], v[56:59]
    ds_read_b128 v[108:111], v4 offset:1328
    ds_read_b64 v[76:77], v6 offset:896
    s_waitcnt lgkmcnt(8)
    s_waitcnt lgkmcnt(7)
    v_mfma_f32_16x16x32_f16 v[8:11], v[40:43], v[52:55], v[8:11]
    ds_read_b64 v[78:79], v6 offset:904
    v_mfma_f32_16x16x32_f16 v[56:59], v[12:15], v[52:55], v[56:59]
    ds_read_b128 v[96:99], v4 offset:1392
    ds_read_b64 v[120:121], v6 offset:960
    s_waitcnt lgkmcnt(8)
    s_waitcnt lgkmcnt(7)
    v_mfma_f32_16x16x32_f16 v[8:11], v[72:75], v[60:63], v[8:11]
    ds_read_b64 v[122:123], v6 offset:968
    v_mfma_f32_16x16x32_f16 v[56:59], v[16:19], v[60:63], v[56:59]
    ds_read_b128 v[52:55], v4 offset:1456
    s_waitcnt lgkmcnt(7)
    s_waitcnt lgkmcnt(6)
    v_mfma_f32_16x16x32_f16 v[8:11], v[84:87], v[108:111], v[8:11]
    ds_read_b128 v[60:63], v4 offset:1520
    v_mfma_f32_16x16x32_f16 v[56:59], v[24:27], v[108:111], v[56:59]
    ds_read_b64 v[108:109], v6 offset:1024
    ds_read_b64 v[110:111], v6 offset:1032
    s_waitcnt lgkmcnt(7)
    s_waitcnt lgkmcnt(6)
    v_mfma_f32_16x16x32_f16 v[8:11], v[76:79], v[96:99], v[8:11]
    v_mfma_f32_16x16x32_f16 v[56:59], v[28:31], v[96:99], v[56:59]
    ds_read_b128 v[96:99], v4 offset:1584
    s_waitcnt lgkmcnt(5)
    s_waitcnt lgkmcnt(4)
    v_mfma_f32_16x16x32_f16 v[8:11], v[120:123], v[52:55], v[8:11]
    v_mfma_f32_16x16x32_f16 v[56:59], v[20:23], v[52:55], v[56:59]
    ds_read_b128 v[52:55], v4 offset:1648
    s_waitcnt lgkmcnt(2)
    s_nop 0
    v_mfma_f32_16x16x32_f16 v[8:11], v[108:111], v[60:63], v[8:11]
    v_mfma_f32_16x16x32_f16 v[56:59], v[88:91], v[60:63], v[56:59]
    v_mfma_f32_16x16x32_f16 v[104:107], v[116:119], v[60:63], v[104:107]
    ds_read_b128 v[60:63], v4 offset:1712
    s_waitcnt lgkmcnt(2)
    v_mfma_f32_16x16x32_f16 v[56:59], v[64:67], v[96:99], v[56:59]
    s_nop 2
    v_cvt_pk_f16_f32 v8, v8, v9
    v_cvt_pk_f16_f32 v9, v10, v11
    ds_write_b64 v1, v[8:9] offset:0
    s_mov_b64 exec, 1
    ds_add_u32 v3, v0 offset:64
    s_mov_b64 exec, -1
    s_setprio 1
    v_mfma_f32_16x16x32_f16 v[104:107], v[124:127], v[96:99], v[104:107]
    ds_read_b128 v[8:11], v4 offset:1776
    s_waitcnt lgkmcnt(4)
    v_mfma_f32_16x16x32_f16 v[56:59], v[80:83], v[52:55], v[56:59]
    ds_read_b128 v[96:99], v4 offset:1840
    v_mfma_f32_16x16x32_f16 v[104:107], v[68:71], v[52:55], v[104:107]
    ds_read_b128 v[52:55], v4 offset:1904
    s_nop 0
    s_waitcnt lgkmcnt(5)
    v_mfma_f32_16x16x32_f16 v[56:59], v[40:43], v[60:63], v[56:59]
    v_mfma_f32_16x16x32_f16 v[104:107], v[12:15], v[60:63], v[104:107]
    ds_read_b32 v5, v3 offset:56
    ds_read_b128 v[60:63], v4 offset:1968
    s_waitcnt lgkmcnt(4)
    v_mfma_f32_16x16x32_f16 v[56:59], v[72:75], v[8:11], v[56:59]
    v_mfma_f32_16x16x32_f16 v[104:107], v[16:19], v[8:11], v[104:107]
    ds_read_b128 v[8:11], v4 offset:2032
    s_waitcnt lgkmcnt(4)
    v_mfma_f32_16x16x32_f16 v[56:59], v[84:87], v[96:99], v[56:59]
    v_mfma_f32_16x16x32_f16 v[104:107], v[24:27], v[96:99], v[104:107]
    s_waitcnt lgkmcnt(3)
    v_mfma_f32_16x16x32_f16 v[56:59], v[76:79], v[52:55], v[56:59]
    s_waitcnt lgkmcnt(2)
    v_cmp_gt_u32_e64 vcc, 2, v5
    s_cbranch_vccz L_x2_74
    s_mov_b32 s46, 0
L_sp_75:
    ds_read_b32 v5, v3 offset:56
    s_waitcnt lgkmcnt(0)
    v_cmp_gt_u32 vcc, 2, v5
    s_cbranch_vccz L_spd_76
    s_add_u32 s46, s46, 1
    s_sleep 1
    s_cmp_lt_u32 s46, 400000
    s_cbranch_scc1 L_sp_75
    s_branch L_end
    s_nop 0
L_spd_76:
L_x2_74:
    ds_read_b128 v[96:99], v4 offset:2096
    v_mfma_f32_16x16x32_f16 v[104:107], v[28:31], v[52:55], v[104:107]
    s_waitcnt lgkmcnt(2)
    v_mfma_f32_16x16x32_f16 v[56:59], v[120:123], v[60:63], v[56:59]
    ds_read_b128 v[52:55], v4 offset:2160
    v_mfma_f32_16x16x32_f16 v[104:107], v[20:23], v[60:63], v[104:107]
    s_waitcnt lgkmcnt(2)
    v_mfma_f32_16x16x32_f16 v[56:59], v[108:111], v[8:11], v[56:59]
    ds_read_b128 v[60:63], v4 offset:2224
    v_mfma_f32_16x16x32_f16 v[104:107], v[88:91], v[8:11], v[104:107]
    v_mfma_f32_16x16x32_f16 v[112:115], v[116:119], v[8:11], v[112:115]
    ds_read_b128 v[116:119], v4 offset:1520
    s_waitcnt lgkmcnt(3)
    v_mfma_f32_16x16x32_f16 v[104:107], v[64:67], v[96:99], v[104:107]
    s_nop 1
    v_cvt_pk_f16_f32 v56, v56, v57
    v_cvt_pk_f16_f32 v57, v58, v59
    ds_write_b64 v1, v[56:57] offset:512
    s_mov_b64 exec, 1
    ds_add_u32 v3, v0 offset:68
    s_mov_b64 exec, -1
    s_setprio 0
    v_mfma_f32_16x16x32_f16 v[112:115], v[124:127], v[96:99], v[112:115]
    ds_read_b128 v[8:11], v4 offset:1504
    s_waitcnt lgkmcnt(5)
    v_mfma_f32_16x16x32_f16 v[104:107], v[80:83], v[52:55], v[104:107]
    v_mfma_f32_16x16x32_f16 v[112:115], v[68:71], v[52:55], v[112:115]
    ds_read_b128 v[56:59], v4 offset:2288
    s_waitcnt lgkmcnt(5)
    v_mfma_f32_16x16x32_f16 v[104:107], v[40:43], v[60:63], v[104:107]
    v_mfma_f32_16x16x32_f16 v[112:115], v[12:15], v[60:63], v[112:115]
    ds_read_b128 v[124:127], v4 offset:2352
    s_waitcnt lgkmcnt(5)
    v_mfma_f32_16x16x32_f16 v[96:99], v[116:119], v[44:47], 0
    v_mfma_f32_16x16x32_f16 v[68:71], v[116:119], v[48:51], 0
    ds_read_b128 v[52:55], v4 offset:2416
    s_waitcnt lgkmcnt(3)
    v_mfma_f32_16x16x32_f16 v[12:15], v[8:11], v[44:47], 0
    v_mfma_f32_16x16x32_f16 v[60:63], v[8:11], v[48:51], 0
    ds_read_b128 v[116:119], v4 offset:2480
    s_waitcnt lgkmcnt(3)
    v_mfma_f32_16x16x32_f16 v[104:107], v[72:75], v[56:59], v[104:107]
    v_mfma_f32_16x16x32_f16 v[112:115], v[16:19], v[56:59], v[112:115]
    ds_read_b128 v[8:11], v4 offset:2544
    s_waitcnt lgkmcnt(3)
    s_nop 0
    v_mfma_f32_16x16x32_f16 v[104:107], v[84:87], v[124:127], v[104:107]
    v_cvt_pkrtz_f16_f32 v96, v96, v68
    v_cvt_pkrtz_f16_f32 v97, v97, v69
    v_mfma_f32_16x16x32_f16 v[112:115], v[24:27], v[124:127], v[112:115]
    v_cvt_pkrtz_f16_f32 v98, v98, v70
    v_cvt_pkrtz_f16_f32 v99, v99, v71
    s_nop 0
    s_waitcnt lgkmcnt(2)
    v_mfma_f32_16x16x32_f16 v[104:107], v[76:79], v[52:55], v[104:107]
    v_cvt_pkrtz_f16_f32 v12, v12, v60
    v_cvt_pkrtz_f16_f32 v13, v13, v61
    v_mfma_f32_16x16x32_f16 v[112:115], v[28:31], v[52:55], v[112:115]
    v_cvt_pkrtz_f16_f32 v14, v14, v62
    v_cvt_pkrtz_f16_f32 v15, v15, v63
    s_waitcnt lgkmcnt(1)
    v_mfma_f32_16x16x32_f16 v[104:107], v[120:123], v[116:119], v[104:107]
    v_mfma_f32_16x16x32_f16 v[112:115], v[20:23], v[116:119], v[112:115]
    ds_read_b128 v[16:19], v4 offset:2608
    s_waitcnt lgkmcnt(1)
    v_mfma_f32_16x16x32_f16 v[104:107], v[108:111], v[8:11], v[104:107]
    ds_read_b128 v[56:59], v4 offset:2672
    v_mfma_f32_16x16x32_f16 v[112:115], v[88:91], v[8:11], v[112:115]
    ds_read_b128 v[24:27], v4 offset:2032
    v_mfma_f32_16x16x32_f16 v[104:107], v[96:99], v[32:35], v[104:107]
    v_mfma_f32_16x16x32_f16 v[112:115], v[96:99], v[36:39], v[112:115]
    ds_read_b128 v[124:127], v4 offset:2016
    v_mfma_f32_16x16x32_f16 v[104:107], v[12:15], v[92:95], v[104:107]
    v_mfma_f32_16x16x32_f16 v[112:115], v[12:15], v[100:103], v[112:115]
    ds_read_b128 v[68:71], v4 offset:2736
    s_waitcnt lgkmcnt(4)
    v_mfma_f32_16x16x32_f16 v[112:115], v[64:67], v[16:19], v[112:115]
    ds_read_b128 v[28:31], v4 offset:2800
    s_waitcnt lgkmcnt(4)
    v_mfma_f32_16x16x32_f16 v[112:115], v[80:83], v[56:59], v[112:115]
    s_nop 0
    s_nop 0
    v_cvt_pk_f16_f32 v104, v104, v105
    v_cvt_pk_f16_f32 v105, v106, v107
    ds_write_b64 v1, v[104:105] offset:1024
    s_mov_b64 exec, 1
    ds_add_u32 v3, v0 offset:72
    s_mov_b64 exec, -1
    s_setprio 0
    s_waitcnt lgkmcnt(5)
    v_mfma_f32_16x16x32_f16 v[60:63], v[24:27], v[44:47], 0
    ds_read_b128 v[52:55], v4 offset:2864
    v_mfma_f32_16x16x32_f16 v[116:119], v[24:27], v[48:51], 0
    ds_read_b128 v[20:23], v4 offset:2928
    s_nop 0
    s_waitcnt lgkmcnt(6)
    v_mfma_f32_16x16x32_f16 v[8:11], v[124:127], v[44:47], 0
    ds_read_b128 v[88:91], v4 offset:2992
    v_mfma_f32_16x16x32_f16 v[96:99], v[124:127], v[48:51], 0
    ds_read_b128 v[36:39], v4 offset:3056
    s_waitcnt lgkmcnt(7)
    v_mfma_f32_16x16x32_f16 v[112:115], v[40:43], v[68:71], v[112:115]
    s_waitcnt lgkmcnt(6)
    v_mfma_f32_16x16x32_f16 v[112:115], v[72:75], v[28:31], v[112:115]
    s_waitcnt lgkmcnt(3)
    v_mfma_f32_16x16x32_f16 v[112:115], v[84:87], v[52:55], v[112:115]
    v_cvt_pkrtz_f16_f32 v60, v60, v116
    v_cvt_pkrtz_f16_f32 v61, v61, v117
    s_waitcnt lgkmcnt(2)
    v_mfma_f32_16x16x32_f16 v[112:115], v[76:79], v[20:23], v[112:115]
    v_cvt_pkrtz_f16_f32 v62, v62, v118
    v_cvt_pkrtz_f16_f32 v63, v63, v119
    s_waitcnt lgkmcnt(1)
    v_mfma_f32_16x16x32_f16 v[112:115], v[120:123], v[88:91], v[112:115]
    v_cvt_pkrtz_f16_f32 v8, v8, v96
    v_cvt_pkrtz_f16_f32 v9, v9, v97
    s_waitcnt lgkmcnt(0)
    v_mfma_f32_16x16x32_f16 v[112:115], v[108:111], v[36:39], v[112:115]
    v_cvt_pkrtz_f16_f32 v10, v10, v98
    v_cvt_pkrtz_f16_f32 v11, v11, v99
    v_mfma_f32_16x16x32_f16 v[112:115], v[60:63], v[32:35], v[112:115]
    s_nop 0
    v_mfma_f32_16x16x32_f16 v[112:115], v[8:11], v[92:95], v[112:115]
    s_nop 7
    v_cvt_pk_f16_f32 v112, v112, v113
    v_cvt_pk_f16_f32 v113, v114, v115
    ds_write_b64 v1, v[112:113] offset:1536
    s_mov_b64 exec, 1
    ds_add_u32 v3, v0 offset:76
    s_mov_b64 exec, -1
L_fin:
L_end:
    s_endpgm
L_codeend:
.section .rodata,"a"
.p2align 6
.amdhsa_kernel recurrent_scan__ssm_conv_s4d__moe_arch_mod__prompt_kernel
  .amdhsa_next_free_vgpr 128
  .amdhsa_next_free_sgpr 102
  .amdhsa_accum_offset 128
  .amdhsa_group_segment_fixed_size 0
  .amdhsa_kernarg_size 120
  .amdhsa_user_sgpr_count 2
  .amdhsa_user_sgpr_kernarg_segment_ptr 1
  .amdhsa_system_sgpr_workgroup_id_x 1
  .amdhsa_float_denorm_mode_32 3
.end_amdhsa_kernel
```

```asm
; @launch grid=(256,1,1) block=(1024,1,1) lds=161280
.amdgcn_target "amdgcn-amd-amdhsa--gfx950"
.text
.globl recurrent_scan__ssm_conv_s4d__moe_arch_mod__prompt_kernel
.p2align 12
.p2align 8
.type recurrent_scan__ssm_conv_s4d__moe_arch_mod__prompt_kernel,@function
recurrent_scan__ssm_conv_s4d__moe_arch_mod__prompt_kernel:
    s_cmp_ge_u32 s2, 256
    s_nop 0
    s_cbranch_scc1 L_end
    s_load_dwordx16 s[4:19], s[0:1], 0
    s_load_dwordx8 s[20:27], s[0:1], 64
    s_load_dwordx4 s[28:31], s[0:1], 96
    s_load_dwordx2 s[32:33], s[0:1], 112
    s_getpc_b64 s[62:63]
L_pc:
    v_readfirstlane_b32 s3, v0
    v_and_b32 v1, 63, v0
    v_mov_b32 v3, 0
    v_lshlrev_b32 v2, 4, v1
    s_and_b32 s35, s2, 7
    s_lshr_b32 s36, s2, 3
    s_lshr_b32 s3, s3, 6
    s_and_b32 s40, s36, 15
    s_lshl4_add_u32 s37, s35, s40
    s_lshr_b32 s38, s36, 4
    s_xor_b32 s38, s38, 1
    s_and_b32 s34, s3, 3
    s_cmp_ge_u32 s3, 4
    s_cbranch_scc1 L_p1
    s_setprio 3
    s_lshl_b32 s40, s2, 14
    s_lshl_b32 s41, s34, 9
    v_lshrrev_b32_e64 v118, 3, v1
    v_and_b32 v113, 112, v2
    v_add_u32_e64 v113, s41, v113
    v_lshl_add_u32 v112, v118, 11, v113
    v_add_u32 v112, s40, v112
    s_waitcnt lgkmcnt(0)
    s_load_dword s47, s[32:33], 0
    global_load_dwordx4 v[32:35], v113, s[20:21] offset:0
    global_load_dwordx4 v[36:39], v113, s[20:21] offset:128
    global_load_dwordx4 v[40:43], v113, s[20:21] offset:256
    global_load_dwordx4 v[44:47], v113, s[20:21] offset:384
    global_load_dwordx4 v[16:19], v112, s[4:5] offset:0 nt
    global_load_dwordx4 v[20:23], v112, s[4:5] offset:128 nt
    global_load_dwordx4 v[24:27], v112, s[4:5] offset:256 nt
    global_load_dwordx4 v[28:31], v112, s[4:5] offset:384 nt
    s_barrier
    s_branch L_tok
    s_nop 0
L_p1:
    s_cmp_ge_u32 s3, 8
    s_cbranch_scc1 L_p2
    s_and_b32 s40, s36, 3
    s_lshl2_add_u32 s40, s40, s34
    s_lshl_b32 s40, s40, 11
    v_and_b32 v0, 15, v1
    v_lshl_add_u32 v0, v0, 7, s40
    v_cmp_gt_u32 vcc, L_codeend-L_pc-4, v0
    s_nop 1
    v_cndmask_b32 v0, v3, v0, vcc
    global_load_dword v31, v0, s[62:63]
    s_lshl_b32 s40, s34, 7
    s_and_b32 s41, s40, 128
    s_add_u32 s40, s40, 384
    v_cmp_gt_u32 vcc, 32, v1
    v_mov_b32 v32, s40
    v_mov_b32 v33, s41
    v_cndmask_b32 v32, v33, v32, vcc
    v_cndmask_b32 v34, 0, -1, vcc
    v_lshl_add_u32 v32, v1, 2, v32
    v_subrev_u32 v32, 128, v32
    ds_write_b32 v32, v34
    s_waitcnt lgkmcnt(0)
    s_barrier
    s_branch L_exp
L_p2:
    s_lshl2_add_u32 s60, s38, s34
    s_bfe_u32 s59, s3, 0x10002
    s_lshl_b32 s40, s59, 2
    s_xor_b32 s34, s60, s40
    v_and_b32 v32, 15, v1
    v_lshrrev_b32 v33, 4, v1
    s_cmp_ge_u32 s34, 5
    s_cbranch_scc1 L_q5
    s_lshl_b32 s40, s34, 2
    s_lshr_b32 s41, 0xccb5a, s40
    s_and_b32 s41, s41, 15
    s_add_u32 s41, s41, 40
    s_lshr_b32 s45, 0x29735, s40
    s_and_b32 s45, s45, 15
    s_bfm_b32 s45, s45, 0
    s_mov_b32 s44, 0
    v_lshl_add_u32 v86, v33, 3, v32
    v_sub_u32_e64 v86, s41, v86
    v_lshrrev_b64 v[86:87], v86, s[44:45]
    s_mov_b32 s43, 0xffff
    v_bfe_i32 v36, v86, 0, 1
    v_bfe_i32 v87, v86, 1, 1
    v_bfi_b32 v36, s43, v36, v87
    v_and_b32 v36, 0x3c003c00, v36
    v_bfe_i32 v37, v86, 2, 1
    v_bfe_i32 v87, v86, 3, 1
    v_bfi_b32 v37, s43, v37, v87
    v_and_b32 v37, 0x3c003c00, v37
    v_bfe_i32 v38, v86, 4, 1
    v_bfe_i32 v87, v86, 5, 1
    v_bfi_b32 v38, s43, v38, v87
    v_and_b32 v38, 0x3c003c00, v38
    v_bfe_i32 v39, v86, 6, 1
    v_bfe_i32 v87, v86, 7, 1
    v_bfi_b32 v39, s43, v39, v87
    v_and_b32 v39, 0x3c003c00, v39
    s_branch L_qw
    s_nop 0
L_q5:
    s_cmp_ge_u32 s34, 6
    s_cbranch_scc1 L_q6
    v_lshlrev_b32 v85, 1, v32
    v_sub_u32 v85, v85, v33
    v_lshl_add_u32 v36, v85, 4, 48
    v_and_b32 v86, 1, v1
    v_cmp_eq_u32 vcc, 0, v86
    v_mov_b32 v85, 0x03020706
    v_mov_b32 v87, 0x05040100
    v_cndmask_b32_e64 v37, v85, v87, vcc
    v_mov_b32 v85, 4412
    v_mov_b32 v87, 5312
    v_cndmask_b32 v85, v85, v87, vcc
    v_lshlrev_b32 v86, 2, v33
    v_sub_u32 v86, v86, v32
    v_lshl_add_u32 v39, v86, 2, v85
    v_sub_u32 v85, 3, v32
    v_and_b32_e64 v85, 3, v85
    v_mul_u32_u24 v85, 1086, v85
    v_lshl_add_u32 v86, v33, 3, v32
    v_sub_u32_e64 v86, 39, v86
    v_lshl_add_u32 v38, v86, 1, v85
    s_branch L_qw
L_q6:
    s_cmp_ge_u32 s34, 7
    s_cbranch_scc1 L_q7
    v_and_b32 v31, 31, v1
    v_mov_b32 v85, 0
    v_cmp_gt_u32 vcc, 24, v31
    v_mov_b32 v86, 0x9876a987
    s_nop 0
    v_cndmask_b32 v85, v85, v86, vcc
    v_cmp_gt_u32 vcc, 16, v31
    v_mov_b32 v86, 0x54aa6543
    s_nop 0
    v_cndmask_b32 v85, v85, v86, vcc
    v_cmp_gt_u32 vcc, 8, v31
    v_mov_b32 v86, 0x2113210
    s_nop 0
    v_cndmask_b32 v85, v85, v86, vcc
    v_lshlrev_b32_e64 v86, 2, v31
    v_bfe_u32 v85, v85, v86, 4
    s_mov_b32 s41, 0xf00f0ff0
    v_bfe_u32 v86, s41, v31, 1
    v_mad_u32_u24 v85, v86, 10, v85
    v_lshrrev_b32 v86, 5, v1
    v_mad_u32_u24 v85, v85, 17, v86
    v_lshlrev_b32 v36, 4, v85
    v_mad_u32_u24 v85, v31, 17, v86
    v_lshlrev_b32 v37, 4, v85
    v_lshrrev_b32 v85, 1, v1
    v_and_b32_e64 v86, 1, v1
    v_sub_u32 v85, 1135, v85
    v_mad_u32_u24 v87, v86, 48, v85
    v_lshlrev_b32 v38, 2, v87
    v_lshlrev_b32 v86, 5, v86
    v_sub_u32 v85, v85, v86
    v_add_u32 v85, 128, v85
    v_lshlrev_b32 v39, 2, v85
    s_branch L_qw
L_q7:
    v_cmp_gt_u32 vcc, 32, v1
    v_bfe_u32 v85, v1, 2, 2
    v_bfe_u32 v86, v1, 3, 2
    v_cndmask_b32 v86, v86, v85, vcc
    v_lshlrev_b32 v86, 2, v86
    s_mov_b32 s41, 0xb630
    v_bfe_u32 v86, s41, v86, 4
    v_mov_b32 v87, 5248
    v_mov_b32 v36, 4352
    v_cndmask_b32 v87, v87, v36, vcc
    v_lshl_add_u32 v86, v86, 6, v87
    v_and_b32 v87, 7, v1
    v_min_u32 v87, 4, v87
    v_and_b32 v36, 3, v1
    v_cndmask_b32 v87, v87, v36, vcc
    v_cmp_gt_u32 vcc, 16, v1
    v_mul_u32_u24 v85, 1088, v85
    s_mov_b32 s41, 0xffff0000
    v_cndmask_b32 v86, v86, v85, vcc
    v_lshl_add_u32 v36, v87, 4, v86
    v_mov_b32 v37, 0
    v_mov_b32_e64 v38, 0
    v_mov_b32_e64 v39, 0
    v_writelane_b32 v38, s41, 3
    v_writelane_b32 v39, -1, 3
    v_writelane_b32 v38, -1, 7
    v_writelane_b32 v39, -1, 7
    v_writelane_b32 v37, s41, 11
    v_writelane_b32 v38, -1, 11
    v_writelane_b32 v37, -1, 15
    v_writelane_b32 v38, -1, 15
L_qw:
    s_lshl_b32 s58, s38, 10
    s_sub_u32 s58, 10512, s58
    s_sub_u32 s40, s34, 4
    s_mul_i32 s40, s40, 4624
    s_add_u32 s40, s40, s58
    s_lshl_b32 s41, s34, 10
    s_add_u32 s41, s41, 4864
    s_cmp_lt_u32 s34, 4
    s_cselect_b32 s40, s41, s40
    v_add_u32_e64 v85, s40, v2
    ds_write_b128 v85, v[36:39]
    s_lshl3_add_u32 s42, s37, s60
    s_lshl_b32 s40, s42, 8
    v_lshl_add_u32 v24, v1, 2, s40
    s_lshr_b32 s40, s42, 1
    s_lshl_b32 s40, s40, 2
    s_waitcnt lgkmcnt(0)
    s_load_dword s48, s[14:15], s40
    s_load_dword s49, s[16:17], s40
    s_barrier
    global_load_dword v8, v24, s[6:7]
    global_load_dword v9, v24, s[8:9]
    global_load_dword v10, v24, s[10:11]
    global_load_dword v11, v24, s[12:13]
    s_branch L_cnv
    s_nop 0
L_tok:
    s_setprio 3
    s_cmp_ge_u32 s34, 2
    s_cselect_b32 s40, 4, 0
    s_add_u32 s40, s40, s34
    s_add_u32 s41, s34, 2
    s_cmp_eq_u32 s38, 0
    s_cselect_b32 s20, s40, s41
    s_cselect_b32 s21, s41, s40
    s_mov_b32 s30, 0x3f803f80
    s_mov_b32 s31, 0xffff0000
    s_lshl_b32 s40, s2, 7
    s_lshl_b32 s41, s34, 20
    s_add_u32 s40, s40, s41
    s_add_u32 s40, s40, 2097152
    s_add_u32 s52, s32, s40
    s_addc_u32 s53, s33, 0
    s_add_u32 s50, s32, 32768
    s_addc_u32 s51, s33, 0
    s_lshl_b32 s40, s2, 6
    s_add_u32 s58, s50, s40
    s_addc_u32 s59, s51, 0
    s_lshl_b32 s40, s21, 11
    s_add_u32 s60, s50, s40
    s_addc_u32 s61, s51, 0
    s_nop 0
    s_lshl_b32 s41, s37, 15
    s_add_u32 s41, s41, 2097152
    s_lshl_b32 s40, s20, 12
    s_add_u32 s40, s40, s41
    s_add_u32 s54, s32, s40
    s_addc_u32 s55, s33, 0
    s_lshl_b32 s40, s21, 12
    s_add_u32 s40, s40, s41
    s_add_u32 s56, s32, s40
    s_addc_u32 s57, s33, 0
    s_lshl_b32 s40, s20, 19
    s_lshl4_add_u32 s40, s37, s40
    s_add_u32 s40, s40, 4096
    s_add_u32 s28, s28, s40
    s_addc_u32 s29, s29, 0
    s_lshl_b32 s40, s20, 9
    s_add_u32 s40, s40, 9488
    s_lshl_b32 s41, s21, 9
    s_add_u32 s41, s41, 9488
    s_nop 0
    s_lshl_b32 s42, s34, 9
    s_add_u32 s42, s42, 52096
    v_lshl_add_u32 v5, v1, 3, s42
    v_add_u32 v11, 57664, v5
    s_lshl_b32 s42, s34, 2
    v_mov_b32 v10, s42
    v_and_b32 v58, 112, v2
    v_lshrrev_b32_e64 v59, 4, v1
    v_mul_u32_u24 v56, 4624, v118
    v_add3_u32 v114, v56, v58, s40
    v_mul_u32_u24 v56, 289, v58
    v_lshlrev_b32_e64 v117, 4, v118
    v_add3_u32 v8, v56, v117, s40
    v_add3_u32 v9, v56, v117, s41
    v_lshl_add_u32 v116, v118, 17, v58
    v_bfe_u32 v56, v1, 2, 2
    v_mul_u32_u24 v56, 4624, v56
    v_lshl_add_u32 v56, v59, 7, v56
    v_and_b32 v57, 2, v1
    v_lshl_add_u32 v56, v57, 5, v56
    v_and_b32 v57, 1, v1
    v_lshl_add_u32 v56, v57, 3, v56
    v_add_u32 v115, s40, v56
    v_and_b32 v57, 15, v1
    v_lshl_add_u32 v56, v57, 2, v59
    v_lshl_add_u32 v6, v56, 3, s40
    v_lshlrev_b32 v4, 13, v56
    s_lshl_b32 s40, s20, 11
    v_lshl_add_u32 v7, v56, 5, s40
    s_lshl_b32 s40, s34, 7
    v_add_u32 v120, s40, v117
    v_lshlrev_b32 v118, 3, v118
    v_mov_b32 v53, 1
    s_waitcnt lgkmcnt(0)
    s_add_u32 s39, s47, 1
    s_mul_i32 s39, s39, 0x9e3779b1
    v_mov_b32 v52, s39
    s_mov_b64 exec, 1
    ds_write_b64 v3, v[52:53] offset:40
    s_mov_b64 exec, -1
    v_lshlrev_b32 v57, 3, v1
    v_and_b32 v119, 0xffff, v52
    s_and_b32 s42, s39, 1
    s_mul_i32 s42, s42, 0x01010101
    s_and_b32 s43, s39, 0xfefefefe
    s_or_b32 s43, s43, s42
    v_bfe_u32 v56, s43, v57, 8
    v_lshl_or_b32 v12, v56, 14, v56
    v_lshrrev_b32 v14, 4, v12
    s_waitcnt vmcnt(4)
    v_dot2_f32_bf16 v51, v32, s30, 0
    v_dot2_f32_bf16 v52, v33, s30, 0
    v_dot2_f32_bf16 v51, v34, s30, v51
    v_dot2_f32_bf16 v52, v35, s30, v52
    v_dot2_f32_bf16 v51, v36, s30, v51
    v_dot2_f32_bf16 v52, v37, s30, v52
    v_dot2_f32_bf16 v51, v38, s30, v51
    v_dot2_f32_bf16 v52, v39, s30, v52
    v_dot2_f32_bf16 v51, v40, s30, v51
    v_dot2_f32_bf16 v52, v41, s30, v52
    v_dot2_f32_bf16 v51, v42, s30, v51
    v_dot2_f32_bf16 v52, v43, s30, v52
    v_dot2_f32_bf16 v51, v44, s30, v51
    v_dot2_f32_bf16 v52, v45, s30, v52
    v_dot2_f32_bf16 v51, v46, s30, v51
    v_dot2_f32_bf16 v52, v47, s30, v52
    s_waitcnt vmcnt(3)
    s_nop 0
    v_dot2_f32_bf16 v49, v16, v16, 0
    v_dot2_f32_bf16 v48, v16, s30, 0
    v_dot2_f32_bf16 v50, v16, v32, 0
    v_dot2_f32_bf16 v49, v17, v17, v49
    v_dot2_f32_bf16 v48, v17, s30, v48
    v_dot2_f32_bf16 v50, v17, v33, v50
    v_dot2_f32_bf16 v49, v18, v18, v49
    v_dot2_f32_bf16 v48, v18, s30, v48
    v_dot2_f32_bf16 v50, v18, v34, v50
    v_dot2_f32_bf16 v49, v19, v19, v49
    v_dot2_f32_bf16 v48, v19, s30, v48
    v_dot2_f32_bf16 v50, v19, v35, v50
    v_add_f32 v51, v51, v52
    s_waitcnt vmcnt(2)
    v_dot2_f32_bf16 v49, v20, v20, v49
    v_dot2_f32_bf16 v48, v20, s30, v48
    v_dot2_f32_bf16 v50, v20, v36, v50
    v_dot2_f32_bf16 v49, v21, v21, v49
    v_dot2_f32_bf16 v48, v21, s30, v48
    v_dot2_f32_bf16 v50, v21, v37, v50
    v_dot2_f32_bf16 v49, v22, v22, v49
    v_dot2_f32_bf16 v48, v22, s30, v48
    v_dot2_f32_bf16 v50, v22, v38, v50
    v_dot2_f32_bf16 v49, v23, v23, v49
    v_dot2_f32_bf16 v48, v23, s30, v48
    v_dot2_f32_bf16 v50, v23, v39, v50
    s_waitcnt vmcnt(1)
    s_nop 0
    v_dot2_f32_bf16 v49, v24, v24, v49
    v_dot2_f32_bf16 v48, v24, s30, v48
    v_dot2_f32_bf16 v50, v24, v40, v50
    v_dot2_f32_bf16 v49, v25, v25, v49
    v_dot2_f32_bf16 v48, v25, s30, v48
    v_dot2_f32_bf16 v50, v25, v41, v50
    v_dot2_f32_bf16 v49, v26, v26, v49
    v_dot2_f32_bf16 v48, v26, s30, v48
    v_dot2_f32_bf16 v50, v26, v42, v50
    v_dot2_f32_bf16 v49, v27, v27, v49
    v_dot2_f32_bf16 v48, v27, s30, v48
    v_dot2_f32_bf16 v50, v27, v43, v50
    s_nop 0
    s_waitcnt vmcnt(0)
    v_dot2_f32_bf16 v49, v28, v28, v49
    v_dot2_f32_bf16 v48, v28, s30, v48
    v_dot2_f32_bf16 v50, v28, v44, v50
    v_dot2_f32_bf16 v49, v29, v29, v49
    v_dot2_f32_bf16 v48, v29, s30, v48
    v_dot2_f32_bf16 v50, v29, v45, v50
    v_dot2_f32_bf16 v49, v30, v30, v49
    v_dot2_f32_bf16 v48, v30, s30, v48
    v_dot2_f32_bf16 v50, v30, v46, v50
    v_dot2_f32_bf16 v49, v31, v31, v49
    v_dot2_f32_bf16 v48, v31, s30, v48
    v_dot2_f32_bf16 v50, v31, v47, v50
    v_add_f32_dpp v51, v51, v51 quad_perm:[1,0,3,2] row_mask:0xf bank_mask:0xf
    v_add_f32_dpp v49, v49, v49 quad_perm:[1,0,3,2] row_mask:0xf bank_mask:0xf
    v_add_f32_dpp v48, v48, v48 quad_perm:[1,0,3,2] row_mask:0xf bank_mask:0xf
    v_add_f32_dpp v50, v50, v50 quad_perm:[1,0,3,2] row_mask:0xf bank_mask:0xf
    v_add_f32_dpp v51, v51, v51 quad_perm:[2,3,0,1] row_mask:0xf bank_mask:0xf
    v_add_f32_dpp v49, v49, v49 quad_perm:[2,3,0,1] row_mask:0xf bank_mask:0xf
    v_add_f32_dpp v48, v48, v48 quad_perm:[2,3,0,1] row_mask:0xf bank_mask:0xf
    v_add_f32_dpp v50, v50, v50 quad_perm:[2,3,0,1] row_mask:0xf bank_mask:0xf
    v_add_f32_dpp v51, v51, v51 row_half_mirror row_mask:0xf bank_mask:0xf
    v_add_f32_dpp v49, v49, v49 row_half_mirror row_mask:0xf bank_mask:0xf
    v_add_f32_dpp v48, v48, v48 row_half_mirror row_mask:0xf bank_mask:0xf
    v_add_f32_dpp v50, v50, v50 row_half_mirror row_mask:0xf bank_mask:0xf
    v_and_b32 v49, 0x7fffffff, v49
    s_mov_b32 exec_lo, 0x01010101
    s_mov_b32 exec_hi, 0x01010101
    ds_write_b128 v120, v[48:51] offset:256
    s_mov_b64 exec, -1
    s_mov_b32 s46, 0
    ds_read_b128 v[60:63], v117 offset:256
    ds_read_b128 v[64:67], v117 offset:384
    ds_read_b128 v[68:71], v117 offset:512
    ds_read_b128 v[72:75], v117 offset:640
    v_lshlrev_b32_e64 v80, 16, v16
    v_and_b32 v81, 0xffff0000, v16
    v_lshlrev_b32_e64 v82, 16, v17
    v_and_b32 v83, 0xffff0000, v17
    v_lshlrev_b32_e64 v84, 16, v18
    v_and_b32 v85, 0xffff0000, v18
    v_lshlrev_b32_e64 v86, 16, v19
    v_and_b32 v87, 0xffff0000, v19
    v_lshlrev_b32_e64 v88, 16, v20
    v_and_b32 v89, 0xffff0000, v20
    v_lshlrev_b32_e64 v90, 16, v21
    v_and_b32 v91, 0xffff0000, v21
    v_lshlrev_b32_e64 v92, 16, v22
    v_and_b32 v93, 0xffff0000, v22
    s_branch L_spc_3
    s_nop 0
L_sp_1:
    ds_read_b128 v[60:63], v117 offset:256
    ds_read_b128 v[64:67], v117 offset:384
    ds_read_b128 v[68:71], v117 offset:512
    ds_read_b128 v[72:75], v117 offset:640
L_spc_3:
    s_waitcnt lgkmcnt(0)
    v_or3_b32 v52, v61, v65, v69
    v_or_b32 v52, v52, v73
    v_cmp_gt_i32_e64 vcc, 0, v52
    s_cbranch_vccz L_spd_2
    s_add_u32 s46, s46, 1
    s_cmp_lt_u32 s46, 400000
    s_cbranch_scc1 L_sp_1
    s_branch L_end
L_spd_2:
    v_pk_add_f32 v[60:61], v[60:61], v[64:65]
    v_pk_add_f32 v[68:69], v[68:69], v[72:73]
    v_pk_add_f32 v[62:63], v[62:63], v[66:67]
    v_pk_add_f32 v[70:71], v[70:71], v[74:75]
    v_pk_add_f32 v[60:61], v[60:61], v[68:69]
    v_pk_add_f32 v[62:63], v[62:63], v[70:71]
    v_mul_f32 v48, 0x3a800000, v60
    v_mul_f32 v49, 0x3a800000, v61
    v_fma_f32 v49, -v48, v48, v49
    v_max_f32_e64 v49, 0, v49
    v_cvt_pk_bf16_f32 v54, v48, v49
    v_and_b32 v49, 0xffff0000, v54
    v_add_f32 v49, 0x3727c5ac, v49
    v_cvt_pk_bf16_f32 v49, v49, v49
    v_and_b32 v49, 0xffff0000, v49
    v_sqrt_f32_e64 v49, v49
    v_lshlrev_b32_e64 v54, 16, v54
    v_cvt_pk_bf16_f32 v52, v48, v49
    v_and_b32 v49, 0xffff0000, v52
    v_rcp_f32_e64 v55, v49
    v_fma_f32 v53, -v54, v63, v62
    s_cmp_lg_u32 s34, 0
    s_cbranch_scc1 L_nohdr_4
    v_mul_f32 v53, v53, v55
    s_brev_b32 s40, 1
    v_cvt_pk_bf16_f32 v53, v53, v53
    v_ashrrev_i32_e64 v49, 31, v53
    v_bitop3_b32 v53, v53, v49, s40 bitop3:0x1e
    v_and_or_b32 v53, v53, s31, v119
    s_mov_b32 exec_lo, 0x01010101
    s_mov_b32 exec_hi, 0x01010101
    global_store_dwordx2 v118, v[52:53], s[58:59] sc1
    s_mov_b64 exec, -1
L_nohdr_4:
    v_mul_f32 v56, 0xbfb8aa3b, v55
    v_lshlrev_b32 v94, 16, v23
    v_and_b32 v95, 0xffff0000, v23
    v_mul_f32 v58, -v54, v56
    v_lshlrev_b32_e64 v96, 16, v24
    v_and_b32 v97, 0xffff0000, v24
    v_lshlrev_b32_e64 v98, 16, v25
    v_and_b32 v99, 0xffff0000, v25
    v_lshlrev_b32_e64 v100, 16, v26
    v_and_b32 v101, 0xffff0000, v26
    v_lshlrev_b32_e64 v102, 16, v27
    v_and_b32 v103, 0xffff0000, v27
    v_lshlrev_b32_e64 v104, 16, v28
    v_and_b32 v105, 0xffff0000, v28
    v_lshlrev_b32_e64 v106, 16, v29
    v_and_b32 v107, 0xffff0000, v29
    v_lshlrev_b32_e64 v108, 16, v30
    v_and_b32 v109, 0xffff0000, v30
    v_lshlrev_b32_e64 v110, 16, v31
    v_and_b32 v111, 0xffff0000, v31
    v_pk_fma_f32 v[80:81], v[80:81], v[56:57], v[58:59] op_sel_hi:[1,0,0]
    v_pk_fma_f32 v[82:83], v[82:83], v[56:57], v[58:59] op_sel_hi:[1,0,0]
    v_pk_fma_f32 v[84:85], v[84:85], v[56:57], v[58:59] op_sel_hi:[1,0,0]
    v_pk_fma_f32 v[86:87], v[86:87], v[56:57], v[58:59] op_sel_hi:[1,0,0]
    v_cvt_pk_f16_f32 v16, v80, v81
    v_cvt_pk_f16_f32 v17, v82, v83
    v_cvt_pk_f16_f32 v18, v84, v85
    v_cvt_pk_f16_f32 v19, v86, v87
    ds_write_b128 v114, v[16:19] offset:0
    v_pk_fma_f32 v[88:89], v[88:89], v[56:57], v[58:59] op_sel_hi:[1,0,0]
    v_pk_fma_f32 v[90:91], v[90:91], v[56:57], v[58:59] op_sel_hi:[1,0,0]
    v_pk_fma_f32 v[92:93], v[92:93], v[56:57], v[58:59] op_sel_hi:[1,0,0]
    v_pk_fma_f32 v[94:95], v[94:95], v[56:57], v[58:59] op_sel_hi:[1,0,0]
    v_cvt_pk_f16_f32 v20, v88, v89
    v_cvt_pk_f16_f32 v21, v90, v91
    v_cvt_pk_f16_f32 v22, v92, v93
    v_cvt_pk_f16_f32 v23, v94, v95
    ds_write_b128 v114, v[20:23] offset:128
    v_pk_fma_f32 v[96:97], v[96:97], v[56:57], v[58:59] op_sel_hi:[1,0,0]
    v_pk_fma_f32 v[98:99], v[98:99], v[56:57], v[58:59] op_sel_hi:[1,0,0]
    v_pk_fma_f32 v[100:101], v[100:101], v[56:57], v[58:59] op_sel_hi:[1,0,0]
    v_pk_fma_f32 v[102:103], v[102:103], v[56:57], v[58:59] op_sel_hi:[1,0,0]
    v_cvt_pk_f16_f32 v24, v96, v97
    v_cvt_pk_f16_f32 v25, v98, v99
    v_cvt_pk_f16_f32 v26, v100, v101
    v_cvt_pk_f16_f32 v27, v102, v103
    ds_write_b128 v114, v[24:27] offset:256
    v_pk_fma_f32 v[104:105], v[104:105], v[56:57], v[58:59] op_sel_hi:[1,0,0]
    v_pk_fma_f32 v[106:107], v[106:107], v[56:57], v[58:59] op_sel_hi:[1,0,0]
    v_pk_fma_f32 v[108:109], v[108:109], v[56:57], v[58:59] op_sel_hi:[1,0,0]
    v_pk_fma_f32 v[110:111], v[110:111], v[56:57], v[58:59] op_sel_hi:[1,0,0]
    v_cvt_pk_f16_f32 v28, v104, v105
    v_cvt_pk_f16_f32 v29, v106, v107
    v_cvt_pk_f16_f32 v30, v108, v109
    v_cvt_pk_f16_f32 v31, v110, v111
    ds_write_b128 v114, v[28:31] offset:384
    ds_read_b64_tr_b16 v[32:33], v115 offset:0
    ds_read_b64_tr_b16 v[34:35], v115 offset:18496
    ds_read_b64_tr_b16 v[36:37], v115 offset:16
    ds_read_b64_tr_b16 v[38:39], v115 offset:18512
    ds_read_b64_tr_b16 v[40:41], v115 offset:32
    ds_read_b64_tr_b16 v[42:43], v115 offset:18528
    ds_read_b64_tr_b16 v[44:45], v115 offset:48
    ds_read_b64_tr_b16 v[46:47], v115 offset:18544
    s_mov_b32 s22, 0x00030003
    s_nop 0
    s_waitcnt lgkmcnt(6)
    v_bfi_b32 v32, s22, v12, v32
    v_bfi_b32 v34, s22, v14, v34
    global_store_dwordx4 v116, v[32:35], s[52:53] offset:0 sc1
    s_add_u32 s52, s52, 32768
    s_addc_u32 s53, s53, 0
    s_waitcnt lgkmcnt(4)
    v_bfi_b32 v36, s22, v12, v36
    v_bfi_b32 v38, s22, v14, v38
    global_store_dwordx4 v116, v[36:39], s[52:53] offset:0 sc1
    s_add_u32 s52, s52, 32768
    s_addc_u32 s53, s53, 0
    s_waitcnt lgkmcnt(2)
    v_bfi_b32 v40, s22, v12, v40
    v_bfi_b32 v42, s22, v14, v42
    global_store_dwordx4 v116, v[40:43], s[52:53] offset:0 sc1
    s_add_u32 s52, s52, 32768
    s_addc_u32 s53, s53, 0
    s_waitcnt lgkmcnt(0)
    v_bfi_b32 v44, s22, v12, v44
    v_bfi_b32 v46, s22, v14, v46
    global_store_dwordx4 v116, v[44:47], s[52:53] offset:0 sc1
    v_lshrrev_b32 v80, 3, v7
    v_sub_u32 v80, 0xffff, v80
    s_lshl_b32 s40, s21, 8
    s_sub_u32 s40, 0xffff, s40
    v_lshlrev_b32 v84, 1, v1
    v_sub_u32 v84, s40, v84
    v_subrev_u32 v81, 1, v80
    v_subrev_u32 v85, 1, v84
    v_subrev_u32_e64 v82, 2, v80
    v_subrev_u32 v86, 128, v84
    v_subrev_u32_e64 v83, 3, v80
    v_subrev_u32 v87, 129, v84
    v_mov_b32 v76, 1
    v_lshrrev_b32 v52, 4, v1
    v_add_u32_e64 v52, v52, v10
    v_lshlrev_b32_e64 v52, 3, v52
    s_mov_b32 s46, 0
L_sp_5:
    ds_read_b32 v48, v3 offset:80
    s_waitcnt lgkmcnt(0)
    v_cmp_gt_u32_e64 vcc, 4, v48
    s_cbranch_vccz L_spd_6
    s_add_u32 s46, s46, 1
    s_sleep 2
    s_cmp_lt_u32 s46, 400000
    s_cbranch_scc1 L_sp_5
    s_branch L_end
    s_nop 0
L_spd_6:
    global_load_dwordx4 v[60:63], v7, s[50:51] offset:0
    global_load_dwordx4 v[64:67], v7, s[50:51] offset:16
    global_load_dwordx4 v[68:71], v2, s[60:61] offset:0
    global_load_dwordx4 v[72:75], v2, s[60:61] offset:1024
    s_cmp_ge_u32 s34, 2
    s_cbranch_scc1 L_late_9
    s_mov_b32 s46, 0
L_sp_10:
    ds_read_b32 v48, v3 offset:84
    s_waitcnt lgkmcnt(0)
    v_cmp_gt_u32 vcc, 4, v48
    s_cbranch_vccz L_spd_11
    s_add_u32 s46, s46, 1
    s_sleep 2
    s_cmp_lt_u32 s46, 400000
    s_cbranch_scc1 L_sp_10
    s_branch L_end
L_spd_11:
    s_cmp_ge_u32 s21, 6
    s_cbranch_scc1 L_nob_12
    global_load_dwordx4 v[32:35], v2, s[56:57] offset:0 sc1
    global_load_dwordx4 v[36:39], v2, s[56:57] offset:1024 sc1
    global_load_dwordx4 v[40:43], v2, s[56:57] offset:2048 sc1
    global_load_dwordx4 v[44:47], v2, s[56:57] offset:3072 sc1
L_nob_12:
    global_load_dwordx4 v[16:19], v2, s[54:55] offset:0 sc1
    global_load_dwordx4 v[20:23], v2, s[54:55] offset:1024 sc1
    global_load_dwordx4 v[24:27], v2, s[54:55] offset:2048 sc1
    global_load_dwordx4 v[28:31], v2, s[54:55] offset:3072 sc1
    s_mov_b32 s46, 0
    s_waitcnt vmcnt(8)
    s_branch L_rc_7
    s_nop 0
L_late_9:
    s_mov_b32 s46, 0
    s_waitcnt vmcnt(0)
L_rc_7:
    v_xor_b32_e64 v50, v119, v61
    v_bitop3_b32 v50, v50, v63, v119 bitop3:0xf6
    v_bitop3_b32 v50, v50, v65, v119 bitop3:0xf6
    v_bitop3_b32 v50, v50, v67, v119 bitop3:0xf6
    v_bitop3_b32 v50, v50, v69, v119 bitop3:0xf6
    v_bitop3_b32 v50, v50, v71, v119 bitop3:0xf6
    v_bitop3_b32 v50, v50, v73, v119 bitop3:0xf6
    v_bitop3_b32 v50, v50, v75, v119 bitop3:0xf6
    v_and_b32 v50, 0xffff, v50
    v_cmp_ne_u32 vcc, 0, v50
    s_cbranch_vccz L_ro_8
    global_load_dwordx4 v[60:63], v7, s[50:51] offset:0 sc1
    global_load_dwordx4 v[64:67], v7, s[50:51] offset:16 sc1
    global_load_dwordx4 v[68:71], v2, s[60:61] offset:0 sc1
    global_load_dwordx4 v[72:75], v2, s[60:61] offset:1024 sc1
    s_add_u32 s46, s46, 1
    s_cmp_lt_u32 s46, 50000
    s_waitcnt vmcnt(0)
    s_cbranch_scc1 L_rc_7
    s_branch L_end
L_ro_8:
    v_and_or_b32 v80, v61, s31, v80
    v_and_or_b32 v81, v63, s31, v81
    v_and_or_b32 v82, v65, s31, v82
    v_and_or_b32 v83, v67, s31, v83
    v_and_or_b32 v84, v69, s31, v84
    v_and_or_b32 v85, v71, s31, v85
    v_and_or_b32 v86, v73, s31, v86
    v_and_or_b32 v87, v75, s31, v87
    v_max3_u32 v48, v80, v81, v82
    v_med3_u32 v49, v80, v81, v82
    v_med3_u32 v49, v48, v49, v83
    v_max_u32 v48, v48, v83
    v_med3_u32 v49, v48, v49, v84
    v_max_u32 v48, v48, v84
    v_med3_u32 v49, v48, v49, v85
    v_max_u32_e64 v48, v48, v85
    v_med3_u32 v49, v48, v49, v86
    v_max_u32_e64 v48, v48, v86
    v_med3_u32 v49, v48, v49, v87
    v_max_u32 v48, v48, v87
    s_nop 0
    v_max_u32_dpp v51, v49, v49 quad_perm:[1,0,3,2] row_mask:0xf bank_mask:0xf
    v_min_u32_dpp v50, v48, v48 quad_perm:[1,0,3,2] row_mask:0xf bank_mask:0xf
    v_max_u32 v49, v50, v51
    v_max_u32_dpp v48, v48, v48 quad_perm:[1,0,3,2] row_mask:0xf bank_mask:0xf
    s_nop 0
    v_max_u32_dpp v51, v49, v49 quad_perm:[2,3,0,1] row_mask:0xf bank_mask:0xf
    v_min_u32_dpp v50, v48, v48 quad_perm:[2,3,0,1] row_mask:0xf bank_mask:0xf
    v_max_u32 v49, v50, v51
    v_max_u32_dpp v48, v48, v48 quad_perm:[2,3,0,1] row_mask:0xf bank_mask:0xf
    s_nop 0
    v_max_u32_dpp v51, v49, v49 row_half_mirror row_mask:0xf bank_mask:0xf
    v_min_u32_dpp v50, v48, v48 row_half_mirror row_mask:0xf bank_mask:0xf
    v_max_u32 v49, v50, v51
    v_max_u32_dpp v48, v48, v48 row_half_mirror row_mask:0xf bank_mask:0xf
    s_nop 0
    v_max_u32_dpp v51, v49, v49 row_mirror row_mask:0xf bank_mask:0xf
    v_min_u32_dpp v50, v48, v48 row_mirror row_mask:0xf bank_mask:0xf
    v_max_u32_e64 v49, v50, v51
    v_max_u32_dpp v48, v48, v48 row_mirror row_mask:0xf bank_mask:0xf
    s_mov_b32 exec_lo, 0x00010001
    s_mov_b32 exec_hi, 0x00010001
    ds_write_b64 v52, v[48:49] offset:128
    s_mov_b64 exec, -1
    s_cmp_lt_u32 s34, 2
    s_cbranch_scc1 L_early_13
    s_mov_b32 s46, 0
L_sp_14:
    ds_read_b32 v48, v3 offset:92
    s_waitcnt lgkmcnt(0)
    v_cmp_gt_u32 vcc, 4, v48
    s_cbranch_vccz L_spd_15
    s_add_u32 s46, s46, 1
    s_sleep 1
    s_cmp_lt_u32 s46, 400000
    s_cbranch_scc1 L_sp_14
    s_branch L_end
    s_nop 0
L_spd_15:
    s_cmp_ge_u32 s21, 6
    s_cbranch_scc1 L_nob_16
    global_load_dwordx4 v[32:35], v2, s[56:57] offset:0 sc1
    global_load_dwordx4 v[36:39], v2, s[56:57] offset:1024 sc1
    global_load_dwordx4 v[40:43], v2, s[56:57] offset:2048 sc1
    global_load_dwordx4 v[44:47], v2, s[56:57] offset:3072 sc1
L_nob_16:
    global_load_dwordx4 v[16:19], v2, s[54:55] offset:0 sc1
    global_load_dwordx4 v[20:23], v2, s[54:55] offset:1024 sc1
    global_load_dwordx4 v[24:27], v2, s[54:55] offset:2048 sc1
    global_load_dwordx4 v[28:31], v2, s[54:55] offset:3072 sc1
L_early_13:
    v_and_b32 v92, 0xffff0000, v60
    v_lshlrev_b32_e64 v88, 16, v60
    v_mul_f32 v92, 0xbf317218, v92
    v_and_b32 v93, 0xffff0000, v62
    v_lshlrev_b32_e64 v89, 16, v62
    v_mul_f32 v93, 0xbf317218, v93
    v_and_b32 v94, 0xffff0000, v64
    v_lshlrev_b32_e64 v90, 16, v64
    v_mul_f32 v94, 0xbf317218, v94
    v_and_b32 v95, 0xffff0000, v66
    v_lshlrev_b32_e64 v91, 16, v66
    v_mul_f32 v95, 0xbf317218, v95
    s_mov_b32 s46, 0
L_pa_17:
    v_mov_b32_e64 v57, 0
    s_cmp_ge_u32 s21, 6
    s_cbranch_scc1 L_nob_19
    s_waitcnt vmcnt(7)
    ds_write_b128 v9, v[32:35] offset:0
    v_bitop3_b32 v57, v57, v32, v12 bitop3:0xf6
    v_bitop3_b32 v57, v57, v34, v14 bitop3:0xf6
    s_waitcnt vmcnt(6)
    ds_write_b128 v9, v[36:39] offset:128
    v_bitop3_b32 v57, v57, v36, v12 bitop3:0xf6
    v_bitop3_b32 v57, v57, v38, v14 bitop3:0xf6
    s_waitcnt vmcnt(5)
    ds_write_b128 v9, v[40:43] offset:256
    v_bitop3_b32 v57, v57, v40, v12 bitop3:0xf6
    v_bitop3_b32 v57, v57, v42, v14 bitop3:0xf6
    s_waitcnt vmcnt(4)
    ds_write_b128 v9, v[44:47] offset:384
    v_bitop3_b32 v57, v57, v44, v12 bitop3:0xf6
    v_bitop3_b32 v57, v57, v46, v14 bitop3:0xf6
L_nob_19:
    s_waitcnt vmcnt(3)
    ds_write_b128 v8, v[16:19] offset:0
    v_bitop3_b32 v57, v57, v16, v12 bitop3:0xf6
    v_bitop3_b32 v57, v57, v18, v14 bitop3:0xf6
    s_waitcnt vmcnt(2)
    ds_write_b128 v8, v[20:23] offset:128
    v_bitop3_b32 v57, v57, v20, v12 bitop3:0xf6
    v_bitop3_b32 v57, v57, v22, v14 bitop3:0xf6
    s_waitcnt vmcnt(1)
    ds_write_b128 v8, v[24:27] offset:256
    v_bitop3_b32 v57, v57, v24, v12 bitop3:0xf6
    v_bitop3_b32 v57, v57, v26, v14 bitop3:0xf6
    s_nop 0
    s_waitcnt vmcnt(0)
    ds_write_b128 v8, v[28:31] offset:384
    v_bitop3_b32 v57, v57, v28, v12 bitop3:0xf6
    v_bitop3_b32 v57, v57, v30, v14 bitop3:0xf6
    v_and_b32 v57, 0x00030003, v57
    v_cmp_ne_u32 vcc, 0, v57
    s_cbranch_vccz L_po_18
    s_cmp_ge_u32 s21, 6
    s_cbranch_scc1 L_nob_20
    global_load_dwordx4 v[32:35], v2, s[56:57] offset:0 sc1
    global_load_dwordx4 v[36:39], v2, s[56:57] offset:1024 sc1
    global_load_dwordx4 v[40:43], v2, s[56:57] offset:2048 sc1
    global_load_dwordx4 v[44:47], v2, s[56:57] offset:3072 sc1
L_nob_20:
    global_load_dwordx4 v[16:19], v2, s[54:55] offset:0 sc1
    global_load_dwordx4 v[20:23], v2, s[54:55] offset:1024 sc1
    global_load_dwordx4 v[24:27], v2, s[54:55] offset:2048 sc1
    global_load_dwordx4 v[28:31], v2, s[54:55] offset:3072 sc1
    s_add_u32 s46, s46, 1
    s_cmp_lt_u32 s46, 50000
    s_cbranch_scc1 L_pa_17
    s_branch L_end
    s_nop 0
L_po_18:
    v_and_b32 v57, 8, v10
    s_mov_b64 exec, 1
    ds_add_u32 v57, v76 offset:48
    s_mov_b64 exec, -1
    s_setprio 0
    ds_read_b64 v[112:113], v6 offset:0
    ds_read_b64 v[114:115], v6 offset:4624
    ds_read_b64 v[116:117], v6 offset:9248
    ds_read_b64 v[118:119], v6 offset:13872
    ds_read_b64 v[120:121], v6 offset:18496
    ds_read_b64 v[122:123], v6 offset:23120
    ds_read_b64 v[124:125], v6 offset:27744
    ds_read_b64 v[126:127], v6 offset:32368
    s_mov_b32 s46, 0
L_sp_21:
    ds_read_b128 v[80:83], v3 offset:0
    ds_read_b128 v[84:87], v3 offset:16
    s_waitcnt lgkmcnt(0)
    v_min3_u32 v96, v80, v81, v82
    v_min3_u32 v96, v96, v83, v84
    v_min3_u32 v96, v96, v85, v86
    v_min_u32 v96, v96, v87
    v_cmp_eq_u32 vcc, 0, v96
    s_cbranch_vccz L_spd_22
    s_add_u32 s46, s46, 1
    s_sleep 1
    s_cmp_lt_u32 s46, 400000
    s_cbranch_scc1 L_sp_21
    s_branch L_end
L_spd_22:
    v_exp_f16 v96, v112
    v_exp_f16_sdwa v97, v112 dst_sel:DWORD dst_unused:UNUSED_PAD src0_sel:WORD_1
    v_exp_f16_e64 v98, v113
    v_exp_f16_sdwa v99, v113 dst_sel:DWORD dst_unused:UNUSED_PAD src0_sel:WORD_1
    v_fma_mix_f32 v96, v96, v80, v80 op_sel:[0,0,0] op_sel_hi:[1,0,0]
    v_fma_mix_f32 v97, v97, v80, v80 op_sel:[0,0,0] op_sel_hi:[1,0,0]
    v_fma_mix_f32 v98, v98, v80, v80 op_sel:[0,0,0] op_sel_hi:[1,0,0]
    v_fma_mix_f32 v99, v99, v80, v80 op_sel:[0,0,0] op_sel_hi:[1,0,0]
    v_rcp_f32 v16, v96
    v_rcp_f32 v17, v97
    v_rcp_f32 v18, v98
    v_rcp_f32 v19, v99
    v_exp_f16 v96, v114
    v_exp_f16_sdwa v97, v114 dst_sel:DWORD dst_unused:UNUSED_PAD src0_sel:WORD_1
    v_exp_f16 v98, v115
    v_exp_f16_sdwa v99, v115 dst_sel:DWORD dst_unused:UNUSED_PAD src0_sel:WORD_1
    v_fma_mix_f32 v96, v96, v81, v81 op_sel:[0,0,0] op_sel_hi:[1,0,0]
    v_fma_mix_f32 v97, v97, v81, v81 op_sel:[0,0,0] op_sel_hi:[1,0,0]
    v_fma_mix_f32 v98, v98, v81, v81 op_sel:[0,0,0] op_sel_hi:[1,0,0]
    v_fma_mix_f32 v99, v99, v81, v81 op_sel:[0,0,0] op_sel_hi:[1,0,0]
    v_rcp_f32 v20, v96
    v_rcp_f32 v21, v97
    v_rcp_f32 v22, v98
    v_rcp_f32 v23, v99
    v_exp_f16_e64 v96, v116
    v_exp_f16_sdwa v97, v116 dst_sel:DWORD dst_unused:UNUSED_PAD src0_sel:WORD_1
    v_exp_f16_e64 v98, v117
    v_exp_f16_sdwa v99, v117 dst_sel:DWORD dst_unused:UNUSED_PAD src0_sel:WORD_1
    v_fma_mix_f32 v96, v96, v82, v82 op_sel:[0,0,0] op_sel_hi:[1,0,0]
    v_fma_mix_f32 v97, v97, v82, v82 op_sel:[0,0,0] op_sel_hi:[1,0,0]
    v_fma_mix_f32 v98, v98, v82, v82 op_sel:[0,0,0] op_sel_hi:[1,0,0]
    v_fma_mix_f32 v99, v99, v82, v82 op_sel:[0,0,0] op_sel_hi:[1,0,0]
    v_rcp_f32 v24, v96
    v_rcp_f32 v25, v97
    v_rcp_f32 v26, v98
    v_rcp_f32 v27, v99
    v_exp_f16_e64 v96, v118
    v_exp_f16_sdwa v97, v118 dst_sel:DWORD dst_unused:UNUSED_PAD src0_sel:WORD_1
    v_exp_f16_e64 v98, v119
    v_exp_f16_sdwa v99, v119 dst_sel:DWORD dst_unused:UNUSED_PAD src0_sel:WORD_1
    v_fma_mix_f32 v96, v96, v83, v83 op_sel:[0,0,0] op_sel_hi:[1,0,0]
    v_fma_mix_f32 v97, v97, v83, v83 op_sel:[0,0,0] op_sel_hi:[1,0,0]
    v_fma_mix_f32 v98, v98, v83, v83 op_sel:[0,0,0] op_sel_hi:[1,0,0]
    v_fma_mix_f32 v99, v99, v83, v83 op_sel:[0,0,0] op_sel_hi:[1,0,0]
    v_rcp_f32 v28, v96
    v_rcp_f32 v29, v97
    v_rcp_f32 v30, v98
    v_rcp_f32 v31, v99
    v_exp_f16_e64 v96, v120
    v_exp_f16_sdwa v97, v120 dst_sel:DWORD dst_unused:UNUSED_PAD src0_sel:WORD_1
    v_exp_f16_e64 v98, v121
    v_exp_f16_sdwa v99, v121 dst_sel:DWORD dst_unused:UNUSED_PAD src0_sel:WORD_1
    v_fma_mix_f32 v96, v96, v84, v84 op_sel:[0,0,0] op_sel_hi:[1,0,0]
    v_fma_mix_f32 v97, v97, v84, v84 op_sel:[0,0,0] op_sel_hi:[1,0,0]
    v_fma_mix_f32 v98, v98, v84, v84 op_sel:[0,0,0] op_sel_hi:[1,0,0]
    v_fma_mix_f32 v99, v99, v84, v84 op_sel:[0,0,0] op_sel_hi:[1,0,0]
    v_rcp_f32 v32, v96
    v_rcp_f32 v33, v97
    v_rcp_f32 v34, v98
    v_rcp_f32 v35, v99
    v_exp_f16_e64 v96, v122
    v_exp_f16_sdwa v97, v122 dst_sel:DWORD dst_unused:UNUSED_PAD src0_sel:WORD_1
    v_exp_f16_e64 v98, v123
    v_exp_f16_sdwa v99, v123 dst_sel:DWORD dst_unused:UNUSED_PAD src0_sel:WORD_1
    v_fma_mix_f32 v96, v96, v85, v85 op_sel:[0,0,0] op_sel_hi:[1,0,0]
    v_fma_mix_f32 v97, v97, v85, v85 op_sel:[0,0,0] op_sel_hi:[1,0,0]
    v_fma_mix_f32 v98, v98, v85, v85 op_sel:[0,0,0] op_sel_hi:[1,0,0]
    v_fma_mix_f32 v99, v99, v85, v85 op_sel:[0,0,0] op_sel_hi:[1,0,0]
    v_rcp_f32 v36, v96
    v_rcp_f32 v37, v97
    v_rcp_f32 v38, v98
    v_rcp_f32 v39, v99
    v_exp_f16_e64 v96, v124
    v_exp_f16_sdwa v97, v124 dst_sel:DWORD dst_unused:UNUSED_PAD src0_sel:WORD_1
    v_exp_f16_e64 v98, v125
    v_exp_f16_sdwa v99, v125 dst_sel:DWORD dst_unused:UNUSED_PAD src0_sel:WORD_1
    v_fma_mix_f32 v96, v96, v86, v86 op_sel:[0,0,0] op_sel_hi:[1,0,0]
    v_fma_mix_f32 v97, v97, v86, v86 op_sel:[0,0,0] op_sel_hi:[1,0,0]
    v_fma_mix_f32 v98, v98, v86, v86 op_sel:[0,0,0] op_sel_hi:[1,0,0]
    v_fma_mix_f32 v99, v99, v86, v86 op_sel:[0,0,0] op_sel_hi:[1,0,0]
    v_rcp_f32 v40, v96
    v_rcp_f32 v41, v97
    v_rcp_f32 v42, v98
    v_rcp_f32 v43, v99
    v_exp_f16_e64 v96, v126
    v_exp_f16_sdwa v97, v126 dst_sel:DWORD dst_unused:UNUSED_PAD src0_sel:WORD_1
    v_exp_f16_e64 v98, v127
    v_exp_f16_sdwa v99, v127 dst_sel:DWORD dst_unused:UNUSED_PAD src0_sel:WORD_1
    v_fma_mix_f32 v96, v96, v87, v87 op_sel:[0,0,0] op_sel_hi:[1,0,0]
    v_fma_mix_f32 v97, v97, v87, v87 op_sel:[0,0,0] op_sel_hi:[1,0,0]
    v_fma_mix_f32 v98, v98, v87, v87 op_sel:[0,0,0] op_sel_hi:[1,0,0]
    v_fma_mix_f32 v99, v99, v87, v87 op_sel:[0,0,0] op_sel_hi:[1,0,0]
    v_rcp_f32 v44, v96
    v_rcp_f32 v45, v97
    v_rcp_f32_e64 v46, v98
    v_rcp_f32_e64 v47, v99
    s_mov_b32 s46, 0
L_sp_23:
    ds_read_b64 v[100:101], v3 offset:32
    s_waitcnt lgkmcnt(0)
    v_cmp_eq_u32 vcc, 0, v100
    s_cbranch_vccz L_spd_24
    s_add_u32 s46, s46, 1
    s_sleep 1
    s_cmp_lt_u32 s46, 400000
    s_cbranch_scc1 L_sp_23
    s_branch L_end
L_spd_24:
    s_mov_b64 s[4:5], -1
    s_mov_b64 s[6:7], -1
    s_mov_b64 s[8:9], -1
    s_mov_b64 s[10:11], -1
    v_readfirstlane_b32 s40, v100
    s_andn2_b32 s40, 2047, s40
    s_lshr_b32 s41, s40, 8
    s_cmp_lg_u32 s41, s20
    s_cbranch_scc1 L_nomk_25
    s_bfe_u32 s41, s40, 0x20002
    s_bfe_u32 s42, s40, 0x40004
    s_lshl4_add_u32 s41, s41, s42
    s_lshl_b64 s[42:43], 1, s41
    s_and_b32 s40, s40, 3
    s_cmp_eq_u32 s40, 0
    s_cselect_b64 s[44:45], s[42:43], 0
    s_andn2_b64 s[4:5], s[4:5], s[44:45]
    s_cmp_eq_u32 s40, 1
    s_cselect_b64 s[44:45], s[42:43], 0
    s_andn2_b64 s[6:7], s[6:7], s[44:45]
    s_cmp_eq_u32 s40, 2
    s_cselect_b64 s[44:45], s[42:43], 0
    s_andn2_b64 s[8:9], s[8:9], s[44:45]
    s_cmp_eq_u32 s40, 3
    s_cselect_b64 s[44:45], s[42:43], 0
    s_andn2_b64 s[10:11], s[10:11], s[44:45]
L_nomk_25:
    v_readfirstlane_b32 s40, v101
    s_andn2_b32 s40, 2047, s40
    s_lshr_b32 s41, s40, 8
    s_cmp_lg_u32 s41, s20
    s_cbranch_scc1 L_nomk_26
    s_bfe_u32 s41, s40, 0x20002
    s_bfe_u32 s42, s40, 0x40004
    s_lshl4_add_u32 s41, s41, s42
    s_lshl_b64 s[42:43], 1, s41
    s_and_b32 s40, s40, 3
    s_cmp_eq_u32 s40, 0
    s_cselect_b64 s[44:45], s[42:43], 0
    s_andn2_b64 s[4:5], s[4:5], s[44:45]
    s_cmp_eq_u32 s40, 1
    s_cselect_b64 s[44:45], s[42:43], 0
    s_andn2_b64 s[6:7], s[6:7], s[44:45]
    s_cmp_eq_u32 s40, 2
    s_cselect_b64 s[44:45], s[42:43], 0
    s_andn2_b64 s[8:9], s[8:9], s[44:45]
    s_cmp_eq_u32 s40, 3
    s_cselect_b64 s[44:45], s[42:43], 0
    s_andn2_b64 s[10:11], s[10:11], s[44:45]
L_nomk_26:
    s_setprio 2
    s_mov_b32 s46, 0
L_sp_27:
    ds_read_b32 v96, v10 offset:64
    s_waitcnt lgkmcnt(0)
    v_cmp_gt_u32 vcc, 8, v96
    s_cbranch_vccz L_spd_28
    s_add_u32 s46, s46, 1
    s_sleep 1
    s_cmp_lt_u32 s46, 400000
    s_cbranch_scc1 L_sp_27
    s_branch L_end
    s_nop 0
L_spd_28:
    ds_read_b64 v[48:49], v5 offset:0
    ds_read_b64 v[50:51], v5 offset:14416
    ds_read_b64 v[52:53], v5 offset:28832
    ds_read_b64 v[54:55], v5 offset:43248
    ds_read_b64 v[56:57], v11 offset:0
    ds_read_b64 v[58:59], v11 offset:14416
    ds_read_b64 v[60:61], v11 offset:28832
    ds_read_b64 v[62:63], v11 offset:43248
    s_waitcnt lgkmcnt(6)
    v_fma_mix_f32 v16, v48, v16, v92 op_sel:[0,0,0] op_sel_hi:[1,0,0]
    v_fma_mix_f32 v20, v50, v20, v92 op_sel:[0,0,0] op_sel_hi:[1,0,0]
    s_waitcnt lgkmcnt(4)
    v_fma_mix_f32 v24, v52, v24, v92 op_sel:[0,0,0] op_sel_hi:[1,0,0]
    v_fma_mix_f32 v28, v54, v28, v92 op_sel:[0,0,0] op_sel_hi:[1,0,0]
    s_waitcnt lgkmcnt(2)
    v_fma_mix_f32 v32, v56, v32, v92 op_sel:[0,0,0] op_sel_hi:[1,0,0]
    v_fma_mix_f32 v36, v58, v36, v92 op_sel:[0,0,0] op_sel_hi:[1,0,0]
    s_waitcnt lgkmcnt(0)
    v_fma_mix_f32 v40, v60, v40, v92 op_sel:[0,0,0] op_sel_hi:[1,0,0]
    v_fma_mix_f32 v44, v62, v44, v92 op_sel:[0,0,0] op_sel_hi:[1,0,0]
    v_fma_mix_f32 v16, v112, v16, v88 op_sel:[0,0,0] op_sel_hi:[1,0,0]
    v_fma_mix_f32 v20, v114, v20, v88 op_sel:[0,0,0] op_sel_hi:[1,0,0]
    v_fma_mix_f32 v24, v116, v24, v88 op_sel:[0,0,0] op_sel_hi:[1,0,0]
    v_fma_mix_f32 v28, v118, v28, v88 op_sel:[0,0,0] op_sel_hi:[1,0,0]
    v_fma_mix_f32 v32, v120, v32, v88 op_sel:[0,0,0] op_sel_hi:[1,0,0]
    v_fma_mix_f32 v36, v122, v36, v88 op_sel:[0,0,0] op_sel_hi:[1,0,0]
    v_fma_mix_f32 v40, v124, v40, v88 op_sel:[0,0,0] op_sel_hi:[1,0,0]
    v_fma_mix_f32 v44, v126, v44, v88 op_sel:[0,0,0] op_sel_hi:[1,0,0]
    v_cvt_pk_bf16_f32 v64, v16, v20
    v_cvt_pk_bf16_f32 v65, v24, v28
    v_cvt_pk_bf16_f32 v66, v32, v36
    v_cvt_pk_bf16_f32 v67, v40, v44
    s_mov_b64 exec, s[4:5]
    global_store_dwordx4 v4, v[64:67], s[28:29] offset:-4096
    s_mov_b64 exec, -1
    v_fma_mix_f32 v17, v48, v17, v93 op_sel:[1,0,0] op_sel_hi:[1,0,0]
    v_fma_mix_f32 v21, v50, v21, v93 op_sel:[1,0,0] op_sel_hi:[1,0,0]
    v_fma_mix_f32 v25, v52, v25, v93 op_sel:[1,0,0] op_sel_hi:[1,0,0]
    v_fma_mix_f32 v29, v54, v29, v93 op_sel:[1,0,0] op_sel_hi:[1,0,0]
    v_fma_mix_f32 v33, v56, v33, v93 op_sel:[1,0,0] op_sel_hi:[1,0,0]
    v_fma_mix_f32 v37, v58, v37, v93 op_sel:[1,0,0] op_sel_hi:[1,0,0]
    v_fma_mix_f32 v41, v60, v41, v93 op_sel:[1,0,0] op_sel_hi:[1,0,0]
    v_fma_mix_f32 v45, v62, v45, v93 op_sel:[1,0,0] op_sel_hi:[1,0,0]
    v_fma_mix_f32 v17, v112, v17, v89 op_sel:[1,0,0] op_sel_hi:[1,0,0]
    v_fma_mix_f32 v21, v114, v21, v89 op_sel:[1,0,0] op_sel_hi:[1,0,0]
    v_fma_mix_f32 v25, v116, v25, v89 op_sel:[1,0,0] op_sel_hi:[1,0,0]
    v_fma_mix_f32 v29, v118, v29, v89 op_sel:[1,0,0] op_sel_hi:[1,0,0]
    v_fma_mix_f32 v33, v120, v33, v89 op_sel:[1,0,0] op_sel_hi:[1,0,0]
    v_fma_mix_f32 v37, v122, v37, v89 op_sel:[1,0,0] op_sel_hi:[1,0,0]
    v_fma_mix_f32 v41, v124, v41, v89 op_sel:[1,0,0] op_sel_hi:[1,0,0]
    v_fma_mix_f32 v45, v126, v45, v89 op_sel:[1,0,0] op_sel_hi:[1,0,0]
    v_cvt_pk_bf16_f32 v68, v17, v21
    v_cvt_pk_bf16_f32 v69, v25, v29
    v_cvt_pk_bf16_f32 v70, v33, v37
    v_cvt_pk_bf16_f32 v71, v41, v45
    s_mov_b64 exec, s[6:7]
    global_store_dwordx4 v4, v[68:71], s[28:29] offset:-2048
    s_mov_b64 exec, -1
    v_fma_mix_f32 v18, v49, v18, v94 op_sel:[0,0,0] op_sel_hi:[1,0,0]
    v_fma_mix_f32 v22, v51, v22, v94 op_sel:[0,0,0] op_sel_hi:[1,0,0]
    v_fma_mix_f32 v26, v53, v26, v94 op_sel:[0,0,0] op_sel_hi:[1,0,0]
    v_fma_mix_f32 v30, v55, v30, v94 op_sel:[0,0,0] op_sel_hi:[1,0,0]
    v_fma_mix_f32 v34, v57, v34, v94 op_sel:[0,0,0] op_sel_hi:[1,0,0]
    v_fma_mix_f32 v38, v59, v38, v94 op_sel:[0,0,0] op_sel_hi:[1,0,0]
    v_fma_mix_f32 v42, v61, v42, v94 op_sel:[0,0,0] op_sel_hi:[1,0,0]
    v_fma_mix_f32 v46, v63, v46, v94 op_sel:[0,0,0] op_sel_hi:[1,0,0]
    v_fma_mix_f32 v18, v113, v18, v90 op_sel:[0,0,0] op_sel_hi:[1,0,0]
    v_fma_mix_f32 v22, v115, v22, v90 op_sel:[0,0,0] op_sel_hi:[1,0,0]
    v_fma_mix_f32 v26, v117, v26, v90 op_sel:[0,0,0] op_sel_hi:[1,0,0]
    v_fma_mix_f32 v30, v119, v30, v90 op_sel:[0,0,0] op_sel_hi:[1,0,0]
    v_fma_mix_f32 v34, v121, v34, v90 op_sel:[0,0,0] op_sel_hi:[1,0,0]
    v_fma_mix_f32 v38, v123, v38, v90 op_sel:[0,0,0] op_sel_hi:[1,0,0]
    v_fma_mix_f32 v42, v125, v42, v90 op_sel:[0,0,0] op_sel_hi:[1,0,0]
    v_fma_mix_f32 v46, v127, v46, v90 op_sel:[0,0,0] op_sel_hi:[1,0,0]
    v_cvt_pk_bf16_f32 v72, v18, v22
    v_cvt_pk_bf16_f32 v73, v26, v30
    v_cvt_pk_bf16_f32 v74, v34, v38
    v_cvt_pk_bf16_f32 v75, v42, v46
    s_mov_b64 exec, s[8:9]
    global_store_dwordx4 v4, v[72:75], s[28:29] offset:0
    s_mov_b64 exec, -1
    v_fma_mix_f32 v19, v49, v19, v95 op_sel:[1,0,0] op_sel_hi:[1,0,0]
    v_fma_mix_f32 v23, v51, v23, v95 op_sel:[1,0,0] op_sel_hi:[1,0,0]
    v_fma_mix_f32 v27, v53, v27, v95 op_sel:[1,0,0] op_sel_hi:[1,0,0]
    v_fma_mix_f32 v31, v55, v31, v95 op_sel:[1,0,0] op_sel_hi:[1,0,0]
    v_fma_mix_f32 v35, v57, v35, v95 op_sel:[1,0,0] op_sel_hi:[1,0,0]
    v_fma_mix_f32 v39, v59, v39, v95 op_sel:[1,0,0] op_sel_hi:[1,0,0]
    v_fma_mix_f32 v43, v61, v43, v95 op_sel:[1,0,0] op_sel_hi:[1,0,0]
    v_fma_mix_f32 v47, v63, v47, v95 op_sel:[1,0,0] op_sel_hi:[1,0,0]
    v_fma_mix_f32 v19, v113, v19, v91 op_sel:[1,0,0] op_sel_hi:[1,0,0]
    v_fma_mix_f32 v23, v115, v23, v91 op_sel:[1,0,0] op_sel_hi:[1,0,0]
    v_fma_mix_f32 v27, v117, v27, v91 op_sel:[1,0,0] op_sel_hi:[1,0,0]
    v_fma_mix_f32 v31, v119, v31, v91 op_sel:[1,0,0] op_sel_hi:[1,0,0]
    v_fma_mix_f32 v35, v121, v35, v91 op_sel:[1,0,0] op_sel_hi:[1,0,0]
    v_fma_mix_f32 v39, v123, v39, v91 op_sel:[1,0,0] op_sel_hi:[1,0,0]
    v_fma_mix_f32 v43, v125, v43, v91 op_sel:[1,0,0] op_sel_hi:[1,0,0]
    v_fma_mix_f32 v47, v127, v47, v91 op_sel:[1,0,0] op_sel_hi:[1,0,0]
    v_cvt_pk_bf16_f32 v76, v19, v23
    v_cvt_pk_bf16_f32 v77, v27, v31
    v_cvt_pk_bf16_f32 v78, v35, v39
    v_cvt_pk_bf16_f32 v79, v43, v47
    s_mov_b64 exec, s[10:11]
    global_store_dwordx4 v4, v[76:79], s[28:29] offset:2048
    s_mov_b64 exec, -1
    s_or_b32 s40, s2, s3
    s_cbranch_scc1 L_fin
    s_add_u32 s40, s47, 1
    v_mov_b32 v5, s40
    s_mov_b64 exec, 1
    global_store_dword v3, v5, s[32:33]
    s_branch L_fin
    s_nop 0
L_exp:
    v_lshrrev_b32 v20, 4, v1
    v_and_b32 v21, 240, v2
    v_lshrrev_b32_e64 v22, 5, v1
    v_and_b32_e64 v23, 1, v20
    v_lshl_add_u32 v4, v22, 4, v23
    v_mul_u32_u24 v4, 7168, v4
    v_add_u32 v4, v4, v21
    s_bitcmp1_b32 s35, 0
    s_cselect_b64 s[48:49], s[24:25], s[22:23]
    s_lshr_b32 s40, s35, 1
    s_lshl2_add_u32 s40, s40, s34
    s_lshl_b32 s43, s40, 7
    s_mul_i32 s40, s40, 458752
    s_mul_i32 s41, s36, 37
    s_lshr_b32 s41, s41, 8
    s_mul_i32 s42, s41, 7
    s_sub_u32 s7, s36, s42
    s_lshl_b32 s41, s41, 2
    s_lshr_b32 s41, 0x2031, s41
    s_and_b32 s41, s41, 3
    s_lshl2_add_u32 s7, s7, s41
    s_lshl_b32 s41, s7, 8
    s_add_u32 s40, s40, s41
    s_add_u32 s48, s48, s40
    s_addc_u32 s49, s49, 0
    s_add_u32 s10, s48, 229376
    s_addc_u32 s11, s49, 0
    v_lshl_add_u32 v5, v22, 3, v23
    v_lshl_add_u32 v5, v5, 11, v21
    v_lshrrev_b32 v19, 1, v21
    v_and_b32 v23, 3, v1
    v_mul_u32_u24 v14, 0x5555, v23
    v_lshlrev_b32 v23, 3, v23
    v_lshl_add_u32 v17, v20, 5, v23
    v_and_b32 v22, 8, v1
    v_lshl_add_u32 v11, v22, 6, v17
    v_bfe_i32 v9, v1, 2, 1
    v_lshrrev_b32 v7, 16, v9
    v_lshlrev_b32 v9, 16, v9
    v_xor_b32 v6, 0xffff, v7
    v_xor_b32 v8, 0xffff0000, v9
    v_and_b32 v23, 512, v2
    v_lshl_add_u32 v23, v21, 1, v23
    v_and_b32 v22, 16, v1
    s_lshl_b32 s40, s34, 10
    v_add3_u32 v10, v22, v23, s40
    v_add_u32 v17, s43, v17
    s_add_u32 s30, s32, 32768
    s_addc_u32 s31, s33, 0
    s_lshl2_add_u32 s40, s7, s34
    s_lshl_b32 s40, s40, 16
    s_lshl_b32 s41, s35, 8
    s_add_u32 s40, s40, s41
    s_add_u32 s40, s40, 4096
    s_add_u32 s50, s26, s40
    s_addc_u32 s51, s27, 0
    s_add_u32 s52, s50, 32768
    s_addc_u32 s53, s51, 0
    s_add_u32 s74, s50, 8192
    s_addc_u32 s75, s51, 0
    s_add_u32 s76, s52, 8192
    s_addc_u32 s77, s53, 0
    s_lshl_b32 s40, s2, 7
    s_add_u32 s40, s40, 98304
    s_add_u32 s54, s32, s40
    s_addc_u32 s55, s33, 0
    s_lshl_b32 s40, s36, 10
    s_lshl2_add_u32 s40, s35, s40
    s_add_u32 s40, s40, 98304
    s_add_u32 s56, s32, s40
    s_addc_u32 s57, s33, 0
    s_lshl_b32 s40, s2, 10
    s_add_u32 s40, s40, 131072
    s_add_u32 s58, s32, s40
    s_addc_u32 s59, s33, 0
    s_lshl_b32 s40, s36, 13
    s_lshl_b32 s41, s34, 7
    s_add_u32 s40, s40, s41
    s_add_u32 s40, s40, 135168
    s_add_u32 s60, s32, s40
    s_addc_u32 s61, s33, 0
    s_mul_i32 s40, s35, 28
    s_add_u32 s40, s40, s36
    s_lshl_b32 s40, s40, 10
    s_add_u32 s40, s40, 524288
    s_add_u32 s62, s32, s40
    s_addc_u32 s63, s33, 0
    s_setprio 3
    s_lshl_b32 s40, s34, 7
    v_mov_b32 v16, s40
    s_mov_b32 s46, 0
L_sp_29:
    ds_read_b64 v[22:23], v3 offset:40
    s_waitcnt lgkmcnt(0)
    v_cmp_eq_u32_e64 vcc, 0, v23
    s_cbranch_vccz L_spd_30
    s_add_u32 s46, s46, 1
    s_cmp_lt_u32 s46, 400000
    s_cbranch_scc1 L_sp_29
    s_branch L_end
    s_nop 0
L_spd_30:
    v_readfirstlane_b32 s39, v22
    s_and_b32 s40, s39, 1
    s_mul_i32 s40, s40, 0x01010101
    s_and_b32 s41, s39, 0xfefefefe
    s_or_b32 s41, s41, s40
    v_bfe_u32 v28, s41, v11, 8
    v_lshrrev_b32 v29, v2, s41
    v_lshrrev_b32_e64 v30, 8, v29
    s_cmp_ge_u32 s36, 28
    s_cbranch_scc1 L_noexp
    global_load_dwordx4 v[32:35], v4, s[48:49] nt
    s_add_u32 s48, s48, 14336
    s_addc_u32 s49, s49, 0
    global_load_dwordx4 v[36:39], v4, s[10:11] nt
    s_add_u32 s10, s10, 14336
    s_addc_u32 s11, s11, 0
    s_cmp_lg_u32 s34, 0
    s_cbranch_scc1 L_warm_31
    s_load_dword s8, s[54:55], 0 glc
L_warm_31:
    v_and_b32 v18, 128, v2
    v_lshl_add_u32 v18, v16, 1, v18
    global_load_dword v31, v18, s[62:63]
    s_waitcnt vmcnt(2)
    s_nop 0
    global_load_dwordx4 v[40:43], v4, s[48:49] nt
    s_add_u32 s48, s48, 14336
    s_addc_u32 s49, s49, 0
    s_waitcnt vmcnt(2)
    global_load_dwordx4 v[44:47], v4, s[10:11] nt
    s_add_u32 s10, s10, 14336
    s_addc_u32 s11, s11, 0
    s_waitcnt vmcnt(1)
    global_load_dwordx4 v[48:51], v4, s[48:49] nt
    s_add_u32 s48, s48, 14336
    s_addc_u32 s49, s49, 0
    s_waitcnt vmcnt(1)
    global_load_dwordx4 v[52:55], v4, s[10:11] nt
    s_add_u32 s10, s10, 14336
    s_addc_u32 s11, s11, 0
    s_waitcnt vmcnt(2)
    global_load_dwordx4 v[56:59], v4, s[48:49] nt
    s_add_u32 s48, s48, 14336
    s_addc_u32 s49, s49, 0
    s_waitcnt vmcnt(3)
    global_load_dwordx4 v[60:63], v4, s[10:11] nt
    s_add_u32 s10, s10, 14336
    s_addc_u32 s11, s11, 0
    s_waitcnt vmcnt(4)
    global_load_dwordx4 v[64:67], v4, s[48:49] nt
    s_add_u32 s48, s48, 14336
    s_addc_u32 s49, s49, 0
    s_waitcnt vmcnt(5)
    global_load_dwordx4 v[68:71], v4, s[10:11] nt
    s_add_u32 s10, s10, 14336
    s_addc_u32 s11, s11, 0
    s_waitcnt vmcnt(5)
    global_load_dwordx4 v[72:75], v4, s[48:49] nt
    s_add_u32 s48, s48, 14336
    s_addc_u32 s49, s49, 0
    s_waitcnt vmcnt(5)
    global_load_dwordx4 v[76:79], v4, s[10:11] nt
    s_add_u32 s10, s10, 14336
    s_addc_u32 s11, s11, 0
    s_waitcnt vmcnt(5)
    global_load_dwordx4 v[80:83], v4, s[48:49] nt
    s_add_u32 s48, s48, 14336
    s_addc_u32 s49, s49, 0
    s_waitcnt vmcnt(5)
    global_load_dwordx4 v[84:87], v4, s[10:11] nt
    s_add_u32 s10, s10, 14336
    s_addc_u32 s11, s11, 0
    s_waitcnt vmcnt(5)
    global_load_dwordx4 v[88:91], v4, s[48:49] nt
    s_waitcnt vmcnt(5)
    global_load_dwordx4 v[92:95], v4, s[10:11] nt
    s_mov_b32 s46, 0
L_sp_32:
    ds_read_b64 v[24:25], v19 offset:128
    s_waitcnt lgkmcnt(0)
    v_cmp_eq_u32 vcc, 0, v24
    s_cbranch_vccz L_spd_33
    s_add_u32 s46, s46, 1
    s_sleep 1
    s_cmp_lt_u32 s46, 400000
    s_cbranch_scc1 L_sp_32
    s_branch L_end
    s_nop 0
L_spd_33:
    v_max_u32_dpp v27, v25, v25 quad_perm:[1,0,3,2] row_mask:0xf bank_mask:0xf
    v_min_u32_dpp v26, v24, v24 quad_perm:[1,0,3,2] row_mask:0xf bank_mask:0xf
    v_max_u32 v25, v26, v27
    v_max_u32_dpp v24, v24, v24 quad_perm:[1,0,3,2] row_mask:0xf bank_mask:0xf
    s_nop 0
    v_max_u32_dpp v27, v25, v25 quad_perm:[2,3,0,1] row_mask:0xf bank_mask:0xf
    v_min_u32_dpp v26, v24, v24 quad_perm:[2,3,0,1] row_mask:0xf bank_mask:0xf
    v_max_u32 v25, v26, v27
    v_max_u32_dpp v24, v24, v24 quad_perm:[2,3,0,1] row_mask:0xf bank_mask:0xf
    s_nop 0
    v_max_u32_dpp v27, v25, v25 row_half_mirror row_mask:0xf bank_mask:0xf
    v_min_u32_dpp v26, v24, v24 row_half_mirror row_mask:0xf bank_mask:0xf
    v_max_u32 v25, v26, v27
    v_max_u32_dpp v24, v24, v24 row_half_mirror row_mask:0xf bank_mask:0xf
    s_nop 0
    v_max_u32_dpp v27, v25, v25 row_mirror row_mask:0xf bank_mask:0xf
    v_min_u32_dpp v26, v24, v24 row_mirror row_mask:0xf bank_mask:0xf
    v_max_u32_e64 v25, v26, v27
    v_max_u32_dpp v24, v24, v24 row_mirror row_mask:0xf bank_mask:0xf
    s_mov_b32 vcc_lo, 0xff00ff00
    s_mov_b32 vcc_hi, 0xff00ff00
    s_movk_i32 s40, 2047
    v_cndmask_b32 v16, v24, v25, vcc
    v_bfi_b32 v18, v16, 0, s40
    v_lshl_add_u32 v17, v18, 11, v17
    v_lshlrev_b32_e64 v18, 3, v18
    global_load_dwordx2 v[20:21], v17, s[4:5]
    global_load_dword v22, v18, s[30:31] sc1
    v_mov_b32 v0, 1
    s_mov_b64 exec, 1
    ds_add_u32 v3, v0 offset:92
    s_mov_b64 exec, -1
    s_mov_b64 exec, 1
    ds_write_b64 v3, v[24:25] offset:32
    s_mov_b64 exec, -1
    v_readfirstlane_b32 s16, v24
    v_readfirstlane_b32 s17, v25
    s_cmp_eq_u32 s34, 0
    s_cselect_b32 s16, s16, s17
    s_andn2_b32 s17, 2047, s16
    s_lshr_b32 s40, s17, 8
    s_add_u32 s41, s40, 2
    s_bfe_u32 s19, s41, 0x10002
    s_xor_b32 s19, s19, s38
    s_and_b32 s42, s34, 2
    s_or_b32 s19, s19, s42
    s_cmp_eq_u32 s38, 0
    s_cselect_b32 s18, s40, s41
    s_and_b32 s18, s18, 3
    s_mul_i32 s40, s35, 28672
    s_and_b32 s41, s34, 1
    s_lshl_b32 s41, s41, 9
    s_add_u32 s40, s40, s41
    s_and_b32 s41, s36, 15
    s_lshl_b32 s41, s41, 5
    s_add_u32 s40, s40, s41
    s_add_u32 s40, s40, 524288
    s_add_u32 s22, s32, s40
    s_addc_u32 s23, s33, 0
    s_add_u32 s24, s22, 262144
    s_addc_u32 s25, s23, 0
    s_bfe_u32 s40, s17, 0x20002
    s_bfe_u32 s41, s17, 0x40004
    s_lshl4_add_u32 s40, s40, s41
    s_and_b32 s41, s17, 3
    s_lshl2_add_u32 s40, s40, s41
    s_lshl_b32 s41, s18, 8
    s_add_u32 s40, s40, s41
    s_lshl_b32 s40, s40, 1
    s_add_u32 s20, s40, 52096
    s_bitcmp1_b32 s16, 31
    s_brev_b32 s40, 1
    s_cselect_b32 s40, s40, -1
    s_xor_b32 s40, s40, s16
    s_and_b32 s21, s40, 0xffff0000
    v_mov_b32 v0, 1
    s_waitcnt vmcnt(0)
    v_and_b32 v17, 0xffff0000, v22
    v_rcp_f32 v17, v17
    v_lshlrev_b32 v22, 16, v22
    v_lshlrev_b32_e64 v24, 16, v20
    v_and_b32 v25, 0xffff0000, v20
    v_mul_f32 v22, -v22, v17
    v_lshlrev_b32_e64 v26, 16, v21
    v_and_b32 v27, 0xffff0000, v21
    v_fma_f32 v24, v24, v17, v22
    v_fma_f32 v25, v25, v17, v22
    v_fma_f32 v26, v26, v17, v22
    v_fma_f32 v27, v27, v17, v22
    v_cvt_pk_bf16_f32 v12, v24, v25
    v_cvt_pk_bf16_f32 v13, v26, v27
    v_mov_b32 v24, 0
    v_mov_b32 v25, 0
    v_mov_b32 v26, 0
    v_mov_b32 v27, 0
    v_and_b32_dpp v16, v12, v6 quad_perm:[0,0,0,0] row_mask:0xf bank_mask:0xf
    v_and_b32_dpp v17, v12, v7 quad_perm:[0,0,0,0] row_mask:0xf bank_mask:0xf
    v_and_b32_dpp v18, v12, v8 quad_perm:[0,0,0,0] row_mask:0xf bank_mask:0xf
    v_and_b32_dpp v19, v12, v9 quad_perm:[0,0,0,0] row_mask:0xf bank_mask:0xf
    v_and_b32_dpp v20, v13, v6 quad_perm:[0,0,0,0] row_mask:0xf bank_mask:0xf
    v_and_b32_dpp v21, v13, v7 quad_perm:[0,0,0,0] row_mask:0xf bank_mask:0xf
    v_and_b32_dpp v22, v13, v8 quad_perm:[0,0,0,0] row_mask:0xf bank_mask:0xf
    v_and_b32_dpp v23, v13, v9 quad_perm:[0,0,0,0] row_mask:0xf bank_mask:0xf
    v_smfmac_f32_16x16x64_bf16 v[24:27], v[16:19], v[32:39], v14
    v_and_b32_dpp v16, v12, v6 quad_perm:[1,1,1,1] row_mask:0xf bank_mask:0xf
    v_and_b32_dpp v17, v12, v7 quad_perm:[1,1,1,1] row_mask:0xf bank_mask:0xf
    v_and_b32_dpp v18, v12, v8 quad_perm:[1,1,1,1] row_mask:0xf bank_mask:0xf
    v_and_b32_dpp v19, v12, v9 quad_perm:[1,1,1,1] row_mask:0xf bank_mask:0xf
    v_smfmac_f32_16x16x64_bf16 v[24:27], v[20:23], v[40:47], v14
    global_load_dwordx4 v[96:99], v5, s[50:51] offset:-4096 nt
    v_and_b32_dpp v20, v13, v6 quad_perm:[1,1,1,1] row_mask:0xf bank_mask:0xf
    v_and_b32_dpp v21, v13, v7 quad_perm:[1,1,1,1] row_mask:0xf bank_mask:0xf
    v_and_b32_dpp v22, v13, v8 quad_perm:[1,1,1,1] row_mask:0xf bank_mask:0xf
    v_and_b32_dpp v23, v13, v9 quad_perm:[1,1,1,1] row_mask:0xf bank_mask:0xf
    s_mov_b64 exec, 1
    ds_add_rtn_u32 v31, v3, v0 offset:60
    s_mov_b64 exec, -1
    v_smfmac_f32_16x16x64_bf16 v[24:27], v[16:19], v[48:55], v14
    global_load_dwordx4 v[100:103], v5, s[52:53] offset:-4096 nt
    v_and_b32_dpp v16, v12, v6 quad_perm:[2,2,2,2] row_mask:0xf bank_mask:0xf
    v_and_b32_dpp v17, v12, v7 quad_perm:[2,2,2,2] row_mask:0xf bank_mask:0xf
    v_and_b32_dpp v18, v12, v8 quad_perm:[2,2,2,2] row_mask:0xf bank_mask:0xf
    v_and_b32_dpp v19, v12, v9 quad_perm:[2,2,2,2] row_mask:0xf bank_mask:0xf
    v_smfmac_f32_16x16x64_bf16 v[24:27], v[20:23], v[56:63], v14
    global_load_dwordx4 v[104:107], v5, s[50:51] offset:0 nt
    v_and_b32_dpp v20, v13, v6 quad_perm:[2,2,2,2] row_mask:0xf bank_mask:0xf
    v_and_b32_dpp v21, v13, v7 quad_perm:[2,2,2,2] row_mask:0xf bank_mask:0xf
    v_and_b32_dpp v22, v13, v8 quad_perm:[2,2,2,2] row_mask:0xf bank_mask:0xf
    v_and_b32_dpp v23, v13, v9 quad_perm:[2,2,2,2] row_mask:0xf bank_mask:0xf
    v_smfmac_f32_16x16x64_bf16 v[24:27], v[16:19], v[64:71], v14
    global_load_dwordx4 v[108:111], v5, s[52:53] offset:0 nt
    v_and_b32_dpp v16, v12, v6 quad_perm:[3,3,3,3] row_mask:0xf bank_mask:0xf
    v_and_b32_dpp v17, v12, v7 quad_perm:[3,3,3,3] row_mask:0xf bank_mask:0xf
    v_and_b32_dpp v18, v12, v8 quad_perm:[3,3,3,3] row_mask:0xf bank_mask:0xf
    v_and_b32_dpp v19, v12, v9 quad_perm:[3,3,3,3] row_mask:0xf bank_mask:0xf
    s_waitcnt lgkmcnt(0)
    v_readfirstlane_b32 s40, v31
    s_cmp_lg_u32 s40, 3
    s_cbranch_scc1 L_ef_34
    v_mov_b32_e64 v31, s39
    v_lshlrev_b32_e64 v0, 7, v1
    s_mov_b64 exec, 255
    global_store_dword v0, v31, s[56:57] sc1
    s_mov_b64 exec, -1
L_ef_34:
    s_nop 0
    v_smfmac_f32_16x16x64_bf16 v[24:27], v[20:23], v[72:79], v14
    global_load_dwordx4 v[112:115], v5, s[74:75] offset:-4096 nt
    v_and_b32_dpp v20, v13, v6 quad_perm:[3,3,3,3] row_mask:0xf bank_mask:0xf
    v_and_b32_dpp v21, v13, v7 quad_perm:[3,3,3,3] row_mask:0xf bank_mask:0xf
    v_and_b32_dpp v22, v13, v8 quad_perm:[3,3,3,3] row_mask:0xf bank_mask:0xf
    v_and_b32_dpp v23, v13, v9 quad_perm:[3,3,3,3] row_mask:0xf bank_mask:0xf
    v_smfmac_f32_16x16x64_bf16 v[24:27], v[16:19], v[80:87], v14
    global_load_dwordx4 v[116:119], v5, s[76:77] offset:-4096 nt
    v_smfmac_f32_16x16x64_bf16 v[24:27], v[20:23], v[88:95], v14
    global_load_dwordx4 v[120:123], v5, s[74:75] offset:0 nt
    v_mov_b32_e64 v0, 1
    s_movk_i32 s6, 255
    s_nop 4
    ds_write_b128 v10, v[24:27] offset:768
    s_mov_b64 exec, 1
    ds_add_rtn_u32 v31, v3, v0 offset:52
    s_mov_b64 exec, -1
    ds_read_b128 v[48:51], v2 offset:768
    ds_read_b128 v[52:55], v2 offset:1792
    ds_read_b128 v[56:59], v2 offset:2816
    ds_read_b128 v[60:63], v2 offset:3840
    s_waitcnt lgkmcnt(4)
    v_readfirstlane_b32 s40, v31
    s_cmp_lg_u32 s40, 3
    s_cbranch_scc1 L_ha_35
    s_waitcnt lgkmcnt(2)
    v_add_f32 v48, v48, v52
    v_add_f32 v49, v49, v53
    v_add_f32 v50, v50, v54
    v_add_f32 v51, v51, v55
    s_waitcnt lgkmcnt(0)
    v_add_f32 v56, v56, v60
    v_add_f32 v57, v57, v61
    v_add_f32 v58, v58, v62
    v_add_f32 v59, v59, v63
    v_add_f32 v48, v48, v56
    v_add_f32 v49, v49, v57
    v_add_f32 v50, v50, v58
    v_add_f32 v51, v51, v59
    v_bfi_b32 v48, s6, v29, v48
    v_bfi_b32 v50, s6, v30, v50
    global_store_dwordx4 v2, v[48:51], s[58:59] sc1
L_ha_35:
    global_load_dwordx4 v[124:127], v5, s[76:77] offset:0 nt
    v_mov_b32 v24, 0
    v_mov_b32 v25, 0
    v_mov_b32 v26, 0
    v_mov_b32 v27, 0
    s_cmp_lg_u32 s19, 0
    s_cbranch_scc1 L_nort_36
    v_and_b32 v75, 3, v1
    v_lshrrev_b32 v72, 5, v1
    v_lshl_add_u32 v72, v75, 1, v72
    v_lshrrev_b32 v73, 2, v1
    v_lshlrev_b32 v73, 10, v73
    v_lshl_add_u32 v73, v75, 3, v73
    v_add_u32 v74, 16384, v73
    s_lshl_b32 s40, s17, 11
    s_lshl4_add_u32 s40, s37, s40
    v_lshl_add_u32 v75, v72, 1, s40
    global_load_ushort v76, v75, s[4:5]
    v_mov_b32 v80, 0xbfb8aa3b
    v_mul_f32 v80, s21, v80
    v_exp_f32 v80, v80
    v_mov_b32 v84, v28
    v_mov_b32 v85, 0
    v_add_f32 v80, 1.0, v80
    v_rcp_f32 v80, v80
    s_lshl_b32 s40, s18, 2
    v_mov_b32 v81, s40
    v_mul_f32 v80, 0xbfb8aa3b, v80
    v_mul_u32_u24 v78, 14416, v72
    v_add_u32 v78, s20, v78
    s_lshl_b32 s40, s17, 1
    v_mul_u32_u24 v77, 4624, v72
    v_add_u32_e64 v77, s40, v77
    v_lshlrev_b32 v79, 2, v72
L_nort_36:
    s_mov_b32 s46, 0
L_mf_37:
    s_load_dwordx8 s[8:15], s[54:55], 0 glc
    s_add_u32 s46, s46, 1
    s_cmp_gt_u32 s46, 50000
    s_cbranch_scc1 L_end
    s_waitcnt lgkmcnt(0)
    s_xor_b32 s40, s8, s39
    s_xor_b32 s41, s9, s39
    s_or_b32 s40, s40, s41
    s_xor_b32 s41, s10, s39
    s_or_b32 s40, s40, s41
    s_xor_b32 s41, s11, s39
    s_or_b32 s40, s40, s41
    s_xor_b32 s41, s12, s39
    s_or_b32 s40, s40, s41
    s_xor_b32 s41, s13, s39
    s_or_b32 s40, s40, s41
    s_xor_b32 s41, s14, s39
    s_or_b32 s40, s40, s41
    s_xor_b32 s41, s15, s39
    s_or_b32 s40, s40, s41
    s_cbranch_scc1 L_mf_37
    s_mov_b32 s46, 0
L_hp_38:
    global_load_dwordx2 v[32:33], v11, s[60:61] offset:-4096 sc1
    global_load_dwordx2 v[34:35], v11, s[60:61] offset:-3072 sc1
    global_load_dwordx2 v[36:37], v11, s[60:61] offset:-2048 sc1
    global_load_dwordx2 v[38:39], v11, s[60:61] offset:-1024 sc1
    global_load_dwordx2 v[40:41], v11, s[60:61] offset:0 sc1
    global_load_dwordx2 v[42:43], v11, s[60:61] offset:1024 sc1
    global_load_dwordx2 v[44:45], v11, s[60:61] offset:2048 sc1
    global_load_dwordx2 v[46:47], v11, s[60:61] offset:3072 sc1
    s_add_u32 s46, s46, 1
    s_cmp_gt_u32 s46, 50000
    s_cbranch_scc1 L_end
L_hc_39:
    s_waitcnt vmcnt(7)
    v_xor_b32 v31, v28, v32
    s_waitcnt vmcnt(6)
    v_bitop3_b32 v31, v31, v34, v28 bitop3:0xf6
    s_waitcnt vmcnt(5)
    v_bitop3_b32 v31, v31, v36, v28 bitop3:0xf6
    v_add_f32 v64, v32, v36
    v_add_f32 v65, v33, v37
    s_waitcnt vmcnt(4)
    v_bitop3_b32 v31, v31, v38, v28 bitop3:0xf6
    v_add_f32 v66, v34, v38
    v_add_f32 v67, v35, v39
    s_waitcnt vmcnt(3)
    v_bitop3_b32 v31, v31, v40, v28 bitop3:0xf6
    v_add_f32 v64, v64, v40
    v_add_f32_e64 v65, v65, v41
    s_waitcnt vmcnt(2)
    v_bitop3_b32 v31, v31, v42, v28 bitop3:0xf6
    v_add_f32 v66, v66, v42
    v_add_f32 v67, v67, v43
    s_waitcnt vmcnt(1)
    v_bitop3_b32 v31, v31, v44, v28 bitop3:0xf6
    v_add_f32 v64, v64, v44
    v_add_f32 v65, v65, v45
    s_waitcnt vmcnt(0)
    v_bitop3_b32 v31, v31, v46, v28 bitop3:0xf6
    v_add_f32 v66, v66, v46
    v_add_f32 v67, v67, v47
    v_and_b32 v31, 0xff, v31
    v_cmp_ne_u32_e64 vcc, 0, v31
    v_mul_f32 v68, 0xbfb8aa3b, v64
    v_mul_f32 v69, 0xbfb8aa3b, v65
    s_cbranch_vccnz L_hp_38
    v_exp_f32 v68, v68
    v_exp_f32 v69, v69
    v_mul_f32 v64, v64, v66
    v_mul_f32 v65, v65, v67
    v_add_f32 v68, 1.0, v68
    v_add_f32 v69, 1.0, v69
    v_rcp_f32 v68, v68
    v_rcp_f32 v69, v69
    v_mul_f32 v64, v64, v68
    v_mul_f32 v65, v65, v69
    v_cvt_pk_bf16_f32 v12, v64, v65
    s_nop 1
    v_and_b32_dpp v16, v12, v6 quad_perm:[0,0,0,0] row_mask:0xf bank_mask:0xf
    v_and_b32_dpp v17, v12, v7 quad_perm:[0,0,0,0] row_mask:0xf bank_mask:0xf
    v_and_b32_dpp v18, v12, v8 quad_perm:[0,0,0,0] row_mask:0xf bank_mask:0xf
    v_and_b32_dpp v19, v12, v9 quad_perm:[0,0,0,0] row_mask:0xf bank_mask:0xf
    v_and_b32_dpp v20, v12, v6 quad_perm:[1,1,1,1] row_mask:0xf bank_mask:0xf
    v_and_b32_dpp v21, v12, v7 quad_perm:[1,1,1,1] row_mask:0xf bank_mask:0xf
    v_and_b32_dpp v22, v12, v8 quad_perm:[1,1,1,1] row_mask:0xf bank_mask:0xf
    v_and_b32_dpp v23, v12, v9 quad_perm:[1,1,1,1] row_mask:0xf bank_mask:0xf
    v_smfmac_f32_16x16x64_bf16 v[24:27], v[16:19], v[96:103], v14
    v_and_b32_dpp v16, v12, v6 quad_perm:[2,2,2,2] row_mask:0xf bank_mask:0xf
    v_and_b32_dpp v17, v12, v7 quad_perm:[2,2,2,2] row_mask:0xf bank_mask:0xf
    v_and_b32_dpp v18, v12, v8 quad_perm:[2,2,2,2] row_mask:0xf bank_mask:0xf
    v_and_b32_dpp v19, v12, v9 quad_perm:[2,2,2,2] row_mask:0xf bank_mask:0xf
    v_smfmac_f32_16x16x64_bf16 v[24:27], v[20:23], v[104:111], v14
    v_and_b32_dpp v20, v12, v6 quad_perm:[3,3,3,3] row_mask:0xf bank_mask:0xf
    v_and_b32_dpp v21, v12, v7 quad_perm:[3,3,3,3] row_mask:0xf bank_mask:0xf
    v_and_b32_dpp v22, v12, v8 quad_perm:[3,3,3,3] row_mask:0xf bank_mask:0xf
    v_and_b32_dpp v23, v12, v9 quad_perm:[3,3,3,3] row_mask:0xf bank_mask:0xf
    v_smfmac_f32_16x16x64_bf16 v[24:27], v[16:19], v[112:119], v14
    s_nop 0
    v_smfmac_f32_16x16x64_bf16 v[24:27], v[20:23], v[120:127], v14
    s_add_u32 s58, s62, 262144
    s_addc_u32 s59, s63, 0
    v_mov_b32_e64 v0, 1
    s_movk_i32 s6, 255
    s_nop 3
    ds_write_b128 v10, v[24:27] offset:768
    s_mov_b64 exec, 1
    ds_add_rtn_u32 v31, v3, v0 offset:52
    s_mov_b64 exec, -1
    ds_read_b128 v[48:51], v2 offset:768
    ds_read_b128 v[52:55], v2 offset:1792
    ds_read_b128 v[56:59], v2 offset:2816
    ds_read_b128 v[60:63], v2 offset:3840
    s_waitcnt lgkmcnt(4)
    v_readfirstlane_b32 s40, v31
    s_cmp_lg_u32 s40, 7
    s_cbranch_scc1 L_hb_40
    s_waitcnt lgkmcnt(2)
    v_add_f32 v48, v48, v52
    v_add_f32 v49, v49, v53
    v_add_f32 v50, v50, v54
    v_add_f32 v51, v51, v55
    s_waitcnt lgkmcnt(0)
    v_add_f32 v56, v56, v60
    v_add_f32 v57, v57, v61
    v_add_f32 v58, v58, v62
    v_add_f32 v59, v59, v63
    v_add_f32 v48, v48, v56
    v_add_f32 v49, v49, v57
    v_add_f32_e64 v50, v50, v58
    v_add_f32_e64 v51, v51, v59
    v_bfi_b32 v48, s6, v29, v48
    v_bfi_b32 v50, s6, v30, v50
    global_store_dwordx4 v2, v[48:51], s[62:63]
    global_store_dwordx4 v2, v[48:51], s[58:59] sc1
L_hb_40:
    s_branch L_routed
    s_nop 0
L_noexp:
    s_mov_b32 s46, 0
L_sp_41:
    ds_read_b64 v[24:25], v19 offset:128
    s_waitcnt lgkmcnt(0)
    v_cmp_eq_u32 vcc, 0, v24
    s_cbranch_vccz L_spd_42
    s_add_u32 s46, s46, 1
    s_sleep 2
    s_cmp_lt_u32 s46, 400000
    s_cbranch_scc1 L_sp_41
    s_branch L_end
L_spd_42:
    v_max_u32_dpp v27, v25, v25 quad_perm:[1,0,3,2] row_mask:0xf bank_mask:0xf
    v_min_u32_dpp v26, v24, v24 quad_perm:[1,0,3,2] row_mask:0xf bank_mask:0xf
    v_max_u32 v25, v26, v27
    v_max_u32_dpp v24, v24, v24 quad_perm:[1,0,3,2] row_mask:0xf bank_mask:0xf
    s_nop 0
    v_max_u32_dpp v27, v25, v25 quad_perm:[2,3,0,1] row_mask:0xf bank_mask:0xf
    v_min_u32_dpp v26, v24, v24 quad_perm:[2,3,0,1] row_mask:0xf bank_mask:0xf
    v_max_u32 v25, v26, v27
    v_max_u32_dpp v24, v24, v24 quad_perm:[2,3,0,1] row_mask:0xf bank_mask:0xf
    s_nop 0
    v_max_u32_dpp v27, v25, v25 row_half_mirror row_mask:0xf bank_mask:0xf
    v_min_u32_dpp v26, v24, v24 row_half_mirror row_mask:0xf bank_mask:0xf
    v_max_u32 v25, v26, v27
    v_max_u32_dpp v24, v24, v24 row_half_mirror row_mask:0xf bank_mask:0xf
    s_nop 0
    v_max_u32_dpp v27, v25, v25 row_mirror row_mask:0xf bank_mask:0xf
    v_min_u32_dpp v26, v24, v24 row_mirror row_mask:0xf bank_mask:0xf
    v_max_u32_e64 v25, v26, v27
    v_max_u32_dpp v24, v24, v24 row_mirror row_mask:0xf bank_mask:0xf
    v_mov_b32 v0, 1
    s_mov_b64 exec, 1
    ds_add_u32 v3, v0 offset:92
    s_mov_b64 exec, -1
    s_mov_b64 exec, 1
    ds_write_b64 v3, v[24:25] offset:32
    s_mov_b64 exec, -1
    v_readfirstlane_b32 s16, v24
    v_readfirstlane_b32 s17, v25
    s_cmp_eq_u32 s34, 0
    s_cselect_b32 s16, s16, s17
    s_andn2_b32 s17, 2047, s16
    s_lshr_b32 s40, s17, 8
    s_add_u32 s41, s40, 2
    s_bfe_u32 s19, s41, 0x10002
    s_xor_b32 s19, s19, s38
    s_and_b32 s42, s34, 2
    s_or_b32 s19, s19, s42
    s_cmp_eq_u32 s38, 0
    s_cselect_b32 s18, s40, s41
    s_and_b32 s18, s18, 3
    s_mul_i32 s40, s35, 28672
    s_and_b32 s41, s34, 1
    s_lshl_b32 s41, s41, 9
    s_add_u32 s40, s40, s41
    s_and_b32 s41, s36, 15
    s_lshl_b32 s41, s41, 5
    s_add_u32 s40, s40, s41
    s_add_u32 s40, s40, 524288
    s_add_u32 s22, s32, s40
    s_addc_u32 s23, s33, 0
    s_add_u32 s24, s22, 262144
    s_addc_u32 s25, s23, 0
    s_bfe_u32 s40, s17, 0x20002
    s_bfe_u32 s41, s17, 0x40004
    s_lshl4_add_u32 s40, s40, s41
    s_and_b32 s41, s17, 3
    s_lshl2_add_u32 s40, s40, s41
    s_lshl_b32 s41, s18, 8
    s_add_u32 s40, s40, s41
    s_lshl_b32 s40, s40, 1
    s_add_u32 s20, s40, 52096
    s_bitcmp1_b32 s16, 31
    s_brev_b32 s40, 1
    s_cselect_b32 s40, s40, -1
    s_xor_b32 s40, s40, s16
    s_and_b32 s21, s40, 0xffff0000
    s_cmp_lg_u32 s19, 0
    s_cbranch_scc1 L_fin
    v_and_b32 v75, 3, v1
    v_lshrrev_b32 v72, 5, v1
    v_lshl_add_u32 v72, v75, 1, v72
    v_lshrrev_b32 v73, 2, v1
    v_lshlrev_b32 v73, 10, v73
    v_lshl_add_u32 v73, v75, 3, v73
    v_add_u32 v74, 16384, v73
    s_lshl_b32 s40, s17, 11
    s_lshl4_add_u32 s40, s37, s40
    v_lshl_add_u32 v75, v72, 1, s40
    global_load_ushort v76, v75, s[4:5]
    v_mov_b32 v80, 0xbfb8aa3b
    v_mul_f32 v80, s21, v80
    v_exp_f32 v80, v80
    v_mov_b32 v84, v28
    v_mov_b32 v85, 0
    v_add_f32 v80, 1.0, v80
    v_rcp_f32 v80, v80
    s_lshl_b32 s40, s18, 2
    v_mov_b32 v81, s40
    v_mul_f32 v80, 0xbfb8aa3b, v80
    v_mul_u32_u24 v78, 14416, v72
    v_add_u32 v78, s20, v78
    s_lshl_b32 s40, s17, 1
    v_mul_u32_u24 v77, 4624, v72
    v_add_u32 v77, s40, v77
    v_lshlrev_b32 v79, 2, v72
L_nort_43:
    s_mov_b32 s46, 0
L_sp_44:
    ds_read_b32 v72, v3 offset:64
    s_waitcnt lgkmcnt(0)
    v_cmp_gt_u32 vcc, 8, v72
    s_cbranch_vccz L_spd_45
    s_add_u32 s46, s46, 1
    s_sleep 4
    s_cmp_lt_u32 s46, 400000
    s_cbranch_scc1 L_sp_44
    s_branch L_end
    s_nop 0
L_spd_45:
L_routed:
    s_cmp_lg_u32 s19, 0
    s_cbranch_scc1 L_fin
    s_mov_b32 s46, 0
L_ba_46:
    global_load_dwordx2 v[82:83], v73, s[22:23] sc1
    s_mov_b32 exec_hi, 0xffff
    global_load_dwordx2 v[84:85], v74, s[22:23] sc1
    s_mov_b32 exec_hi, -1
L_bc_47:
    s_waitcnt vmcnt(0)
    v_xor_b32_e64 v31, v28, v82
    v_bitop3_b32 v31, v31, v84, v28 bitop3:0xf6
    v_and_b32 v31, 0xff, v31
    v_cmp_ne_u32 vcc, 0, v31
    v_add_f32 v86, v82, v84
    v_add_f32_e64 v87, v83, v85
    s_cbranch_vccz L_bo_48
    s_add_u32 s46, s46, 1
    s_cmp_lt_u32 s46, 24
    s_cbranch_scc1 L_ba_46
    s_cmp_gt_u32 s46, 50000
    s_cbranch_scc1 L_end
    s_sleep 2
    global_load_dwordx2 v[82:83], v73, s[24:25] sc1
    s_mov_b32 exec_hi, 0xffff
    global_load_dwordx2 v[84:85], v74, s[24:25] sc1
    s_mov_b32 exec_hi, -1
    s_branch L_bc_47
    s_nop 0
L_bo_48:
    v_lshlrev_b32 v76, 16, v76
    s_nop 0
    v_permlane32_swap_b32 v86, v87
    v_add_f32_e64 v86, v86, v87
    v_mov_b32 v87, v86
    s_mov_b32 s46, 0
    ds_read_b32 v72, v81 offset:64
    ds_read_u16 v82, v78
    ds_read_u16 v83, v77 offset:9488
    ds_read_b32 v84, v79 offset:0
    v_permlane16_swap_b32 v86, v87
    v_add_f32 v86, v86, v87
    s_nop 1
    v_add_f32_dpp v86, v86, v86 row_ror:8 row_mask:0xf bank_mask:0xf
    s_nop 1
    v_add_f32_dpp v86, v86, v86 row_ror:4 row_mask:0xf bank_mask:0xf
    s_branch L_spc_51
    s_nop 0
L_sp_49:
    ds_read_b32 v72, v81 offset:64
    ds_read_u16 v82, v78
    ds_read_u16 v83, v77 offset:9488
    ds_read_b32 v84, v79 offset:0
L_spc_51:
    s_waitcnt lgkmcnt(0)
    v_cmp_gt_u32 vcc, 8, v72
    s_cbranch_vccz L_spd_50
    s_add_u32 s46, s46, 1
    s_sleep 1
    s_cmp_lt_u32 s46, 400000
    s_cbranch_scc1 L_sp_49
    s_branch L_end
L_spd_50:
    v_fma_mix_f32 v77, v86, v80, v83 op_sel_hi:[0,0,1]
    v_exp_f32 v86, v77
    v_fma_mix_f32 v82, v82, v77, 0 op_sel_hi:[1,0,0]
    v_fma_f32 v86, v86, v84, v84
    v_rcp_f32 v86, v86
    s_mov_b32 exec_lo, 15
    s_mov_b32 exec_hi, 15
    v_fmac_f32 v76, v82, v86
    v_cvt_pk_bf16_f32 v76, v76, v76
    global_store_short v75, v76, s[28:29]
    s_branch L_fin
    s_nop 0
L_cnv:
    v_add_u32_e64 v85, s58, v2
    ds_read_b128 v[12:15], v85 offset:0
    ds_read_b128 v[4:7], v85 offset:4624
    ds_read_b128 v[16:19], v85 offset:9248
    ds_read_b128 v[20:23], v85 offset:13872
    s_mul_i32 s50, s34, 14416
    s_add_u32 s50, s50, 45952
    s_mov_b32 m0, s50
    s_mov_b32 s52, 0x3f803f80
    s_mov_b32 s54, 0x41000000
    s_mov_b32 s55, 0
    s_mul_i32 s56, s59, 0x02020000
    s_add_u32 s56, s56, 0x01000c0c
    s_lshl3_add_u32 s40, s37, s34
    s_lshl_b32 s40, s40, 11
    s_add_u32 s40, s40, 8388608
    s_add_u32 s62, s32, s40
    s_addc_u32 s63, s33, 0
    v_mov_b32 v88, 0
    v_mov_b32 v89, 0
    v_mov_b32 v90, 0
    v_mov_b32 v91, 0
    s_mul_i32 s40, s34, 4624
    s_add_u32 s40, s40, 8960
    v_add_u32 v85, s40, v2
    s_mov_b32 exec_lo, -1
    s_mov_b32 exec_hi, 1
    ds_write_b128 v85, v[88:91]
    s_mov_b64 exec, -1
    v_mov_b32 v86, 0x3c00
    ds_write_addtid_b32 v86
    s_waitcnt lgkmcnt(0)
    s_and_b32 s41, s34, 1
    s_lshl_b32 s41, s41, 4
    s_lshr_b32 s48, s48, s41
    s_lshl_b32 s48, s48, 16
    s_lshr_b32 s51, s49, s41
    s_lshl_b32 s51, s51, 16
    v_mov_b32 v85, 0x3fb8aa3b
    v_mul_f32 v85, s48, v85
    v_exp_f32 v85, v85
    v_mov_b32 v26, 0
    v_cvt_pk_bf16_f32 v85, v85, v85
    v_writelane_b32 v26, s51, 0
    v_and_b32 v85, 0xffff0000, v85
    s_bitset0_b32 s51, 31
    v_mul_f32 v28, 0xbfb8aa3b, v85
    v_mul_f32 v29, 0x3e22f983, v85
    v_add_f32 v30, v85, v85
    v_mov_b32 v0, 1
    s_lshl_b32 s41, s60, 2
    v_mov_b32 v31, s41
    v_and_b32 v24, 12, v31
    v_add_u32 v4, s40, v4
    v_add_u32 v16, s50, v16
    v_add_u32 v17, s50, v17
    v_add_u32 v6, s50, v6
    v_add_u32 v7, s50, v7
    v_add_u32 v20, s50, v20
    v_add_u32 v18, s50, v18
    v_add_u32 v19, s50, v19
    s_mov_b32 s57, s40
    s_sub_u32 s41, s50, s57
    s_add_u32 s41, s41, 8912
    s_and_b32 s41, s41, 255
    s_add_u32 s41, s41, s57
    s_sub_u32 s41, s41, 8704
    s_mov_b32 exec_lo, 0x0f000000
    s_mov_b32 exec_hi, 0x0f000000
    v_mov_b32 v16, s41
    s_sub_u32 s41, s50, s57
    s_add_u32 s41, s41, 8816
    s_and_b32 s41, s41, 255
    s_add_u32 s41, s41, s57
    s_sub_u32 s41, s41, 8704
    s_mov_b32 exec_lo, 0xf0000000
    s_mov_b32 exec_hi, 0xf0000000
    v_mov_b32 v16, s41
    s_mov_b64 exec, -1
    s_add_u32 s41, s50, 1072
    v_sub_u32 v25, s41, v2
    s_mov_b32 s46, 0
L_sp_52:
    ds_read_b64 v[42:43], v3 offset:40
    s_waitcnt lgkmcnt(0)
    v_cmp_eq_u32 vcc, 0, v43
    s_cbranch_vccz L_spd_53
    s_add_u32 s46, s46, 1
    s_sleep 1
    s_cmp_lt_u32 s46, 400000
    s_cbranch_scc1 L_sp_52
    s_branch L_end
    s_nop 0
L_spd_53:
    v_readfirstlane_b32 s39, v42
    v_lshlrev_b32_e64 v40, 2, v1
    v_alignbit_b32 v40, v42, v42, v40
    v_bfi_b32 v40, 1, v42, v40
    v_lshrrev_b32 v41, 1, v40
    v_lshrrev_b32 v42, 2, v40
    v_lshrrev_b32_e64 v43, 3, v40
    s_add_u32 s41, s50, 6144
    v_lshl_add_u32 v1, v1, 3, s41
    s_mov_b32 s61, 0x00010001
    v_lshrrev_b32 v27, 1, v2
    s_cmp_eq_u32 s38, 0
    s_mov_b32 s40, -57664
    s_cselect_b32 s40, 57664, s40
    v_add_u32 v37, s40, v17
    v_add_u32 v36, s40, v16
    s_add_u32 s40, s40, s50
    s_sub_u32 s41, s40, s57
    s_add_u32 s41, s41, 8912
    s_and_b32 s41, s41, 255
    s_add_u32 s41, s41, s57
    s_sub_u32 s41, s41, 8704
    s_mov_b32 exec_lo, 0x0f000000
    s_mov_b32 exec_hi, 0x0f000000
    v_mov_b32 v36, s41
    s_sub_u32 s41, s40, s57
    s_add_u32 s41, s41, 8816
    s_and_b32 s41, s41, 255
    s_add_u32 s41, s41, s57
    s_sub_u32 s41, s41, 8704
    s_mov_b32 exec_lo, 0xf0000000
    s_mov_b32 exec_hi, 0xf0000000
    v_mov_b32 v36, s41
    s_mov_b64 exec, -1
    s_setprio 3
    s_waitcnt vmcnt(3)
    v_perm_b32 v32, v8, v8, s56
    v_mul_f32 v32, 0x3fb8aa3b, v32
    v_exp_f32 v32, v32
    s_waitcnt vmcnt(2)
    v_perm_b32 v33, v9, v9, s56
    v_cvt_pk_bf16_f32 v32, v32, v32
    v_and_b32 v32, 0xffff0000, v32
    v_pk_mul_f32 v[32:33], v[32:33], v[28:29]
    s_cmp_lg_u32 s59, 0
    s_cbranch_scc1 L_nosc_54
    v_pk_mul_f32 v[90:91], v[32:33], s[54:55] op_sel_hi:[1,0]
    v_exp_f32_e64 v90, v90
    v_cos_f32 v88, v91
    v_sin_f32_e64 v89, v91
    s_nop 0
    v_pk_mul_f32 v[88:89], v[88:89], v[90:91] op_sel_hi:[1,0]
    v_cvt_pk_f16_f32 v45, v88, v89
    v_pk_mul_f32 v[90:91], v[88:89], v[88:89] op_sel:[1,1] op_sel_hi:[1,0] neg_lo:[1,0]
    v_pk_fma_f32 v[88:89], v[88:89], v[88:89], v[90:91] op_sel:[0,0,0] op_sel_hi:[0,1,1]
    s_waitcnt vmcnt(0)
    s_nop 0
    v_cvt_pk_f16_f32 v46, v88, v89
    v_pk_mul_f32 v[90:91], v[88:89], v[88:89] op_sel:[1,1] op_sel_hi:[1,0] neg_lo:[1,0]
    v_and_b32 v85, 0x7fff7fff, v10
    v_pk_fma_f32 v[88:89], v[88:89], v[88:89], v[90:91] op_sel:[0,0,0] op_sel_hi:[0,1,1]
    v_and_b32 v86, 0x7fff7fff, v11
    v_cvt_pk_f16_f32 v48, v88, v89
    v_pk_mul_f32 v[90:91], v[88:89], v[88:89] op_sel:[1,1] op_sel_hi:[1,0] neg_lo:[1,0]
    v_dot2_f32_bf16 v84, v85, s52, 0
    v_pk_fma_f32 v[88:89], v[88:89], v[88:89], v[90:91] op_sel:[0,0,0] op_sel_hi:[0,1,1]
    v_dot2_f32_bf16 v84, v86, s52, v84
    v_cvt_pk_f16_f32 v52, v88, v89
    s_nop 1
    s_nop 0
    v_add_f32_dpp v84, v84, v84 row_shr:1 row_mask:0xf bank_mask:0xf
    v_pk_mul_f32 v[90:91], v[88:89], v[88:89] op_sel:[1,1] op_sel_hi:[1,0] neg_lo:[1,0]
    v_pk_fma_f32 v[88:89], v[88:89], v[88:89], v[90:91] op_sel:[0,0,0] op_sel_hi:[0,1,1]
    v_add_f32_dpp v84, v84, v84 row_shr:2 row_mask:0xf bank_mask:0xf
    v_cvt_pk_f16_f32 v60, v88, v89
    s_nop 0
    v_add_f32_dpp v84, v84, v84 row_shr:4 row_mask:0xf bank_mask:0xf
    v_exp_f32 v94, v32
    v_cos_f32 v92, v33
    v_add_f32_dpp v84, v84, v84 row_shr:8 row_mask:0xf bank_mask:0xf
    v_sin_f32 v93, v33
    s_nop 0
    v_add_f32_dpp v84, v84, v84 row_bcast:15 row_mask:0xa bank_mask:0xf
    v_pk_mul_f32 v[92:93], v[92:93], v[94:95] op_sel_hi:[1,0]
    s_nop 0
    v_add_f32_dpp v84, v84, v84 row_bcast:31 row_mask:0xc bank_mask:0xf
    v_cvt_pk_f16_f32 v61, v92, v93
    v_pk_mul_f32 v[94:95], v[92:93], v[92:93] op_sel:[1,1] op_sel_hi:[1,0] neg_lo:[1,0]
    v_fma_f32 v84, v84, v30, s51
    v_pk_fma_f32 v[92:93], v[92:93], v[92:93], v[94:95] op_sel:[0,0,0] op_sel_hi:[0,1,1]
    v_frexp_exp_i32_f32_e64 v84, v84
    v_cvt_pk_f16_f32 v62, v92, v93
    v_readlane_b32 s40, v84, 63
    s_sub_i32 s40, 126, s40
    s_max_i32 s40, s40, 67
    s_min_i32 s40, s40, 187
    s_lshl_b32 s40, s40, 23
    v_mov_b32 v78, 0x40053526
    v_mul_f32 v78, s40, v78
    v_mul_f32 v26, s40, v26
    s_mov_b64 exec, 1
    ds_write_b32 v31, v78 offset:0
    s_mov_b64 exec, -1
    s_branch L_scj_55
L_nosc_54:
    v_pk_mul_f32 v[90:91], v[32:33], s[54:55] op_sel_hi:[1,0]
    v_exp_f32 v90, v90
    v_cos_f32 v88, v91
    v_exp_f32 v94, v32
    v_sin_f32 v89, v91
    s_nop 0
    v_pk_mul_f32 v[88:89], v[88:89], v[90:91] op_sel_hi:[1,0]
    v_cos_f32 v92, v33
    v_cvt_pk_f16_f32 v45, v88, v89
    v_pk_mul_f32 v[90:91], v[88:89], v[88:89] op_sel:[1,1] op_sel_hi:[1,0] neg_lo:[1,0]
    v_sin_f32_e64 v93, v33
    v_pk_fma_f32 v[88:89], v[88:89], v[88:89], v[90:91] op_sel:[0,0,0] op_sel_hi:[0,1,1]
    v_cvt_pk_f16_f32 v46, v88, v89
    v_pk_mul_f32 v[92:93], v[92:93], v[94:95] op_sel_hi:[1,0]
    v_pk_mul_f32 v[90:91], v[88:89], v[88:89] op_sel:[1,1] op_sel_hi:[1,0] neg_lo:[1,0]
    v_pk_fma_f32 v[88:89], v[88:89], v[88:89], v[90:91] op_sel:[0,0,0] op_sel_hi:[0,1,1]
    v_cvt_pk_f16_f32 v48, v88, v89
    v_cvt_pk_f16_f32 v61, v92, v93
    v_pk_mul_f32 v[90:91], v[88:89], v[88:89] op_sel:[1,1] op_sel_hi:[1,0] neg_lo:[1,0]
    v_pk_fma_f32 v[88:89], v[88:89], v[88:89], v[90:91] op_sel:[0,0,0] op_sel_hi:[0,1,1]
    v_pk_mul_f32 v[94:95], v[92:93], v[92:93] op_sel:[1,1] op_sel_hi:[1,0] neg_lo:[1,0]
    v_cvt_pk_f16_f32 v52, v88, v89
    v_pk_mul_f32 v[90:91], v[88:89], v[88:89] op_sel:[1,1] op_sel_hi:[1,0] neg_lo:[1,0]
    v_pk_fma_f32 v[92:93], v[92:93], v[92:93], v[94:95] op_sel:[0,0,0] op_sel_hi:[0,1,1]
    v_pk_fma_f32 v[88:89], v[88:89], v[88:89], v[90:91] op_sel:[0,0,0] op_sel_hi:[0,1,1]
    v_cvt_pk_f16_f32 v60, v88, v89
    v_cvt_pk_f16_f32 v62, v92, v93
L_scj_55:
    v_pk_mul_f16 v47, v46, v45 op_sel:[1,1] op_sel_hi:[1,0] neg_lo:[1,0]
    v_pk_fma_f16 v47, v46, v45, v47 op_sel:[0,0,0] op_sel_hi:[0,1,1]
    ds_write_addtid_b32 v45 offset:272
    ds_write_addtid_b32 v46 offset:544
    v_pk_mul_f16 v49, v48, v45 op_sel:[1,1] op_sel_hi:[1,0] neg_lo:[1,0]
    v_pk_mul_f16 v50, v48, v46 op_sel:[1,1] op_sel_hi:[1,0] neg_lo:[1,0]
    v_pk_fma_f16 v49, v48, v45, v49 op_sel:[0,0,0] op_sel_hi:[0,1,1]
    v_pk_fma_f16 v50, v48, v46, v50 op_sel:[0,0,0] op_sel_hi:[0,1,1]
    ds_write_addtid_b32 v47 offset:816
    ds_write_addtid_b32 v48 offset:1088
    v_pk_mul_f16 v51, v48, v47 op_sel:[1,1] op_sel_hi:[1,0] neg_lo:[1,0]
    v_pk_fma_f16 v51, v48, v47, v51 op_sel:[0,0,0] op_sel_hi:[0,1,1]
    ds_write_addtid_b32 v49 offset:1360
    ds_write_addtid_b32 v50 offset:1632
    v_pk_mul_f32 v[90:91], v[88:89], v[88:89] op_sel:[1,1] op_sel_hi:[1,0] neg_lo:[1,0]
    v_pk_mul_f16 v53, v52, v45 op_sel:[1,1] op_sel_hi:[1,0] neg_lo:[1,0]
    v_pk_mul_f16 v54, v52, v46 op_sel:[1,1] op_sel_hi:[1,0] neg_lo:[1,0]
    v_pk_fma_f16 v53, v52, v45, v53 op_sel:[0,0,0] op_sel_hi:[0,1,1]
    v_pk_fma_f16 v54, v52, v46, v54 op_sel:[0,0,0] op_sel_hi:[0,1,1]
    ds_write_addtid_b32 v51 offset:1904
    ds_write_addtid_b32 v52 offset:2176
    v_pk_mul_f16 v55, v52, v47 op_sel:[1,1] op_sel_hi:[1,0] neg_lo:[1,0]
    v_pk_mul_f16 v56, v52, v48 op_sel:[1,1] op_sel_hi:[1,0] neg_lo:[1,0]
    v_pk_fma_f16 v55, v52, v47, v55 op_sel:[0,0,0] op_sel_hi:[0,1,1]
    v_pk_fma_f16 v56, v52, v48, v56 op_sel:[0,0,0] op_sel_hi:[0,1,1]
    ds_write_addtid_b32 v53 offset:2448
    ds_write_addtid_b32 v54 offset:2720
    v_pk_mul_f16 v57, v52, v49 op_sel:[1,1] op_sel_hi:[1,0] neg_lo:[1,0]
    v_pk_mul_f16 v58, v52, v50 op_sel:[1,1] op_sel_hi:[1,0] neg_lo:[1,0]
    v_pk_fma_f32 v[88:89], v[88:89], v[88:89], v[90:91] op_sel:[0,0,0] op_sel_hi:[0,1,1]
    v_pk_fma_f16 v57, v52, v49, v57 op_sel:[0,0,0] op_sel_hi:[0,1,1]
    v_pk_fma_f16 v58, v52, v50, v58 op_sel:[0,0,0] op_sel_hi:[0,1,1]
    ds_write_addtid_b32 v55 offset:2992
    ds_write_addtid_b32 v56 offset:3264
    v_pk_mul_f16 v59, v52, v51 op_sel:[1,1] op_sel_hi:[1,0] neg_lo:[1,0]
    v_pk_fma_f16 v59, v52, v51, v59 op_sel:[0,0,0] op_sel_hi:[0,1,1]
    ds_write_addtid_b32 v57 offset:3536
    ds_write_addtid_b32 v58 offset:3808
    v_pk_mul_f16 v80, v60, v45 op_sel:[1,1] op_sel_hi:[1,0] neg_lo:[1,0]
    v_pk_mul_f16 v81, v60, v46 op_sel:[1,1] op_sel_hi:[1,0] neg_lo:[1,0]
    v_pk_fma_f16 v80, v60, v45, v80 op_sel:[0,0,0] op_sel_hi:[0,1,1]
    v_pk_fma_f16 v81, v60, v46, v81 op_sel:[0,0,0] op_sel_hi:[0,1,1]
    ds_write_addtid_b32 v59 offset:4080
    ds_write_addtid_b32 v60 offset:4352
    v_cvt_pk_f16_f32 v64, v88, v89
    v_pk_mul_f16 v82, v60, v47 op_sel:[1,1] op_sel_hi:[1,0] neg_lo:[1,0]
    v_pk_mul_f16 v83, v60, v48 op_sel:[1,1] op_sel_hi:[1,0] neg_lo:[1,0]
    v_pk_fma_f16 v82, v60, v47, v82 op_sel:[0,0,0] op_sel_hi:[0,1,1]
    v_pk_fma_f16 v83, v60, v48, v83 op_sel:[0,0,0] op_sel_hi:[0,1,1]
    ds_write_addtid_b32 v80 offset:4624
    ds_write_addtid_b32 v81 offset:4896
    v_pk_mul_f16 v80, v60, v49 op_sel:[1,1] op_sel_hi:[1,0] neg_lo:[1,0]
    v_pk_mul_f16 v81, v60, v50 op_sel:[1,1] op_sel_hi:[1,0] neg_lo:[1,0]
    v_pk_fma_f16 v80, v60, v49, v80 op_sel:[0,0,0] op_sel_hi:[0,1,1]
    v_pk_fma_f16 v81, v60, v50, v81 op_sel:[0,0,0] op_sel_hi:[0,1,1]
    ds_write_addtid_b32 v82 offset:5168
    ds_write_addtid_b32 v83 offset:5440
    v_pk_mul_f16 v82, v60, v51 op_sel:[1,1] op_sel_hi:[1,0] neg_lo:[1,0]
    v_pk_mul_f16 v83, v60, v52 op_sel:[1,1] op_sel_hi:[1,0] neg_lo:[1,0]
    v_pk_mul_f32 v[90:91], v[88:89], v[88:89] op_sel:[1,1] op_sel_hi:[1,0] neg_lo:[1,0]
    v_pk_fma_f16 v82, v60, v51, v82 op_sel:[0,0,0] op_sel_hi:[0,1,1]
    v_pk_fma_f16 v83, v60, v52, v83 op_sel:[0,0,0] op_sel_hi:[0,1,1]
    ds_write_addtid_b32 v80 offset:5712
    ds_write_addtid_b32 v81 offset:5984
    v_pk_mul_f16 v80, v60, v53 op_sel:[1,1] op_sel_hi:[1,0] neg_lo:[1,0]
    v_pk_mul_f16 v81, v60, v54 op_sel:[1,1] op_sel_hi:[1,0] neg_lo:[1,0]
    v_pk_fma_f16 v80, v60, v53, v80 op_sel:[0,0,0] op_sel_hi:[0,1,1]
    v_pk_fma_f16 v81, v60, v54, v81 op_sel:[0,0,0] op_sel_hi:[0,1,1]
    ds_write_addtid_b32 v82 offset:6256
    ds_write_addtid_b32 v83 offset:6528
    v_pk_mul_f16 v82, v60, v55 op_sel:[1,1] op_sel_hi:[1,0] neg_lo:[1,0]
    v_pk_mul_f16 v83, v60, v56 op_sel:[1,1] op_sel_hi:[1,0] neg_lo:[1,0]
    v_pk_fma_f16 v82, v60, v55, v82 op_sel:[0,0,0] op_sel_hi:[0,1,1]
    v_pk_fma_f16 v83, v60, v56, v83 op_sel:[0,0,0] op_sel_hi:[0,1,1]
    v_pk_fma_f32 v[88:89], v[88:89], v[88:89], v[90:91] op_sel:[0,0,0] op_sel_hi:[0,1,1]
    ds_write_addtid_b32 v80 offset:6800
    ds_write_addtid_b32 v81 offset:7072
    v_pk_mul_f16 v80, v60, v57 op_sel:[1,1] op_sel_hi:[1,0] neg_lo:[1,0]
    v_pk_mul_f16 v81, v60, v58 op_sel:[1,1] op_sel_hi:[1,0] neg_lo:[1,0]
    v_pk_fma_f16 v80, v60, v57, v80 op_sel:[0,0,0] op_sel_hi:[0,1,1]
    v_pk_fma_f16 v81, v60, v58, v81 op_sel:[0,0,0] op_sel_hi:[0,1,1]
    ds_write_addtid_b32 v82 offset:7344
    ds_write_addtid_b32 v83 offset:7616
    v_pk_mul_f16 v82, v60, v59 op_sel:[1,1] op_sel_hi:[1,0] neg_lo:[1,0]
    v_pk_fma_f16 v82, v60, v59, v82 op_sel:[0,0,0] op_sel_hi:[0,1,1]
    ds_write_addtid_b32 v80 offset:7888
    ds_write_addtid_b32 v81 offset:8160
    ds_write_addtid_b32 v82 offset:8432
    v_cvt_pk_f16_f32 v65, v88, v89
    s_mov_b32 s46, 0
    ds_read_b32 v78, v31 offset:0
    s_waitcnt vmcnt(0)
    v_perm_b32 v92, v10, v10, s56
    v_perm_b32 v93, v11, v11, s56
    v_mul_f32 v34, 0x3ef5fdf0, v30
    s_branch L_spc_58
    s_nop 0
L_sp_56:
    ds_read_b32 v78, v31 offset:0
L_spc_58:
    s_waitcnt lgkmcnt(0)
    v_cmp_eq_u32 vcc, 0, v78
    s_cbranch_vccz L_spd_57
    s_add_u32 s46, s46, 1
    s_sleep 1
    s_cmp_lt_u32 s46, 400000
    s_cbranch_scc1 L_sp_56
    s_branch L_end
    s_nop 0
L_spd_57:
    v_mul_f32_e64 v34, v34, v78
    v_pk_mul_f32 v[92:93], v[92:93], v[34:35] op_sel_hi:[1,0] neg_hi:[1,0]
    v_cvt_pk_f16_f32 v67, v92, v93
    v_pk_mul_f16 v73, v67, v64 op_sel:[1,1] op_sel_hi:[1,0]
    v_pk_fma_f16 v73, v67, v64, v73 op_sel:[0,0,0] op_sel_hi:[0,1,1] neg_hi:[0,1,0]
    v_pk_mul_f16 v68, v67, v61 op_sel:[1,1] op_sel_hi:[1,0]
    v_pk_mul_f16 v69, v67, v62 op_sel:[1,1] op_sel_hi:[1,0]
    v_pk_fma_f16 v68, v67, v61, v68 op_sel:[0,0,0] op_sel_hi:[0,1,1] neg_hi:[0,1,0]
    v_pk_fma_f16 v69, v67, v62, v69 op_sel:[0,0,0] op_sel_hi:[0,1,1] neg_hi:[0,1,0]
    ds_write_addtid_b32 v67 offset:8704
    ds_write_addtid_b32 v73 offset:11696
    v_pk_mul_f16 v75, v73, v45 op_sel:[1,1] op_sel_hi:[1,0]
    v_pk_mul_f16 v70, v68, v62 op_sel:[1,1] op_sel_hi:[1,0]
    v_pk_fma_f16 v75, v73, v45, v75 op_sel:[0,0,0] op_sel_hi:[0,1,1] neg_hi:[0,1,0]
    v_pk_fma_f16 v70, v68, v62, v70 op_sel:[0,0,0] op_sel_hi:[0,1,1] neg_hi:[0,1,0]
    ds_write_addtid_b32 v68 offset:8976
    ds_write_addtid_b32 v69 offset:9248
    v_pk_mul_f16 v71, v69, v62 op_sel:[1,1] op_sel_hi:[1,0]
    v_pk_mul_f16 v76, v75, v64 op_sel:[1,1] op_sel_hi:[1,0]
    v_pk_fma_f16 v71, v69, v62, v71 op_sel:[0,0,0] op_sel_hi:[0,1,1] neg_hi:[0,1,0]
    v_pk_fma_f16 v76, v75, v64, v76 op_sel:[0,0,0] op_sel_hi:[0,1,1] neg_hi:[0,1,0]
    ds_write_addtid_b32 v75 offset:10064
    ds_write_addtid_b32 v70 offset:9520
    v_pk_mul_f16 v77, v75, v65 op_sel:[1,1] op_sel_hi:[1,0]
    v_pk_mul_f16 v63, v70, v62 op_sel:[1,1] op_sel_hi:[1,0]
    v_pk_fma_f16 v77, v75, v65, v77 op_sel:[0,0,0] op_sel_hi:[0,1,1] neg_hi:[0,1,0]
    v_pk_fma_f16 v63, v70, v62, v63 op_sel:[0,0,0] op_sel_hi:[0,1,1] neg_hi:[0,1,0]
    ds_write_addtid_b32 v71 offset:12240
    ds_write_addtid_b32 v76 offset:13600
    v_pk_mul_f16 v72, v71, v62 op_sel:[1,1] op_sel_hi:[1,0]
    v_pk_mul_f16 v74, v71, v64 op_sel:[1,1] op_sel_hi:[1,0]
    v_pk_fma_f16 v72, v71, v62, v72 op_sel:[0,0,0] op_sel_hi:[0,1,1] neg_hi:[0,1,0]
    v_pk_fma_f16 v74, v71, v64, v74 op_sel:[0,0,0] op_sel_hi:[0,1,1] neg_hi:[0,1,0]
    ds_write_addtid_b32 v77 offset:10608
    ds_write_addtid_b32 v63 offset:12512
    v_pk_mul_f16 v66, v76, v65 op_sel:[1,1] op_sel_hi:[1,0]
    v_pk_mul_f16 v79, v77, v65 op_sel:[1,1] op_sel_hi:[1,0]
    v_pk_fma_f16 v66, v76, v65, v66 op_sel:[0,0,0] op_sel_hi:[0,1,1] neg_hi:[0,1,0]
    v_pk_fma_f16 v79, v77, v65, v79 op_sel:[0,0,0] op_sel_hi:[0,1,1] neg_hi:[0,1,0]
    ds_write_addtid_b32 v72 offset:12784
    ds_write_addtid_b32 v74 offset:11424
    v_pk_mul_f16 v80, v63, v62 op_sel:[1,1] op_sel_hi:[1,0]
    v_pk_mul_f16 v81, v69, v64 op_sel:[1,1] op_sel_hi:[1,0]
    v_pk_fma_f16 v80, v63, v62, v80 op_sel:[0,0,0] op_sel_hi:[0,1,1] neg_hi:[0,1,0]
    v_pk_fma_f16 v81, v69, v64, v81 op_sel:[0,0,0] op_sel_hi:[0,1,1] neg_hi:[0,1,0]
    ds_write_addtid_b32 v66 offset:13872
    ds_write_addtid_b32 v79 offset:10880
    v_pk_mul_f16 v82, v72, v64 op_sel:[1,1] op_sel_hi:[1,0]
    v_pk_mul_f16 v83, v71, v65 op_sel:[1,1] op_sel_hi:[1,0]
    v_pk_fma_f16 v82, v72, v64, v82 op_sel:[0,0,0] op_sel_hi:[0,1,1] neg_hi:[0,1,0]
    v_pk_fma_f16 v83, v71, v65, v83 op_sel:[0,0,0] op_sel_hi:[0,1,1] neg_hi:[0,1,0]
    ds_write_addtid_b32 v80 offset:13056
    ds_write_addtid_b32 v81 offset:11968
    v_pk_mul_f16 v80, v74, v65 op_sel:[1,1] op_sel_hi:[1,0]
    v_pk_mul_f16 v81, v66, v65 op_sel:[1,1] op_sel_hi:[1,0]
    v_pk_fma_f16 v80, v74, v65, v80 op_sel:[0,0,0] op_sel_hi:[0,1,1] neg_hi:[0,1,0]
    v_pk_fma_f16 v81, v66, v65, v81 op_sel:[0,0,0] op_sel_hi:[0,1,1] neg_hi:[0,1,0]
    ds_write_addtid_b32 v82 offset:9792
    ds_write_addtid_b32 v83 offset:13328
    v_pk_mul_f16 v82, v79, v65 op_sel:[1,1] op_sel_hi:[1,0]
    v_pk_fma_f16 v82, v79, v65, v82 op_sel:[0,0,0] op_sel_hi:[0,1,1] neg_hi:[0,1,0]
    ds_write_addtid_b32 v80 offset:10336
    ds_write_addtid_b32 v81 offset:14144
    ds_write_addtid_b32 v82 offset:11152
    s_mov_b64 exec, 1
    ds_add_u32 v3, v0 offset:80
    s_mov_b64 exec, -1
    s_cmp_lg_u32 s59, 0
    s_cbranch_scc1 L_recv_59
    s_nop 0
    s_setprio 2
    ds_read_b128 v[88:91], v16 offset:8704
    ds_read_b128 v[92:95], v17 offset:0
    ds_read_b128 v[96:99], v16 offset:8736
    ds_read_b128 v[100:103], v17 offset:32
    ds_read_b128 v[104:107], v16 offset:8768
    ds_read_b128 v[108:111], v17 offset:64
    ds_read_b128 v[44:47], v16 offset:8800
    ds_read_b128 v[48:51], v17 offset:96
    s_waitcnt lgkmcnt(6)
    v_mfma_f32_32x32x16_f16 v[112:127], v[88:91], v[92:95], 0
    ds_read_b128 v[88:91], v16 offset:8832
    ds_read_b128 v[92:95], v17 offset:128
    s_waitcnt lgkmcnt(6)
    v_mfma_f32_32x32x16_f16 v[112:127], v[96:99], v[100:103], v[112:127]
    ds_read_b128 v[96:99], v16 offset:8864
    ds_read_b128 v[100:103], v17 offset:160
    s_waitcnt lgkmcnt(6)
    v_mfma_f32_32x32x16_f16 v[112:127], v[104:107], v[108:111], v[112:127]
    ds_read_b128 v[104:107], v16 offset:8896
    ds_read_b128 v[108:111], v17 offset:192
    s_waitcnt lgkmcnt(6)
    v_mfma_f32_32x32x16_f16 v[112:127], v[44:47], v[48:51], v[112:127]
    ds_read_b128 v[44:47], v16 offset:8928
    ds_read_b128 v[48:51], v17 offset:224
    s_waitcnt lgkmcnt(6)
    v_mfma_f32_32x32x16_f16 v[112:127], v[88:91], v[92:95], v[112:127]
    s_waitcnt lgkmcnt(4)
    v_mfma_f32_32x32x16_f16 v[112:127], v[96:99], v[100:103], v[112:127]
    s_waitcnt lgkmcnt(2)
    v_mfma_f32_32x32x16_f16 v[112:127], v[104:107], v[108:111], v[112:127]
    s_waitcnt lgkmcnt(0)
    v_mfma_f32_32x32x16_f16 v[112:127], v[44:47], v[48:51], v[112:127]
    s_mov_b32 s46, 0
L_sp_61:
    ds_read_b32 v85, v24 offset:96
    s_waitcnt lgkmcnt(0)
    v_cmp_gt_u32 vcc, 1, v85
    s_cbranch_vccz L_spd_62
    s_add_u32 s46, s46, 1
    s_cmp_lt_u32 s46, 400000
    s_cbranch_scc1 L_sp_61
    s_branch L_end
L_spd_62:
    s_setprio 3
    ds_read_b128 v[88:91], v36 offset:8704
    ds_read_b128 v[92:95], v37 offset:0
    ds_read_b128 v[96:99], v36 offset:8736
    ds_read_b128 v[100:103], v37 offset:32
    ds_read_b128 v[104:107], v36 offset:8768
    ds_read_b128 v[108:111], v37 offset:64
    ds_read_b128 v[44:47], v36 offset:8800
    ds_read_b128 v[48:51], v37 offset:96
    s_waitcnt lgkmcnt(6)
    v_mfma_f32_32x32x16_f16 v[112:127], v[88:91], v[92:95], v[112:127]
    ds_read_b128 v[88:91], v36 offset:8832
    ds_read_b128 v[92:95], v37 offset:128
    s_waitcnt lgkmcnt(6)
    v_mfma_f32_32x32x16_f16 v[112:127], v[96:99], v[100:103], v[112:127]
    ds_read_b128 v[96:99], v36 offset:8864
    ds_read_b128 v[100:103], v37 offset:160
    s_waitcnt lgkmcnt(6)
    v_mfma_f32_32x32x16_f16 v[112:127], v[104:107], v[108:111], v[112:127]
    ds_read_b128 v[104:107], v36 offset:8896
    ds_read_b128 v[108:111], v37 offset:192
    s_waitcnt lgkmcnt(6)
    v_mfma_f32_32x32x16_f16 v[112:127], v[44:47], v[48:51], v[112:127]
    ds_read_b128 v[44:47], v36 offset:8928
    ds_read_b128 v[48:51], v37 offset:224
    s_waitcnt lgkmcnt(6)
    v_mfma_f32_32x32x16_f16 v[112:127], v[88:91], v[92:95], v[112:127]
    s_waitcnt lgkmcnt(4)
    v_mfma_f32_32x32x16_f16 v[112:127], v[96:99], v[100:103], v[112:127]
    s_waitcnt lgkmcnt(2)
    v_mfma_f32_32x32x16_f16 v[112:127], v[104:107], v[108:111], v[112:127]
    s_waitcnt lgkmcnt(0)
    v_mfma_f32_32x32x16_f16 v[112:127], v[44:47], v[48:51], v[112:127]
    s_mov_b64 exec, 1
    ds_add_u32 v3, v0 offset:84
    s_mov_b64 exec, -1
    s_mov_b64 exec, 1
    ds_write_b32 v24, v0 offset:112
    s_mov_b64 exec, -1
    s_nop 5
    v_cvt_pkrtz_f16_f32 v109, v122, v123
    v_add_f32 v112, v112, v26
    v_cvt_pkrtz_f16_f32 v88, v119, v118
    v_cvt_pkrtz_f16_f32 v89, v117, v116
    v_mov_b32_dpp v85, v109 quad_perm:[1,0,3,2] row_mask:0xf bank_mask:0xf
    v_cvt_pkrtz_f16_f32 v90, v115, v114
    v_cvt_pkrtz_f16_f32 v91, v113, v112
    v_cvt_pkrtz_f16_f32 v108, v121, v120
    v_bfi_b32 v88, s61, v40, v88
    v_bfi_b32 v89, s61, v41, v89
    v_bfi_b32 v90, s61, v42, v90
    v_bfi_b32 v91, s61, v43, v91
    v_perm_b32 v109, v85, v109, v5
    global_store_dwordx4 v2, v[88:91], s[62:63] sc1
    v_bfi_b32 v108, s61, v40, v108
    v_bfi_b32 v109, s61, v41, v109
    global_store_dwordx2 v27, v[108:109], s[62:63] offset:1024 sc1
    v_mov_b32 v79, s39
    s_mov_b64 exec, 1
    global_store_dwordx2 v3, v[78:79], s[62:63] offset:2040 sc1
    s_mov_b64 exec, -1
    ds_read_b128 v[44:47], v2 offset:4864
    ds_read_b128 v[48:51], v2 offset:5888
    ds_read_b128 v[52:55], v2 offset:6912
    ds_read_b128 v[56:59], v2 offset:7936
    s_branch L_arr_60
L_recv_59:
    s_mov_b64 exec, 1
    ds_write_b32 v24, v0 offset:96
    s_mov_b64 exec, -1
    ds_read_b128 v[44:47], v2 offset:4864
    ds_read_b128 v[48:51], v2 offset:5888
    ds_read_b128 v[52:55], v2 offset:6912
    ds_read_b128 v[56:59], v2 offset:7936
    v_xor_b32_e64 v31, 16, v31
    s_load_dword s42, s[62:63], 2040 glc
    s_mov_b32 s46, 0
L_sp_63:
    ds_read_b32 v85, v24 offset:112
    s_waitcnt lgkmcnt(0)
    v_cmp_gt_u32 vcc, 1, v85
    s_cbranch_vccz L_spd_64
    s_add_u32 s46, s46, 1
    s_sleep 2
    s_cmp_lt_u32 s46, 400000
    s_cbranch_scc1 L_sp_63
    s_branch L_end
    s_nop 0
L_spd_64:
    s_mov_b32 s46, 0
L_km_65:
    s_load_dwordx2 s[42:43], s[62:63], 2040 glc
    s_add_u32 s46, s46, 1
    s_cmp_gt_u32 s46, 50000
    s_cbranch_scc1 L_end
    s_waitcnt lgkmcnt(0)
    s_cmp_lg_u32 s43, s39
    s_cbranch_scc1 L_km_65
    s_mov_b32 s46, 0
L_ka_66:
    global_load_dwordx4 v[88:91], v2, s[62:63] sc1
    global_load_dwordx2 v[108:109], v27, s[62:63] offset:1024 sc1
    v_mov_b32 v110, s42
    s_mov_b64 exec, 1
    ds_write_b32 v31, v110 offset:0
    s_mov_b64 exec, -1
    s_add_u32 s46, s46, 1
    s_cmp_gt_u32 s46, 50000
    s_cbranch_scc1 L_end
    s_waitcnt vmcnt(1)
    v_xor_b32_e64 v85, v88, v40
    v_bitop3_b32 v85, v85, v89, v41 bitop3:0xf6
    v_bitop3_b32 v85, v85, v90, v42 bitop3:0xf6
    v_bitop3_b32 v85, v85, v91, v43 bitop3:0xf6
    s_nop 0
    s_waitcnt vmcnt(0)
    v_bitop3_b32 v85, v85, v108, v40 bitop3:0xf6
    v_bitop3_b32 v85, v85, v109, v41 bitop3:0xf6
    v_and_b32 v85, 0x00010001, v85
    v_cmp_ne_u32 vcc, 0, v85
    s_cbranch_vccnz L_ka_66
L_arr_60:
    ds_write_b128 v25, v[88:91]
    v_alignbit_b32 v92, v89, v88, 16
    v_readlane_b32 s40, v88, 63
    v_readlane_b32 s53, v108, 63
    v_readlane_b32 s41, v92, 63
    v_mov_b32_dpp v99, v88 wave_shr:1 row_mask:0xf bank_mask:0xf bound_ctrl:0
    s_pack_ll_b32_b16 s42, s40, s40
    v_alignbit_b32 v93, v90, v89, 16
    v_alignbit_b32 v94, v91, v90, 16
    v_alignbit_b32 v95, v99, v91, 16
    v_mov_b32 v104, 0
    ds_write_b128 v25, v[92:95] offset:1088
    v_and_b32 v105, s42, v21
    v_and_b32 v106, s42, v22
    v_and_b32_e64 v107, s42, v23
    v_writelane_b32 v107, s40, 11
    v_writelane_b32 v107, s41, 15
    ds_write_b128 v20, v[104:107]
    v_mov_b32_dpp v111, v89 wave_shr:1 row_mask:0xf bank_mask:0xf bound_ctrl:0
    ds_write2_b32 v18, v108, v108 offset0:0 offset1:225
    s_pack_ll_b32_b16 s53, s53, s53
    ds_write2_b32 v19, v109, v109 offset0:0 offset1:225
    v_mov_b32 v96, v89
    v_mov_b32 v97, v90
    v_mov_b32 v98, v91
    ds_write_b128 v25, v[96:99] offset:2176
    v_mov_b32 v100, v93
    v_mov_b32 v101, v94
    v_mov_b32_e64 v102, v95
    v_alignbit_b32 v103, v111, v99, 16
    ds_write_b128 v25, v[100:103] offset:3264
    v_pk_mul_f16 v12, v12, s53
    v_pk_mul_f16 v13, v13, s53
    v_pk_mul_f16 v14, v14, s53
    v_pk_mul_f16 v15, v15, s53
    v_mov_b32_e64 v5, v24
    s_cmp_lg_u32 s38, 0
    s_cbranch_scc1 L_set1_67
    ds_read_b64 v[32:33], v7 offset:512
    ds_read_b64 v[34:35], v7 offset:520
    ds_read_b64 v[36:37], v7 offset:448
    ds_read_b64 v[38:39], v7 offset:456
    ds_read_b64 v[40:41], v6 offset:576
    ds_read_b64 v[42:43], v6 offset:584
    ds_read_b64 v[60:61], v6 offset:64
    ds_read_b64 v[62:63], v6 offset:72
    ds_read_b64 v[64:65], v7 offset:576
    ds_read_b64 v[66:67], v7 offset:584
    ds_read_b64 v[68:69], v6 offset:640
    ds_read_b64 v[70:71], v6 offset:648
    ds_read_b64 v[72:73], v6 offset:128
    ds_read_b64 v[74:75], v6 offset:136
    ds_read_b64 v[76:77], v6 offset:704
    ds_read_b64 v[78:79], v6 offset:712
    ds_read_b64 v[80:81], v6 offset:192
    ds_read_b64 v[82:83], v6 offset:200
    s_mov_b32 s46, 0
L_sp_68:
    ds_read_b32 v5, v3 offset:48
    s_waitcnt lgkmcnt(0)
    v_cmp_gt_u32 vcc, 2, v5
    s_cbranch_vccz L_spd_69
    s_add_u32 s46, s46, 1
    s_sleep 2
    s_cmp_lt_u32 s46, 400000
    s_cbranch_scc1 L_sp_68
    s_branch L_end
    s_nop 0
L_spd_69:
    s_setprio 2
    ds_read_b128 v[84:87], v4 offset:496
    ds_read_b128 v[8:11], v4 offset:480
    ds_read_b128 v[16:19], v4 offset:1536
    ds_read_b128 v[20:23], v4 offset:1008
    ds_read_b128 v[24:27], v4 offset:992
    s_waitcnt lgkmcnt(4)
    v_mfma_f32_16x16x32_f16 v[28:31], v[84:87], v[52:55], 0
    ds_read_b128 v[88:91], v4 offset:48
    s_waitcnt lgkmcnt(4)
    v_mfma_f32_16x16x32_f16 v[96:99], v[8:11], v[56:59], 0
    ds_read_b64 v[92:93], v6 offset:768
    s_waitcnt lgkmcnt(4)
    v_mfma_f32_16x16x32_f16 v[104:107], v[12:15], v[16:19], 0
    ds_read_b64 v[94:95], v6 offset:776
    s_waitcnt lgkmcnt(4)
    v_mfma_f32_16x16x32_f16 v[112:115], v[20:23], v[52:55], 0
    ds_read_b64 v[100:101], v6 offset:256
    s_nop 0
    v_cvt_pkrtz_f16_f32 v28, v28, v96
    v_cvt_pkrtz_f16_f32 v29, v29, v97
    s_waitcnt lgkmcnt(4)
    v_mfma_f32_16x16x32_f16 v[120:123], v[24:27], v[56:59], 0
    ds_read_b64 v[102:103], v6 offset:264
    v_cvt_pkrtz_f16_f32 v30, v30, v98
    v_cvt_pkrtz_f16_f32 v31, v31, v99
    s_nop 1
    v_mfma_f32_16x16x32_f16 v[104:107], v[28:31], v[32:35], v[104:107]
    ds_read_b128 v[124:127], v4 offset:112
    v_mfma_f32_16x16x32_f16 v[16:19], v[28:31], v[36:39], 0
    ds_read_b128 v[20:23], v4 offset:176
    s_waitcnt lgkmcnt(6)
    v_mfma_f32_16x16x32_f16 v[96:99], v[40:43], v[88:91], 0
    ds_read_b64 v[108:109], v6 offset:832
    v_cvt_pkrtz_f16_f32 v112, v112, v120
    v_cvt_pkrtz_f16_f32 v113, v113, v121
    v_mfma_f32_16x16x32_f16 v[28:31], v[60:63], v[88:91], 0
    ds_read_b64 v[110:111], v6 offset:840
    ds_read_b64 v[116:117], v6 offset:320
    v_cvt_pkrtz_f16_f32 v114, v114, v122
    v_cvt_pkrtz_f16_f32 v115, v115, v123
    s_nop 0
    s_nop 1
    v_mfma_f32_16x16x32_f16 v[104:107], v[112:115], v[64:67], v[104:107]
    ds_read_b128 v[60:63], v4 offset:240
    ds_read_b64 v[118:119], v6 offset:328
    ds_read_b64 v[84:85], v6 offset:896
    ds_read_b64 v[86:87], v6 offset:904
    v_mfma_f32_16x16x32_f16 v[16:19], v[112:115], v[32:35], v[16:19]
    ds_read_b128 v[32:35], v4 offset:304
    ds_read_b64 v[8:9], v6 offset:384
    s_waitcnt lgkmcnt(10)
    v_mfma_f32_16x16x32_f16 v[96:99], v[68:71], v[124:127], v[96:99]
    ds_read_b64 v[10:11], v6 offset:392
    v_mfma_f32_16x16x32_f16 v[28:31], v[72:75], v[124:127], v[28:31]
    ds_read_b128 v[112:115], v4 offset:368
    ds_read_b64 v[24:25], v6 offset:960
    s_waitcnt lgkmcnt(12)
    v_mfma_f32_16x16x32_f16 v[96:99], v[76:79], v[20:23], v[96:99]
    ds_read_b64 v[26:27], v6 offset:968
    v_mfma_f32_16x16x32_f16 v[28:31], v[80:83], v[20:23], v[28:31]
    ds_read_b128 v[72:75], v4 offset:432
    ds_read_b64 v[36:37], v6 offset:448
    s_nop 0
    s_waitcnt lgkmcnt(11)
    v_mfma_f32_16x16x32_f16 v[96:99], v[92:95], v[60:63], v[96:99]
    ds_read_b64 v[38:39], v6 offset:456
    v_mfma_f32_16x16x32_f16 v[28:31], v[100:103], v[60:63], v[28:31]
    ds_read_b64 v[88:89], v6 offset:1024
    ds_read_b64 v[90:91], v6 offset:1032
    s_waitcnt lgkmcnt(10)
    v_mfma_f32_16x16x32_f16 v[96:99], v[108:111], v[32:35], v[96:99]
    ds_read_b128 v[124:127], v4 offset:496
    v_mfma_f32_16x16x32_f16 v[28:31], v[116:119], v[32:35], v[28:31]
    ds_read_b64 v[120:121], v6 offset:512
    s_waitcnt lgkmcnt(9)
    v_mfma_f32_16x16x32_f16 v[96:99], v[84:87], v[112:115], v[96:99]
    ds_read_b64 v[122:123], v6 offset:520
    v_mfma_f32_16x16x32_f16 v[28:31], v[8:11], v[112:115], v[28:31]
    ds_read_b128 v[80:83], v4 offset:560
    s_waitcnt lgkmcnt(9)
    s_waitcnt lgkmcnt(8)
    v_mfma_f32_16x16x32_f16 v[96:99], v[24:27], v[72:75], v[96:99]
    ds_read_b128 v[20:23], v4 offset:624
    s_waitcnt lgkmcnt(7)
    v_mfma_f32_16x16x32_f16 v[28:31], v[36:39], v[72:75], v[28:31]
    ds_read_b128 v[100:103], v4 offset:688
    s_waitcnt lgkmcnt(6)
    s_waitcnt lgkmcnt(5)
    v_mfma_f32_16x16x32_f16 v[96:99], v[88:91], v[124:127], v[96:99]
    ds_read_b128 v[60:63], v4 offset:752
    s_waitcnt lgkmcnt(4)
    v_mfma_f32_16x16x32_f16 v[28:31], v[120:123], v[124:127], v[28:31]
    ds_read_b128 v[116:119], v4 offset:1520
    s_waitcnt lgkmcnt(4)
    v_mfma_f32_16x16x32_f16 v[28:31], v[40:43], v[80:83], v[28:31]
    ds_read_b128 v[32:35], v4 offset:1504
    s_waitcnt lgkmcnt(4)
    v_mfma_f32_16x16x32_f16 v[28:31], v[68:71], v[20:23], v[28:31]
    v_cvt_pk_f16_f32 v96, v96, v97
    v_cvt_pk_f16_f32 v97, v98, v99
    ds_write_b64 v1, v[96:97] offset:0
    s_mov_b64 exec, 1
    ds_add_u32 v3, v0 offset:64
    s_mov_b64 exec, -1
    s_setprio 1
    s_waitcnt lgkmcnt(5)
    v_mfma_f32_16x16x32_f16 v[28:31], v[76:79], v[100:103], v[28:31]
    s_waitcnt lgkmcnt(4)
    v_mfma_f32_16x16x32_f16 v[28:31], v[92:95], v[60:63], v[28:31]
    ds_read_b128 v[8:11], v4 offset:816
    s_waitcnt lgkmcnt(4)
    v_mfma_f32_16x16x32_f16 v[112:115], v[116:119], v[44:47], 0
    ds_read_b128 v[36:39], v4 offset:880
    v_mfma_f32_16x16x32_f16 v[72:75], v[116:119], v[48:51], 0
    ds_read_b128 v[120:123], v4 offset:944
    v_mfma_f32_16x16x32_f16 v[80:83], v[116:119], v[52:55], 0
    ds_read_b128 v[20:23], v4 offset:1008
    s_waitcnt lgkmcnt(6)
    v_mfma_f32_16x16x32_f16 v[96:99], v[32:35], v[56:59], 0
    ds_read_b128 v[100:103], v4 offset:2032
    v_mfma_f32_16x16x32_f16 v[60:63], v[32:35], v[44:47], 0
    ds_read_b64 v[124:125], v7 offset:0
    v_mfma_f32_16x16x32_f16 v[116:119], v[32:35], v[48:51], 0
    ds_read_b64 v[126:127], v7 offset:8
    s_waitcnt lgkmcnt(6)
    v_mfma_f32_16x16x32_f16 v[28:31], v[108:111], v[8:11], v[28:31]
    ds_read_b128 v[8:11], v4 offset:2016
    s_waitcnt lgkmcnt(6)
    v_mfma_f32_16x16x32_f16 v[28:31], v[84:87], v[36:39], v[28:31]
    ds_read_b64 v[32:33], v7 offset:640
    s_waitcnt lgkmcnt(6)
    v_mfma_f32_16x16x32_f16 v[28:31], v[24:27], v[120:123], v[28:31]
    ds_read_b64 v[34:35], v7 offset:648
    s_waitcnt lgkmcnt(6)
    v_mfma_f32_16x16x32_f16 v[28:31], v[88:91], v[20:23], v[28:31]
    ds_read_b64 v[36:37], v7 offset:192
    s_waitcnt lgkmcnt(6)
    v_mfma_f32_16x16x32_f16 v[120:123], v[100:103], v[44:47], 0
    ds_read_b64 v[38:39], v7 offset:200
    v_cvt_pkrtz_f16_f32 v112, v112, v72
    v_cvt_pkrtz_f16_f32 v113, v113, v73
    v_mfma_f32_16x16x32_f16 v[20:23], v[100:103], v[48:51], 0
    v_cvt_pkrtz_f16_f32 v114, v114, v74
    v_cvt_pkrtz_f16_f32 v115, v115, v75
    v_mfma_f32_16x16x32_f16 v[72:75], v[100:103], v[52:55], 0
    ds_read_b64 v[52:53], v7 offset:64
    v_cvt_pk_f16_f32 v28, v28, v29
    v_cvt_pk_f16_f32 v29, v30, v31
    ds_write_b64 v1, v[28:29] offset:512
    s_mov_b64 exec, 1
    ds_add_u32 v3, v0 offset:68
    s_mov_b64 exec, -1
    s_setprio 0
    v_cvt_pkrtz_f16_f32 v80, v80, v96
    v_cvt_pkrtz_f16_f32 v81, v81, v97
    s_waitcnt lgkmcnt(7)
    v_mfma_f32_16x16x32_f16 v[28:31], v[8:11], v[56:59], 0
    ds_read_b32 v5, v3 offset:56
    ds_read_b64 v[54:55], v7 offset:72
    v_cvt_pkrtz_f16_f32 v82, v82, v98
    v_cvt_pkrtz_f16_f32 v83, v83, v99
    v_mfma_f32_16x16x32_f16 v[56:59], v[8:11], v[44:47], 0
    ds_read_b64 v[100:101], v7 offset:256
    v_cvt_pkrtz_f16_f32 v60, v60, v116
    v_cvt_pkrtz_f16_f32 v61, v61, v117
    v_mfma_f32_16x16x32_f16 v[96:99], v[8:11], v[48:51], 0
    ds_read_b64 v[102:103], v7 offset:264
    v_cvt_pkrtz_f16_f32 v62, v62, v118
    v_cvt_pkrtz_f16_f32 v63, v63, v119
    v_mfma_f32_16x16x32_f16 v[104:107], v[112:115], v[124:127], v[104:107]
    ds_read_b64 v[8:9], v6 offset:0
    s_waitcnt lgkmcnt(10)
    v_mfma_f32_16x16x32_f16 v[104:107], v[80:83], v[32:35], v[104:107]
    ds_read_b64 v[10:11], v6 offset:8
    v_mfma_f32_16x16x32_f16 v[16:19], v[80:83], v[64:67], v[16:19]
    s_waitcnt lgkmcnt(5)
    v_cmp_gt_u32 vcc, 2, v5
    s_cbranch_vccz L_x2_70
    s_mov_b32 s46, 0
L_sp_71:
    ds_read_b32 v5, v3 offset:56
    s_waitcnt lgkmcnt(0)
    v_cmp_gt_u32 vcc, 2, v5
    s_cbranch_vccz L_spd_72
    s_add_u32 s46, s46, 1
    s_sleep 1
    s_cmp_lt_u32 s46, 400000
    s_cbranch_scc1 L_sp_71
    s_branch L_end
L_spd_72:
L_x2_70:
    ds_read_b128 v[64:67], v4 offset:2048
    v_mfma_f32_16x16x32_f16 v[104:107], v[60:63], v[36:39], v[104:107]
    ds_read_b64 v[116:117], v6 offset:64
    v_cvt_pkrtz_f16_f32 v120, v120, v20
    v_cvt_pkrtz_f16_f32 v121, v121, v21
    v_cvt_pkrtz_f16_f32 v122, v122, v22
    v_cvt_pkrtz_f16_f32 v123, v123, v23
    v_cvt_pkrtz_f16_f32 v72, v72, v28
    v_cvt_pkrtz_f16_f32 v73, v73, v29
    v_cvt_pkrtz_f16_f32 v74, v74, v30
    v_cvt_pkrtz_f16_f32 v75, v75, v31
    v_cvt_pkrtz_f16_f32 v56, v56, v96
    v_cvt_pkrtz_f16_f32 v57, v57, v97
    v_cvt_pkrtz_f16_f32 v58, v58, v98
    v_cvt_pkrtz_f16_f32 v59, v59, v99
    s_waitcnt lgkmcnt(6)
    s_nop 0
    v_mfma_f32_16x16x32_f16 v[104:107], v[120:123], v[52:55], v[104:107]
    ds_read_b128 v[60:63], v4 offset:2544
    v_mfma_f32_16x16x32_f16 v[16:19], v[120:123], v[124:127], v[16:19]
    ds_read_b64 v[118:119], v6 offset:72
    ds_read_b128 v[28:31], v4 offset:2608
    v_mfma_f32_16x16x32_f16 v[16:19], v[72:75], v[32:35], v[16:19]
    ds_read_b128 v[124:127], v4 offset:2544
    s_waitcnt lgkmcnt(8)
    s_nop 0
    v_mfma_f32_16x16x32_f16 v[104:107], v[56:59], v[100:103], v[104:107]
    ds_read_b128 v[120:123], v4 offset:2528
    ds_read_b64 v[112:113], v6 offset:128
    v_mfma_f32_16x16x32_f16 v[16:19], v[56:59], v[36:39], v[16:19]
    ds_read_b64 v[114:115], v6 offset:136
    s_waitcnt lgkmcnt(8)
    v_mfma_f32_16x16x32_f16 v[16:19], v[12:15], v[64:67], v[16:19]
    ds_read_b128 v[32:35], v4 offset:2672
    ds_read_b64 v[80:81], v6 offset:192
    s_waitcnt lgkmcnt(8)
    v_mfma_f32_16x16x32_f16 v[104:107], v[8:11], v[60:63], v[104:107]
    ds_read_b64 v[82:83], v6 offset:200
    ds_read_b128 v[72:75], v4 offset:2736
    s_waitcnt lgkmcnt(9)
    s_waitcnt lgkmcnt(8)
    v_mfma_f32_16x16x32_f16 v[104:107], v[116:119], v[28:31], v[104:107]
    ds_read_b64 v[20:21], v6 offset:256
    ds_read_b64 v[22:23], v6 offset:264
    s_nop 0
    s_waitcnt lgkmcnt(9)
    v_mfma_f32_16x16x32_f16 v[56:59], v[124:127], v[44:47], 0
    ds_read_b128 v[36:39], v4 offset:2800
    ds_read_b64 v[96:97], v6 offset:320
    v_mfma_f32_16x16x32_f16 v[64:67], v[124:127], v[48:51], 0
    ds_read_b64 v[98:99], v6 offset:328
    s_nop 0
    s_waitcnt lgkmcnt(11)
    v_mfma_f32_16x16x32_f16 v[28:31], v[120:123], v[44:47], 0
    ds_read_b128 v[12:15], v4 offset:2864
    v_mfma_f32_16x16x32_f16 v[124:127], v[120:123], v[48:51], 0
    ds_read_b128 v[60:63], v4 offset:2928
    ds_read_b64 v[120:121], v6 offset:384
    ds_read_b64 v[122:123], v6 offset:392
    s_waitcnt lgkmcnt(13)
    s_waitcnt lgkmcnt(12)
    v_mfma_f32_16x16x32_f16 v[104:107], v[112:115], v[32:35], v[104:107]
    ds_read_b128 v[32:35], v4 offset:2992
    s_waitcnt lgkmcnt(11)
    s_waitcnt lgkmcnt(10)
    v_mfma_f32_16x16x32_f16 v[104:107], v[80:83], v[72:75], v[104:107]
    ds_read_b64 v[72:73], v6 offset:448
    ds_read_b64 v[74:75], v6 offset:456
    s_waitcnt lgkmcnt(10)
    s_waitcnt lgkmcnt(9)
    v_mfma_f32_16x16x32_f16 v[104:107], v[20:23], v[36:39], v[104:107]
    ds_read_b64 v[36:37], v7 offset:128
    ds_read_b64 v[38:39], v7 offset:136
    v_cvt_pkrtz_f16_f32 v56, v56, v64
    v_cvt_pkrtz_f16_f32 v57, v57, v65
    s_waitcnt lgkmcnt(9)
    s_waitcnt lgkmcnt(8)
    v_mfma_f32_16x16x32_f16 v[104:107], v[96:99], v[12:15], v[104:107]
    ds_read_b64 v[12:13], v7 offset:320
    ds_read_b64 v[14:15], v7 offset:328
    v_cvt_pkrtz_f16_f32 v58, v58, v66
    v_cvt_pkrtz_f16_f32 v59, v59, v67
    s_nop 0
    s_waitcnt lgkmcnt(7)
    v_mfma_f32_16x16x32_f16 v[104:107], v[120:123], v[60:63], v[104:107]
    ds_read_b128 v[64:67], v4 offset:3056
    ds_read_b64 v[60:61], v6 offset:512
    v_cvt_pkrtz_f16_f32 v28, v28, v124
    v_cvt_pkrtz_f16_f32 v29, v29, v125
    s_waitcnt lgkmcnt(6)
    v_mfma_f32_16x16x32_f16 v[104:107], v[72:75], v[32:35], v[104:107]
    ds_read_b64 v[62:63], v6 offset:520
    v_cvt_pkrtz_f16_f32 v30, v30, v126
    v_cvt_pkrtz_f16_f32 v31, v31, v127
    s_waitcnt lgkmcnt(5)
    v_mfma_f32_16x16x32_f16 v[104:107], v[56:59], v[36:39], v[104:107]
    ds_read_b128 v[32:35], v4 offset:3120
    v_mfma_f32_16x16x32_f16 v[16:19], v[56:59], v[52:55], v[16:19]
    ds_read_b128 v[124:127], v4 offset:3184
    s_waitcnt lgkmcnt(5)
    v_mfma_f32_16x16x32_f16 v[104:107], v[28:31], v[12:15], v[104:107]
    v_mfma_f32_16x16x32_f16 v[16:19], v[28:31], v[100:103], v[16:19]
    ds_read_b128 v[52:55], v4 offset:3248
    s_waitcnt lgkmcnt(3)
    v_mfma_f32_16x16x32_f16 v[104:107], v[60:63], v[64:67], v[104:107]
    v_mfma_f32_16x16x32_f16 v[16:19], v[8:11], v[64:67], v[16:19]
    ds_read_b128 v[56:59], v4 offset:3312
    s_waitcnt lgkmcnt(3)
    v_mfma_f32_16x16x32_f16 v[104:107], v[40:43], v[32:35], v[104:107]
    v_mfma_f32_16x16x32_f16 v[16:19], v[116:119], v[32:35], v[16:19]
    ds_read_b128 v[100:103], v4 offset:3376
    s_waitcnt lgkmcnt(3)
    v_mfma_f32_16x16x32_f16 v[104:107], v[68:71], v[124:127], v[104:107]
    v_mfma_f32_16x16x32_f16 v[16:19], v[112:115], v[124:127], v[16:19]
    ds_read_b128 v[28:31], v4 offset:3440
    s_waitcnt lgkmcnt(3)
    v_mfma_f32_16x16x32_f16 v[104:107], v[76:79], v[52:55], v[104:107]
    v_mfma_f32_16x16x32_f16 v[16:19], v[80:83], v[52:55], v[16:19]
    ds_read_b128 v[8:11], v4 offset:3504
    s_waitcnt lgkmcnt(3)
    v_mfma_f32_16x16x32_f16 v[104:107], v[92:95], v[56:59], v[104:107]
    v_mfma_f32_16x16x32_f16 v[16:19], v[20:23], v[56:59], v[16:19]
    ds_read_b128 v[64:67], v4 offset:3568
    s_waitcnt lgkmcnt(3)
    v_mfma_f32_16x16x32_f16 v[104:107], v[108:111], v[100:103], v[104:107]
    v_mfma_f32_16x16x32_f16 v[16:19], v[96:99], v[100:103], v[16:19]
    ds_read_b128 v[116:119], v4 offset:3632
    s_waitcnt lgkmcnt(3)
    v_mfma_f32_16x16x32_f16 v[104:107], v[84:87], v[28:31], v[104:107]
    ds_read_b128 v[32:35], v4 offset:3696
    v_mfma_f32_16x16x32_f16 v[16:19], v[120:123], v[28:31], v[16:19]
    ds_read_b128 v[112:115], v4 offset:3056
    s_waitcnt lgkmcnt(4)
    v_mfma_f32_16x16x32_f16 v[104:107], v[24:27], v[8:11], v[104:107]
    v_mfma_f32_16x16x32_f16 v[16:19], v[72:75], v[8:11], v[16:19]
    ds_read_b128 v[124:127], v4 offset:3040
    s_waitcnt lgkmcnt(4)
    v_mfma_f32_16x16x32_f16 v[104:107], v[88:91], v[64:67], v[104:107]
    v_mfma_f32_16x16x32_f16 v[16:19], v[60:63], v[64:67], v[16:19]
    ds_read_b128 v[80:83], v4 offset:3760
    s_waitcnt lgkmcnt(4)
    v_mfma_f32_16x16x32_f16 v[16:19], v[40:43], v[116:119], v[16:19]
    ds_read_b128 v[52:55], v4 offset:3824
    s_waitcnt lgkmcnt(4)
    v_mfma_f32_16x16x32_f16 v[16:19], v[68:71], v[32:35], v[16:19]
    s_nop 0
    s_nop 0
    v_cvt_pk_f16_f32 v104, v104, v105
    v_cvt_pk_f16_f32 v105, v106, v107
    ds_write_b64 v1, v[104:105] offset:1024
    s_mov_b64 exec, 1
    ds_add_u32 v3, v0 offset:72
    s_mov_b64 exec, -1
    s_setprio 0
    s_waitcnt lgkmcnt(5)
    v_mfma_f32_16x16x32_f16 v[56:59], v[112:115], v[44:47], 0
    ds_read_b128 v[20:23], v4 offset:3888
    v_mfma_f32_16x16x32_f16 v[100:103], v[112:115], v[48:51], 0
    ds_read_b128 v[96:99], v4 offset:3952
    s_nop 0
    s_waitcnt lgkmcnt(6)
    v_mfma_f32_16x16x32_f16 v[28:31], v[124:127], v[44:47], 0
    ds_read_b128 v[120:123], v4 offset:4016
    v_mfma_f32_16x16x32_f16 v[8:11], v[124:127], v[48:51], 0
    ds_read_b128 v[72:75], v4 offset:4080
    s_waitcnt lgkmcnt(7)
    v_mfma_f32_16x16x32_f16 v[16:19], v[76:79], v[80:83], v[16:19]
    s_waitcnt lgkmcnt(6)
    v_mfma_f32_16x16x32_f16 v[16:19], v[92:95], v[52:55], v[16:19]
    s_waitcnt lgkmcnt(3)
    v_mfma_f32_16x16x32_f16 v[16:19], v[108:111], v[20:23], v[16:19]
    v_cvt_pkrtz_f16_f32 v56, v56, v100
    v_cvt_pkrtz_f16_f32 v57, v57, v101
    s_waitcnt lgkmcnt(2)
    v_mfma_f32_16x16x32_f16 v[16:19], v[84:87], v[96:99], v[16:19]
    v_cvt_pkrtz_f16_f32 v58, v58, v102
    v_cvt_pkrtz_f16_f32 v59, v59, v103
    s_waitcnt lgkmcnt(1)
    v_mfma_f32_16x16x32_f16 v[16:19], v[24:27], v[120:123], v[16:19]
    v_cvt_pkrtz_f16_f32 v28, v28, v8
    v_cvt_pkrtz_f16_f32 v29, v29, v9
    s_waitcnt lgkmcnt(0)
    v_mfma_f32_16x16x32_f16 v[16:19], v[88:91], v[72:75], v[16:19]
    v_cvt_pkrtz_f16_f32 v30, v30, v10
    v_cvt_pkrtz_f16_f32 v31, v31, v11
    v_mfma_f32_16x16x32_f16 v[16:19], v[56:59], v[36:39], v[16:19]
    s_nop 0
    v_mfma_f32_16x16x32_f16 v[16:19], v[28:31], v[12:15], v[16:19]
    s_nop 7
    v_cvt_pk_f16_f32 v16, v16, v17
    v_cvt_pk_f16_f32 v17, v18, v19
    ds_write_b64 v1, v[16:17] offset:1536
    s_mov_b64 exec, 1
    ds_add_u32 v3, v0 offset:76
    s_mov_b64 exec, -1
    s_branch L_fin
    s_nop 0
L_set1_67:
    ds_read_b64 v[32:33], v7 offset:128
    ds_read_b64 v[34:35], v7 offset:136
    ds_read_b64 v[36:37], v7 offset:64
    ds_read_b64 v[38:39], v7 offset:72
    ds_read_b64 v[40:41], v7 offset:0
    ds_read_b64 v[42:43], v7 offset:8
    ds_read_b64 v[60:61], v7 offset:640
    ds_read_b64 v[62:63], v7 offset:648
    s_mov_b32 s46, 0
L_sp_73:
    ds_read_b32 v5, v3 offset:48
    s_waitcnt lgkmcnt(0)
    v_cmp_gt_u32_e64 vcc, 2, v5
    s_cbranch_vccz L_spd_74
    s_add_u32 s46, s46, 1
    s_sleep 2
    s_cmp_lt_u32 s46, 400000
    s_cbranch_scc1 L_sp_73
    s_branch L_end
    s_nop 0
L_spd_74:
    s_setprio 2
    ds_read_b128 v[64:67], v4 offset:496
    ds_read_b128 v[68:71], v4 offset:480
    s_waitcnt lgkmcnt(1)
    v_mfma_f32_16x16x32_f16 v[76:79], v[64:67], v[44:47], 0
    ds_read_b128 v[72:75], v4 offset:512
    v_mfma_f32_16x16x32_f16 v[84:87], v[64:67], v[48:51], 0
    ds_read_b128 v[80:83], v4 offset:1024
    v_mfma_f32_16x16x32_f16 v[16:19], v[64:67], v[52:55], 0
    ds_read_b128 v[8:11], v4 offset:1008
    s_waitcnt lgkmcnt(3)
    s_nop 0
    v_mfma_f32_16x16x32_f16 v[20:23], v[68:71], v[56:59], 0
    ds_read_b64 v[24:25], v7 offset:576
    v_mfma_f32_16x16x32_f16 v[28:31], v[68:71], v[44:47], 0
    ds_read_b128 v[88:91], v4 offset:992
    v_mfma_f32_16x16x32_f16 v[96:99], v[68:71], v[48:51], 0
    ds_read_b64 v[26:27], v7 offset:584
    s_waitcnt lgkmcnt(5)
    v_mfma_f32_16x16x32_f16 v[104:107], v[12:15], v[72:75], 0
    ds_read_b64 v[92:93], v7 offset:320
    s_waitcnt lgkmcnt(5)
    v_mfma_f32_16x16x32_f16 v[112:115], v[12:15], v[80:83], 0
    ds_read_b64 v[94:95], v7 offset:328
    s_waitcnt lgkmcnt(5)
    s_nop 0
    v_mfma_f32_16x16x32_f16 v[120:123], v[8:11], v[44:47], 0
    ds_read_b64 v[100:101], v7 offset:256
    v_cvt_pkrtz_f16_f32 v76, v76, v84
    v_cvt_pkrtz_f16_f32 v77, v77, v85
    v_mfma_f32_16x16x32_f16 v[64:67], v[8:11], v[48:51], 0
    ds_read_b64 v[102:103], v7 offset:264
    v_cvt_pkrtz_f16_f32 v78, v78, v86
    v_cvt_pkrtz_f16_f32 v79, v79, v87
    v_mfma_f32_16x16x32_f16 v[72:75], v[8:11], v[52:55], 0
    ds_read_b64 v[108:109], v7 offset:192
    v_cvt_pkrtz_f16_f32 v16, v16, v20
    v_cvt_pkrtz_f16_f32 v17, v17, v21
    s_nop 0
    s_waitcnt lgkmcnt(6)
    v_mfma_f32_16x16x32_f16 v[80:83], v[88:91], v[56:59], 0
    ds_read_b64 v[110:111], v7 offset:200
    v_cvt_pkrtz_f16_f32 v18, v18, v22
    v_cvt_pkrtz_f16_f32 v19, v19, v23
    v_mfma_f32_16x16x32_f16 v[84:87], v[88:91], v[44:47], 0
    ds_read_b64 v[116:117], v6 offset:0
    v_cvt_pkrtz_f16_f32 v28, v28, v96
    v_cvt_pkrtz_f16_f32 v29, v29, v97
    v_mfma_f32_16x16x32_f16 v[52:55], v[88:91], v[48:51], 0
    ds_read_b64 v[118:119], v6 offset:8
    v_cvt_pkrtz_f16_f32 v30, v30, v98
    v_cvt_pkrtz_f16_f32 v31, v31, v99
    v_mfma_f32_16x16x32_f16 v[8:11], v[76:79], v[32:35], 0
    ds_read_b64 v[124:125], v6 offset:64
    v_mfma_f32_16x16x32_f16 v[56:59], v[76:79], v[36:39], 0
    ds_read_b128 v[20:23], v4 offset:496
    v_mfma_f32_16x16x32_f16 v[104:107], v[76:79], v[40:43], v[104:107]
    ds_read_b64 v[126:127], v6 offset:72
    ds_read_b128 v[88:91], v4 offset:560
    v_mfma_f32_16x16x32_f16 v[104:107], v[16:19], v[60:63], v[104:107]
    ds_read_b64 v[68:69], v6 offset:128
    ds_read_b64 v[70:71], v6 offset:136
    s_waitcnt lgkmcnt(14)
    v_mfma_f32_16x16x32_f16 v[112:115], v[16:19], v[24:27], v[112:115]
    ds_read_b128 v[96:99], v4 offset:624
    ds_read_b64 v[12:13], v6 offset:192
    s_waitcnt lgkmcnt(14)
    v_mfma_f32_16x16x32_f16 v[8:11], v[28:31], v[92:95], v[8:11]
    ds_read_b64 v[14:15], v6 offset:200
    s_waitcnt lgkmcnt(13)
    v_mfma_f32_16x16x32_f16 v[56:59], v[28:31], v[100:103], v[56:59]
    ds_read_b128 v[76:79], v4 offset:688
    s_waitcnt lgkmcnt(12)
    v_mfma_f32_16x16x32_f16 v[104:107], v[28:31], v[108:111], v[104:107]
    ds_read_b64 v[16:17], v6 offset:256
    s_waitcnt lgkmcnt(11)
    s_waitcnt lgkmcnt(9)
    v_mfma_f32_16x16x32_f16 v[8:11], v[116:119], v[20:23], v[8:11]
    ds_read_b64 v[18:19], v6 offset:264
    v_cvt_pkrtz_f16_f32 v120, v120, v64
    v_cvt_pkrtz_f16_f32 v121, v121, v65
    v_cvt_pkrtz_f16_f32 v122, v122, v66
    s_waitcnt lgkmcnt(9)
    s_waitcnt lgkmcnt(8)
    v_mfma_f32_16x16x32_f16 v[8:11], v[124:127], v[88:91], v[8:11]
    ds_read_b64 v[24:25], v6 offset:320
    v_cvt_pkrtz_f16_f32 v123, v123, v67
    v_cvt_pkrtz_f16_f32 v72, v72, v80
    v_cvt_pkrtz_f16_f32 v73, v73, v81
    s_waitcnt lgkmcnt(7)
    s_waitcnt lgkmcnt(6)
    v_mfma_f32_16x16x32_f16 v[8:11], v[68:71], v[96:99], v[8:11]
    ds_read_b64 v[26:27], v6 offset:328
    v_cvt_pkrtz_f16_f32 v74, v74, v82
    v_cvt_pkrtz_f16_f32 v75, v75, v83
    v_cvt_pkrtz_f16_f32 v84, v84, v52
    s_waitcnt lgkmcnt(5)
    s_waitcnt lgkmcnt(4)
    v_mfma_f32_16x16x32_f16 v[8:11], v[12:15], v[76:79], v[8:11]
    ds_read_b64 v[28:29], v6 offset:384
    v_cvt_pkrtz_f16_f32 v85, v85, v53
    v_cvt_pkrtz_f16_f32 v86, v86, v54
    v_cvt_pkrtz_f16_f32 v87, v87, v55
    v_mfma_f32_16x16x32_f16 v[56:59], v[120:123], v[32:35], v[56:59]
    ds_read_b128 v[96:99], v4 offset:752
    v_mfma_f32_16x16x32_f16 v[104:107], v[120:123], v[36:39], v[104:107]
    ds_read_b128 v[76:79], v4 offset:816
    v_mfma_f32_16x16x32_f16 v[112:115], v[120:123], v[40:43], v[112:115]
    ds_read_b64 v[30:31], v6 offset:392
    ds_read_b128 v[52:55], v4 offset:880
    v_mfma_f32_16x16x32_f16 v[112:115], v[72:75], v[60:63], v[112:115]
    ds_read_b64 v[20:21], v6 offset:448
    ds_read_b64 v[22:23], v6 offset:456
    v_mfma_f32_16x16x32_f16 v[56:59], v[84:87], v[92:95], v[56:59]
    ds_read_b128 v[120:123], v4 offset:944
    ds_read_b64 v[88:89], v6 offset:512
    v_mfma_f32_16x16x32_f16 v[104:107], v[84:87], v[100:103], v[104:107]
    ds_read_b64 v[90:91], v6 offset:520
    v_mfma_f32_16x16x32_f16 v[112:115], v[84:87], v[108:111], v[112:115]
    ds_read_b128 v[60:63], v4 offset:1008
    ds_read_b64 v[64:65], v6 offset:576
    s_waitcnt lgkmcnt(14)
    s_waitcnt lgkmcnt(10)
    v_mfma_f32_16x16x32_f16 v[8:11], v[16:19], v[96:99], v[8:11]
    ds_read_b64 v[66:67], v6 offset:584
    s_waitcnt lgkmcnt(10)
    s_nop 0
    v_mfma_f32_16x16x32_f16 v[8:11], v[24:27], v[76:79], v[8:11]
    ds_read_b128 v[108:111], v4 offset:1072
    ds_read_b64 v[80:81], v6 offset:640
    s_waitcnt lgkmcnt(11)
    s_waitcnt lgkmcnt(10)
    v_mfma_f32_16x16x32_f16 v[8:11], v[28:31], v[52:55], v[8:11]
    ds_read_b64 v[82:83], v6 offset:648
    s_waitcnt lgkmcnt(9)
    s_waitcnt lgkmcnt(8)
    v_mfma_f32_16x16x32_f16 v[8:11], v[20:23], v[120:123], v[8:11]
    ds_read_b128 v[96:99], v4 offset:1136
    ds_read_b64 v[40:41], v6 offset:704
    s_waitcnt lgkmcnt(8)
    s_waitcnt lgkmcnt(7)
    v_mfma_f32_16x16x32_f16 v[8:11], v[88:91], v[60:63], v[8:11]
    ds_read_b64 v[42:43], v6 offset:712
    v_mfma_f32_16x16x32_f16 v[56:59], v[116:119], v[60:63], v[56:59]
    ds_read_b128 v[52:55], v4 offset:1200
    ds_read_b64 v[72:73], v6 offset:768
    s_waitcnt lgkmcnt(8)
    s_waitcnt lgkmcnt(7)
    v_mfma_f32_16x16x32_f16 v[8:11], v[64:67], v[108:111], v[8:11]
    ds_read_b64 v[74:75], v6 offset:776
    v_mfma_f32_16x16x32_f16 v[56:59], v[124:127], v[108:111], v[56:59]
    ds_read_b128 v[60:63], v4 offset:1264
    ds_read_b64 v[84:85], v6 offset:832
    s_waitcnt lgkmcnt(8)
    s_waitcnt lgkmcnt(7)
    v_mfma_f32_16x16x32_f16 v[8:11], v[80:83], v[96:99], v[8:11]
    ds_read_b64 v[86:87], v6 offset:840
    v_mfma_f32_16x16x32_f16 v[56:59], v[68:71], v[96:99], v[56:59]
    ds_read_b128 v[108:111], v4 offset:1328
    ds_read_b64 v[76:77], v6 offset:896
    s_waitcnt lgkmcnt(8)
    s_waitcnt lgkmcnt(7)
    v_mfma_f32_16x16x32_f16 v[8:11], v[40:43], v[52:55], v[8:11]
    ds_read_b64 v[78:79], v6 offset:904
    v_mfma_f32_16x16x32_f16 v[56:59], v[12:15], v[52:55], v[56:59]
    ds_read_b128 v[96:99], v4 offset:1392
    ds_read_b64 v[120:121], v6 offset:960
    s_waitcnt lgkmcnt(8)
    s_waitcnt lgkmcnt(7)
    v_mfma_f32_16x16x32_f16 v[8:11], v[72:75], v[60:63], v[8:11]
    ds_read_b64 v[122:123], v6 offset:968
    v_mfma_f32_16x16x32_f16 v[56:59], v[16:19], v[60:63], v[56:59]
    ds_read_b128 v[52:55], v4 offset:1456
    s_waitcnt lgkmcnt(7)
    s_waitcnt lgkmcnt(6)
    v_mfma_f32_16x16x32_f16 v[8:11], v[84:87], v[108:111], v[8:11]
    ds_read_b128 v[60:63], v4 offset:1520
    v_mfma_f32_16x16x32_f16 v[56:59], v[24:27], v[108:111], v[56:59]
    ds_read_b64 v[108:109], v6 offset:1024
    ds_read_b64 v[110:111], v6 offset:1032
    s_waitcnt lgkmcnt(7)
    s_waitcnt lgkmcnt(6)
    v_mfma_f32_16x16x32_f16 v[8:11], v[76:79], v[96:99], v[8:11]
    v_mfma_f32_16x16x32_f16 v[56:59], v[28:31], v[96:99], v[56:59]
    ds_read_b128 v[96:99], v4 offset:1584
    s_waitcnt lgkmcnt(5)
    s_waitcnt lgkmcnt(4)
    v_mfma_f32_16x16x32_f16 v[8:11], v[120:123], v[52:55], v[8:11]
    v_mfma_f32_16x16x32_f16 v[56:59], v[20:23], v[52:55], v[56:59]
    ds_read_b128 v[52:55], v4 offset:1648
    s_waitcnt lgkmcnt(2)
    s_nop 0
    v_mfma_f32_16x16x32_f16 v[8:11], v[108:111], v[60:63], v[8:11]
    v_mfma_f32_16x16x32_f16 v[56:59], v[88:91], v[60:63], v[56:59]
    v_mfma_f32_16x16x32_f16 v[104:107], v[116:119], v[60:63], v[104:107]
    ds_read_b128 v[60:63], v4 offset:1712
    s_waitcnt lgkmcnt(2)
    v_mfma_f32_16x16x32_f16 v[56:59], v[64:67], v[96:99], v[56:59]
    s_nop 2
    v_cvt_pk_f16_f32 v8, v8, v9
    v_cvt_pk_f16_f32 v9, v10, v11
    ds_write_b64 v1, v[8:9] offset:0
    s_mov_b64 exec, 1
    ds_add_u32 v3, v0 offset:64
    s_mov_b64 exec, -1
    s_setprio 1
    v_mfma_f32_16x16x32_f16 v[104:107], v[124:127], v[96:99], v[104:107]
    ds_read_b128 v[8:11], v4 offset:1776
    s_waitcnt lgkmcnt(4)
    v_mfma_f32_16x16x32_f16 v[56:59], v[80:83], v[52:55], v[56:59]
    ds_read_b128 v[96:99], v4 offset:1840
    v_mfma_f32_16x16x32_f16 v[104:107], v[68:71], v[52:55], v[104:107]
    ds_read_b128 v[52:55], v4 offset:1904
    s_nop 0
    s_waitcnt lgkmcnt(5)
    v_mfma_f32_16x16x32_f16 v[56:59], v[40:43], v[60:63], v[56:59]
    v_mfma_f32_16x16x32_f16 v[104:107], v[12:15], v[60:63], v[104:107]
    ds_read_b32 v5, v3 offset:56
    ds_read_b128 v[60:63], v4 offset:1968
    s_waitcnt lgkmcnt(4)
    v_mfma_f32_16x16x32_f16 v[56:59], v[72:75], v[8:11], v[56:59]
    v_mfma_f32_16x16x32_f16 v[104:107], v[16:19], v[8:11], v[104:107]
    ds_read_b128 v[8:11], v4 offset:2032
    s_waitcnt lgkmcnt(4)
    v_mfma_f32_16x16x32_f16 v[56:59], v[84:87], v[96:99], v[56:59]
    v_mfma_f32_16x16x32_f16 v[104:107], v[24:27], v[96:99], v[104:107]
    s_waitcnt lgkmcnt(3)
    v_mfma_f32_16x16x32_f16 v[56:59], v[76:79], v[52:55], v[56:59]
    s_waitcnt lgkmcnt(2)
    v_cmp_gt_u32_e64 vcc, 2, v5
    s_cbranch_vccz L_x2_75
    s_mov_b32 s46, 0
L_sp_76:
    ds_read_b32 v5, v3 offset:56
    s_waitcnt lgkmcnt(0)
    v_cmp_gt_u32 vcc, 2, v5
    s_cbranch_vccz L_spd_77
    s_add_u32 s46, s46, 1
    s_sleep 1
    s_cmp_lt_u32 s46, 400000
    s_cbranch_scc1 L_sp_76
    s_branch L_end
    s_nop 0
L_spd_77:
L_x2_75:
    ds_read_b128 v[96:99], v4 offset:2096
    v_mfma_f32_16x16x32_f16 v[104:107], v[28:31], v[52:55], v[104:107]
    s_waitcnt lgkmcnt(2)
    v_mfma_f32_16x16x32_f16 v[56:59], v[120:123], v[60:63], v[56:59]
    ds_read_b128 v[52:55], v4 offset:2160
    v_mfma_f32_16x16x32_f16 v[104:107], v[20:23], v[60:63], v[104:107]
    s_waitcnt lgkmcnt(2)
    v_mfma_f32_16x16x32_f16 v[56:59], v[108:111], v[8:11], v[56:59]
    ds_read_b128 v[60:63], v4 offset:2224
    v_mfma_f32_16x16x32_f16 v[104:107], v[88:91], v[8:11], v[104:107]
    v_mfma_f32_16x16x32_f16 v[112:115], v[116:119], v[8:11], v[112:115]
    ds_read_b128 v[116:119], v4 offset:1520
    s_waitcnt lgkmcnt(3)
    v_mfma_f32_16x16x32_f16 v[104:107], v[64:67], v[96:99], v[104:107]
    s_nop 1
    v_cvt_pk_f16_f32 v56, v56, v57
    v_cvt_pk_f16_f32 v57, v58, v59
    ds_write_b64 v1, v[56:57] offset:512
    s_mov_b64 exec, 1
    ds_add_u32 v3, v0 offset:68
    s_mov_b64 exec, -1
    s_setprio 0
    v_mfma_f32_16x16x32_f16 v[112:115], v[124:127], v[96:99], v[112:115]
    ds_read_b128 v[8:11], v4 offset:1504
    s_waitcnt lgkmcnt(5)
    v_mfma_f32_16x16x32_f16 v[104:107], v[80:83], v[52:55], v[104:107]
    v_mfma_f32_16x16x32_f16 v[112:115], v[68:71], v[52:55], v[112:115]
    ds_read_b128 v[56:59], v4 offset:2288
    s_waitcnt lgkmcnt(5)
    v_mfma_f32_16x16x32_f16 v[104:107], v[40:43], v[60:63], v[104:107]
    v_mfma_f32_16x16x32_f16 v[112:115], v[12:15], v[60:63], v[112:115]
    ds_read_b128 v[124:127], v4 offset:2352
    s_waitcnt lgkmcnt(5)
    v_mfma_f32_16x16x32_f16 v[96:99], v[116:119], v[44:47], 0
    v_mfma_f32_16x16x32_f16 v[68:71], v[116:119], v[48:51], 0
    ds_read_b128 v[52:55], v4 offset:2416
    s_waitcnt lgkmcnt(3)
    v_mfma_f32_16x16x32_f16 v[12:15], v[8:11], v[44:47], 0
    v_mfma_f32_16x16x32_f16 v[60:63], v[8:11], v[48:51], 0
    ds_read_b128 v[116:119], v4 offset:2480
    s_waitcnt lgkmcnt(3)
    v_mfma_f32_16x16x32_f16 v[104:107], v[72:75], v[56:59], v[104:107]
    v_mfma_f32_16x16x32_f16 v[112:115], v[16:19], v[56:59], v[112:115]
    ds_read_b128 v[8:11], v4 offset:2544
    s_waitcnt lgkmcnt(3)
    s_nop 0
    v_mfma_f32_16x16x32_f16 v[104:107], v[84:87], v[124:127], v[104:107]
    v_cvt_pkrtz_f16_f32 v96, v96, v68
    v_cvt_pkrtz_f16_f32 v97, v97, v69
    v_mfma_f32_16x16x32_f16 v[112:115], v[24:27], v[124:127], v[112:115]
    v_cvt_pkrtz_f16_f32 v98, v98, v70
    v_cvt_pkrtz_f16_f32 v99, v99, v71
    s_nop 0
    s_waitcnt lgkmcnt(2)
    v_mfma_f32_16x16x32_f16 v[104:107], v[76:79], v[52:55], v[104:107]
    v_cvt_pkrtz_f16_f32 v12, v12, v60
    v_cvt_pkrtz_f16_f32 v13, v13, v61
    v_mfma_f32_16x16x32_f16 v[112:115], v[28:31], v[52:55], v[112:115]
    v_cvt_pkrtz_f16_f32 v14, v14, v62
    v_cvt_pkrtz_f16_f32 v15, v15, v63
    s_waitcnt lgkmcnt(1)
    v_mfma_f32_16x16x32_f16 v[104:107], v[120:123], v[116:119], v[104:107]
    v_mfma_f32_16x16x32_f16 v[112:115], v[20:23], v[116:119], v[112:115]
    ds_read_b128 v[16:19], v4 offset:2608
    s_waitcnt lgkmcnt(1)
    v_mfma_f32_16x16x32_f16 v[104:107], v[108:111], v[8:11], v[104:107]
    ds_read_b128 v[56:59], v4 offset:2672
    v_mfma_f32_16x16x32_f16 v[112:115], v[88:91], v[8:11], v[112:115]
    ds_read_b128 v[24:27], v4 offset:2032
    v_mfma_f32_16x16x32_f16 v[104:107], v[96:99], v[32:35], v[104:107]
    v_mfma_f32_16x16x32_f16 v[112:115], v[96:99], v[36:39], v[112:115]
    ds_read_b128 v[124:127], v4 offset:2016
    v_mfma_f32_16x16x32_f16 v[104:107], v[12:15], v[92:95], v[104:107]
    v_mfma_f32_16x16x32_f16 v[112:115], v[12:15], v[100:103], v[112:115]
    ds_read_b128 v[68:71], v4 offset:2736
    s_waitcnt lgkmcnt(4)
    v_mfma_f32_16x16x32_f16 v[112:115], v[64:67], v[16:19], v[112:115]
    ds_read_b128 v[28:31], v4 offset:2800
    s_waitcnt lgkmcnt(4)
    v_mfma_f32_16x16x32_f16 v[112:115], v[80:83], v[56:59], v[112:115]
    s_nop 0
    s_nop 0
    v_cvt_pk_f16_f32 v104, v104, v105
    v_cvt_pk_f16_f32 v105, v106, v107
    ds_write_b64 v1, v[104:105] offset:1024
    s_mov_b64 exec, 1
    ds_add_u32 v3, v0 offset:72
    s_mov_b64 exec, -1
    s_setprio 0
    s_waitcnt lgkmcnt(5)
    v_mfma_f32_16x16x32_f16 v[60:63], v[24:27], v[44:47], 0
    ds_read_b128 v[52:55], v4 offset:2864
    v_mfma_f32_16x16x32_f16 v[116:119], v[24:27], v[48:51], 0
    ds_read_b128 v[20:23], v4 offset:2928
    s_nop 0
    s_waitcnt lgkmcnt(6)
    v_mfma_f32_16x16x32_f16 v[8:11], v[124:127], v[44:47], 0
    ds_read_b128 v[88:91], v4 offset:2992
    v_mfma_f32_16x16x32_f16 v[96:99], v[124:127], v[48:51], 0
    ds_read_b128 v[36:39], v4 offset:3056
    s_waitcnt lgkmcnt(7)
    v_mfma_f32_16x16x32_f16 v[112:115], v[40:43], v[68:71], v[112:115]
    s_waitcnt lgkmcnt(6)
    v_mfma_f32_16x16x32_f16 v[112:115], v[72:75], v[28:31], v[112:115]
    s_waitcnt lgkmcnt(3)
    v_mfma_f32_16x16x32_f16 v[112:115], v[84:87], v[52:55], v[112:115]
    v_cvt_pkrtz_f16_f32 v60, v60, v116
    v_cvt_pkrtz_f16_f32 v61, v61, v117
    s_waitcnt lgkmcnt(2)
    v_mfma_f32_16x16x32_f16 v[112:115], v[76:79], v[20:23], v[112:115]
    v_cvt_pkrtz_f16_f32 v62, v62, v118
    v_cvt_pkrtz_f16_f32 v63, v63, v119
    s_waitcnt lgkmcnt(1)
    v_mfma_f32_16x16x32_f16 v[112:115], v[120:123], v[88:91], v[112:115]
    v_cvt_pkrtz_f16_f32 v8, v8, v96
    v_cvt_pkrtz_f16_f32 v9, v9, v97
    s_waitcnt lgkmcnt(0)
    v_mfma_f32_16x16x32_f16 v[112:115], v[108:111], v[36:39], v[112:115]
    v_cvt_pkrtz_f16_f32 v10, v10, v98
    v_cvt_pkrtz_f16_f32 v11, v11, v99
    v_mfma_f32_16x16x32_f16 v[112:115], v[60:63], v[32:35], v[112:115]
    s_nop 0
    v_mfma_f32_16x16x32_f16 v[112:115], v[8:11], v[92:95], v[112:115]
    s_nop 7
    v_cvt_pk_f16_f32 v112, v112, v113
    v_cvt_pk_f16_f32 v113, v114, v115
    ds_write_b64 v1, v[112:113] offset:1536
    s_mov_b64 exec, 1
    ds_add_u32 v3, v0 offset:76
    s_mov_b64 exec, -1
L_fin:
L_end:
    s_endpgm
L_codeend:
.section .rodata,"a"
.p2align 6
.amdhsa_kernel recurrent_scan__ssm_conv_s4d__moe_arch_mod__prompt_kernel
  .amdhsa_next_free_vgpr 128
  .amdhsa_next_free_sgpr 102
  .amdhsa_accum_offset 128
  .amdhsa_group_segment_fixed_size 0
  .amdhsa_kernarg_size 120
  .amdhsa_user_sgpr_count 2
  .amdhsa_user_sgpr_kernarg_segment_ptr 1
  .amdhsa_system_sgpr_workgroup_id_x 1
  .amdhsa_float_denorm_mode_32 3
.end_amdhsa_kernel
```

```asm
; @launch grid=(256,1,1) block=(1024,1,1) lds=161280
.amdgcn_target "amdgcn-amd-amdhsa--gfx950"
.text
.globl recurrent_scan__ssm_conv_s4d__moe_arch_mod__prompt_kernel
.p2align 12
.p2align 8
.type recurrent_scan__ssm_conv_s4d__moe_arch_mod__prompt_kernel,@function
recurrent_scan__ssm_conv_s4d__moe_arch_mod__prompt_kernel:
    s_cmp_ge_u32 s2, 256
    s_nop 0
    s_cbranch_scc1 L_end
    s_load_dwordx16 s[4:19], s[0:1], 0
    s_load_dwordx8 s[20:27], s[0:1], 64
    s_load_dwordx4 s[28:31], s[0:1], 96
    s_load_dwordx2 s[32:33], s[0:1], 112
    s_getpc_b64 s[62:63]
L_pc:
    v_readfirstlane_b32 s3, v0
    v_and_b32 v1, 63, v0
    v_mov_b32 v3, 0
    v_lshlrev_b32 v2, 4, v1
    s_and_b32 s35, s2, 7
    s_lshr_b32 s36, s2, 3
    s_lshr_b32 s3, s3, 6
    s_and_b32 s40, s36, 15
    s_lshl4_add_u32 s37, s35, s40
    s_lshr_b32 s38, s36, 4
    s_xor_b32 s38, s38, 1
    s_and_b32 s34, s3, 3
    s_cmp_ge_u32 s3, 4
    s_cbranch_scc1 L_p1
    s_setprio 3
    s_lshl_b32 s40, s2, 14
    s_lshl_b32 s41, s34, 9
    v_lshrrev_b32_e64 v118, 3, v1
    v_and_b32 v113, 112, v2
    v_add_u32_e64 v113, s41, v113
    v_lshl_add_u32 v112, v118, 11, v113
    v_add_u32 v112, s40, v112
    s_waitcnt lgkmcnt(0)
    s_load_dword s47, s[32:33], 0
    global_load_dwordx4 v[32:35], v113, s[20:21] offset:0
    global_load_dwordx4 v[36:39], v113, s[20:21] offset:128
    global_load_dwordx4 v[40:43], v113, s[20:21] offset:256
    global_load_dwordx4 v[44:47], v113, s[20:21] offset:384
    global_load_dwordx4 v[16:19], v112, s[4:5] offset:0 nt
    global_load_dwordx4 v[20:23], v112, s[4:5] offset:128 nt
    global_load_dwordx4 v[24:27], v112, s[4:5] offset:256 nt
    global_load_dwordx4 v[28:31], v112, s[4:5] offset:384 nt
    s_barrier
    s_branch L_tok
    s_nop 0
L_p1:
    s_cmp_ge_u32 s3, 8
    s_cbranch_scc1 L_p2
    s_and_b32 s40, s36, 3
    s_lshl2_add_u32 s40, s40, s34
    s_lshl_b32 s40, s40, 11
    v_and_b32 v0, 15, v1
    v_lshl_add_u32 v0, v0, 7, s40
    v_cmp_gt_u32 vcc, L_codeend-L_pc-4, v0
    s_nop 1
    v_cndmask_b32 v0, v3, v0, vcc
    global_load_dword v31, v0, s[62:63]
    s_lshl_b32 s40, s34, 7
    s_and_b32 s41, s40, 128
    s_add_u32 s40, s40, 384
    v_cmp_gt_u32 vcc, 32, v1
    v_mov_b32 v32, s40
    v_mov_b32 v33, s41
    v_cndmask_b32 v32, v33, v32, vcc
    v_cndmask_b32 v34, 0, -1, vcc
    v_lshl_add_u32 v32, v1, 2, v32
    v_subrev_u32 v32, 128, v32
    ds_write_b32 v32, v34
    s_waitcnt lgkmcnt(0)
    s_barrier
    s_branch L_exp
L_p2:
    s_lshl2_add_u32 s60, s38, s34
    s_bfe_u32 s59, s3, 0x10002
    s_lshl_b32 s40, s59, 2
    s_xor_b32 s34, s60, s40
    v_and_b32 v32, 15, v1
    v_lshrrev_b32 v33, 4, v1
    s_cmp_ge_u32 s34, 5
    s_cbranch_scc1 L_q5
    s_lshl_b32 s40, s34, 2
    s_lshr_b32 s41, 0xccb5a, s40
    s_and_b32 s41, s41, 15
    s_add_u32 s41, s41, 40
    s_lshr_b32 s45, 0x29735, s40
    s_and_b32 s45, s45, 15
    s_bfm_b32 s45, s45, 0
    s_mov_b32 s44, 0
    v_lshl_add_u32 v86, v33, 3, v32
    v_sub_u32_e64 v86, s41, v86
    v_lshrrev_b64 v[86:87], v86, s[44:45]
    s_mov_b32 s43, 0xffff
    v_bfe_i32 v36, v86, 0, 1
    v_bfe_i32 v87, v86, 1, 1
    v_bfi_b32 v36, s43, v36, v87
    v_and_b32 v36, 0x3c003c00, v36
    v_bfe_i32 v37, v86, 2, 1
    v_bfe_i32 v87, v86, 3, 1
    v_bfi_b32 v37, s43, v37, v87
    v_and_b32 v37, 0x3c003c00, v37
    v_bfe_i32 v38, v86, 4, 1
    v_bfe_i32 v87, v86, 5, 1
    v_bfi_b32 v38, s43, v38, v87
    v_and_b32 v38, 0x3c003c00, v38
    v_bfe_i32 v39, v86, 6, 1
    v_bfe_i32 v87, v86, 7, 1
    v_bfi_b32 v39, s43, v39, v87
    v_and_b32 v39, 0x3c003c00, v39
    s_branch L_qw
    s_nop 0
L_q5:
    s_cmp_ge_u32 s34, 6
    s_cbranch_scc1 L_q6
    v_lshlrev_b32 v85, 1, v32
    v_sub_u32 v85, v85, v33
    v_lshl_add_u32 v36, v85, 4, 48
    v_and_b32 v86, 1, v1
    v_cmp_eq_u32 vcc, 0, v86
    v_mov_b32 v85, 0x03020706
    v_mov_b32 v87, 0x05040100
    v_cndmask_b32_e64 v37, v85, v87, vcc
    v_mov_b32 v85, 4412
    v_mov_b32 v87, 5312
    v_cndmask_b32 v85, v85, v87, vcc
    v_lshlrev_b32 v86, 2, v33
    v_sub_u32 v86, v86, v32
    v_lshl_add_u32 v39, v86, 2, v85
    v_sub_u32 v85, 3, v32
    v_and_b32_e64 v85, 3, v85
    v_mul_u32_u24 v85, 1086, v85
    v_lshl_add_u32 v86, v33, 3, v32
    v_sub_u32_e64 v86, 39, v86
    v_lshl_add_u32 v38, v86, 1, v85
    s_branch L_qw
L_q6:
    s_cmp_ge_u32 s34, 7
    s_cbranch_scc1 L_q7
    v_and_b32 v31, 31, v1
    v_mov_b32 v85, 0
    v_cmp_gt_u32 vcc, 24, v31
    v_mov_b32 v86, 0x9876a987
    s_nop 0
    v_cndmask_b32 v85, v85, v86, vcc
    v_cmp_gt_u32 vcc, 16, v31
    v_mov_b32 v86, 0x54aa6543
    s_nop 0
    v_cndmask_b32 v85, v85, v86, vcc
    v_cmp_gt_u32 vcc, 8, v31
    v_mov_b32 v86, 0x2113210
    s_nop 0
    v_cndmask_b32 v85, v85, v86, vcc
    v_lshlrev_b32_e64 v86, 2, v31
    v_bfe_u32 v85, v85, v86, 4
    s_mov_b32 s41, 0xf00f0ff0
    v_bfe_u32 v86, s41, v31, 1
    v_mad_u32_u24 v85, v86, 10, v85
    v_lshrrev_b32 v86, 5, v1
    v_mad_u32_u24 v85, v85, 17, v86
    v_lshlrev_b32 v36, 4, v85
    v_mad_u32_u24 v85, v31, 17, v86
    v_lshlrev_b32 v37, 4, v85
    v_lshrrev_b32 v85, 1, v1
    v_and_b32_e64 v86, 1, v1
    v_sub_u32 v85, 1135, v85
    v_mad_u32_u24 v87, v86, 48, v85
    v_lshlrev_b32 v38, 2, v87
    v_lshlrev_b32 v86, 5, v86
    v_sub_u32 v85, v85, v86
    v_add_u32 v85, 128, v85
    v_lshlrev_b32 v39, 2, v85
    s_branch L_qw
L_q7:
    v_cmp_gt_u32 vcc, 32, v1
    v_bfe_u32 v85, v1, 2, 2
    v_bfe_u32 v86, v1, 3, 2
    v_cndmask_b32 v86, v86, v85, vcc
    v_lshlrev_b32 v86, 2, v86
    s_mov_b32 s41, 0xb630
    v_bfe_u32 v86, s41, v86, 4
    v_mov_b32 v87, 5248
    v_mov_b32 v36, 4352
    v_cndmask_b32 v87, v87, v36, vcc
    v_lshl_add_u32 v86, v86, 6, v87
    v_and_b32 v87, 7, v1
    v_min_u32 v87, 4, v87
    v_and_b32 v36, 3, v1
    v_cndmask_b32 v87, v87, v36, vcc
    v_cmp_gt_u32 vcc, 16, v1
    v_mul_u32_u24 v85, 1088, v85
    s_mov_b32 s41, 0xffff0000
    v_cndmask_b32 v86, v86, v85, vcc
    v_lshl_add_u32 v36, v87, 4, v86
    v_mov_b32 v37, 0
    v_mov_b32_e64 v38, 0
    v_mov_b32_e64 v39, 0
    v_writelane_b32 v38, s41, 3
    v_writelane_b32 v39, -1, 3
    v_writelane_b32 v38, -1, 7
    v_writelane_b32 v39, -1, 7
    v_writelane_b32 v37, s41, 11
    v_writelane_b32 v38, -1, 11
    v_writelane_b32 v37, -1, 15
    v_writelane_b32 v38, -1, 15
L_qw:
    s_lshl_b32 s58, s38, 10
    s_sub_u32 s58, 10512, s58
    s_sub_u32 s40, s34, 4
    s_mul_i32 s40, s40, 4624
    s_add_u32 s40, s40, s58
    s_lshl_b32 s41, s34, 10
    s_add_u32 s41, s41, 4864
    s_cmp_lt_u32 s34, 4
    s_cselect_b32 s40, s41, s40
    v_add_u32_e64 v85, s40, v2
    ds_write_b128 v85, v[36:39]
    s_lshl3_add_u32 s42, s37, s60
    s_lshl_b32 s40, s42, 8
    v_lshl_add_u32 v24, v1, 2, s40
    s_lshr_b32 s40, s42, 1
    s_lshl_b32 s40, s40, 2
    s_waitcnt lgkmcnt(0)
    s_load_dword s48, s[14:15], s40
    s_load_dword s49, s[16:17], s40
    s_barrier
    global_load_dword v8, v24, s[6:7]
    global_load_dword v9, v24, s[8:9]
    global_load_dword v10, v24, s[10:11]
    global_load_dword v11, v24, s[12:13]
    s_branch L_cnv
    s_nop 0
L_tok:
    s_setprio 3
    s_cmp_ge_u32 s34, 2
    s_cselect_b32 s40, 4, 0
    s_add_u32 s40, s40, s34
    s_add_u32 s41, s34, 2
    s_cmp_eq_u32 s38, 0
    s_cselect_b32 s20, s40, s41
    s_cselect_b32 s21, s41, s40
    s_mov_b32 s30, 0x3f803f80
    s_mov_b32 s31, 0xffff0000
    s_lshl_b32 s40, s2, 7
    s_lshl_b32 s41, s34, 20
    s_add_u32 s40, s40, s41
    s_add_u32 s40, s40, 2097152
    s_add_u32 s52, s32, s40
    s_addc_u32 s53, s33, 0
    s_add_u32 s50, s32, 32768
    s_addc_u32 s51, s33, 0
    s_lshl_b32 s40, s2, 6
    s_add_u32 s58, s50, s40
    s_addc_u32 s59, s51, 0
    s_lshl_b32 s40, s21, 11
    s_add_u32 s60, s50, s40
    s_addc_u32 s61, s51, 0
    s_nop 0
    s_lshl_b32 s41, s37, 15
    s_add_u32 s41, s41, 2097152
    s_lshl_b32 s40, s20, 12
    s_add_u32 s40, s40, s41
    s_add_u32 s54, s32, s40
    s_addc_u32 s55, s33, 0
    s_lshl_b32 s40, s21, 12
    s_add_u32 s40, s40, s41
    s_add_u32 s56, s32, s40
    s_addc_u32 s57, s33, 0
    s_lshl_b32 s40, s20, 19
    s_lshl4_add_u32 s40, s37, s40
    s_add_u32 s40, s40, 4096
    s_add_u32 s28, s28, s40
    s_addc_u32 s29, s29, 0
    s_lshl_b32 s40, s20, 9
    s_add_u32 s40, s40, 9488
    s_lshl_b32 s41, s21, 9
    s_add_u32 s41, s41, 9488
    s_nop 0
    s_lshl_b32 s42, s34, 9
    s_add_u32 s42, s42, 52096
    v_lshl_add_u32 v5, v1, 3, s42
    v_add_u32 v11, 57664, v5
    s_lshl_b32 s42, s34, 2
    v_mov_b32 v10, s42
    v_and_b32 v58, 112, v2
    v_lshrrev_b32_e64 v59, 4, v1
    v_mul_u32_u24 v56, 4624, v118
    v_add3_u32 v114, v56, v58, s40
    v_mul_u32_u24 v56, 289, v58
    v_lshlrev_b32_e64 v117, 4, v118
    v_add3_u32 v8, v56, v117, s40
    v_add3_u32 v9, v56, v117, s41
    v_lshl_add_u32 v116, v118, 17, v58
    v_bfe_u32 v56, v1, 2, 2
    v_mul_u32_u24 v56, 4624, v56
    v_lshl_add_u32 v56, v59, 7, v56
    v_and_b32 v57, 2, v1
    v_lshl_add_u32 v56, v57, 5, v56
    v_and_b32 v57, 1, v1
    v_lshl_add_u32 v56, v57, 3, v56
    v_add_u32 v115, s40, v56
    v_and_b32 v57, 15, v1
    v_lshl_add_u32 v56, v57, 2, v59
    v_lshl_add_u32 v6, v56, 3, s40
    v_lshlrev_b32 v4, 13, v56
    s_lshl_b32 s40, s20, 11
    v_lshl_add_u32 v7, v56, 5, s40
    s_lshl_b32 s40, s34, 7
    v_add_u32 v120, s40, v117
    v_lshlrev_b32 v118, 3, v118
    v_mov_b32 v53, 1
    s_waitcnt lgkmcnt(0)
    s_add_u32 s39, s47, 1
    s_mul_i32 s39, s39, 0x9e3779b1
    v_mov_b32 v52, s39
    s_mov_b64 exec, 1
    ds_write_b64 v3, v[52:53] offset:40
    s_mov_b64 exec, -1
    v_lshlrev_b32 v57, 3, v1
    v_and_b32 v119, 0xffff, v52
    s_and_b32 s42, s39, 1
    s_mul_i32 s42, s42, 0x01010101
    s_and_b32 s43, s39, 0xfefefefe
    s_or_b32 s43, s43, s42
    v_bfe_u32 v56, s43, v57, 8
    v_lshl_or_b32 v12, v56, 14, v56
    v_lshrrev_b32 v14, 4, v12
    s_waitcnt vmcnt(4)
    v_dot2_f32_bf16 v51, v32, s30, 0
    v_dot2_f32_bf16 v52, v33, s30, 0
    v_dot2_f32_bf16 v51, v34, s30, v51
    v_dot2_f32_bf16 v52, v35, s30, v52
    v_dot2_f32_bf16 v51, v36, s30, v51
    v_dot2_f32_bf16 v52, v37, s30, v52
    v_dot2_f32_bf16 v51, v38, s30, v51
    v_dot2_f32_bf16 v52, v39, s30, v52
    v_dot2_f32_bf16 v51, v40, s30, v51
    v_dot2_f32_bf16 v52, v41, s30, v52
    v_dot2_f32_bf16 v51, v42, s30, v51
    v_dot2_f32_bf16 v52, v43, s30, v52
    v_dot2_f32_bf16 v51, v44, s30, v51
    v_dot2_f32_bf16 v52, v45, s30, v52
    v_dot2_f32_bf16 v51, v46, s30, v51
    v_dot2_f32_bf16 v52, v47, s30, v52
    s_waitcnt vmcnt(3)
    s_nop 0
    v_dot2_f32_bf16 v49, v16, v16, 0
    v_dot2_f32_bf16 v48, v16, s30, 0
    v_dot2_f32_bf16 v50, v16, v32, 0
    v_dot2_f32_bf16 v49, v17, v17, v49
    v_dot2_f32_bf16 v48, v17, s30, v48
    v_dot2_f32_bf16 v50, v17, v33, v50
    v_dot2_f32_bf16 v49, v18, v18, v49
    v_dot2_f32_bf16 v48, v18, s30, v48
    v_dot2_f32_bf16 v50, v18, v34, v50
    v_dot2_f32_bf16 v49, v19, v19, v49
    v_dot2_f32_bf16 v48, v19, s30, v48
    v_dot2_f32_bf16 v50, v19, v35, v50
    v_add_f32 v51, v51, v52
    s_waitcnt vmcnt(2)
    v_dot2_f32_bf16 v49, v20, v20, v49
    v_dot2_f32_bf16 v48, v20, s30, v48
    v_dot2_f32_bf16 v50, v20, v36, v50
    v_dot2_f32_bf16 v49, v21, v21, v49
    v_dot2_f32_bf16 v48, v21, s30, v48
    v_dot2_f32_bf16 v50, v21, v37, v50
    v_dot2_f32_bf16 v49, v22, v22, v49
    v_dot2_f32_bf16 v48, v22, s30, v48
    v_dot2_f32_bf16 v50, v22, v38, v50
    v_dot2_f32_bf16 v49, v23, v23, v49
    v_dot2_f32_bf16 v48, v23, s30, v48
    v_dot2_f32_bf16 v50, v23, v39, v50
    s_waitcnt vmcnt(1)
    s_nop 0
    v_dot2_f32_bf16 v49, v24, v24, v49
    v_dot2_f32_bf16 v48, v24, s30, v48
    v_dot2_f32_bf16 v50, v24, v40, v50
    v_dot2_f32_bf16 v49, v25, v25, v49
    v_dot2_f32_bf16 v48, v25, s30, v48
    v_dot2_f32_bf16 v50, v25, v41, v50
    v_dot2_f32_bf16 v49, v26, v26, v49
    v_dot2_f32_bf16 v48, v26, s30, v48
    v_dot2_f32_bf16 v50, v26, v42, v50
    v_dot2_f32_bf16 v49, v27, v27, v49
    v_dot2_f32_bf16 v48, v27, s30, v48
    v_dot2_f32_bf16 v50, v27, v43, v50
    s_nop 0
    s_waitcnt vmcnt(0)
    v_dot2_f32_bf16 v49, v28, v28, v49
    v_dot2_f32_bf16 v48, v28, s30, v48
    v_dot2_f32_bf16 v50, v28, v44, v50
    v_dot2_f32_bf16 v49, v29, v29, v49
    v_dot2_f32_bf16 v48, v29, s30, v48
    v_dot2_f32_bf16 v50, v29, v45, v50
    v_dot2_f32_bf16 v49, v30, v30, v49
    v_dot2_f32_bf16 v48, v30, s30, v48
    v_dot2_f32_bf16 v50, v30, v46, v50
    v_dot2_f32_bf16 v49, v31, v31, v49
    v_dot2_f32_bf16 v48, v31, s30, v48
    v_dot2_f32_bf16 v50, v31, v47, v50
    v_add_f32_dpp v51, v51, v51 quad_perm:[1,0,3,2] row_mask:0xf bank_mask:0xf
    v_add_f32_dpp v49, v49, v49 quad_perm:[1,0,3,2] row_mask:0xf bank_mask:0xf
    v_add_f32_dpp v48, v48, v48 quad_perm:[1,0,3,2] row_mask:0xf bank_mask:0xf
    v_add_f32_dpp v50, v50, v50 quad_perm:[1,0,3,2] row_mask:0xf bank_mask:0xf
    v_add_f32_dpp v51, v51, v51 quad_perm:[2,3,0,1] row_mask:0xf bank_mask:0xf
    v_add_f32_dpp v49, v49, v49 quad_perm:[2,3,0,1] row_mask:0xf bank_mask:0xf
    v_add_f32_dpp v48, v48, v48 quad_perm:[2,3,0,1] row_mask:0xf bank_mask:0xf
    v_add_f32_dpp v50, v50, v50 quad_perm:[2,3,0,1] row_mask:0xf bank_mask:0xf
    v_add_f32_dpp v51, v51, v51 row_half_mirror row_mask:0xf bank_mask:0xf
    v_add_f32_dpp v49, v49, v49 row_half_mirror row_mask:0xf bank_mask:0xf
    v_add_f32_dpp v48, v48, v48 row_half_mirror row_mask:0xf bank_mask:0xf
    v_add_f32_dpp v50, v50, v50 row_half_mirror row_mask:0xf bank_mask:0xf
    v_and_b32 v49, 0x7fffffff, v49
    s_mov_b32 exec_lo, 0x01010101
    s_mov_b32 exec_hi, 0x01010101
    ds_write_b128 v120, v[48:51] offset:256
    s_mov_b64 exec, -1
    s_mov_b32 s46, 0
    ds_read_b128 v[60:63], v117 offset:256
    ds_read_b128 v[64:67], v117 offset:384
    ds_read_b128 v[68:71], v117 offset:512
    ds_read_b128 v[72:75], v117 offset:640
    v_lshlrev_b32_e64 v80, 16, v16
    v_and_b32 v81, 0xffff0000, v16
    v_lshlrev_b32_e64 v82, 16, v17
    v_and_b32 v83, 0xffff0000, v17
    v_lshlrev_b32_e64 v84, 16, v18
    v_and_b32 v85, 0xffff0000, v18
    v_lshlrev_b32_e64 v86, 16, v19
    v_and_b32 v87, 0xffff0000, v19
    v_lshlrev_b32_e64 v88, 16, v20
    v_and_b32 v89, 0xffff0000, v20
    v_lshlrev_b32_e64 v90, 16, v21
    v_and_b32 v91, 0xffff0000, v21
    v_lshlrev_b32_e64 v92, 16, v22
    v_and_b32 v93, 0xffff0000, v22
    s_branch L_spc_3
    s_nop 0
L_sp_1:
    ds_read_b128 v[60:63], v117 offset:256
    ds_read_b128 v[64:67], v117 offset:384
    ds_read_b128 v[68:71], v117 offset:512
    ds_read_b128 v[72:75], v117 offset:640
L_spc_3:
    s_waitcnt lgkmcnt(0)
    v_or3_b32 v52, v61, v65, v69
    v_or_b32 v52, v52, v73
    v_cmp_gt_i32_e64 vcc, 0, v52
    s_cbranch_vccz L_spd_2
    s_add_u32 s46, s46, 1
    s_cmp_lt_u32 s46, 400000
    s_cbranch_scc1 L_sp_1
    s_branch L_end
L_spd_2:
    v_pk_add_f32 v[60:61], v[60:61], v[64:65]
    v_pk_add_f32 v[68:69], v[68:69], v[72:73]
    v_pk_add_f32 v[62:63], v[62:63], v[66:67]
    v_pk_add_f32 v[70:71], v[70:71], v[74:75]
    v_pk_add_f32 v[60:61], v[60:61], v[68:69]
    v_pk_add_f32 v[62:63], v[62:63], v[70:71]
    v_mul_f32 v48, 0x3a800000, v60
    v_mul_f32 v49, 0x3a800000, v61
    v_fma_f32 v49, -v48, v48, v49
    v_max_f32_e64 v49, 0, v49
    v_cvt_pk_bf16_f32 v54, v48, v49
    v_and_b32 v49, 0xffff0000, v54
    v_add_f32 v49, 0x3727c5ac, v49
    v_cvt_pk_bf16_f32 v49, v49, v49
    v_and_b32 v49, 0xffff0000, v49
    v_sqrt_f32_e64 v49, v49
    v_lshlrev_b32_e64 v54, 16, v54
    v_cvt_pk_bf16_f32 v52, v48, v49
    v_and_b32 v49, 0xffff0000, v52
    v_rcp_f32_e64 v55, v49
    v_fma_f32 v53, -v54, v63, v62
    s_cmp_lg_u32 s34, 0
    s_cbranch_scc1 L_nohdr_4
    v_mul_f32 v53, v53, v55
    s_brev_b32 s40, 1
    v_cvt_pk_bf16_f32 v53, v53, v53
    v_ashrrev_i32_e64 v49, 31, v53
    v_bitop3_b32 v53, v53, v49, s40 bitop3:0x1e
    v_and_or_b32 v53, v53, s31, v119
    s_mov_b32 exec_lo, 0x01010101
    s_mov_b32 exec_hi, 0x01010101
    global_store_dwordx2 v118, v[52:53], s[58:59] sc1
    s_mov_b64 exec, -1
L_nohdr_4:
    v_mul_f32 v56, 0xbfb8aa3b, v55
    v_lshlrev_b32 v94, 16, v23
    v_and_b32 v95, 0xffff0000, v23
    v_mul_f32 v58, -v54, v56
    v_lshlrev_b32_e64 v96, 16, v24
    v_and_b32 v97, 0xffff0000, v24
    v_lshlrev_b32_e64 v98, 16, v25
    v_and_b32 v99, 0xffff0000, v25
    v_lshlrev_b32_e64 v100, 16, v26
    v_and_b32 v101, 0xffff0000, v26
    v_lshlrev_b32_e64 v102, 16, v27
    v_and_b32 v103, 0xffff0000, v27
    v_lshlrev_b32_e64 v104, 16, v28
    v_and_b32 v105, 0xffff0000, v28
    v_lshlrev_b32_e64 v106, 16, v29
    v_and_b32 v107, 0xffff0000, v29
    v_lshlrev_b32_e64 v108, 16, v30
    v_and_b32 v109, 0xffff0000, v30
    v_lshlrev_b32_e64 v110, 16, v31
    v_and_b32 v111, 0xffff0000, v31
    v_pk_fma_f32 v[80:81], v[80:81], v[56:57], v[58:59] op_sel_hi:[1,0,0]
    v_pk_fma_f32 v[82:83], v[82:83], v[56:57], v[58:59] op_sel_hi:[1,0,0]
    v_pk_fma_f32 v[84:85], v[84:85], v[56:57], v[58:59] op_sel_hi:[1,0,0]
    v_pk_fma_f32 v[86:87], v[86:87], v[56:57], v[58:59] op_sel_hi:[1,0,0]
    v_cvt_pk_f16_f32 v16, v80, v81
    v_cvt_pk_f16_f32 v17, v82, v83
    v_cvt_pk_f16_f32 v18, v84, v85
    v_cvt_pk_f16_f32 v19, v86, v87
    ds_write_b128 v114, v[16:19] offset:0
    v_pk_fma_f32 v[88:89], v[88:89], v[56:57], v[58:59] op_sel_hi:[1,0,0]
    v_pk_fma_f32 v[90:91], v[90:91], v[56:57], v[58:59] op_sel_hi:[1,0,0]
    v_pk_fma_f32 v[92:93], v[92:93], v[56:57], v[58:59] op_sel_hi:[1,0,0]
    v_pk_fma_f32 v[94:95], v[94:95], v[56:57], v[58:59] op_sel_hi:[1,0,0]
    v_cvt_pk_f16_f32 v20, v88, v89
    v_cvt_pk_f16_f32 v21, v90, v91
    v_cvt_pk_f16_f32 v22, v92, v93
    v_cvt_pk_f16_f32 v23, v94, v95
    ds_write_b128 v114, v[20:23] offset:128
    v_pk_fma_f32 v[96:97], v[96:97], v[56:57], v[58:59] op_sel_hi:[1,0,0]
    v_pk_fma_f32 v[98:99], v[98:99], v[56:57], v[58:59] op_sel_hi:[1,0,0]
    v_pk_fma_f32 v[100:101], v[100:101], v[56:57], v[58:59] op_sel_hi:[1,0,0]
    v_pk_fma_f32 v[102:103], v[102:103], v[56:57], v[58:59] op_sel_hi:[1,0,0]
    v_cvt_pk_f16_f32 v24, v96, v97
    v_cvt_pk_f16_f32 v25, v98, v99
    v_cvt_pk_f16_f32 v26, v100, v101
    v_cvt_pk_f16_f32 v27, v102, v103
    ds_write_b128 v114, v[24:27] offset:256
    v_pk_fma_f32 v[104:105], v[104:105], v[56:57], v[58:59] op_sel_hi:[1,0,0]
    v_pk_fma_f32 v[106:107], v[106:107], v[56:57], v[58:59] op_sel_hi:[1,0,0]
    v_pk_fma_f32 v[108:109], v[108:109], v[56:57], v[58:59] op_sel_hi:[1,0,0]
    v_pk_fma_f32 v[110:111], v[110:111], v[56:57], v[58:59] op_sel_hi:[1,0,0]
    v_cvt_pk_f16_f32 v28, v104, v105
    v_cvt_pk_f16_f32 v29, v106, v107
    v_cvt_pk_f16_f32 v30, v108, v109
    v_cvt_pk_f16_f32 v31, v110, v111
    ds_write_b128 v114, v[28:31] offset:384
    ds_read_b64_tr_b16 v[32:33], v115 offset:0
    ds_read_b64_tr_b16 v[34:35], v115 offset:18496
    ds_read_b64_tr_b16 v[36:37], v115 offset:16
    ds_read_b64_tr_b16 v[38:39], v115 offset:18512
    ds_read_b64_tr_b16 v[40:41], v115 offset:32
    ds_read_b64_tr_b16 v[42:43], v115 offset:18528
    ds_read_b64_tr_b16 v[44:45], v115 offset:48
    ds_read_b64_tr_b16 v[46:47], v115 offset:18544
    s_mov_b32 s22, 0x00030003
    s_nop 0
    s_waitcnt lgkmcnt(6)
    v_bfi_b32 v32, s22, v12, v32
    v_bfi_b32 v34, s22, v14, v34
    global_store_dwordx4 v116, v[32:35], s[52:53] offset:0 sc1
    s_add_u32 s52, s52, 32768
    s_addc_u32 s53, s53, 0
    s_waitcnt lgkmcnt(4)
    v_bfi_b32 v36, s22, v12, v36
    v_bfi_b32 v38, s22, v14, v38
    global_store_dwordx4 v116, v[36:39], s[52:53] offset:0 sc1
    s_add_u32 s52, s52, 32768
    s_addc_u32 s53, s53, 0
    s_waitcnt lgkmcnt(2)
    v_bfi_b32 v40, s22, v12, v40
    v_bfi_b32 v42, s22, v14, v42
    global_store_dwordx4 v116, v[40:43], s[52:53] offset:0 sc1
    s_add_u32 s52, s52, 32768
    s_addc_u32 s53, s53, 0
    s_waitcnt lgkmcnt(0)
    v_bfi_b32 v44, s22, v12, v44
    v_bfi_b32 v46, s22, v14, v46
    global_store_dwordx4 v116, v[44:47], s[52:53] offset:0 sc1
    v_lshrrev_b32 v80, 3, v7
    v_sub_u32 v80, 0xffff, v80
    s_lshl_b32 s40, s21, 8
    s_sub_u32 s40, 0xffff, s40
    v_lshlrev_b32 v84, 1, v1
    v_sub_u32 v84, s40, v84
    v_subrev_u32 v81, 1, v80
    v_subrev_u32 v85, 1, v84
    v_subrev_u32_e64 v82, 2, v80
    v_subrev_u32 v86, 128, v84
    v_subrev_u32_e64 v83, 3, v80
    v_subrev_u32 v87, 129, v84
    v_mov_b32 v76, 1
    v_lshrrev_b32 v52, 4, v1
    v_add_u32_e64 v52, v52, v10
    v_lshlrev_b32_e64 v52, 3, v52
    s_mov_b32 s46, 0
L_sp_5:
    ds_read_b32 v48, v3 offset:80
    s_waitcnt lgkmcnt(0)
    v_cmp_gt_u32_e64 vcc, 4, v48
    s_cbranch_vccz L_spd_6
    s_add_u32 s46, s46, 1
    s_sleep 2
    s_cmp_lt_u32 s46, 400000
    s_cbranch_scc1 L_sp_5
    s_branch L_end
    s_nop 0
L_spd_6:
    global_load_dwordx4 v[60:63], v7, s[50:51] offset:0
    global_load_dwordx4 v[64:67], v7, s[50:51] offset:16
    global_load_dwordx4 v[68:71], v2, s[60:61] offset:0
    global_load_dwordx4 v[72:75], v2, s[60:61] offset:1024
    s_cmp_ge_u32 s34, 2
    s_cbranch_scc1 L_late_9
    s_mov_b32 s46, 0
L_sp_10:
    ds_read_b32 v48, v3 offset:84
    s_waitcnt lgkmcnt(0)
    v_cmp_gt_u32 vcc, 4, v48
    s_cbranch_vccz L_spd_11
    s_add_u32 s46, s46, 1
    s_sleep 2
    s_cmp_lt_u32 s46, 400000
    s_cbranch_scc1 L_sp_10
    s_branch L_end
L_spd_11:
    s_cmp_ge_u32 s21, 6
    s_cbranch_scc1 L_nob_12
    global_load_dwordx4 v[32:35], v2, s[56:57] offset:0 sc1
    global_load_dwordx4 v[36:39], v2, s[56:57] offset:1024 sc1
    global_load_dwordx4 v[40:43], v2, s[56:57] offset:2048 sc1
    global_load_dwordx4 v[44:47], v2, s[56:57] offset:3072 sc1
L_nob_12:
    global_load_dwordx4 v[16:19], v2, s[54:55] offset:0 sc1
    global_load_dwordx4 v[20:23], v2, s[54:55] offset:1024 sc1
    global_load_dwordx4 v[24:27], v2, s[54:55] offset:2048 sc1
    global_load_dwordx4 v[28:31], v2, s[54:55] offset:3072 sc1
    s_mov_b32 s46, 0
    s_waitcnt vmcnt(8)
    s_branch L_rc_7
    s_nop 0
L_late_9:
    s_mov_b32 s46, 0
    s_waitcnt vmcnt(0)
L_rc_7:
    v_xor_b32_e64 v50, v119, v61
    v_bitop3_b32 v50, v50, v63, v119 bitop3:0xf6
    v_bitop3_b32 v50, v50, v65, v119 bitop3:0xf6
    v_bitop3_b32 v50, v50, v67, v119 bitop3:0xf6
    v_bitop3_b32 v50, v50, v69, v119 bitop3:0xf6
    v_bitop3_b32 v50, v50, v71, v119 bitop3:0xf6
    v_bitop3_b32 v50, v50, v73, v119 bitop3:0xf6
    v_bitop3_b32 v50, v50, v75, v119 bitop3:0xf6
    v_and_b32 v50, 0xffff, v50
    v_cmp_ne_u32 vcc, 0, v50
    s_cbranch_vccz L_ro_8
    global_load_dwordx4 v[60:63], v7, s[50:51] offset:0 sc1
    global_load_dwordx4 v[64:67], v7, s[50:51] offset:16 sc1
    global_load_dwordx4 v[68:71], v2, s[60:61] offset:0 sc1
    global_load_dwordx4 v[72:75], v2, s[60:61] offset:1024 sc1
    s_add_u32 s46, s46, 1
    s_cmp_lt_u32 s46, 50000
    s_waitcnt vmcnt(0)
    s_cbranch_scc1 L_rc_7
    s_branch L_end
L_ro_8:
    v_and_or_b32 v80, v61, s31, v80
    v_and_or_b32 v81, v63, s31, v81
    v_and_or_b32 v82, v65, s31, v82
    v_and_or_b32 v83, v67, s31, v83
    v_and_or_b32 v84, v69, s31, v84
    v_and_or_b32 v85, v71, s31, v85
    v_and_or_b32 v86, v73, s31, v86
    v_and_or_b32 v87, v75, s31, v87
    v_max3_u32 v48, v80, v81, v82
    v_med3_u32 v49, v80, v81, v82
    v_med3_u32 v49, v48, v49, v83
    v_max_u32 v48, v48, v83
    v_med3_u32 v49, v48, v49, v84
    v_max_u32 v48, v48, v84
    v_med3_u32 v49, v48, v49, v85
    v_max_u32_e64 v48, v48, v85
    v_med3_u32 v49, v48, v49, v86
    v_max_u32_e64 v48, v48, v86
    v_med3_u32 v49, v48, v49, v87
    v_max_u32 v48, v48, v87
    s_nop 0
    v_max_u32_dpp v51, v49, v49 quad_perm:[1,0,3,2] row_mask:0xf bank_mask:0xf
    v_min_u32_dpp v50, v48, v48 quad_perm:[1,0,3,2] row_mask:0xf bank_mask:0xf
    v_max_u32 v49, v50, v51
    v_max_u32_dpp v48, v48, v48 quad_perm:[1,0,3,2] row_mask:0xf bank_mask:0xf
    s_nop 0
    v_max_u32_dpp v51, v49, v49 quad_perm:[2,3,0,1] row_mask:0xf bank_mask:0xf
    v_min_u32_dpp v50, v48, v48 quad_perm:[2,3,0,1] row_mask:0xf bank_mask:0xf
    v_max_u32 v49, v50, v51
    v_max_u32_dpp v48, v48, v48 quad_perm:[2,3,0,1] row_mask:0xf bank_mask:0xf
    s_nop 0
    v_max_u32_dpp v51, v49, v49 row_half_mirror row_mask:0xf bank_mask:0xf
    v_min_u32_dpp v50, v48, v48 row_half_mirror row_mask:0xf bank_mask:0xf
    v_max_u32 v49, v50, v51
    v_max_u32_dpp v48, v48, v48 row_half_mirror row_mask:0xf bank_mask:0xf
    s_nop 0
    v_max_u32_dpp v51, v49, v49 row_mirror row_mask:0xf bank_mask:0xf
    v_min_u32_dpp v50, v48, v48 row_mirror row_mask:0xf bank_mask:0xf
    v_max_u32_e64 v49, v50, v51
    v_max_u32_dpp v48, v48, v48 row_mirror row_mask:0xf bank_mask:0xf
    s_mov_b32 exec_lo, 0x00010001
    s_mov_b32 exec_hi, 0x00010001
    ds_write_b64 v52, v[48:49] offset:128
    s_mov_b64 exec, -1
    s_cmp_lt_u32 s34, 2
    s_cbranch_scc1 L_early_13
    s_mov_b32 s46, 0
L_sp_14:
    ds_read_b32 v48, v3 offset:92
    s_waitcnt lgkmcnt(0)
    v_cmp_gt_u32 vcc, 4, v48
    s_cbranch_vccz L_spd_15
    s_add_u32 s46, s46, 1
    s_sleep 1
    s_cmp_lt_u32 s46, 400000
    s_cbranch_scc1 L_sp_14
    s_branch L_end
    s_nop 0
L_spd_15:
    s_cmp_ge_u32 s21, 6
    s_cbranch_scc1 L_nob_16
    global_load_dwordx4 v[32:35], v2, s[56:57] offset:0 sc1
    global_load_dwordx4 v[36:39], v2, s[56:57] offset:1024 sc1
    global_load_dwordx4 v[40:43], v2, s[56:57] offset:2048 sc1
    global_load_dwordx4 v[44:47], v2, s[56:57] offset:3072 sc1
L_nob_16:
    global_load_dwordx4 v[16:19], v2, s[54:55] offset:0 sc1
    global_load_dwordx4 v[20:23], v2, s[54:55] offset:1024 sc1
    global_load_dwordx4 v[24:27], v2, s[54:55] offset:2048 sc1
    global_load_dwordx4 v[28:31], v2, s[54:55] offset:3072 sc1
L_early_13:
    v_and_b32 v92, 0xffff0000, v60
    v_lshlrev_b32_e64 v88, 16, v60
    v_mul_f32 v92, 0xbf317218, v92
    v_and_b32 v93, 0xffff0000, v62
    v_lshlrev_b32_e64 v89, 16, v62
    v_mul_f32 v93, 0xbf317218, v93
    v_and_b32 v94, 0xffff0000, v64
    v_lshlrev_b32_e64 v90, 16, v64
    v_mul_f32 v94, 0xbf317218, v94
    v_and_b32 v95, 0xffff0000, v66
    v_lshlrev_b32_e64 v91, 16, v66
    v_mul_f32 v95, 0xbf317218, v95
    s_mov_b32 s46, 0
L_pa_17:
    v_mov_b32_e64 v57, 0
    s_cmp_ge_u32 s21, 6
    s_cbranch_scc1 L_nob_19
    s_waitcnt vmcnt(7)
    ds_write_b128 v9, v[32:35] offset:0
    v_bitop3_b32 v57, v57, v32, v12 bitop3:0xf6
    v_bitop3_b32 v57, v57, v34, v14 bitop3:0xf6
    s_waitcnt vmcnt(6)
    ds_write_b128 v9, v[36:39] offset:128
    v_bitop3_b32 v57, v57, v36, v12 bitop3:0xf6
    v_bitop3_b32 v57, v57, v38, v14 bitop3:0xf6
    s_waitcnt vmcnt(5)
    ds_write_b128 v9, v[40:43] offset:256
    v_bitop3_b32 v57, v57, v40, v12 bitop3:0xf6
    v_bitop3_b32 v57, v57, v42, v14 bitop3:0xf6
    s_waitcnt vmcnt(4)
    ds_write_b128 v9, v[44:47] offset:384
    v_bitop3_b32 v57, v57, v44, v12 bitop3:0xf6
    v_bitop3_b32 v57, v57, v46, v14 bitop3:0xf6
L_nob_19:
    s_waitcnt vmcnt(3)
    ds_write_b128 v8, v[16:19] offset:0
    v_bitop3_b32 v57, v57, v16, v12 bitop3:0xf6
    v_bitop3_b32 v57, v57, v18, v14 bitop3:0xf6
    s_waitcnt vmcnt(2)
    ds_write_b128 v8, v[20:23] offset:128
    v_bitop3_b32 v57, v57, v20, v12 bitop3:0xf6
    v_bitop3_b32 v57, v57, v22, v14 bitop3:0xf6
    s_waitcnt vmcnt(1)
    ds_write_b128 v8, v[24:27] offset:256
    v_bitop3_b32 v57, v57, v24, v12 bitop3:0xf6
    v_bitop3_b32 v57, v57, v26, v14 bitop3:0xf6
    s_nop 0
    s_waitcnt vmcnt(0)
    ds_write_b128 v8, v[28:31] offset:384
    v_bitop3_b32 v57, v57, v28, v12 bitop3:0xf6
    v_bitop3_b32 v57, v57, v30, v14 bitop3:0xf6
    v_and_b32 v57, 0x00030003, v57
    v_cmp_ne_u32 vcc, 0, v57
    s_cbranch_vccz L_po_18
    s_cmp_ge_u32 s21, 6
    s_cbranch_scc1 L_nob_20
    global_load_dwordx4 v[32:35], v2, s[56:57] offset:0 sc1
    global_load_dwordx4 v[36:39], v2, s[56:57] offset:1024 sc1
    global_load_dwordx4 v[40:43], v2, s[56:57] offset:2048 sc1
    global_load_dwordx4 v[44:47], v2, s[56:57] offset:3072 sc1
L_nob_20:
    global_load_dwordx4 v[16:19], v2, s[54:55] offset:0 sc1
    global_load_dwordx4 v[20:23], v2, s[54:55] offset:1024 sc1
    global_load_dwordx4 v[24:27], v2, s[54:55] offset:2048 sc1
    global_load_dwordx4 v[28:31], v2, s[54:55] offset:3072 sc1
    s_add_u32 s46, s46, 1
    s_cmp_lt_u32 s46, 50000
    s_cbranch_scc1 L_pa_17
    s_branch L_end
    s_nop 0
L_po_18:
    v_and_b32 v57, 8, v10
    s_mov_b64 exec, 1
    ds_add_u32 v57, v76 offset:48
    s_mov_b64 exec, -1
    s_setprio 0
    ds_read_b64 v[112:113], v6 offset:0
    ds_read_b64 v[114:115], v6 offset:4624
    ds_read_b64 v[116:117], v6 offset:9248
    ds_read_b64 v[118:119], v6 offset:13872
    ds_read_b64 v[120:121], v6 offset:18496
    ds_read_b64 v[122:123], v6 offset:23120
    ds_read_b64 v[124:125], v6 offset:27744
    ds_read_b64 v[126:127], v6 offset:32368
    s_mov_b32 s46, 0
L_sp_21:
    ds_read_b128 v[80:83], v3 offset:0
    ds_read_b128 v[84:87], v3 offset:16
    s_waitcnt lgkmcnt(0)
    v_min3_u32 v96, v80, v81, v82
    v_min3_u32 v96, v96, v83, v84
    v_min3_u32 v96, v96, v85, v86
    v_min_u32 v96, v96, v87
    v_cmp_eq_u32 vcc, 0, v96
    s_cbranch_vccz L_spd_22
    s_add_u32 s46, s46, 1
    s_sleep 1
    s_cmp_lt_u32 s46, 400000
    s_cbranch_scc1 L_sp_21
    s_branch L_end
L_spd_22:
    v_exp_f16 v96, v112
    v_exp_f16_sdwa v97, v112 dst_sel:DWORD dst_unused:UNUSED_PAD src0_sel:WORD_1
    v_exp_f16_e64 v98, v113
    v_exp_f16_sdwa v99, v113 dst_sel:DWORD dst_unused:UNUSED_PAD src0_sel:WORD_1
    v_fma_mix_f32 v96, v96, v80, v80 op_sel:[0,0,0] op_sel_hi:[1,0,0]
    v_fma_mix_f32 v97, v97, v80, v80 op_sel:[0,0,0] op_sel_hi:[1,0,0]
    v_fma_mix_f32 v98, v98, v80, v80 op_sel:[0,0,0] op_sel_hi:[1,0,0]
    v_fma_mix_f32 v99, v99, v80, v80 op_sel:[0,0,0] op_sel_hi:[1,0,0]
    v_rcp_f32 v16, v96
    v_rcp_f32 v17, v97
    v_rcp_f32 v18, v98
    v_rcp_f32 v19, v99
    v_exp_f16 v96, v114
    v_exp_f16_sdwa v97, v114 dst_sel:DWORD dst_unused:UNUSED_PAD src0_sel:WORD_1
    v_exp_f16 v98, v115
    v_exp_f16_sdwa v99, v115 dst_sel:DWORD dst_unused:UNUSED_PAD src0_sel:WORD_1
    v_fma_mix_f32 v96, v96, v81, v81 op_sel:[0,0,0] op_sel_hi:[1,0,0]
    v_fma_mix_f32 v97, v97, v81, v81 op_sel:[0,0,0] op_sel_hi:[1,0,0]
    v_fma_mix_f32 v98, v98, v81, v81 op_sel:[0,0,0] op_sel_hi:[1,0,0]
    v_fma_mix_f32 v99, v99, v81, v81 op_sel:[0,0,0] op_sel_hi:[1,0,0]
    v_rcp_f32 v20, v96
    v_rcp_f32 v21, v97
    v_rcp_f32 v22, v98
    v_rcp_f32 v23, v99
    v_exp_f16_e64 v96, v116
    v_exp_f16_sdwa v97, v116 dst_sel:DWORD dst_unused:UNUSED_PAD src0_sel:WORD_1
    v_exp_f16_e64 v98, v117
    v_exp_f16_sdwa v99, v117 dst_sel:DWORD dst_unused:UNUSED_PAD src0_sel:WORD_1
    v_fma_mix_f32 v96, v96, v82, v82 op_sel:[0,0,0] op_sel_hi:[1,0,0]
    v_fma_mix_f32 v97, v97, v82, v82 op_sel:[0,0,0] op_sel_hi:[1,0,0]
    v_fma_mix_f32 v98, v98, v82, v82 op_sel:[0,0,0] op_sel_hi:[1,0,0]
    v_fma_mix_f32 v99, v99, v82, v82 op_sel:[0,0,0] op_sel_hi:[1,0,0]
    v_rcp_f32 v24, v96
    v_rcp_f32 v25, v97
    v_rcp_f32 v26, v98
    v_rcp_f32 v27, v99
    v_exp_f16_e64 v96, v118
    v_exp_f16_sdwa v97, v118 dst_sel:DWORD dst_unused:UNUSED_PAD src0_sel:WORD_1
    v_exp_f16_e64 v98, v119
    v_exp_f16_sdwa v99, v119 dst_sel:DWORD dst_unused:UNUSED_PAD src0_sel:WORD_1
    v_fma_mix_f32 v96, v96, v83, v83 op_sel:[0,0,0] op_sel_hi:[1,0,0]
    v_fma_mix_f32 v97, v97, v83, v83 op_sel:[0,0,0] op_sel_hi:[1,0,0]
    v_fma_mix_f32 v98, v98, v83, v83 op_sel:[0,0,0] op_sel_hi:[1,0,0]
    v_fma_mix_f32 v99, v99, v83, v83 op_sel:[0,0,0] op_sel_hi:[1,0,0]
    v_rcp_f32 v28, v96
    v_rcp_f32 v29, v97
    v_rcp_f32 v30, v98
    v_rcp_f32 v31, v99
    v_exp_f16_e64 v96, v120
    v_exp_f16_sdwa v97, v120 dst_sel:DWORD dst_unused:UNUSED_PAD src0_sel:WORD_1
    v_exp_f16_e64 v98, v121
    v_exp_f16_sdwa v99, v121 dst_sel:DWORD dst_unused:UNUSED_PAD src0_sel:WORD_1
    v_fma_mix_f32 v96, v96, v84, v84 op_sel:[0,0,0] op_sel_hi:[1,0,0]
    v_fma_mix_f32 v97, v97, v84, v84 op_sel:[0,0,0] op_sel_hi:[1,0,0]
    v_fma_mix_f32 v98, v98, v84, v84 op_sel:[0,0,0] op_sel_hi:[1,0,0]
    v_fma_mix_f32 v99, v99, v84, v84 op_sel:[0,0,0] op_sel_hi:[1,0,0]
    v_rcp_f32 v32, v96
    v_rcp_f32 v33, v97
    v_rcp_f32 v34, v98
    v_rcp_f32 v35, v99
    v_exp_f16_e64 v96, v122
    v_exp_f16_sdwa v97, v122 dst_sel:DWORD dst_unused:UNUSED_PAD src0_sel:WORD_1
    v_exp_f16_e64 v98, v123
    v_exp_f16_sdwa v99, v123 dst_sel:DWORD dst_unused:UNUSED_PAD src0_sel:WORD_1
    v_fma_mix_f32 v96, v96, v85, v85 op_sel:[0,0,0] op_sel_hi:[1,0,0]
    v_fma_mix_f32 v97, v97, v85, v85 op_sel:[0,0,0] op_sel_hi:[1,0,0]
    v_fma_mix_f32 v98, v98, v85, v85 op_sel:[0,0,0] op_sel_hi:[1,0,0]
    v_fma_mix_f32 v99, v99, v85, v85 op_sel:[0,0,0] op_sel_hi:[1,0,0]
    v_rcp_f32 v36, v96
    v_rcp_f32 v37, v97
    v_rcp_f32 v38, v98
    v_rcp_f32 v39, v99
    v_exp_f16_e64 v96, v124
    v_exp_f16_sdwa v97, v124 dst_sel:DWORD dst_unused:UNUSED_PAD src0_sel:WORD_1
    v_exp_f16_e64 v98, v125
    v_exp_f16_sdwa v99, v125 dst_sel:DWORD dst_unused:UNUSED_PAD src0_sel:WORD_1
    v_fma_mix_f32 v96, v96, v86, v86 op_sel:[0,0,0] op_sel_hi:[1,0,0]
    v_fma_mix_f32 v97, v97, v86, v86 op_sel:[0,0,0] op_sel_hi:[1,0,0]
    v_fma_mix_f32 v98, v98, v86, v86 op_sel:[0,0,0] op_sel_hi:[1,0,0]
    v_fma_mix_f32 v99, v99, v86, v86 op_sel:[0,0,0] op_sel_hi:[1,0,0]
    v_rcp_f32 v40, v96
    v_rcp_f32 v41, v97
    v_rcp_f32 v42, v98
    v_rcp_f32 v43, v99
    v_exp_f16_e64 v96, v126
    v_exp_f16_sdwa v97, v126 dst_sel:DWORD dst_unused:UNUSED_PAD src0_sel:WORD_1
    v_exp_f16_e64 v98, v127
    v_exp_f16_sdwa v99, v127 dst_sel:DWORD dst_unused:UNUSED_PAD src0_sel:WORD_1
    v_fma_mix_f32 v96, v96, v87, v87 op_sel:[0,0,0] op_sel_hi:[1,0,0]
    v_fma_mix_f32 v97, v97, v87, v87 op_sel:[0,0,0] op_sel_hi:[1,0,0]
    v_fma_mix_f32 v98, v98, v87, v87 op_sel:[0,0,0] op_sel_hi:[1,0,0]
    v_fma_mix_f32 v99, v99, v87, v87 op_sel:[0,0,0] op_sel_hi:[1,0,0]
    v_rcp_f32 v44, v96
    v_rcp_f32 v45, v97
    v_rcp_f32_e64 v46, v98
    v_rcp_f32_e64 v47, v99
    s_mov_b32 s46, 0
L_sp_23:
    ds_read_b64 v[100:101], v3 offset:32
    s_waitcnt lgkmcnt(0)
    v_cmp_eq_u32 vcc, 0, v100
    s_cbranch_vccz L_spd_24
    s_add_u32 s46, s46, 1
    s_sleep 1
    s_cmp_lt_u32 s46, 400000
    s_cbranch_scc1 L_sp_23
    s_branch L_end
L_spd_24:
    s_mov_b64 s[4:5], -1
    s_mov_b64 s[6:7], -1
    s_mov_b64 s[8:9], -1
    s_mov_b64 s[10:11], -1
    v_readfirstlane_b32 s40, v100
    s_andn2_b32 s40, 2047, s40
    s_lshr_b32 s41, s40, 8
    s_cmp_lg_u32 s41, s20
    s_cbranch_scc1 L_nomk_25
    s_bfe_u32 s41, s40, 0x20002
    s_bfe_u32 s42, s40, 0x40004
    s_lshl4_add_u32 s41, s41, s42
    s_lshl_b64 s[42:43], 1, s41
    s_and_b32 s40, s40, 3
    s_cmp_eq_u32 s40, 0
    s_cselect_b64 s[44:45], s[42:43], 0
    s_andn2_b64 s[4:5], s[4:5], s[44:45]
    s_cmp_eq_u32 s40, 1
    s_cselect_b64 s[44:45], s[42:43], 0
    s_andn2_b64 s[6:7], s[6:7], s[44:45]
    s_cmp_eq_u32 s40, 2
    s_cselect_b64 s[44:45], s[42:43], 0
    s_andn2_b64 s[8:9], s[8:9], s[44:45]
    s_cmp_eq_u32 s40, 3
    s_cselect_b64 s[44:45], s[42:43], 0
    s_andn2_b64 s[10:11], s[10:11], s[44:45]
L_nomk_25:
    v_readfirstlane_b32 s40, v101
    s_andn2_b32 s40, 2047, s40
    s_lshr_b32 s41, s40, 8
    s_cmp_lg_u32 s41, s20
    s_cbranch_scc1 L_nomk_26
    s_bfe_u32 s41, s40, 0x20002
    s_bfe_u32 s42, s40, 0x40004
    s_lshl4_add_u32 s41, s41, s42
    s_lshl_b64 s[42:43], 1, s41
    s_and_b32 s40, s40, 3
    s_cmp_eq_u32 s40, 0
    s_cselect_b64 s[44:45], s[42:43], 0
    s_andn2_b64 s[4:5], s[4:5], s[44:45]
    s_cmp_eq_u32 s40, 1
    s_cselect_b64 s[44:45], s[42:43], 0
    s_andn2_b64 s[6:7], s[6:7], s[44:45]
    s_cmp_eq_u32 s40, 2
    s_cselect_b64 s[44:45], s[42:43], 0
    s_andn2_b64 s[8:9], s[8:9], s[44:45]
    s_cmp_eq_u32 s40, 3
    s_cselect_b64 s[44:45], s[42:43], 0
    s_andn2_b64 s[10:11], s[10:11], s[44:45]
L_nomk_26:
    s_setprio 2
    s_mov_b32 s46, 0
L_sp_27:
    ds_read_b32 v96, v10 offset:64
    s_waitcnt lgkmcnt(0)
    v_cmp_gt_u32 vcc, 8, v96
    s_cbranch_vccz L_spd_28
    s_add_u32 s46, s46, 1
    s_sleep 1
    s_cmp_lt_u32 s46, 400000
    s_cbranch_scc1 L_sp_27
    s_branch L_end
    s_nop 0
L_spd_28:
    ds_read_b64 v[48:49], v5 offset:0
    ds_read_b64 v[50:51], v5 offset:14416
    ds_read_b64 v[52:53], v5 offset:28832
    ds_read_b64 v[54:55], v5 offset:43248
    ds_read_b64 v[56:57], v11 offset:0
    ds_read_b64 v[58:59], v11 offset:14416
    ds_read_b64 v[60:61], v11 offset:28832
    ds_read_b64 v[62:63], v11 offset:43248
    s_waitcnt lgkmcnt(6)
    v_fma_mix_f32 v16, v48, v16, v92 op_sel:[0,0,0] op_sel_hi:[1,0,0]
    v_fma_mix_f32 v20, v50, v20, v92 op_sel:[0,0,0] op_sel_hi:[1,0,0]
    s_waitcnt lgkmcnt(4)
    v_fma_mix_f32 v24, v52, v24, v92 op_sel:[0,0,0] op_sel_hi:[1,0,0]
    v_fma_mix_f32 v28, v54, v28, v92 op_sel:[0,0,0] op_sel_hi:[1,0,0]
    s_waitcnt lgkmcnt(2)
    v_fma_mix_f32 v32, v56, v32, v92 op_sel:[0,0,0] op_sel_hi:[1,0,0]
    v_fma_mix_f32 v36, v58, v36, v92 op_sel:[0,0,0] op_sel_hi:[1,0,0]
    s_waitcnt lgkmcnt(0)
    v_fma_mix_f32 v40, v60, v40, v92 op_sel:[0,0,0] op_sel_hi:[1,0,0]
    v_fma_mix_f32 v44, v62, v44, v92 op_sel:[0,0,0] op_sel_hi:[1,0,0]
    v_fma_mix_f32 v16, v112, v16, v88 op_sel:[0,0,0] op_sel_hi:[1,0,0]
    v_fma_mix_f32 v20, v114, v20, v88 op_sel:[0,0,0] op_sel_hi:[1,0,0]
    v_fma_mix_f32 v24, v116, v24, v88 op_sel:[0,0,0] op_sel_hi:[1,0,0]
    v_fma_mix_f32 v28, v118, v28, v88 op_sel:[0,0,0] op_sel_hi:[1,0,0]
    v_fma_mix_f32 v32, v120, v32, v88 op_sel:[0,0,0] op_sel_hi:[1,0,0]
    v_fma_mix_f32 v36, v122, v36, v88 op_sel:[0,0,0] op_sel_hi:[1,0,0]
    v_fma_mix_f32 v40, v124, v40, v88 op_sel:[0,0,0] op_sel_hi:[1,0,0]
    v_fma_mix_f32 v44, v126, v44, v88 op_sel:[0,0,0] op_sel_hi:[1,0,0]
    v_cvt_pk_bf16_f32 v64, v16, v20
    v_cvt_pk_bf16_f32 v65, v24, v28
    v_cvt_pk_bf16_f32 v66, v32, v36
    v_cvt_pk_bf16_f32 v67, v40, v44
    s_mov_b64 exec, s[4:5]
    global_store_dwordx4 v4, v[64:67], s[28:29] offset:-4096
    s_mov_b64 exec, -1
    v_fma_mix_f32 v17, v48, v17, v93 op_sel:[1,0,0] op_sel_hi:[1,0,0]
    v_fma_mix_f32 v21, v50, v21, v93 op_sel:[1,0,0] op_sel_hi:[1,0,0]
    v_fma_mix_f32 v25, v52, v25, v93 op_sel:[1,0,0] op_sel_hi:[1,0,0]
    v_fma_mix_f32 v29, v54, v29, v93 op_sel:[1,0,0] op_sel_hi:[1,0,0]
    v_fma_mix_f32 v33, v56, v33, v93 op_sel:[1,0,0] op_sel_hi:[1,0,0]
    v_fma_mix_f32 v37, v58, v37, v93 op_sel:[1,0,0] op_sel_hi:[1,0,0]
    v_fma_mix_f32 v41, v60, v41, v93 op_sel:[1,0,0] op_sel_hi:[1,0,0]
    v_fma_mix_f32 v45, v62, v45, v93 op_sel:[1,0,0] op_sel_hi:[1,0,0]
    v_fma_mix_f32 v17, v112, v17, v89 op_sel:[1,0,0] op_sel_hi:[1,0,0]
    v_fma_mix_f32 v21, v114, v21, v89 op_sel:[1,0,0] op_sel_hi:[1,0,0]
    v_fma_mix_f32 v25, v116, v25, v89 op_sel:[1,0,0] op_sel_hi:[1,0,0]
    v_fma_mix_f32 v29, v118, v29, v89 op_sel:[1,0,0] op_sel_hi:[1,0,0]
    v_fma_mix_f32 v33, v120, v33, v89 op_sel:[1,0,0] op_sel_hi:[1,0,0]
    v_fma_mix_f32 v37, v122, v37, v89 op_sel:[1,0,0] op_sel_hi:[1,0,0]
    v_fma_mix_f32 v41, v124, v41, v89 op_sel:[1,0,0] op_sel_hi:[1,0,0]
    v_fma_mix_f32 v45, v126, v45, v89 op_sel:[1,0,0] op_sel_hi:[1,0,0]
    v_cvt_pk_bf16_f32 v68, v17, v21
    v_cvt_pk_bf16_f32 v69, v25, v29
    v_cvt_pk_bf16_f32 v70, v33, v37
    v_cvt_pk_bf16_f32 v71, v41, v45
    s_mov_b64 exec, s[6:7]
    global_store_dwordx4 v4, v[68:71], s[28:29] offset:-2048
    s_mov_b64 exec, -1
    v_fma_mix_f32 v18, v49, v18, v94 op_sel:[0,0,0] op_sel_hi:[1,0,0]
    v_fma_mix_f32 v22, v51, v22, v94 op_sel:[0,0,0] op_sel_hi:[1,0,0]
    v_fma_mix_f32 v26, v53, v26, v94 op_sel:[0,0,0] op_sel_hi:[1,0,0]
    v_fma_mix_f32 v30, v55, v30, v94 op_sel:[0,0,0] op_sel_hi:[1,0,0]
    v_fma_mix_f32 v34, v57, v34, v94 op_sel:[0,0,0] op_sel_hi:[1,0,0]
    v_fma_mix_f32 v38, v59, v38, v94 op_sel:[0,0,0] op_sel_hi:[1,0,0]
    v_fma_mix_f32 v42, v61, v42, v94 op_sel:[0,0,0] op_sel_hi:[1,0,0]
    v_fma_mix_f32 v46, v63, v46, v94 op_sel:[0,0,0] op_sel_hi:[1,0,0]
    v_fma_mix_f32 v18, v113, v18, v90 op_sel:[0,0,0] op_sel_hi:[1,0,0]
    v_fma_mix_f32 v22, v115, v22, v90 op_sel:[0,0,0] op_sel_hi:[1,0,0]
    v_fma_mix_f32 v26, v117, v26, v90 op_sel:[0,0,0] op_sel_hi:[1,0,0]
    v_fma_mix_f32 v30, v119, v30, v90 op_sel:[0,0,0] op_sel_hi:[1,0,0]
    v_fma_mix_f32 v34, v121, v34, v90 op_sel:[0,0,0] op_sel_hi:[1,0,0]
    v_fma_mix_f32 v38, v123, v38, v90 op_sel:[0,0,0] op_sel_hi:[1,0,0]
    v_fma_mix_f32 v42, v125, v42, v90 op_sel:[0,0,0] op_sel_hi:[1,0,0]
    v_fma_mix_f32 v46, v127, v46, v90 op_sel:[0,0,0] op_sel_hi:[1,0,0]
    v_cvt_pk_bf16_f32 v72, v18, v22
    v_cvt_pk_bf16_f32 v73, v26, v30
    v_cvt_pk_bf16_f32 v74, v34, v38
    v_cvt_pk_bf16_f32 v75, v42, v46
    s_mov_b64 exec, s[8:9]
    global_store_dwordx4 v4, v[72:75], s[28:29] offset:0
    s_mov_b64 exec, -1
    v_fma_mix_f32 v19, v49, v19, v95 op_sel:[1,0,0] op_sel_hi:[1,0,0]
    v_fma_mix_f32 v23, v51, v23, v95 op_sel:[1,0,0] op_sel_hi:[1,0,0]
    v_fma_mix_f32 v27, v53, v27, v95 op_sel:[1,0,0] op_sel_hi:[1,0,0]
    v_fma_mix_f32 v31, v55, v31, v95 op_sel:[1,0,0] op_sel_hi:[1,0,0]
    v_fma_mix_f32 v35, v57, v35, v95 op_sel:[1,0,0] op_sel_hi:[1,0,0]
    v_fma_mix_f32 v39, v59, v39, v95 op_sel:[1,0,0] op_sel_hi:[1,0,0]
    v_fma_mix_f32 v43, v61, v43, v95 op_sel:[1,0,0] op_sel_hi:[1,0,0]
    v_fma_mix_f32 v47, v63, v47, v95 op_sel:[1,0,0] op_sel_hi:[1,0,0]
    v_fma_mix_f32 v19, v113, v19, v91 op_sel:[1,0,0] op_sel_hi:[1,0,0]
    v_fma_mix_f32 v23, v115, v23, v91 op_sel:[1,0,0] op_sel_hi:[1,0,0]
    v_fma_mix_f32 v27, v117, v27, v91 op_sel:[1,0,0] op_sel_hi:[1,0,0]
    v_fma_mix_f32 v31, v119, v31, v91 op_sel:[1,0,0] op_sel_hi:[1,0,0]
    v_fma_mix_f32 v35, v121, v35, v91 op_sel:[1,0,0] op_sel_hi:[1,0,0]
    v_fma_mix_f32 v39, v123, v39, v91 op_sel:[1,0,0] op_sel_hi:[1,0,0]
    v_fma_mix_f32 v43, v125, v43, v91 op_sel:[1,0,0] op_sel_hi:[1,0,0]
    v_fma_mix_f32 v47, v127, v47, v91 op_sel:[1,0,0] op_sel_hi:[1,0,0]
    v_cvt_pk_bf16_f32 v76, v19, v23
    v_cvt_pk_bf16_f32 v77, v27, v31
    v_cvt_pk_bf16_f32 v78, v35, v39
    v_cvt_pk_bf16_f32 v79, v43, v47
    s_mov_b64 exec, s[10:11]
    global_store_dwordx4 v4, v[76:79], s[28:29] offset:2048
    s_mov_b64 exec, -1
    s_or_b32 s40, s2, s3
    s_cbranch_scc1 L_fin
    s_add_u32 s40, s47, 1
    v_mov_b32 v5, s40
    s_mov_b64 exec, 1
    global_store_dword v3, v5, s[32:33]
    s_branch L_fin
    s_nop 0
L_exp:
    v_lshrrev_b32 v20, 4, v1
    v_and_b32 v21, 240, v2
    v_lshrrev_b32_e64 v22, 5, v1
    v_and_b32_e64 v23, 1, v20
    v_lshl_add_u32 v4, v22, 4, v23
    v_mul_u32_u24 v4, 7168, v4
    v_add_u32 v4, v4, v21
    s_bitcmp1_b32 s35, 0
    s_cselect_b64 s[48:49], s[24:25], s[22:23]
    s_lshr_b32 s40, s35, 1
    s_lshl2_add_u32 s40, s40, s34
    s_lshl_b32 s43, s40, 7
    s_mul_i32 s40, s40, 458752
    s_mul_i32 s41, s36, 37
    s_lshr_b32 s41, s41, 8
    s_mul_i32 s42, s41, 7
    s_sub_u32 s7, s36, s42
    s_lshl_b32 s41, s41, 2
    s_lshr_b32 s41, 0x2031, s41
    s_and_b32 s41, s41, 3
    s_lshl2_add_u32 s7, s7, s41
    s_lshl_b32 s41, s7, 8
    s_add_u32 s40, s40, s41
    s_add_u32 s48, s48, s40
    s_addc_u32 s49, s49, 0
    s_add_u32 s10, s48, 229376
    s_addc_u32 s11, s49, 0
    v_lshl_add_u32 v5, v22, 3, v23
    v_lshl_add_u32 v5, v5, 11, v21
    v_lshrrev_b32 v19, 1, v21
    v_and_b32 v23, 3, v1
    v_mul_u32_u24 v14, 0x5555, v23
    v_lshlrev_b32 v23, 3, v23
    v_lshl_add_u32 v17, v20, 5, v23
    v_and_b32 v22, 8, v1
    v_lshl_add_u32 v11, v22, 6, v17
    v_bfe_i32 v9, v1, 2, 1
    v_lshrrev_b32 v7, 16, v9
    v_lshlrev_b32 v9, 16, v9
    v_xor_b32 v6, 0xffff, v7
    v_xor_b32 v8, 0xffff0000, v9
    v_and_b32 v23, 512, v2
    v_lshl_add_u32 v23, v21, 1, v23
    v_and_b32 v22, 16, v1
    s_lshl_b32 s40, s34, 10
    v_add3_u32 v10, v22, v23, s40
    v_add_u32 v17, s43, v17
    s_add_u32 s30, s32, 32768
    s_addc_u32 s31, s33, 0
    s_lshl2_add_u32 s40, s7, s34
    s_lshl_b32 s40, s40, 16
    s_lshl_b32 s41, s35, 8
    s_add_u32 s40, s40, s41
    s_add_u32 s40, s40, 4096
    s_add_u32 s50, s26, s40
    s_addc_u32 s51, s27, 0
    s_add_u32 s52, s50, 32768
    s_addc_u32 s53, s51, 0
    s_add_u32 s74, s50, 8192
    s_addc_u32 s75, s51, 0
    s_add_u32 s76, s52, 8192
    s_addc_u32 s77, s53, 0
    s_lshl_b32 s40, s2, 7
    s_add_u32 s40, s40, 98304
    s_add_u32 s54, s32, s40
    s_addc_u32 s55, s33, 0
    s_lshl_b32 s40, s36, 10
    s_lshl2_add_u32 s40, s35, s40
    s_add_u32 s40, s40, 98304
    s_add_u32 s56, s32, s40
    s_addc_u32 s57, s33, 0
    s_lshl_b32 s40, s2, 10
    s_add_u32 s40, s40, 131072
    s_add_u32 s58, s32, s40
    s_addc_u32 s59, s33, 0
    s_lshl_b32 s40, s36, 13
    s_lshl_b32 s41, s34, 7
    s_add_u32 s40, s40, s41
    s_add_u32 s40, s40, 135168
    s_add_u32 s60, s32, s40
    s_addc_u32 s61, s33, 0
    s_mul_i32 s40, s35, 28
    s_add_u32 s40, s40, s36
    s_lshl_b32 s40, s40, 10
    s_add_u32 s40, s40, 524288
    s_add_u32 s62, s32, s40
    s_addc_u32 s63, s33, 0
    s_setprio 3
    s_lshl_b32 s40, s34, 7
    v_mov_b32 v16, s40
    s_mov_b32 s46, 0
L_sp_29:
    ds_read_b64 v[22:23], v3 offset:40
    s_waitcnt lgkmcnt(0)
    v_cmp_eq_u32_e64 vcc, 0, v23
    s_cbranch_vccz L_spd_30
    s_add_u32 s46, s46, 1
    s_cmp_lt_u32 s46, 400000
    s_cbranch_scc1 L_sp_29
    s_branch L_end
L_spd_30:
    v_readfirstlane_b32 s39, v22
    s_and_b32 s40, s39, 1
    s_mul_i32 s40, s40, 0x01010101
    s_and_b32 s41, s39, 0xfefefefe
    s_or_b32 s41, s41, s40
    v_bfe_u32 v28, s41, v11, 8
    v_lshrrev_b32 v29, v2, s41
    v_lshrrev_b32 v30, 8, v29
    s_cmp_ge_u32 s36, 28
    s_cbranch_scc1 L_noexp
    global_load_dwordx4 v[32:35], v4, s[48:49] nt
    s_add_u32 s48, s48, 14336
    s_addc_u32 s49, s49, 0
    global_load_dwordx4 v[36:39], v4, s[10:11] nt
    s_add_u32 s10, s10, 14336
    s_addc_u32 s11, s11, 0
    s_cmp_lg_u32 s34, 0
    s_cbranch_scc1 L_warm_31
    s_load_dword s8, s[54:55], 0 glc
L_warm_31:
    v_and_b32 v18, 128, v2
    v_lshl_add_u32 v18, v16, 1, v18
    global_load_dword v31, v18, s[62:63]
    s_nop 0
    s_waitcnt vmcnt(2)
    global_load_dwordx4 v[40:43], v4, s[48:49] nt
    s_add_u32 s48, s48, 14336
    s_addc_u32 s49, s49, 0
    s_waitcnt vmcnt(2)
    global_load_dwordx4 v[44:47], v4, s[10:11] nt
    s_add_u32 s10, s10, 14336
    s_addc_u32 s11, s11, 0
    s_waitcnt vmcnt(1)
    global_load_dwordx4 v[48:51], v4, s[48:49] nt
    s_add_u32 s48, s48, 14336
    s_addc_u32 s49, s49, 0
    s_waitcnt vmcnt(1)
    global_load_dwordx4 v[52:55], v4, s[10:11] nt
    s_add_u32 s10, s10, 14336
    s_addc_u32 s11, s11, 0
    s_waitcnt vmcnt(2)
    global_load_dwordx4 v[56:59], v4, s[48:49] nt
    s_add_u32 s48, s48, 14336
    s_addc_u32 s49, s49, 0
    s_waitcnt vmcnt(3)
    global_load_dwordx4 v[60:63], v4, s[10:11] nt
    s_add_u32 s10, s10, 14336
    s_addc_u32 s11, s11, 0
    s_waitcnt vmcnt(4)
    global_load_dwordx4 v[64:67], v4, s[48:49] nt
    s_add_u32 s48, s48, 14336
    s_addc_u32 s49, s49, 0
    s_waitcnt vmcnt(5)
    global_load_dwordx4 v[68:71], v4, s[10:11] nt
    s_add_u32 s10, s10, 14336
    s_addc_u32 s11, s11, 0
    s_waitcnt vmcnt(5)
    global_load_dwordx4 v[72:75], v4, s[48:49] nt
    s_add_u32 s48, s48, 14336
    s_addc_u32 s49, s49, 0
    s_waitcnt vmcnt(5)
    global_load_dwordx4 v[76:79], v4, s[10:11] nt
    s_add_u32 s10, s10, 14336
    s_addc_u32 s11, s11, 0
    s_mov_b32 s46, 0
L_sp_32:
    ds_read_b64 v[24:25], v19 offset:128
    s_waitcnt lgkmcnt(0)
    v_cmp_eq_u32 vcc, 0, v24
    s_cbranch_vccz L_spd_33
    s_add_u32 s46, s46, 1
    s_sleep 1
    s_cmp_lt_u32 s46, 400000
    s_cbranch_scc1 L_sp_32
    s_branch L_end
    s_nop 0
L_spd_33:
    v_max_u32_dpp v27, v25, v25 quad_perm:[1,0,3,2] row_mask:0xf bank_mask:0xf
    v_min_u32_dpp v26, v24, v24 quad_perm:[1,0,3,2] row_mask:0xf bank_mask:0xf
    v_max_u32 v25, v26, v27
    v_max_u32_dpp v24, v24, v24 quad_perm:[1,0,3,2] row_mask:0xf bank_mask:0xf
    s_nop 0
    v_max_u32_dpp v27, v25, v25 quad_perm:[2,3,0,1] row_mask:0xf bank_mask:0xf
    v_min_u32_dpp v26, v24, v24 quad_perm:[2,3,0,1] row_mask:0xf bank_mask:0xf
    v_max_u32 v25, v26, v27
    v_max_u32_dpp v24, v24, v24 quad_perm:[2,3,0,1] row_mask:0xf bank_mask:0xf
    s_nop 0
    v_max_u32_dpp v27, v25, v25 row_half_mirror row_mask:0xf bank_mask:0xf
    v_min_u32_dpp v26, v24, v24 row_half_mirror row_mask:0xf bank_mask:0xf
    v_max_u32 v25, v26, v27
    v_max_u32_dpp v24, v24, v24 row_half_mirror row_mask:0xf bank_mask:0xf
    s_nop 0
    v_max_u32_dpp v27, v25, v25 row_mirror row_mask:0xf bank_mask:0xf
    v_min_u32_dpp v26, v24, v24 row_mirror row_mask:0xf bank_mask:0xf
    v_max_u32_e64 v25, v26, v27
    v_max_u32_dpp v24, v24, v24 row_mirror row_mask:0xf bank_mask:0xf
    s_mov_b32 vcc_lo, 0xff00ff00
    s_mov_b32 vcc_hi, 0xff00ff00
    s_movk_i32 s40, 2047
    v_cndmask_b32 v16, v24, v25, vcc
    v_bfi_b32 v18, v16, 0, s40
    v_lshl_add_u32 v17, v18, 11, v17
    v_lshlrev_b32_e64 v18, 3, v18
    global_load_dwordx2 v[20:21], v17, s[4:5]
    global_load_dword v22, v18, s[30:31] sc1
    v_mov_b32_e64 v0, 1
    s_mov_b64 exec, 1
    ds_add_u32 v3, v0 offset:92
    s_mov_b64 exec, -1
    global_load_dwordx4 v[80:83], v4, s[48:49] nt
    s_add_u32 s48, s48, 14336
    s_addc_u32 s49, s49, 0
    global_load_dwordx4 v[84:87], v4, s[10:11] nt
    s_add_u32 s10, s10, 14336
    s_addc_u32 s11, s11, 0
    global_load_dwordx4 v[88:91], v4, s[48:49] nt
    global_load_dwordx4 v[92:95], v4, s[10:11] nt
    s_mov_b64 exec, 1
    ds_write_b64 v3, v[24:25] offset:32
    s_mov_b64 exec, -1
    v_readfirstlane_b32 s16, v24
    v_readfirstlane_b32 s17, v25
    s_cmp_eq_u32 s34, 0
    s_cselect_b32 s16, s16, s17
    s_andn2_b32 s17, 2047, s16
    s_lshr_b32 s40, s17, 8
    s_add_u32 s41, s40, 2
    s_bfe_u32 s19, s41, 0x10002
    s_xor_b32 s19, s19, s38
    s_and_b32 s42, s34, 2
    s_or_b32 s19, s19, s42
    s_cmp_eq_u32 s38, 0
    s_cselect_b32 s18, s40, s41
    s_and_b32 s18, s18, 3
    s_mul_i32 s40, s35, 28672
    s_and_b32 s41, s34, 1
    s_lshl_b32 s41, s41, 9
    s_add_u32 s40, s40, s41
    s_and_b32 s41, s36, 15
    s_lshl_b32 s41, s41, 5
    s_add_u32 s40, s40, s41
    s_add_u32 s40, s40, 524288
    s_add_u32 s22, s32, s40
    s_addc_u32 s23, s33, 0
    s_add_u32 s24, s22, 262144
    s_nop 0
    s_addc_u32 s25, s23, 0
    s_bfe_u32 s40, s17, 0x20002
    s_bfe_u32 s41, s17, 0x40004
    s_lshl4_add_u32 s40, s40, s41
    s_and_b32 s41, s17, 3
    s_lshl2_add_u32 s40, s40, s41
    s_lshl_b32 s41, s18, 8
    s_add_u32 s40, s40, s41
    s_lshl_b32 s40, s40, 1
    s_add_u32 s20, s40, 52096
    s_bitcmp1_b32 s16, 31
    s_brev_b32 s40, 1
    s_cselect_b32 s40, s40, -1
    s_xor_b32 s40, s40, s16
    s_and_b32 s21, s40, 0xffff0000
    v_mov_b32 v0, 1
    s_waitcnt vmcnt(4)
    v_and_b32 v17, 0xffff0000, v22
    v_rcp_f32 v17, v17
    v_lshlrev_b32 v22, 16, v22
    v_lshlrev_b32_e64 v24, 16, v20
    v_and_b32 v25, 0xffff0000, v20
    v_mul_f32 v22, -v22, v17
    v_lshlrev_b32_e64 v26, 16, v21
    v_and_b32 v27, 0xffff0000, v21
    v_fma_f32 v24, v24, v17, v22
    v_fma_f32 v25, v25, v17, v22
    v_fma_f32 v26, v26, v17, v22
    v_fma_f32 v27, v27, v17, v22
    v_cvt_pk_bf16_f32 v12, v24, v25
    v_cvt_pk_bf16_f32 v13, v26, v27
    v_mov_b32 v24, 0
    v_mov_b32 v25, 0
    v_mov_b32_e64 v26, 0
    v_mov_b32_e64 v27, 0
    v_and_b32_dpp v16, v12, v6 quad_perm:[0,0,0,0] row_mask:0xf bank_mask:0xf
    v_and_b32_dpp v17, v12, v7 quad_perm:[0,0,0,0] row_mask:0xf bank_mask:0xf
    v_and_b32_dpp v18, v12, v8 quad_perm:[0,0,0,0] row_mask:0xf bank_mask:0xf
    v_and_b32_dpp v19, v12, v9 quad_perm:[0,0,0,0] row_mask:0xf bank_mask:0xf
    v_and_b32_dpp v20, v13, v6 quad_perm:[0,0,0,0] row_mask:0xf bank_mask:0xf
    v_and_b32_dpp v21, v13, v7 quad_perm:[0,0,0,0] row_mask:0xf bank_mask:0xf
    v_and_b32_dpp v22, v13, v8 quad_perm:[0,0,0,0] row_mask:0xf bank_mask:0xf
    v_and_b32_dpp v23, v13, v9 quad_perm:[0,0,0,0] row_mask:0xf bank_mask:0xf
    v_smfmac_f32_16x16x64_bf16 v[24:27], v[16:19], v[32:39], v14
    v_and_b32_dpp v16, v12, v6 quad_perm:[1,1,1,1] row_mask:0xf bank_mask:0xf
    v_and_b32_dpp v17, v12, v7 quad_perm:[1,1,1,1] row_mask:0xf bank_mask:0xf
    v_and_b32_dpp v18, v12, v8 quad_perm:[1,1,1,1] row_mask:0xf bank_mask:0xf
    v_and_b32_dpp v19, v12, v9 quad_perm:[1,1,1,1] row_mask:0xf bank_mask:0xf
    v_smfmac_f32_16x16x64_bf16 v[24:27], v[20:23], v[40:47], v14
    v_and_b32_dpp v20, v13, v6 quad_perm:[1,1,1,1] row_mask:0xf bank_mask:0xf
    v_and_b32_dpp v21, v13, v7 quad_perm:[1,1,1,1] row_mask:0xf bank_mask:0xf
    v_and_b32_dpp v22, v13, v8 quad_perm:[1,1,1,1] row_mask:0xf bank_mask:0xf
    v_and_b32_dpp v23, v13, v9 quad_perm:[1,1,1,1] row_mask:0xf bank_mask:0xf
    v_smfmac_f32_16x16x64_bf16 v[24:27], v[16:19], v[48:55], v14
    v_and_b32_dpp v16, v12, v6 quad_perm:[2,2,2,2] row_mask:0xf bank_mask:0xf
    v_and_b32_dpp v17, v12, v7 quad_perm:[2,2,2,2] row_mask:0xf bank_mask:0xf
    v_and_b32_dpp v18, v12, v8 quad_perm:[2,2,2,2] row_mask:0xf bank_mask:0xf
    v_and_b32_dpp v19, v12, v9 quad_perm:[2,2,2,2] row_mask:0xf bank_mask:0xf
    v_smfmac_f32_16x16x64_bf16 v[24:27], v[20:23], v[56:63], v14
    v_and_b32_dpp v20, v13, v6 quad_perm:[2,2,2,2] row_mask:0xf bank_mask:0xf
    v_and_b32_dpp v21, v13, v7 quad_perm:[2,2,2,2] row_mask:0xf bank_mask:0xf
    v_and_b32_dpp v22, v13, v8 quad_perm:[2,2,2,2] row_mask:0xf bank_mask:0xf
    v_and_b32_dpp v23, v13, v9 quad_perm:[2,2,2,2] row_mask:0xf bank_mask:0xf
    s_mov_b64 exec, 1
    ds_add_rtn_u32 v31, v3, v0 offset:60
    s_mov_b64 exec, -1
    v_smfmac_f32_16x16x64_bf16 v[24:27], v[16:19], v[64:71], v14
    v_and_b32_dpp v16, v12, v6 quad_perm:[3,3,3,3] row_mask:0xf bank_mask:0xf
    v_and_b32_dpp v17, v12, v7 quad_perm:[3,3,3,3] row_mask:0xf bank_mask:0xf
    v_and_b32_dpp v18, v12, v8 quad_perm:[3,3,3,3] row_mask:0xf bank_mask:0xf
    v_and_b32_dpp v19, v12, v9 quad_perm:[3,3,3,3] row_mask:0xf bank_mask:0xf
    v_smfmac_f32_16x16x64_bf16 v[24:27], v[20:23], v[72:79], v14
    v_and_b32_dpp v20, v13, v6 quad_perm:[3,3,3,3] row_mask:0xf bank_mask:0xf
    v_and_b32_dpp v21, v13, v7 quad_perm:[3,3,3,3] row_mask:0xf bank_mask:0xf
    v_and_b32_dpp v22, v13, v8 quad_perm:[3,3,3,3] row_mask:0xf bank_mask:0xf
    v_and_b32_dpp v23, v13, v9 quad_perm:[3,3,3,3] row_mask:0xf bank_mask:0xf
    s_waitcnt vmcnt(2)
    v_smfmac_f32_16x16x64_bf16 v[24:27], v[16:19], v[80:87], v14
    global_load_dwordx4 v[96:99], v5, s[50:51] offset:-4096 nt
    s_waitcnt vmcnt(1)
    s_waitcnt lgkmcnt(0)
    v_readfirstlane_b32 s40, v31
    s_cmp_lg_u32 s40, 3
    s_cbranch_scc1 L_ef_34
    v_mov_b32_e64 v31, s39
    v_lshlrev_b32 v0, 7, v1
    s_mov_b64 exec, 255
    global_store_dword v0, v31, s[56:57] sc1
    s_mov_b64 exec, -1
L_ef_34:
    v_smfmac_f32_16x16x64_bf16 v[24:27], v[20:23], v[88:95], v14
    global_load_dwordx4 v[100:103], v5, s[52:53] offset:-4096 nt
    v_mov_b32_e64 v0, 1
    s_movk_i32 s6, 255
    s_nop 4
    ds_write_b128 v10, v[24:27] offset:768
    s_mov_b64 exec, 1
    ds_add_rtn_u32 v31, v3, v0 offset:52
    s_mov_b64 exec, -1
    ds_read_b128 v[48:51], v2 offset:768
    ds_read_b128 v[52:55], v2 offset:1792
    ds_read_b128 v[56:59], v2 offset:2816
    ds_read_b128 v[60:63], v2 offset:3840
    s_waitcnt lgkmcnt(4)
    v_readfirstlane_b32 s40, v31
    s_cmp_lg_u32 s40, 3
    s_cbranch_scc1 L_ha_35
    s_waitcnt lgkmcnt(2)
    v_add_f32 v48, v48, v52
    v_add_f32 v49, v49, v53
    v_add_f32 v50, v50, v54
    v_add_f32 v51, v51, v55
    s_waitcnt lgkmcnt(0)
    v_add_f32 v56, v56, v60
    v_add_f32 v57, v57, v61
    v_add_f32 v58, v58, v62
    v_add_f32 v59, v59, v63
    v_add_f32 v48, v48, v56
    v_add_f32 v49, v49, v57
    v_add_f32 v50, v50, v58
    v_add_f32 v51, v51, v59
    v_bfi_b32 v48, s6, v29, v48
    v_bfi_b32 v50, s6, v30, v50
    global_store_dwordx4 v2, v[48:51], s[58:59] sc1
L_ha_35:
    global_load_dwordx4 v[104:107], v5, s[50:51] offset:0 nt
    global_load_dwordx4 v[108:111], v5, s[52:53] offset:0 nt
    global_load_dwordx4 v[112:115], v5, s[74:75] offset:-4096 nt
    global_load_dwordx4 v[116:119], v5, s[76:77] offset:-4096 nt
    global_load_dwordx4 v[120:123], v5, s[74:75] offset:0 nt
    global_load_dwordx4 v[124:127], v5, s[76:77] offset:0 nt
    v_mov_b32 v24, 0
    v_mov_b32 v25, 0
    v_mov_b32 v26, 0
    v_mov_b32 v27, 0
    s_cmp_lg_u32 s19, 0
    s_cbranch_scc1 L_nort_36
    v_and_b32 v75, 3, v1
    v_lshrrev_b32 v72, 5, v1
    v_lshl_add_u32 v72, v75, 1, v72
    v_lshrrev_b32 v73, 2, v1
    v_lshlrev_b32 v73, 10, v73
    v_lshl_add_u32 v73, v75, 3, v73
    v_add_u32 v74, 16384, v73
    s_lshl_b32 s40, s17, 11
    s_lshl4_add_u32 s40, s37, s40
    v_lshl_add_u32 v75, v72, 1, s40
    global_load_ushort v76, v75, s[4:5]
    v_mov_b32 v80, 0xbfb8aa3b
    v_mul_f32 v80, s21, v80
    v_exp_f32 v80, v80
    v_mov_b32 v84, v28
    v_mov_b32 v85, 0
    v_add_f32 v80, 1.0, v80
    v_rcp_f32_e64 v80, v80
    s_lshl_b32 s40, s18, 2
    v_mov_b32_e64 v81, s40
    v_mul_f32 v80, 0xbfb8aa3b, v80
    v_mul_u32_u24 v78, 14416, v72
    v_add_u32 v78, s20, v78
    s_lshl_b32 s40, s17, 1
    v_mul_u32_u24 v77, 4624, v72
    v_add_u32_e64 v77, s40, v77
    v_lshlrev_b32 v79, 2, v72
L_nort_36:
    s_mov_b32 s46, 0
L_mf_37:
    s_load_dwordx8 s[8:15], s[54:55], 0 glc
    s_add_u32 s46, s46, 1
    s_cmp_gt_u32 s46, 50000
    s_cbranch_scc1 L_end
    s_waitcnt lgkmcnt(0)
    s_xor_b32 s40, s8, s39
    s_xor_b32 s41, s9, s39
    s_or_b32 s40, s40, s41
    s_xor_b32 s41, s10, s39
    s_or_b32 s40, s40, s41
    s_xor_b32 s41, s11, s39
    s_or_b32 s40, s40, s41
    s_xor_b32 s41, s12, s39
    s_or_b32 s40, s40, s41
    s_xor_b32 s41, s13, s39
    s_or_b32 s40, s40, s41
    s_xor_b32 s41, s14, s39
    s_or_b32 s40, s40, s41
    s_xor_b32 s41, s15, s39
    s_or_b32 s40, s40, s41
    s_cbranch_scc1 L_mf_37
    s_mov_b32 s46, 0
L_hp_38:
    global_load_dwordx2 v[32:33], v11, s[60:61] offset:-4096 sc1
    global_load_dwordx2 v[34:35], v11, s[60:61] offset:-3072 sc1
    global_load_dwordx2 v[36:37], v11, s[60:61] offset:-2048 sc1
    global_load_dwordx2 v[38:39], v11, s[60:61] offset:-1024 sc1
    global_load_dwordx2 v[40:41], v11, s[60:61] offset:0 sc1
    global_load_dwordx2 v[42:43], v11, s[60:61] offset:1024 sc1
    global_load_dwordx2 v[44:45], v11, s[60:61] offset:2048 sc1
    global_load_dwordx2 v[46:47], v11, s[60:61] offset:3072 sc1
    s_add_u32 s46, s46, 1
    s_cmp_gt_u32 s46, 50000
    s_cbranch_scc1 L_end
L_hc_39:
    s_waitcnt vmcnt(7)
    v_xor_b32 v31, v28, v32
    s_waitcnt vmcnt(6)
    v_bitop3_b32 v31, v31, v34, v28 bitop3:0xf6
    s_waitcnt vmcnt(5)
    v_bitop3_b32 v31, v31, v36, v28 bitop3:0xf6
    v_add_f32 v64, v32, v36
    v_add_f32 v65, v33, v37
    s_waitcnt vmcnt(4)
    v_bitop3_b32 v31, v31, v38, v28 bitop3:0xf6
    v_add_f32 v66, v34, v38
    v_add_f32 v67, v35, v39
    s_waitcnt vmcnt(3)
    v_bitop3_b32 v31, v31, v40, v28 bitop3:0xf6
    v_add_f32 v64, v64, v40
    v_add_f32_e64 v65, v65, v41
    s_waitcnt vmcnt(2)
    v_bitop3_b32 v31, v31, v42, v28 bitop3:0xf6
    v_add_f32 v66, v66, v42
    v_add_f32 v67, v67, v43
    s_waitcnt vmcnt(1)
    v_bitop3_b32 v31, v31, v44, v28 bitop3:0xf6
    v_add_f32 v64, v64, v44
    v_add_f32 v65, v65, v45
    s_waitcnt vmcnt(0)
    v_bitop3_b32 v31, v31, v46, v28 bitop3:0xf6
    v_add_f32 v66, v66, v46
    v_add_f32 v67, v67, v47
    v_and_b32 v31, 0xff, v31
    v_cmp_ne_u32_e64 vcc, 0, v31
    v_mul_f32 v68, 0xbfb8aa3b, v64
    v_mul_f32 v69, 0xbfb8aa3b, v65
    s_cbranch_vccnz L_hp_38
    v_exp_f32 v68, v68
    v_exp_f32 v69, v69
    v_mul_f32 v64, v64, v66
    v_mul_f32 v65, v65, v67
    v_add_f32 v68, 1.0, v68
    v_add_f32 v69, 1.0, v69
    v_rcp_f32 v68, v68
    v_rcp_f32 v69, v69
    v_mul_f32 v64, v64, v68
    v_mul_f32 v65, v65, v69
    v_cvt_pk_bf16_f32 v12, v64, v65
    s_nop 1
    v_and_b32_dpp v16, v12, v6 quad_perm:[0,0,0,0] row_mask:0xf bank_mask:0xf
    v_and_b32_dpp v17, v12, v7 quad_perm:[0,0,0,0] row_mask:0xf bank_mask:0xf
    v_and_b32_dpp v18, v12, v8 quad_perm:[0,0,0,0] row_mask:0xf bank_mask:0xf
    v_and_b32_dpp v19, v12, v9 quad_perm:[0,0,0,0] row_mask:0xf bank_mask:0xf
    v_and_b32_dpp v20, v12, v6 quad_perm:[1,1,1,1] row_mask:0xf bank_mask:0xf
    v_and_b32_dpp v21, v12, v7 quad_perm:[1,1,1,1] row_mask:0xf bank_mask:0xf
    v_and_b32_dpp v22, v12, v8 quad_perm:[1,1,1,1] row_mask:0xf bank_mask:0xf
    v_and_b32_dpp v23, v12, v9 quad_perm:[1,1,1,1] row_mask:0xf bank_mask:0xf
    v_smfmac_f32_16x16x64_bf16 v[24:27], v[16:19], v[96:103], v14
    v_and_b32_dpp v16, v12, v6 quad_perm:[2,2,2,2] row_mask:0xf bank_mask:0xf
    v_and_b32_dpp v17, v12, v7 quad_perm:[2,2,2,2] row_mask:0xf bank_mask:0xf
    v_and_b32_dpp v18, v12, v8 quad_perm:[2,2,2,2] row_mask:0xf bank_mask:0xf
    v_and_b32_dpp v19, v12, v9 quad_perm:[2,2,2,2] row_mask:0xf bank_mask:0xf
    v_smfmac_f32_16x16x64_bf16 v[24:27], v[20:23], v[104:111], v14
    v_and_b32_dpp v20, v12, v6 quad_perm:[3,3,3,3] row_mask:0xf bank_mask:0xf
    v_and_b32_dpp v21, v12, v7 quad_perm:[3,3,3,3] row_mask:0xf bank_mask:0xf
    v_and_b32_dpp v22, v12, v8 quad_perm:[3,3,3,3] row_mask:0xf bank_mask:0xf
    v_and_b32_dpp v23, v12, v9 quad_perm:[3,3,3,3] row_mask:0xf bank_mask:0xf
    v_smfmac_f32_16x16x64_bf16 v[24:27], v[16:19], v[112:119], v14
    s_nop 0
    v_smfmac_f32_16x16x64_bf16 v[24:27], v[20:23], v[120:127], v14
    s_add_u32 s58, s62, 262144
    s_addc_u32 s59, s63, 0
    v_mov_b32_e64 v0, 1
    s_movk_i32 s6, 255
    s_nop 3
    ds_write_b128 v10, v[24:27] offset:768
    s_mov_b64 exec, 1
    ds_add_rtn_u32 v31, v3, v0 offset:52
    s_mov_b64 exec, -1
    ds_read_b128 v[48:51], v2 offset:768
    ds_read_b128 v[52:55], v2 offset:1792
    ds_read_b128 v[56:59], v2 offset:2816
    ds_read_b128 v[60:63], v2 offset:3840
    s_waitcnt lgkmcnt(4)
    v_readfirstlane_b32 s40, v31
    s_cmp_lg_u32 s40, 7
    s_cbranch_scc1 L_hb_40
    s_waitcnt lgkmcnt(2)
    v_add_f32 v48, v48, v52
    v_add_f32 v49, v49, v53
    v_add_f32 v50, v50, v54
    v_add_f32 v51, v51, v55
    s_waitcnt lgkmcnt(0)
    v_add_f32 v56, v56, v60
    v_add_f32 v57, v57, v61
    v_add_f32 v58, v58, v62
    v_add_f32 v59, v59, v63
    v_add_f32 v48, v48, v56
    v_add_f32 v49, v49, v57
    v_add_f32_e64 v50, v50, v58
    v_add_f32_e64 v51, v51, v59
    v_bfi_b32 v48, s6, v29, v48
    v_bfi_b32 v50, s6, v30, v50
    global_store_dwordx4 v2, v[48:51], s[62:63]
    global_store_dwordx4 v2, v[48:51], s[58:59] sc1
L_hb_40:
    s_branch L_routed
    s_nop 0
L_noexp:
    s_mov_b32 s46, 0
L_sp_41:
    ds_read_b64 v[24:25], v19 offset:128
    s_waitcnt lgkmcnt(0)
    v_cmp_eq_u32 vcc, 0, v24
    s_cbranch_vccz L_spd_42
    s_add_u32 s46, s46, 1
    s_sleep 2
    s_cmp_lt_u32 s46, 400000
    s_cbranch_scc1 L_sp_41
    s_branch L_end
L_spd_42:
    v_max_u32_dpp v27, v25, v25 quad_perm:[1,0,3,2] row_mask:0xf bank_mask:0xf
    v_min_u32_dpp v26, v24, v24 quad_perm:[1,0,3,2] row_mask:0xf bank_mask:0xf
    v_max_u32 v25, v26, v27
    v_max_u32_dpp v24, v24, v24 quad_perm:[1,0,3,2] row_mask:0xf bank_mask:0xf
    s_nop 0
    v_max_u32_dpp v27, v25, v25 quad_perm:[2,3,0,1] row_mask:0xf bank_mask:0xf
    v_min_u32_dpp v26, v24, v24 quad_perm:[2,3,0,1] row_mask:0xf bank_mask:0xf
    v_max_u32 v25, v26, v27
    v_max_u32_dpp v24, v24, v24 quad_perm:[2,3,0,1] row_mask:0xf bank_mask:0xf
    s_nop 0
    v_max_u32_dpp v27, v25, v25 row_half_mirror row_mask:0xf bank_mask:0xf
    v_min_u32_dpp v26, v24, v24 row_half_mirror row_mask:0xf bank_mask:0xf
    v_max_u32 v25, v26, v27
    v_max_u32_dpp v24, v24, v24 row_half_mirror row_mask:0xf bank_mask:0xf
    s_nop 0
    v_max_u32_dpp v27, v25, v25 row_mirror row_mask:0xf bank_mask:0xf
    v_min_u32_dpp v26, v24, v24 row_mirror row_mask:0xf bank_mask:0xf
    v_max_u32_e64 v25, v26, v27
    v_max_u32_dpp v24, v24, v24 row_mirror row_mask:0xf bank_mask:0xf
    v_mov_b32 v0, 1
    s_mov_b64 exec, 1
    ds_add_u32 v3, v0 offset:92
    s_mov_b64 exec, -1
    s_mov_b64 exec, 1
    ds_write_b64 v3, v[24:25] offset:32
    s_mov_b64 exec, -1
    v_readfirstlane_b32 s16, v24
    v_readfirstlane_b32 s17, v25
    s_cmp_eq_u32 s34, 0
    s_cselect_b32 s16, s16, s17
    s_andn2_b32 s17, 2047, s16
    s_lshr_b32 s40, s17, 8
    s_add_u32 s41, s40, 2
    s_bfe_u32 s19, s41, 0x10002
    s_xor_b32 s19, s19, s38
    s_and_b32 s42, s34, 2
    s_or_b32 s19, s19, s42
    s_cmp_eq_u32 s38, 0
    s_cselect_b32 s18, s40, s41
    s_and_b32 s18, s18, 3
    s_mul_i32 s40, s35, 28672
    s_and_b32 s41, s34, 1
    s_lshl_b32 s41, s41, 9
    s_add_u32 s40, s40, s41
    s_and_b32 s41, s36, 15
    s_lshl_b32 s41, s41, 5
    s_add_u32 s40, s40, s41
    s_add_u32 s40, s40, 524288
    s_add_u32 s22, s32, s40
    s_addc_u32 s23, s33, 0
    s_add_u32 s24, s22, 262144
    s_addc_u32 s25, s23, 0
    s_bfe_u32 s40, s17, 0x20002
    s_bfe_u32 s41, s17, 0x40004
    s_lshl4_add_u32 s40, s40, s41
    s_and_b32 s41, s17, 3
    s_lshl2_add_u32 s40, s40, s41
    s_lshl_b32 s41, s18, 8
    s_add_u32 s40, s40, s41
    s_lshl_b32 s40, s40, 1
    s_add_u32 s20, s40, 52096
    s_bitcmp1_b32 s16, 31
    s_brev_b32 s40, 1
    s_cselect_b32 s40, s40, -1
    s_xor_b32 s40, s40, s16
    s_and_b32 s21, s40, 0xffff0000
    s_cmp_lg_u32 s19, 0
    s_cbranch_scc1 L_fin
    v_and_b32 v75, 3, v1
    v_lshrrev_b32 v72, 5, v1
    v_lshl_add_u32 v72, v75, 1, v72
    v_lshrrev_b32 v73, 2, v1
    v_lshlrev_b32 v73, 10, v73
    v_lshl_add_u32 v73, v75, 3, v73
    v_add_u32 v74, 16384, v73
    s_lshl_b32 s40, s17, 11
    s_lshl4_add_u32 s40, s37, s40
    v_lshl_add_u32 v75, v72, 1, s40
    global_load_ushort v76, v75, s[4:5]
    v_mov_b32 v80, 0xbfb8aa3b
    v_mul_f32 v80, s21, v80
    v_exp_f32 v80, v80
    v_mov_b32 v84, v28
    v_mov_b32 v85, 0
    v_add_f32 v80, 1.0, v80
    v_rcp_f32 v80, v80
    s_lshl_b32 s40, s18, 2
    v_mov_b32 v81, s40
    v_mul_f32 v80, 0xbfb8aa3b, v80
    v_mul_u32_u24 v78, 14416, v72
    v_add_u32 v78, s20, v78
    s_lshl_b32 s40, s17, 1
    v_mul_u32_u24 v77, 4624, v72
    v_add_u32 v77, s40, v77
    v_lshlrev_b32 v79, 2, v72
L_nort_43:
    s_mov_b32 s46, 0
L_sp_44:
    ds_read_b32 v72, v3 offset:64
    s_waitcnt lgkmcnt(0)
    v_cmp_gt_u32 vcc, 8, v72
    s_cbranch_vccz L_spd_45
    s_add_u32 s46, s46, 1
    s_sleep 4
    s_cmp_lt_u32 s46, 400000
    s_cbranch_scc1 L_sp_44
    s_branch L_end
    s_nop 0
L_spd_45:
L_routed:
    s_cmp_lg_u32 s19, 0
    s_cbranch_scc1 L_fin
    s_mov_b32 s46, 0
L_ba_46:
    global_load_dwordx2 v[82:83], v73, s[22:23] sc1
    s_mov_b32 exec_hi, 0xffff
    global_load_dwordx2 v[84:85], v74, s[22:23] sc1
    s_mov_b32 exec_hi, -1
L_bc_47:
    s_waitcnt vmcnt(0)
    v_xor_b32_e64 v31, v28, v82
    v_bitop3_b32 v31, v31, v84, v28 bitop3:0xf6
    v_and_b32 v31, 0xff, v31
    v_cmp_ne_u32 vcc, 0, v31
    v_add_f32 v86, v82, v84
    v_add_f32_e64 v87, v83, v85
    s_cbranch_vccz L_bo_48
    s_add_u32 s46, s46, 1
    s_cmp_lt_u32 s46, 24
    s_cbranch_scc1 L_ba_46
    s_cmp_gt_u32 s46, 50000
    s_cbranch_scc1 L_end
    s_sleep 2
    global_load_dwordx2 v[82:83], v73, s[24:25] sc1
    s_mov_b32 exec_hi, 0xffff
    global_load_dwordx2 v[84:85], v74, s[24:25] sc1
    s_mov_b32 exec_hi, -1
    s_branch L_bc_47
    s_nop 0
L_bo_48:
    v_lshlrev_b32 v76, 16, v76
    s_nop 0
    v_permlane32_swap_b32 v86, v87
    v_add_f32_e64 v86, v86, v87
    v_mov_b32 v87, v86
    s_mov_b32 s46, 0
    ds_read_b32 v72, v81 offset:64
    ds_read_u16 v82, v78
    ds_read_u16 v83, v77 offset:9488
    ds_read_b32 v84, v79 offset:0
    v_permlane16_swap_b32 v86, v87
    v_add_f32 v86, v86, v87
    s_nop 1
    v_add_f32_dpp v86, v86, v86 row_ror:8 row_mask:0xf bank_mask:0xf
    s_nop 1
    v_add_f32_dpp v86, v86, v86 row_ror:4 row_mask:0xf bank_mask:0xf
    s_branch L_spc_51
    s_nop 0
L_sp_49:
    ds_read_b32 v72, v81 offset:64
    ds_read_u16 v82, v78
    ds_read_u16 v83, v77 offset:9488
    ds_read_b32 v84, v79 offset:0
L_spc_51:
    s_waitcnt lgkmcnt(0)
    v_cmp_gt_u32 vcc, 8, v72
    s_cbranch_vccz L_spd_50
    s_add_u32 s46, s46, 1
    s_sleep 1
    s_cmp_lt_u32 s46, 400000
    s_cbranch_scc1 L_sp_49
    s_branch L_end
L_spd_50:
    v_fma_mix_f32 v77, v86, v80, v83 op_sel_hi:[0,0,1]
    v_exp_f32 v86, v77
    v_fma_mix_f32 v82, v82, v77, 0 op_sel_hi:[1,0,0]
    v_fma_f32 v86, v86, v84, v84
    v_rcp_f32 v86, v86
    s_mov_b32 exec_lo, 15
    s_mov_b32 exec_hi, 15
    v_fmac_f32 v76, v82, v86
    v_cvt_pk_bf16_f32 v76, v76, v76
    global_store_short v75, v76, s[28:29]
    s_branch L_fin
    s_nop 0
L_cnv:
    v_add_u32_e64 v85, s58, v2
    ds_read_b128 v[12:15], v85 offset:0
    ds_read_b128 v[4:7], v85 offset:4624
    ds_read_b128 v[16:19], v85 offset:9248
    ds_read_b128 v[20:23], v85 offset:13872
    s_mul_i32 s50, s34, 14416
    s_add_u32 s50, s50, 45952
    s_mov_b32 m0, s50
    s_mov_b32 s52, 0x3f803f80
    s_mov_b32 s54, 0x41000000
    s_mov_b32 s55, 0
    s_mul_i32 s56, s59, 0x02020000
    s_add_u32 s56, s56, 0x01000c0c
    s_lshl3_add_u32 s40, s37, s34
    s_lshl_b32 s40, s40, 11
    s_add_u32 s40, s40, 8388608
    s_add_u32 s62, s32, s40
    s_addc_u32 s63, s33, 0
    v_mov_b32 v88, 0
    v_mov_b32 v89, 0
    v_mov_b32 v90, 0
    v_mov_b32 v91, 0
    s_mul_i32 s40, s34, 4624
    s_add_u32 s40, s40, 8960
    v_add_u32 v85, s40, v2
    s_mov_b32 exec_lo, -1
    s_mov_b32 exec_hi, 1
    ds_write_b128 v85, v[88:91]
    s_mov_b64 exec, -1
    v_mov_b32 v86, 0x3c00
    ds_write_addtid_b32 v86
    s_waitcnt lgkmcnt(0)
    s_and_b32 s41, s34, 1
    s_lshl_b32 s41, s41, 4
    s_lshr_b32 s48, s48, s41
    s_lshl_b32 s48, s48, 16
    s_lshr_b32 s51, s49, s41
    s_lshl_b32 s51, s51, 16
    v_mov_b32 v85, 0x3fb8aa3b
    v_mul_f32 v85, s48, v85
    v_exp_f32 v85, v85
    v_mov_b32 v26, 0
    v_cvt_pk_bf16_f32 v85, v85, v85
    v_writelane_b32 v26, s51, 0
    v_and_b32 v85, 0xffff0000, v85
    s_bitset0_b32 s51, 31
    v_mul_f32 v28, 0xbfb8aa3b, v85
    v_mul_f32 v29, 0x3e22f983, v85
    v_add_f32 v30, v85, v85
    v_mov_b32 v0, 1
    s_lshl_b32 s41, s60, 2
    v_mov_b32 v31, s41
    v_and_b32 v24, 12, v31
    v_add_u32 v4, s40, v4
    v_add_u32 v16, s50, v16
    v_add_u32 v17, s50, v17
    v_add_u32 v6, s50, v6
    v_add_u32 v7, s50, v7
    v_add_u32 v20, s50, v20
    v_add_u32 v18, s50, v18
    v_add_u32 v19, s50, v19
    s_mov_b32 s57, s40
    s_sub_u32 s41, s50, s57
    s_add_u32 s41, s41, 8912
    s_and_b32 s41, s41, 255
    s_add_u32 s41, s41, s57
    s_sub_u32 s41, s41, 8704
    s_mov_b32 exec_lo, 0x0f000000
    s_mov_b32 exec_hi, 0x0f000000
    v_mov_b32 v16, s41
    s_sub_u32 s41, s50, s57
    s_add_u32 s41, s41, 8816
    s_and_b32 s41, s41, 255
    s_add_u32 s41, s41, s57
    s_sub_u32 s41, s41, 8704
    s_mov_b32 exec_lo, 0xf0000000
    s_mov_b32 exec_hi, 0xf0000000
    v_mov_b32 v16, s41
    s_mov_b64 exec, -1
    s_add_u32 s41, s50, 1072
    v_sub_u32 v25, s41, v2
    s_mov_b32 s46, 0
L_sp_52:
    ds_read_b64 v[42:43], v3 offset:40
    s_waitcnt lgkmcnt(0)
    v_cmp_eq_u32 vcc, 0, v43
    s_cbranch_vccz L_spd_53
    s_add_u32 s46, s46, 1
    s_sleep 1
    s_cmp_lt_u32 s46, 400000
    s_cbranch_scc1 L_sp_52
    s_branch L_end
    s_nop 0
L_spd_53:
    v_readfirstlane_b32 s39, v42
    v_lshlrev_b32_e64 v40, 2, v1
    v_alignbit_b32 v40, v42, v42, v40
    v_bfi_b32 v40, 1, v42, v40
    v_lshrrev_b32 v41, 1, v40
    v_lshrrev_b32 v42, 2, v40
    v_lshrrev_b32_e64 v43, 3, v40
    s_add_u32 s41, s50, 6144
    v_lshl_add_u32 v1, v1, 3, s41
    s_mov_b32 s61, 0x00010001
    v_lshrrev_b32 v27, 1, v2
    s_cmp_eq_u32 s38, 0
    s_mov_b32 s40, -57664
    s_cselect_b32 s40, 57664, s40
    v_add_u32 v37, s40, v17
    v_add_u32 v36, s40, v16
    s_add_u32 s40, s40, s50
    s_sub_u32 s41, s40, s57
    s_add_u32 s41, s41, 8912
    s_and_b32 s41, s41, 255
    s_add_u32 s41, s41, s57
    s_sub_u32 s41, s41, 8704
    s_mov_b32 exec_lo, 0x0f000000
    s_mov_b32 exec_hi, 0x0f000000
    v_mov_b32 v36, s41
    s_sub_u32 s41, s40, s57
    s_add_u32 s41, s41, 8816
    s_and_b32 s41, s41, 255
    s_add_u32 s41, s41, s57
    s_sub_u32 s41, s41, 8704
    s_mov_b32 exec_lo, 0xf0000000
    s_mov_b32 exec_hi, 0xf0000000
    v_mov_b32 v36, s41
    s_mov_b64 exec, -1
    s_setprio 3
    s_waitcnt vmcnt(3)
    v_perm_b32 v32, v8, v8, s56
    v_mul_f32 v32, 0x3fb8aa3b, v32
    v_exp_f32 v32, v32
    s_waitcnt vmcnt(2)
    v_perm_b32 v33, v9, v9, s56
    v_cvt_pk_bf16_f32 v32, v32, v32
    v_and_b32 v32, 0xffff0000, v32
    v_pk_mul_f32 v[32:33], v[32:33], v[28:29]
    s_cmp_lg_u32 s59, 0
    s_cbranch_scc1 L_nosc_54
    v_pk_mul_f32 v[90:91], v[32:33], s[54:55] op_sel_hi:[1,0]
    v_exp_f32_e64 v90, v90
    v_cos_f32 v88, v91
    v_sin_f32_e64 v89, v91
    s_nop 0
    v_pk_mul_f32 v[88:89], v[88:89], v[90:91] op_sel_hi:[1,0]
    v_cvt_pk_f16_f32 v45, v88, v89
    v_pk_mul_f32 v[90:91], v[88:89], v[88:89] op_sel:[1,1] op_sel_hi:[1,0] neg_lo:[1,0]
    v_pk_fma_f32 v[88:89], v[88:89], v[88:89], v[90:91] op_sel:[0,0,0] op_sel_hi:[0,1,1]
    s_waitcnt vmcnt(0)
    s_nop 0
    v_cvt_pk_f16_f32 v46, v88, v89
    v_pk_mul_f32 v[90:91], v[88:89], v[88:89] op_sel:[1,1] op_sel_hi:[1,0] neg_lo:[1,0]
    v_and_b32 v85, 0x7fff7fff, v10
    v_pk_fma_f32 v[88:89], v[88:89], v[88:89], v[90:91] op_sel:[0,0,0] op_sel_hi:[0,1,1]
    v_and_b32 v86, 0x7fff7fff, v11
    v_cvt_pk_f16_f32 v48, v88, v89
    v_pk_mul_f32 v[90:91], v[88:89], v[88:89] op_sel:[1,1] op_sel_hi:[1,0] neg_lo:[1,0]
    v_dot2_f32_bf16 v84, v85, s52, 0
    v_pk_fma_f32 v[88:89], v[88:89], v[88:89], v[90:91] op_sel:[0,0,0] op_sel_hi:[0,1,1]
    v_dot2_f32_bf16 v84, v86, s52, v84
    v_cvt_pk_f16_f32 v52, v88, v89
    s_nop 1
    s_nop 0
    v_add_f32_dpp v84, v84, v84 row_shr:1 row_mask:0xf bank_mask:0xf
    v_pk_mul_f32 v[90:91], v[88:89], v[88:89] op_sel:[1,1] op_sel_hi:[1,0] neg_lo:[1,0]
    v_pk_fma_f32 v[88:89], v[88:89], v[88:89], v[90:91] op_sel:[0,0,0] op_sel_hi:[0,1,1]
    v_add_f32_dpp v84, v84, v84 row_shr:2 row_mask:0xf bank_mask:0xf
    v_cvt_pk_f16_f32 v60, v88, v89
    s_nop 0
    v_add_f32_dpp v84, v84, v84 row_shr:4 row_mask:0xf bank_mask:0xf
    v_exp_f32 v94, v32
    v_cos_f32 v92, v33
    v_add_f32_dpp v84, v84, v84 row_shr:8 row_mask:0xf bank_mask:0xf
    v_sin_f32 v93, v33
    s_nop 0
    v_add_f32_dpp v84, v84, v84 row_bcast:15 row_mask:0xa bank_mask:0xf
    v_pk_mul_f32 v[92:93], v[92:93], v[94:95] op_sel_hi:[1,0]
    s_nop 0
    v_add_f32_dpp v84, v84, v84 row_bcast:31 row_mask:0xc bank_mask:0xf
    v_cvt_pk_f16_f32 v61, v92, v93
    v_pk_mul_f32 v[94:95], v[92:93], v[92:93] op_sel:[1,1] op_sel_hi:[1,0] neg_lo:[1,0]
    v_fma_f32 v84, v84, v30, s51
    v_pk_fma_f32 v[92:93], v[92:93], v[92:93], v[94:95] op_sel:[0,0,0] op_sel_hi:[0,1,1]
    v_frexp_exp_i32_f32_e64 v84, v84
    v_cvt_pk_f16_f32 v62, v92, v93
    v_readlane_b32 s40, v84, 63
    s_sub_i32 s40, 126, s40
    s_max_i32 s40, s40, 67
    s_min_i32 s40, s40, 187
    s_lshl_b32 s40, s40, 23
    v_mov_b32 v78, 0x40053526
    v_mul_f32 v78, s40, v78
    v_mul_f32 v26, s40, v26
    s_mov_b64 exec, 1
    ds_write_b32 v31, v78 offset:0
    s_mov_b64 exec, -1
    s_branch L_scj_55
L_nosc_54:
    v_pk_mul_f32 v[90:91], v[32:33], s[54:55] op_sel_hi:[1,0]
    v_exp_f32 v90, v90
    v_cos_f32 v88, v91
    v_exp_f32 v94, v32
    v_sin_f32 v89, v91
    s_nop 0
    v_pk_mul_f32 v[88:89], v[88:89], v[90:91] op_sel_hi:[1,0]
    v_cos_f32 v92, v33
    v_cvt_pk_f16_f32 v45, v88, v89
    v_pk_mul_f32 v[90:91], v[88:89], v[88:89] op_sel:[1,1] op_sel_hi:[1,0] neg_lo:[1,0]
    v_sin_f32_e64 v93, v33
    v_pk_fma_f32 v[88:89], v[88:89], v[88:89], v[90:91] op_sel:[0,0,0] op_sel_hi:[0,1,1]
    v_cvt_pk_f16_f32 v46, v88, v89
    v_pk_mul_f32 v[92:93], v[92:93], v[94:95] op_sel_hi:[1,0]
    v_pk_mul_f32 v[90:91], v[88:89], v[88:89] op_sel:[1,1] op_sel_hi:[1,0] neg_lo:[1,0]
    v_pk_fma_f32 v[88:89], v[88:89], v[88:89], v[90:91] op_sel:[0,0,0] op_sel_hi:[0,1,1]
    v_cvt_pk_f16_f32 v48, v88, v89
    v_cvt_pk_f16_f32 v61, v92, v93
    v_pk_mul_f32 v[90:91], v[88:89], v[88:89] op_sel:[1,1] op_sel_hi:[1,0] neg_lo:[1,0]
    v_pk_fma_f32 v[88:89], v[88:89], v[88:89], v[90:91] op_sel:[0,0,0] op_sel_hi:[0,1,1]
    v_pk_mul_f32 v[94:95], v[92:93], v[92:93] op_sel:[1,1] op_sel_hi:[1,0] neg_lo:[1,0]
    v_cvt_pk_f16_f32 v52, v88, v89
    v_pk_mul_f32 v[90:91], v[88:89], v[88:89] op_sel:[1,1] op_sel_hi:[1,0] neg_lo:[1,0]
    v_pk_fma_f32 v[92:93], v[92:93], v[92:93], v[94:95] op_sel:[0,0,0] op_sel_hi:[0,1,1]
    v_pk_fma_f32 v[88:89], v[88:89], v[88:89], v[90:91] op_sel:[0,0,0] op_sel_hi:[0,1,1]
    v_cvt_pk_f16_f32 v60, v88, v89
    v_cvt_pk_f16_f32 v62, v92, v93
L_scj_55:
    v_pk_mul_f16 v47, v46, v45 op_sel:[1,1] op_sel_hi:[1,0] neg_lo:[1,0]
    v_pk_fma_f16 v47, v46, v45, v47 op_sel:[0,0,0] op_sel_hi:[0,1,1]
    ds_write_addtid_b32 v45 offset:272
    ds_write_addtid_b32 v46 offset:544
    v_pk_mul_f16 v49, v48, v45 op_sel:[1,1] op_sel_hi:[1,0] neg_lo:[1,0]
    v_pk_mul_f16 v50, v48, v46 op_sel:[1,1] op_sel_hi:[1,0] neg_lo:[1,0]
    v_pk_fma_f16 v49, v48, v45, v49 op_sel:[0,0,0] op_sel_hi:[0,1,1]
    v_pk_fma_f16 v50, v48, v46, v50 op_sel:[0,0,0] op_sel_hi:[0,1,1]
    ds_write_addtid_b32 v47 offset:816
    ds_write_addtid_b32 v48 offset:1088
    v_pk_mul_f16 v51, v48, v47 op_sel:[1,1] op_sel_hi:[1,0] neg_lo:[1,0]
    v_pk_fma_f16 v51, v48, v47, v51 op_sel:[0,0,0] op_sel_hi:[0,1,1]
    ds_write_addtid_b32 v49 offset:1360
    ds_write_addtid_b32 v50 offset:1632
    v_pk_mul_f32 v[90:91], v[88:89], v[88:89] op_sel:[1,1] op_sel_hi:[1,0] neg_lo:[1,0]
    v_pk_mul_f16 v53, v52, v45 op_sel:[1,1] op_sel_hi:[1,0] neg_lo:[1,0]
    v_pk_mul_f16 v54, v52, v46 op_sel:[1,1] op_sel_hi:[1,0] neg_lo:[1,0]
    v_pk_fma_f16 v53, v52, v45, v53 op_sel:[0,0,0] op_sel_hi:[0,1,1]
    v_pk_fma_f16 v54, v52, v46, v54 op_sel:[0,0,0] op_sel_hi:[0,1,1]
    ds_write_addtid_b32 v51 offset:1904
    ds_write_addtid_b32 v52 offset:2176
    v_pk_mul_f16 v55, v52, v47 op_sel:[1,1] op_sel_hi:[1,0] neg_lo:[1,0]
    v_pk_mul_f16 v56, v52, v48 op_sel:[1,1] op_sel_hi:[1,0] neg_lo:[1,0]
    v_pk_fma_f16 v55, v52, v47, v55 op_sel:[0,0,0] op_sel_hi:[0,1,1]
    v_pk_fma_f16 v56, v52, v48, v56 op_sel:[0,0,0] op_sel_hi:[0,1,1]
    ds_write_addtid_b32 v53 offset:2448
    ds_write_addtid_b32 v54 offset:2720
    v_pk_mul_f16 v57, v52, v49 op_sel:[1,1] op_sel_hi:[1,0] neg_lo:[1,0]
    v_pk_mul_f16 v58, v52, v50 op_sel:[1,1] op_sel_hi:[1,0] neg_lo:[1,0]
    v_pk_fma_f32 v[88:89], v[88:89], v[88:89], v[90:91] op_sel:[0,0,0] op_sel_hi:[0,1,1]
    v_pk_fma_f16 v57, v52, v49, v57 op_sel:[0,0,0] op_sel_hi:[0,1,1]
    v_pk_fma_f16 v58, v52, v50, v58 op_sel:[0,0,0] op_sel_hi:[0,1,1]
    ds_write_addtid_b32 v55 offset:2992
    ds_write_addtid_b32 v56 offset:3264
    v_pk_mul_f16 v59, v52, v51 op_sel:[1,1] op_sel_hi:[1,0] neg_lo:[1,0]
    v_pk_fma_f16 v59, v52, v51, v59 op_sel:[0,0,0] op_sel_hi:[0,1,1]
    ds_write_addtid_b32 v57 offset:3536
    ds_write_addtid_b32 v58 offset:3808
    v_pk_mul_f16 v80, v60, v45 op_sel:[1,1] op_sel_hi:[1,0] neg_lo:[1,0]
    v_pk_mul_f16 v81, v60, v46 op_sel:[1,1] op_sel_hi:[1,0] neg_lo:[1,0]
    v_pk_fma_f16 v80, v60, v45, v80 op_sel:[0,0,0] op_sel_hi:[0,1,1]
    v_pk_fma_f16 v81, v60, v46, v81 op_sel:[0,0,0] op_sel_hi:[0,1,1]
    ds_write_addtid_b32 v59 offset:4080
    ds_write_addtid_b32 v60 offset:4352
    v_cvt_pk_f16_f32 v64, v88, v89
    v_pk_mul_f16 v82, v60, v47 op_sel:[1,1] op_sel_hi:[1,0] neg_lo:[1,0]
    v_pk_mul_f16 v83, v60, v48 op_sel:[1,1] op_sel_hi:[1,0] neg_lo:[1,0]
    v_pk_fma_f16 v82, v60, v47, v82 op_sel:[0,0,0] op_sel_hi:[0,1,1]
    v_pk_fma_f16 v83, v60, v48, v83 op_sel:[0,0,0] op_sel_hi:[0,1,1]
    ds_write_addtid_b32 v80 offset:4624
    ds_write_addtid_b32 v81 offset:4896
    v_pk_mul_f16 v80, v60, v49 op_sel:[1,1] op_sel_hi:[1,0] neg_lo:[1,0]
    v_pk_mul_f16 v81, v60, v50 op_sel:[1,1] op_sel_hi:[1,0] neg_lo:[1,0]
    v_pk_fma_f16 v80, v60, v49, v80 op_sel:[0,0,0] op_sel_hi:[0,1,1]
    v_pk_fma_f16 v81, v60, v50, v81 op_sel:[0,0,0] op_sel_hi:[0,1,1]
    ds_write_addtid_b32 v82 offset:5168
    ds_write_addtid_b32 v83 offset:5440
    v_pk_mul_f16 v82, v60, v51 op_sel:[1,1] op_sel_hi:[1,0] neg_lo:[1,0]
    v_pk_mul_f16 v83, v60, v52 op_sel:[1,1] op_sel_hi:[1,0] neg_lo:[1,0]
    v_pk_mul_f32 v[90:91], v[88:89], v[88:89] op_sel:[1,1] op_sel_hi:[1,0] neg_lo:[1,0]
    v_pk_fma_f16 v82, v60, v51, v82 op_sel:[0,0,0] op_sel_hi:[0,1,1]
    v_pk_fma_f16 v83, v60, v52, v83 op_sel:[0,0,0] op_sel_hi:[0,1,1]
    ds_write_addtid_b32 v80 offset:5712
    ds_write_addtid_b32 v81 offset:5984
    v_pk_mul_f16 v80, v60, v53 op_sel:[1,1] op_sel_hi:[1,0] neg_lo:[1,0]
    v_pk_mul_f16 v81, v60, v54 op_sel:[1,1] op_sel_hi:[1,0] neg_lo:[1,0]
    v_pk_fma_f16 v80, v60, v53, v80 op_sel:[0,0,0] op_sel_hi:[0,1,1]
    v_pk_fma_f16 v81, v60, v54, v81 op_sel:[0,0,0] op_sel_hi:[0,1,1]
    ds_write_addtid_b32 v82 offset:6256
    ds_write_addtid_b32 v83 offset:6528
    v_pk_mul_f16 v82, v60, v55 op_sel:[1,1] op_sel_hi:[1,0] neg_lo:[1,0]
    v_pk_mul_f16 v83, v60, v56 op_sel:[1,1] op_sel_hi:[1,0] neg_lo:[1,0]
    v_pk_fma_f16 v82, v60, v55, v82 op_sel:[0,0,0] op_sel_hi:[0,1,1]
    v_pk_fma_f16 v83, v60, v56, v83 op_sel:[0,0,0] op_sel_hi:[0,1,1]
    v_pk_fma_f32 v[88:89], v[88:89], v[88:89], v[90:91] op_sel:[0,0,0] op_sel_hi:[0,1,1]
    ds_write_addtid_b32 v80 offset:6800
    ds_write_addtid_b32 v81 offset:7072
    v_pk_mul_f16 v80, v60, v57 op_sel:[1,1] op_sel_hi:[1,0] neg_lo:[1,0]
    v_pk_mul_f16 v81, v60, v58 op_sel:[1,1] op_sel_hi:[1,0] neg_lo:[1,0]
    v_pk_fma_f16 v80, v60, v57, v80 op_sel:[0,0,0] op_sel_hi:[0,1,1]
    v_pk_fma_f16 v81, v60, v58, v81 op_sel:[0,0,0] op_sel_hi:[0,1,1]
    ds_write_addtid_b32 v82 offset:7344
    ds_write_addtid_b32 v83 offset:7616
    v_pk_mul_f16 v82, v60, v59 op_sel:[1,1] op_sel_hi:[1,0] neg_lo:[1,0]
    v_pk_fma_f16 v82, v60, v59, v82 op_sel:[0,0,0] op_sel_hi:[0,1,1]
    ds_write_addtid_b32 v80 offset:7888
    ds_write_addtid_b32 v81 offset:8160
    ds_write_addtid_b32 v82 offset:8432
    v_cvt_pk_f16_f32 v65, v88, v89
    s_mov_b32 s46, 0
    ds_read_b32 v78, v31 offset:0
    s_waitcnt vmcnt(0)
    v_perm_b32 v92, v10, v10, s56
    v_perm_b32 v93, v11, v11, s56
    v_mul_f32 v34, 0x3ef5fdf0, v30
    s_branch L_spc_58
    s_nop 0
L_sp_56:
    ds_read_b32 v78, v31 offset:0
L_spc_58:
    s_waitcnt lgkmcnt(0)
    v_cmp_eq_u32 vcc, 0, v78
    s_cbranch_vccz L_spd_57
    s_add_u32 s46, s46, 1
    s_sleep 1
    s_cmp_lt_u32 s46, 400000
    s_cbranch_scc1 L_sp_56
    s_branch L_end
    s_nop 0
L_spd_57:
    v_mul_f32_e64 v34, v34, v78
    v_pk_mul_f32 v[92:93], v[92:93], v[34:35] op_sel_hi:[1,0] neg_hi:[1,0]
    v_cvt_pk_f16_f32 v67, v92, v93
    v_pk_mul_f16 v73, v67, v64 op_sel:[1,1] op_sel_hi:[1,0]
    v_pk_fma_f16 v73, v67, v64, v73 op_sel:[0,0,0] op_sel_hi:[0,1,1] neg_hi:[0,1,0]
    v_pk_mul_f16 v68, v67, v61 op_sel:[1,1] op_sel_hi:[1,0]
    v_pk_mul_f16 v69, v67, v62 op_sel:[1,1] op_sel_hi:[1,0]
    v_pk_fma_f16 v68, v67, v61, v68 op_sel:[0,0,0] op_sel_hi:[0,1,1] neg_hi:[0,1,0]
    v_pk_fma_f16 v69, v67, v62, v69 op_sel:[0,0,0] op_sel_hi:[0,1,1] neg_hi:[0,1,0]
    ds_write_addtid_b32 v67 offset:8704
    ds_write_addtid_b32 v73 offset:11696
    v_pk_mul_f16 v75, v73, v45 op_sel:[1,1] op_sel_hi:[1,0]
    v_pk_mul_f16 v70, v68, v62 op_sel:[1,1] op_sel_hi:[1,0]
    v_pk_fma_f16 v75, v73, v45, v75 op_sel:[0,0,0] op_sel_hi:[0,1,1] neg_hi:[0,1,0]
    v_pk_fma_f16 v70, v68, v62, v70 op_sel:[0,0,0] op_sel_hi:[0,1,1] neg_hi:[0,1,0]
    ds_write_addtid_b32 v68 offset:8976
    ds_write_addtid_b32 v69 offset:9248
    v_pk_mul_f16 v71, v69, v62 op_sel:[1,1] op_sel_hi:[1,0]
    v_pk_mul_f16 v76, v75, v64 op_sel:[1,1] op_sel_hi:[1,0]
    v_pk_fma_f16 v71, v69, v62, v71 op_sel:[0,0,0] op_sel_hi:[0,1,1] neg_hi:[0,1,0]
    v_pk_fma_f16 v76, v75, v64, v76 op_sel:[0,0,0] op_sel_hi:[0,1,1] neg_hi:[0,1,0]
    ds_write_addtid_b32 v75 offset:10064
    ds_write_addtid_b32 v70 offset:9520
    v_pk_mul_f16 v77, v75, v65 op_sel:[1,1] op_sel_hi:[1,0]
    v_pk_mul_f16 v63, v70, v62 op_sel:[1,1] op_sel_hi:[1,0]
    v_pk_fma_f16 v77, v75, v65, v77 op_sel:[0,0,0] op_sel_hi:[0,1,1] neg_hi:[0,1,0]
    v_pk_fma_f16 v63, v70, v62, v63 op_sel:[0,0,0] op_sel_hi:[0,1,1] neg_hi:[0,1,0]
    ds_write_addtid_b32 v71 offset:12240
    ds_write_addtid_b32 v76 offset:13600
    v_pk_mul_f16 v72, v71, v62 op_sel:[1,1] op_sel_hi:[1,0]
    v_pk_mul_f16 v74, v71, v64 op_sel:[1,1] op_sel_hi:[1,0]
    v_pk_fma_f16 v72, v71, v62, v72 op_sel:[0,0,0] op_sel_hi:[0,1,1] neg_hi:[0,1,0]
    v_pk_fma_f16 v74, v71, v64, v74 op_sel:[0,0,0] op_sel_hi:[0,1,1] neg_hi:[0,1,0]
    ds_write_addtid_b32 v77 offset:10608
    ds_write_addtid_b32 v63 offset:12512
    v_pk_mul_f16 v66, v76, v65 op_sel:[1,1] op_sel_hi:[1,0]
    v_pk_mul_f16 v79, v77, v65 op_sel:[1,1] op_sel_hi:[1,0]
    v_pk_fma_f16 v66, v76, v65, v66 op_sel:[0,0,0] op_sel_hi:[0,1,1] neg_hi:[0,1,0]
    v_pk_fma_f16 v79, v77, v65, v79 op_sel:[0,0,0] op_sel_hi:[0,1,1] neg_hi:[0,1,0]
    ds_write_addtid_b32 v72 offset:12784
    ds_write_addtid_b32 v74 offset:11424
    v_pk_mul_f16 v80, v63, v62 op_sel:[1,1] op_sel_hi:[1,0]
    v_pk_mul_f16 v81, v69, v64 op_sel:[1,1] op_sel_hi:[1,0]
    v_pk_fma_f16 v80, v63, v62, v80 op_sel:[0,0,0] op_sel_hi:[0,1,1] neg_hi:[0,1,0]
    v_pk_fma_f16 v81, v69, v64, v81 op_sel:[0,0,0] op_sel_hi:[0,1,1] neg_hi:[0,1,0]
    ds_write_addtid_b32 v66 offset:13872
    ds_write_addtid_b32 v79 offset:10880
    v_pk_mul_f16 v82, v72, v64 op_sel:[1,1] op_sel_hi:[1,0]
    v_pk_mul_f16 v83, v71, v65 op_sel:[1,1] op_sel_hi:[1,0]
    v_pk_fma_f16 v82, v72, v64, v82 op_sel:[0,0,0] op_sel_hi:[0,1,1] neg_hi:[0,1,0]
    v_pk_fma_f16 v83, v71, v65, v83 op_sel:[0,0,0] op_sel_hi:[0,1,1] neg_hi:[0,1,0]
    ds_write_addtid_b32 v80 offset:13056
    ds_write_addtid_b32 v81 offset:11968
    v_pk_mul_f16 v80, v74, v65 op_sel:[1,1] op_sel_hi:[1,0]
    v_pk_mul_f16 v81, v66, v65 op_sel:[1,1] op_sel_hi:[1,0]
    v_pk_fma_f16 v80, v74, v65, v80 op_sel:[0,0,0] op_sel_hi:[0,1,1] neg_hi:[0,1,0]
    v_pk_fma_f16 v81, v66, v65, v81 op_sel:[0,0,0] op_sel_hi:[0,1,1] neg_hi:[0,1,0]
    ds_write_addtid_b32 v82 offset:9792
    ds_write_addtid_b32 v83 offset:13328
    v_pk_mul_f16 v82, v79, v65 op_sel:[1,1] op_sel_hi:[1,0]
    v_pk_fma_f16 v82, v79, v65, v82 op_sel:[0,0,0] op_sel_hi:[0,1,1] neg_hi:[0,1,0]
    ds_write_addtid_b32 v80 offset:10336
    ds_write_addtid_b32 v81 offset:14144
    ds_write_addtid_b32 v82 offset:11152
    s_mov_b64 exec, 1
    ds_add_u32 v3, v0 offset:80
    s_mov_b64 exec, -1
    s_cmp_lg_u32 s59, 0
    s_cbranch_scc1 L_recv_59
    s_nop 0
    s_setprio 2
    ds_read_b128 v[88:91], v16 offset:8704
    ds_read_b128 v[92:95], v17 offset:0
    ds_read_b128 v[96:99], v16 offset:8736
    ds_read_b128 v[100:103], v17 offset:32
    ds_read_b128 v[104:107], v16 offset:8768
    ds_read_b128 v[108:111], v17 offset:64
    ds_read_b128 v[44:47], v16 offset:8800
    ds_read_b128 v[48:51], v17 offset:96
    s_waitcnt lgkmcnt(6)
    v_mfma_f32_32x32x16_f16 v[112:127], v[88:91], v[92:95], 0
    ds_read_b128 v[88:91], v16 offset:8832
    ds_read_b128 v[92:95], v17 offset:128
    s_waitcnt lgkmcnt(6)
    v_mfma_f32_32x32x16_f16 v[112:127], v[96:99], v[100:103], v[112:127]
    ds_read_b128 v[96:99], v16 offset:8864
    ds_read_b128 v[100:103], v17 offset:160
    s_waitcnt lgkmcnt(6)
    v_mfma_f32_32x32x16_f16 v[112:127], v[104:107], v[108:111], v[112:127]
    ds_read_b128 v[104:107], v16 offset:8896
    ds_read_b128 v[108:111], v17 offset:192
    s_waitcnt lgkmcnt(6)
    v_mfma_f32_32x32x16_f16 v[112:127], v[44:47], v[48:51], v[112:127]
    ds_read_b128 v[44:47], v16 offset:8928
    ds_read_b128 v[48:51], v17 offset:224
    s_waitcnt lgkmcnt(6)
    v_mfma_f32_32x32x16_f16 v[112:127], v[88:91], v[92:95], v[112:127]
    s_waitcnt lgkmcnt(4)
    v_mfma_f32_32x32x16_f16 v[112:127], v[96:99], v[100:103], v[112:127]
    s_waitcnt lgkmcnt(2)
    v_mfma_f32_32x32x16_f16 v[112:127], v[104:107], v[108:111], v[112:127]
    s_waitcnt lgkmcnt(0)
    v_mfma_f32_32x32x16_f16 v[112:127], v[44:47], v[48:51], v[112:127]
    s_mov_b32 s46, 0
L_sp_61:
    ds_read_b32 v85, v24 offset:96
    s_waitcnt lgkmcnt(0)
    v_cmp_gt_u32 vcc, 1, v85
    s_cbranch_vccz L_spd_62
    s_add_u32 s46, s46, 1
    s_cmp_lt_u32 s46, 400000
    s_cbranch_scc1 L_sp_61
    s_branch L_end
L_spd_62:
    s_setprio 3
    ds_read_b128 v[88:91], v36 offset:8704
    ds_read_b128 v[92:95], v37 offset:0
    ds_read_b128 v[96:99], v36 offset:8736
    ds_read_b128 v[100:103], v37 offset:32
    ds_read_b128 v[104:107], v36 offset:8768
    ds_read_b128 v[108:111], v37 offset:64
    ds_read_b128 v[44:47], v36 offset:8800
    ds_read_b128 v[48:51], v37 offset:96
    s_waitcnt lgkmcnt(6)
    v_mfma_f32_32x32x16_f16 v[112:127], v[88:91], v[92:95], v[112:127]
    ds_read_b128 v[88:91], v36 offset:8832
    ds_read_b128 v[92:95], v37 offset:128
    s_waitcnt lgkmcnt(6)
    v_mfma_f32_32x32x16_f16 v[112:127], v[96:99], v[100:103], v[112:127]
    ds_read_b128 v[96:99], v36 offset:8864
    ds_read_b128 v[100:103], v37 offset:160
    s_waitcnt lgkmcnt(6)
    v_mfma_f32_32x32x16_f16 v[112:127], v[104:107], v[108:111], v[112:127]
    ds_read_b128 v[104:107], v36 offset:8896
    ds_read_b128 v[108:111], v37 offset:192
    s_waitcnt lgkmcnt(6)
    v_mfma_f32_32x32x16_f16 v[112:127], v[44:47], v[48:51], v[112:127]
    ds_read_b128 v[44:47], v36 offset:8928
    ds_read_b128 v[48:51], v37 offset:224
    s_waitcnt lgkmcnt(6)
    v_mfma_f32_32x32x16_f16 v[112:127], v[88:91], v[92:95], v[112:127]
    s_waitcnt lgkmcnt(4)
    v_mfma_f32_32x32x16_f16 v[112:127], v[96:99], v[100:103], v[112:127]
    s_waitcnt lgkmcnt(2)
    v_mfma_f32_32x32x16_f16 v[112:127], v[104:107], v[108:111], v[112:127]
    s_waitcnt lgkmcnt(0)
    v_mfma_f32_32x32x16_f16 v[112:127], v[44:47], v[48:51], v[112:127]
    s_mov_b64 exec, 1
    ds_add_u32 v3, v0 offset:84
    s_mov_b64 exec, -1
    s_mov_b64 exec, 1
    ds_write_b32 v24, v0 offset:112
    s_mov_b64 exec, -1
    s_nop 5
    v_cvt_pkrtz_f16_f32 v109, v122, v123
    v_add_f32 v112, v112, v26
    v_cvt_pkrtz_f16_f32 v88, v119, v118
    v_cvt_pkrtz_f16_f32 v89, v117, v116
    v_mov_b32_dpp v85, v109 quad_perm:[1,0,3,2] row_mask:0xf bank_mask:0xf
    v_cvt_pkrtz_f16_f32 v90, v115, v114
    v_cvt_pkrtz_f16_f32 v91, v113, v112
    v_cvt_pkrtz_f16_f32 v108, v121, v120
    v_bfi_b32 v88, s61, v40, v88
    v_bfi_b32 v89, s61, v41, v89
    v_bfi_b32 v90, s61, v42, v90
    v_bfi_b32 v91, s61, v43, v91
    v_perm_b32 v109, v85, v109, v5
    global_store_dwordx4 v2, v[88:91], s[62:63] sc1
    v_bfi_b32 v108, s61, v40, v108
    v_bfi_b32 v109, s61, v41, v109
    global_store_dwordx2 v27, v[108:109], s[62:63] offset:1024 sc1
    v_mov_b32 v79, s39
    s_mov_b64 exec, 1
    global_store_dwordx2 v3, v[78:79], s[62:63] offset:2040 sc1
    s_mov_b64 exec, -1
    ds_read_b128 v[44:47], v2 offset:4864
    ds_read_b128 v[48:51], v2 offset:5888
    ds_read_b128 v[52:55], v2 offset:6912
    ds_read_b128 v[56:59], v2 offset:7936
    s_branch L_arr_60
L_recv_59:
    s_mov_b64 exec, 1
    ds_write_b32 v24, v0 offset:96
    s_mov_b64 exec, -1
    ds_read_b128 v[44:47], v2 offset:4864
    ds_read_b128 v[48:51], v2 offset:5888
    ds_read_b128 v[52:55], v2 offset:6912
    ds_read_b128 v[56:59], v2 offset:7936
    v_xor_b32_e64 v31, 16, v31
    s_load_dword s42, s[62:63], 2040 glc
    s_mov_b32 s46, 0
L_sp_63:
    ds_read_b32 v85, v24 offset:112
    s_waitcnt lgkmcnt(0)
    v_cmp_gt_u32 vcc, 1, v85
    s_cbranch_vccz L_spd_64
    s_add_u32 s46, s46, 1
    s_sleep 2
    s_cmp_lt_u32 s46, 400000
    s_cbranch_scc1 L_sp_63
    s_branch L_end
    s_nop 0
L_spd_64:
    s_mov_b32 s46, 0
L_km_65:
    s_load_dwordx2 s[42:43], s[62:63], 2040 glc
    s_add_u32 s46, s46, 1
    s_cmp_gt_u32 s46, 50000
    s_cbranch_scc1 L_end
    s_waitcnt lgkmcnt(0)
    s_cmp_lg_u32 s43, s39
    s_cbranch_scc1 L_km_65
    s_mov_b32 s46, 0
L_ka_66:
    global_load_dwordx4 v[88:91], v2, s[62:63] sc1
    global_load_dwordx2 v[108:109], v27, s[62:63] offset:1024 sc1
    v_mov_b32 v110, s42
    s_mov_b64 exec, 1
    ds_write_b32 v31, v110 offset:0
    s_mov_b64 exec, -1
    s_add_u32 s46, s46, 1
    s_cmp_gt_u32 s46, 50000
    s_cbranch_scc1 L_end
    s_waitcnt vmcnt(1)
    v_xor_b32_e64 v85, v88, v40
    v_bitop3_b32 v85, v85, v89, v41 bitop3:0xf6
    v_bitop3_b32 v85, v85, v90, v42 bitop3:0xf6
    v_bitop3_b32 v85, v85, v91, v43 bitop3:0xf6
    s_nop 0
    s_waitcnt vmcnt(0)
    v_bitop3_b32 v85, v85, v108, v40 bitop3:0xf6
    v_bitop3_b32 v85, v85, v109, v41 bitop3:0xf6
    v_and_b32 v85, 0x00010001, v85
    v_cmp_ne_u32 vcc, 0, v85
    s_cbranch_vccnz L_ka_66
L_arr_60:
    ds_write_b128 v25, v[88:91]
    v_alignbit_b32 v92, v89, v88, 16
    v_readlane_b32 s40, v88, 63
    v_readlane_b32 s53, v108, 63
    v_readlane_b32 s41, v92, 63
    v_mov_b32_dpp v99, v88 wave_shr:1 row_mask:0xf bank_mask:0xf bound_ctrl:0
    s_pack_ll_b32_b16 s42, s40, s40
    v_alignbit_b32 v93, v90, v89, 16
    v_alignbit_b32 v94, v91, v90, 16
    v_alignbit_b32 v95, v99, v91, 16
    v_mov_b32 v104, 0
    ds_write_b128 v25, v[92:95] offset:1088
    v_and_b32 v105, s42, v21
    v_and_b32 v106, s42, v22
    v_and_b32_e64 v107, s42, v23
    v_writelane_b32 v107, s40, 11
    v_writelane_b32 v107, s41, 15
    ds_write_b128 v20, v[104:107]
    v_mov_b32_dpp v111, v89 wave_shr:1 row_mask:0xf bank_mask:0xf bound_ctrl:0
    ds_write2_b32 v18, v108, v108 offset0:0 offset1:225
    s_pack_ll_b32_b16 s53, s53, s53
    ds_write2_b32 v19, v109, v109 offset0:0 offset1:225
    v_mov_b32 v96, v89
    v_mov_b32 v97, v90
    v_mov_b32 v98, v91
    ds_write_b128 v25, v[96:99] offset:2176
    v_mov_b32 v100, v93
    v_mov_b32 v101, v94
    v_mov_b32_e64 v102, v95
    v_alignbit_b32 v103, v111, v99, 16
    ds_write_b128 v25, v[100:103] offset:3264
    v_pk_mul_f16 v12, v12, s53
    v_pk_mul_f16 v13, v13, s53
    v_pk_mul_f16 v14, v14, s53
    v_pk_mul_f16 v15, v15, s53
    v_mov_b32_e64 v5, v24
    s_cmp_lg_u32 s38, 0
    s_cbranch_scc1 L_set1_67
    ds_read_b64 v[32:33], v7 offset:512
    ds_read_b64 v[34:35], v7 offset:520
    ds_read_b64 v[36:37], v7 offset:448
    ds_read_b64 v[38:39], v7 offset:456
    ds_read_b64 v[40:41], v6 offset:576
    ds_read_b64 v[42:43], v6 offset:584
    ds_read_b64 v[60:61], v6 offset:64
    ds_read_b64 v[62:63], v6 offset:72
    ds_read_b64 v[64:65], v7 offset:576
    ds_read_b64 v[66:67], v7 offset:584
    ds_read_b64 v[68:69], v6 offset:640
    ds_read_b64 v[70:71], v6 offset:648
    ds_read_b64 v[72:73], v6 offset:128
    ds_read_b64 v[74:75], v6 offset:136
    ds_read_b64 v[76:77], v6 offset:704
    ds_read_b64 v[78:79], v6 offset:712
    ds_read_b64 v[80:81], v6 offset:192
    ds_read_b64 v[82:83], v6 offset:200
    s_mov_b32 s46, 0
L_sp_68:
    ds_read_b32 v5, v3 offset:48
    s_waitcnt lgkmcnt(0)
    v_cmp_gt_u32 vcc, 2, v5
    s_cbranch_vccz L_spd_69
    s_add_u32 s46, s46, 1
    s_sleep 2
    s_cmp_lt_u32 s46, 400000
    s_cbranch_scc1 L_sp_68
    s_branch L_end
    s_nop 0
L_spd_69:
    s_setprio 2
    ds_read_b128 v[84:87], v4 offset:496
    ds_read_b128 v[8:11], v4 offset:480
    ds_read_b128 v[16:19], v4 offset:1536
    ds_read_b128 v[20:23], v4 offset:1008
    ds_read_b128 v[24:27], v4 offset:992
    s_waitcnt lgkmcnt(4)
    v_mfma_f32_16x16x32_f16 v[28:31], v[84:87], v[52:55], 0
    ds_read_b128 v[88:91], v4 offset:48
    s_waitcnt lgkmcnt(4)
    v_mfma_f32_16x16x32_f16 v[96:99], v[8:11], v[56:59], 0
    ds_read_b64 v[92:93], v6 offset:768
    s_waitcnt lgkmcnt(4)
    v_mfma_f32_16x16x32_f16 v[104:107], v[12:15], v[16:19], 0
    ds_read_b64 v[94:95], v6 offset:776
    s_waitcnt lgkmcnt(4)
    v_mfma_f32_16x16x32_f16 v[112:115], v[20:23], v[52:55], 0
    ds_read_b64 v[100:101], v6 offset:256
    s_nop 0
    v_cvt_pkrtz_f16_f32 v28, v28, v96
    v_cvt_pkrtz_f16_f32 v29, v29, v97
    s_waitcnt lgkmcnt(4)
    v_mfma_f32_16x16x32_f16 v[120:123], v[24:27], v[56:59], 0
    ds_read_b64 v[102:103], v6 offset:264
    v_cvt_pkrtz_f16_f32 v30, v30, v98
    v_cvt_pkrtz_f16_f32 v31, v31, v99
    s_nop 1
    v_mfma_f32_16x16x32_f16 v[104:107], v[28:31], v[32:35], v[104:107]
    ds_read_b128 v[124:127], v4 offset:112
    v_mfma_f32_16x16x32_f16 v[16:19], v[28:31], v[36:39], 0
    ds_read_b128 v[20:23], v4 offset:176
    s_waitcnt lgkmcnt(6)
    v_mfma_f32_16x16x32_f16 v[96:99], v[40:43], v[88:91], 0
    ds_read_b64 v[108:109], v6 offset:832
    v_cvt_pkrtz_f16_f32 v112, v112, v120
    v_cvt_pkrtz_f16_f32 v113, v113, v121
    v_mfma_f32_16x16x32_f16 v[28:31], v[60:63], v[88:91], 0
    ds_read_b64 v[110:111], v6 offset:840
    ds_read_b64 v[116:117], v6 offset:320
    v_cvt_pkrtz_f16_f32 v114, v114, v122
    v_cvt_pkrtz_f16_f32 v115, v115, v123
    s_nop 0
    s_nop 1
    v_mfma_f32_16x16x32_f16 v[104:107], v[112:115], v[64:67], v[104:107]
    ds_read_b128 v[60:63], v4 offset:240
    ds_read_b64 v[118:119], v6 offset:328
    ds_read_b64 v[84:85], v6 offset:896
    ds_read_b64 v[86:87], v6 offset:904
    v_mfma_f32_16x16x32_f16 v[16:19], v[112:115], v[32:35], v[16:19]
    ds_read_b128 v[32:35], v4 offset:304
    ds_read_b64 v[8:9], v6 offset:384
    s_waitcnt lgkmcnt(10)
    v_mfma_f32_16x16x32_f16 v[96:99], v[68:71], v[124:127], v[96:99]
    ds_read_b64 v[10:11], v6 offset:392
    v_mfma_f32_16x16x32_f16 v[28:31], v[72:75], v[124:127], v[28:31]
    ds_read_b128 v[112:115], v4 offset:368
    ds_read_b64 v[24:25], v6 offset:960
    s_waitcnt lgkmcnt(12)
    v_mfma_f32_16x16x32_f16 v[96:99], v[76:79], v[20:23], v[96:99]
    ds_read_b64 v[26:27], v6 offset:968
    v_mfma_f32_16x16x32_f16 v[28:31], v[80:83], v[20:23], v[28:31]
    ds_read_b128 v[72:75], v4 offset:432
    ds_read_b64 v[36:37], v6 offset:448
    s_nop 0
    s_waitcnt lgkmcnt(11)
    v_mfma_f32_16x16x32_f16 v[96:99], v[92:95], v[60:63], v[96:99]
    ds_read_b64 v[38:39], v6 offset:456
    v_mfma_f32_16x16x32_f16 v[28:31], v[100:103], v[60:63], v[28:31]
    ds_read_b64 v[88:89], v6 offset:1024
    ds_read_b64 v[90:91], v6 offset:1032
    s_waitcnt lgkmcnt(10)
    v_mfma_f32_16x16x32_f16 v[96:99], v[108:111], v[32:35], v[96:99]
    ds_read_b128 v[124:127], v4 offset:496
    v_mfma_f32_16x16x32_f16 v[28:31], v[116:119], v[32:35], v[28:31]
    ds_read_b64 v[120:121], v6 offset:512
    s_waitcnt lgkmcnt(9)
    v_mfma_f32_16x16x32_f16 v[96:99], v[84:87], v[112:115], v[96:99]
    ds_read_b64 v[122:123], v6 offset:520
    v_mfma_f32_16x16x32_f16 v[28:31], v[8:11], v[112:115], v[28:31]
    ds_read_b128 v[80:83], v4 offset:560
    s_waitcnt lgkmcnt(9)
    s_waitcnt lgkmcnt(8)
    v_mfma_f32_16x16x32_f16 v[96:99], v[24:27], v[72:75], v[96:99]
    ds_read_b128 v[20:23], v4 offset:624
    s_waitcnt lgkmcnt(7)
    v_mfma_f32_16x16x32_f16 v[28:31], v[36:39], v[72:75], v[28:31]
    ds_read_b128 v[100:103], v4 offset:688
    s_waitcnt lgkmcnt(6)
    s_waitcnt lgkmcnt(5)
    v_mfma_f32_16x16x32_f16 v[96:99], v[88:91], v[124:127], v[96:99]
    ds_read_b128 v[60:63], v4 offset:752
    s_waitcnt lgkmcnt(4)
    v_mfma_f32_16x16x32_f16 v[28:31], v[120:123], v[124:127], v[28:31]
    ds_read_b128 v[116:119], v4 offset:1520
    s_waitcnt lgkmcnt(4)
    v_mfma_f32_16x16x32_f16 v[28:31], v[40:43], v[80:83], v[28:31]
    ds_read_b128 v[32:35], v4 offset:1504
    s_waitcnt lgkmcnt(4)
    v_mfma_f32_16x16x32_f16 v[28:31], v[68:71], v[20:23], v[28:31]
    v_cvt_pk_f16_f32 v96, v96, v97
    v_cvt_pk_f16_f32 v97, v98, v99
    ds_write_b64 v1, v[96:97] offset:0
    s_mov_b64 exec, 1
    ds_add_u32 v3, v0 offset:64
    s_mov_b64 exec, -1
    s_setprio 1
    s_waitcnt lgkmcnt(5)
    v_mfma_f32_16x16x32_f16 v[28:31], v[76:79], v[100:103], v[28:31]
    s_waitcnt lgkmcnt(4)
    v_mfma_f32_16x16x32_f16 v[28:31], v[92:95], v[60:63], v[28:31]
    ds_read_b128 v[8:11], v4 offset:816
    s_waitcnt lgkmcnt(4)
    v_mfma_f32_16x16x32_f16 v[112:115], v[116:119], v[44:47], 0
    ds_read_b128 v[36:39], v4 offset:880
    v_mfma_f32_16x16x32_f16 v[72:75], v[116:119], v[48:51], 0
    ds_read_b128 v[120:123], v4 offset:944
    v_mfma_f32_16x16x32_f16 v[80:83], v[116:119], v[52:55], 0
    ds_read_b128 v[20:23], v4 offset:1008
    s_waitcnt lgkmcnt(6)
    v_mfma_f32_16x16x32_f16 v[96:99], v[32:35], v[56:59], 0
    ds_read_b128 v[100:103], v4 offset:2032
    v_mfma_f32_16x16x32_f16 v[60:63], v[32:35], v[44:47], 0
    ds_read_b64 v[124:125], v7 offset:0
    v_mfma_f32_16x16x32_f16 v[116:119], v[32:35], v[48:51], 0
    ds_read_b64 v[126:127], v7 offset:8
    s_waitcnt lgkmcnt(6)
    v_mfma_f32_16x16x32_f16 v[28:31], v[108:111], v[8:11], v[28:31]
    ds_read_b128 v[8:11], v4 offset:2016
    s_waitcnt lgkmcnt(6)
    v_mfma_f32_16x16x32_f16 v[28:31], v[84:87], v[36:39], v[28:31]
    ds_read_b64 v[32:33], v7 offset:640
    s_waitcnt lgkmcnt(6)
    v_mfma_f32_16x16x32_f16 v[28:31], v[24:27], v[120:123], v[28:31]
    ds_read_b64 v[34:35], v7 offset:648
    s_waitcnt lgkmcnt(6)
    v_mfma_f32_16x16x32_f16 v[28:31], v[88:91], v[20:23], v[28:31]
    ds_read_b64 v[36:37], v7 offset:192
    s_waitcnt lgkmcnt(6)
    v_mfma_f32_16x16x32_f16 v[120:123], v[100:103], v[44:47], 0
    ds_read_b64 v[38:39], v7 offset:200
    v_cvt_pkrtz_f16_f32 v112, v112, v72
    v_cvt_pkrtz_f16_f32 v113, v113, v73
    v_mfma_f32_16x16x32_f16 v[20:23], v[100:103], v[48:51], 0
    v_cvt_pkrtz_f16_f32 v114, v114, v74
    v_cvt_pkrtz_f16_f32 v115, v115, v75
    v_mfma_f32_16x16x32_f16 v[72:75], v[100:103], v[52:55], 0
    ds_read_b64 v[52:53], v7 offset:64
    v_cvt_pk_f16_f32 v28, v28, v29
    v_cvt_pk_f16_f32 v29, v30, v31
    ds_write_b64 v1, v[28:29] offset:512
    s_mov_b64 exec, 1
    ds_add_u32 v3, v0 offset:68
    s_mov_b64 exec, -1
    s_setprio 0
    v_cvt_pkrtz_f16_f32 v80, v80, v96
    v_cvt_pkrtz_f16_f32 v81, v81, v97
    s_waitcnt lgkmcnt(7)
    v_mfma_f32_16x16x32_f16 v[28:31], v[8:11], v[56:59], 0
    ds_read_b32 v5, v3 offset:56
    ds_read_b64 v[54:55], v7 offset:72
    v_cvt_pkrtz_f16_f32 v82, v82, v98
    v_cvt_pkrtz_f16_f32 v83, v83, v99
    v_mfma_f32_16x16x32_f16 v[56:59], v[8:11], v[44:47], 0
    ds_read_b64 v[100:101], v7 offset:256
    v_cvt_pkrtz_f16_f32 v60, v60, v116
    v_cvt_pkrtz_f16_f32 v61, v61, v117
    v_mfma_f32_16x16x32_f16 v[96:99], v[8:11], v[48:51], 0
    ds_read_b64 v[102:103], v7 offset:264
    v_cvt_pkrtz_f16_f32 v62, v62, v118
    v_cvt_pkrtz_f16_f32 v63, v63, v119
    v_mfma_f32_16x16x32_f16 v[104:107], v[112:115], v[124:127], v[104:107]
    ds_read_b64 v[8:9], v6 offset:0
    s_waitcnt lgkmcnt(10)
    v_mfma_f32_16x16x32_f16 v[104:107], v[80:83], v[32:35], v[104:107]
    ds_read_b64 v[10:11], v6 offset:8
    v_mfma_f32_16x16x32_f16 v[16:19], v[80:83], v[64:67], v[16:19]
    s_waitcnt lgkmcnt(5)
    v_cmp_gt_u32 vcc, 2, v5
    s_cbranch_vccz L_x2_70
    s_mov_b32 s46, 0
L_sp_71:
    ds_read_b32 v5, v3 offset:56
    s_waitcnt lgkmcnt(0)
    v_cmp_gt_u32 vcc, 2, v5
    s_cbranch_vccz L_spd_72
    s_add_u32 s46, s46, 1
    s_sleep 1
    s_cmp_lt_u32 s46, 400000
    s_cbranch_scc1 L_sp_71
    s_branch L_end
L_spd_72:
L_x2_70:
    ds_read_b128 v[64:67], v4 offset:2048
    v_mfma_f32_16x16x32_f16 v[104:107], v[60:63], v[36:39], v[104:107]
    ds_read_b64 v[116:117], v6 offset:64
    v_cvt_pkrtz_f16_f32 v120, v120, v20
    v_cvt_pkrtz_f16_f32 v121, v121, v21
    v_cvt_pkrtz_f16_f32 v122, v122, v22
    v_cvt_pkrtz_f16_f32 v123, v123, v23
    v_cvt_pkrtz_f16_f32 v72, v72, v28
    v_cvt_pkrtz_f16_f32 v73, v73, v29
    v_cvt_pkrtz_f16_f32 v74, v74, v30
    v_cvt_pkrtz_f16_f32 v75, v75, v31
    v_cvt_pkrtz_f16_f32 v56, v56, v96
    v_cvt_pkrtz_f16_f32 v57, v57, v97
    v_cvt_pkrtz_f16_f32 v58, v58, v98
    v_cvt_pkrtz_f16_f32 v59, v59, v99
    s_waitcnt lgkmcnt(6)
    s_nop 0
    v_mfma_f32_16x16x32_f16 v[104:107], v[120:123], v[52:55], v[104:107]
    ds_read_b128 v[60:63], v4 offset:2544
    v_mfma_f32_16x16x32_f16 v[16:19], v[120:123], v[124:127], v[16:19]
    ds_read_b64 v[118:119], v6 offset:72
    ds_read_b128 v[28:31], v4 offset:2608
    v_mfma_f32_16x16x32_f16 v[16:19], v[72:75], v[32:35], v[16:19]
    ds_read_b128 v[124:127], v4 offset:2544
    s_waitcnt lgkmcnt(8)
    s_nop 0
    v_mfma_f32_16x16x32_f16 v[104:107], v[56:59], v[100:103], v[104:107]
    ds_read_b128 v[120:123], v4 offset:2528
    ds_read_b64 v[112:113], v6 offset:128
    v_mfma_f32_16x16x32_f16 v[16:19], v[56:59], v[36:39], v[16:19]
    ds_read_b64 v[114:115], v6 offset:136
    s_waitcnt lgkmcnt(8)
    v_mfma_f32_16x16x32_f16 v[16:19], v[12:15], v[64:67], v[16:19]
    ds_read_b128 v[32:35], v4 offset:2672
    ds_read_b64 v[80:81], v6 offset:192
    s_waitcnt lgkmcnt(8)
    v_mfma_f32_16x16x32_f16 v[104:107], v[8:11], v[60:63], v[104:107]
    ds_read_b64 v[82:83], v6 offset:200
    ds_read_b128 v[72:75], v4 offset:2736
    s_waitcnt lgkmcnt(9)
    s_waitcnt lgkmcnt(8)
    v_mfma_f32_16x16x32_f16 v[104:107], v[116:119], v[28:31], v[104:107]
    ds_read_b64 v[20:21], v6 offset:256
    ds_read_b64 v[22:23], v6 offset:264
    s_nop 0
    s_waitcnt lgkmcnt(9)
    v_mfma_f32_16x16x32_f16 v[56:59], v[124:127], v[44:47], 0
    ds_read_b128 v[36:39], v4 offset:2800
    ds_read_b64 v[96:97], v6 offset:320
    v_mfma_f32_16x16x32_f16 v[64:67], v[124:127], v[48:51], 0
    ds_read_b64 v[98:99], v6 offset:328
    s_nop 0
    s_waitcnt lgkmcnt(11)
    v_mfma_f32_16x16x32_f16 v[28:31], v[120:123], v[44:47], 0
    ds_read_b128 v[12:15], v4 offset:2864
    v_mfma_f32_16x16x32_f16 v[124:127], v[120:123], v[48:51], 0
    ds_read_b128 v[60:63], v4 offset:2928
    ds_read_b64 v[120:121], v6 offset:384
    ds_read_b64 v[122:123], v6 offset:392
    s_waitcnt lgkmcnt(13)
    s_waitcnt lgkmcnt(12)
    v_mfma_f32_16x16x32_f16 v[104:107], v[112:115], v[32:35], v[104:107]
    ds_read_b128 v[32:35], v4 offset:2992
    s_waitcnt lgkmcnt(11)
    s_waitcnt lgkmcnt(10)
    v_mfma_f32_16x16x32_f16 v[104:107], v[80:83], v[72:75], v[104:107]
    ds_read_b64 v[72:73], v6 offset:448
    ds_read_b64 v[74:75], v6 offset:456
    s_waitcnt lgkmcnt(10)
    s_waitcnt lgkmcnt(9)
    v_mfma_f32_16x16x32_f16 v[104:107], v[20:23], v[36:39], v[104:107]
    ds_read_b64 v[36:37], v7 offset:128
    ds_read_b64 v[38:39], v7 offset:136
    v_cvt_pkrtz_f16_f32 v56, v56, v64
    v_cvt_pkrtz_f16_f32 v57, v57, v65
    s_waitcnt lgkmcnt(9)
    s_waitcnt lgkmcnt(8)
    v_mfma_f32_16x16x32_f16 v[104:107], v[96:99], v[12:15], v[104:107]
    ds_read_b64 v[12:13], v7 offset:320
    ds_read_b64 v[14:15], v7 offset:328
    v_cvt_pkrtz_f16_f32 v58, v58, v66
    v_cvt_pkrtz_f16_f32 v59, v59, v67
    s_nop 0
    s_waitcnt lgkmcnt(7)
    v_mfma_f32_16x16x32_f16 v[104:107], v[120:123], v[60:63], v[104:107]
    ds_read_b128 v[64:67], v4 offset:3056
    ds_read_b64 v[60:61], v6 offset:512
    v_cvt_pkrtz_f16_f32 v28, v28, v124
    v_cvt_pkrtz_f16_f32 v29, v29, v125
    s_waitcnt lgkmcnt(6)
    v_mfma_f32_16x16x32_f16 v[104:107], v[72:75], v[32:35], v[104:107]
    ds_read_b64 v[62:63], v6 offset:520
    v_cvt_pkrtz_f16_f32 v30, v30, v126
    v_cvt_pkrtz_f16_f32 v31, v31, v127
    s_waitcnt lgkmcnt(5)
    v_mfma_f32_16x16x32_f16 v[104:107], v[56:59], v[36:39], v[104:107]
    ds_read_b128 v[32:35], v4 offset:3120
    v_mfma_f32_16x16x32_f16 v[16:19], v[56:59], v[52:55], v[16:19]
    ds_read_b128 v[124:127], v4 offset:3184
    s_waitcnt lgkmcnt(5)
    v_mfma_f32_16x16x32_f16 v[104:107], v[28:31], v[12:15], v[104:107]
    v_mfma_f32_16x16x32_f16 v[16:19], v[28:31], v[100:103], v[16:19]
    ds_read_b128 v[52:55], v4 offset:3248
    s_waitcnt lgkmcnt(3)
    v_mfma_f32_16x16x32_f16 v[104:107], v[60:63], v[64:67], v[104:107]
    v_mfma_f32_16x16x32_f16 v[16:19], v[8:11], v[64:67], v[16:19]
    ds_read_b128 v[56:59], v4 offset:3312
    s_waitcnt lgkmcnt(3)
    v_mfma_f32_16x16x32_f16 v[104:107], v[40:43], v[32:35], v[104:107]
    v_mfma_f32_16x16x32_f16 v[16:19], v[116:119], v[32:35], v[16:19]
    ds_read_b128 v[100:103], v4 offset:3376
    s_waitcnt lgkmcnt(3)
    v_mfma_f32_16x16x32_f16 v[104:107], v[68:71], v[124:127], v[104:107]
    v_mfma_f32_16x16x32_f16 v[16:19], v[112:115], v[124:127], v[16:19]
    ds_read_b128 v[28:31], v4 offset:3440
    s_waitcnt lgkmcnt(3)
    v_mfma_f32_16x16x32_f16 v[104:107], v[76:79], v[52:55], v[104:107]
    v_mfma_f32_16x16x32_f16 v[16:19], v[80:83], v[52:55], v[16:19]
    ds_read_b128 v[8:11], v4 offset:3504
    s_waitcnt lgkmcnt(3)
    v_mfma_f32_16x16x32_f16 v[104:107], v[92:95], v[56:59], v[104:107]
    v_mfma_f32_16x16x32_f16 v[16:19], v[20:23], v[56:59], v[16:19]
    ds_read_b128 v[64:67], v4 offset:3568
    s_waitcnt lgkmcnt(3)
    v_mfma_f32_16x16x32_f16 v[104:107], v[108:111], v[100:103], v[104:107]
    v_mfma_f32_16x16x32_f16 v[16:19], v[96:99], v[100:103], v[16:19]
    ds_read_b128 v[116:119], v4 offset:3632
    s_waitcnt lgkmcnt(3)
    v_mfma_f32_16x16x32_f16 v[104:107], v[84:87], v[28:31], v[104:107]
    ds_read_b128 v[32:35], v4 offset:3696
    v_mfma_f32_16x16x32_f16 v[16:19], v[120:123], v[28:31], v[16:19]
    ds_read_b128 v[112:115], v4 offset:3056
    s_waitcnt lgkmcnt(4)
    v_mfma_f32_16x16x32_f16 v[104:107], v[24:27], v[8:11], v[104:107]
    v_mfma_f32_16x16x32_f16 v[16:19], v[72:75], v[8:11], v[16:19]
    ds_read_b128 v[124:127], v4 offset:3040
    s_waitcnt lgkmcnt(4)
    v_mfma_f32_16x16x32_f16 v[104:107], v[88:91], v[64:67], v[104:107]
    v_mfma_f32_16x16x32_f16 v[16:19], v[60:63], v[64:67], v[16:19]
    ds_read_b128 v[80:83], v4 offset:3760
    s_waitcnt lgkmcnt(4)
    v_mfma_f32_16x16x32_f16 v[16:19], v[40:43], v[116:119], v[16:19]
    ds_read_b128 v[52:55], v4 offset:3824
    s_waitcnt lgkmcnt(4)
    v_mfma_f32_16x16x32_f16 v[16:19], v[68:71], v[32:35], v[16:19]
    s_nop 0
    s_nop 0
    v_cvt_pk_f16_f32 v104, v104, v105
    v_cvt_pk_f16_f32 v105, v106, v107
    ds_write_b64 v1, v[104:105] offset:1024
    s_mov_b64 exec, 1
    ds_add_u32 v3, v0 offset:72
    s_mov_b64 exec, -1
    s_setprio 0
    s_waitcnt lgkmcnt(5)
    v_mfma_f32_16x16x32_f16 v[56:59], v[112:115], v[44:47], 0
    ds_read_b128 v[20:23], v4 offset:3888
    v_mfma_f32_16x16x32_f16 v[100:103], v[112:115], v[48:51], 0
    ds_read_b128 v[96:99], v4 offset:3952
    s_nop 0
    s_waitcnt lgkmcnt(6)
    v_mfma_f32_16x16x32_f16 v[28:31], v[124:127], v[44:47], 0
    ds_read_b128 v[120:123], v4 offset:4016
    v_mfma_f32_16x16x32_f16 v[8:11], v[124:127], v[48:51], 0
    ds_read_b128 v[72:75], v4 offset:4080
    s_waitcnt lgkmcnt(7)
    v_mfma_f32_16x16x32_f16 v[16:19], v[76:79], v[80:83], v[16:19]
    s_waitcnt lgkmcnt(6)
    v_mfma_f32_16x16x32_f16 v[16:19], v[92:95], v[52:55], v[16:19]
    s_waitcnt lgkmcnt(3)
    v_mfma_f32_16x16x32_f16 v[16:19], v[108:111], v[20:23], v[16:19]
    v_cvt_pkrtz_f16_f32 v56, v56, v100
    v_cvt_pkrtz_f16_f32 v57, v57, v101
    s_waitcnt lgkmcnt(2)
    v_mfma_f32_16x16x32_f16 v[16:19], v[84:87], v[96:99], v[16:19]
    v_cvt_pkrtz_f16_f32 v58, v58, v102
    v_cvt_pkrtz_f16_f32 v59, v59, v103
    s_waitcnt lgkmcnt(1)
    v_mfma_f32_16x16x32_f16 v[16:19], v[24:27], v[120:123], v[16:19]
    v_cvt_pkrtz_f16_f32 v28, v28, v8
    v_cvt_pkrtz_f16_f32 v29, v29, v9
    s_waitcnt lgkmcnt(0)
    v_mfma_f32_16x16x32_f16 v[16:19], v[88:91], v[72:75], v[16:19]
    v_cvt_pkrtz_f16_f32 v30, v30, v10
    v_cvt_pkrtz_f16_f32 v31, v31, v11
    v_mfma_f32_16x16x32_f16 v[16:19], v[56:59], v[36:39], v[16:19]
    s_nop 0
    v_mfma_f32_16x16x32_f16 v[16:19], v[28:31], v[12:15], v[16:19]
    s_nop 7
    v_cvt_pk_f16_f32 v16, v16, v17
    v_cvt_pk_f16_f32 v17, v18, v19
    ds_write_b64 v1, v[16:17] offset:1536
    s_mov_b64 exec, 1
    ds_add_u32 v3, v0 offset:76
    s_mov_b64 exec, -1
    s_branch L_fin
    s_nop 0
L_set1_67:
    ds_read_b64 v[32:33], v7 offset:128
    ds_read_b64 v[34:35], v7 offset:136
    ds_read_b64 v[36:37], v7 offset:64
    ds_read_b64 v[38:39], v7 offset:72
    ds_read_b64 v[40:41], v7 offset:0
    ds_read_b64 v[42:43], v7 offset:8
    ds_read_b64 v[60:61], v7 offset:640
    ds_read_b64 v[62:63], v7 offset:648
    s_mov_b32 s46, 0
L_sp_73:
    ds_read_b32 v5, v3 offset:48
    s_waitcnt lgkmcnt(0)
    v_cmp_gt_u32_e64 vcc, 2, v5
    s_cbranch_vccz L_spd_74
    s_add_u32 s46, s46, 1
    s_sleep 2
    s_cmp_lt_u32 s46, 400000
    s_cbranch_scc1 L_sp_73
    s_branch L_end
    s_nop 0
L_spd_74:
    s_setprio 2
    ds_read_b128 v[64:67], v4 offset:496
    ds_read_b128 v[68:71], v4 offset:480
    s_waitcnt lgkmcnt(1)
    v_mfma_f32_16x16x32_f16 v[76:79], v[64:67], v[44:47], 0
    ds_read_b128 v[72:75], v4 offset:512
    v_mfma_f32_16x16x32_f16 v[84:87], v[64:67], v[48:51], 0
    ds_read_b128 v[80:83], v4 offset:1024
    v_mfma_f32_16x16x32_f16 v[16:19], v[64:67], v[52:55], 0
    ds_read_b128 v[8:11], v4 offset:1008
    s_waitcnt lgkmcnt(3)
    s_nop 0
    v_mfma_f32_16x16x32_f16 v[20:23], v[68:71], v[56:59], 0
    ds_read_b64 v[24:25], v7 offset:576
    v_mfma_f32_16x16x32_f16 v[28:31], v[68:71], v[44:47], 0
    ds_read_b128 v[88:91], v4 offset:992
    v_mfma_f32_16x16x32_f16 v[96:99], v[68:71], v[48:51], 0
    ds_read_b64 v[26:27], v7 offset:584
    s_waitcnt lgkmcnt(5)
    v_mfma_f32_16x16x32_f16 v[104:107], v[12:15], v[72:75], 0
    ds_read_b64 v[92:93], v7 offset:320
    s_waitcnt lgkmcnt(5)
    v_mfma_f32_16x16x32_f16 v[112:115], v[12:15], v[80:83], 0
    ds_read_b64 v[94:95], v7 offset:328
    s_waitcnt lgkmcnt(5)
    s_nop 0
    v_mfma_f32_16x16x32_f16 v[120:123], v[8:11], v[44:47], 0
    ds_read_b64 v[100:101], v7 offset:256
    v_cvt_pkrtz_f16_f32 v76, v76, v84
    v_cvt_pkrtz_f16_f32 v77, v77, v85
    v_mfma_f32_16x16x32_f16 v[64:67], v[8:11], v[48:51], 0
    ds_read_b64 v[102:103], v7 offset:264
    v_cvt_pkrtz_f16_f32 v78, v78, v86
    v_cvt_pkrtz_f16_f32 v79, v79, v87
    v_mfma_f32_16x16x32_f16 v[72:75], v[8:11], v[52:55], 0
    ds_read_b64 v[108:109], v7 offset:192
    v_cvt_pkrtz_f16_f32 v16, v16, v20
    v_cvt_pkrtz_f16_f32 v17, v17, v21
    s_nop 0
    s_waitcnt lgkmcnt(6)
    v_mfma_f32_16x16x32_f16 v[80:83], v[88:91], v[56:59], 0
    ds_read_b64 v[110:111], v7 offset:200
    v_cvt_pkrtz_f16_f32 v18, v18, v22
    v_cvt_pkrtz_f16_f32 v19, v19, v23
    v_mfma_f32_16x16x32_f16 v[84:87], v[88:91], v[44:47], 0
    ds_read_b64 v[116:117], v6 offset:0
    v_cvt_pkrtz_f16_f32 v28, v28, v96
    v_cvt_pkrtz_f16_f32 v29, v29, v97
    v_mfma_f32_16x16x32_f16 v[52:55], v[88:91], v[48:51], 0
    ds_read_b64 v[118:119], v6 offset:8
    v_cvt_pkrtz_f16_f32 v30, v30, v98
    v_cvt_pkrtz_f16_f32 v31, v31, v99
    v_mfma_f32_16x16x32_f16 v[8:11], v[76:79], v[32:35], 0
    ds_read_b64 v[124:125], v6 offset:64
    v_mfma_f32_16x16x32_f16 v[56:59], v[76:79], v[36:39], 0
    ds_read_b128 v[20:23], v4 offset:496
    v_mfma_f32_16x16x32_f16 v[104:107], v[76:79], v[40:43], v[104:107]
    ds_read_b64 v[126:127], v6 offset:72
    ds_read_b128 v[88:91], v4 offset:560
    v_mfma_f32_16x16x32_f16 v[104:107], v[16:19], v[60:63], v[104:107]
    ds_read_b64 v[68:69], v6 offset:128
    ds_read_b64 v[70:71], v6 offset:136
    s_waitcnt lgkmcnt(14)
    v_mfma_f32_16x16x32_f16 v[112:115], v[16:19], v[24:27], v[112:115]
    ds_read_b128 v[96:99], v4 offset:624
    ds_read_b64 v[12:13], v6 offset:192
    s_waitcnt lgkmcnt(14)
    v_mfma_f32_16x16x32_f16 v[8:11], v[28:31], v[92:95], v[8:11]
    ds_read_b64 v[14:15], v6 offset:200
    s_waitcnt lgkmcnt(13)
    v_mfma_f32_16x16x32_f16 v[56:59], v[28:31], v[100:103], v[56:59]
    ds_read_b128 v[76:79], v4 offset:688
    s_waitcnt lgkmcnt(12)
    v_mfma_f32_16x16x32_f16 v[104:107], v[28:31], v[108:111], v[104:107]
    ds_read_b64 v[16:17], v6 offset:256
    s_waitcnt lgkmcnt(11)
    s_waitcnt lgkmcnt(9)
    v_mfma_f32_16x16x32_f16 v[8:11], v[116:119], v[20:23], v[8:11]
    ds_read_b64 v[18:19], v6 offset:264
    v_cvt_pkrtz_f16_f32 v120, v120, v64
    v_cvt_pkrtz_f16_f32 v121, v121, v65
    v_cvt_pkrtz_f16_f32 v122, v122, v66
    s_waitcnt lgkmcnt(9)
    s_waitcnt lgkmcnt(8)
    v_mfma_f32_16x16x32_f16 v[8:11], v[124:127], v[88:91], v[8:11]
    ds_read_b64 v[24:25], v6 offset:320
    v_cvt_pkrtz_f16_f32 v123, v123, v67
    v_cvt_pkrtz_f16_f32 v72, v72, v80
    v_cvt_pkrtz_f16_f32 v73, v73, v81
    s_waitcnt lgkmcnt(7)
    s_waitcnt lgkmcnt(6)
    v_mfma_f32_16x16x32_f16 v[8:11], v[68:71], v[96:99], v[8:11]
    ds_read_b64 v[26:27], v6 offset:328
    v_cvt_pkrtz_f16_f32 v74, v74, v82
    v_cvt_pkrtz_f16_f32 v75, v75, v83
    v_cvt_pkrtz_f16_f32 v84, v84, v52
    s_waitcnt lgkmcnt(5)
    s_waitcnt lgkmcnt(4)
    v_mfma_f32_16x16x32_f16 v[8:11], v[12:15], v[76:79], v[8:11]
    ds_read_b64 v[28:29], v6 offset:384
    v_cvt_pkrtz_f16_f32 v85, v85, v53
    v_cvt_pkrtz_f16_f32 v86, v86, v54
    v_cvt_pkrtz_f16_f32 v87, v87, v55
    v_mfma_f32_16x16x32_f16 v[56:59], v[120:123], v[32:35], v[56:59]
    ds_read_b128 v[96:99], v4 offset:752
    v_mfma_f32_16x16x32_f16 v[104:107], v[120:123], v[36:39], v[104:107]
    ds_read_b128 v[76:79], v4 offset:816
    v_mfma_f32_16x16x32_f16 v[112:115], v[120:123], v[40:43], v[112:115]
    ds_read_b64 v[30:31], v6 offset:392
    ds_read_b128 v[52:55], v4 offset:880
    v_mfma_f32_16x16x32_f16 v[112:115], v[72:75], v[60:63], v[112:115]
    ds_read_b64 v[20:21], v6 offset:448
    ds_read_b64 v[22:23], v6 offset:456
    v_mfma_f32_16x16x32_f16 v[56:59], v[84:87], v[92:95], v[56:59]
    ds_read_b128 v[120:123], v4 offset:944
    ds_read_b64 v[88:89], v6 offset:512
    v_mfma_f32_16x16x32_f16 v[104:107], v[84:87], v[100:103], v[104:107]
    ds_read_b64 v[90:91], v6 offset:520
    v_mfma_f32_16x16x32_f16 v[112:115], v[84:87], v[108:111], v[112:115]
    ds_read_b128 v[60:63], v4 offset:1008
    ds_read_b64 v[64:65], v6 offset:576
    s_waitcnt lgkmcnt(14)
    s_waitcnt lgkmcnt(10)
    v_mfma_f32_16x16x32_f16 v[8:11], v[16:19], v[96:99], v[8:11]
    ds_read_b64 v[66:67], v6 offset:584
    s_waitcnt lgkmcnt(10)
    s_nop 0
    v_mfma_f32_16x16x32_f16 v[8:11], v[24:27], v[76:79], v[8:11]
    ds_read_b128 v[108:111], v4 offset:1072
    ds_read_b64 v[80:81], v6 offset:640
    s_waitcnt lgkmcnt(11)
    s_waitcnt lgkmcnt(10)
    v_mfma_f32_16x16x32_f16 v[8:11], v[28:31], v[52:55], v[8:11]
    ds_read_b64 v[82:83], v6 offset:648
    s_waitcnt lgkmcnt(9)
    s_waitcnt lgkmcnt(8)
    v_mfma_f32_16x16x32_f16 v[8:11], v[20:23], v[120:123], v[8:11]
    ds_read_b128 v[96:99], v4 offset:1136
    ds_read_b64 v[40:41], v6 offset:704
    s_waitcnt lgkmcnt(8)
    s_waitcnt lgkmcnt(7)
    v_mfma_f32_16x16x32_f16 v[8:11], v[88:91], v[60:63], v[8:11]
    ds_read_b64 v[42:43], v6 offset:712
    v_mfma_f32_16x16x32_f16 v[56:59], v[116:119], v[60:63], v[56:59]
    ds_read_b128 v[52:55], v4 offset:1200
    ds_read_b64 v[72:73], v6 offset:768
    s_waitcnt lgkmcnt(8)
    s_waitcnt lgkmcnt(7)
    v_mfma_f32_16x16x32_f16 v[8:11], v[64:67], v[108:111], v[8:11]
    ds_read_b64 v[74:75], v6 offset:776
    v_mfma_f32_16x16x32_f16 v[56:59], v[124:127], v[108:111], v[56:59]
    ds_read_b128 v[60:63], v4 offset:1264
    ds_read_b64 v[84:85], v6 offset:832
    s_waitcnt lgkmcnt(8)
    s_waitcnt lgkmcnt(7)
    v_mfma_f32_16x16x32_f16 v[8:11], v[80:83], v[96:99], v[8:11]
    ds_read_b64 v[86:87], v6 offset:840
    v_mfma_f32_16x16x32_f16 v[56:59], v[68:71], v[96:99], v[56:59]
    ds_read_b128 v[108:111], v4 offset:1328
    ds_read_b64 v[76:77], v6 offset:896
    s_waitcnt lgkmcnt(8)
    s_waitcnt lgkmcnt(7)
    v_mfma_f32_16x16x32_f16 v[8:11], v[40:43], v[52:55], v[8:11]
    ds_read_b64 v[78:79], v6 offset:904
    v_mfma_f32_16x16x32_f16 v[56:59], v[12:15], v[52:55], v[56:59]
    ds_read_b128 v[96:99], v4 offset:1392
    ds_read_b64 v[120:121], v6 offset:960
    s_waitcnt lgkmcnt(8)
    s_waitcnt lgkmcnt(7)
    v_mfma_f32_16x16x32_f16 v[8:11], v[72:75], v[60:63], v[8:11]
    ds_read_b64 v[122:123], v6 offset:968
    v_mfma_f32_16x16x32_f16 v[56:59], v[16:19], v[60:63], v[56:59]
    ds_read_b128 v[52:55], v4 offset:1456
    s_waitcnt lgkmcnt(7)
    s_waitcnt lgkmcnt(6)
    v_mfma_f32_16x16x32_f16 v[8:11], v[84:87], v[108:111], v[8:11]
    ds_read_b128 v[60:63], v4 offset:1520
    v_mfma_f32_16x16x32_f16 v[56:59], v[24:27], v[108:111], v[56:59]
    ds_read_b64 v[108:109], v6 offset:1024
    ds_read_b64 v[110:111], v6 offset:1032
    s_waitcnt lgkmcnt(7)
    s_waitcnt lgkmcnt(6)
    v_mfma_f32_16x16x32_f16 v[8:11], v[76:79], v[96:99], v[8:11]
    v_mfma_f32_16x16x32_f16 v[56:59], v[28:31], v[96:99], v[56:59]
    ds_read_b128 v[96:99], v4 offset:1584
    s_waitcnt lgkmcnt(5)
    s_waitcnt lgkmcnt(4)
    v_mfma_f32_16x16x32_f16 v[8:11], v[120:123], v[52:55], v[8:11]
    v_mfma_f32_16x16x32_f16 v[56:59], v[20:23], v[52:55], v[56:59]
    ds_read_b128 v[52:55], v4 offset:1648
    s_waitcnt lgkmcnt(2)
    s_nop 0
    v_mfma_f32_16x16x32_f16 v[8:11], v[108:111], v[60:63], v[8:11]
    v_mfma_f32_16x16x32_f16 v[56:59], v[88:91], v[60:63], v[56:59]
    v_mfma_f32_16x16x32_f16 v[104:107], v[116:119], v[60:63], v[104:107]
    ds_read_b128 v[60:63], v4 offset:1712
    s_waitcnt lgkmcnt(2)
    v_mfma_f32_16x16x32_f16 v[56:59], v[64:67], v[96:99], v[56:59]
    s_nop 2
    v_cvt_pk_f16_f32 v8, v8, v9
    v_cvt_pk_f16_f32 v9, v10, v11
    ds_write_b64 v1, v[8:9] offset:0
    s_mov_b64 exec, 1
    ds_add_u32 v3, v0 offset:64
    s_mov_b64 exec, -1
    s_setprio 1
    v_mfma_f32_16x16x32_f16 v[104:107], v[124:127], v[96:99], v[104:107]
    ds_read_b128 v[8:11], v4 offset:1776
    s_waitcnt lgkmcnt(4)
    v_mfma_f32_16x16x32_f16 v[56:59], v[80:83], v[52:55], v[56:59]
    ds_read_b128 v[96:99], v4 offset:1840
    v_mfma_f32_16x16x32_f16 v[104:107], v[68:71], v[52:55], v[104:107]
    ds_read_b128 v[52:55], v4 offset:1904
    s_nop 0
    s_waitcnt lgkmcnt(5)
    v_mfma_f32_16x16x32_f16 v[56:59], v[40:43], v[60:63], v[56:59]
    v_mfma_f32_16x16x32_f16 v[104:107], v[12:15], v[60:63], v[104:107]
    ds_read_b32 v5, v3 offset:56
    ds_read_b128 v[60:63], v4 offset:1968
    s_waitcnt lgkmcnt(4)
    v_mfma_f32_16x16x32_f16 v[56:59], v[72:75], v[8:11], v[56:59]
    v_mfma_f32_16x16x32_f16 v[104:107], v[16:19], v[8:11], v[104:107]
    ds_read_b128 v[8:11], v4 offset:2032
    s_waitcnt lgkmcnt(4)
    v_mfma_f32_16x16x32_f16 v[56:59], v[84:87], v[96:99], v[56:59]
    v_mfma_f32_16x16x32_f16 v[104:107], v[24:27], v[96:99], v[104:107]
    s_waitcnt lgkmcnt(3)
    v_mfma_f32_16x16x32_f16 v[56:59], v[76:79], v[52:55], v[56:59]
    s_waitcnt lgkmcnt(2)
    v_cmp_gt_u32_e64 vcc, 2, v5
    s_cbranch_vccz L_x2_75
    s_mov_b32 s46, 0
L_sp_76:
    ds_read_b32 v5, v3 offset:56
    s_waitcnt lgkmcnt(0)
    v_cmp_gt_u32 vcc, 2, v5
    s_cbranch_vccz L_spd_77
    s_add_u32 s46, s46, 1
    s_sleep 1
    s_cmp_lt_u32 s46, 400000
    s_cbranch_scc1 L_sp_76
    s_branch L_end
    s_nop 0
L_spd_77:
L_x2_75:
    ds_read_b128 v[96:99], v4 offset:2096
    v_mfma_f32_16x16x32_f16 v[104:107], v[28:31], v[52:55], v[104:107]
    s_waitcnt lgkmcnt(2)
    v_mfma_f32_16x16x32_f16 v[56:59], v[120:123], v[60:63], v[56:59]
    ds_read_b128 v[52:55], v4 offset:2160
    v_mfma_f32_16x16x32_f16 v[104:107], v[20:23], v[60:63], v[104:107]
    s_waitcnt lgkmcnt(2)
    v_mfma_f32_16x16x32_f16 v[56:59], v[108:111], v[8:11], v[56:59]
    ds_read_b128 v[60:63], v4 offset:2224
    v_mfma_f32_16x16x32_f16 v[104:107], v[88:91], v[8:11], v[104:107]
    v_mfma_f32_16x16x32_f16 v[112:115], v[116:119], v[8:11], v[112:115]
    ds_read_b128 v[116:119], v4 offset:1520
    s_waitcnt lgkmcnt(3)
    v_mfma_f32_16x16x32_f16 v[104:107], v[64:67], v[96:99], v[104:107]
    s_nop 1
    v_cvt_pk_f16_f32 v56, v56, v57
    v_cvt_pk_f16_f32 v57, v58, v59
    ds_write_b64 v1, v[56:57] offset:512
    s_mov_b64 exec, 1
    ds_add_u32 v3, v0 offset:68
    s_mov_b64 exec, -1
    s_setprio 0
    v_mfma_f32_16x16x32_f16 v[112:115], v[124:127], v[96:99], v[112:115]
    ds_read_b128 v[8:11], v4 offset:1504
    s_waitcnt lgkmcnt(5)
    v_mfma_f32_16x16x32_f16 v[104:107], v[80:83], v[52:55], v[104:107]
    v_mfma_f32_16x16x32_f16 v[112:115], v[68:71], v[52:55], v[112:115]
    ds_read_b128 v[56:59], v4 offset:2288
    s_waitcnt lgkmcnt(5)
    v_mfma_f32_16x16x32_f16 v[104:107], v[40:43], v[60:63], v[104:107]
    v_mfma_f32_16x16x32_f16 v[112:115], v[12:15], v[60:63], v[112:115]
    ds_read_b128 v[124:127], v4 offset:2352
    s_waitcnt lgkmcnt(5)
    v_mfma_f32_16x16x32_f16 v[96:99], v[116:119], v[44:47], 0
    v_mfma_f32_16x16x32_f16 v[68:71], v[116:119], v[48:51], 0
    ds_read_b128 v[52:55], v4 offset:2416
    s_waitcnt lgkmcnt(3)
    v_mfma_f32_16x16x32_f16 v[12:15], v[8:11], v[44:47], 0
    v_mfma_f32_16x16x32_f16 v[60:63], v[8:11], v[48:51], 0
    ds_read_b128 v[116:119], v4 offset:2480
    s_waitcnt lgkmcnt(3)
    v_mfma_f32_16x16x32_f16 v[104:107], v[72:75], v[56:59], v[104:107]
    v_mfma_f32_16x16x32_f16 v[112:115], v[16:19], v[56:59], v[112:115]
    ds_read_b128 v[8:11], v4 offset:2544
    s_waitcnt lgkmcnt(3)
    s_nop 0
    v_mfma_f32_16x16x32_f16 v[104:107], v[84:87], v[124:127], v[104:107]
    v_cvt_pkrtz_f16_f32 v96, v96, v68
    v_cvt_pkrtz_f16_f32 v97, v97, v69
    v_mfma_f32_16x16x32_f16 v[112:115], v[24:27], v[124:127], v[112:115]
    v_cvt_pkrtz_f16_f32 v98, v98, v70
    v_cvt_pkrtz_f16_f32 v99, v99, v71
    s_nop 0
    s_waitcnt lgkmcnt(2)
    v_mfma_f32_16x16x32_f16 v[104:107], v[76:79], v[52:55], v[104:107]
    v_cvt_pkrtz_f16_f32 v12, v12, v60
    v_cvt_pkrtz_f16_f32 v13, v13, v61
    v_mfma_f32_16x16x32_f16 v[112:115], v[28:31], v[52:55], v[112:115]
    v_cvt_pkrtz_f16_f32 v14, v14, v62
    v_cvt_pkrtz_f16_f32 v15, v15, v63
    s_waitcnt lgkmcnt(1)
    v_mfma_f32_16x16x32_f16 v[104:107], v[120:123], v[116:119], v[104:107]
    v_mfma_f32_16x16x32_f16 v[112:115], v[20:23], v[116:119], v[112:115]
    ds_read_b128 v[16:19], v4 offset:2608
    s_waitcnt lgkmcnt(1)
    v_mfma_f32_16x16x32_f16 v[104:107], v[108:111], v[8:11], v[104:107]
    ds_read_b128 v[56:59], v4 offset:2672
    v_mfma_f32_16x16x32_f16 v[112:115], v[88:91], v[8:11], v[112:115]
    ds_read_b128 v[24:27], v4 offset:2032
    v_mfma_f32_16x16x32_f16 v[104:107], v[96:99], v[32:35], v[104:107]
    v_mfma_f32_16x16x32_f16 v[112:115], v[96:99], v[36:39], v[112:115]
    ds_read_b128 v[124:127], v4 offset:2016
    v_mfma_f32_16x16x32_f16 v[104:107], v[12:15], v[92:95], v[104:107]
    v_mfma_f32_16x16x32_f16 v[112:115], v[12:15], v[100:103], v[112:115]
    ds_read_b128 v[68:71], v4 offset:2736
    s_waitcnt lgkmcnt(4)
    v_mfma_f32_16x16x32_f16 v[112:115], v[64:67], v[16:19], v[112:115]
    ds_read_b128 v[28:31], v4 offset:2800
    s_waitcnt lgkmcnt(4)
    v_mfma_f32_16x16x32_f16 v[112:115], v[80:83], v[56:59], v[112:115]
    s_nop 0
    s_nop 0
    v_cvt_pk_f16_f32 v104, v104, v105
    v_cvt_pk_f16_f32 v105, v106, v107
    ds_write_b64 v1, v[104:105] offset:1024
    s_mov_b64 exec, 1
    ds_add_u32 v3, v0 offset:72
    s_mov_b64 exec, -1
    s_setprio 0
    s_waitcnt lgkmcnt(5)
    v_mfma_f32_16x16x32_f16 v[60:63], v[24:27], v[44:47], 0
    ds_read_b128 v[52:55], v4 offset:2864
    v_mfma_f32_16x16x32_f16 v[116:119], v[24:27], v[48:51], 0
    ds_read_b128 v[20:23], v4 offset:2928
    s_nop 0
    s_waitcnt lgkmcnt(6)
    v_mfma_f32_16x16x32_f16 v[8:11], v[124:127], v[44:47], 0
    ds_read_b128 v[88:91], v4 offset:2992
    v_mfma_f32_16x16x32_f16 v[96:99], v[124:127], v[48:51], 0
    ds_read_b128 v[36:39], v4 offset:3056
    s_waitcnt lgkmcnt(7)
    v_mfma_f32_16x16x32_f16 v[112:115], v[40:43], v[68:71], v[112:115]
    s_waitcnt lgkmcnt(6)
    v_mfma_f32_16x16x32_f16 v[112:115], v[72:75], v[28:31], v[112:115]
    s_waitcnt lgkmcnt(3)
    v_mfma_f32_16x16x32_f16 v[112:115], v[84:87], v[52:55], v[112:115]
    v_cvt_pkrtz_f16_f32 v60, v60, v116
    v_cvt_pkrtz_f16_f32 v61, v61, v117
    s_waitcnt lgkmcnt(2)
    v_mfma_f32_16x16x32_f16 v[112:115], v[76:79], v[20:23], v[112:115]
    v_cvt_pkrtz_f16_f32 v62, v62, v118
    v_cvt_pkrtz_f16_f32 v63, v63, v119
    s_waitcnt lgkmcnt(1)
    v_mfma_f32_16x16x32_f16 v[112:115], v[120:123], v[88:91], v[112:115]
    v_cvt_pkrtz_f16_f32 v8, v8, v96
    v_cvt_pkrtz_f16_f32 v9, v9, v97
    s_waitcnt lgkmcnt(0)
    v_mfma_f32_16x16x32_f16 v[112:115], v[108:111], v[36:39], v[112:115]
    v_cvt_pkrtz_f16_f32 v10, v10, v98
    v_cvt_pkrtz_f16_f32 v11, v11, v99
    v_mfma_f32_16x16x32_f16 v[112:115], v[60:63], v[32:35], v[112:115]
    s_nop 0
    v_mfma_f32_16x16x32_f16 v[112:115], v[8:11], v[92:95], v[112:115]
    s_nop 7
    v_cvt_pk_f16_f32 v112, v112, v113
    v_cvt_pk_f16_f32 v113, v114, v115
    ds_write_b64 v1, v[112:113] offset:1536
    s_mov_b64 exec, 1
    ds_add_u32 v3, v0 offset:76
    s_mov_b64 exec, -1
L_fin:
L_end:
    s_endpgm
L_codeend:
.section .rodata,"a"
.p2align 6
.amdhsa_kernel recurrent_scan__ssm_conv_s4d__moe_arch_mod__prompt_kernel
  .amdhsa_next_free_vgpr 128
  .amdhsa_next_free_sgpr 102
  .amdhsa_accum_offset 128
  .amdhsa_group_segment_fixed_size 0
  .amdhsa_kernarg_size 120
  .amdhsa_user_sgpr_count 2
  .amdhsa_user_sgpr_kernarg_segment_ptr 1
  .amdhsa_system_sgpr_workgroup_id_x 1
  .amdhsa_float_denorm_mode_32 3
.end_amdhsa_kernel
```

```asm
; @launch grid=(256,1,1) block=(1024,1,1) lds=161280
.amdgcn_target "amdgcn-amd-amdhsa--gfx950"
.text
.globl recurrent_scan__ssm_conv_s4d__moe_arch_mod__prompt_kernel
.p2align 12
.p2align 8
.type recurrent_scan__ssm_conv_s4d__moe_arch_mod__prompt_kernel,@function
recurrent_scan__ssm_conv_s4d__moe_arch_mod__prompt_kernel:
    s_cmp_ge_u32 s2, 256
    s_nop 0
    s_cbranch_scc1 L_end
    s_load_dwordx16 s[4:19], s[0:1], 0
    s_load_dwordx8 s[20:27], s[0:1], 64
    s_load_dwordx4 s[28:31], s[0:1], 96
    s_load_dwordx2 s[32:33], s[0:1], 112
    s_getpc_b64 s[62:63]
L_pc:
    v_readfirstlane_b32 s3, v0
    v_and_b32 v1, 63, v0
    v_mov_b32 v3, 0
    v_lshlrev_b32 v2, 4, v1
    s_and_b32 s35, s2, 7
    s_lshr_b32 s36, s2, 3
    s_lshr_b32 s3, s3, 6
    s_and_b32 s40, s36, 15
    s_lshl4_add_u32 s37, s35, s40
    s_lshr_b32 s38, s36, 4
    s_xor_b32 s38, s38, 1
    s_and_b32 s34, s3, 3
    s_cmp_ge_u32 s3, 4
    s_cbranch_scc1 L_p1
    s_setprio 3
    s_lshl_b32 s40, s2, 14
    s_lshl_b32 s41, s34, 9
    v_lshrrev_b32_e64 v118, 3, v1
    v_and_b32 v113, 112, v2
    v_add_u32_e64 v113, s41, v113
    v_lshl_add_u32 v112, v118, 11, v113
    v_add_u32 v112, s40, v112
    s_waitcnt lgkmcnt(0)
    s_load_dword s47, s[32:33], 0
    global_load_dwordx4 v[32:35], v113, s[20:21] offset:0
    global_load_dwordx4 v[36:39], v113, s[20:21] offset:128
    global_load_dwordx4 v[40:43], v113, s[20:21] offset:256
    global_load_dwordx4 v[44:47], v113, s[20:21] offset:384
    global_load_dwordx4 v[16:19], v112, s[4:5] offset:0 nt
    global_load_dwordx4 v[20:23], v112, s[4:5] offset:128 nt
    global_load_dwordx4 v[24:27], v112, s[4:5] offset:256 nt
    global_load_dwordx4 v[28:31], v112, s[4:5] offset:384 nt
    s_barrier
    s_branch L_tok
    s_nop 0
L_p1:
    s_cmp_ge_u32 s3, 8
    s_cbranch_scc1 L_p2
    s_and_b32 s40, s36, 3
    s_lshl2_add_u32 s40, s40, s34
    s_lshl_b32 s40, s40, 11
    v_and_b32 v0, 15, v1
    v_lshl_add_u32 v0, v0, 7, s40
    v_cmp_gt_u32 vcc, L_codeend-L_pc-4, v0
    s_nop 1
    v_cndmask_b32 v0, v3, v0, vcc
    global_load_dword v31, v0, s[62:63]
    s_lshl_b32 s40, s34, 7
    s_and_b32 s41, s40, 128
    s_add_u32 s40, s40, 384
    v_cmp_gt_u32 vcc, 32, v1
    v_mov_b32 v32, s40
    v_mov_b32 v33, s41
    v_cndmask_b32 v32, v33, v32, vcc
    v_cndmask_b32 v34, 0, -1, vcc
    v_lshl_add_u32 v32, v1, 2, v32
    v_subrev_u32 v32, 128, v32
    ds_write_b32 v32, v34
    s_waitcnt lgkmcnt(0)
    s_barrier
    s_branch L_exp
L_p2:
    s_lshl2_add_u32 s60, s38, s34
    s_bfe_u32 s59, s3, 0x10002
    s_lshl_b32 s40, s59, 2
    s_xor_b32 s34, s60, s40
    v_and_b32 v32, 15, v1
    v_lshrrev_b32 v33, 4, v1
    s_cmp_ge_u32 s34, 5
    s_cbranch_scc1 L_q5
    s_lshl_b32 s40, s34, 2
    s_lshr_b32 s41, 0xccb5a, s40
    s_and_b32 s41, s41, 15
    s_add_u32 s41, s41, 40
    s_lshr_b32 s45, 0x29735, s40
    s_and_b32 s45, s45, 15
    s_bfm_b32 s45, s45, 0
    s_mov_b32 s44, 0
    v_lshl_add_u32 v86, v33, 3, v32
    v_sub_u32_e64 v86, s41, v86
    v_lshrrev_b64 v[86:87], v86, s[44:45]
    s_mov_b32 s43, 0xffff
    v_bfe_i32 v36, v86, 0, 1
    v_bfe_i32 v87, v86, 1, 1
    v_bfi_b32 v36, s43, v36, v87
    v_and_b32 v36, 0x3c003c00, v36
    v_bfe_i32 v37, v86, 2, 1
    v_bfe_i32 v87, v86, 3, 1
    v_bfi_b32 v37, s43, v37, v87
    v_and_b32 v37, 0x3c003c00, v37
    v_bfe_i32 v38, v86, 4, 1
    v_bfe_i32 v87, v86, 5, 1
    v_bfi_b32 v38, s43, v38, v87
    v_and_b32 v38, 0x3c003c00, v38
    v_bfe_i32 v39, v86, 6, 1
    v_bfe_i32 v87, v86, 7, 1
    v_bfi_b32 v39, s43, v39, v87
    v_and_b32 v39, 0x3c003c00, v39
    s_branch L_qw
    s_nop 0
L_q5:
    s_cmp_ge_u32 s34, 6
    s_cbranch_scc1 L_q6
    v_lshlrev_b32 v85, 1, v32
    v_sub_u32 v85, v85, v33
    v_lshl_add_u32 v36, v85, 4, 48
    v_and_b32 v86, 1, v1
    v_cmp_eq_u32 vcc, 0, v86
    v_mov_b32 v85, 0x03020706
    v_mov_b32 v87, 0x05040100
    v_cndmask_b32_e64 v37, v85, v87, vcc
    v_mov_b32 v85, 4412
    v_mov_b32 v87, 5312
    v_cndmask_b32 v85, v85, v87, vcc
    v_lshlrev_b32 v86, 2, v33
    v_sub_u32 v86, v86, v32
    v_lshl_add_u32 v39, v86, 2, v85
    v_sub_u32 v85, 3, v32
    v_and_b32_e64 v85, 3, v85
    v_mul_u32_u24 v85, 1086, v85
    v_lshl_add_u32 v86, v33, 3, v32
    v_sub_u32_e64 v86, 39, v86
    v_lshl_add_u32 v38, v86, 1, v85
    s_branch L_qw
L_q6:
    s_cmp_ge_u32 s34, 7
    s_cbranch_scc1 L_q7
    v_and_b32 v31, 31, v1
    v_mov_b32 v85, 0
    v_cmp_gt_u32 vcc, 24, v31
    v_mov_b32 v86, 0x9876a987
    s_nop 0
    v_cndmask_b32 v85, v85, v86, vcc
    v_cmp_gt_u32 vcc, 16, v31
    v_mov_b32 v86, 0x54aa6543
    s_nop 0
    v_cndmask_b32 v85, v85, v86, vcc
    v_cmp_gt_u32 vcc, 8, v31
    v_mov_b32 v86, 0x2113210
    s_nop 0
    v_cndmask_b32 v85, v85, v86, vcc
    v_lshlrev_b32_e64 v86, 2, v31
    v_bfe_u32 v85, v85, v86, 4
    s_mov_b32 s41, 0xf00f0ff0
    v_bfe_u32 v86, s41, v31, 1
    v_mad_u32_u24 v85, v86, 10, v85
    v_lshrrev_b32 v86, 5, v1
    v_mad_u32_u24 v85, v85, 17, v86
    v_lshlrev_b32 v36, 4, v85
    v_mad_u32_u24 v85, v31, 17, v86
    v_lshlrev_b32 v37, 4, v85
    v_lshrrev_b32 v85, 1, v1
    v_and_b32_e64 v86, 1, v1
    v_sub_u32 v85, 1135, v85
    v_mad_u32_u24 v87, v86, 48, v85
    v_lshlrev_b32 v38, 2, v87
    v_lshlrev_b32 v86, 5, v86
    v_sub_u32 v85, v85, v86
    v_add_u32 v85, 128, v85
    v_lshlrev_b32 v39, 2, v85
    s_branch L_qw
L_q7:
    v_cmp_gt_u32 vcc, 32, v1
    v_bfe_u32 v85, v1, 2, 2
    v_bfe_u32 v86, v1, 3, 2
    v_cndmask_b32 v86, v86, v85, vcc
    v_lshlrev_b32 v86, 2, v86
    s_mov_b32 s41, 0xb630
    v_bfe_u32 v86, s41, v86, 4
    v_mov_b32 v87, 5248
    v_mov_b32 v36, 4352
    v_cndmask_b32 v87, v87, v36, vcc
    v_lshl_add_u32 v86, v86, 6, v87
    v_and_b32 v87, 7, v1
    v_min_u32 v87, 4, v87
    v_and_b32 v36, 3, v1
    v_cndmask_b32 v87, v87, v36, vcc
    v_cmp_gt_u32 vcc, 16, v1
    v_mul_u32_u24 v85, 1088, v85
    s_mov_b32 s41, 0xffff0000
    v_cndmask_b32 v86, v86, v85, vcc
    v_lshl_add_u32 v36, v87, 4, v86
    v_mov_b32 v37, 0
    v_mov_b32_e64 v38, 0
    v_mov_b32_e64 v39, 0
    v_writelane_b32 v38, s41, 3
    v_writelane_b32 v39, -1, 3
    v_writelane_b32 v38, -1, 7
    v_writelane_b32 v39, -1, 7
    v_writelane_b32 v37, s41, 11
    v_writelane_b32 v38, -1, 11
    v_writelane_b32 v37, -1, 15
    v_writelane_b32 v38, -1, 15
L_qw:
    s_lshl_b32 s58, s38, 10
    s_sub_u32 s58, 10512, s58
    s_sub_u32 s40, s34, 4
    s_mul_i32 s40, s40, 4624
    s_add_u32 s40, s40, s58
    s_lshl_b32 s41, s34, 10
    s_add_u32 s41, s41, 4864
    s_cmp_lt_u32 s34, 4
    s_cselect_b32 s40, s41, s40
    v_add_u32_e64 v85, s40, v2
    ds_write_b128 v85, v[36:39]
    s_lshl3_add_u32 s42, s37, s60
    s_lshl_b32 s40, s42, 8
    v_lshl_add_u32 v24, v1, 2, s40
    s_lshr_b32 s40, s42, 1
    s_lshl_b32 s40, s40, 2
    s_waitcnt lgkmcnt(0)
    s_load_dword s48, s[14:15], s40
    s_load_dword s49, s[16:17], s40
    s_barrier
    global_load_dword v8, v24, s[6:7]
    global_load_dword v9, v24, s[8:9]
    global_load_dword v10, v24, s[10:11]
    global_load_dword v11, v24, s[12:13]
    s_branch L_cnv
    s_nop 0
L_tok:
    s_setprio 3
    s_cmp_ge_u32 s34, 2
    s_cselect_b32 s40, 4, 0
    s_add_u32 s40, s40, s34
    s_add_u32 s41, s34, 2
    s_cmp_eq_u32 s38, 0
    s_cselect_b32 s20, s40, s41
    s_cselect_b32 s21, s41, s40
    s_mov_b32 s30, 0x3f803f80
    s_mov_b32 s31, 0xffff0000
    s_lshl_b32 s40, s2, 7
    s_lshl_b32 s41, s34, 20
    s_add_u32 s40, s40, s41
    s_add_u32 s40, s40, 2097152
    s_add_u32 s52, s32, s40
    s_addc_u32 s53, s33, 0
    s_add_u32 s50, s32, 32768
    s_addc_u32 s51, s33, 0
    s_lshl_b32 s40, s2, 6
    s_add_u32 s58, s50, s40
    s_addc_u32 s59, s51, 0
    s_lshl_b32 s40, s21, 11
    s_add_u32 s60, s50, s40
    s_addc_u32 s61, s51, 0
    s_nop 0
    s_lshl_b32 s41, s37, 15
    s_add_u32 s41, s41, 2097152
    s_lshl_b32 s40, s20, 12
    s_add_u32 s40, s40, s41
    s_add_u32 s54, s32, s40
    s_addc_u32 s55, s33, 0
    s_lshl_b32 s40, s21, 12
    s_add_u32 s40, s40, s41
    s_add_u32 s56, s32, s40
    s_addc_u32 s57, s33, 0
    s_lshl_b32 s40, s20, 19
    s_lshl4_add_u32 s40, s37, s40
    s_add_u32 s40, s40, 4096
    s_add_u32 s28, s28, s40
    s_addc_u32 s29, s29, 0
    s_lshl_b32 s40, s20, 9
    s_add_u32 s40, s40, 9488
    s_lshl_b32 s41, s21, 9
    s_add_u32 s41, s41, 9488
    s_nop 0
    s_lshl_b32 s42, s34, 9
    s_add_u32 s42, s42, 52096
    v_lshl_add_u32 v5, v1, 3, s42
    v_add_u32 v11, 57664, v5
    s_lshl_b32 s42, s34, 2
    v_mov_b32 v10, s42
    v_and_b32 v58, 112, v2
    v_lshrrev_b32_e64 v59, 4, v1
    v_mul_u32_u24 v56, 4624, v118
    v_add3_u32 v114, v56, v58, s40
    v_mul_u32_u24 v56, 289, v58
    v_lshlrev_b32_e64 v117, 4, v118
    v_add3_u32 v8, v56, v117, s40
    v_add3_u32 v9, v56, v117, s41
    v_lshl_add_u32 v116, v118, 17, v58
    v_bfe_u32 v56, v1, 2, 2
    v_mul_u32_u24 v56, 4624, v56
    v_lshl_add_u32 v56, v59, 7, v56
    v_and_b32 v57, 2, v1
    v_lshl_add_u32 v56, v57, 5, v56
    v_and_b32 v57, 1, v1
    v_lshl_add_u32 v56, v57, 3, v56
    v_add_u32 v115, s40, v56
    v_and_b32 v57, 15, v1
    v_lshl_add_u32 v56, v57, 2, v59
    v_lshl_add_u32 v6, v56, 3, s40
    v_lshlrev_b32 v4, 13, v56
    s_lshl_b32 s40, s20, 11
    v_lshl_add_u32 v7, v56, 5, s40
    s_lshl_b32 s40, s34, 7
    v_add_u32 v120, s40, v117
    v_lshlrev_b32 v118, 3, v118
    v_mov_b32 v53, 1
    s_waitcnt lgkmcnt(0)
    s_add_u32 s39, s47, 1
    s_mul_i32 s39, s39, 0x9e3779b1
    v_mov_b32 v52, s39
    s_mov_b64 exec, 1
    ds_write_b64 v3, v[52:53] offset:40
    s_mov_b64 exec, -1
    v_lshlrev_b32 v57, 3, v1
    v_and_b32 v119, 0xffff, v52
    s_and_b32 s42, s39, 1
    s_mul_i32 s42, s42, 0x01010101
    s_and_b32 s43, s39, 0xfefefefe
    s_or_b32 s43, s43, s42
    v_bfe_u32 v56, s43, v57, 8
    v_lshl_or_b32 v12, v56, 14, v56
    v_lshrrev_b32 v14, 4, v12
    s_waitcnt vmcnt(4)
    v_dot2_f32_bf16 v51, v32, s30, 0
    v_dot2_f32_bf16 v52, v33, s30, 0
    v_dot2_f32_bf16 v51, v34, s30, v51
    v_dot2_f32_bf16 v52, v35, s30, v52
    v_dot2_f32_bf16 v51, v36, s30, v51
    v_dot2_f32_bf16 v52, v37, s30, v52
    v_dot2_f32_bf16 v51, v38, s30, v51
    v_dot2_f32_bf16 v52, v39, s30, v52
    v_dot2_f32_bf16 v51, v40, s30, v51
    v_dot2_f32_bf16 v52, v41, s30, v52
    v_dot2_f32_bf16 v51, v42, s30, v51
    v_dot2_f32_bf16 v52, v43, s30, v52
    v_dot2_f32_bf16 v51, v44, s30, v51
    v_dot2_f32_bf16 v52, v45, s30, v52
    v_dot2_f32_bf16 v51, v46, s30, v51
    v_dot2_f32_bf16 v52, v47, s30, v52
    s_waitcnt vmcnt(3)
    s_nop 0
    v_dot2_f32_bf16 v49, v16, v16, 0
    v_dot2_f32_bf16 v48, v16, s30, 0
    v_dot2_f32_bf16 v50, v16, v32, 0
    v_dot2_f32_bf16 v49, v17, v17, v49
    v_dot2_f32_bf16 v48, v17, s30, v48
    v_dot2_f32_bf16 v50, v17, v33, v50
    v_dot2_f32_bf16 v49, v18, v18, v49
    v_dot2_f32_bf16 v48, v18, s30, v48
    v_dot2_f32_bf16 v50, v18, v34, v50
    v_dot2_f32_bf16 v49, v19, v19, v49
    v_dot2_f32_bf16 v48, v19, s30, v48
    v_dot2_f32_bf16 v50, v19, v35, v50
    v_add_f32 v51, v51, v52
    s_waitcnt vmcnt(2)
    v_dot2_f32_bf16 v49, v20, v20, v49
    v_dot2_f32_bf16 v48, v20, s30, v48
    v_dot2_f32_bf16 v50, v20, v36, v50
    v_dot2_f32_bf16 v49, v21, v21, v49
    v_dot2_f32_bf16 v48, v21, s30, v48
    v_dot2_f32_bf16 v50, v21, v37, v50
    v_dot2_f32_bf16 v49, v22, v22, v49
    v_dot2_f32_bf16 v48, v22, s30, v48
    v_dot2_f32_bf16 v50, v22, v38, v50
    v_dot2_f32_bf16 v49, v23, v23, v49
    v_dot2_f32_bf16 v48, v23, s30, v48
    v_dot2_f32_bf16 v50, v23, v39, v50
    s_waitcnt vmcnt(1)
    s_nop 0
    v_dot2_f32_bf16 v49, v24, v24, v49
    v_dot2_f32_bf16 v48, v24, s30, v48
    v_dot2_f32_bf16 v50, v24, v40, v50
    v_dot2_f32_bf16 v49, v25, v25, v49
    v_dot2_f32_bf16 v48, v25, s30, v48
    v_dot2_f32_bf16 v50, v25, v41, v50
    v_dot2_f32_bf16 v49, v26, v26, v49
    v_dot2_f32_bf16 v48, v26, s30, v48
    v_dot2_f32_bf16 v50, v26, v42, v50
    v_dot2_f32_bf16 v49, v27, v27, v49
    v_dot2_f32_bf16 v48, v27, s30, v48
    v_dot2_f32_bf16 v50, v27, v43, v50
    s_nop 0
    s_waitcnt vmcnt(0)
    v_dot2_f32_bf16 v49, v28, v28, v49
    v_dot2_f32_bf16 v48, v28, s30, v48
    v_dot2_f32_bf16 v50, v28, v44, v50
    v_dot2_f32_bf16 v49, v29, v29, v49
    v_dot2_f32_bf16 v48, v29, s30, v48
    v_dot2_f32_bf16 v50, v29, v45, v50
    v_dot2_f32_bf16 v49, v30, v30, v49
    v_dot2_f32_bf16 v48, v30, s30, v48
    v_dot2_f32_bf16 v50, v30, v46, v50
    v_dot2_f32_bf16 v49, v31, v31, v49
    v_dot2_f32_bf16 v48, v31, s30, v48
    v_dot2_f32_bf16 v50, v31, v47, v50
    v_add_f32_dpp v51, v51, v51 quad_perm:[1,0,3,2] row_mask:0xf bank_mask:0xf
    v_add_f32_dpp v49, v49, v49 quad_perm:[1,0,3,2] row_mask:0xf bank_mask:0xf
    v_add_f32_dpp v48, v48, v48 quad_perm:[1,0,3,2] row_mask:0xf bank_mask:0xf
    v_add_f32_dpp v50, v50, v50 quad_perm:[1,0,3,2] row_mask:0xf bank_mask:0xf
    v_add_f32_dpp v51, v51, v51 quad_perm:[2,3,0,1] row_mask:0xf bank_mask:0xf
    v_add_f32_dpp v49, v49, v49 quad_perm:[2,3,0,1] row_mask:0xf bank_mask:0xf
    v_add_f32_dpp v48, v48, v48 quad_perm:[2,3,0,1] row_mask:0xf bank_mask:0xf
    v_add_f32_dpp v50, v50, v50 quad_perm:[2,3,0,1] row_mask:0xf bank_mask:0xf
    v_add_f32_dpp v51, v51, v51 row_half_mirror row_mask:0xf bank_mask:0xf
    v_add_f32_dpp v49, v49, v49 row_half_mirror row_mask:0xf bank_mask:0xf
    v_add_f32_dpp v48, v48, v48 row_half_mirror row_mask:0xf bank_mask:0xf
    v_add_f32_dpp v50, v50, v50 row_half_mirror row_mask:0xf bank_mask:0xf
    v_and_b32 v49, 0x7fffffff, v49
    s_mov_b32 exec_lo, 0x01010101
    s_mov_b32 exec_hi, 0x01010101
    ds_write_b128 v120, v[48:51] offset:256
    s_mov_b64 exec, -1
    s_mov_b32 s46, 0
    ds_read_b128 v[60:63], v117 offset:256
    ds_read_b128 v[64:67], v117 offset:384
    ds_read_b128 v[68:71], v117 offset:512
    ds_read_b128 v[72:75], v117 offset:640
    v_lshlrev_b32_e64 v80, 16, v16
    v_and_b32 v81, 0xffff0000, v16
    v_lshlrev_b32_e64 v82, 16, v17
    v_and_b32 v83, 0xffff0000, v17
    v_lshlrev_b32_e64 v84, 16, v18
    v_and_b32 v85, 0xffff0000, v18
    v_lshlrev_b32_e64 v86, 16, v19
    v_and_b32 v87, 0xffff0000, v19
    v_lshlrev_b32_e64 v88, 16, v20
    v_and_b32 v89, 0xffff0000, v20
    v_lshlrev_b32_e64 v90, 16, v21
    v_and_b32 v91, 0xffff0000, v21
    v_lshlrev_b32_e64 v92, 16, v22
    v_and_b32 v93, 0xffff0000, v22
    s_branch L_spc_3
    s_nop 0
L_sp_1:
    ds_read_b128 v[60:63], v117 offset:256
    ds_read_b128 v[64:67], v117 offset:384
    ds_read_b128 v[68:71], v117 offset:512
    ds_read_b128 v[72:75], v117 offset:640
L_spc_3:
    s_waitcnt lgkmcnt(0)
    v_or3_b32 v52, v61, v65, v69
    v_or_b32 v52, v52, v73
    v_cmp_gt_i32_e64 vcc, 0, v52
    s_cbranch_vccz L_spd_2
    s_add_u32 s46, s46, 1
    s_cmp_lt_u32 s46, 400000
    s_cbranch_scc1 L_sp_1
    s_branch L_end
L_spd_2:
    v_pk_add_f32 v[60:61], v[60:61], v[64:65]
    v_pk_add_f32 v[68:69], v[68:69], v[72:73]
    v_pk_add_f32 v[62:63], v[62:63], v[66:67]
    v_pk_add_f32 v[70:71], v[70:71], v[74:75]
    v_pk_add_f32 v[60:61], v[60:61], v[68:69]
    v_pk_add_f32 v[62:63], v[62:63], v[70:71]
    v_mul_f32 v48, 0x3a800000, v60
    v_mul_f32 v49, 0x3a800000, v61
    v_fma_f32 v49, -v48, v48, v49
    v_max_f32_e64 v49, 0, v49
    v_cvt_pk_bf16_f32 v54, v48, v49
    v_and_b32 v49, 0xffff0000, v54
    v_add_f32 v49, 0x3727c5ac, v49
    v_cvt_pk_bf16_f32 v49, v49, v49
    v_and_b32 v49, 0xffff0000, v49
    v_sqrt_f32_e64 v49, v49
    v_lshlrev_b32_e64 v54, 16, v54
    v_cvt_pk_bf16_f32 v52, v48, v49
    v_and_b32 v49, 0xffff0000, v52
    v_rcp_f32_e64 v55, v49
    v_fma_f32 v53, -v54, v63, v62
    s_cmp_lg_u32 s34, 0
    s_cbranch_scc1 L_nohdr_4
    v_mul_f32 v53, v53, v55
    s_brev_b32 s40, 1
    v_cvt_pk_bf16_f32 v53, v53, v53
    v_ashrrev_i32_e64 v49, 31, v53
    v_bitop3_b32 v53, v53, v49, s40 bitop3:0x1e
    v_and_or_b32 v53, v53, s31, v119
    s_mov_b32 exec_lo, 0x01010101
    s_mov_b32 exec_hi, 0x01010101
    global_store_dwordx2 v118, v[52:53], s[58:59] sc1
    s_mov_b64 exec, -1
L_nohdr_4:
    v_mul_f32 v56, 0xbfb8aa3b, v55
    v_lshlrev_b32 v94, 16, v23
    v_and_b32 v95, 0xffff0000, v23
    v_mul_f32 v58, -v54, v56
    v_lshlrev_b32_e64 v96, 16, v24
    v_and_b32 v97, 0xffff0000, v24
    v_lshlrev_b32_e64 v98, 16, v25
    v_and_b32 v99, 0xffff0000, v25
    v_lshlrev_b32_e64 v100, 16, v26
    v_and_b32 v101, 0xffff0000, v26
    v_lshlrev_b32_e64 v102, 16, v27
    v_and_b32 v103, 0xffff0000, v27
    v_lshlrev_b32_e64 v104, 16, v28
    v_and_b32 v105, 0xffff0000, v28
    v_lshlrev_b32_e64 v106, 16, v29
    v_and_b32 v107, 0xffff0000, v29
    v_lshlrev_b32_e64 v108, 16, v30
    v_and_b32 v109, 0xffff0000, v30
    v_lshlrev_b32_e64 v110, 16, v31
    v_and_b32 v111, 0xffff0000, v31
    v_pk_fma_f32 v[80:81], v[80:81], v[56:57], v[58:59] op_sel_hi:[1,0,0]
    v_pk_fma_f32 v[82:83], v[82:83], v[56:57], v[58:59] op_sel_hi:[1,0,0]
    v_pk_fma_f32 v[84:85], v[84:85], v[56:57], v[58:59] op_sel_hi:[1,0,0]
    v_pk_fma_f32 v[86:87], v[86:87], v[56:57], v[58:59] op_sel_hi:[1,0,0]
    v_cvt_pk_f16_f32 v16, v80, v81
    v_cvt_pk_f16_f32 v17, v82, v83
    v_cvt_pk_f16_f32 v18, v84, v85
    v_cvt_pk_f16_f32 v19, v86, v87
    ds_write_b128 v114, v[16:19] offset:0
    v_pk_fma_f32 v[88:89], v[88:89], v[56:57], v[58:59] op_sel_hi:[1,0,0]
    v_pk_fma_f32 v[90:91], v[90:91], v[56:57], v[58:59] op_sel_hi:[1,0,0]
    v_pk_fma_f32 v[92:93], v[92:93], v[56:57], v[58:59] op_sel_hi:[1,0,0]
    v_pk_fma_f32 v[94:95], v[94:95], v[56:57], v[58:59] op_sel_hi:[1,0,0]
    v_cvt_pk_f16_f32 v20, v88, v89
    v_cvt_pk_f16_f32 v21, v90, v91
    v_cvt_pk_f16_f32 v22, v92, v93
    v_cvt_pk_f16_f32 v23, v94, v95
    ds_write_b128 v114, v[20:23] offset:128
    v_pk_fma_f32 v[96:97], v[96:97], v[56:57], v[58:59] op_sel_hi:[1,0,0]
    v_pk_fma_f32 v[98:99], v[98:99], v[56:57], v[58:59] op_sel_hi:[1,0,0]
    v_pk_fma_f32 v[100:101], v[100:101], v[56:57], v[58:59] op_sel_hi:[1,0,0]
    v_pk_fma_f32 v[102:103], v[102:103], v[56:57], v[58:59] op_sel_hi:[1,0,0]
    v_cvt_pk_f16_f32 v24, v96, v97
    v_cvt_pk_f16_f32 v25, v98, v99
    v_cvt_pk_f16_f32 v26, v100, v101
    v_cvt_pk_f16_f32 v27, v102, v103
    ds_write_b128 v114, v[24:27] offset:256
    v_pk_fma_f32 v[104:105], v[104:105], v[56:57], v[58:59] op_sel_hi:[1,0,0]
    v_pk_fma_f32 v[106:107], v[106:107], v[56:57], v[58:59] op_sel_hi:[1,0,0]
    v_pk_fma_f32 v[108:109], v[108:109], v[56:57], v[58:59] op_sel_hi:[1,0,0]
    v_pk_fma_f32 v[110:111], v[110:111], v[56:57], v[58:59] op_sel_hi:[1,0,0]
    v_cvt_pk_f16_f32 v28, v104, v105
    v_cvt_pk_f16_f32 v29, v106, v107
    v_cvt_pk_f16_f32 v30, v108, v109
    v_cvt_pk_f16_f32 v31, v110, v111
    ds_write_b128 v114, v[28:31] offset:384
    ds_read_b64_tr_b16 v[32:33], v115 offset:0
    ds_read_b64_tr_b16 v[34:35], v115 offset:18496
    ds_read_b64_tr_b16 v[36:37], v115 offset:16
    ds_read_b64_tr_b16 v[38:39], v115 offset:18512
    ds_read_b64_tr_b16 v[40:41], v115 offset:32
    ds_read_b64_tr_b16 v[42:43], v115 offset:18528
    ds_read_b64_tr_b16 v[44:45], v115 offset:48
    ds_read_b64_tr_b16 v[46:47], v115 offset:18544
    s_mov_b32 s22, 0x00030003
    s_nop 0
    s_waitcnt lgkmcnt(6)
    v_bfi_b32 v32, s22, v12, v32
    v_bfi_b32 v34, s22, v14, v34
    global_store_dwordx4 v116, v[32:35], s[52:53] offset:0 sc1
    s_add_u32 s52, s52, 32768
    s_addc_u32 s53, s53, 0
    s_waitcnt lgkmcnt(4)
    v_bfi_b32 v36, s22, v12, v36
    v_bfi_b32 v38, s22, v14, v38
    global_store_dwordx4 v116, v[36:39], s[52:53] offset:0 sc1
    s_add_u32 s52, s52, 32768
    s_addc_u32 s53, s53, 0
    s_waitcnt lgkmcnt(2)
    v_bfi_b32 v40, s22, v12, v40
    v_bfi_b32 v42, s22, v14, v42
    global_store_dwordx4 v116, v[40:43], s[52:53] offset:0 sc1
    s_add_u32 s52, s52, 32768
    s_addc_u32 s53, s53, 0
    s_waitcnt lgkmcnt(0)
    v_bfi_b32 v44, s22, v12, v44
    v_bfi_b32 v46, s22, v14, v46
    global_store_dwordx4 v116, v[44:47], s[52:53] offset:0 sc1
    v_lshrrev_b32 v80, 3, v7
    v_sub_u32 v80, 0xffff, v80
    s_lshl_b32 s40, s21, 8
    s_sub_u32 s40, 0xffff, s40
    v_lshlrev_b32 v84, 1, v1
    v_sub_u32 v84, s40, v84
    v_subrev_u32 v81, 1, v80
    v_subrev_u32 v85, 1, v84
    v_subrev_u32_e64 v82, 2, v80
    v_subrev_u32 v86, 128, v84
    v_subrev_u32_e64 v83, 3, v80
    v_subrev_u32 v87, 129, v84
    v_mov_b32 v76, 1
    v_lshrrev_b32 v52, 4, v1
    v_add_u32_e64 v52, v52, v10
    v_lshlrev_b32_e64 v52, 3, v52
    s_mov_b32 s46, 0
L_sp_5:
    ds_read_b32 v48, v3 offset:80
    s_waitcnt lgkmcnt(0)
    v_cmp_gt_u32_e64 vcc, 4, v48
    s_cbranch_vccz L_spd_6
    s_add_u32 s46, s46, 1
    s_sleep 2
    s_cmp_lt_u32 s46, 400000
    s_cbranch_scc1 L_sp_5
    s_branch L_end
    s_nop 0
L_spd_6:
    global_load_dwordx4 v[60:63], v7, s[50:51] offset:0
    global_load_dwordx4 v[64:67], v7, s[50:51] offset:16
    global_load_dwordx4 v[68:71], v2, s[60:61] offset:0
    global_load_dwordx4 v[72:75], v2, s[60:61] offset:1024
    s_cmp_ge_u32 s34, 2
    s_cbranch_scc1 L_late_9
    s_mov_b32 s46, 0
L_sp_10:
    ds_read_b32 v48, v3 offset:84
    s_waitcnt lgkmcnt(0)
    v_cmp_gt_u32 vcc, 4, v48
    s_cbranch_vccz L_spd_11
    s_add_u32 s46, s46, 1
    s_sleep 2
    s_cmp_lt_u32 s46, 400000
    s_cbranch_scc1 L_sp_10
    s_branch L_end
L_spd_11:
    s_cmp_ge_u32 s21, 6
    s_cbranch_scc1 L_nob_12
    global_load_dwordx4 v[32:35], v2, s[56:57] offset:0 sc1
    global_load_dwordx4 v[36:39], v2, s[56:57] offset:1024 sc1
    global_load_dwordx4 v[40:43], v2, s[56:57] offset:2048 sc1
    global_load_dwordx4 v[44:47], v2, s[56:57] offset:3072 sc1
L_nob_12:
    global_load_dwordx4 v[16:19], v2, s[54:55] offset:0 sc1
    global_load_dwordx4 v[20:23], v2, s[54:55] offset:1024 sc1
    global_load_dwordx4 v[24:27], v2, s[54:55] offset:2048 sc1
    global_load_dwordx4 v[28:31], v2, s[54:55] offset:3072 sc1
    s_mov_b32 s46, 0
    s_waitcnt vmcnt(8)
    s_branch L_rc_7
    s_nop 0
L_late_9:
    s_mov_b32 s46, 0
    s_waitcnt vmcnt(0)
L_rc_7:
    v_xor_b32_e64 v50, v119, v61
    v_bitop3_b32 v50, v50, v63, v119 bitop3:0xf6
    v_bitop3_b32 v50, v50, v65, v119 bitop3:0xf6
    v_bitop3_b32 v50, v50, v67, v119 bitop3:0xf6
    v_bitop3_b32 v50, v50, v69, v119 bitop3:0xf6
    v_bitop3_b32 v50, v50, v71, v119 bitop3:0xf6
    v_bitop3_b32 v50, v50, v73, v119 bitop3:0xf6
    v_bitop3_b32 v50, v50, v75, v119 bitop3:0xf6
    v_and_b32 v50, 0xffff, v50
    v_cmp_ne_u32 vcc, 0, v50
    s_cbranch_vccz L_ro_8
    global_load_dwordx4 v[60:63], v7, s[50:51] offset:0 sc1
    global_load_dwordx4 v[64:67], v7, s[50:51] offset:16 sc1
    global_load_dwordx4 v[68:71], v2, s[60:61] offset:0 sc1
    global_load_dwordx4 v[72:75], v2, s[60:61] offset:1024 sc1
    s_add_u32 s46, s46, 1
    s_cmp_lt_u32 s46, 50000
    s_waitcnt vmcnt(0)
    s_cbranch_scc1 L_rc_7
    s_branch L_end
L_ro_8:
    v_and_or_b32 v80, v61, s31, v80
    v_and_or_b32 v81, v63, s31, v81
    v_and_or_b32 v82, v65, s31, v82
    v_and_or_b32 v83, v67, s31, v83
    v_and_or_b32 v84, v69, s31, v84
    v_and_or_b32 v85, v71, s31, v85
    v_and_or_b32 v86, v73, s31, v86
    v_and_or_b32 v87, v75, s31, v87
    v_max3_u32 v48, v80, v81, v82
    v_med3_u32 v49, v80, v81, v82
    v_med3_u32 v49, v48, v49, v83
    v_max_u32 v48, v48, v83
    v_med3_u32 v49, v48, v49, v84
    v_max_u32 v48, v48, v84
    v_med3_u32 v49, v48, v49, v85
    v_max_u32_e64 v48, v48, v85
    v_med3_u32 v49, v48, v49, v86
    v_max_u32_e64 v48, v48, v86
    v_med3_u32 v49, v48, v49, v87
    v_max_u32 v48, v48, v87
    s_nop 0
    v_max_u32_dpp v51, v49, v49 quad_perm:[1,0,3,2] row_mask:0xf bank_mask:0xf
    v_min_u32_dpp v50, v48, v48 quad_perm:[1,0,3,2] row_mask:0xf bank_mask:0xf
    v_max_u32 v49, v50, v51
    v_max_u32_dpp v48, v48, v48 quad_perm:[1,0,3,2] row_mask:0xf bank_mask:0xf
    s_nop 0
    v_max_u32_dpp v51, v49, v49 quad_perm:[2,3,0,1] row_mask:0xf bank_mask:0xf
    v_min_u32_dpp v50, v48, v48 quad_perm:[2,3,0,1] row_mask:0xf bank_mask:0xf
    v_max_u32 v49, v50, v51
    v_max_u32_dpp v48, v48, v48 quad_perm:[2,3,0,1] row_mask:0xf bank_mask:0xf
    s_nop 0
    v_max_u32_dpp v51, v49, v49 row_half_mirror row_mask:0xf bank_mask:0xf
    v_min_u32_dpp v50, v48, v48 row_half_mirror row_mask:0xf bank_mask:0xf
    v_max_u32 v49, v50, v51
    v_max_u32_dpp v48, v48, v48 row_half_mirror row_mask:0xf bank_mask:0xf
    s_nop 0
    v_max_u32_dpp v51, v49, v49 row_mirror row_mask:0xf bank_mask:0xf
    v_min_u32_dpp v50, v48, v48 row_mirror row_mask:0xf bank_mask:0xf
    v_max_u32_e64 v49, v50, v51
    v_max_u32_dpp v48, v48, v48 row_mirror row_mask:0xf bank_mask:0xf
    s_mov_b32 exec_lo, 0x00010001
    s_mov_b32 exec_hi, 0x00010001
    ds_write_b64 v52, v[48:49] offset:128
    s_mov_b64 exec, -1
    s_cmp_lt_u32 s34, 2
    s_cbranch_scc1 L_early_13
    s_mov_b32 s46, 0
L_sp_14:
    ds_read_b32 v48, v3 offset:92
    s_waitcnt lgkmcnt(0)
    v_cmp_gt_u32 vcc, 4, v48
    s_cbranch_vccz L_spd_15
    s_add_u32 s46, s46, 1
    s_sleep 1
    s_cmp_lt_u32 s46, 400000
    s_cbranch_scc1 L_sp_14
    s_branch L_end
    s_nop 0
L_spd_15:
    s_cmp_ge_u32 s21, 6
    s_cbranch_scc1 L_nob_16
    global_load_dwordx4 v[32:35], v2, s[56:57] offset:0 sc1
    global_load_dwordx4 v[36:39], v2, s[56:57] offset:1024 sc1
    global_load_dwordx4 v[40:43], v2, s[56:57] offset:2048 sc1
    global_load_dwordx4 v[44:47], v2, s[56:57] offset:3072 sc1
L_nob_16:
    global_load_dwordx4 v[16:19], v2, s[54:55] offset:0 sc1
    global_load_dwordx4 v[20:23], v2, s[54:55] offset:1024 sc1
    global_load_dwordx4 v[24:27], v2, s[54:55] offset:2048 sc1
    global_load_dwordx4 v[28:31], v2, s[54:55] offset:3072 sc1
L_early_13:
    v_and_b32 v92, 0xffff0000, v60
    v_lshlrev_b32_e64 v88, 16, v60
    v_mul_f32 v92, 0xbf317218, v92
    v_and_b32 v93, 0xffff0000, v62
    v_lshlrev_b32_e64 v89, 16, v62
    v_mul_f32 v93, 0xbf317218, v93
    v_and_b32 v94, 0xffff0000, v64
    v_lshlrev_b32_e64 v90, 16, v64
    v_mul_f32 v94, 0xbf317218, v94
    v_and_b32 v95, 0xffff0000, v66
    v_lshlrev_b32_e64 v91, 16, v66
    v_mul_f32 v95, 0xbf317218, v95
    s_mov_b32 s46, 0
L_pa_17:
    v_mov_b32_e64 v57, 0
    s_cmp_ge_u32 s21, 6
    s_cbranch_scc1 L_nob_19
    s_waitcnt vmcnt(7)
    ds_write_b128 v9, v[32:35] offset:0
    v_bitop3_b32 v57, v57, v32, v12 bitop3:0xf6
    v_bitop3_b32 v57, v57, v34, v14 bitop3:0xf6
    s_waitcnt vmcnt(6)
    ds_write_b128 v9, v[36:39] offset:128
    v_bitop3_b32 v57, v57, v36, v12 bitop3:0xf6
    v_bitop3_b32 v57, v57, v38, v14 bitop3:0xf6
    s_waitcnt vmcnt(5)
    ds_write_b128 v9, v[40:43] offset:256
    v_bitop3_b32 v57, v57, v40, v12 bitop3:0xf6
    v_bitop3_b32 v57, v57, v42, v14 bitop3:0xf6
    s_waitcnt vmcnt(4)
    ds_write_b128 v9, v[44:47] offset:384
    v_bitop3_b32 v57, v57, v44, v12 bitop3:0xf6
    v_bitop3_b32 v57, v57, v46, v14 bitop3:0xf6
L_nob_19:
    s_waitcnt vmcnt(3)
    ds_write_b128 v8, v[16:19] offset:0
    v_bitop3_b32 v57, v57, v16, v12 bitop3:0xf6
    v_bitop3_b32 v57, v57, v18, v14 bitop3:0xf6
    s_waitcnt vmcnt(2)
    ds_write_b128 v8, v[20:23] offset:128
    v_bitop3_b32 v57, v57, v20, v12 bitop3:0xf6
    v_bitop3_b32 v57, v57, v22, v14 bitop3:0xf6
    s_waitcnt vmcnt(1)
    ds_write_b128 v8, v[24:27] offset:256
    v_bitop3_b32 v57, v57, v24, v12 bitop3:0xf6
    v_bitop3_b32 v57, v57, v26, v14 bitop3:0xf6
    s_nop 0
    s_waitcnt vmcnt(0)
    ds_write_b128 v8, v[28:31] offset:384
    v_bitop3_b32 v57, v57, v28, v12 bitop3:0xf6
    v_bitop3_b32 v57, v57, v30, v14 bitop3:0xf6
    v_and_b32 v57, 0x00030003, v57
    v_cmp_ne_u32 vcc, 0, v57
    s_cbranch_vccz L_po_18
    s_cmp_ge_u32 s21, 6
    s_cbranch_scc1 L_nob_20
    global_load_dwordx4 v[32:35], v2, s[56:57] offset:0 sc1
    global_load_dwordx4 v[36:39], v2, s[56:57] offset:1024 sc1
    global_load_dwordx4 v[40:43], v2, s[56:57] offset:2048 sc1
    global_load_dwordx4 v[44:47], v2, s[56:57] offset:3072 sc1
L_nob_20:
    global_load_dwordx4 v[16:19], v2, s[54:55] offset:0 sc1
    global_load_dwordx4 v[20:23], v2, s[54:55] offset:1024 sc1
    global_load_dwordx4 v[24:27], v2, s[54:55] offset:2048 sc1
    global_load_dwordx4 v[28:31], v2, s[54:55] offset:3072 sc1
    s_add_u32 s46, s46, 1
    s_cmp_lt_u32 s46, 50000
    s_cbranch_scc1 L_pa_17
    s_branch L_end
    s_nop 0
L_po_18:
    v_and_b32 v57, 8, v10
    s_mov_b64 exec, 1
    ds_add_u32 v57, v76 offset:48
    s_mov_b64 exec, -1
    s_setprio 0
    ds_read_b64 v[112:113], v6 offset:0
    ds_read_b64 v[114:115], v6 offset:4624
    ds_read_b64 v[116:117], v6 offset:9248
    ds_read_b64 v[118:119], v6 offset:13872
    ds_read_b64 v[120:121], v6 offset:18496
    ds_read_b64 v[122:123], v6 offset:23120
    ds_read_b64 v[124:125], v6 offset:27744
    ds_read_b64 v[126:127], v6 offset:32368
    s_mov_b32 s46, 0
L_sp_21:
    ds_read_b128 v[80:83], v3 offset:0
    ds_read_b128 v[84:87], v3 offset:16
    s_waitcnt lgkmcnt(0)
    v_min3_u32 v96, v80, v81, v82
    v_min3_u32 v96, v96, v83, v84
    v_min3_u32 v96, v96, v85, v86
    v_min_u32 v96, v96, v87
    v_cmp_eq_u32 vcc, 0, v96
    s_cbranch_vccz L_spd_22
    s_add_u32 s46, s46, 1
    s_sleep 1
    s_cmp_lt_u32 s46, 400000
    s_cbranch_scc1 L_sp_21
    s_branch L_end
L_spd_22:
    v_exp_f16 v96, v112
    v_exp_f16_sdwa v97, v112 dst_sel:DWORD dst_unused:UNUSED_PAD src0_sel:WORD_1
    v_exp_f16_e64 v98, v113
    v_exp_f16_sdwa v99, v113 dst_sel:DWORD dst_unused:UNUSED_PAD src0_sel:WORD_1
    v_fma_mix_f32 v96, v96, v80, v80 op_sel:[0,0,0] op_sel_hi:[1,0,0]
    v_fma_mix_f32 v97, v97, v80, v80 op_sel:[0,0,0] op_sel_hi:[1,0,0]
    v_fma_mix_f32 v98, v98, v80, v80 op_sel:[0,0,0] op_sel_hi:[1,0,0]
    v_fma_mix_f32 v99, v99, v80, v80 op_sel:[0,0,0] op_sel_hi:[1,0,0]
    v_rcp_f32 v16, v96
    v_rcp_f32 v17, v97
    v_rcp_f32 v18, v98
    v_rcp_f32 v19, v99
    v_exp_f16 v96, v114
    v_exp_f16_sdwa v97, v114 dst_sel:DWORD dst_unused:UNUSED_PAD src0_sel:WORD_1
    v_exp_f16 v98, v115
    v_exp_f16_sdwa v99, v115 dst_sel:DWORD dst_unused:UNUSED_PAD src0_sel:WORD_1
    v_fma_mix_f32 v96, v96, v81, v81 op_sel:[0,0,0] op_sel_hi:[1,0,0]
    v_fma_mix_f32 v97, v97, v81, v81 op_sel:[0,0,0] op_sel_hi:[1,0,0]
    v_fma_mix_f32 v98, v98, v81, v81 op_sel:[0,0,0] op_sel_hi:[1,0,0]
    v_fma_mix_f32 v99, v99, v81, v81 op_sel:[0,0,0] op_sel_hi:[1,0,0]
    v_rcp_f32 v20, v96
    v_rcp_f32 v21, v97
    v_rcp_f32 v22, v98
    v_rcp_f32 v23, v99
    v_exp_f16_e64 v96, v116
    v_exp_f16_sdwa v97, v116 dst_sel:DWORD dst_unused:UNUSED_PAD src0_sel:WORD_1
    v_exp_f16_e64 v98, v117
    v_exp_f16_sdwa v99, v117 dst_sel:DWORD dst_unused:UNUSED_PAD src0_sel:WORD_1
    v_fma_mix_f32 v96, v96, v82, v82 op_sel:[0,0,0] op_sel_hi:[1,0,0]
    v_fma_mix_f32 v97, v97, v82, v82 op_sel:[0,0,0] op_sel_hi:[1,0,0]
    v_fma_mix_f32 v98, v98, v82, v82 op_sel:[0,0,0] op_sel_hi:[1,0,0]
    v_fma_mix_f32 v99, v99, v82, v82 op_sel:[0,0,0] op_sel_hi:[1,0,0]
    v_rcp_f32 v24, v96
    v_rcp_f32 v25, v97
    v_rcp_f32 v26, v98
    v_rcp_f32 v27, v99
    v_exp_f16_e64 v96, v118
    v_exp_f16_sdwa v97, v118 dst_sel:DWORD dst_unused:UNUSED_PAD src0_sel:WORD_1
    v_exp_f16_e64 v98, v119
    v_exp_f16_sdwa v99, v119 dst_sel:DWORD dst_unused:UNUSED_PAD src0_sel:WORD_1
    v_fma_mix_f32 v96, v96, v83, v83 op_sel:[0,0,0] op_sel_hi:[1,0,0]
    v_fma_mix_f32 v97, v97, v83, v83 op_sel:[0,0,0] op_sel_hi:[1,0,0]
    v_fma_mix_f32 v98, v98, v83, v83 op_sel:[0,0,0] op_sel_hi:[1,0,0]
    v_fma_mix_f32 v99, v99, v83, v83 op_sel:[0,0,0] op_sel_hi:[1,0,0]
    v_rcp_f32 v28, v96
    v_rcp_f32 v29, v97
    v_rcp_f32 v30, v98
    v_rcp_f32 v31, v99
    v_exp_f16_e64 v96, v120
    v_exp_f16_sdwa v97, v120 dst_sel:DWORD dst_unused:UNUSED_PAD src0_sel:WORD_1
    v_exp_f16_e64 v98, v121
    v_exp_f16_sdwa v99, v121 dst_sel:DWORD dst_unused:UNUSED_PAD src0_sel:WORD_1
    v_fma_mix_f32 v96, v96, v84, v84 op_sel:[0,0,0] op_sel_hi:[1,0,0]
    v_fma_mix_f32 v97, v97, v84, v84 op_sel:[0,0,0] op_sel_hi:[1,0,0]
    v_fma_mix_f32 v98, v98, v84, v84 op_sel:[0,0,0] op_sel_hi:[1,0,0]
    v_fma_mix_f32 v99, v99, v84, v84 op_sel:[0,0,0] op_sel_hi:[1,0,0]
    v_rcp_f32 v32, v96
    v_rcp_f32 v33, v97
    v_rcp_f32 v34, v98
    v_rcp_f32 v35, v99
    v_exp_f16_e64 v96, v122
    v_exp_f16_sdwa v97, v122 dst_sel:DWORD dst_unused:UNUSED_PAD src0_sel:WORD_1
    v_exp_f16_e64 v98, v123
    v_exp_f16_sdwa v99, v123 dst_sel:DWORD dst_unused:UNUSED_PAD src0_sel:WORD_1
    v_fma_mix_f32 v96, v96, v85, v85 op_sel:[0,0,0] op_sel_hi:[1,0,0]
    v_fma_mix_f32 v97, v97, v85, v85 op_sel:[0,0,0] op_sel_hi:[1,0,0]
    v_fma_mix_f32 v98, v98, v85, v85 op_sel:[0,0,0] op_sel_hi:[1,0,0]
    v_fma_mix_f32 v99, v99, v85, v85 op_sel:[0,0,0] op_sel_hi:[1,0,0]
    v_rcp_f32 v36, v96
    v_rcp_f32 v37, v97
    v_rcp_f32 v38, v98
    v_rcp_f32 v39, v99
    v_exp_f16_e64 v96, v124
    v_exp_f16_sdwa v97, v124 dst_sel:DWORD dst_unused:UNUSED_PAD src0_sel:WORD_1
    v_exp_f16_e64 v98, v125
    v_exp_f16_sdwa v99, v125 dst_sel:DWORD dst_unused:UNUSED_PAD src0_sel:WORD_1
    v_fma_mix_f32 v96, v96, v86, v86 op_sel:[0,0,0] op_sel_hi:[1,0,0]
    v_fma_mix_f32 v97, v97, v86, v86 op_sel:[0,0,0] op_sel_hi:[1,0,0]
    v_fma_mix_f32 v98, v98, v86, v86 op_sel:[0,0,0] op_sel_hi:[1,0,0]
    v_fma_mix_f32 v99, v99, v86, v86 op_sel:[0,0,0] op_sel_hi:[1,0,0]
    v_rcp_f32 v40, v96
    v_rcp_f32 v41, v97
    v_rcp_f32 v42, v98
    v_rcp_f32 v43, v99
    v_exp_f16_e64 v96, v126
    v_exp_f16_sdwa v97, v126 dst_sel:DWORD dst_unused:UNUSED_PAD src0_sel:WORD_1
    v_exp_f16_e64 v98, v127
    v_exp_f16_sdwa v99, v127 dst_sel:DWORD dst_unused:UNUSED_PAD src0_sel:WORD_1
    v_fma_mix_f32 v96, v96, v87, v87 op_sel:[0,0,0] op_sel_hi:[1,0,0]
    v_fma_mix_f32 v97, v97, v87, v87 op_sel:[0,0,0] op_sel_hi:[1,0,0]
    v_fma_mix_f32 v98, v98, v87, v87 op_sel:[0,0,0] op_sel_hi:[1,0,0]
    v_fma_mix_f32 v99, v99, v87, v87 op_sel:[0,0,0] op_sel_hi:[1,0,0]
    v_rcp_f32 v44, v96
    v_rcp_f32 v45, v97
    v_rcp_f32_e64 v46, v98
    v_rcp_f32_e64 v47, v99
    s_mov_b32 s46, 0
L_sp_23:
    ds_read_b64 v[100:101], v3 offset:32
    s_waitcnt lgkmcnt(0)
    v_cmp_eq_u32 vcc, 0, v100
    s_cbranch_vccz L_spd_24
    s_add_u32 s46, s46, 1
    s_sleep 1
    s_cmp_lt_u32 s46, 400000
    s_cbranch_scc1 L_sp_23
    s_branch L_end
L_spd_24:
    s_mov_b64 s[4:5], -1
    s_mov_b64 s[6:7], -1
    s_mov_b64 s[8:9], -1
    s_mov_b64 s[10:11], -1
    v_readfirstlane_b32 s40, v100
    s_andn2_b32 s40, 2047, s40
    s_lshr_b32 s41, s40, 8
    s_cmp_lg_u32 s41, s20
    s_cbranch_scc1 L_nomk_25
    s_bfe_u32 s41, s40, 0x20002
    s_bfe_u32 s42, s40, 0x40004
    s_lshl4_add_u32 s41, s41, s42
    s_lshl_b64 s[42:43], 1, s41
    s_and_b32 s40, s40, 3
    s_cmp_eq_u32 s40, 0
    s_cselect_b64 s[44:45], s[42:43], 0
    s_andn2_b64 s[4:5], s[4:5], s[44:45]
    s_cmp_eq_u32 s40, 1
    s_cselect_b64 s[44:45], s[42:43], 0
    s_andn2_b64 s[6:7], s[6:7], s[44:45]
    s_cmp_eq_u32 s40, 2
    s_cselect_b64 s[44:45], s[42:43], 0
    s_andn2_b64 s[8:9], s[8:9], s[44:45]
    s_cmp_eq_u32 s40, 3
    s_cselect_b64 s[44:45], s[42:43], 0
    s_andn2_b64 s[10:11], s[10:11], s[44:45]
L_nomk_25:
    v_readfirstlane_b32 s40, v101
    s_andn2_b32 s40, 2047, s40
    s_lshr_b32 s41, s40, 8
    s_cmp_lg_u32 s41, s20
    s_cbranch_scc1 L_nomk_26
    s_bfe_u32 s41, s40, 0x20002
    s_bfe_u32 s42, s40, 0x40004
    s_lshl4_add_u32 s41, s41, s42
    s_lshl_b64 s[42:43], 1, s41
    s_and_b32 s40, s40, 3
    s_cmp_eq_u32 s40, 0
    s_cselect_b64 s[44:45], s[42:43], 0
    s_andn2_b64 s[4:5], s[4:5], s[44:45]
    s_cmp_eq_u32 s40, 1
    s_cselect_b64 s[44:45], s[42:43], 0
    s_andn2_b64 s[6:7], s[6:7], s[44:45]
    s_cmp_eq_u32 s40, 2
    s_cselect_b64 s[44:45], s[42:43], 0
    s_andn2_b64 s[8:9], s[8:9], s[44:45]
    s_cmp_eq_u32 s40, 3
    s_cselect_b64 s[44:45], s[42:43], 0
    s_andn2_b64 s[10:11], s[10:11], s[44:45]
L_nomk_26:
    s_setprio 1
    s_mov_b32 s46, 0
L_sp_27:
    ds_read_b32 v96, v10 offset:64
    s_waitcnt lgkmcnt(0)
    v_cmp_gt_u32 vcc, 8, v96
    s_cbranch_vccz L_spd_28
    s_add_u32 s46, s46, 1
    s_sleep 1
    s_cmp_lt_u32 s46, 400000
    s_cbranch_scc1 L_sp_27
    s_branch L_end
    s_nop 0
L_spd_28:
    ds_read_b64 v[48:49], v5 offset:0
    ds_read_b64 v[50:51], v5 offset:14416
    ds_read_b64 v[52:53], v5 offset:28832
    ds_read_b64 v[54:55], v5 offset:43248
    ds_read_b64 v[56:57], v11 offset:0
    ds_read_b64 v[58:59], v11 offset:14416
    ds_read_b64 v[60:61], v11 offset:28832
    ds_read_b64 v[62:63], v11 offset:43248
    s_waitcnt lgkmcnt(6)
    v_fma_mix_f32 v16, v48, v16, v92 op_sel:[0,0,0] op_sel_hi:[1,0,0]
    v_fma_mix_f32 v20, v50, v20, v92 op_sel:[0,0,0] op_sel_hi:[1,0,0]
    s_waitcnt lgkmcnt(4)
    v_fma_mix_f32 v24, v52, v24, v92 op_sel:[0,0,0] op_sel_hi:[1,0,0]
    v_fma_mix_f32 v28, v54, v28, v92 op_sel:[0,0,0] op_sel_hi:[1,0,0]
    s_waitcnt lgkmcnt(2)
    v_fma_mix_f32 v32, v56, v32, v92 op_sel:[0,0,0] op_sel_hi:[1,0,0]
    v_fma_mix_f32 v36, v58, v36, v92 op_sel:[0,0,0] op_sel_hi:[1,0,0]
    s_waitcnt lgkmcnt(0)
    v_fma_mix_f32 v40, v60, v40, v92 op_sel:[0,0,0] op_sel_hi:[1,0,0]
    v_fma_mix_f32 v44, v62, v44, v92 op_sel:[0,0,0] op_sel_hi:[1,0,0]
    v_fma_mix_f32 v16, v112, v16, v88 op_sel:[0,0,0] op_sel_hi:[1,0,0]
    v_fma_mix_f32 v20, v114, v20, v88 op_sel:[0,0,0] op_sel_hi:[1,0,0]
    v_fma_mix_f32 v24, v116, v24, v88 op_sel:[0,0,0] op_sel_hi:[1,0,0]
    v_fma_mix_f32 v28, v118, v28, v88 op_sel:[0,0,0] op_sel_hi:[1,0,0]
    v_fma_mix_f32 v32, v120, v32, v88 op_sel:[0,0,0] op_sel_hi:[1,0,0]
    v_fma_mix_f32 v36, v122, v36, v88 op_sel:[0,0,0] op_sel_hi:[1,0,0]
    v_fma_mix_f32 v40, v124, v40, v88 op_sel:[0,0,0] op_sel_hi:[1,0,0]
    v_fma_mix_f32 v44, v126, v44, v88 op_sel:[0,0,0] op_sel_hi:[1,0,0]
    v_cvt_pk_bf16_f32 v64, v16, v20
    v_cvt_pk_bf16_f32 v65, v24, v28
    v_cvt_pk_bf16_f32 v66, v32, v36
    v_cvt_pk_bf16_f32 v67, v40, v44
    s_mov_b64 exec, s[4:5]
    global_store_dwordx4 v4, v[64:67], s[28:29] offset:-4096
    s_mov_b64 exec, -1
    v_fma_mix_f32 v17, v48, v17, v93 op_sel:[1,0,0] op_sel_hi:[1,0,0]
    v_fma_mix_f32 v21, v50, v21, v93 op_sel:[1,0,0] op_sel_hi:[1,0,0]
    v_fma_mix_f32 v25, v52, v25, v93 op_sel:[1,0,0] op_sel_hi:[1,0,0]
    v_fma_mix_f32 v29, v54, v29, v93 op_sel:[1,0,0] op_sel_hi:[1,0,0]
    v_fma_mix_f32 v33, v56, v33, v93 op_sel:[1,0,0] op_sel_hi:[1,0,0]
    v_fma_mix_f32 v37, v58, v37, v93 op_sel:[1,0,0] op_sel_hi:[1,0,0]
    v_fma_mix_f32 v41, v60, v41, v93 op_sel:[1,0,0] op_sel_hi:[1,0,0]
    v_fma_mix_f32 v45, v62, v45, v93 op_sel:[1,0,0] op_sel_hi:[1,0,0]
    v_fma_mix_f32 v17, v112, v17, v89 op_sel:[1,0,0] op_sel_hi:[1,0,0]
    v_fma_mix_f32 v21, v114, v21, v89 op_sel:[1,0,0] op_sel_hi:[1,0,0]
    v_fma_mix_f32 v25, v116, v25, v89 op_sel:[1,0,0] op_sel_hi:[1,0,0]
    v_fma_mix_f32 v29, v118, v29, v89 op_sel:[1,0,0] op_sel_hi:[1,0,0]
    v_fma_mix_f32 v33, v120, v33, v89 op_sel:[1,0,0] op_sel_hi:[1,0,0]
    v_fma_mix_f32 v37, v122, v37, v89 op_sel:[1,0,0] op_sel_hi:[1,0,0]
    v_fma_mix_f32 v41, v124, v41, v89 op_sel:[1,0,0] op_sel_hi:[1,0,0]
    v_fma_mix_f32 v45, v126, v45, v89 op_sel:[1,0,0] op_sel_hi:[1,0,0]
    v_cvt_pk_bf16_f32 v68, v17, v21
    v_cvt_pk_bf16_f32 v69, v25, v29
    v_cvt_pk_bf16_f32 v70, v33, v37
    v_cvt_pk_bf16_f32 v71, v41, v45
    s_mov_b64 exec, s[6:7]
    global_store_dwordx4 v4, v[68:71], s[28:29] offset:-2048
    s_mov_b64 exec, -1
    v_fma_mix_f32 v18, v49, v18, v94 op_sel:[0,0,0] op_sel_hi:[1,0,0]
    v_fma_mix_f32 v22, v51, v22, v94 op_sel:[0,0,0] op_sel_hi:[1,0,0]
    v_fma_mix_f32 v26, v53, v26, v94 op_sel:[0,0,0] op_sel_hi:[1,0,0]
    v_fma_mix_f32 v30, v55, v30, v94 op_sel:[0,0,0] op_sel_hi:[1,0,0]
    v_fma_mix_f32 v34, v57, v34, v94 op_sel:[0,0,0] op_sel_hi:[1,0,0]
    v_fma_mix_f32 v38, v59, v38, v94 op_sel:[0,0,0] op_sel_hi:[1,0,0]
    v_fma_mix_f32 v42, v61, v42, v94 op_sel:[0,0,0] op_sel_hi:[1,0,0]
    v_fma_mix_f32 v46, v63, v46, v94 op_sel:[0,0,0] op_sel_hi:[1,0,0]
    v_fma_mix_f32 v18, v113, v18, v90 op_sel:[0,0,0] op_sel_hi:[1,0,0]
    v_fma_mix_f32 v22, v115, v22, v90 op_sel:[0,0,0] op_sel_hi:[1,0,0]
    v_fma_mix_f32 v26, v117, v26, v90 op_sel:[0,0,0] op_sel_hi:[1,0,0]
    v_fma_mix_f32 v30, v119, v30, v90 op_sel:[0,0,0] op_sel_hi:[1,0,0]
    v_fma_mix_f32 v34, v121, v34, v90 op_sel:[0,0,0] op_sel_hi:[1,0,0]
    v_fma_mix_f32 v38, v123, v38, v90 op_sel:[0,0,0] op_sel_hi:[1,0,0]
    v_fma_mix_f32 v42, v125, v42, v90 op_sel:[0,0,0] op_sel_hi:[1,0,0]
    v_fma_mix_f32 v46, v127, v46, v90 op_sel:[0,0,0] op_sel_hi:[1,0,0]
    v_cvt_pk_bf16_f32 v72, v18, v22
    v_cvt_pk_bf16_f32 v73, v26, v30
    v_cvt_pk_bf16_f32 v74, v34, v38
    v_cvt_pk_bf16_f32 v75, v42, v46
    s_mov_b64 exec, s[8:9]
    global_store_dwordx4 v4, v[72:75], s[28:29] offset:0
    s_mov_b64 exec, -1
    v_fma_mix_f32 v19, v49, v19, v95 op_sel:[1,0,0] op_sel_hi:[1,0,0]
    v_fma_mix_f32 v23, v51, v23, v95 op_sel:[1,0,0] op_sel_hi:[1,0,0]
    v_fma_mix_f32 v27, v53, v27, v95 op_sel:[1,0,0] op_sel_hi:[1,0,0]
    v_fma_mix_f32 v31, v55, v31, v95 op_sel:[1,0,0] op_sel_hi:[1,0,0]
    v_fma_mix_f32 v35, v57, v35, v95 op_sel:[1,0,0] op_sel_hi:[1,0,0]
    v_fma_mix_f32 v39, v59, v39, v95 op_sel:[1,0,0] op_sel_hi:[1,0,0]
    v_fma_mix_f32 v43, v61, v43, v95 op_sel:[1,0,0] op_sel_hi:[1,0,0]
    v_fma_mix_f32 v47, v63, v47, v95 op_sel:[1,0,0] op_sel_hi:[1,0,0]
    v_fma_mix_f32 v19, v113, v19, v91 op_sel:[1,0,0] op_sel_hi:[1,0,0]
    v_fma_mix_f32 v23, v115, v23, v91 op_sel:[1,0,0] op_sel_hi:[1,0,0]
    v_fma_mix_f32 v27, v117, v27, v91 op_sel:[1,0,0] op_sel_hi:[1,0,0]
    v_fma_mix_f32 v31, v119, v31, v91 op_sel:[1,0,0] op_sel_hi:[1,0,0]
    v_fma_mix_f32 v35, v121, v35, v91 op_sel:[1,0,0] op_sel_hi:[1,0,0]
    v_fma_mix_f32 v39, v123, v39, v91 op_sel:[1,0,0] op_sel_hi:[1,0,0]
    v_fma_mix_f32 v43, v125, v43, v91 op_sel:[1,0,0] op_sel_hi:[1,0,0]
    v_fma_mix_f32 v47, v127, v47, v91 op_sel:[1,0,0] op_sel_hi:[1,0,0]
    v_cvt_pk_bf16_f32 v76, v19, v23
    v_cvt_pk_bf16_f32 v77, v27, v31
    v_cvt_pk_bf16_f32 v78, v35, v39
    v_cvt_pk_bf16_f32 v79, v43, v47
    s_mov_b64 exec, s[10:11]
    global_store_dwordx4 v4, v[76:79], s[28:29] offset:2048
    s_mov_b64 exec, -1
    s_or_b32 s40, s2, s3
    s_cbranch_scc1 L_fin
    s_add_u32 s40, s47, 1
    v_mov_b32 v5, s40
    s_mov_b64 exec, 1
    global_store_dword v3, v5, s[32:33]
    s_branch L_fin
    s_nop 0
L_exp:
    v_lshrrev_b32 v20, 4, v1
    v_and_b32 v21, 240, v2
    v_lshrrev_b32_e64 v22, 5, v1
    v_and_b32_e64 v23, 1, v20
    v_lshl_add_u32 v4, v22, 4, v23
    v_mul_u32_u24 v4, 7168, v4
    v_add_u32 v4, v4, v21
    s_bitcmp1_b32 s35, 0
    s_cselect_b64 s[48:49], s[24:25], s[22:23]
    s_lshr_b32 s40, s35, 1
    s_lshl2_add_u32 s40, s40, s34
    s_lshl_b32 s43, s40, 7
    s_mul_i32 s40, s40, 458752
    s_mul_i32 s41, s36, 37
    s_lshr_b32 s41, s41, 8
    s_mul_i32 s42, s41, 7
    s_sub_u32 s7, s36, s42
    s_lshl_b32 s41, s41, 2
    s_lshr_b32 s41, 0x2031, s41
    s_and_b32 s41, s41, 3
    s_lshl2_add_u32 s7, s7, s41
    s_lshl_b32 s41, s7, 8
    s_add_u32 s40, s40, s41
    s_add_u32 s48, s48, s40
    s_addc_u32 s49, s49, 0
    s_add_u32 s10, s48, 229376
    s_addc_u32 s11, s49, 0
    v_lshl_add_u32 v5, v22, 3, v23
    v_lshl_add_u32 v5, v5, 11, v21
    v_lshrrev_b32 v19, 1, v21
    v_and_b32 v23, 3, v1
    v_mul_u32_u24 v14, 0x5555, v23
    v_lshlrev_b32 v23, 3, v23
    v_lshl_add_u32 v17, v20, 5, v23
    v_and_b32 v22, 8, v1
    v_lshl_add_u32 v11, v22, 6, v17
    v_bfe_i32 v9, v1, 2, 1
    v_lshrrev_b32 v7, 16, v9
    v_lshlrev_b32 v9, 16, v9
    v_xor_b32 v6, 0xffff, v7
    v_xor_b32 v8, 0xffff0000, v9
    v_and_b32 v23, 512, v2
    v_lshl_add_u32 v23, v21, 1, v23
    v_and_b32 v22, 16, v1
    s_lshl_b32 s40, s34, 10
    v_add3_u32 v10, v22, v23, s40
    v_add_u32 v17, s43, v17
    s_add_u32 s30, s32, 32768
    s_addc_u32 s31, s33, 0
    s_lshl2_add_u32 s40, s7, s34
    s_lshl_b32 s40, s40, 16
    s_lshl_b32 s41, s35, 8
    s_add_u32 s40, s40, s41
    s_add_u32 s40, s40, 4096
    s_add_u32 s50, s26, s40
    s_addc_u32 s51, s27, 0
    s_add_u32 s52, s50, 32768
    s_addc_u32 s53, s51, 0
    s_add_u32 s74, s50, 8192
    s_addc_u32 s75, s51, 0
    s_add_u32 s76, s52, 8192
    s_addc_u32 s77, s53, 0
    s_lshl_b32 s40, s2, 7
    s_add_u32 s40, s40, 98304
    s_add_u32 s54, s32, s40
    s_addc_u32 s55, s33, 0
    s_lshl_b32 s40, s36, 10
    s_lshl2_add_u32 s40, s35, s40
    s_add_u32 s40, s40, 98304
    s_add_u32 s56, s32, s40
    s_addc_u32 s57, s33, 0
    s_lshl_b32 s40, s2, 10
    s_add_u32 s40, s40, 131072
    s_add_u32 s58, s32, s40
    s_addc_u32 s59, s33, 0
    s_lshl_b32 s40, s36, 13
    s_lshl_b32 s41, s34, 7
    s_add_u32 s40, s40, s41
    s_add_u32 s40, s40, 135168
    s_add_u32 s60, s32, s40
    s_addc_u32 s61, s33, 0
    s_mul_i32 s40, s35, 28
    s_add_u32 s40, s40, s36
    s_lshl_b32 s40, s40, 10
    s_add_u32 s40, s40, 524288
    s_add_u32 s62, s32, s40
    s_addc_u32 s63, s33, 0
    s_setprio 3
    s_lshl_b32 s40, s34, 7
    v_mov_b32 v16, s40
    s_mov_b32 s46, 0
L_sp_29:
    ds_read_b64 v[22:23], v3 offset:40
    s_waitcnt lgkmcnt(0)
    v_cmp_eq_u32_e64 vcc, 0, v23
    s_cbranch_vccz L_spd_30
    s_add_u32 s46, s46, 1
    s_cmp_lt_u32 s46, 400000
    s_cbranch_scc1 L_sp_29
    s_branch L_end
L_spd_30:
    v_readfirstlane_b32 s39, v22
    s_and_b32 s40, s39, 1
    s_mul_i32 s40, s40, 0x01010101
    s_and_b32 s41, s39, 0xfefefefe
    s_or_b32 s41, s41, s40
    v_bfe_u32 v28, s41, v11, 8
    v_lshrrev_b32 v29, v2, s41
    v_lshrrev_b32 v30, 8, v29
    s_cmp_ge_u32 s36, 28
    s_cbranch_scc1 L_noexp
    global_load_dwordx4 v[32:35], v4, s[48:49] nt
    s_add_u32 s48, s48, 14336
    s_addc_u32 s49, s49, 0
    global_load_dwordx4 v[36:39], v4, s[10:11] nt
    s_add_u32 s10, s10, 14336
    s_addc_u32 s11, s11, 0
    s_cmp_lg_u32 s34, 0
    s_cbranch_scc1 L_warm_31
    s_load_dword s8, s[54:55], 0 glc
L_warm_31:
    v_and_b32 v18, 128, v2
    v_lshl_add_u32 v18, v16, 1, v18
    global_load_dword v31, v18, s[62:63]
    s_nop 0
    s_waitcnt vmcnt(2)
    global_load_dwordx4 v[40:43], v4, s[48:49] nt
    s_add_u32 s48, s48, 14336
    s_addc_u32 s49, s49, 0
    s_waitcnt vmcnt(2)
    global_load_dwordx4 v[44:47], v4, s[10:11] nt
    s_add_u32 s10, s10, 14336
    s_addc_u32 s11, s11, 0
    s_waitcnt vmcnt(1)
    global_load_dwordx4 v[48:51], v4, s[48:49] nt
    s_add_u32 s48, s48, 14336
    s_addc_u32 s49, s49, 0
    s_waitcnt vmcnt(1)
    global_load_dwordx4 v[52:55], v4, s[10:11] nt
    s_add_u32 s10, s10, 14336
    s_addc_u32 s11, s11, 0
    s_waitcnt vmcnt(2)
    global_load_dwordx4 v[56:59], v4, s[48:49] nt
    s_add_u32 s48, s48, 14336
    s_addc_u32 s49, s49, 0
    s_waitcnt vmcnt(3)
    global_load_dwordx4 v[60:63], v4, s[10:11] nt
    s_add_u32 s10, s10, 14336
    s_addc_u32 s11, s11, 0
    s_waitcnt vmcnt(4)
    global_load_dwordx4 v[64:67], v4, s[48:49] nt
    s_add_u32 s48, s48, 14336
    s_addc_u32 s49, s49, 0
    s_waitcnt vmcnt(5)
    global_load_dwordx4 v[68:71], v4, s[10:11] nt
    s_add_u32 s10, s10, 14336
    s_addc_u32 s11, s11, 0
    s_waitcnt vmcnt(5)
    global_load_dwordx4 v[72:75], v4, s[48:49] nt
    s_add_u32 s48, s48, 14336
    s_addc_u32 s49, s49, 0
    s_waitcnt vmcnt(5)
    global_load_dwordx4 v[76:79], v4, s[10:11] nt
    s_add_u32 s10, s10, 14336
    s_addc_u32 s11, s11, 0
    s_mov_b32 s46, 0
L_sp_32:
    ds_read_b64 v[24:25], v19 offset:128
    s_waitcnt lgkmcnt(0)
    v_cmp_eq_u32 vcc, 0, v24
    s_cbranch_vccz L_spd_33
    s_add_u32 s46, s46, 1
    s_sleep 1
    s_cmp_lt_u32 s46, 400000
    s_cbranch_scc1 L_sp_32
    s_branch L_end
    s_nop 0
L_spd_33:
    v_max_u32_dpp v27, v25, v25 quad_perm:[1,0,3,2] row_mask:0xf bank_mask:0xf
    v_min_u32_dpp v26, v24, v24 quad_perm:[1,0,3,2] row_mask:0xf bank_mask:0xf
    v_max_u32 v25, v26, v27
    v_max_u32_dpp v24, v24, v24 quad_perm:[1,0,3,2] row_mask:0xf bank_mask:0xf
    s_nop 0
    v_max_u32_dpp v27, v25, v25 quad_perm:[2,3,0,1] row_mask:0xf bank_mask:0xf
    v_min_u32_dpp v26, v24, v24 quad_perm:[2,3,0,1] row_mask:0xf bank_mask:0xf
    v_max_u32 v25, v26, v27
    v_max_u32_dpp v24, v24, v24 quad_perm:[2,3,0,1] row_mask:0xf bank_mask:0xf
    s_nop 0
    v_max_u32_dpp v27, v25, v25 row_half_mirror row_mask:0xf bank_mask:0xf
    v_min_u32_dpp v26, v24, v24 row_half_mirror row_mask:0xf bank_mask:0xf
    v_max_u32 v25, v26, v27
    v_max_u32_dpp v24, v24, v24 row_half_mirror row_mask:0xf bank_mask:0xf
    s_nop 0
    v_max_u32_dpp v27, v25, v25 row_mirror row_mask:0xf bank_mask:0xf
    v_min_u32_dpp v26, v24, v24 row_mirror row_mask:0xf bank_mask:0xf
    v_max_u32_e64 v25, v26, v27
    v_max_u32_dpp v24, v24, v24 row_mirror row_mask:0xf bank_mask:0xf
    s_mov_b32 vcc_lo, 0xff00ff00
    s_mov_b32 vcc_hi, 0xff00ff00
    s_movk_i32 s40, 2047
    v_cndmask_b32 v16, v24, v25, vcc
    v_bfi_b32 v18, v16, 0, s40
    v_lshl_add_u32 v17, v18, 11, v17
    v_lshlrev_b32_e64 v18, 3, v18
    global_load_dwordx2 v[20:21], v17, s[4:5]
    global_load_dword v22, v18, s[30:31] sc1
    v_mov_b32_e64 v0, 1
    s_mov_b64 exec, 1
    ds_add_u32 v3, v0 offset:92
    s_mov_b64 exec, -1
    global_load_dwordx4 v[80:83], v4, s[48:49] nt
    s_add_u32 s48, s48, 14336
    s_addc_u32 s49, s49, 0
    global_load_dwordx4 v[84:87], v4, s[10:11] nt
    s_add_u32 s10, s10, 14336
    s_addc_u32 s11, s11, 0
    global_load_dwordx4 v[88:91], v4, s[48:49] nt
    global_load_dwordx4 v[92:95], v4, s[10:11] nt
    s_mov_b64 exec, 1
    ds_write_b64 v3, v[24:25] offset:32
    s_mov_b64 exec, -1
    v_readfirstlane_b32 s16, v24
    v_readfirstlane_b32 s17, v25
    s_cmp_eq_u32 s34, 0
    s_cselect_b32 s16, s16, s17
    s_andn2_b32 s17, 2047, s16
    s_lshr_b32 s40, s17, 8
    s_add_u32 s41, s40, 2
    s_bfe_u32 s19, s41, 0x10002
    s_xor_b32 s19, s19, s38
    s_and_b32 s42, s34, 2
    s_or_b32 s19, s19, s42
    s_cmp_eq_u32 s38, 0
    s_cselect_b32 s18, s40, s41
    s_and_b32 s18, s18, 3
    s_mul_i32 s40, s35, 28672
    s_and_b32 s41, s34, 1
    s_lshl_b32 s41, s41, 9
    s_add_u32 s40, s40, s41
    s_and_b32 s41, s36, 15
    s_lshl_b32 s41, s41, 5
    s_add_u32 s40, s40, s41
    s_add_u32 s40, s40, 524288
    s_add_u32 s22, s32, s40
    s_addc_u32 s23, s33, 0
    s_add_u32 s24, s22, 262144
    s_nop 0
    s_addc_u32 s25, s23, 0
    s_bfe_u32 s40, s17, 0x20002
    s_bfe_u32 s41, s17, 0x40004
    s_lshl4_add_u32 s40, s40, s41
    s_and_b32 s41, s17, 3
    s_lshl2_add_u32 s40, s40, s41
    s_lshl_b32 s41, s18, 8
    s_add_u32 s40, s40, s41
    s_lshl_b32 s40, s40, 1
    s_add_u32 s20, s40, 52096
    s_bitcmp1_b32 s16, 31
    s_brev_b32 s40, 1
    s_cselect_b32 s40, s40, -1
    s_xor_b32 s40, s40, s16
    s_and_b32 s21, s40, 0xffff0000
    v_mov_b32 v0, 1
    s_waitcnt vmcnt(4)
    v_and_b32 v17, 0xffff0000, v22
    v_rcp_f32 v17, v17
    v_lshlrev_b32 v22, 16, v22
    v_lshlrev_b32_e64 v24, 16, v20
    v_and_b32 v25, 0xffff0000, v20
    v_mul_f32 v22, -v22, v17
    v_lshlrev_b32_e64 v26, 16, v21
    v_and_b32 v27, 0xffff0000, v21
    v_fma_f32 v24, v24, v17, v22
    v_fma_f32 v25, v25, v17, v22
    v_fma_f32 v26, v26, v17, v22
    v_fma_f32 v27, v27, v17, v22
    v_cvt_pk_bf16_f32 v12, v24, v25
    v_cvt_pk_bf16_f32 v13, v26, v27
    v_mov_b32 v24, 0
    v_mov_b32 v25, 0
    v_mov_b32 v26, 0
    v_mov_b32 v27, 0
    v_and_b32_dpp v16, v12, v6 quad_perm:[0,0,0,0] row_mask:0xf bank_mask:0xf
    v_and_b32_dpp v17, v12, v7 quad_perm:[0,0,0,0] row_mask:0xf bank_mask:0xf
    v_and_b32_dpp v18, v12, v8 quad_perm:[0,0,0,0] row_mask:0xf bank_mask:0xf
    v_and_b32_dpp v19, v12, v9 quad_perm:[0,0,0,0] row_mask:0xf bank_mask:0xf
    v_and_b32_dpp v20, v13, v6 quad_perm:[0,0,0,0] row_mask:0xf bank_mask:0xf
    v_and_b32_dpp v21, v13, v7 quad_perm:[0,0,0,0] row_mask:0xf bank_mask:0xf
    v_and_b32_dpp v22, v13, v8 quad_perm:[0,0,0,0] row_mask:0xf bank_mask:0xf
    v_and_b32_dpp v23, v13, v9 quad_perm:[0,0,0,0] row_mask:0xf bank_mask:0xf
    v_smfmac_f32_16x16x64_bf16 v[24:27], v[16:19], v[32:39], v14
    v_and_b32_dpp v16, v12, v6 quad_perm:[1,1,1,1] row_mask:0xf bank_mask:0xf
    v_and_b32_dpp v17, v12, v7 quad_perm:[1,1,1,1] row_mask:0xf bank_mask:0xf
    v_and_b32_dpp v18, v12, v8 quad_perm:[1,1,1,1] row_mask:0xf bank_mask:0xf
    v_and_b32_dpp v19, v12, v9 quad_perm:[1,1,1,1] row_mask:0xf bank_mask:0xf
    v_smfmac_f32_16x16x64_bf16 v[24:27], v[20:23], v[40:47], v14
    v_and_b32_dpp v20, v13, v6 quad_perm:[1,1,1,1] row_mask:0xf bank_mask:0xf
    v_and_b32_dpp v21, v13, v7 quad_perm:[1,1,1,1] row_mask:0xf bank_mask:0xf
    v_and_b32_dpp v22, v13, v8 quad_perm:[1,1,1,1] row_mask:0xf bank_mask:0xf
    v_and_b32_dpp v23, v13, v9 quad_perm:[1,1,1,1] row_mask:0xf bank_mask:0xf
    v_smfmac_f32_16x16x64_bf16 v[24:27], v[16:19], v[48:55], v14
    v_and_b32_dpp v16, v12, v6 quad_perm:[2,2,2,2] row_mask:0xf bank_mask:0xf
    v_and_b32_dpp v17, v12, v7 quad_perm:[2,2,2,2] row_mask:0xf bank_mask:0xf
    v_and_b32_dpp v18, v12, v8 quad_perm:[2,2,2,2] row_mask:0xf bank_mask:0xf
    v_and_b32_dpp v19, v12, v9 quad_perm:[2,2,2,2] row_mask:0xf bank_mask:0xf
    v_smfmac_f32_16x16x64_bf16 v[24:27], v[20:23], v[56:63], v14
    v_and_b32_dpp v20, v13, v6 quad_perm:[2,2,2,2] row_mask:0xf bank_mask:0xf
    v_and_b32_dpp v21, v13, v7 quad_perm:[2,2,2,2] row_mask:0xf bank_mask:0xf
    v_and_b32_dpp v22, v13, v8 quad_perm:[2,2,2,2] row_mask:0xf bank_mask:0xf
    v_and_b32_dpp v23, v13, v9 quad_perm:[2,2,2,2] row_mask:0xf bank_mask:0xf
    v_smfmac_f32_16x16x64_bf16 v[24:27], v[16:19], v[64:71], v14
    v_and_b32_dpp v16, v12, v6 quad_perm:[3,3,3,3] row_mask:0xf bank_mask:0xf
    v_and_b32_dpp v17, v12, v7 quad_perm:[3,3,3,3] row_mask:0xf bank_mask:0xf
    v_and_b32_dpp v18, v12, v8 quad_perm:[3,3,3,3] row_mask:0xf bank_mask:0xf
    v_and_b32_dpp v19, v12, v9 quad_perm:[3,3,3,3] row_mask:0xf bank_mask:0xf
    s_mov_b64 exec, 1
    ds_add_rtn_u32 v31, v3, v0 offset:60
    s_mov_b64 exec, -1
    v_smfmac_f32_16x16x64_bf16 v[24:27], v[20:23], v[72:79], v14
    v_and_b32_dpp v20, v13, v6 quad_perm:[3,3,3,3] row_mask:0xf bank_mask:0xf
    v_and_b32_dpp v21, v13, v7 quad_perm:[3,3,3,3] row_mask:0xf bank_mask:0xf
    v_and_b32_dpp v22, v13, v8 quad_perm:[3,3,3,3] row_mask:0xf bank_mask:0xf
    v_and_b32_dpp v23, v13, v9 quad_perm:[3,3,3,3] row_mask:0xf bank_mask:0xf
    s_waitcnt vmcnt(2)
    v_smfmac_f32_16x16x64_bf16 v[24:27], v[16:19], v[80:87], v14
    global_load_dwordx4 v[96:99], v5, s[50:51] offset:-4096 nt
    s_waitcnt vmcnt(1)
    s_waitcnt lgkmcnt(0)
    v_readfirstlane_b32 s40, v31
    s_cmp_lg_u32 s40, 3
    s_cbranch_scc1 L_ef_34
    v_mov_b32 v31, s39
    v_lshlrev_b32 v0, 7, v1
    s_mov_b64 exec, 255
    global_store_dword v0, v31, s[56:57] sc1
    s_mov_b64 exec, -1
L_ef_34:
    v_smfmac_f32_16x16x64_bf16 v[24:27], v[20:23], v[88:95], v14
    global_load_dwordx4 v[100:103], v5, s[52:53] offset:-4096 nt
    v_mov_b32 v0, 1
    s_movk_i32 s6, 255
    s_nop 4
    ds_write_b128 v10, v[24:27] offset:768
    s_mov_b64 exec, 1
    ds_add_rtn_u32 v31, v3, v0 offset:52
    s_mov_b64 exec, -1
    ds_read_b128 v[48:51], v2 offset:768
    ds_read_b128 v[52:55], v2 offset:1792
    ds_read_b128 v[56:59], v2 offset:2816
    ds_read_b128 v[60:63], v2 offset:3840
    s_waitcnt lgkmcnt(4)
    v_readfirstlane_b32 s40, v31
    s_cmp_lg_u32 s40, 3
    s_cbranch_scc1 L_ha_35
    s_waitcnt lgkmcnt(2)
    v_add_f32 v48, v48, v52
    v_add_f32 v49, v49, v53
    v_add_f32 v50, v50, v54
    v_add_f32 v51, v51, v55
    s_waitcnt lgkmcnt(0)
    v_add_f32 v56, v56, v60
    v_add_f32 v57, v57, v61
    v_add_f32 v58, v58, v62
    v_add_f32 v59, v59, v63
    v_add_f32 v48, v48, v56
    v_add_f32 v49, v49, v57
    v_add_f32 v50, v50, v58
    v_add_f32 v51, v51, v59
    v_bfi_b32 v48, s6, v29, v48
    v_bfi_b32 v50, s6, v30, v50
    global_store_dwordx4 v2, v[48:51], s[58:59] sc1
L_ha_35:
    global_load_dwordx4 v[104:107], v5, s[50:51] offset:0 nt
    global_load_dwordx4 v[108:111], v5, s[52:53] offset:0 nt
    global_load_dwordx4 v[112:115], v5, s[74:75] offset:-4096 nt
    global_load_dwordx4 v[116:119], v5, s[76:77] offset:-4096 nt
    global_load_dwordx4 v[120:123], v5, s[74:75] offset:0 nt
    global_load_dwordx4 v[124:127], v5, s[76:77] offset:0 nt
    v_mov_b32 v24, 0
    v_mov_b32 v25, 0
    v_mov_b32 v26, 0
    v_mov_b32 v27, 0
    s_cmp_lg_u32 s19, 0
    s_cbranch_scc1 L_nort_36
    v_and_b32 v75, 3, v1
    v_lshrrev_b32 v72, 5, v1
    v_lshl_add_u32 v72, v75, 1, v72
    v_lshrrev_b32 v73, 2, v1
    v_lshlrev_b32 v73, 10, v73
    v_lshl_add_u32 v73, v75, 3, v73
    v_add_u32 v74, 16384, v73
    s_lshl_b32 s40, s17, 11
    s_lshl4_add_u32 s40, s37, s40
    v_lshl_add_u32 v75, v72, 1, s40
    global_load_ushort v76, v75, s[4:5]
    v_mov_b32 v80, 0xbfb8aa3b
    v_mul_f32 v80, s21, v80
    v_exp_f32 v80, v80
    v_mov_b32 v84, v28
    v_mov_b32 v85, 0
    v_add_f32 v80, 1.0, v80
    v_rcp_f32_e64 v80, v80
    s_lshl_b32 s40, s18, 2
    v_mov_b32_e64 v81, s40
    v_mul_f32 v80, 0xbfb8aa3b, v80
    v_mul_u32_u24 v78, 14416, v72
    v_add_u32 v78, s20, v78
    s_lshl_b32 s40, s17, 1
    v_mul_u32_u24 v77, 4624, v72
    v_add_u32_e64 v77, s40, v77
    v_lshlrev_b32 v79, 2, v72
L_nort_36:
    s_mov_b32 s46, 0
L_mf_37:
    s_load_dwordx8 s[8:15], s[54:55], 0 glc
    s_add_u32 s46, s46, 1
    s_cmp_gt_u32 s46, 50000
    s_cbranch_scc1 L_end
    s_waitcnt lgkmcnt(0)
    s_xor_b32 s40, s8, s39
    s_xor_b32 s41, s9, s39
    s_or_b32 s40, s40, s41
    s_xor_b32 s41, s10, s39
    s_or_b32 s40, s40, s41
    s_xor_b32 s41, s11, s39
    s_or_b32 s40, s40, s41
    s_xor_b32 s41, s12, s39
    s_or_b32 s40, s40, s41
    s_xor_b32 s41, s13, s39
    s_or_b32 s40, s40, s41
    s_xor_b32 s41, s14, s39
    s_or_b32 s40, s40, s41
    s_xor_b32 s41, s15, s39
    s_or_b32 s40, s40, s41
    s_cbranch_scc1 L_mf_37
    s_mov_b32 s46, 0
L_hp_38:
    global_load_dwordx2 v[32:33], v11, s[60:61] offset:-4096 sc1
    global_load_dwordx2 v[34:35], v11, s[60:61] offset:-3072 sc1
    global_load_dwordx2 v[36:37], v11, s[60:61] offset:-2048 sc1
    global_load_dwordx2 v[38:39], v11, s[60:61] offset:-1024 sc1
    global_load_dwordx2 v[40:41], v11, s[60:61] offset:0 sc1
    global_load_dwordx2 v[42:43], v11, s[60:61] offset:1024 sc1
    global_load_dwordx2 v[44:45], v11, s[60:61] offset:2048 sc1
    global_load_dwordx2 v[46:47], v11, s[60:61] offset:3072 sc1
    s_add_u32 s46, s46, 1
    s_cmp_gt_u32 s46, 50000
    s_cbranch_scc1 L_end
L_hc_39:
    s_waitcnt vmcnt(7)
    v_xor_b32 v31, v28, v32
    s_waitcnt vmcnt(6)
    v_bitop3_b32 v31, v31, v34, v28 bitop3:0xf6
    s_waitcnt vmcnt(5)
    v_bitop3_b32 v31, v31, v36, v28 bitop3:0xf6
    v_add_f32 v64, v32, v36
    v_add_f32 v65, v33, v37
    s_waitcnt vmcnt(4)
    v_bitop3_b32 v31, v31, v38, v28 bitop3:0xf6
    v_add_f32 v66, v34, v38
    v_add_f32 v67, v35, v39
    s_waitcnt vmcnt(3)
    v_bitop3_b32 v31, v31, v40, v28 bitop3:0xf6
    v_add_f32 v64, v64, v40
    v_add_f32_e64 v65, v65, v41
    s_waitcnt vmcnt(2)
    v_bitop3_b32 v31, v31, v42, v28 bitop3:0xf6
    v_add_f32 v66, v66, v42
    v_add_f32 v67, v67, v43
    s_waitcnt vmcnt(1)
    v_bitop3_b32 v31, v31, v44, v28 bitop3:0xf6
    v_add_f32 v64, v64, v44
    v_add_f32 v65, v65, v45
    s_waitcnt vmcnt(0)
    v_bitop3_b32 v31, v31, v46, v28 bitop3:0xf6
    v_add_f32 v66, v66, v46
    v_add_f32 v67, v67, v47
    v_and_b32 v31, 0xff, v31
    v_cmp_ne_u32_e64 vcc, 0, v31
    v_mul_f32 v68, 0xbfb8aa3b, v64
    v_mul_f32 v69, 0xbfb8aa3b, v65
    s_cbranch_vccnz L_hp_38
    v_exp_f32 v68, v68
    v_exp_f32 v69, v69
    v_mul_f32 v64, v64, v66
    v_mul_f32 v65, v65, v67
    v_add_f32 v68, 1.0, v68
    v_add_f32 v69, 1.0, v69
    v_rcp_f32 v68, v68
    v_rcp_f32 v69, v69
    v_mul_f32 v64, v64, v68
    v_mul_f32 v65, v65, v69
    v_cvt_pk_bf16_f32 v12, v64, v65
    s_nop 1
    v_and_b32_dpp v16, v12, v6 quad_perm:[0,0,0,0] row_mask:0xf bank_mask:0xf
    v_and_b32_dpp v17, v12, v7 quad_perm:[0,0,0,0] row_mask:0xf bank_mask:0xf
    v_and_b32_dpp v18, v12, v8 quad_perm:[0,0,0,0] row_mask:0xf bank_mask:0xf
    v_and_b32_dpp v19, v12, v9 quad_perm:[0,0,0,0] row_mask:0xf bank_mask:0xf
    v_and_b32_dpp v20, v12, v6 quad_perm:[1,1,1,1] row_mask:0xf bank_mask:0xf
    v_and_b32_dpp v21, v12, v7 quad_perm:[1,1,1,1] row_mask:0xf bank_mask:0xf
    v_and_b32_dpp v22, v12, v8 quad_perm:[1,1,1,1] row_mask:0xf bank_mask:0xf
    v_and_b32_dpp v23, v12, v9 quad_perm:[1,1,1,1] row_mask:0xf bank_mask:0xf
    v_smfmac_f32_16x16x64_bf16 v[24:27], v[16:19], v[96:103], v14
    v_and_b32_dpp v16, v12, v6 quad_perm:[2,2,2,2] row_mask:0xf bank_mask:0xf
    v_and_b32_dpp v17, v12, v7 quad_perm:[2,2,2,2] row_mask:0xf bank_mask:0xf
    v_and_b32_dpp v18, v12, v8 quad_perm:[2,2,2,2] row_mask:0xf bank_mask:0xf
    v_and_b32_dpp v19, v12, v9 quad_perm:[2,2,2,2] row_mask:0xf bank_mask:0xf
    v_smfmac_f32_16x16x64_bf16 v[24:27], v[20:23], v[104:111], v14
    v_and_b32_dpp v20, v12, v6 quad_perm:[3,3,3,3] row_mask:0xf bank_mask:0xf
    v_and_b32_dpp v21, v12, v7 quad_perm:[3,3,3,3] row_mask:0xf bank_mask:0xf
    v_and_b32_dpp v22, v12, v8 quad_perm:[3,3,3,3] row_mask:0xf bank_mask:0xf
    v_and_b32_dpp v23, v12, v9 quad_perm:[3,3,3,3] row_mask:0xf bank_mask:0xf
    v_smfmac_f32_16x16x64_bf16 v[24:27], v[16:19], v[112:119], v14
    s_nop 0
    v_smfmac_f32_16x16x64_bf16 v[24:27], v[20:23], v[120:127], v14
    s_add_u32 s58, s62, 262144
    s_addc_u32 s59, s63, 0
    v_mov_b32_e64 v0, 1
    s_movk_i32 s6, 255
    s_nop 3
    ds_write_b128 v10, v[24:27] offset:768
    s_mov_b64 exec, 1
    ds_add_rtn_u32 v31, v3, v0 offset:52
    s_mov_b64 exec, -1
    ds_read_b128 v[48:51], v2 offset:768
    ds_read_b128 v[52:55], v2 offset:1792
    ds_read_b128 v[56:59], v2 offset:2816
    ds_read_b128 v[60:63], v2 offset:3840
    s_waitcnt lgkmcnt(4)
    v_readfirstlane_b32 s40, v31
    s_cmp_lg_u32 s40, 7
    s_cbranch_scc1 L_hb_40
    s_waitcnt lgkmcnt(2)
    v_add_f32 v48, v48, v52
    v_add_f32 v49, v49, v53
    v_add_f32 v50, v50, v54
    v_add_f32 v51, v51, v55
    s_waitcnt lgkmcnt(0)
    v_add_f32 v56, v56, v60
    v_add_f32 v57, v57, v61
    v_add_f32 v58, v58, v62
    v_add_f32 v59, v59, v63
    v_add_f32 v48, v48, v56
    v_add_f32 v49, v49, v57
    v_add_f32_e64 v50, v50, v58
    v_add_f32_e64 v51, v51, v59
    v_bfi_b32 v48, s6, v29, v48
    v_bfi_b32 v50, s6, v30, v50
    global_store_dwordx4 v2, v[48:51], s[62:63]
    global_store_dwordx4 v2, v[48:51], s[58:59] sc1
L_hb_40:
    s_branch L_routed
    s_nop 0
L_noexp:
    s_mov_b32 s46, 0
L_sp_41:
    ds_read_b64 v[24:25], v19 offset:128
    s_waitcnt lgkmcnt(0)
    v_cmp_eq_u32 vcc, 0, v24
    s_cbranch_vccz L_spd_42
    s_add_u32 s46, s46, 1
    s_sleep 2
    s_cmp_lt_u32 s46, 400000
    s_cbranch_scc1 L_sp_41
    s_branch L_end
L_spd_42:
    v_max_u32_dpp v27, v25, v25 quad_perm:[1,0,3,2] row_mask:0xf bank_mask:0xf
    v_min_u32_dpp v26, v24, v24 quad_perm:[1,0,3,2] row_mask:0xf bank_mask:0xf
    v_max_u32 v25, v26, v27
    v_max_u32_dpp v24, v24, v24 quad_perm:[1,0,3,2] row_mask:0xf bank_mask:0xf
    s_nop 0
    v_max_u32_dpp v27, v25, v25 quad_perm:[2,3,0,1] row_mask:0xf bank_mask:0xf
    v_min_u32_dpp v26, v24, v24 quad_perm:[2,3,0,1] row_mask:0xf bank_mask:0xf
    v_max_u32 v25, v26, v27
    v_max_u32_dpp v24, v24, v24 quad_perm:[2,3,0,1] row_mask:0xf bank_mask:0xf
    s_nop 0
    v_max_u32_dpp v27, v25, v25 row_half_mirror row_mask:0xf bank_mask:0xf
    v_min_u32_dpp v26, v24, v24 row_half_mirror row_mask:0xf bank_mask:0xf
    v_max_u32 v25, v26, v27
    v_max_u32_dpp v24, v24, v24 row_half_mirror row_mask:0xf bank_mask:0xf
    s_nop 0
    v_max_u32_dpp v27, v25, v25 row_mirror row_mask:0xf bank_mask:0xf
    v_min_u32_dpp v26, v24, v24 row_mirror row_mask:0xf bank_mask:0xf
    v_max_u32_e64 v25, v26, v27
    v_max_u32_dpp v24, v24, v24 row_mirror row_mask:0xf bank_mask:0xf
    v_mov_b32 v0, 1
    s_mov_b64 exec, 1
    ds_add_u32 v3, v0 offset:92
    s_mov_b64 exec, -1
    s_mov_b64 exec, 1
    ds_write_b64 v3, v[24:25] offset:32
    s_mov_b64 exec, -1
    v_readfirstlane_b32 s16, v24
    v_readfirstlane_b32 s17, v25
    s_cmp_eq_u32 s34, 0
    s_cselect_b32 s16, s16, s17
    s_andn2_b32 s17, 2047, s16
    s_lshr_b32 s40, s17, 8
    s_add_u32 s41, s40, 2
    s_bfe_u32 s19, s41, 0x10002
    s_xor_b32 s19, s19, s38
    s_and_b32 s42, s34, 2
    s_or_b32 s19, s19, s42
    s_cmp_eq_u32 s38, 0
    s_cselect_b32 s18, s40, s41
    s_and_b32 s18, s18, 3
    s_mul_i32 s40, s35, 28672
    s_and_b32 s41, s34, 1
    s_lshl_b32 s41, s41, 9
    s_add_u32 s40, s40, s41
    s_and_b32 s41, s36, 15
    s_lshl_b32 s41, s41, 5
    s_add_u32 s40, s40, s41
    s_add_u32 s40, s40, 524288
    s_add_u32 s22, s32, s40
    s_addc_u32 s23, s33, 0
    s_add_u32 s24, s22, 262144
    s_addc_u32 s25, s23, 0
    s_bfe_u32 s40, s17, 0x20002
    s_bfe_u32 s41, s17, 0x40004
    s_lshl4_add_u32 s40, s40, s41
    s_and_b32 s41, s17, 3
    s_lshl2_add_u32 s40, s40, s41
    s_lshl_b32 s41, s18, 8
    s_add_u32 s40, s40, s41
    s_lshl_b32 s40, s40, 1
    s_add_u32 s20, s40, 52096
    s_bitcmp1_b32 s16, 31
    s_brev_b32 s40, 1
    s_cselect_b32 s40, s40, -1
    s_xor_b32 s40, s40, s16
    s_and_b32 s21, s40, 0xffff0000
    s_cmp_lg_u32 s19, 0
    s_cbranch_scc1 L_fin
    v_and_b32 v75, 3, v1
    v_lshrrev_b32 v72, 5, v1
    v_lshl_add_u32 v72, v75, 1, v72
    v_lshrrev_b32 v73, 2, v1
    v_lshlrev_b32 v73, 10, v73
    v_lshl_add_u32 v73, v75, 3, v73
    v_add_u32 v74, 16384, v73
    s_lshl_b32 s40, s17, 11
    s_lshl4_add_u32 s40, s37, s40
    v_lshl_add_u32 v75, v72, 1, s40
    global_load_ushort v76, v75, s[4:5]
    v_mov_b32 v80, 0xbfb8aa3b
    v_mul_f32 v80, s21, v80
    v_exp_f32 v80, v80
    v_mov_b32 v84, v28
    v_mov_b32 v85, 0
    v_add_f32 v80, 1.0, v80
    v_rcp_f32 v80, v80
    s_lshl_b32 s40, s18, 2
    v_mov_b32 v81, s40
    v_mul_f32 v80, 0xbfb8aa3b, v80
    v_mul_u32_u24 v78, 14416, v72
    v_add_u32 v78, s20, v78
    s_lshl_b32 s40, s17, 1
    v_mul_u32_u24 v77, 4624, v72
    v_add_u32 v77, s40, v77
    v_lshlrev_b32 v79, 2, v72
L_nort_43:
    s_mov_b32 s46, 0
L_sp_44:
    ds_read_b32 v72, v3 offset:64
    s_waitcnt lgkmcnt(0)
    v_cmp_gt_u32 vcc, 8, v72
    s_cbranch_vccz L_spd_45
    s_add_u32 s46, s46, 1
    s_sleep 4
    s_cmp_lt_u32 s46, 400000
    s_cbranch_scc1 L_sp_44
    s_branch L_end
    s_nop 0
L_spd_45:
L_routed:
    s_cmp_lg_u32 s19, 0
    s_cbranch_scc1 L_fin
    s_mov_b32 s46, 0
L_ba_46:
    global_load_dwordx2 v[82:83], v73, s[22:23] sc1
    s_mov_b32 exec_hi, 0xffff
    global_load_dwordx2 v[84:85], v74, s[22:23] sc1
    s_mov_b32 exec_hi, -1
L_bc_47:
    s_waitcnt vmcnt(0)
    v_xor_b32_e64 v31, v28, v82
    v_bitop3_b32 v31, v31, v84, v28 bitop3:0xf6
    v_and_b32 v31, 0xff, v31
    v_cmp_ne_u32 vcc, 0, v31
    v_add_f32 v86, v82, v84
    v_add_f32_e64 v87, v83, v85
    s_cbranch_vccz L_bo_48
    s_add_u32 s46, s46, 1
    s_cmp_lt_u32 s46, 24
    s_cbranch_scc1 L_ba_46
    s_cmp_gt_u32 s46, 50000
    s_cbranch_scc1 L_end
    s_sleep 2
    global_load_dwordx2 v[82:83], v73, s[24:25] sc1
    s_mov_b32 exec_hi, 0xffff
    global_load_dwordx2 v[84:85], v74, s[24:25] sc1
    s_mov_b32 exec_hi, -1
    s_branch L_bc_47
    s_nop 0
L_bo_48:
    v_lshlrev_b32 v76, 16, v76
    s_nop 0
    v_permlane32_swap_b32 v86, v87
    v_add_f32_e64 v86, v86, v87
    v_mov_b32 v87, v86
    s_mov_b32 s46, 0
    ds_read_b32 v72, v81 offset:64
    ds_read_u16 v82, v78
    ds_read_u16 v83, v77 offset:9488
    ds_read_b32 v84, v79 offset:0
    v_permlane16_swap_b32 v86, v87
    v_add_f32 v86, v86, v87
    s_nop 1
    v_add_f32_dpp v86, v86, v86 row_ror:8 row_mask:0xf bank_mask:0xf
    s_nop 1
    v_add_f32_dpp v86, v86, v86 row_ror:4 row_mask:0xf bank_mask:0xf
    s_branch L_spc_51
    s_nop 0
L_sp_49:
    ds_read_b32 v72, v81 offset:64
    ds_read_u16 v82, v78
    ds_read_u16 v83, v77 offset:9488
    ds_read_b32 v84, v79 offset:0
L_spc_51:
    s_waitcnt lgkmcnt(0)
    v_cmp_gt_u32 vcc, 8, v72
    s_cbranch_vccz L_spd_50
    s_add_u32 s46, s46, 1
    s_sleep 1
    s_cmp_lt_u32 s46, 400000
    s_cbranch_scc1 L_sp_49
    s_branch L_end
L_spd_50:
    v_fma_mix_f32 v77, v86, v80, v83 op_sel_hi:[0,0,1]
    v_exp_f32 v86, v77
    v_fma_mix_f32 v82, v82, v77, 0 op_sel_hi:[1,0,0]
    v_fma_f32 v86, v86, v84, v84
    v_rcp_f32 v86, v86
    s_mov_b32 exec_lo, 15
    s_mov_b32 exec_hi, 15
    v_fmac_f32 v76, v82, v86
    v_cvt_pk_bf16_f32 v76, v76, v76
    global_store_short v75, v76, s[28:29]
    s_branch L_fin
    s_nop 0
L_cnv:
    v_add_u32_e64 v85, s58, v2
    ds_read_b128 v[12:15], v85 offset:0
    ds_read_b128 v[4:7], v85 offset:4624
    ds_read_b128 v[16:19], v85 offset:9248
    ds_read_b128 v[20:23], v85 offset:13872
    s_mul_i32 s50, s34, 14416
    s_add_u32 s50, s50, 45952
    s_mov_b32 m0, s50
    s_mov_b32 s52, 0x3f803f80
    s_mov_b32 s54, 0x41000000
    s_mov_b32 s55, 0
    s_mul_i32 s56, s59, 0x02020000
    s_add_u32 s56, s56, 0x01000c0c
    s_lshl3_add_u32 s40, s37, s34
    s_lshl_b32 s40, s40, 11
    s_add_u32 s40, s40, 8388608
    s_add_u32 s62, s32, s40
    s_addc_u32 s63, s33, 0
    v_mov_b32 v88, 0
    v_mov_b32 v89, 0
    v_mov_b32 v90, 0
    v_mov_b32 v91, 0
    s_mul_i32 s40, s34, 4624
    s_add_u32 s40, s40, 8960
    v_add_u32 v85, s40, v2
    s_mov_b32 exec_lo, -1
    s_mov_b32 exec_hi, 1
    ds_write_b128 v85, v[88:91]
    s_mov_b64 exec, -1
    v_mov_b32 v86, 0x3c00
    ds_write_addtid_b32 v86
    s_waitcnt lgkmcnt(0)
    s_and_b32 s41, s34, 1
    s_lshl_b32 s41, s41, 4
    s_lshr_b32 s48, s48, s41
    s_lshl_b32 s48, s48, 16
    s_lshr_b32 s51, s49, s41
    s_lshl_b32 s51, s51, 16
    v_mov_b32 v85, 0x3fb8aa3b
    v_mul_f32 v85, s48, v85
    v_exp_f32 v85, v85
    v_mov_b32 v26, 0
    v_cvt_pk_bf16_f32 v85, v85, v85
    v_writelane_b32 v26, s51, 0
    v_and_b32 v85, 0xffff0000, v85
    s_bitset0_b32 s51, 31
    v_mul_f32 v28, 0xbfb8aa3b, v85
    v_mul_f32 v29, 0x3e22f983, v85
    v_add_f32 v30, v85, v85
    v_mov_b32 v0, 1
    s_lshl_b32 s41, s60, 2
    v_mov_b32 v31, s41
    v_and_b32 v24, 12, v31
    v_add_u32 v4, s40, v4
    v_add_u32 v16, s50, v16
    v_add_u32 v17, s50, v17
    v_add_u32 v6, s50, v6
    v_add_u32 v7, s50, v7
    v_add_u32 v20, s50, v20
    v_add_u32 v18, s50, v18
    v_add_u32 v19, s50, v19
    s_mov_b32 s57, s40
    s_sub_u32 s41, s50, s57
    s_add_u32 s41, s41, 8912
    s_and_b32 s41, s41, 255
    s_add_u32 s41, s41, s57
    s_sub_u32 s41, s41, 8704
    s_mov_b32 exec_lo, 0x0f000000
    s_mov_b32 exec_hi, 0x0f000000
    v_mov_b32 v16, s41
    s_sub_u32 s41, s50, s57
    s_add_u32 s41, s41, 8816
    s_and_b32 s41, s41, 255
    s_add_u32 s41, s41, s57
    s_sub_u32 s41, s41, 8704
    s_mov_b32 exec_lo, 0xf0000000
    s_mov_b32 exec_hi, 0xf0000000
    v_mov_b32 v16, s41
    s_mov_b64 exec, -1
    s_add_u32 s41, s50, 1072
    v_sub_u32 v25, s41, v2
    s_mov_b32 s46, 0
L_sp_52:
    ds_read_b64 v[42:43], v3 offset:40
    s_waitcnt lgkmcnt(0)
    v_cmp_eq_u32 vcc, 0, v43
    s_cbranch_vccz L_spd_53
    s_add_u32 s46, s46, 1
    s_sleep 1
    s_cmp_lt_u32 s46, 400000
    s_cbranch_scc1 L_sp_52
    s_branch L_end
    s_nop 0
L_spd_53:
    v_readfirstlane_b32 s39, v42
    v_lshlrev_b32_e64 v40, 2, v1
    v_alignbit_b32 v40, v42, v42, v40
    v_bfi_b32 v40, 1, v42, v40
    v_lshrrev_b32 v41, 1, v40
    v_lshrrev_b32 v42, 2, v40
    v_lshrrev_b32_e64 v43, 3, v40
    s_add_u32 s41, s50, 6144
    v_lshl_add_u32 v1, v1, 3, s41
    s_mov_b32 s61, 0x00010001
    v_lshrrev_b32 v27, 1, v2
    s_cmp_eq_u32 s38, 0
    s_mov_b32 s40, -57664
    s_cselect_b32 s40, 57664, s40
    v_add_u32 v37, s40, v17
    v_add_u32 v36, s40, v16
    s_add_u32 s40, s40, s50
    s_sub_u32 s41, s40, s57
    s_add_u32 s41, s41, 8912
    s_and_b32 s41, s41, 255
    s_add_u32 s41, s41, s57
    s_sub_u32 s41, s41, 8704
    s_mov_b32 exec_lo, 0x0f000000
    s_mov_b32 exec_hi, 0x0f000000
    v_mov_b32 v36, s41
    s_sub_u32 s41, s40, s57
    s_add_u32 s41, s41, 8816
    s_and_b32 s41, s41, 255
    s_add_u32 s41, s41, s57
    s_sub_u32 s41, s41, 8704
    s_mov_b32 exec_lo, 0xf0000000
    s_mov_b32 exec_hi, 0xf0000000
    v_mov_b32 v36, s41
    s_mov_b64 exec, -1
    s_setprio 3
    s_waitcnt vmcnt(3)
    v_perm_b32 v32, v8, v8, s56
    v_mul_f32 v32, 0x3fb8aa3b, v32
    v_exp_f32 v32, v32
    s_waitcnt vmcnt(2)
    v_perm_b32 v33, v9, v9, s56
    v_cvt_pk_bf16_f32 v32, v32, v32
    v_and_b32 v32, 0xffff0000, v32
    v_pk_mul_f32 v[32:33], v[32:33], v[28:29]
    v_rndne_f32 v87, v33
    v_sub_f32 v33, v33, v87
    s_cmp_lg_u32 s59, 0
    s_cbranch_scc1 L_nosc_54
    v_pk_mul_f32 v[90:91], v[32:33], s[54:55] op_sel_hi:[1,0]
    v_exp_f32 v90, v90
    v_cos_f32 v88, v91
    v_sin_f32 v89, v91
    s_nop 0
    v_pk_mul_f32 v[88:89], v[88:89], v[90:91] op_sel_hi:[1,0]
    v_cvt_pk_f16_f32 v45, v88, v89
    v_pk_mul_f32 v[90:91], v[88:89], v[88:89] op_sel:[1,1] op_sel_hi:[1,0] neg_lo:[1,0]
    v_pk_fma_f32 v[88:89], v[88:89], v[88:89], v[90:91] op_sel:[0,0,0] op_sel_hi:[0,1,1]
    s_waitcnt vmcnt(0)
    s_nop 0
    v_cvt_pk_f16_f32 v46, v88, v89
    v_pk_mul_f32 v[90:91], v[88:89], v[88:89] op_sel:[1,1] op_sel_hi:[1,0] neg_lo:[1,0]
    v_and_b32 v85, 0x7fff7fff, v10
    v_pk_fma_f32 v[88:89], v[88:89], v[88:89], v[90:91] op_sel:[0,0,0] op_sel_hi:[0,1,1]
    v_and_b32 v86, 0x7fff7fff, v11
    v_cvt_pk_f16_f32 v48, v88, v89
    v_pk_mul_f32 v[90:91], v[88:89], v[88:89] op_sel:[1,1] op_sel_hi:[1,0] neg_lo:[1,0]
    v_dot2_f32_bf16 v84, v85, s52, 0
    v_pk_fma_f32 v[88:89], v[88:89], v[88:89], v[90:91] op_sel:[0,0,0] op_sel_hi:[0,1,1]
    v_dot2_f32_bf16 v84, v86, s52, v84
    v_cvt_pk_f16_f32 v52, v88, v89
    s_nop 1
    s_nop 0
    v_add_f32_dpp v84, v84, v84 row_shr:1 row_mask:0xf bank_mask:0xf
    v_pk_mul_f32 v[90:91], v[88:89], v[88:89] op_sel:[1,1] op_sel_hi:[1,0] neg_lo:[1,0]
    v_pk_fma_f32 v[88:89], v[88:89], v[88:89], v[90:91] op_sel:[0,0,0] op_sel_hi:[0,1,1]
    v_add_f32_dpp v84, v84, v84 row_shr:2 row_mask:0xf bank_mask:0xf
    v_cvt_pk_f16_f32 v60, v88, v89
    s_nop 0
    v_add_f32_dpp v84, v84, v84 row_shr:4 row_mask:0xf bank_mask:0xf
    v_exp_f32 v94, v32
    v_cos_f32 v92, v33
    v_add_f32_dpp v84, v84, v84 row_shr:8 row_mask:0xf bank_mask:0xf
    v_sin_f32 v93, v33
    s_nop 0
    v_add_f32_dpp v84, v84, v84 row_bcast:15 row_mask:0xa bank_mask:0xf
    v_pk_mul_f32 v[92:93], v[92:93], v[94:95] op_sel_hi:[1,0]
    s_nop 0
    v_add_f32_dpp v84, v84, v84 row_bcast:31 row_mask:0xc bank_mask:0xf
    v_cvt_pk_f16_f32 v61, v92, v93
    v_pk_mul_f32 v[94:95], v[92:93], v[92:93] op_sel:[1,1] op_sel_hi:[1,0] neg_lo:[1,0]
    v_fma_f32 v84, v84, v30, s51
    v_pk_fma_f32 v[92:93], v[92:93], v[92:93], v[94:95] op_sel:[0,0,0] op_sel_hi:[0,1,1]
    v_frexp_exp_i32_f32_e64 v84, v84
    v_cvt_pk_f16_f32 v62, v92, v93
    v_readlane_b32 s40, v84, 63
    s_sub_i32 s40, 126, s40
    s_max_i32 s40, s40, 67
    s_min_i32 s40, s40, 187
    s_lshl_b32 s40, s40, 23
    v_mov_b32 v78, 0x40053526
    v_mul_f32 v78, s40, v78
    v_mul_f32 v26, s40, v26
    s_mov_b64 exec, 1
    ds_write_b32 v31, v78 offset:0
    s_mov_b64 exec, -1
    s_branch L_scj_55
L_nosc_54:
    v_pk_mul_f32 v[90:91], v[32:33], s[54:55] op_sel_hi:[1,0]
    v_exp_f32 v90, v90
    v_cos_f32 v88, v91
    v_exp_f32 v94, v32
    v_sin_f32 v89, v91
    s_nop 0
    v_pk_mul_f32 v[88:89], v[88:89], v[90:91] op_sel_hi:[1,0]
    v_cos_f32 v92, v33
    v_cvt_pk_f16_f32 v45, v88, v89
    v_pk_mul_f32 v[90:91], v[88:89], v[88:89] op_sel:[1,1] op_sel_hi:[1,0] neg_lo:[1,0]
    v_sin_f32_e64 v93, v33
    v_pk_fma_f32 v[88:89], v[88:89], v[88:89], v[90:91] op_sel:[0,0,0] op_sel_hi:[0,1,1]
    v_cvt_pk_f16_f32 v46, v88, v89
    v_pk_mul_f32 v[92:93], v[92:93], v[94:95] op_sel_hi:[1,0]
    v_pk_mul_f32 v[90:91], v[88:89], v[88:89] op_sel:[1,1] op_sel_hi:[1,0] neg_lo:[1,0]
    v_pk_fma_f32 v[88:89], v[88:89], v[88:89], v[90:91] op_sel:[0,0,0] op_sel_hi:[0,1,1]
    v_cvt_pk_f16_f32 v48, v88, v89
    v_cvt_pk_f16_f32 v61, v92, v93
    v_pk_mul_f32 v[90:91], v[88:89], v[88:89] op_sel:[1,1] op_sel_hi:[1,0] neg_lo:[1,0]
    v_pk_fma_f32 v[88:89], v[88:89], v[88:89], v[90:91] op_sel:[0,0,0] op_sel_hi:[0,1,1]
    v_pk_mul_f32 v[94:95], v[92:93], v[92:93] op_sel:[1,1] op_sel_hi:[1,0] neg_lo:[1,0]
    v_cvt_pk_f16_f32 v52, v88, v89
    v_pk_mul_f32 v[90:91], v[88:89], v[88:89] op_sel:[1,1] op_sel_hi:[1,0] neg_lo:[1,0]
    v_pk_fma_f32 v[92:93], v[92:93], v[92:93], v[94:95] op_sel:[0,0,0] op_sel_hi:[0,1,1]
    v_pk_fma_f32 v[88:89], v[88:89], v[88:89], v[90:91] op_sel:[0,0,0] op_sel_hi:[0,1,1]
    v_cvt_pk_f16_f32 v60, v88, v89
    v_cvt_pk_f16_f32 v62, v92, v93
L_scj_55:
    v_pk_mul_f16 v47, v46, v45 op_sel:[1,1] op_sel_hi:[1,0] neg_lo:[1,0]
    v_pk_fma_f16 v47, v46, v45, v47 op_sel:[0,0,0] op_sel_hi:[0,1,1]
    ds_write_addtid_b32 v45 offset:272
    ds_write_addtid_b32 v46 offset:544
    v_pk_mul_f16 v49, v48, v45 op_sel:[1,1] op_sel_hi:[1,0] neg_lo:[1,0]
    v_pk_mul_f16 v50, v48, v46 op_sel:[1,1] op_sel_hi:[1,0] neg_lo:[1,0]
    v_pk_fma_f16 v49, v48, v45, v49 op_sel:[0,0,0] op_sel_hi:[0,1,1]
    v_pk_fma_f16 v50, v48, v46, v50 op_sel:[0,0,0] op_sel_hi:[0,1,1]
    ds_write_addtid_b32 v47 offset:816
    ds_write_addtid_b32 v48 offset:1088
    v_pk_mul_f16 v51, v48, v47 op_sel:[1,1] op_sel_hi:[1,0] neg_lo:[1,0]
    v_pk_fma_f16 v51, v48, v47, v51 op_sel:[0,0,0] op_sel_hi:[0,1,1]
    ds_write_addtid_b32 v49 offset:1360
    ds_write_addtid_b32 v50 offset:1632
    v_pk_mul_f32 v[90:91], v[88:89], v[88:89] op_sel:[1,1] op_sel_hi:[1,0] neg_lo:[1,0]
    v_pk_mul_f16 v53, v52, v45 op_sel:[1,1] op_sel_hi:[1,0] neg_lo:[1,0]
    v_pk_mul_f16 v54, v52, v46 op_sel:[1,1] op_sel_hi:[1,0] neg_lo:[1,0]
    v_pk_fma_f16 v53, v52, v45, v53 op_sel:[0,0,0] op_sel_hi:[0,1,1]
    v_pk_fma_f16 v54, v52, v46, v54 op_sel:[0,0,0] op_sel_hi:[0,1,1]
    ds_write_addtid_b32 v51 offset:1904
    ds_write_addtid_b32 v52 offset:2176
    v_pk_mul_f16 v55, v52, v47 op_sel:[1,1] op_sel_hi:[1,0] neg_lo:[1,0]
    v_pk_mul_f16 v56, v52, v48 op_sel:[1,1] op_sel_hi:[1,0] neg_lo:[1,0]
    v_pk_fma_f16 v55, v52, v47, v55 op_sel:[0,0,0] op_sel_hi:[0,1,1]
    v_pk_fma_f16 v56, v52, v48, v56 op_sel:[0,0,0] op_sel_hi:[0,1,1]
    ds_write_addtid_b32 v53 offset:2448
    ds_write_addtid_b32 v54 offset:2720
    v_pk_mul_f16 v57, v52, v49 op_sel:[1,1] op_sel_hi:[1,0] neg_lo:[1,0]
    v_pk_mul_f16 v58, v52, v50 op_sel:[1,1] op_sel_hi:[1,0] neg_lo:[1,0]
    v_pk_fma_f32 v[88:89], v[88:89], v[88:89], v[90:91] op_sel:[0,0,0] op_sel_hi:[0,1,1]
    v_pk_fma_f16 v57, v52, v49, v57 op_sel:[0,0,0] op_sel_hi:[0,1,1]
    v_pk_fma_f16 v58, v52, v50, v58 op_sel:[0,0,0] op_sel_hi:[0,1,1]
    ds_write_addtid_b32 v55 offset:2992
    ds_write_addtid_b32 v56 offset:3264
    v_pk_mul_f16 v59, v52, v51 op_sel:[1,1] op_sel_hi:[1,0] neg_lo:[1,0]
    v_pk_fma_f16 v59, v52, v51, v59 op_sel:[0,0,0] op_sel_hi:[0,1,1]
    ds_write_addtid_b32 v57 offset:3536
    ds_write_addtid_b32 v58 offset:3808
    v_pk_mul_f16 v80, v60, v45 op_sel:[1,1] op_sel_hi:[1,0] neg_lo:[1,0]
    v_pk_mul_f16 v81, v60, v46 op_sel:[1,1] op_sel_hi:[1,0] neg_lo:[1,0]
    v_pk_fma_f16 v80, v60, v45, v80 op_sel:[0,0,0] op_sel_hi:[0,1,1]
    v_pk_fma_f16 v81, v60, v46, v81 op_sel:[0,0,0] op_sel_hi:[0,1,1]
    ds_write_addtid_b32 v59 offset:4080
    ds_write_addtid_b32 v60 offset:4352
    v_cvt_pk_f16_f32 v64, v88, v89
    v_pk_mul_f16 v82, v60, v47 op_sel:[1,1] op_sel_hi:[1,0] neg_lo:[1,0]
    v_pk_mul_f16 v83, v60, v48 op_sel:[1,1] op_sel_hi:[1,0] neg_lo:[1,0]
    v_pk_fma_f16 v82, v60, v47, v82 op_sel:[0,0,0] op_sel_hi:[0,1,1]
    v_pk_fma_f16 v83, v60, v48, v83 op_sel:[0,0,0] op_sel_hi:[0,1,1]
    ds_write_addtid_b32 v80 offset:4624
    ds_write_addtid_b32 v81 offset:4896
    v_pk_mul_f16 v80, v60, v49 op_sel:[1,1] op_sel_hi:[1,0] neg_lo:[1,0]
    v_pk_mul_f16 v81, v60, v50 op_sel:[1,1] op_sel_hi:[1,0] neg_lo:[1,0]
    v_pk_fma_f16 v80, v60, v49, v80 op_sel:[0,0,0] op_sel_hi:[0,1,1]
    v_pk_fma_f16 v81, v60, v50, v81 op_sel:[0,0,0] op_sel_hi:[0,1,1]
    ds_write_addtid_b32 v82 offset:5168
    ds_write_addtid_b32 v83 offset:5440
    v_pk_mul_f16 v82, v60, v51 op_sel:[1,1] op_sel_hi:[1,0] neg_lo:[1,0]
    v_pk_mul_f16 v83, v60, v52 op_sel:[1,1] op_sel_hi:[1,0] neg_lo:[1,0]
    v_pk_mul_f32 v[90:91], v[88:89], v[88:89] op_sel:[1,1] op_sel_hi:[1,0] neg_lo:[1,0]
    v_pk_fma_f16 v82, v60, v51, v82 op_sel:[0,0,0] op_sel_hi:[0,1,1]
    v_pk_fma_f16 v83, v60, v52, v83 op_sel:[0,0,0] op_sel_hi:[0,1,1]
    ds_write_addtid_b32 v80 offset:5712
    ds_write_addtid_b32 v81 offset:5984
    v_pk_mul_f16 v80, v60, v53 op_sel:[1,1] op_sel_hi:[1,0] neg_lo:[1,0]
    v_pk_mul_f16 v81, v60, v54 op_sel:[1,1] op_sel_hi:[1,0] neg_lo:[1,0]
    v_pk_fma_f16 v80, v60, v53, v80 op_sel:[0,0,0] op_sel_hi:[0,1,1]
    v_pk_fma_f16 v81, v60, v54, v81 op_sel:[0,0,0] op_sel_hi:[0,1,1]
    ds_write_addtid_b32 v82 offset:6256
    ds_write_addtid_b32 v83 offset:6528
    v_pk_mul_f16 v82, v60, v55 op_sel:[1,1] op_sel_hi:[1,0] neg_lo:[1,0]
    v_pk_mul_f16 v83, v60, v56 op_sel:[1,1] op_sel_hi:[1,0] neg_lo:[1,0]
    v_pk_fma_f16 v82, v60, v55, v82 op_sel:[0,0,0] op_sel_hi:[0,1,1]
    v_pk_fma_f16 v83, v60, v56, v83 op_sel:[0,0,0] op_sel_hi:[0,1,1]
    v_pk_fma_f32 v[88:89], v[88:89], v[88:89], v[90:91] op_sel:[0,0,0] op_sel_hi:[0,1,1]
    ds_write_addtid_b32 v80 offset:6800
    ds_write_addtid_b32 v81 offset:7072
    v_pk_mul_f16 v80, v60, v57 op_sel:[1,1] op_sel_hi:[1,0] neg_lo:[1,0]
    v_pk_mul_f16 v81, v60, v58 op_sel:[1,1] op_sel_hi:[1,0] neg_lo:[1,0]
    v_pk_fma_f16 v80, v60, v57, v80 op_sel:[0,0,0] op_sel_hi:[0,1,1]
    v_pk_fma_f16 v81, v60, v58, v81 op_sel:[0,0,0] op_sel_hi:[0,1,1]
    ds_write_addtid_b32 v82 offset:7344
    ds_write_addtid_b32 v83 offset:7616
    v_pk_mul_f16 v82, v60, v59 op_sel:[1,1] op_sel_hi:[1,0] neg_lo:[1,0]
    v_pk_fma_f16 v82, v60, v59, v82 op_sel:[0,0,0] op_sel_hi:[0,1,1]
    ds_write_addtid_b32 v80 offset:7888
    ds_write_addtid_b32 v81 offset:8160
    ds_write_addtid_b32 v82 offset:8432
    v_cvt_pk_f16_f32 v65, v88, v89
    s_mov_b32 s46, 0
    ds_read_b32 v78, v31 offset:0
    s_waitcnt vmcnt(0)
    v_perm_b32 v92, v10, v10, s56
    v_perm_b32 v93, v11, v11, s56
    v_mul_f32 v34, 0x3ef5fdf0, v30
    s_branch L_spc_58
    s_nop 0
L_sp_56:
    ds_read_b32 v78, v31 offset:0
L_spc_58:
    s_waitcnt lgkmcnt(0)
    v_cmp_eq_u32 vcc, 0, v78
    s_cbranch_vccz L_spd_57
    s_add_u32 s46, s46, 1
    s_sleep 1
    s_cmp_lt_u32 s46, 400000
    s_cbranch_scc1 L_sp_56
    s_branch L_end
    s_nop 0
L_spd_57:
    v_mul_f32_e64 v34, v34, v78
    v_pk_mul_f32 v[92:93], v[92:93], v[34:35] op_sel_hi:[1,0] neg_hi:[1,0]
    v_cvt_pk_f16_f32 v67, v92, v93
    v_pk_mul_f16 v73, v67, v64 op_sel:[1,1] op_sel_hi:[1,0]
    v_pk_fma_f16 v73, v67, v64, v73 op_sel:[0,0,0] op_sel_hi:[0,1,1] neg_hi:[0,1,0]
    v_pk_mul_f16 v68, v67, v61 op_sel:[1,1] op_sel_hi:[1,0]
    v_pk_mul_f16 v69, v67, v62 op_sel:[1,1] op_sel_hi:[1,0]
    v_pk_fma_f16 v68, v67, v61, v68 op_sel:[0,0,0] op_sel_hi:[0,1,1] neg_hi:[0,1,0]
    v_pk_fma_f16 v69, v67, v62, v69 op_sel:[0,0,0] op_sel_hi:[0,1,1] neg_hi:[0,1,0]
    ds_write_addtid_b32 v67 offset:8704
    ds_write_addtid_b32 v73 offset:11696
    v_pk_mul_f16 v75, v73, v45 op_sel:[1,1] op_sel_hi:[1,0]
    v_pk_mul_f16 v70, v68, v62 op_sel:[1,1] op_sel_hi:[1,0]
    v_pk_fma_f16 v75, v73, v45, v75 op_sel:[0,0,0] op_sel_hi:[0,1,1] neg_hi:[0,1,0]
    v_pk_fma_f16 v70, v68, v62, v70 op_sel:[0,0,0] op_sel_hi:[0,1,1] neg_hi:[0,1,0]
    ds_write_addtid_b32 v68 offset:8976
    ds_write_addtid_b32 v69 offset:9248
    v_pk_mul_f16 v71, v69, v62 op_sel:[1,1] op_sel_hi:[1,0]
    v_pk_mul_f16 v76, v75, v64 op_sel:[1,1] op_sel_hi:[1,0]
    v_pk_fma_f16 v71, v69, v62, v71 op_sel:[0,0,0] op_sel_hi:[0,1,1] neg_hi:[0,1,0]
    v_pk_fma_f16 v76, v75, v64, v76 op_sel:[0,0,0] op_sel_hi:[0,1,1] neg_hi:[0,1,0]
    ds_write_addtid_b32 v75 offset:10064
    ds_write_addtid_b32 v70 offset:9520
    v_pk_mul_f16 v77, v75, v65 op_sel:[1,1] op_sel_hi:[1,0]
    v_pk_mul_f16 v63, v70, v62 op_sel:[1,1] op_sel_hi:[1,0]
    v_pk_fma_f16 v77, v75, v65, v77 op_sel:[0,0,0] op_sel_hi:[0,1,1] neg_hi:[0,1,0]
    v_pk_fma_f16 v63, v70, v62, v63 op_sel:[0,0,0] op_sel_hi:[0,1,1] neg_hi:[0,1,0]
    ds_write_addtid_b32 v71 offset:12240
    ds_write_addtid_b32 v76 offset:13600
    v_pk_mul_f16 v72, v71, v62 op_sel:[1,1] op_sel_hi:[1,0]
    v_pk_mul_f16 v74, v71, v64 op_sel:[1,1] op_sel_hi:[1,0]
    v_pk_fma_f16 v72, v71, v62, v72 op_sel:[0,0,0] op_sel_hi:[0,1,1] neg_hi:[0,1,0]
    v_pk_fma_f16 v74, v71, v64, v74 op_sel:[0,0,0] op_sel_hi:[0,1,1] neg_hi:[0,1,0]
    ds_write_addtid_b32 v77 offset:10608
    ds_write_addtid_b32 v63 offset:12512
    v_pk_mul_f16 v66, v76, v65 op_sel:[1,1] op_sel_hi:[1,0]
    v_pk_mul_f16 v79, v77, v65 op_sel:[1,1] op_sel_hi:[1,0]
    v_pk_fma_f16 v66, v76, v65, v66 op_sel:[0,0,0] op_sel_hi:[0,1,1] neg_hi:[0,1,0]
    v_pk_fma_f16 v79, v77, v65, v79 op_sel:[0,0,0] op_sel_hi:[0,1,1] neg_hi:[0,1,0]
    ds_write_addtid_b32 v72 offset:12784
    ds_write_addtid_b32 v74 offset:11424
    v_pk_mul_f16 v80, v63, v62 op_sel:[1,1] op_sel_hi:[1,0]
    v_pk_mul_f16 v81, v69, v64 op_sel:[1,1] op_sel_hi:[1,0]
    v_pk_fma_f16 v80, v63, v62, v80 op_sel:[0,0,0] op_sel_hi:[0,1,1] neg_hi:[0,1,0]
    v_pk_fma_f16 v81, v69, v64, v81 op_sel:[0,0,0] op_sel_hi:[0,1,1] neg_hi:[0,1,0]
    ds_write_addtid_b32 v66 offset:13872
    ds_write_addtid_b32 v79 offset:10880
    v_pk_mul_f16 v82, v72, v64 op_sel:[1,1] op_sel_hi:[1,0]
    v_pk_mul_f16 v83, v71, v65 op_sel:[1,1] op_sel_hi:[1,0]
    v_pk_fma_f16 v82, v72, v64, v82 op_sel:[0,0,0] op_sel_hi:[0,1,1] neg_hi:[0,1,0]
    v_pk_fma_f16 v83, v71, v65, v83 op_sel:[0,0,0] op_sel_hi:[0,1,1] neg_hi:[0,1,0]
    ds_write_addtid_b32 v80 offset:13056
    ds_write_addtid_b32 v81 offset:11968
    v_pk_mul_f16 v80, v74, v65 op_sel:[1,1] op_sel_hi:[1,0]
    v_pk_mul_f16 v81, v66, v65 op_sel:[1,1] op_sel_hi:[1,0]
    v_pk_fma_f16 v80, v74, v65, v80 op_sel:[0,0,0] op_sel_hi:[0,1,1] neg_hi:[0,1,0]
    v_pk_fma_f16 v81, v66, v65, v81 op_sel:[0,0,0] op_sel_hi:[0,1,1] neg_hi:[0,1,0]
    ds_write_addtid_b32 v82 offset:9792
    ds_write_addtid_b32 v83 offset:13328
    v_pk_mul_f16 v82, v79, v65 op_sel:[1,1] op_sel_hi:[1,0]
    v_pk_fma_f16 v82, v79, v65, v82 op_sel:[0,0,0] op_sel_hi:[0,1,1] neg_hi:[0,1,0]
    ds_write_addtid_b32 v80 offset:10336
    ds_write_addtid_b32 v81 offset:14144
    ds_write_addtid_b32 v82 offset:11152
    s_mov_b64 exec, 1
    ds_add_u32 v3, v0 offset:80
    s_mov_b64 exec, -1
    s_cmp_lg_u32 s59, 0
    s_cbranch_scc1 L_recv_59
    s_nop 0
    s_setprio 2
    ds_read_b128 v[88:91], v16 offset:8704
    ds_read_b128 v[92:95], v17 offset:0
    ds_read_b128 v[96:99], v16 offset:8736
    ds_read_b128 v[100:103], v17 offset:32
    ds_read_b128 v[104:107], v16 offset:8768
    ds_read_b128 v[108:111], v17 offset:64
    ds_read_b128 v[44:47], v16 offset:8800
    ds_read_b128 v[48:51], v17 offset:96
    s_waitcnt lgkmcnt(6)
    v_mfma_f32_32x32x16_f16 v[112:127], v[88:91], v[92:95], 0
    ds_read_b128 v[88:91], v16 offset:8832
    ds_read_b128 v[92:95], v17 offset:128
    s_waitcnt lgkmcnt(6)
    v_mfma_f32_32x32x16_f16 v[112:127], v[96:99], v[100:103], v[112:127]
    ds_read_b128 v[96:99], v16 offset:8864
    ds_read_b128 v[100:103], v17 offset:160
    s_waitcnt lgkmcnt(6)
    v_mfma_f32_32x32x16_f16 v[112:127], v[104:107], v[108:111], v[112:127]
    ds_read_b128 v[104:107], v16 offset:8896
    ds_read_b128 v[108:111], v17 offset:192
    s_waitcnt lgkmcnt(6)
    v_mfma_f32_32x32x16_f16 v[112:127], v[44:47], v[48:51], v[112:127]
    ds_read_b128 v[44:47], v16 offset:8928
    ds_read_b128 v[48:51], v17 offset:224
    s_waitcnt lgkmcnt(6)
    v_mfma_f32_32x32x16_f16 v[112:127], v[88:91], v[92:95], v[112:127]
    s_waitcnt lgkmcnt(4)
    v_mfma_f32_32x32x16_f16 v[112:127], v[96:99], v[100:103], v[112:127]
    s_waitcnt lgkmcnt(2)
    v_mfma_f32_32x32x16_f16 v[112:127], v[104:107], v[108:111], v[112:127]
    s_waitcnt lgkmcnt(0)
    v_mfma_f32_32x32x16_f16 v[112:127], v[44:47], v[48:51], v[112:127]
    s_mov_b32 s46, 0
L_sp_61:
    ds_read_b32 v85, v24 offset:96
    s_waitcnt lgkmcnt(0)
    v_cmp_gt_u32 vcc, 1, v85
    s_cbranch_vccz L_spd_62
    s_add_u32 s46, s46, 1
    s_cmp_lt_u32 s46, 400000
    s_cbranch_scc1 L_sp_61
    s_branch L_end
L_spd_62:
    s_setprio 3
    ds_read_b128 v[88:91], v36 offset:8704
    ds_read_b128 v[92:95], v37 offset:0
    ds_read_b128 v[96:99], v36 offset:8736
    ds_read_b128 v[100:103], v37 offset:32
    ds_read_b128 v[104:107], v36 offset:8768
    ds_read_b128 v[108:111], v37 offset:64
    ds_read_b128 v[44:47], v36 offset:8800
    ds_read_b128 v[48:51], v37 offset:96
    s_waitcnt lgkmcnt(6)
    v_mfma_f32_32x32x16_f16 v[112:127], v[88:91], v[92:95], v[112:127]
    ds_read_b128 v[88:91], v36 offset:8832
    ds_read_b128 v[92:95], v37 offset:128
    s_waitcnt lgkmcnt(6)
    v_mfma_f32_32x32x16_f16 v[112:127], v[96:99], v[100:103], v[112:127]
    ds_read_b128 v[96:99], v36 offset:8864
    ds_read_b128 v[100:103], v37 offset:160
    s_waitcnt lgkmcnt(6)
    v_mfma_f32_32x32x16_f16 v[112:127], v[104:107], v[108:111], v[112:127]
    ds_read_b128 v[104:107], v36 offset:8896
    ds_read_b128 v[108:111], v37 offset:192
    s_waitcnt lgkmcnt(6)
    v_mfma_f32_32x32x16_f16 v[112:127], v[44:47], v[48:51], v[112:127]
    ds_read_b128 v[44:47], v36 offset:8928
    ds_read_b128 v[48:51], v37 offset:224
    s_waitcnt lgkmcnt(6)
    v_mfma_f32_32x32x16_f16 v[112:127], v[88:91], v[92:95], v[112:127]
    s_waitcnt lgkmcnt(4)
    v_mfma_f32_32x32x16_f16 v[112:127], v[96:99], v[100:103], v[112:127]
    s_waitcnt lgkmcnt(2)
    v_mfma_f32_32x32x16_f16 v[112:127], v[104:107], v[108:111], v[112:127]
    s_waitcnt lgkmcnt(0)
    v_mfma_f32_32x32x16_f16 v[112:127], v[44:47], v[48:51], v[112:127]
    s_mov_b64 exec, 1
    ds_add_u32 v3, v0 offset:84
    s_mov_b64 exec, -1
    s_mov_b64 exec, 1
    ds_write_b32 v24, v0 offset:112
    s_mov_b64 exec, -1
    s_nop 5
    v_cvt_pkrtz_f16_f32 v109, v122, v123
    v_add_f32 v112, v112, v26
    v_cvt_pkrtz_f16_f32 v88, v119, v118
    v_cvt_pkrtz_f16_f32 v89, v117, v116
    v_mov_b32_dpp v85, v109 quad_perm:[1,0,3,2] row_mask:0xf bank_mask:0xf
    v_cvt_pkrtz_f16_f32 v90, v115, v114
    v_cvt_pkrtz_f16_f32 v91, v113, v112
    v_cvt_pkrtz_f16_f32 v108, v121, v120
    v_bfi_b32 v88, s61, v40, v88
    v_bfi_b32 v89, s61, v41, v89
    v_bfi_b32 v90, s61, v42, v90
    v_bfi_b32 v91, s61, v43, v91
    v_perm_b32 v109, v85, v109, v5
    global_store_dwordx4 v2, v[88:91], s[62:63] sc1
    v_bfi_b32 v108, s61, v40, v108
    v_bfi_b32 v109, s61, v41, v109
    global_store_dwordx2 v27, v[108:109], s[62:63] offset:1024 sc1
    v_mov_b32 v79, s39
    s_mov_b64 exec, 1
    global_store_dwordx2 v3, v[78:79], s[62:63] offset:2040 sc1
    s_mov_b64 exec, -1
    ds_read_b128 v[44:47], v2 offset:4864
    ds_read_b128 v[48:51], v2 offset:5888
    ds_read_b128 v[52:55], v2 offset:6912
    ds_read_b128 v[56:59], v2 offset:7936
    s_branch L_arr_60
L_recv_59:
    s_mov_b64 exec, 1
    ds_write_b32 v24, v0 offset:96
    s_mov_b64 exec, -1
    ds_read_b128 v[44:47], v2 offset:4864
    ds_read_b128 v[48:51], v2 offset:5888
    ds_read_b128 v[52:55], v2 offset:6912
    ds_read_b128 v[56:59], v2 offset:7936
    v_xor_b32_e64 v31, 16, v31
    s_load_dword s42, s[62:63], 2040 glc
    s_mov_b32 s46, 0
L_sp_63:
    ds_read_b32 v85, v24 offset:112
    s_waitcnt lgkmcnt(0)
    v_cmp_gt_u32 vcc, 1, v85
    s_cbranch_vccz L_spd_64
    s_add_u32 s46, s46, 1
    s_sleep 2
    s_cmp_lt_u32 s46, 400000
    s_cbranch_scc1 L_sp_63
    s_branch L_end
    s_nop 0
L_spd_64:
    s_mov_b32 s46, 0
L_km_65:
    s_load_dwordx2 s[42:43], s[62:63], 2040 glc
    s_add_u32 s46, s46, 1
    s_cmp_gt_u32 s46, 50000
    s_cbranch_scc1 L_end
    s_waitcnt lgkmcnt(0)
    s_cmp_lg_u32 s43, s39
    s_cbranch_scc1 L_km_65
    s_mov_b32 s46, 0
L_ka_66:
    global_load_dwordx4 v[88:91], v2, s[62:63] sc1
    global_load_dwordx2 v[108:109], v27, s[62:63] offset:1024 sc1
    v_mov_b32 v110, s42
    s_mov_b64 exec, 1
    ds_write_b32 v31, v110 offset:0
    s_mov_b64 exec, -1
    s_add_u32 s46, s46, 1
    s_cmp_gt_u32 s46, 50000
    s_cbranch_scc1 L_end
    s_waitcnt vmcnt(1)
    v_xor_b32_e64 v85, v88, v40
    v_bitop3_b32 v85, v85, v89, v41 bitop3:0xf6
    v_bitop3_b32 v85, v85, v90, v42 bitop3:0xf6
    v_bitop3_b32 v85, v85, v91, v43 bitop3:0xf6
    s_nop 0
    s_waitcnt vmcnt(0)
    v_bitop3_b32 v85, v85, v108, v40 bitop3:0xf6
    v_bitop3_b32 v85, v85, v109, v41 bitop3:0xf6
    v_and_b32 v85, 0x00010001, v85
    v_cmp_ne_u32 vcc, 0, v85
    s_cbranch_vccnz L_ka_66
L_arr_60:
    ds_write_b128 v25, v[88:91]
    v_alignbit_b32 v92, v89, v88, 16
    v_readlane_b32 s40, v88, 63
    v_readlane_b32 s53, v108, 63
    v_readlane_b32 s41, v92, 63
    v_mov_b32_dpp v99, v88 wave_shr:1 row_mask:0xf bank_mask:0xf bound_ctrl:0
    s_pack_ll_b32_b16 s42, s40, s40
    v_alignbit_b32 v93, v90, v89, 16
    v_alignbit_b32 v94, v91, v90, 16
    v_alignbit_b32 v95, v99, v91, 16
    v_mov_b32 v104, 0
    ds_write_b128 v25, v[92:95] offset:1088
    v_and_b32 v105, s42, v21
    v_and_b32 v106, s42, v22
    v_and_b32_e64 v107, s42, v23
    v_writelane_b32 v107, s40, 11
    v_writelane_b32 v107, s41, 15
    ds_write_b128 v20, v[104:107]
    v_mov_b32_dpp v111, v89 wave_shr:1 row_mask:0xf bank_mask:0xf bound_ctrl:0
    ds_write2_b32 v18, v108, v108 offset0:0 offset1:225
    s_pack_ll_b32_b16 s53, s53, s53
    ds_write2_b32 v19, v109, v109 offset0:0 offset1:225
    v_mov_b32 v96, v89
    v_mov_b32 v97, v90
    v_mov_b32 v98, v91
    ds_write_b128 v25, v[96:99] offset:2176
    v_mov_b32 v100, v93
    v_mov_b32 v101, v94
    v_mov_b32_e64 v102, v95
    v_alignbit_b32 v103, v111, v99, 16
    ds_write_b128 v25, v[100:103] offset:3264
    v_pk_mul_f16 v12, v12, s53
    v_pk_mul_f16 v13, v13, s53
    v_pk_mul_f16 v14, v14, s53
    v_pk_mul_f16 v15, v15, s53
    v_mov_b32_e64 v5, v24
    s_cmp_lg_u32 s38, 0
    s_cbranch_scc1 L_set1_67
    ds_read_b64 v[32:33], v7 offset:512
    ds_read_b64 v[34:35], v7 offset:520
    ds_read_b64 v[36:37], v7 offset:448
    ds_read_b64 v[38:39], v7 offset:456
    ds_read_b64 v[40:41], v6 offset:576
    ds_read_b64 v[42:43], v6 offset:584
    ds_read_b64 v[60:61], v6 offset:64
    ds_read_b64 v[62:63], v6 offset:72
    ds_read_b64 v[64:65], v7 offset:576
    ds_read_b64 v[66:67], v7 offset:584
    ds_read_b64 v[68:69], v6 offset:640
    ds_read_b64 v[70:71], v6 offset:648
    ds_read_b64 v[72:73], v6 offset:128
    ds_read_b64 v[74:75], v6 offset:136
    ds_read_b64 v[76:77], v6 offset:704
    ds_read_b64 v[78:79], v6 offset:712
    ds_read_b64 v[80:81], v6 offset:192
    ds_read_b64 v[82:83], v6 offset:200
    ds_read_b64 v[84:85], v6 offset:768
    ds_read_b64 v[86:87], v6 offset:776
    s_mov_b32 s46, 0
L_sp_68:
    ds_read_b32 v5, v3 offset:48
    s_waitcnt lgkmcnt(0)
    v_cmp_gt_u32_e64 vcc, 2, v5
    s_cbranch_vccz L_spd_69
    s_add_u32 s46, s46, 1
    s_sleep 2
    s_cmp_lt_u32 s46, 400000
    s_cbranch_scc1 L_sp_68
    s_nop 0
    s_branch L_end
    s_nop 0
L_spd_69:
    s_setprio 2
    ds_read_b128 v[8:11], v4 offset:496
    ds_read_b128 v[16:19], v4 offset:480
    ds_read_b128 v[20:23], v4 offset:1536
    ds_read_b128 v[24:27], v4 offset:1008
    ds_read_b128 v[28:31], v4 offset:992
    ds_read_b128 v[88:91], v4 offset:48
    s_waitcnt lgkmcnt(5)
    v_mfma_f32_16x16x32_f16 v[92:95], v[8:11], v[52:55], 0
    s_waitcnt lgkmcnt(4)
    ds_read_b128 v[96:99], v4 offset:112
    ds_read_b128 v[100:103], v4 offset:368
    v_mfma_f32_16x16x32_f16 v[104:107], v[16:19], v[56:59], 0
    s_waitcnt lgkmcnt(5)
    ds_read_b128 v[108:111], v4 offset:176
    ds_read_b64 v[112:113], v6 offset:896
    v_mfma_f32_16x16x32_f16 v[116:119], v[12:15], v[20:23], 0
    s_waitcnt lgkmcnt(6)
    ds_read_b128 v[120:123], v4 offset:240
    ds_read_b64 v[114:115], v6 offset:904
    v_mfma_f32_16x16x32_f16 v[124:127], v[24:27], v[52:55], 0
    s_waitcnt lgkmcnt(7)
    ds_read_b64 v[8:9], v6 offset:256
    ds_read_b64 v[16:17], v6 offset:384
    v_mfma_f32_16x16x32_f16 v[20:23], v[28:31], v[56:59], 0
    v_cvt_pkrtz_f16_f32 v92, v92, v104
    v_cvt_pkrtz_f16_f32 v93, v93, v105
    v_cvt_pkrtz_f16_f32 v94, v94, v106
    v_cvt_pkrtz_f16_f32 v95, v95, v107
    s_nop 1
    v_mfma_f32_16x16x32_f16 v[116:119], v[92:95], v[32:35], v[116:119]
    ds_read_b64 v[10:11], v6 offset:264
    ds_read_b64 v[18:19], v6 offset:392
    v_mfma_f32_16x16x32_f16 v[24:27], v[92:95], v[36:39], 0
    s_waitcnt lgkmcnt(10)
    ds_read_b128 v[28:31], v4 offset:304
    ds_read_b128 v[104:107], v4 offset:432
    v_mfma_f32_16x16x32_f16 v[36:39], v[40:43], v[88:91], 0
    v_cvt_pkrtz_f16_f32 v124, v124, v20
    v_cvt_pkrtz_f16_f32 v125, v125, v21
    v_cvt_pkrtz_f16_f32 v126, v126, v22
    v_cvt_pkrtz_f16_f32 v127, v127, v23
    v_mfma_f32_16x16x32_f16 v[92:95], v[60:63], v[88:91], 0
    ds_read_b64 v[20:21], v6 offset:832
    ds_read_b64 v[60:61], v6 offset:960
    v_mfma_f32_16x16x32_f16 v[116:119], v[124:127], v[64:67], v[116:119]
    ds_read_b64 v[22:23], v6 offset:840
    ds_read_b64 v[62:63], v6 offset:968
    v_mfma_f32_16x16x32_f16 v[24:27], v[124:127], v[32:35], v[24:27]
    s_waitcnt lgkmcnt(15)
    ds_read_b64 v[88:89], v6 offset:320
    ds_read_b64 v[32:33], v6 offset:448
    v_mfma_f32_16x16x32_f16 v[36:39], v[68:71], v[96:99], v[36:39]
    ds_read_b64 v[90:91], v6 offset:328
    ds_read_b64 v[34:35], v6 offset:456
    v_mfma_f32_16x16x32_f16 v[92:95], v[72:75], v[96:99], v[92:95]
    s_waitcnt lgkmcnt(15)
    ds_read_b128 v[124:127], v4 offset:496
    v_mfma_f32_16x16x32_f16 v[36:39], v[76:79], v[108:111], v[36:39]
    ds_read_b64 v[72:73], v6 offset:1024
    v_mfma_f32_16x16x32_f16 v[92:95], v[80:83], v[108:111], v[92:95]
    ds_read_b64 v[74:75], v6 offset:1032
    v_mfma_f32_16x16x32_f16 v[36:39], v[84:87], v[120:123], v[36:39]
    s_waitcnt lgkmcnt(14)
    ds_read_b64 v[96:97], v6 offset:512
    v_mfma_f32_16x16x32_f16 v[92:95], v[8:11], v[120:123], v[92:95]
    s_waitcnt lgkmcnt(9)
    ds_read_b64 v[98:99], v6 offset:520
    v_mfma_f32_16x16x32_f16 v[36:39], v[20:23], v[28:31], v[36:39]
    s_waitcnt lgkmcnt(6)
    ds_read_b128 v[80:83], v4 offset:560
    v_mfma_f32_16x16x32_f16 v[92:95], v[88:91], v[28:31], v[92:95]
    ds_read_b128 v[108:111], v4 offset:624
    v_mfma_f32_16x16x32_f16 v[36:39], v[112:115], v[100:103], v[36:39]
    ds_read_b128 v[120:123], v4 offset:688
    v_mfma_f32_16x16x32_f16 v[92:95], v[16:19], v[100:103], v[92:95]
    ds_read_b128 v[8:11], v4 offset:752
    v_mfma_f32_16x16x32_f16 v[36:39], v[60:63], v[104:107], v[36:39]
    s_waitcnt lgkmcnt(9)
    ds_read_b128 v[28:31], v4 offset:1520
    v_mfma_f32_16x16x32_f16 v[92:95], v[32:35], v[104:107], v[92:95]
    s_waitcnt lgkmcnt(7)
    ds_read_b128 v[88:91], v4 offset:1504
    v_mfma_f32_16x16x32_f16 v[36:39], v[72:75], v[124:127], v[36:39]
    s_waitcnt lgkmcnt(6)
    ds_read_b128 v[100:103], v4 offset:816
    v_mfma_f32_16x16x32_f16 v[92:95], v[96:99], v[124:127], v[92:95]
    s_waitcnt lgkmcnt(6)
    ds_read_b128 v[16:19], v4 offset:880
    v_mfma_f32_16x16x32_f16 v[92:95], v[40:43], v[80:83], v[92:95]
    s_waitcnt lgkmcnt(6)
    ds_read_b128 v[104:107], v4 offset:944
    v_mfma_f32_16x16x32_f16 v[92:95], v[68:71], v[108:111], v[92:95]
    s_waitcnt lgkmcnt(6)
    v_cvt_pk_f16_f32 v36, v36, v37
    v_cvt_pk_f16_f32 v37, v38, v39
    v_mfma_f32_16x16x32_f16 v[92:95], v[76:79], v[120:123], v[92:95]
    s_waitcnt lgkmcnt(5)
    s_waitcnt lgkmcnt(4)
    ds_write_b64 v1, v[36:37] offset:0
    v_mfma_f32_16x16x32_f16 v[92:95], v[84:87], v[8:11], v[92:95]
    s_mov_b64 exec, 1
    ds_add_u32 v3, v0 offset:64
    s_mov_b64 exec, -1
    v_mfma_f32_16x16x32_f16 v[32:35], v[28:31], v[44:47], 0
    s_setprio 1
    ds_read_b128 v[124:127], v4 offset:1008
    v_mfma_f32_16x16x32_f16 v[96:99], v[28:31], v[48:51], 0
    ds_read_b128 v[80:83], v4 offset:2032
    v_mfma_f32_16x16x32_f16 v[108:111], v[28:31], v[52:55], 0
    s_waitcnt lgkmcnt(7)
    ds_read_b64 v[120:121], v6 offset:128
    v_mfma_f32_16x16x32_f16 v[36:39], v[88:91], v[56:59], 0
    ds_read_b32 v5, v3 offset:56
    v_mfma_f32_16x16x32_f16 v[8:11], v[88:91], v[44:47], 0
    s_nop 0
    v_cvt_pkrtz_f16_f32 v32, v32, v96
    v_cvt_pkrtz_f16_f32 v33, v33, v97
    v_mfma_f32_16x16x32_f16 v[28:31], v[88:91], v[48:51], 0
    s_waitcnt lgkmcnt(8)
    ds_read_b64 v[88:89], v7 offset:640
    v_cvt_pkrtz_f16_f32 v34, v34, v98
    v_cvt_pkrtz_f16_f32 v35, v35, v99
    v_mfma_f32_16x16x32_f16 v[92:95], v[20:23], v[100:103], v[92:95]
    s_waitcnt lgkmcnt(8)
    ds_read_b128 v[96:99], v4 offset:2016
    ds_read_b64 v[90:91], v7 offset:648
    v_cvt_pkrtz_f16_f32 v108, v108, v36
    v_cvt_pkrtz_f16_f32 v109, v109, v37
    v_mfma_f32_16x16x32_f16 v[92:95], v[112:115], v[16:19], v[92:95]
    s_waitcnt lgkmcnt(9)
    ds_read_b64 v[100:101], v7 offset:192
    v_cvt_pkrtz_f16_f32 v110, v110, v38
    v_cvt_pkrtz_f16_f32 v111, v111, v39
    v_mfma_f32_16x16x32_f16 v[92:95], v[60:63], v[104:107], v[92:95]
    s_waitcnt lgkmcnt(7)
    ds_read_b64 v[16:17], v7 offset:0
    ds_read_b64 v[102:103], v7 offset:200
    v_cvt_pkrtz_f16_f32 v8, v8, v28
    v_cvt_pkrtz_f16_f32 v9, v9, v29
    v_mfma_f32_16x16x32_f16 v[92:95], v[72:75], v[124:127], v[92:95]
    s_waitcnt lgkmcnt(8)
    ds_read_b64 v[18:19], v7 offset:8
    ds_read_b64 v[36:37], v7 offset:64
    v_cvt_pkrtz_f16_f32 v10, v10, v30
    v_cvt_pkrtz_f16_f32 v11, v11, v31
    v_mfma_f32_16x16x32_f16 v[104:107], v[80:83], v[44:47], 0
    ds_read_b64 v[38:39], v7 offset:72
    ds_read_b64 v[122:123], v6 offset:136
    v_mfma_f32_16x16x32_f16 v[124:127], v[80:83], v[48:51], 0
    s_waitcnt lgkmcnt(10)
    v_cmp_gt_u32 vcc, 2, v5
    s_cbranch_vccz L_x2_70
    s_mov_b32 s46, 0
L_sp_71:
    ds_read_b32 v5, v3 offset:56
    s_waitcnt lgkmcnt(0)
    v_cmp_gt_u32 vcc, 2, v5
    s_cbranch_vccz L_spd_72
    s_add_u32 s46, s46, 1
    s_sleep 1
    s_cmp_lt_u32 s46, 400000
    s_cbranch_scc1 L_sp_71
    s_branch L_end
L_spd_72:
L_x2_70:
    v_mfma_f32_16x16x32_f16 v[28:31], v[80:83], v[52:55], 0
    s_waitcnt lgkmcnt(8)
    ds_read_b64 v[52:53], v7 offset:256
    v_cvt_pk_f16_f32 v92, v92, v93
    v_cvt_pk_f16_f32 v93, v94, v95
    v_mfma_f32_16x16x32_f16 v[80:83], v[96:99], v[56:59], 0
    ds_read_b64 v[54:55], v7 offset:264
    ds_write_b64 v1, v[92:93] offset:512
    v_mfma_f32_16x16x32_f16 v[56:59], v[96:99], v[44:47], 0
    s_mov_b64 exec, 1
    ds_add_u32 v3, v0 offset:68
    s_mov_b64 exec, -1
    v_mfma_f32_16x16x32_f16 v[92:95], v[96:99], v[48:51], 0
    s_waitcnt lgkmcnt(7)
    ds_read_b128 v[96:99], v4 offset:2544
    v_cvt_pkrtz_f16_f32 v104, v104, v124
    v_cvt_pkrtz_f16_f32 v105, v105, v125
    v_mfma_f32_16x16x32_f16 v[116:119], v[32:35], v[16:19], v[116:119]
    s_setprio 0
    ds_read_b64 v[32:33], v6 offset:0
    v_cvt_pkrtz_f16_f32 v106, v106, v126
    v_cvt_pkrtz_f16_f32 v107, v107, v127
    v_mfma_f32_16x16x32_f16 v[116:119], v[108:111], v[88:91], v[116:119]
    ds_read_b64 v[34:35], v6 offset:8
    v_cvt_pkrtz_f16_f32 v28, v28, v80
    v_cvt_pkrtz_f16_f32 v29, v29, v81
    v_mfma_f32_16x16x32_f16 v[24:27], v[108:111], v[64:67], v[24:27]
    ds_read_b128 v[124:127], v4 offset:2608
    v_cvt_pkrtz_f16_f32 v30, v30, v82
    v_cvt_pkrtz_f16_f32 v31, v31, v83
    v_mfma_f32_16x16x32_f16 v[116:119], v[8:11], v[100:103], v[116:119]
    s_waitcnt lgkmcnt(9)
    ds_read_b64 v[64:65], v6 offset:64
    v_cvt_pkrtz_f16_f32 v56, v56, v92
    v_cvt_pkrtz_f16_f32 v57, v57, v93
    v_mfma_f32_16x16x32_f16 v[116:119], v[104:107], v[36:39], v[116:119]
    ds_read_b64 v[66:67], v6 offset:72
    ds_read_b64 v[108:109], v6 offset:192
    v_cvt_pkrtz_f16_f32 v58, v58, v94
    v_mfma_f32_16x16x32_f16 v[24:27], v[104:107], v[16:19], v[24:27]
    ds_read_b128 v[80:83], v4 offset:2544
    ds_read_b64 v[110:111], v6 offset:200
    v_cvt_pkrtz_f16_f32 v59, v59, v95
    v_mfma_f32_16x16x32_f16 v[24:27], v[28:31], v[88:91], v[24:27]
    s_waitcnt lgkmcnt(11)
    ds_read_b128 v[8:11], v4 offset:2048
    ds_read_b128 v[16:19], v4 offset:2800
    v_mfma_f32_16x16x32_f16 v[116:119], v[56:59], v[52:55], v[116:119]
    ds_read_b128 v[104:107], v4 offset:2528
    ds_read_b64 v[92:93], v6 offset:256
    v_mfma_f32_16x16x32_f16 v[24:27], v[56:59], v[100:103], v[24:27]
    s_waitcnt lgkmcnt(3)
    ds_read_b64 v[94:95], v6 offset:264
    v_mfma_f32_16x16x32_f16 v[24:27], v[12:15], v[8:11], v[24:27]
    ds_read_b128 v[88:91], v4 offset:2672
    ds_read_b128 v[28:31], v4 offset:2864
    v_mfma_f32_16x16x32_f16 v[116:119], v[32:35], v[96:99], v[116:119]
    ds_read_b128 v[100:103], v4 offset:2736
    ds_read_b64 v[56:57], v6 offset:320
    v_mfma_f32_16x16x32_f16 v[116:119], v[64:67], v[124:127], v[116:119]
    ds_read_b64 v[58:59], v6 offset:328
    v_mfma_f32_16x16x32_f16 v[12:15], v[80:83], v[44:47], 0
    ds_read_b64 v[8:9], v6 offset:384
    v_mfma_f32_16x16x32_f16 v[96:99], v[80:83], v[48:51], 0
    s_waitcnt lgkmcnt(8)
    ds_read_b64 v[10:11], v6 offset:392
    v_mfma_f32_16x16x32_f16 v[124:127], v[104:107], v[44:47], 0
    v_mfma_f32_16x16x32_f16 v[80:83], v[104:107], v[48:51], 0
    s_waitcnt lgkmcnt(6)
    ds_read_b128 v[104:107], v4 offset:2928
    v_mfma_f32_16x16x32_f16 v[116:119], v[120:123], v[88:91], v[116:119]
    s_waitcnt lgkmcnt(5)
    ds_read_b64 v[90:91], v6 offset:456
    v_cvt_pkrtz_f16_f32 v12, v12, v96
    v_cvt_pkrtz_f16_f32 v13, v13, v97
    v_mfma_f32_16x16x32_f16 v[116:119], v[108:111], v[100:103], v[116:119]
    ds_read_b64 v[88:89], v6 offset:448
    ds_read_b128 v[100:103], v4 offset:2992
    v_cvt_pkrtz_f16_f32 v14, v14, v98
    v_mfma_f32_16x16x32_f16 v[116:119], v[92:95], v[16:19], v[116:119]
    s_waitcnt lgkmcnt(6)
    ds_read_b64 v[16:17], v7 offset:128
    ds_read_b64 v[18:19], v7 offset:136
    v_cvt_pkrtz_f16_f32 v15, v15, v99
    v_mfma_f32_16x16x32_f16 v[116:119], v[56:59], v[28:31], v[116:119]
    s_waitcnt lgkmcnt(5)
    ds_read_b64 v[96:97], v7 offset:320
    ds_read_b64 v[98:99], v7 offset:328
    v_cvt_pkrtz_f16_f32 v124, v124, v80
    v_mfma_f32_16x16x32_f16 v[116:119], v[8:11], v[104:107], v[116:119]
    s_waitcnt lgkmcnt(4)
    ds_read_b64 v[28:29], v6 offset:512
    ds_read_b128 v[104:107], v4 offset:3056
    v_cvt_pkrtz_f16_f32 v125, v125, v81
    v_mfma_f32_16x16x32_f16 v[116:119], v[88:91], v[100:103], v[116:119]
    s_waitcnt lgkmcnt(4)
    ds_read_b128 v[100:103], v4 offset:3120
    v_cvt_pkrtz_f16_f32 v126, v126, v82
    v_mfma_f32_16x16x32_f16 v[116:119], v[12:15], v[16:19], v[116:119]
    ds_read_b64 v[30:31], v6 offset:520
    v_cvt_pkrtz_f16_f32 v127, v127, v83
    v_mfma_f32_16x16x32_f16 v[24:27], v[12:15], v[36:39], v[24:27]
    s_waitcnt lgkmcnt(4)
    ds_read_b128 v[80:83], v4 offset:3184
    v_mfma_f32_16x16x32_f16 v[116:119], v[124:127], v[96:99], v[116:119]
    v_mfma_f32_16x16x32_f16 v[24:27], v[124:127], v[52:55], v[24:27]
    s_waitcnt lgkmcnt(1)
    ds_read_b128 v[36:39], v4 offset:3248
    v_mfma_f32_16x16x32_f16 v[116:119], v[28:31], v[104:107], v[116:119]
    v_mfma_f32_16x16x32_f16 v[24:27], v[32:35], v[104:107], v[24:27]
    ds_read_b128 v[12:15], v4 offset:3312
    v_mfma_f32_16x16x32_f16 v[116:119], v[40:43], v[100:103], v[116:119]
    v_mfma_f32_16x16x32_f16 v[24:27], v[64:67], v[100:103], v[24:27]
    s_waitcnt lgkmcnt(2)
    ds_read_b128 v[52:55], v4 offset:3376
    v_mfma_f32_16x16x32_f16 v[116:119], v[68:71], v[80:83], v[116:119]
    v_mfma_f32_16x16x32_f16 v[24:27], v[120:123], v[80:83], v[24:27]
    s_waitcnt lgkmcnt(2)
    ds_read_b128 v[124:127], v4 offset:3440
    v_mfma_f32_16x16x32_f16 v[116:119], v[76:79], v[36:39], v[116:119]
    v_mfma_f32_16x16x32_f16 v[24:27], v[108:111], v[36:39], v[24:27]
    s_waitcnt lgkmcnt(2)
    ds_read_b128 v[32:35], v4 offset:3504
    v_mfma_f32_16x16x32_f16 v[116:119], v[84:87], v[12:15], v[116:119]
    v_mfma_f32_16x16x32_f16 v[24:27], v[92:95], v[12:15], v[24:27]
    s_waitcnt lgkmcnt(2)
    ds_read_b128 v[104:107], v4 offset:3568
    v_mfma_f32_16x16x32_f16 v[116:119], v[20:23], v[52:55], v[116:119]
    ds_read_b128 v[64:67], v4 offset:3632
    v_mfma_f32_16x16x32_f16 v[24:27], v[56:59], v[52:55], v[24:27]
    s_waitcnt lgkmcnt(3)
    ds_read_b128 v[100:103], v4 offset:3696
    v_mfma_f32_16x16x32_f16 v[116:119], v[112:115], v[124:127], v[116:119]
    ds_read_b128 v[120:123], v4 offset:3056
    v_mfma_f32_16x16x32_f16 v[24:27], v[8:11], v[124:127], v[24:27]
    s_waitcnt lgkmcnt(4)
    ds_read_b128 v[80:83], v4 offset:3040
    v_mfma_f32_16x16x32_f16 v[116:119], v[60:63], v[32:35], v[116:119]
    ds_read_b128 v[108:111], v4 offset:3760
    v_mfma_f32_16x16x32_f16 v[24:27], v[88:91], v[32:35], v[24:27]
    s_waitcnt lgkmcnt(5)
    ds_read_b128 v[36:39], v4 offset:3824
    v_mfma_f32_16x16x32_f16 v[116:119], v[72:75], v[104:107], v[116:119]
    ds_read_b128 v[92:95], v4 offset:3888
    v_mfma_f32_16x16x32_f16 v[24:27], v[28:31], v[104:107], v[24:27]
    s_waitcnt lgkmcnt(6)
    ds_read_b128 v[12:15], v4 offset:3952
    v_mfma_f32_16x16x32_f16 v[24:27], v[40:43], v[64:67], v[24:27]
    s_waitcnt lgkmcnt(6)
    ds_read_b128 v[56:59], v4 offset:4016
    v_mfma_f32_16x16x32_f16 v[24:27], v[68:71], v[100:103], v[24:27]
    s_waitcnt lgkmcnt(6)
    v_cvt_pk_f16_f32 v116, v116, v117
    v_cvt_pk_f16_f32 v117, v118, v119
    v_mfma_f32_16x16x32_f16 v[52:55], v[120:123], v[44:47], 0
    s_waitcnt lgkmcnt(5)
    ds_write_b64 v1, v[116:117] offset:1024
    v_mfma_f32_16x16x32_f16 v[8:11], v[120:123], v[48:51], 0
    s_mov_b64 exec, 1
    ds_add_u32 v3, v0 offset:72
    s_mov_b64 exec, -1
    v_mfma_f32_16x16x32_f16 v[124:127], v[80:83], v[44:47], 0
    ds_read_b128 v[88:91], v4 offset:4080
    v_mfma_f32_16x16x32_f16 v[32:35], v[80:83], v[48:51], 0
    s_waitcnt lgkmcnt(7)
    v_mfma_f32_16x16x32_f16 v[24:27], v[76:79], v[108:111], v[24:27]
    s_waitcnt lgkmcnt(6)
    v_cvt_pkrtz_f16_f32 v52, v52, v8
    v_cvt_pkrtz_f16_f32 v53, v53, v9
    v_mfma_f32_16x16x32_f16 v[24:27], v[84:87], v[36:39], v[24:27]
    s_waitcnt lgkmcnt(5)
    v_cvt_pkrtz_f16_f32 v54, v54, v10
    v_cvt_pkrtz_f16_f32 v55, v55, v11
    v_mfma_f32_16x16x32_f16 v[24:27], v[20:23], v[92:95], v[24:27]
    s_waitcnt lgkmcnt(4)
    v_cvt_pkrtz_f16_f32 v124, v124, v32
    v_mfma_f32_16x16x32_f16 v[24:27], v[112:115], v[12:15], v[24:27]
    s_waitcnt lgkmcnt(3)
    v_cvt_pkrtz_f16_f32 v125, v125, v33
    v_mfma_f32_16x16x32_f16 v[24:27], v[60:63], v[56:59], v[24:27]
    s_waitcnt lgkmcnt(0)
    v_cvt_pkrtz_f16_f32 v126, v126, v34
    v_mfma_f32_16x16x32_f16 v[24:27], v[72:75], v[88:91], v[24:27]
    v_cvt_pkrtz_f16_f32 v127, v127, v35
    v_mfma_f32_16x16x32_f16 v[24:27], v[52:55], v[16:19], v[24:27]
    s_nop 0
    v_mfma_f32_16x16x32_f16 v[24:27], v[124:127], v[96:99], v[24:27]
    s_nop 7
    v_cvt_pk_f16_f32 v24, v24, v25
    v_cvt_pk_f16_f32 v25, v26, v27
    ds_write_b64 v1, v[24:25] offset:1536
    s_mov_b64 exec, 1
    ds_add_u32 v3, v0 offset:76
    s_mov_b64 exec, -1
    s_branch L_fin
L_set1_67:
    ds_read_b64 v[32:33], v7 offset:128
    ds_read_b64 v[34:35], v7 offset:136
    ds_read_b64 v[36:37], v7 offset:64
    ds_read_b64 v[38:39], v7 offset:72
    ds_read_b64 v[40:41], v7 offset:0
    ds_read_b64 v[42:43], v7 offset:8
    ds_read_b64 v[60:61], v7 offset:640
    ds_read_b64 v[62:63], v7 offset:648
    ds_read_b64 v[64:65], v7 offset:576
    ds_read_b64 v[66:67], v7 offset:584
    ds_read_b64 v[68:69], v7 offset:320
    ds_read_b64 v[70:71], v7 offset:328
    ds_read_b64 v[72:73], v7 offset:256
    ds_read_b64 v[74:75], v7 offset:264
    ds_read_b64 v[76:77], v7 offset:192
    ds_read_b64 v[78:79], v7 offset:200
    ds_read_b64 v[80:81], v6 offset:0
    ds_read_b64 v[82:83], v6 offset:8
    ds_read_b64 v[84:85], v6 offset:64
    ds_read_b64 v[86:87], v6 offset:72
    s_mov_b32 s46, 0
L_sp_73:
    ds_read_b32 v5, v3 offset:48
    s_waitcnt lgkmcnt(0)
    v_cmp_gt_u32_e64 vcc, 2, v5
    s_cbranch_vccz L_spd_74
    s_add_u32 s46, s46, 1
    s_sleep 2
    s_cmp_lt_u32 s46, 400000
    s_cbranch_scc1 L_sp_73
    s_branch L_end
    s_nop 0
L_spd_74:
    s_setprio 2
    ds_read_b128 v[8:11], v4 offset:496
    ds_read_b128 v[16:19], v4 offset:480
    ds_read_b128 v[20:23], v4 offset:512
    s_waitcnt lgkmcnt(2)
    v_mfma_f32_16x16x32_f16 v[24:27], v[8:11], v[44:47], 0
    ds_read_b128 v[28:31], v4 offset:1024
    v_mfma_f32_16x16x32_f16 v[88:91], v[8:11], v[48:51], 0
    ds_read_b128 v[92:95], v4 offset:1008
    v_mfma_f32_16x16x32_f16 v[96:99], v[8:11], v[52:55], 0
    s_waitcnt lgkmcnt(3)
    v_mfma_f32_16x16x32_f16 v[100:103], v[16:19], v[56:59], 0
    v_mfma_f32_16x16x32_f16 v[104:107], v[16:19], v[44:47], 0
    ds_read_b128 v[108:111], v4 offset:992
    s_nop 1
    v_cvt_pkrtz_f16_f32 v24, v24, v88
    v_mfma_f32_16x16x32_f16 v[112:115], v[16:19], v[48:51], 0
    s_waitcnt lgkmcnt(3)
    v_cvt_pkrtz_f16_f32 v25, v25, v89
    v_mfma_f32_16x16x32_f16 v[116:119], v[12:15], v[20:23], 0
    s_waitcnt lgkmcnt(2)
    v_cvt_pkrtz_f16_f32 v26, v26, v90
    v_mfma_f32_16x16x32_f16 v[120:123], v[12:15], v[28:31], 0
    s_waitcnt lgkmcnt(1)
    v_cvt_pkrtz_f16_f32 v27, v27, v91
    v_mfma_f32_16x16x32_f16 v[124:127], v[92:95], v[44:47], 0
    v_cvt_pkrtz_f16_f32 v96, v96, v100
    v_mfma_f32_16x16x32_f16 v[8:11], v[92:95], v[48:51], 0
    v_cvt_pkrtz_f16_f32 v97, v97, v101
    v_mfma_f32_16x16x32_f16 v[16:19], v[92:95], v[52:55], 0
    s_waitcnt lgkmcnt(0)
    v_cvt_pkrtz_f16_f32 v98, v98, v102
    v_mfma_f32_16x16x32_f16 v[20:23], v[108:111], v[56:59], 0
    ds_read_b128 v[12:15], v4 offset:496
    v_cvt_pkrtz_f16_f32 v99, v99, v103
    v_mfma_f32_16x16x32_f16 v[28:31], v[108:111], v[44:47], 0
    ds_read_b128 v[88:91], v4 offset:624
    v_cvt_pkrtz_f16_f32 v104, v104, v112
    v_mfma_f32_16x16x32_f16 v[52:55], v[108:111], v[48:51], 0
    ds_read_b64 v[92:93], v6 offset:128
    v_cvt_pkrtz_f16_f32 v105, v105, v113
    v_mfma_f32_16x16x32_f16 v[56:59], v[24:27], v[32:35], 0
    ds_read_b64 v[94:95], v6 offset:136
    v_cvt_pkrtz_f16_f32 v106, v106, v114
    v_mfma_f32_16x16x32_f16 v[100:103], v[24:27], v[36:39], 0
    ds_read_b64 v[108:109], v6 offset:192
    v_cvt_pkrtz_f16_f32 v107, v107, v115
    v_mfma_f32_16x16x32_f16 v[116:119], v[24:27], v[40:43], v[116:119]
    ds_read_b128 v[112:115], v4 offset:560
    ds_read_b64 v[110:111], v6 offset:200
    v_cvt_pkrtz_f16_f32 v124, v124, v8
    v_mfma_f32_16x16x32_f16 v[116:119], v[96:99], v[60:63], v[116:119]
    ds_read_b128 v[24:27], v4 offset:816
    v_cvt_pkrtz_f16_f32 v125, v125, v9
    v_mfma_f32_16x16x32_f16 v[120:123], v[96:99], v[64:67], v[120:123]
    ds_read_b128 v[64:67], v4 offset:688
    ds_read_b64 v[96:97], v6 offset:320
    v_cvt_pkrtz_f16_f32 v126, v126, v10
    v_mfma_f32_16x16x32_f16 v[56:59], v[104:107], v[68:71], v[56:59]
    ds_read_b64 v[98:99], v6 offset:328
    v_cvt_pkrtz_f16_f32 v127, v127, v11
    v_mfma_f32_16x16x32_f16 v[100:103], v[104:107], v[72:75], v[100:103]
    ds_read_b128 v[8:11], v4 offset:944
    v_cvt_pkrtz_f16_f32 v16, v16, v20
    v_mfma_f32_16x16x32_f16 v[116:119], v[104:107], v[76:79], v[116:119]
    s_waitcnt lgkmcnt(11)
    ds_read_b64 v[104:105], v6 offset:448
    v_cvt_pkrtz_f16_f32 v17, v17, v21
    v_mfma_f32_16x16x32_f16 v[56:59], v[80:83], v[12:15], v[56:59]
    s_waitcnt lgkmcnt(7)
    ds_read_b64 v[106:107], v6 offset:456
    v_cvt_pkrtz_f16_f32 v18, v18, v22
    v_mfma_f32_16x16x32_f16 v[56:59], v[84:87], v[112:115], v[56:59]
    ds_read_b128 v[12:15], v4 offset:1008
    v_cvt_pkrtz_f16_f32 v19, v19, v23
    v_mfma_f32_16x16x32_f16 v[56:59], v[92:95], v[88:91], v[56:59]
    s_waitcnt lgkmcnt(6)
    ds_read_b128 v[112:115], v4 offset:752
    ds_read_b64 v[20:21], v6 offset:512
    v_cvt_pkrtz_f16_f32 v28, v28, v52
    v_mfma_f32_16x16x32_f16 v[56:59], v[108:111], v[64:67], v[56:59]
    ds_read_b64 v[88:89], v6 offset:256
    ds_read_b64 v[22:23], v6 offset:520
    v_cvt_pkrtz_f16_f32 v29, v29, v53
    v_mfma_f32_16x16x32_f16 v[100:103], v[124:127], v[32:35], v[100:103]
    ds_read_b64 v[90:91], v6 offset:264
    ds_read_b64 v[64:65], v6 offset:576
    v_cvt_pkrtz_f16_f32 v30, v30, v54
    v_mfma_f32_16x16x32_f16 v[116:119], v[124:127], v[36:39], v[116:119]
    ds_read_b64 v[66:67], v6 offset:584
    v_cvt_pkrtz_f16_f32 v31, v31, v55
    v_mfma_f32_16x16x32_f16 v[120:123], v[124:127], v[40:43], v[120:123]
    ds_read_b64 v[54:55], v6 offset:392
    ds_read_b128 v[40:43], v4 offset:1136
    v_mfma_f32_16x16x32_f16 v[120:123], v[16:19], v[60:63], v[120:123]
    ds_read_b64 v[52:53], v6 offset:384
    ds_read_b64 v[124:125], v6 offset:640
    v_mfma_f32_16x16x32_f16 v[100:103], v[28:31], v[68:71], v[100:103]
    ds_read_b128 v[60:63], v4 offset:880
    ds_read_b64 v[126:127], v6 offset:648
    v_mfma_f32_16x16x32_f16 v[116:119], v[28:31], v[72:75], v[116:119]
    ds_read_b128 v[16:19], v4 offset:1200
    v_mfma_f32_16x16x32_f16 v[120:123], v[28:31], v[76:79], v[120:123]
    s_waitcnt lgkmcnt(9)
    ds_read_b128 v[76:79], v4 offset:1072
    ds_read_b64 v[28:29], v6 offset:704
    v_mfma_f32_16x16x32_f16 v[56:59], v[88:91], v[112:115], v[56:59]
    ds_read_b64 v[30:31], v6 offset:712
    v_mfma_f32_16x16x32_f16 v[56:59], v[96:99], v[24:27], v[56:59]
    s_waitcnt lgkmcnt(5)
    ds_read_b128 v[112:115], v4 offset:1264
    v_mfma_f32_16x16x32_f16 v[56:59], v[52:55], v[60:63], v[56:59]
    ds_read_b64 v[24:25], v6 offset:768
    v_mfma_f32_16x16x32_f16 v[56:59], v[104:107], v[8:11], v[56:59]
    ds_read_b64 v[26:27], v6 offset:776
    v_mfma_f32_16x16x32_f16 v[56:59], v[20:23], v[12:15], v[56:59]
    ds_read_b128 v[60:63], v4 offset:1328
    v_mfma_f32_16x16x32_f16 v[100:103], v[80:83], v[12:15], v[100:103]
    s_waitcnt lgkmcnt(6)
    ds_read_b64 v[8:9], v6 offset:832
    v_mfma_f32_16x16x32_f16 v[56:59], v[64:67], v[76:79], v[56:59]
    ds_read_b64 v[10:11], v6 offset:840
    v_mfma_f32_16x16x32_f16 v[100:103], v[84:87], v[76:79], v[100:103]
    ds_read_b128 v[12:15], v4 offset:1392
    v_mfma_f32_16x16x32_f16 v[56:59], v[124:127], v[40:43], v[56:59]
    ds_read_b64 v[76:77], v6 offset:896
    v_mfma_f32_16x16x32_f16 v[100:103], v[92:95], v[40:43], v[100:103]
    s_waitcnt lgkmcnt(8)
    ds_read_b64 v[78:79], v6 offset:904
    v_mfma_f32_16x16x32_f16 v[56:59], v[28:31], v[16:19], v[56:59]
    ds_read_b64 v[40:41], v6 offset:960
    v_mfma_f32_16x16x32_f16 v[100:103], v[108:111], v[16:19], v[100:103]
    s_waitcnt lgkmcnt(7)
    ds_read_b128 v[16:19], v4 offset:1456
    ds_read_b64 v[42:43], v6 offset:968
    v_mfma_f32_16x16x32_f16 v[56:59], v[24:27], v[112:115], v[56:59]
    v_mfma_f32_16x16x32_f16 v[100:103], v[88:91], v[112:115], v[100:103]
    s_waitcnt lgkmcnt(6)
    ds_read_b64 v[112:113], v6 offset:1024
    ds_read_b64 v[114:115], v6 offset:1032
    v_mfma_f32_16x16x32_f16 v[56:59], v[8:11], v[60:63], v[56:59]
    v_mfma_f32_16x16x32_f16 v[100:103], v[96:99], v[60:63], v[100:103]
    s_waitcnt lgkmcnt(5)
    ds_read_b128 v[60:63], v4 offset:1520
    v_mfma_f32_16x16x32_f16 v[56:59], v[76:79], v[12:15], v[56:59]
    v_mfma_f32_16x16x32_f16 v[100:103], v[52:55], v[12:15], v[100:103]
    s_waitcnt lgkmcnt(3)
    ds_read_b128 v[12:15], v4 offset:1584
    v_mfma_f32_16x16x32_f16 v[56:59], v[40:43], v[16:19], v[56:59]
    v_mfma_f32_16x16x32_f16 v[100:103], v[104:107], v[16:19], v[100:103]
    s_waitcnt lgkmcnt(1)
    ds_read_b128 v[16:19], v4 offset:1648
    v_mfma_f32_16x16x32_f16 v[56:59], v[112:115], v[60:63], v[56:59]
    v_mfma_f32_16x16x32_f16 v[100:103], v[20:23], v[60:63], v[100:103]
    v_mfma_f32_16x16x32_f16 v[116:119], v[80:83], v[60:63], v[116:119]
    s_waitcnt lgkmcnt(1)
    ds_read_b128 v[60:63], v4 offset:1712
    v_mfma_f32_16x16x32_f16 v[100:103], v[64:67], v[12:15], v[100:103]
    s_nop 2
    v_cvt_pk_f16_f32 v56, v56, v57
    v_cvt_pk_f16_f32 v57, v58, v59
    v_mfma_f32_16x16x32_f16 v[116:119], v[84:87], v[12:15], v[116:119]
    s_waitcnt lgkmcnt(1)
    ds_read_b128 v[12:15], v4 offset:1776
    ds_write_b64 v1, v[56:57] offset:0
    v_mfma_f32_16x16x32_f16 v[100:103], v[124:127], v[16:19], v[100:103]
    s_mov_b64 exec, 1
    ds_add_u32 v3, v0 offset:64
    s_mov_b64 exec, -1
    v_mfma_f32_16x16x32_f16 v[116:119], v[92:95], v[16:19], v[116:119]
    s_waitcnt lgkmcnt(3)
    ds_read_b128 v[56:59], v4 offset:1904
    v_mfma_f32_16x16x32_f16 v[100:103], v[28:31], v[60:63], v[100:103]
    s_setprio 1
    ds_read_b32 v5, v3 offset:56
    v_mfma_f32_16x16x32_f16 v[116:119], v[108:111], v[60:63], v[116:119]
    s_waitcnt lgkmcnt(4)
    ds_read_b128 v[16:19], v4 offset:1968
    v_mfma_f32_16x16x32_f16 v[100:103], v[24:27], v[12:15], v[100:103]
    ds_read_b128 v[60:63], v4 offset:1840
    v_mfma_f32_16x16x32_f16 v[116:119], v[88:91], v[12:15], v[116:119]
    s_waitcnt lgkmcnt(0)
    ds_read_b128 v[12:15], v4 offset:2032
    v_mfma_f32_16x16x32_f16 v[100:103], v[8:11], v[60:63], v[100:103]
    v_mfma_f32_16x16x32_f16 v[116:119], v[96:99], v[60:63], v[116:119]
    v_cmp_gt_u32 vcc, 2, v5
    s_cbranch_vccz L_x2_75
    s_mov_b32 s46, 0
L_sp_76:
    ds_read_b32 v5, v3 offset:56
    s_waitcnt lgkmcnt(0)
    v_cmp_gt_u32 vcc, 2, v5
    s_cbranch_vccz L_spd_77
    s_add_u32 s46, s46, 1
    s_sleep 1
    s_cmp_lt_u32 s46, 400000
    s_cbranch_scc1 L_sp_76
    s_branch L_end
    s_nop 0
L_spd_77:
L_x2_75:
    v_mfma_f32_16x16x32_f16 v[100:103], v[76:79], v[56:59], v[100:103]
    ds_read_b128 v[60:63], v4 offset:2096
    v_mfma_f32_16x16x32_f16 v[116:119], v[52:55], v[56:59], v[116:119]
    v_mfma_f32_16x16x32_f16 v[100:103], v[40:43], v[16:19], v[100:103]
    ds_read_b128 v[56:59], v4 offset:2160
    v_mfma_f32_16x16x32_f16 v[116:119], v[104:107], v[16:19], v[116:119]
    s_waitcnt lgkmcnt(2)
    v_mfma_f32_16x16x32_f16 v[100:103], v[112:115], v[12:15], v[100:103]
    ds_read_b128 v[16:19], v4 offset:2224
    v_mfma_f32_16x16x32_f16 v[116:119], v[20:23], v[12:15], v[116:119]
    v_mfma_f32_16x16x32_f16 v[120:123], v[80:83], v[12:15], v[120:123]
    s_waitcnt lgkmcnt(2)
    ds_read_b128 v[80:83], v4 offset:1520
    ds_read_b128 v[12:15], v4 offset:1504
    v_mfma_f32_16x16x32_f16 v[116:119], v[64:67], v[60:63], v[116:119]
    s_nop 0
    v_cvt_pk_f16_f32 v100, v100, v101
    v_cvt_pk_f16_f32 v101, v102, v103
    v_mfma_f32_16x16x32_f16 v[120:123], v[84:87], v[60:63], v[120:123]
    s_waitcnt lgkmcnt(3)
    ds_write_b64 v1, v[100:101] offset:512
    v_mfma_f32_16x16x32_f16 v[116:119], v[124:127], v[56:59], v[116:119]
    s_mov_b64 exec, 1
    ds_add_u32 v3, v0 offset:68
    s_mov_b64 exec, -1
    v_mfma_f32_16x16x32_f16 v[120:123], v[92:95], v[56:59], v[120:123]
    s_waitcnt lgkmcnt(4)
    ds_read_b128 v[84:87], v4 offset:2288
    v_mfma_f32_16x16x32_f16 v[116:119], v[28:31], v[16:19], v[116:119]
    s_setprio 0
    v_mfma_f32_16x16x32_f16 v[120:123], v[108:111], v[16:19], v[120:123]
    s_waitcnt lgkmcnt(4)
    ds_read_b128 v[60:63], v4 offset:2352
    v_mfma_f32_16x16x32_f16 v[100:103], v[80:83], v[44:47], 0
    v_mfma_f32_16x16x32_f16 v[92:95], v[80:83], v[48:51], 0
    s_waitcnt lgkmcnt(4)
    ds_read_b128 v[56:59], v4 offset:2416
    v_mfma_f32_16x16x32_f16 v[108:111], v[12:15], v[44:47], 0
    v_mfma_f32_16x16x32_f16 v[16:19], v[12:15], v[48:51], 0
    s_waitcnt lgkmcnt(2)
    ds_read_b128 v[80:83], v4 offset:2480
    v_mfma_f32_16x16x32_f16 v[116:119], v[24:27], v[84:87], v[116:119]
    s_nop 0
    v_cvt_pkrtz_f16_f32 v100, v100, v92
    v_mfma_f32_16x16x32_f16 v[120:123], v[88:91], v[84:87], v[120:123]
    s_waitcnt lgkmcnt(2)
    ds_read_b128 v[12:15], v4 offset:2544
    v_cvt_pkrtz_f16_f32 v101, v101, v93
    v_mfma_f32_16x16x32_f16 v[116:119], v[8:11], v[60:63], v[116:119]
    v_cvt_pkrtz_f16_f32 v102, v102, v94
    v_mfma_f32_16x16x32_f16 v[120:123], v[96:99], v[60:63], v[120:123]
    s_waitcnt lgkmcnt(2)
    v_cvt_pkrtz_f16_f32 v103, v103, v95
    v_mfma_f32_16x16x32_f16 v[116:119], v[76:79], v[56:59], v[116:119]
    v_cvt_pkrtz_f16_f32 v108, v108, v16
    v_mfma_f32_16x16x32_f16 v[120:123], v[52:55], v[56:59], v[120:123]
    s_waitcnt lgkmcnt(1)
    v_cvt_pkrtz_f16_f32 v109, v109, v17
    v_mfma_f32_16x16x32_f16 v[116:119], v[40:43], v[80:83], v[116:119]
    ds_read_b128 v[88:91], v4 offset:2608
    v_cvt_pkrtz_f16_f32 v110, v110, v18
    v_mfma_f32_16x16x32_f16 v[120:123], v[104:107], v[80:83], v[120:123]
    s_waitcnt lgkmcnt(1)
    ds_read_b128 v[84:87], v4 offset:2672
    v_cvt_pkrtz_f16_f32 v111, v111, v19
    v_mfma_f32_16x16x32_f16 v[116:119], v[112:115], v[12:15], v[116:119]
    ds_read_b128 v[96:99], v4 offset:2032
    v_mfma_f32_16x16x32_f16 v[120:123], v[20:23], v[12:15], v[120:123]
    ds_read_b128 v[60:63], v4 offset:2016
    v_mfma_f32_16x16x32_f16 v[116:119], v[100:103], v[32:35], v[116:119]
    ds_read_b128 v[92:95], v4 offset:2736
    v_mfma_f32_16x16x32_f16 v[120:123], v[100:103], v[36:39], v[120:123]
    ds_read_b128 v[52:55], v4 offset:2800
    v_mfma_f32_16x16x32_f16 v[116:119], v[108:111], v[68:71], v[116:119]
    ds_read_b128 v[56:59], v4 offset:2864
    v_mfma_f32_16x16x32_f16 v[120:123], v[108:111], v[72:75], v[120:123]
    s_waitcnt lgkmcnt(6)
    ds_read_b128 v[104:107], v4 offset:2928
    v_mfma_f32_16x16x32_f16 v[120:123], v[64:67], v[88:91], v[120:123]
    s_waitcnt lgkmcnt(6)
    ds_read_b128 v[80:83], v4 offset:2992
    v_mfma_f32_16x16x32_f16 v[120:123], v[124:127], v[84:87], v[120:123]
    s_waitcnt lgkmcnt(6)
    v_cvt_pk_f16_f32 v116, v116, v117
    v_cvt_pk_f16_f32 v117, v118, v119
    v_mfma_f32_16x16x32_f16 v[16:19], v[96:99], v[44:47], 0
    s_waitcnt lgkmcnt(5)
    ds_write_b64 v1, v[116:117] offset:1024
    v_mfma_f32_16x16x32_f16 v[20:23], v[96:99], v[48:51], 0
    s_mov_b64 exec, 1
    ds_add_u32 v3, v0 offset:72
    s_mov_b64 exec, -1
    v_mfma_f32_16x16x32_f16 v[12:15], v[60:63], v[44:47], 0
    ds_read_b128 v[36:39], v4 offset:3056
    v_mfma_f32_16x16x32_f16 v[100:103], v[60:63], v[48:51], 0
    s_waitcnt lgkmcnt(7)
    v_mfma_f32_16x16x32_f16 v[120:123], v[28:31], v[92:95], v[120:123]
    s_waitcnt lgkmcnt(6)
    v_cvt_pkrtz_f16_f32 v16, v16, v20
    v_cvt_pkrtz_f16_f32 v17, v17, v21
    v_mfma_f32_16x16x32_f16 v[120:123], v[24:27], v[52:55], v[120:123]
    s_waitcnt lgkmcnt(5)
    v_cvt_pkrtz_f16_f32 v18, v18, v22
    v_cvt_pkrtz_f16_f32 v19, v19, v23
    v_mfma_f32_16x16x32_f16 v[120:123], v[8:11], v[56:59], v[120:123]
    s_waitcnt lgkmcnt(4)
    v_cvt_pkrtz_f16_f32 v12, v12, v100
    v_mfma_f32_16x16x32_f16 v[120:123], v[76:79], v[104:107], v[120:123]
    s_waitcnt lgkmcnt(3)
    v_cvt_pkrtz_f16_f32 v13, v13, v101
    v_mfma_f32_16x16x32_f16 v[120:123], v[40:43], v[80:83], v[120:123]
    s_waitcnt lgkmcnt(0)
    v_cvt_pkrtz_f16_f32 v14, v14, v102
    v_mfma_f32_16x16x32_f16 v[120:123], v[112:115], v[36:39], v[120:123]
    v_cvt_pkrtz_f16_f32 v15, v15, v103
    v_mfma_f32_16x16x32_f16 v[120:123], v[16:19], v[32:35], v[120:123]
    s_nop 0
    v_mfma_f32_16x16x32_f16 v[120:123], v[12:15], v[68:71], v[120:123]
    s_nop 7
    v_cvt_pk_f16_f32 v120, v120, v121
    v_cvt_pk_f16_f32 v121, v122, v123
    ds_write_b64 v1, v[120:121] offset:1536
    s_mov_b64 exec, 1
    ds_add_u32 v3, v0 offset:76
    s_mov_b64 exec, -1
L_fin:
L_end:
    s_endpgm
L_codeend:
.section .rodata,"a"
.p2align 6
.amdhsa_kernel recurrent_scan__ssm_conv_s4d__moe_arch_mod__prompt_kernel
  .amdhsa_next_free_vgpr 128
  .amdhsa_next_free_sgpr 102
  .amdhsa_accum_offset 128
  .amdhsa_group_segment_fixed_size 0
  .amdhsa_kernarg_size 120
  .amdhsa_user_sgpr_count 2
  .amdhsa_user_sgpr_kernarg_segment_ptr 1
  .amdhsa_system_sgpr_workgroup_id_x 1
  .amdhsa_float_denorm_mode_32 3
.end_amdhsa_kernel
```

```asm
; @launch grid=(256,1,1) block=(1024,1,1) lds=161280
.amdgcn_target "amdgcn-amd-amdhsa--gfx950"
.text
.globl recurrent_scan__ssm_conv_s4d__moe_arch_mod__prompt_kernel
.p2align 12
.p2align 8
.type recurrent_scan__ssm_conv_s4d__moe_arch_mod__prompt_kernel,@function
recurrent_scan__ssm_conv_s4d__moe_arch_mod__prompt_kernel:
    s_cmp_ge_u32 s2, 256
    s_nop 0
    s_cbranch_scc1 L_end
    s_load_dwordx16 s[4:19], s[0:1], 0
    s_load_dwordx8 s[20:27], s[0:1], 64
    s_load_dwordx4 s[28:31], s[0:1], 96
    s_load_dwordx2 s[32:33], s[0:1], 112
    s_getpc_b64 s[62:63]
L_pc:
    v_readfirstlane_b32 s3, v0
    v_and_b32 v1, 63, v0
    v_mov_b32 v3, 0
    v_lshlrev_b32 v2, 4, v1
    s_and_b32 s35, s2, 7
    s_lshr_b32 s36, s2, 3
    s_lshr_b32 s3, s3, 6
    s_and_b32 s40, s36, 15
    s_lshl4_add_u32 s37, s35, s40
    s_lshr_b32 s38, s36, 4
    s_xor_b32 s38, s38, 1
    s_and_b32 s34, s3, 3
    s_cmp_ge_u32 s3, 4
    s_cbranch_scc1 L_p1
    s_setprio 3
    s_lshl_b32 s40, s2, 14
    s_lshl_b32 s41, s34, 9
    v_lshrrev_b32_e64 v118, 3, v1
    v_and_b32 v113, 112, v2
    v_add_u32_e64 v113, s41, v113
    v_lshl_add_u32 v112, v118, 11, v113
    v_add_u32 v112, s40, v112
    s_waitcnt lgkmcnt(0)
    s_load_dword s47, s[32:33], 0
    global_load_dwordx4 v[32:35], v113, s[20:21] offset:0
    global_load_dwordx4 v[36:39], v113, s[20:21] offset:128
    global_load_dwordx4 v[40:43], v113, s[20:21] offset:256
    global_load_dwordx4 v[44:47], v113, s[20:21] offset:384
    global_load_dwordx4 v[16:19], v112, s[4:5] offset:0 nt
    global_load_dwordx4 v[20:23], v112, s[4:5] offset:128 nt
    global_load_dwordx4 v[24:27], v112, s[4:5] offset:256 nt
    global_load_dwordx4 v[28:31], v112, s[4:5] offset:384 nt
    s_barrier
    s_branch L_tok
    s_nop 0
L_p1:
    s_cmp_ge_u32 s3, 8
    s_cbranch_scc1 L_p2
    s_and_b32 s40, s36, 3
    s_lshl2_add_u32 s40, s40, s34
    s_lshl_b32 s40, s40, 11
    v_and_b32 v0, 15, v1
    v_lshl_add_u32 v0, v0, 7, s40
    v_cmp_gt_u32 vcc, L_codeend-L_pc-4, v0
    s_nop 1
    v_cndmask_b32 v0, v3, v0, vcc
    global_load_dword v31, v0, s[62:63]
    s_lshl_b32 s40, s34, 7
    s_and_b32 s41, s40, 128
    s_add_u32 s40, s40, 384
    v_cmp_gt_u32 vcc, 32, v1
    v_mov_b32 v32, s40
    v_mov_b32 v33, s41
    v_cndmask_b32 v32, v33, v32, vcc
    v_cndmask_b32 v34, 0, -1, vcc
    v_lshl_add_u32 v32, v1, 2, v32
    v_subrev_u32 v32, 128, v32
    ds_write_b32 v32, v34
    s_waitcnt lgkmcnt(0)
    s_barrier
    s_branch L_exp
L_p2:
    s_lshl2_add_u32 s60, s38, s34
    s_bfe_u32 s59, s3, 0x10002
    s_lshl_b32 s40, s59, 2
    s_xor_b32 s34, s60, s40
    v_and_b32 v32, 15, v1
    v_lshrrev_b32 v33, 4, v1
    s_cmp_ge_u32 s34, 5
    s_cbranch_scc1 L_q5
    s_lshl_b32 s40, s34, 2
    s_lshr_b32 s41, 0xccb5a, s40
    s_and_b32 s41, s41, 15
    s_add_u32 s41, s41, 40
    s_lshr_b32 s45, 0x29735, s40
    s_and_b32 s45, s45, 15
    s_bfm_b32 s45, s45, 0
    s_mov_b32 s44, 0
    v_lshl_add_u32 v86, v33, 3, v32
    v_sub_u32_e64 v86, s41, v86
    v_lshrrev_b64 v[86:87], v86, s[44:45]
    s_mov_b32 s43, 0xffff
    v_bfe_i32 v36, v86, 0, 1
    v_bfe_i32 v87, v86, 1, 1
    v_bfi_b32 v36, s43, v36, v87
    v_and_b32 v36, 0x3c003c00, v36
    v_bfe_i32 v37, v86, 2, 1
    v_bfe_i32 v87, v86, 3, 1
    v_bfi_b32 v37, s43, v37, v87
    v_and_b32 v37, 0x3c003c00, v37
    v_bfe_i32 v38, v86, 4, 1
    v_bfe_i32 v87, v86, 5, 1
    v_bfi_b32 v38, s43, v38, v87
    v_and_b32 v38, 0x3c003c00, v38
    v_bfe_i32 v39, v86, 6, 1
    v_bfe_i32 v87, v86, 7, 1
    v_bfi_b32 v39, s43, v39, v87
    v_and_b32 v39, 0x3c003c00, v39
    s_branch L_qw
    s_nop 0
L_q5:
    s_cmp_ge_u32 s34, 6
    s_cbranch_scc1 L_q6
    v_lshlrev_b32 v85, 1, v32
    v_sub_u32 v85, v85, v33
    v_lshl_add_u32 v36, v85, 4, 48
    v_and_b32 v86, 1, v1
    v_cmp_eq_u32 vcc, 0, v86
    v_mov_b32 v85, 0x03020706
    v_mov_b32 v87, 0x05040100
    v_cndmask_b32_e64 v37, v85, v87, vcc
    v_mov_b32 v85, 4412
    v_mov_b32 v87, 5312
    v_cndmask_b32 v85, v85, v87, vcc
    v_lshlrev_b32 v86, 2, v33
    v_sub_u32 v86, v86, v32
    v_lshl_add_u32 v39, v86, 2, v85
    v_sub_u32 v85, 3, v32
    v_and_b32_e64 v85, 3, v85
    v_mul_u32_u24 v85, 1086, v85
    v_lshl_add_u32 v86, v33, 3, v32
    v_sub_u32_e64 v86, 39, v86
    v_lshl_add_u32 v38, v86, 1, v85
    s_branch L_qw
L_q6:
    s_cmp_ge_u32 s34, 7
    s_cbranch_scc1 L_q7
    v_and_b32 v31, 31, v1
    v_mov_b32 v85, 0
    v_cmp_gt_u32 vcc, 24, v31
    v_mov_b32 v86, 0x9876a987
    s_nop 0
    v_cndmask_b32 v85, v85, v86, vcc
    v_cmp_gt_u32 vcc, 16, v31
    v_mov_b32 v86, 0x54aa6543
    s_nop 0
    v_cndmask_b32 v85, v85, v86, vcc
    v_cmp_gt_u32 vcc, 8, v31
    v_mov_b32 v86, 0x2113210
    s_nop 0
    v_cndmask_b32 v85, v85, v86, vcc
    v_lshlrev_b32_e64 v86, 2, v31
    v_bfe_u32 v85, v85, v86, 4
    s_mov_b32 s41, 0xf00f0ff0
    v_bfe_u32 v86, s41, v31, 1
    v_mad_u32_u24 v85, v86, 10, v85
    v_lshrrev_b32 v86, 5, v1
    v_mad_u32_u24 v85, v85, 17, v86
    v_lshlrev_b32 v36, 4, v85
    v_mad_u32_u24 v85, v31, 17, v86
    v_lshlrev_b32 v37, 4, v85
    v_lshrrev_b32 v85, 1, v1
    v_and_b32_e64 v86, 1, v1
    v_sub_u32 v85, 1135, v85
    v_mad_u32_u24 v87, v86, 48, v85
    v_lshlrev_b32 v38, 2, v87
    v_lshlrev_b32 v86, 5, v86
    v_sub_u32 v85, v85, v86
    v_add_u32 v85, 128, v85
    v_lshlrev_b32 v39, 2, v85
    s_branch L_qw
L_q7:
    v_cmp_gt_u32 vcc, 32, v1
    v_bfe_u32 v85, v1, 2, 2
    v_bfe_u32 v86, v1, 3, 2
    v_cndmask_b32 v86, v86, v85, vcc
    v_lshlrev_b32 v86, 2, v86
    s_mov_b32 s41, 0xb630
    v_bfe_u32 v86, s41, v86, 4
    v_mov_b32 v87, 5248
    v_mov_b32 v36, 4352
    v_cndmask_b32 v87, v87, v36, vcc
    v_lshl_add_u32 v86, v86, 6, v87
    v_and_b32 v87, 7, v1
    v_min_u32 v87, 4, v87
    v_and_b32 v36, 3, v1
    v_cndmask_b32 v87, v87, v36, vcc
    v_cmp_gt_u32 vcc, 16, v1
    v_mul_u32_u24 v85, 1088, v85
    s_mov_b32 s41, 0xffff0000
    v_cndmask_b32 v86, v86, v85, vcc
    v_lshl_add_u32 v36, v87, 4, v86
    v_mov_b32 v37, 0
    v_mov_b32_e64 v38, 0
    v_mov_b32_e64 v39, 0
    v_writelane_b32 v38, s41, 3
    v_writelane_b32 v39, -1, 3
    v_writelane_b32 v38, -1, 7
    v_writelane_b32 v39, -1, 7
    v_writelane_b32 v37, s41, 11
    v_writelane_b32 v38, -1, 11
    v_writelane_b32 v37, -1, 15
    v_writelane_b32 v38, -1, 15
L_qw:
    s_lshl_b32 s58, s38, 10
    s_sub_u32 s58, 10512, s58
    s_sub_u32 s40, s34, 4
    s_mul_i32 s40, s40, 4624
    s_add_u32 s40, s40, s58
    s_lshl_b32 s41, s34, 10
    s_add_u32 s41, s41, 4864
    s_cmp_lt_u32 s34, 4
    s_cselect_b32 s40, s41, s40
    v_add_u32_e64 v85, s40, v2
    ds_write_b128 v85, v[36:39]
    s_lshl3_add_u32 s42, s37, s60
    s_lshl_b32 s40, s42, 8
    v_lshl_add_u32 v24, v1, 2, s40
    s_lshr_b32 s40, s42, 1
    s_lshl_b32 s40, s40, 2
    s_waitcnt lgkmcnt(0)
    s_load_dword s48, s[14:15], s40
    s_load_dword s49, s[16:17], s40
    s_barrier
    global_load_dword v8, v24, s[6:7]
    global_load_dword v9, v24, s[8:9]
    global_load_dword v10, v24, s[10:11]
    global_load_dword v11, v24, s[12:13]
    s_branch L_cnv
    s_nop 0
L_tok:
    s_setprio 3
    s_cmp_ge_u32 s34, 2
    s_cselect_b32 s40, 4, 0
    s_add_u32 s40, s40, s34
    s_add_u32 s41, s34, 2
    s_cmp_eq_u32 s38, 0
    s_cselect_b32 s20, s40, s41
    s_cselect_b32 s21, s41, s40
    s_mov_b32 s30, 0x3f803f80
    s_mov_b32 s31, 0xffff0000
    s_lshl_b32 s40, s2, 7
    s_lshl_b32 s41, s34, 20
    s_add_u32 s40, s40, s41
    s_add_u32 s40, s40, 2097152
    s_add_u32 s52, s32, s40
    s_addc_u32 s53, s33, 0
    s_add_u32 s50, s32, 32768
    s_addc_u32 s51, s33, 0
    s_lshl_b32 s40, s2, 6
    s_add_u32 s58, s50, s40
    s_addc_u32 s59, s51, 0
    s_lshl_b32 s40, s21, 11
    s_add_u32 s60, s50, s40
    s_addc_u32 s61, s51, 0
    s_nop 0
    s_lshl_b32 s41, s37, 15
    s_add_u32 s41, s41, 2097152
    s_lshl_b32 s40, s20, 12
    s_add_u32 s40, s40, s41
    s_add_u32 s54, s32, s40
    s_addc_u32 s55, s33, 0
    s_lshl_b32 s40, s21, 12
    s_add_u32 s40, s40, s41
    s_add_u32 s56, s32, s40
    s_addc_u32 s57, s33, 0
    s_lshl_b32 s40, s20, 19
    s_lshl4_add_u32 s40, s37, s40
    s_add_u32 s40, s40, 4096
    s_add_u32 s28, s28, s40
    s_addc_u32 s29, s29, 0
    s_lshl_b32 s40, s20, 9
    s_add_u32 s40, s40, 9488
    s_lshl_b32 s41, s21, 9
    s_add_u32 s41, s41, 9488
    s_nop 0
    s_lshl_b32 s42, s34, 9
    s_add_u32 s42, s42, 52096
    v_lshl_add_u32 v5, v1, 3, s42
    v_add_u32 v11, 57664, v5
    s_lshl_b32 s42, s34, 2
    v_mov_b32 v10, s42
    v_and_b32 v58, 112, v2
    v_lshrrev_b32_e64 v59, 4, v1
    v_mul_u32_u24 v56, 4624, v118
    v_add3_u32 v114, v56, v58, s40
    v_mul_u32_u24 v56, 289, v58
    v_lshlrev_b32_e64 v117, 4, v118
    v_add3_u32 v8, v56, v117, s40
    v_add3_u32 v9, v56, v117, s41
    v_lshl_add_u32 v116, v118, 17, v58
    v_bfe_u32 v56, v1, 2, 2
    v_mul_u32_u24 v56, 4624, v56
    v_lshl_add_u32 v56, v59, 7, v56
    v_and_b32 v57, 2, v1
    v_lshl_add_u32 v56, v57, 5, v56
    v_and_b32 v57, 1, v1
    v_lshl_add_u32 v56, v57, 3, v56
    v_add_u32 v115, s40, v56
    v_and_b32 v57, 15, v1
    v_lshl_add_u32 v56, v57, 2, v59
    v_lshl_add_u32 v6, v56, 3, s40
    v_lshlrev_b32 v4, 13, v56
    s_lshl_b32 s40, s20, 11
    v_lshl_add_u32 v7, v56, 5, s40
    s_lshl_b32 s40, s34, 7
    v_add_u32 v120, s40, v117
    v_lshlrev_b32 v118, 3, v118
    v_mov_b32 v53, 1
    s_waitcnt lgkmcnt(0)
    s_add_u32 s39, s47, 1
    s_mul_i32 s39, s39, 0x9e3779b1
    v_mov_b32 v52, s39
    s_mov_b64 exec, 1
    ds_write_b64 v3, v[52:53] offset:40
    s_mov_b64 exec, -1
    v_lshlrev_b32 v57, 3, v1
    v_and_b32 v119, 0xffff, v52
    s_and_b32 s42, s39, 1
    s_mul_i32 s42, s42, 0x01010101
    s_and_b32 s43, s39, 0xfefefefe
    s_or_b32 s43, s43, s42
    v_bfe_u32 v56, s43, v57, 8
    v_lshl_or_b32 v12, v56, 14, v56
    v_lshrrev_b32_e64 v14, 4, v12
    v_and_b32 v12, 0x00030003, v12
    v_and_b32 v14, 0x00030003, v14
    v_mov_b32 v125, 0xbfb8aa3b
    s_mov_b32 exec_lo, 0x0000ffff
    s_mov_b32 exec_hi, 0x0000ffff
    v_mov_b32 v125, 0xbfb8dc2f
    s_mov_b64 exec, -1
    s_waitcnt vmcnt(4)
    v_dot2_f32_bf16 v51, v32, s30, 0
    v_dot2_f32_bf16 v52, v33, s30, 0
    v_dot2_f32_bf16 v51, v34, s30, v51
    v_dot2_f32_bf16 v52, v35, s30, v52
    v_dot2_f32_bf16 v51, v36, s30, v51
    v_dot2_f32_bf16 v52, v37, s30, v52
    v_dot2_f32_bf16 v51, v38, s30, v51
    v_dot2_f32_bf16 v52, v39, s30, v52
    v_dot2_f32_bf16 v51, v40, s30, v51
    v_dot2_f32_bf16 v52, v41, s30, v52
    v_dot2_f32_bf16 v51, v42, s30, v51
    v_dot2_f32_bf16 v52, v43, s30, v52
    v_dot2_f32_bf16 v51, v44, s30, v51
    v_dot2_f32_bf16 v52, v45, s30, v52
    v_dot2_f32_bf16 v51, v46, s30, v51
    v_dot2_f32_bf16 v52, v47, s30, v52
    s_nop 0
    s_waitcnt vmcnt(3)
    v_dot2_f32_bf16 v49, v16, v16, 0
    v_dot2_f32_bf16 v48, v16, s30, 0
    v_dot2_f32_bf16 v50, v16, v32, 0
    v_dot2_f32_bf16 v49, v17, v17, v49
    v_dot2_f32_bf16 v48, v17, s30, v48
    v_dot2_f32_bf16 v50, v17, v33, v50
    v_dot2_f32_bf16 v49, v18, v18, v49
    v_dot2_f32_bf16 v48, v18, s30, v48
    v_dot2_f32_bf16 v50, v18, v34, v50
    v_dot2_f32_bf16 v49, v19, v19, v49
    v_dot2_f32_bf16 v48, v19, s30, v48
    v_dot2_f32_bf16 v50, v19, v35, v50
    v_add_f32 v51, v51, v52
    s_waitcnt vmcnt(2)
    v_dot2_f32_bf16 v49, v20, v20, v49
    v_dot2_f32_bf16 v48, v20, s30, v48
    v_dot2_f32_bf16 v50, v20, v36, v50
    v_dot2_f32_bf16 v49, v21, v21, v49
    v_dot2_f32_bf16 v48, v21, s30, v48
    v_dot2_f32_bf16 v50, v21, v37, v50
    v_dot2_f32_bf16 v49, v22, v22, v49
    v_dot2_f32_bf16 v48, v22, s30, v48
    v_dot2_f32_bf16 v50, v22, v38, v50
    v_dot2_f32_bf16 v49, v23, v23, v49
    v_dot2_f32_bf16 v48, v23, s30, v48
    v_dot2_f32_bf16 v50, v23, v39, v50
    s_nop 0
    s_waitcnt vmcnt(1)
    v_dot2_f32_bf16 v49, v24, v24, v49
    v_dot2_f32_bf16 v48, v24, s30, v48
    v_dot2_f32_bf16 v50, v24, v40, v50
    v_dot2_f32_bf16 v49, v25, v25, v49
    v_dot2_f32_bf16 v48, v25, s30, v48
    v_dot2_f32_bf16 v50, v25, v41, v50
    v_dot2_f32_bf16 v49, v26, v26, v49
    v_dot2_f32_bf16 v48, v26, s30, v48
    v_dot2_f32_bf16 v50, v26, v42, v50
    v_dot2_f32_bf16 v49, v27, v27, v49
    v_dot2_f32_bf16 v48, v27, s30, v48
    v_dot2_f32_bf16 v50, v27, v43, v50
    s_waitcnt vmcnt(0)
    s_nop 0
    v_dot2_f32_bf16 v49, v28, v28, v49
    v_dot2_f32_bf16 v48, v28, s30, v48
    v_dot2_f32_bf16 v50, v28, v44, v50
    v_dot2_f32_bf16 v49, v29, v29, v49
    v_dot2_f32_bf16 v48, v29, s30, v48
    v_dot2_f32_bf16 v50, v29, v45, v50
    v_dot2_f32_bf16 v49, v30, v30, v49
    v_dot2_f32_bf16 v48, v30, s30, v48
    v_dot2_f32_bf16 v50, v30, v46, v50
    v_dot2_f32_bf16 v49, v31, v31, v49
    v_dot2_f32_bf16 v48, v31, s30, v48
    v_dot2_f32_bf16 v50, v31, v47, v50
    v_add_f32_dpp v51, v51, v51 quad_perm:[1,0,3,2] row_mask:0xf bank_mask:0xf
    v_add_f32_dpp v49, v49, v49 quad_perm:[1,0,3,2] row_mask:0xf bank_mask:0xf
    v_add_f32_dpp v48, v48, v48 quad_perm:[1,0,3,2] row_mask:0xf bank_mask:0xf
    v_add_f32_dpp v50, v50, v50 quad_perm:[1,0,3,2] row_mask:0xf bank_mask:0xf
    v_add_f32_dpp v51, v51, v51 quad_perm:[2,3,0,1] row_mask:0xf bank_mask:0xf
    v_add_f32_dpp v49, v49, v49 quad_perm:[2,3,0,1] row_mask:0xf bank_mask:0xf
    v_add_f32_dpp v48, v48, v48 quad_perm:[2,3,0,1] row_mask:0xf bank_mask:0xf
    v_add_f32_dpp v50, v50, v50 quad_perm:[2,3,0,1] row_mask:0xf bank_mask:0xf
    v_add_f32_dpp v51, v51, v51 row_half_mirror row_mask:0xf bank_mask:0xf
    v_add_f32_dpp v49, v49, v49 row_half_mirror row_mask:0xf bank_mask:0xf
    v_add_f32_dpp v48, v48, v48 row_half_mirror row_mask:0xf bank_mask:0xf
    v_add_f32_dpp v50, v50, v50 row_half_mirror row_mask:0xf bank_mask:0xf
    v_and_b32 v49, 0x7fffffff, v49
    s_mov_b32 exec_lo, 0x01010101
    s_mov_b32 exec_hi, 0x01010101
    ds_write_b128 v120, v[48:51] offset:256
    s_mov_b64 exec, -1
    s_mov_b32 s46, 0
    ds_read_b128 v[60:63], v117 offset:256
    ds_read_b128 v[64:67], v117 offset:384
    ds_read_b128 v[68:71], v117 offset:512
    ds_read_b128 v[72:75], v117 offset:640
    v_lshlrev_b32 v80, 16, v16
    v_and_b32 v81, 0xffff0000, v16
    v_lshlrev_b32 v82, 16, v17
    v_and_b32 v83, 0xffff0000, v17
    v_lshlrev_b32_e64 v84, 16, v18
    v_and_b32 v85, 0xffff0000, v18
    v_lshlrev_b32_e64 v86, 16, v19
    v_and_b32 v87, 0xffff0000, v19
    v_lshlrev_b32_e64 v88, 16, v20
    v_and_b32 v89, 0xffff0000, v20
    v_lshlrev_b32_e64 v90, 16, v21
    v_and_b32 v91, 0xffff0000, v21
    v_lshlrev_b32_e64 v92, 16, v22
    v_and_b32 v93, 0xffff0000, v22
    s_branch L_spc_3
    s_nop 0
L_sp_1:
    ds_read_b128 v[60:63], v117 offset:256
    ds_read_b128 v[64:67], v117 offset:384
    ds_read_b128 v[68:71], v117 offset:512
    ds_read_b128 v[72:75], v117 offset:640
L_spc_3:
    s_waitcnt lgkmcnt(0)
    v_or3_b32 v52, v61, v65, v69
    v_or_b32 v52, v52, v73
    v_cmp_gt_i32_e64 vcc, 0, v52
    s_cbranch_vccz L_spd_2
    s_add_u32 s46, s46, 1
    s_cmp_lt_u32 s46, 400000
    s_cbranch_scc1 L_sp_1
    s_branch L_end
L_spd_2:
    v_pk_add_f32 v[60:61], v[60:61], v[64:65]
    v_pk_add_f32 v[68:69], v[68:69], v[72:73]
    v_pk_add_f32 v[62:63], v[62:63], v[66:67]
    v_pk_add_f32 v[70:71], v[70:71], v[74:75]
    v_pk_add_f32 v[60:61], v[60:61], v[68:69]
    v_pk_add_f32 v[62:63], v[62:63], v[70:71]
    v_mul_f32 v48, 0x3a800000, v60
    v_mul_f32 v49, 0x3a800000, v61
    v_fma_f32 v49, -v48, v48, v49
    v_max_f32_e64 v49, 0, v49
    v_cvt_pk_bf16_f32 v54, v48, v49
    v_and_b32 v49, 0xffff0000, v54
    v_add_f32 v49, 0x3727c5ac, v49
    v_cvt_pk_bf16_f32 v49, v49, v49
    v_and_b32 v49, 0xffff0000, v49
    v_sqrt_f32_e64 v49, v49
    v_lshlrev_b32_e64 v54, 16, v54
    v_cvt_pk_bf16_f32 v52, v48, v49
    v_and_b32 v49, 0xffff0000, v52
    v_rcp_f32_e64 v55, v49
    v_fma_f32 v53, -v54, v63, v62
    s_cmp_lg_u32 s34, 0
    s_cbranch_scc1 L_nohdr_4
    v_mul_f32 v53, v53, v55
    s_brev_b32 s40, 1
    v_cvt_pk_bf16_f32 v53, v53, v53
    v_ashrrev_i32_e64 v49, 31, v53
    v_bitop3_b32 v53, v53, v49, s40 bitop3:0x1e
    v_and_or_b32 v53, v53, s31, v119
    s_mov_b32 exec_lo, 0x01010101
    s_mov_b32 exec_hi, 0x01010101
    global_store_dwordx2 v118, v[52:53], s[58:59] sc1
    s_mov_b64 exec, -1
L_nohdr_4:
    v_mul_f32 v56, v125, v55
    v_lshlrev_b32_e64 v94, 16, v23
    v_and_b32 v95, 0xffff0000, v23
    v_mul_f32 v58, -v54, v56
    v_lshlrev_b32_e64 v96, 16, v24
    v_and_b32 v97, 0xffff0000, v24
    v_lshlrev_b32_e64 v98, 16, v25
    v_and_b32 v99, 0xffff0000, v25
    v_lshlrev_b32_e64 v100, 16, v26
    v_and_b32 v101, 0xffff0000, v26
    v_lshlrev_b32_e64 v102, 16, v27
    v_and_b32 v103, 0xffff0000, v27
    v_lshlrev_b32_e64 v104, 16, v28
    v_and_b32 v105, 0xffff0000, v28
    v_lshlrev_b32_e64 v106, 16, v29
    v_and_b32 v107, 0xffff0000, v29
    v_lshlrev_b32_e64 v108, 16, v30
    v_and_b32 v109, 0xffff0000, v30
    v_lshlrev_b32_e64 v110, 16, v31
    v_and_b32 v111, 0xffff0000, v31
    v_pk_fma_f32 v[80:81], v[80:81], v[56:57], v[58:59] op_sel_hi:[1,0,0]
    v_pk_fma_f32 v[82:83], v[82:83], v[56:57], v[58:59] op_sel_hi:[1,0,0]
    v_pk_fma_f32 v[84:85], v[84:85], v[56:57], v[58:59] op_sel_hi:[1,0,0]
    v_pk_fma_f32 v[86:87], v[86:87], v[56:57], v[58:59] op_sel_hi:[1,0,0]
    v_cvt_pk_f16_f32 v16, v80, v81
    v_cvt_pk_f16_f32 v17, v82, v83
    v_cvt_pk_f16_f32 v18, v84, v85
    v_cvt_pk_f16_f32 v19, v86, v87
    ds_write_b128 v114, v[16:19] offset:0
    v_pk_fma_f32 v[88:89], v[88:89], v[56:57], v[58:59] op_sel_hi:[1,0,0]
    v_pk_fma_f32 v[90:91], v[90:91], v[56:57], v[58:59] op_sel_hi:[1,0,0]
    v_pk_fma_f32 v[92:93], v[92:93], v[56:57], v[58:59] op_sel_hi:[1,0,0]
    v_pk_fma_f32 v[94:95], v[94:95], v[56:57], v[58:59] op_sel_hi:[1,0,0]
    v_cvt_pk_f16_f32 v20, v88, v89
    v_cvt_pk_f16_f32 v21, v90, v91
    v_cvt_pk_f16_f32 v22, v92, v93
    v_cvt_pk_f16_f32 v23, v94, v95
    ds_write_b128 v114, v[20:23] offset:128
    v_pk_fma_f32 v[96:97], v[96:97], v[56:57], v[58:59] op_sel_hi:[1,0,0]
    v_pk_fma_f32 v[98:99], v[98:99], v[56:57], v[58:59] op_sel_hi:[1,0,0]
    v_pk_fma_f32 v[100:101], v[100:101], v[56:57], v[58:59] op_sel_hi:[1,0,0]
    v_pk_fma_f32 v[102:103], v[102:103], v[56:57], v[58:59] op_sel_hi:[1,0,0]
    v_cvt_pk_f16_f32 v24, v96, v97
    v_cvt_pk_f16_f32 v25, v98, v99
    v_cvt_pk_f16_f32 v26, v100, v101
    v_cvt_pk_f16_f32 v27, v102, v103
    ds_write_b128 v114, v[24:27] offset:256
    v_pk_fma_f32 v[104:105], v[104:105], v[56:57], v[58:59] op_sel_hi:[1,0,0]
    v_pk_fma_f32 v[106:107], v[106:107], v[56:57], v[58:59] op_sel_hi:[1,0,0]
    v_pk_fma_f32 v[108:109], v[108:109], v[56:57], v[58:59] op_sel_hi:[1,0,0]
    v_pk_fma_f32 v[110:111], v[110:111], v[56:57], v[58:59] op_sel_hi:[1,0,0]
    v_cvt_pk_f16_f32 v28, v104, v105
    v_cvt_pk_f16_f32 v29, v106, v107
    v_cvt_pk_f16_f32 v30, v108, v109
    v_cvt_pk_f16_f32 v31, v110, v111
    ds_write_b128 v114, v[28:31] offset:384
    ds_read_b64_tr_b16 v[32:33], v115 offset:0
    ds_read_b64_tr_b16 v[34:35], v115 offset:18496
    ds_read_b64_tr_b16 v[36:37], v115 offset:16
    ds_read_b64_tr_b16 v[38:39], v115 offset:18512
    ds_read_b64_tr_b16 v[40:41], v115 offset:32
    ds_read_b64_tr_b16 v[42:43], v115 offset:18528
    ds_read_b64_tr_b16 v[44:45], v115 offset:48
    ds_read_b64_tr_b16 v[46:47], v115 offset:18544
    s_mov_b32 s22, 0x00030003
    s_nop 0
    s_waitcnt lgkmcnt(6)
    v_bfi_b32 v32, s22, v12, v32
    v_bfi_b32 v34, s22, v14, v34
    global_store_dwordx4 v116, v[32:35], s[52:53] offset:0 sc1
    s_add_u32 s52, s52, 32768
    s_addc_u32 s53, s53, 0
    s_waitcnt lgkmcnt(4)
    v_bfi_b32 v36, s22, v12, v36
    v_bfi_b32 v38, s22, v14, v38
    global_store_dwordx4 v116, v[36:39], s[52:53] offset:0 sc1
    s_add_u32 s52, s52, 32768
    s_addc_u32 s53, s53, 0
    s_waitcnt lgkmcnt(2)
    v_bfi_b32 v40, s22, v12, v40
    v_bfi_b32 v42, s22, v14, v42
    global_store_dwordx4 v116, v[40:43], s[52:53] offset:0 sc1
    s_add_u32 s52, s52, 32768
    s_addc_u32 s53, s53, 0
    s_waitcnt lgkmcnt(0)
    v_bfi_b32 v44, s22, v12, v44
    v_bfi_b32 v46, s22, v14, v46
    global_store_dwordx4 v116, v[44:47], s[52:53] offset:0 sc1
    v_lshrrev_b32 v80, 3, v7
    v_sub_u32 v80, 0xffff, v80
    s_lshl_b32 s40, s21, 8
    s_sub_u32 s40, 0xffff, s40
    v_lshlrev_b32 v84, 1, v1
    v_sub_u32 v84, s40, v84
    v_subrev_u32 v81, 1, v80
    v_subrev_u32 v85, 1, v84
    v_subrev_u32_e64 v82, 2, v80
    v_subrev_u32 v86, 128, v84
    v_subrev_u32_e64 v83, 3, v80
    v_subrev_u32 v87, 129, v84
    v_mov_b32 v76, 1
    v_lshrrev_b32 v52, 4, v1
    v_add_u32_e64 v52, v52, v10
    v_lshlrev_b32_e64 v52, 3, v52
    s_mov_b32 s46, 0
L_sp_5:
    ds_read_b32 v48, v3 offset:80
    s_waitcnt lgkmcnt(0)
    v_cmp_gt_u32_e64 vcc, 4, v48
    s_cbranch_vccz L_spd_6
    s_add_u32 s46, s46, 1
    s_sleep 2
    s_cmp_lt_u32 s46, 400000
    s_cbranch_scc1 L_sp_5
    s_branch L_end
    s_nop 0
L_spd_6:
    global_load_dwordx4 v[60:63], v7, s[50:51] offset:0
    global_load_dwordx4 v[64:67], v7, s[50:51] offset:16
    global_load_dwordx4 v[68:71], v2, s[60:61] offset:0
    global_load_dwordx4 v[72:75], v2, s[60:61] offset:1024
    s_cmp_ge_u32 s34, 2
    s_cbranch_scc1 L_late_9
    s_mov_b32 s46, 0
L_sp_10:
    ds_read_b32 v48, v3 offset:84
    s_waitcnt lgkmcnt(0)
    v_cmp_gt_u32 vcc, 4, v48
    s_cbranch_vccz L_spd_11
    s_add_u32 s46, s46, 1
    s_sleep 2
    s_cmp_lt_u32 s46, 400000
    s_cbranch_scc1 L_sp_10
    s_branch L_end
L_spd_11:
    s_cmp_ge_u32 s21, 6
    s_cbranch_scc1 L_nob_12
    global_load_dwordx4 v[32:35], v2, s[56:57] offset:0 sc1
    global_load_dwordx4 v[36:39], v2, s[56:57] offset:1024 sc1
    global_load_dwordx4 v[40:43], v2, s[56:57] offset:2048 sc1
    global_load_dwordx4 v[44:47], v2, s[56:57] offset:3072 sc1
L_nob_12:
    global_load_dwordx4 v[16:19], v2, s[54:55] offset:0 sc1
    global_load_dwordx4 v[20:23], v2, s[54:55] offset:1024 sc1
    global_load_dwordx4 v[24:27], v2, s[54:55] offset:2048 sc1
    global_load_dwordx4 v[28:31], v2, s[54:55] offset:3072 sc1
    s_mov_b32 s46, 0
    s_waitcnt vmcnt(8)
    s_branch L_rc_7
    s_nop 0
L_late_9:
    s_mov_b32 s46, 0
    s_waitcnt vmcnt(0)
L_rc_7:
    v_xor_b32_e64 v50, v119, v61
    v_bitop3_b32 v50, v50, v63, v119 bitop3:0xf6
    v_bitop3_b32 v50, v50, v65, v119 bitop3:0xf6
    v_bitop3_b32 v50, v50, v67, v119 bitop3:0xf6
    v_bitop3_b32 v50, v50, v69, v119 bitop3:0xf6
    v_bitop3_b32 v50, v50, v71, v119 bitop3:0xf6
    v_bitop3_b32 v50, v50, v73, v119 bitop3:0xf6
    v_bitop3_b32 v50, v50, v75, v119 bitop3:0xf6
    v_and_b32 v50, 0xffff, v50
    v_cmp_ne_u32 vcc, 0, v50
    s_cbranch_vccz L_ro_8
    global_load_dwordx4 v[60:63], v7, s[50:51] offset:0 sc1
    global_load_dwordx4 v[64:67], v7, s[50:51] offset:16 sc1
    global_load_dwordx4 v[68:71], v2, s[60:61] offset:0 sc1
    global_load_dwordx4 v[72:75], v2, s[60:61] offset:1024 sc1
    s_add_u32 s46, s46, 1
    s_cmp_lt_u32 s46, 50000
    s_waitcnt vmcnt(0)
    s_cbranch_scc1 L_rc_7
    s_branch L_end
L_ro_8:
    v_and_or_b32 v80, v61, s31, v80
    v_and_or_b32 v81, v63, s31, v81
    v_and_or_b32 v82, v65, s31, v82
    v_and_or_b32 v83, v67, s31, v83
    v_and_or_b32 v84, v69, s31, v84
    v_and_or_b32 v85, v71, s31, v85
    v_and_or_b32 v86, v73, s31, v86
    v_and_or_b32 v87, v75, s31, v87
    v_max3_u32 v48, v80, v81, v82
    v_med3_u32 v49, v80, v81, v82
    v_med3_u32 v49, v48, v49, v83
    v_max_u32 v48, v48, v83
    v_med3_u32 v49, v48, v49, v84
    v_max_u32 v48, v48, v84
    v_med3_u32 v49, v48, v49, v85
    v_max_u32_e64 v48, v48, v85
    v_med3_u32 v49, v48, v49, v86
    v_max_u32_e64 v48, v48, v86
    v_med3_u32 v49, v48, v49, v87
    v_max_u32 v48, v48, v87
    s_nop 0
    v_max_u32_dpp v51, v49, v49 quad_perm:[1,0,3,2] row_mask:0xf bank_mask:0xf
    v_min_u32_dpp v50, v48, v48 quad_perm:[1,0,3,2] row_mask:0xf bank_mask:0xf
    v_max_u32 v49, v50, v51
    v_max_u32_dpp v48, v48, v48 quad_perm:[1,0,3,2] row_mask:0xf bank_mask:0xf
    s_nop 0
    v_max_u32_dpp v51, v49, v49 quad_perm:[2,3,0,1] row_mask:0xf bank_mask:0xf
    v_min_u32_dpp v50, v48, v48 quad_perm:[2,3,0,1] row_mask:0xf bank_mask:0xf
    v_max_u32 v49, v50, v51
    v_max_u32_dpp v48, v48, v48 quad_perm:[2,3,0,1] row_mask:0xf bank_mask:0xf
    s_nop 0
    v_max_u32_dpp v51, v49, v49 row_half_mirror row_mask:0xf bank_mask:0xf
    v_min_u32_dpp v50, v48, v48 row_half_mirror row_mask:0xf bank_mask:0xf
    v_max_u32 v49, v50, v51
    v_max_u32_dpp v48, v48, v48 row_half_mirror row_mask:0xf bank_mask:0xf
    s_nop 0
    v_max_u32_dpp v51, v49, v49 row_mirror row_mask:0xf bank_mask:0xf
    v_min_u32_dpp v50, v48, v48 row_mirror row_mask:0xf bank_mask:0xf
    v_max_u32_e64 v49, v50, v51
    v_max_u32_dpp v48, v48, v48 row_mirror row_mask:0xf bank_mask:0xf
    s_mov_b32 exec_lo, 0x00010001
    s_mov_b32 exec_hi, 0x00010001
    ds_write_b64 v52, v[48:49] offset:128
    s_mov_b64 exec, -1
    s_cmp_lt_u32 s34, 2
    s_cbranch_scc1 L_early_13
    s_mov_b32 s46, 0
L_sp_14:
    ds_read_b32 v48, v3 offset:92
    s_waitcnt lgkmcnt(0)
    v_cmp_gt_u32 vcc, 4, v48
    s_cbranch_vccz L_spd_15
    s_add_u32 s46, s46, 1
    s_sleep 1
    s_cmp_lt_u32 s46, 400000
    s_cbranch_scc1 L_sp_14
    s_branch L_end
    s_nop 0
L_spd_15:
    s_cmp_ge_u32 s21, 6
    s_cbranch_scc1 L_nob_16
    global_load_dwordx4 v[32:35], v2, s[56:57] offset:0 sc1
    global_load_dwordx4 v[36:39], v2, s[56:57] offset:1024 sc1
    global_load_dwordx4 v[40:43], v2, s[56:57] offset:2048 sc1
    global_load_dwordx4 v[44:47], v2, s[56:57] offset:3072 sc1
L_nob_16:
    global_load_dwordx4 v[16:19], v2, s[54:55] offset:0 sc1
    global_load_dwordx4 v[20:23], v2, s[54:55] offset:1024 sc1
    global_load_dwordx4 v[24:27], v2, s[54:55] offset:2048 sc1
    global_load_dwordx4 v[28:31], v2, s[54:55] offset:3072 sc1
L_early_13:
    v_and_b32 v92, 0xffff0000, v60
    v_lshlrev_b32_e64 v88, 16, v60
    v_mul_f32 v92, 0xbf317218, v92
    v_and_b32 v93, 0xffff0000, v62
    v_lshlrev_b32_e64 v89, 16, v62
    v_mul_f32 v93, 0xbf317218, v93
    v_and_b32 v94, 0xffff0000, v64
    v_lshlrev_b32_e64 v90, 16, v64
    v_mul_f32 v94, 0xbf317218, v94
    v_and_b32 v95, 0xffff0000, v66
    v_lshlrev_b32 v91, 16, v66
    v_mul_f32 v95, 0xbf317218, v95
    s_mov_b32 s46, 0
L_pa_17:
    v_mov_b32 v57, 0
    s_cmp_ge_u32 s21, 6
    s_cbranch_scc1 L_nob_19
    s_waitcnt vmcnt(7)
    v_xor_b32 v32, v32, v12
    v_xor_b32 v34, v34, v14
    ds_write_b128 v9, v[32:35] offset:0
    v_or3_b32 v57, v57, v32, v34
    s_waitcnt vmcnt(6)
    v_xor_b32 v36, v36, v12
    v_xor_b32_e64 v38, v38, v14
    ds_write_b128 v9, v[36:39] offset:128
    v_or3_b32 v57, v57, v36, v38
    s_waitcnt vmcnt(5)
    v_xor_b32 v40, v40, v12
    v_xor_b32_e64 v42, v42, v14
    ds_write_b128 v9, v[40:43] offset:256
    v_or3_b32 v57, v57, v40, v42
    s_waitcnt vmcnt(4)
    v_xor_b32 v44, v44, v12
    v_xor_b32_e64 v46, v46, v14
    ds_write_b128 v9, v[44:47] offset:384
    v_or3_b32 v57, v57, v44, v46
L_nob_19:
    s_waitcnt vmcnt(3)
    v_xor_b32 v16, v16, v12
    v_xor_b32_e64 v18, v18, v14
    ds_write_b128 v8, v[16:19] offset:0
    v_or3_b32 v57, v57, v16, v18
    s_waitcnt vmcnt(2)
    v_xor_b32 v20, v20, v12
    v_xor_b32_e64 v22, v22, v14
    ds_write_b128 v8, v[20:23] offset:128
    v_or3_b32 v57, v57, v20, v22
    s_waitcnt vmcnt(1)
    v_xor_b32 v24, v24, v12
    v_xor_b32_e64 v26, v26, v14
    ds_write_b128 v8, v[24:27] offset:256
    v_or3_b32 v57, v57, v24, v26
    s_waitcnt vmcnt(0)
    v_xor_b32 v28, v28, v12
    v_xor_b32_e64 v30, v30, v14
    ds_write_b128 v8, v[28:31] offset:384
    v_or3_b32 v57, v57, v28, v30
    v_and_b32 v57, 0x00030003, v57
    v_cmp_ne_u32 vcc, 0, v57
    s_cbranch_vccz L_po_18
    s_cmp_ge_u32 s21, 6
    s_cbranch_scc1 L_nob_20
    global_load_dwordx4 v[32:35], v2, s[56:57] offset:0 sc1
    global_load_dwordx4 v[36:39], v2, s[56:57] offset:1024 sc1
    global_load_dwordx4 v[40:43], v2, s[56:57] offset:2048 sc1
    global_load_dwordx4 v[44:47], v2, s[56:57] offset:3072 sc1
L_nob_20:
    global_load_dwordx4 v[16:19], v2, s[54:55] offset:0 sc1
    global_load_dwordx4 v[20:23], v2, s[54:55] offset:1024 sc1
    global_load_dwordx4 v[24:27], v2, s[54:55] offset:2048 sc1
    global_load_dwordx4 v[28:31], v2, s[54:55] offset:3072 sc1
    s_add_u32 s46, s46, 1
    s_cmp_lt_u32 s46, 50000
    s_cbranch_scc1 L_pa_17
    s_branch L_end
    s_nop 0
L_po_18:
    v_and_b32 v57, 8, v10
    s_mov_b64 exec, 1
    ds_add_u32 v57, v76 offset:48
    s_mov_b64 exec, -1
    s_setprio 0
    ds_read_b64 v[112:113], v6 offset:0
    ds_read_b64 v[114:115], v6 offset:4624
    ds_read_b64 v[116:117], v6 offset:9248
    ds_read_b64 v[118:119], v6 offset:13872
    ds_read_b64 v[120:121], v6 offset:18496
    ds_read_b64 v[122:123], v6 offset:23120
    ds_read_b64 v[124:125], v6 offset:27744
    ds_read_b64 v[126:127], v6 offset:32368
    s_mov_b32 s46, 0
L_sp_21:
    ds_read_b128 v[80:83], v3 offset:0
    ds_read_b128 v[84:87], v3 offset:16
    s_waitcnt lgkmcnt(0)
    v_min3_u32 v96, v80, v81, v82
    v_min3_u32 v96, v96, v83, v84
    v_min3_u32 v96, v96, v85, v86
    v_min_u32 v96, v96, v87
    v_cmp_eq_u32 vcc, 0, v96
    s_cbranch_vccz L_spd_22
    s_add_u32 s46, s46, 1
    s_sleep 1
    s_cmp_lt_u32 s46, 400000
    s_cbranch_scc1 L_sp_21
    s_branch L_end
L_spd_22:
    v_exp_f16 v96, v112
    v_exp_f16_sdwa v97, v112 dst_sel:DWORD dst_unused:UNUSED_PAD src0_sel:WORD_1
    v_exp_f16_e64 v98, v113
    v_exp_f16_sdwa v99, v113 dst_sel:DWORD dst_unused:UNUSED_PAD src0_sel:WORD_1
    v_fma_mix_f32 v96, v96, v80, v80 op_sel:[0,0,0] op_sel_hi:[1,0,0]
    v_fma_mix_f32 v97, v97, v80, v80 op_sel:[0,0,0] op_sel_hi:[1,0,0]
    v_fma_mix_f32 v98, v98, v80, v80 op_sel:[0,0,0] op_sel_hi:[1,0,0]
    v_fma_mix_f32 v99, v99, v80, v80 op_sel:[0,0,0] op_sel_hi:[1,0,0]
    v_rcp_f32 v16, v96
    v_rcp_f32 v17, v97
    v_rcp_f32 v18, v98
    v_rcp_f32 v19, v99
    v_exp_f16 v96, v114
    v_exp_f16_sdwa v97, v114 dst_sel:DWORD dst_unused:UNUSED_PAD src0_sel:WORD_1
    v_exp_f16 v98, v115
    v_exp_f16_sdwa v99, v115 dst_sel:DWORD dst_unused:UNUSED_PAD src0_sel:WORD_1
    v_fma_mix_f32 v96, v96, v81, v81 op_sel:[0,0,0] op_sel_hi:[1,0,0]
    v_fma_mix_f32 v97, v97, v81, v81 op_sel:[0,0,0] op_sel_hi:[1,0,0]
    v_fma_mix_f32 v98, v98, v81, v81 op_sel:[0,0,0] op_sel_hi:[1,0,0]
    v_fma_mix_f32 v99, v99, v81, v81 op_sel:[0,0,0] op_sel_hi:[1,0,0]
    v_rcp_f32 v20, v96
    v_rcp_f32 v21, v97
    v_rcp_f32 v22, v98
    v_rcp_f32 v23, v99
    v_exp_f16_e64 v96, v116
    v_exp_f16_sdwa v97, v116 dst_sel:DWORD dst_unused:UNUSED_PAD src0_sel:WORD_1
    v_exp_f16_e64 v98, v117
    v_exp_f16_sdwa v99, v117 dst_sel:DWORD dst_unused:UNUSED_PAD src0_sel:WORD_1
    v_fma_mix_f32 v96, v96, v82, v82 op_sel:[0,0,0] op_sel_hi:[1,0,0]
    v_fma_mix_f32 v97, v97, v82, v82 op_sel:[0,0,0] op_sel_hi:[1,0,0]
    v_fma_mix_f32 v98, v98, v82, v82 op_sel:[0,0,0] op_sel_hi:[1,0,0]
    v_fma_mix_f32 v99, v99, v82, v82 op_sel:[0,0,0] op_sel_hi:[1,0,0]
    v_rcp_f32 v24, v96
    v_rcp_f32 v25, v97
    v_rcp_f32 v26, v98
    v_rcp_f32 v27, v99
    v_exp_f16_e64 v96, v118
    v_exp_f16_sdwa v97, v118 dst_sel:DWORD dst_unused:UNUSED_PAD src0_sel:WORD_1
    v_exp_f16_e64 v98, v119
    v_exp_f16_sdwa v99, v119 dst_sel:DWORD dst_unused:UNUSED_PAD src0_sel:WORD_1
    v_fma_mix_f32 v96, v96, v83, v83 op_sel:[0,0,0] op_sel_hi:[1,0,0]
    v_fma_mix_f32 v97, v97, v83, v83 op_sel:[0,0,0] op_sel_hi:[1,0,0]
    v_fma_mix_f32 v98, v98, v83, v83 op_sel:[0,0,0] op_sel_hi:[1,0,0]
    v_fma_mix_f32 v99, v99, v83, v83 op_sel:[0,0,0] op_sel_hi:[1,0,0]
    v_rcp_f32 v28, v96
    v_rcp_f32 v29, v97
    v_rcp_f32 v30, v98
    v_rcp_f32 v31, v99
    v_exp_f16_e64 v96, v120
    v_exp_f16_sdwa v97, v120 dst_sel:DWORD dst_unused:UNUSED_PAD src0_sel:WORD_1
    v_exp_f16_e64 v98, v121
    v_exp_f16_sdwa v99, v121 dst_sel:DWORD dst_unused:UNUSED_PAD src0_sel:WORD_1
    v_fma_mix_f32 v96, v96, v84, v84 op_sel:[0,0,0] op_sel_hi:[1,0,0]
    v_fma_mix_f32 v97, v97, v84, v84 op_sel:[0,0,0] op_sel_hi:[1,0,0]
    v_fma_mix_f32 v98, v98, v84, v84 op_sel:[0,0,0] op_sel_hi:[1,0,0]
    v_fma_mix_f32 v99, v99, v84, v84 op_sel:[0,0,0] op_sel_hi:[1,0,0]
    v_rcp_f32 v32, v96
    v_rcp_f32 v33, v97
    v_rcp_f32 v34, v98
    v_rcp_f32 v35, v99
    v_exp_f16_e64 v96, v122
    v_exp_f16_sdwa v97, v122 dst_sel:DWORD dst_unused:UNUSED_PAD src0_sel:WORD_1
    v_exp_f16_e64 v98, v123
    v_exp_f16_sdwa v99, v123 dst_sel:DWORD dst_unused:UNUSED_PAD src0_sel:WORD_1
    v_fma_mix_f32 v96, v96, v85, v85 op_sel:[0,0,0] op_sel_hi:[1,0,0]
    v_fma_mix_f32 v97, v97, v85, v85 op_sel:[0,0,0] op_sel_hi:[1,0,0]
    v_fma_mix_f32 v98, v98, v85, v85 op_sel:[0,0,0] op_sel_hi:[1,0,0]
    v_fma_mix_f32 v99, v99, v85, v85 op_sel:[0,0,0] op_sel_hi:[1,0,0]
    v_rcp_f32 v36, v96
    v_rcp_f32 v37, v97
    v_rcp_f32 v38, v98
    v_rcp_f32 v39, v99
    v_exp_f16_e64 v96, v124
    v_exp_f16_sdwa v97, v124 dst_sel:DWORD dst_unused:UNUSED_PAD src0_sel:WORD_1
    v_exp_f16_e64 v98, v125
    v_exp_f16_sdwa v99, v125 dst_sel:DWORD dst_unused:UNUSED_PAD src0_sel:WORD_1
    v_fma_mix_f32 v96, v96, v86, v86 op_sel:[0,0,0] op_sel_hi:[1,0,0]
    v_fma_mix_f32 v97, v97, v86, v86 op_sel:[0,0,0] op_sel_hi:[1,0,0]
    v_fma_mix_f32 v98, v98, v86, v86 op_sel:[0,0,0] op_sel_hi:[1,0,0]
    v_fma_mix_f32 v99, v99, v86, v86 op_sel:[0,0,0] op_sel_hi:[1,0,0]
    v_rcp_f32 v40, v96
    v_rcp_f32 v41, v97
    v_rcp_f32 v42, v98
    v_rcp_f32 v43, v99
    v_exp_f16_e64 v96, v126
    v_exp_f16_sdwa v97, v126 dst_sel:DWORD dst_unused:UNUSED_PAD src0_sel:WORD_1
    v_exp_f16_e64 v98, v127
    v_exp_f16_sdwa v99, v127 dst_sel:DWORD dst_unused:UNUSED_PAD src0_sel:WORD_1
    v_fma_mix_f32 v96, v96, v87, v87 op_sel:[0,0,0] op_sel_hi:[1,0,0]
    v_fma_mix_f32 v97, v97, v87, v87 op_sel:[0,0,0] op_sel_hi:[1,0,0]
    v_fma_mix_f32 v98, v98, v87, v87 op_sel:[0,0,0] op_sel_hi:[1,0,0]
    v_fma_mix_f32 v99, v99, v87, v87 op_sel:[0,0,0] op_sel_hi:[1,0,0]
    v_rcp_f32 v44, v96
    v_rcp_f32 v45, v97
    v_rcp_f32_e64 v46, v98
    v_rcp_f32_e64 v47, v99
    s_mov_b32 s46, 0
L_sp_23:
    ds_read_b64 v[100:101], v3 offset:32
    s_waitcnt lgkmcnt(0)
    v_cmp_eq_u32 vcc, 0, v100
    s_cbranch_vccz L_spd_24
    s_add_u32 s46, s46, 1
    s_sleep 1
    s_cmp_lt_u32 s46, 400000
    s_cbranch_scc1 L_sp_23
    s_branch L_end
L_spd_24:
    s_mov_b64 s[4:5], -1
    s_mov_b64 s[6:7], -1
    s_mov_b64 s[8:9], -1
    s_mov_b64 s[10:11], -1
    v_readfirstlane_b32 s40, v100
    s_andn2_b32 s40, 2047, s40
    s_lshr_b32 s41, s40, 8
    s_cmp_lg_u32 s41, s20
    s_cbranch_scc1 L_nomk_25
    s_bfe_u32 s41, s40, 0x20002
    s_bfe_u32 s42, s40, 0x40004
    s_lshl4_add_u32 s41, s41, s42
    s_lshl_b64 s[42:43], 1, s41
    s_and_b32 s40, s40, 3
    s_cmp_eq_u32 s40, 0
    s_cselect_b64 s[44:45], s[42:43], 0
    s_andn2_b64 s[4:5], s[4:5], s[44:45]
    s_cmp_eq_u32 s40, 1
    s_cselect_b64 s[44:45], s[42:43], 0
    s_andn2_b64 s[6:7], s[6:7], s[44:45]
    s_cmp_eq_u32 s40, 2
    s_cselect_b64 s[44:45], s[42:43], 0
    s_andn2_b64 s[8:9], s[8:9], s[44:45]
    s_cmp_eq_u32 s40, 3
    s_cselect_b64 s[44:45], s[42:43], 0
    s_andn2_b64 s[10:11], s[10:11], s[44:45]
L_nomk_25:
    v_readfirstlane_b32 s40, v101
    s_andn2_b32 s40, 2047, s40
    s_lshr_b32 s41, s40, 8
    s_cmp_lg_u32 s41, s20
    s_cbranch_scc1 L_nomk_26
    s_bfe_u32 s41, s40, 0x20002
    s_bfe_u32 s42, s40, 0x40004
    s_lshl4_add_u32 s41, s41, s42
    s_lshl_b64 s[42:43], 1, s41
    s_and_b32 s40, s40, 3
    s_cmp_eq_u32 s40, 0
    s_cselect_b64 s[44:45], s[42:43], 0
    s_andn2_b64 s[4:5], s[4:5], s[44:45]
    s_cmp_eq_u32 s40, 1
    s_cselect_b64 s[44:45], s[42:43], 0
    s_andn2_b64 s[6:7], s[6:7], s[44:45]
    s_cmp_eq_u32 s40, 2
    s_cselect_b64 s[44:45], s[42:43], 0
    s_andn2_b64 s[8:9], s[8:9], s[44:45]
    s_cmp_eq_u32 s40, 3
    s_cselect_b64 s[44:45], s[42:43], 0
    s_andn2_b64 s[10:11], s[10:11], s[44:45]
L_nomk_26:
    s_setprio 1
    s_mov_b32 s46, 0
L_sp_27:
    ds_read_b32 v96, v10 offset:64
    s_waitcnt lgkmcnt(0)
    v_cmp_gt_u32 vcc, 8, v96
    s_cbranch_vccz L_spd_28
    s_add_u32 s46, s46, 1
    s_sleep 1
    s_cmp_lt_u32 s46, 400000
    s_cbranch_scc1 L_sp_27
    s_branch L_end
    s_nop 0
L_spd_28:
    ds_read_b64 v[48:49], v5 offset:0
    ds_read_b64 v[50:51], v5 offset:14416
    ds_read_b64 v[52:53], v5 offset:28832
    ds_read_b64 v[54:55], v5 offset:43248
    ds_read_b64 v[56:57], v11 offset:0
    ds_read_b64 v[58:59], v11 offset:14416
    ds_read_b64 v[60:61], v11 offset:28832
    ds_read_b64 v[62:63], v11 offset:43248
    s_waitcnt lgkmcnt(6)
    v_fma_mix_f32 v16, v48, v16, v92 op_sel:[0,0,0] op_sel_hi:[1,0,0]
    v_fma_mix_f32 v20, v50, v20, v92 op_sel:[0,0,0] op_sel_hi:[1,0,0]
    s_waitcnt lgkmcnt(4)
    v_fma_mix_f32 v24, v52, v24, v92 op_sel:[0,0,0] op_sel_hi:[1,0,0]
    v_fma_mix_f32 v28, v54, v28, v92 op_sel:[0,0,0] op_sel_hi:[1,0,0]
    s_waitcnt lgkmcnt(2)
    v_fma_mix_f32 v32, v56, v32, v92 op_sel:[0,0,0] op_sel_hi:[1,0,0]
    v_fma_mix_f32 v36, v58, v36, v92 op_sel:[0,0,0] op_sel_hi:[1,0,0]
    s_waitcnt lgkmcnt(0)
    v_fma_mix_f32 v40, v60, v40, v92 op_sel:[0,0,0] op_sel_hi:[1,0,0]
    v_fma_mix_f32 v44, v62, v44, v92 op_sel:[0,0,0] op_sel_hi:[1,0,0]
    v_fma_mix_f32 v16, v112, v16, v88 op_sel:[0,0,0] op_sel_hi:[1,0,0]
    v_fma_mix_f32 v20, v114, v20, v88 op_sel:[0,0,0] op_sel_hi:[1,0,0]
    v_fma_mix_f32 v24, v116, v24, v88 op_sel:[0,0,0] op_sel_hi:[1,0,0]
    v_fma_mix_f32 v28, v118, v28, v88 op_sel:[0,0,0] op_sel_hi:[1,0,0]
    v_fma_mix_f32 v32, v120, v32, v88 op_sel:[0,0,0] op_sel_hi:[1,0,0]
    v_fma_mix_f32 v36, v122, v36, v88 op_sel:[0,0,0] op_sel_hi:[1,0,0]
    v_fma_mix_f32 v40, v124, v40, v88 op_sel:[0,0,0] op_sel_hi:[1,0,0]
    v_fma_mix_f32 v44, v126, v44, v88 op_sel:[0,0,0] op_sel_hi:[1,0,0]
    v_cvt_pk_bf16_f32 v64, v16, v20
    v_cvt_pk_bf16_f32 v65, v24, v28
    v_cvt_pk_bf16_f32 v66, v32, v36
    v_cvt_pk_bf16_f32 v67, v40, v44
    s_mov_b64 exec, s[4:5]
    global_store_dwordx4 v4, v[64:67], s[28:29] offset:-4096
    s_mov_b64 exec, -1
    v_fma_mix_f32 v17, v48, v17, v93 op_sel:[1,0,0] op_sel_hi:[1,0,0]
    v_fma_mix_f32 v21, v50, v21, v93 op_sel:[1,0,0] op_sel_hi:[1,0,0]
    v_fma_mix_f32 v25, v52, v25, v93 op_sel:[1,0,0] op_sel_hi:[1,0,0]
    v_fma_mix_f32 v29, v54, v29, v93 op_sel:[1,0,0] op_sel_hi:[1,0,0]
    v_fma_mix_f32 v33, v56, v33, v93 op_sel:[1,0,0] op_sel_hi:[1,0,0]
    v_fma_mix_f32 v37, v58, v37, v93 op_sel:[1,0,0] op_sel_hi:[1,0,0]
    v_fma_mix_f32 v41, v60, v41, v93 op_sel:[1,0,0] op_sel_hi:[1,0,0]
    v_fma_mix_f32 v45, v62, v45, v93 op_sel:[1,0,0] op_sel_hi:[1,0,0]
    v_fma_mix_f32 v17, v112, v17, v89 op_sel:[1,0,0] op_sel_hi:[1,0,0]
    v_fma_mix_f32 v21, v114, v21, v89 op_sel:[1,0,0] op_sel_hi:[1,0,0]
    v_fma_mix_f32 v25, v116, v25, v89 op_sel:[1,0,0] op_sel_hi:[1,0,0]
    v_fma_mix_f32 v29, v118, v29, v89 op_sel:[1,0,0] op_sel_hi:[1,0,0]
    v_fma_mix_f32 v33, v120, v33, v89 op_sel:[1,0,0] op_sel_hi:[1,0,0]
    v_fma_mix_f32 v37, v122, v37, v89 op_sel:[1,0,0] op_sel_hi:[1,0,0]
    v_fma_mix_f32 v41, v124, v41, v89 op_sel:[1,0,0] op_sel_hi:[1,0,0]
    v_fma_mix_f32 v45, v126, v45, v89 op_sel:[1,0,0] op_sel_hi:[1,0,0]
    v_cvt_pk_bf16_f32 v68, v17, v21
    v_cvt_pk_bf16_f32 v69, v25, v29
    v_cvt_pk_bf16_f32 v70, v33, v37
    v_cvt_pk_bf16_f32 v71, v41, v45
    s_mov_b64 exec, s[6:7]
    global_store_dwordx4 v4, v[68:71], s[28:29] offset:-2048
    s_mov_b64 exec, -1
    v_fma_mix_f32 v18, v49, v18, v94 op_sel:[0,0,0] op_sel_hi:[1,0,0]
    v_fma_mix_f32 v22, v51, v22, v94 op_sel:[0,0,0] op_sel_hi:[1,0,0]
    v_fma_mix_f32 v26, v53, v26, v94 op_sel:[0,0,0] op_sel_hi:[1,0,0]
    v_fma_mix_f32 v30, v55, v30, v94 op_sel:[0,0,0] op_sel_hi:[1,0,0]
    v_fma_mix_f32 v34, v57, v34, v94 op_sel:[0,0,0] op_sel_hi:[1,0,0]
    v_fma_mix_f32 v38, v59, v38, v94 op_sel:[0,0,0] op_sel_hi:[1,0,0]
    v_fma_mix_f32 v42, v61, v42, v94 op_sel:[0,0,0] op_sel_hi:[1,0,0]
    v_fma_mix_f32 v46, v63, v46, v94 op_sel:[0,0,0] op_sel_hi:[1,0,0]
    v_fma_mix_f32 v18, v113, v18, v90 op_sel:[0,0,0] op_sel_hi:[1,0,0]
    v_fma_mix_f32 v22, v115, v22, v90 op_sel:[0,0,0] op_sel_hi:[1,0,0]
    v_fma_mix_f32 v26, v117, v26, v90 op_sel:[0,0,0] op_sel_hi:[1,0,0]
    v_fma_mix_f32 v30, v119, v30, v90 op_sel:[0,0,0] op_sel_hi:[1,0,0]
    v_fma_mix_f32 v34, v121, v34, v90 op_sel:[0,0,0] op_sel_hi:[1,0,0]
    v_fma_mix_f32 v38, v123, v38, v90 op_sel:[0,0,0] op_sel_hi:[1,0,0]
    v_fma_mix_f32 v42, v125, v42, v90 op_sel:[0,0,0] op_sel_hi:[1,0,0]
    v_fma_mix_f32 v46, v127, v46, v90 op_sel:[0,0,0] op_sel_hi:[1,0,0]
    v_cvt_pk_bf16_f32 v72, v18, v22
    v_cvt_pk_bf16_f32 v73, v26, v30
    v_cvt_pk_bf16_f32 v74, v34, v38
    v_cvt_pk_bf16_f32 v75, v42, v46
    s_mov_b64 exec, s[8:9]
    global_store_dwordx4 v4, v[72:75], s[28:29] offset:0
    s_mov_b64 exec, -1
    v_fma_mix_f32 v19, v49, v19, v95 op_sel:[1,0,0] op_sel_hi:[1,0,0]
    v_fma_mix_f32 v23, v51, v23, v95 op_sel:[1,0,0] op_sel_hi:[1,0,0]
    v_fma_mix_f32 v27, v53, v27, v95 op_sel:[1,0,0] op_sel_hi:[1,0,0]
    v_fma_mix_f32 v31, v55, v31, v95 op_sel:[1,0,0] op_sel_hi:[1,0,0]
    v_fma_mix_f32 v35, v57, v35, v95 op_sel:[1,0,0] op_sel_hi:[1,0,0]
    v_fma_mix_f32 v39, v59, v39, v95 op_sel:[1,0,0] op_sel_hi:[1,0,0]
    v_fma_mix_f32 v43, v61, v43, v95 op_sel:[1,0,0] op_sel_hi:[1,0,0]
    v_fma_mix_f32 v47, v63, v47, v95 op_sel:[1,0,0] op_sel_hi:[1,0,0]
    v_fma_mix_f32 v19, v113, v19, v91 op_sel:[1,0,0] op_sel_hi:[1,0,0]
    v_fma_mix_f32 v23, v115, v23, v91 op_sel:[1,0,0] op_sel_hi:[1,0,0]
    v_fma_mix_f32 v27, v117, v27, v91 op_sel:[1,0,0] op_sel_hi:[1,0,0]
    v_fma_mix_f32 v31, v119, v31, v91 op_sel:[1,0,0] op_sel_hi:[1,0,0]
    v_fma_mix_f32 v35, v121, v35, v91 op_sel:[1,0,0] op_sel_hi:[1,0,0]
    v_fma_mix_f32 v39, v123, v39, v91 op_sel:[1,0,0] op_sel_hi:[1,0,0]
    v_fma_mix_f32 v43, v125, v43, v91 op_sel:[1,0,0] op_sel_hi:[1,0,0]
    v_fma_mix_f32 v47, v127, v47, v91 op_sel:[1,0,0] op_sel_hi:[1,0,0]
    v_cvt_pk_bf16_f32 v76, v19, v23
    v_cvt_pk_bf16_f32 v77, v27, v31
    v_cvt_pk_bf16_f32 v78, v35, v39
    v_cvt_pk_bf16_f32 v79, v43, v47
    s_mov_b64 exec, s[10:11]
    global_store_dwordx4 v4, v[76:79], s[28:29] offset:2048
    s_mov_b64 exec, -1
    s_or_b32 s40, s2, s3
    s_cbranch_scc1 L_fin
    s_add_u32 s40, s47, 1
    v_mov_b32 v5, s40
    s_mov_b64 exec, 1
    global_store_dword v3, v5, s[32:33]
    s_branch L_fin
    s_nop 0
L_exp:
    v_lshrrev_b32 v20, 4, v1
    v_and_b32 v21, 240, v2
    v_lshrrev_b32_e64 v22, 5, v1
    v_and_b32_e64 v23, 1, v20
    v_lshl_add_u32 v4, v22, 4, v23
    v_mul_u32_u24 v4, 7168, v4
    v_add_u32 v4, v4, v21
    s_bitcmp1_b32 s35, 0
    s_cselect_b64 s[48:49], s[24:25], s[22:23]
    s_lshr_b32 s40, s35, 1
    s_lshl2_add_u32 s40, s40, s34
    s_lshl_b32 s43, s40, 7
    s_mul_i32 s40, s40, 458752
    s_mul_i32 s41, s36, 37
    s_lshr_b32 s41, s41, 8
    s_mul_i32 s42, s41, 7
    s_sub_u32 s7, s36, s42
    s_lshl_b32 s41, s41, 2
    s_lshr_b32 s41, 0x2031, s41
    s_and_b32 s41, s41, 3
    s_lshl2_add_u32 s7, s7, s41
    s_lshl_b32 s41, s7, 8
    s_add_u32 s40, s40, s41
    s_add_u32 s48, s48, s40
    s_addc_u32 s49, s49, 0
    s_add_u32 s10, s48, 229376
    s_addc_u32 s11, s49, 0
    v_lshl_add_u32 v5, v22, 3, v23
    v_lshl_add_u32 v5, v5, 11, v21
    v_lshrrev_b32 v19, 1, v21
    v_and_b32 v23, 3, v1
    v_mul_u32_u24 v14, 0x5555, v23
    v_lshlrev_b32 v23, 3, v23
    v_lshl_add_u32 v17, v20, 5, v23
    v_and_b32 v22, 8, v1
    v_lshl_add_u32 v11, v22, 6, v17
    v_bfe_i32 v9, v1, 2, 1
    v_lshrrev_b32 v7, 16, v9
    v_lshlrev_b32 v9, 16, v9
    v_xor_b32 v6, 0xffff, v7
    v_xor_b32 v8, 0xffff0000, v9
    v_and_b32 v23, 512, v2
    v_lshl_add_u32 v23, v21, 1, v23
    v_and_b32 v22, 16, v1
    s_lshl_b32 s40, s34, 10
    v_add3_u32 v10, v22, v23, s40
    v_add_u32 v17, s43, v17
    s_add_u32 s30, s32, 32768
    s_addc_u32 s31, s33, 0
    s_lshl2_add_u32 s40, s7, s34
    s_lshl_b32 s40, s40, 16
    s_lshl_b32 s41, s35, 8
    s_add_u32 s40, s40, s41
    s_add_u32 s40, s40, 4096
    s_add_u32 s50, s26, s40
    s_addc_u32 s51, s27, 0
    s_add_u32 s52, s50, 32768
    s_addc_u32 s53, s51, 0
    s_add_u32 s74, s50, 8192
    s_addc_u32 s75, s51, 0
    s_add_u32 s76, s52, 8192
    s_addc_u32 s77, s53, 0
    s_lshl_b32 s40, s2, 7
    s_add_u32 s40, s40, 98304
    s_add_u32 s54, s32, s40
    s_addc_u32 s55, s33, 0
    s_lshl_b32 s40, s36, 10
    s_lshl2_add_u32 s40, s35, s40
    s_add_u32 s40, s40, 98304
    s_add_u32 s56, s32, s40
    s_addc_u32 s57, s33, 0
    s_lshl_b32 s40, s2, 10
    s_add_u32 s40, s40, 131072
    s_add_u32 s58, s32, s40
    s_addc_u32 s59, s33, 0
    s_lshl_b32 s40, s36, 13
    s_lshl_b32 s41, s34, 7
    s_add_u32 s40, s40, s41
    s_add_u32 s40, s40, 135168
    s_add_u32 s60, s32, s40
    s_addc_u32 s61, s33, 0
    s_mul_i32 s40, s35, 28
    s_add_u32 s40, s40, s36
    s_lshl_b32 s40, s40, 10
    s_add_u32 s40, s40, 524288
    s_add_u32 s62, s32, s40
    s_addc_u32 s63, s33, 0
    s_setprio 3
    s_lshl_b32 s40, s34, 7
    v_mov_b32 v16, s40
    s_mov_b32 s46, 0
L_sp_29:
    ds_read_b64 v[22:23], v3 offset:40
    s_waitcnt lgkmcnt(0)
    v_cmp_eq_u32_e64 vcc, 0, v23
    s_cbranch_vccz L_spd_30
    s_add_u32 s46, s46, 1
    s_cmp_lt_u32 s46, 400000
    s_cbranch_scc1 L_sp_29
    s_branch L_end
L_spd_30:
    v_readfirstlane_b32 s39, v22
    s_and_b32 s40, s39, 1
    s_mul_i32 s40, s40, 0x01010101
    s_and_b32 s41, s39, 0xfefefefe
    s_or_b32 s41, s41, s40
    v_bfe_u32 v28, s41, v11, 8
    v_lshrrev_b32 v29, v2, s41
    v_lshrrev_b32 v30, 8, v29
    s_cmp_ge_u32 s36, 28
    s_cbranch_scc1 L_noexp
    global_load_dwordx4 v[32:35], v4, s[48:49] nt
    s_add_u32 s48, s48, 14336
    s_addc_u32 s49, s49, 0
    global_load_dwordx4 v[36:39], v4, s[10:11] nt
    s_add_u32 s10, s10, 14336
    s_addc_u32 s11, s11, 0
    s_cmp_lg_u32 s34, 0
    s_cbranch_scc1 L_warm_31
    s_load_dword s8, s[54:55], 0 glc
L_warm_31:
    v_and_b32 v18, 128, v2
    v_lshl_add_u32 v18, v16, 1, v18
    global_load_dword v31, v18, s[62:63]
    s_nop 0
    s_waitcnt vmcnt(2)
    global_load_dwordx4 v[40:43], v4, s[48:49] nt
    s_add_u32 s48, s48, 14336
    s_addc_u32 s49, s49, 0
    s_waitcnt vmcnt(2)
    global_load_dwordx4 v[44:47], v4, s[10:11] nt
    s_add_u32 s10, s10, 14336
    s_addc_u32 s11, s11, 0
    s_waitcnt vmcnt(1)
    global_load_dwordx4 v[48:51], v4, s[48:49] nt
    s_add_u32 s48, s48, 14336
    s_addc_u32 s49, s49, 0
    s_waitcnt vmcnt(1)
    global_load_dwordx4 v[52:55], v4, s[10:11] nt
    s_add_u32 s10, s10, 14336
    s_addc_u32 s11, s11, 0
    s_waitcnt vmcnt(2)
    global_load_dwordx4 v[56:59], v4, s[48:49] nt
    s_add_u32 s48, s48, 14336
    s_addc_u32 s49, s49, 0
    s_waitcnt vmcnt(3)
    global_load_dwordx4 v[60:63], v4, s[10:11] nt
    s_add_u32 s10, s10, 14336
    s_addc_u32 s11, s11, 0
    s_waitcnt vmcnt(4)
    global_load_dwordx4 v[64:67], v4, s[48:49] nt
    s_add_u32 s48, s48, 14336
    s_addc_u32 s49, s49, 0
    s_waitcnt vmcnt(5)
    global_load_dwordx4 v[68:71], v4, s[10:11] nt
    s_add_u32 s10, s10, 14336
    s_addc_u32 s11, s11, 0
    s_waitcnt vmcnt(5)
    global_load_dwordx4 v[72:75], v4, s[48:49] nt
    s_add_u32 s48, s48, 14336
    s_addc_u32 s49, s49, 0
    s_waitcnt vmcnt(5)
    global_load_dwordx4 v[76:79], v4, s[10:11] nt
    s_add_u32 s10, s10, 14336
    s_addc_u32 s11, s11, 0
    s_mov_b32 s46, 0
L_sp_32:
    ds_read_b64 v[24:25], v19 offset:128
    s_waitcnt lgkmcnt(0)
    v_cmp_eq_u32 vcc, 0, v24
    s_cbranch_vccz L_spd_33
    s_add_u32 s46, s46, 1
    s_sleep 1
    s_cmp_lt_u32 s46, 400000
    s_cbranch_scc1 L_sp_32
    s_branch L_end
    s_nop 0
L_spd_33:
    v_max_u32_dpp v27, v25, v25 quad_perm:[1,0,3,2] row_mask:0xf bank_mask:0xf
    v_min_u32_dpp v26, v24, v24 quad_perm:[1,0,3,2] row_mask:0xf bank_mask:0xf
    v_max_u32 v25, v26, v27
    v_max_u32_dpp v24, v24, v24 quad_perm:[1,0,3,2] row_mask:0xf bank_mask:0xf
    s_nop 0
    v_max_u32_dpp v27, v25, v25 quad_perm:[2,3,0,1] row_mask:0xf bank_mask:0xf
    v_min_u32_dpp v26, v24, v24 quad_perm:[2,3,0,1] row_mask:0xf bank_mask:0xf
    v_max_u32 v25, v26, v27
    v_max_u32_dpp v24, v24, v24 quad_perm:[2,3,0,1] row_mask:0xf bank_mask:0xf
    s_nop 0
    v_max_u32_dpp v27, v25, v25 row_half_mirror row_mask:0xf bank_mask:0xf
    v_min_u32_dpp v26, v24, v24 row_half_mirror row_mask:0xf bank_mask:0xf
    v_max_u32 v25, v26, v27
    v_max_u32_dpp v24, v24, v24 row_half_mirror row_mask:0xf bank_mask:0xf
    s_nop 0
    v_max_u32_dpp v27, v25, v25 row_mirror row_mask:0xf bank_mask:0xf
    v_min_u32_dpp v26, v24, v24 row_mirror row_mask:0xf bank_mask:0xf
    v_max_u32_e64 v25, v26, v27
    v_max_u32_dpp v24, v24, v24 row_mirror row_mask:0xf bank_mask:0xf
    s_mov_b32 vcc_lo, 0xff00ff00
    s_mov_b32 vcc_hi, 0xff00ff00
    s_movk_i32 s40, 2047
    v_cndmask_b32 v16, v24, v25, vcc
    v_bfi_b32 v18, v16, 0, s40
    v_lshl_add_u32 v17, v18, 11, v17
    v_lshlrev_b32_e64 v18, 3, v18
    global_load_dwordx2 v[20:21], v17, s[4:5]
    global_load_dword v22, v18, s[30:31] sc1
    v_mov_b32_e64 v0, 1
    s_mov_b64 exec, 1
    ds_add_u32 v3, v0 offset:92
    s_mov_b64 exec, -1
    global_load_dwordx4 v[80:83], v4, s[48:49] nt
    s_add_u32 s48, s48, 14336
    s_addc_u32 s49, s49, 0
    global_load_dwordx4 v[84:87], v4, s[10:11] nt
    s_add_u32 s10, s10, 14336
    s_addc_u32 s11, s11, 0
    global_load_dwordx4 v[88:91], v4, s[48:49] nt
    global_load_dwordx4 v[92:95], v4, s[10:11] nt
    s_mov_b64 exec, 1
    ds_write_b64 v3, v[24:25] offset:32
    s_mov_b64 exec, -1
    v_readfirstlane_b32 s16, v24
    v_readfirstlane_b32 s17, v25
    s_cmp_eq_u32 s34, 0
    s_cselect_b32 s16, s16, s17
    s_andn2_b32 s17, 2047, s16
    s_lshr_b32 s40, s17, 8
    s_add_u32 s41, s40, 2
    s_bfe_u32 s19, s41, 0x10002
    s_xor_b32 s19, s19, s38
    s_and_b32 s42, s34, 2
    s_or_b32 s19, s19, s42
    s_cmp_eq_u32 s38, 0
    s_cselect_b32 s18, s40, s41
    s_and_b32 s18, s18, 3
    s_mul_i32 s40, s35, 28672
    s_and_b32 s41, s34, 1
    s_lshl_b32 s41, s41, 9
    s_add_u32 s40, s40, s41
    s_and_b32 s41, s36, 15
    s_lshl_b32 s41, s41, 5
    s_add_u32 s40, s40, s41
    s_add_u32 s40, s40, 524288
    s_add_u32 s22, s32, s40
    s_addc_u32 s23, s33, 0
    s_add_u32 s24, s22, 262144
    s_nop 0
    s_addc_u32 s25, s23, 0
    s_bfe_u32 s40, s17, 0x20002
    s_bfe_u32 s41, s17, 0x40004
    s_lshl4_add_u32 s40, s40, s41
    s_and_b32 s41, s17, 3
    s_lshl2_add_u32 s40, s40, s41
    s_lshl_b32 s41, s18, 8
    s_add_u32 s40, s40, s41
    s_lshl_b32 s40, s40, 1
    s_add_u32 s20, s40, 52096
    s_bitcmp1_b32 s16, 31
    s_brev_b32 s40, 1
    s_cselect_b32 s40, s40, -1
    s_xor_b32 s40, s40, s16
    s_and_b32 s21, s40, 0xffff0000
    v_mov_b32 v0, 1
    s_waitcnt vmcnt(4)
    v_and_b32 v17, 0xffff0000, v22
    v_rcp_f32 v17, v17
    v_lshlrev_b32 v22, 16, v22
    v_lshlrev_b32_e64 v24, 16, v20
    v_and_b32 v25, 0xffff0000, v20
    v_mul_f32 v22, -v22, v17
    v_lshlrev_b32_e64 v26, 16, v21
    v_and_b32 v27, 0xffff0000, v21
    v_fma_f32 v24, v24, v17, v22
    v_fma_f32 v25, v25, v17, v22
    v_fma_f32 v26, v26, v17, v22
    v_fma_f32 v27, v27, v17, v22
    v_cvt_pk_bf16_f32 v12, v24, v25
    v_cvt_pk_bf16_f32 v13, v26, v27
    v_mov_b32 v24, 0
    v_mov_b32 v25, 0
    v_mov_b32 v26, 0
    v_mov_b32 v27, 0
    v_and_b32_dpp v16, v12, v6 quad_perm:[0,0,0,0] row_mask:0xf bank_mask:0xf
    v_and_b32_dpp v17, v12, v7 quad_perm:[0,0,0,0] row_mask:0xf bank_mask:0xf
    v_and_b32_dpp v18, v12, v8 quad_perm:[0,0,0,0] row_mask:0xf bank_mask:0xf
    v_and_b32_dpp v19, v12, v9 quad_perm:[0,0,0,0] row_mask:0xf bank_mask:0xf
    v_and_b32_dpp v20, v13, v6 quad_perm:[0,0,0,0] row_mask:0xf bank_mask:0xf
    v_and_b32_dpp v21, v13, v7 quad_perm:[0,0,0,0] row_mask:0xf bank_mask:0xf
    v_and_b32_dpp v22, v13, v8 quad_perm:[0,0,0,0] row_mask:0xf bank_mask:0xf
    v_and_b32_dpp v23, v13, v9 quad_perm:[0,0,0,0] row_mask:0xf bank_mask:0xf
    v_smfmac_f32_16x16x64_bf16 v[24:27], v[16:19], v[32:39], v14
    v_and_b32_dpp v16, v12, v6 quad_perm:[1,1,1,1] row_mask:0xf bank_mask:0xf
    v_and_b32_dpp v17, v12, v7 quad_perm:[1,1,1,1] row_mask:0xf bank_mask:0xf
    v_and_b32_dpp v18, v12, v8 quad_perm:[1,1,1,1] row_mask:0xf bank_mask:0xf
    v_and_b32_dpp v19, v12, v9 quad_perm:[1,1,1,1] row_mask:0xf bank_mask:0xf
    v_smfmac_f32_16x16x64_bf16 v[24:27], v[20:23], v[40:47], v14
    v_and_b32_dpp v20, v13, v6 quad_perm:[1,1,1,1] row_mask:0xf bank_mask:0xf
    v_and_b32_dpp v21, v13, v7 quad_perm:[1,1,1,1] row_mask:0xf bank_mask:0xf
    v_and_b32_dpp v22, v13, v8 quad_perm:[1,1,1,1] row_mask:0xf bank_mask:0xf
    v_and_b32_dpp v23, v13, v9 quad_perm:[1,1,1,1] row_mask:0xf bank_mask:0xf
    v_smfmac_f32_16x16x64_bf16 v[24:27], v[16:19], v[48:55], v14
    v_and_b32_dpp v16, v12, v6 quad_perm:[2,2,2,2] row_mask:0xf bank_mask:0xf
    v_and_b32_dpp v17, v12, v7 quad_perm:[2,2,2,2] row_mask:0xf bank_mask:0xf
    v_and_b32_dpp v18, v12, v8 quad_perm:[2,2,2,2] row_mask:0xf bank_mask:0xf
    v_and_b32_dpp v19, v12, v9 quad_perm:[2,2,2,2] row_mask:0xf bank_mask:0xf
    v_smfmac_f32_16x16x64_bf16 v[24:27], v[20:23], v[56:63], v14
    v_and_b32_dpp v20, v13, v6 quad_perm:[2,2,2,2] row_mask:0xf bank_mask:0xf
    v_and_b32_dpp v21, v13, v7 quad_perm:[2,2,2,2] row_mask:0xf bank_mask:0xf
    v_and_b32_dpp v22, v13, v8 quad_perm:[2,2,2,2] row_mask:0xf bank_mask:0xf
    v_and_b32_dpp v23, v13, v9 quad_perm:[2,2,2,2] row_mask:0xf bank_mask:0xf
    v_smfmac_f32_16x16x64_bf16 v[24:27], v[16:19], v[64:71], v14
    v_and_b32_dpp v16, v12, v6 quad_perm:[3,3,3,3] row_mask:0xf bank_mask:0xf
    v_and_b32_dpp v17, v12, v7 quad_perm:[3,3,3,3] row_mask:0xf bank_mask:0xf
    v_and_b32_dpp v18, v12, v8 quad_perm:[3,3,3,3] row_mask:0xf bank_mask:0xf
    v_and_b32_dpp v19, v12, v9 quad_perm:[3,3,3,3] row_mask:0xf bank_mask:0xf
    s_mov_b64 exec, 1
    ds_add_rtn_u32 v31, v3, v0 offset:60
    s_mov_b64 exec, -1
    v_smfmac_f32_16x16x64_bf16 v[24:27], v[20:23], v[72:79], v14
    v_and_b32_dpp v20, v13, v6 quad_perm:[3,3,3,3] row_mask:0xf bank_mask:0xf
    v_and_b32_dpp v21, v13, v7 quad_perm:[3,3,3,3] row_mask:0xf bank_mask:0xf
    v_and_b32_dpp v22, v13, v8 quad_perm:[3,3,3,3] row_mask:0xf bank_mask:0xf
    v_and_b32_dpp v23, v13, v9 quad_perm:[3,3,3,3] row_mask:0xf bank_mask:0xf
    s_waitcnt vmcnt(2)
    v_smfmac_f32_16x16x64_bf16 v[24:27], v[16:19], v[80:87], v14
    global_load_dwordx4 v[96:99], v5, s[50:51] offset:-4096 nt
    s_waitcnt vmcnt(1)
    s_waitcnt lgkmcnt(0)
    v_readfirstlane_b32 s40, v31
    s_cmp_lg_u32 s40, 3
    s_cbranch_scc1 L_ef_34
    v_mov_b32 v31, s39
    v_lshlrev_b32 v0, 7, v1
    s_mov_b64 exec, 255
    global_store_dword v0, v31, s[56:57] sc1
    s_mov_b64 exec, -1
L_ef_34:
    v_smfmac_f32_16x16x64_bf16 v[24:27], v[20:23], v[88:95], v14
    global_load_dwordx4 v[100:103], v5, s[52:53] offset:-4096 nt
    v_mov_b32 v0, 1
    s_movk_i32 s6, 255
    s_nop 4
    ds_write_b128 v10, v[24:27] offset:768
    s_mov_b64 exec, 1
    ds_add_rtn_u32 v31, v3, v0 offset:52
    s_mov_b64 exec, -1
    ds_read_b128 v[48:51], v2 offset:768
    ds_read_b128 v[52:55], v2 offset:1792
    ds_read_b128 v[56:59], v2 offset:2816
    ds_read_b128 v[60:63], v2 offset:3840
    s_waitcnt lgkmcnt(4)
    v_readfirstlane_b32 s40, v31
    s_cmp_lg_u32 s40, 3
    s_cbranch_scc1 L_ha_35
    s_waitcnt lgkmcnt(2)
    v_add_f32 v48, v48, v52
    v_add_f32 v49, v49, v53
    v_add_f32 v50, v50, v54
    v_add_f32 v51, v51, v55
    s_waitcnt lgkmcnt(0)
    v_add_f32 v56, v56, v60
    v_add_f32 v57, v57, v61
    v_add_f32 v58, v58, v62
    v_add_f32 v59, v59, v63
    v_add_f32 v48, v48, v56
    v_add_f32 v49, v49, v57
    v_add_f32 v50, v50, v58
    v_add_f32 v51, v51, v59
    v_bfi_b32 v48, s6, v29, v48
    v_bfi_b32 v50, s6, v30, v50
    global_store_dwordx4 v2, v[48:51], s[58:59] sc1
L_ha_35:
    global_load_dwordx4 v[104:107], v5, s[50:51] offset:0 nt
    global_load_dwordx4 v[108:111], v5, s[52:53] offset:0 nt
    global_load_dwordx4 v[112:115], v5, s[74:75] offset:-4096 nt
    global_load_dwordx4 v[116:119], v5, s[76:77] offset:-4096 nt
    global_load_dwordx4 v[120:123], v5, s[74:75] offset:0 nt
    global_load_dwordx4 v[124:127], v5, s[76:77] offset:0 nt
    v_mov_b32 v24, 0
    v_mov_b32 v25, 0
    v_mov_b32 v26, 0
    v_mov_b32 v27, 0
    s_cmp_lg_u32 s19, 0
    s_cbranch_scc1 L_nort_36
    v_and_b32 v75, 3, v1
    v_lshrrev_b32 v72, 5, v1
    v_lshl_add_u32 v72, v75, 1, v72
    v_lshrrev_b32 v73, 2, v1
    v_lshlrev_b32 v73, 10, v73
    v_lshl_add_u32 v73, v75, 3, v73
    v_add_u32 v74, 16384, v73
    s_lshl_b32 s40, s17, 11
    s_lshl4_add_u32 s40, s37, s40
    v_lshl_add_u32 v75, v72, 1, s40
    global_load_ushort v76, v75, s[4:5]
    v_mov_b32 v80, 0xbfb8aa3b
    v_mul_f32 v80, s21, v80
    v_exp_f32 v80, v80
    v_mov_b32 v84, v28
    v_mov_b32 v85, 0
    v_add_f32 v80, 1.0, v80
    v_rcp_f32 v80, v80
    s_lshl_b32 s40, s18, 2
    v_mov_b32 v81, s40
    v_mul_f32 v80, 0xbfb8aa3b, v80
    v_mul_u32_u24 v78, 14416, v72
    v_add_u32 v78, s20, v78
    s_lshl_b32 s40, s17, 1
    v_mul_u32_u24 v77, 4624, v72
    v_add_u32 v77, s40, v77
    v_lshlrev_b32_e64 v79, 2, v72
L_nort_36:
    s_mov_b32 s46, 0
L_mf_37:
    s_load_dwordx8 s[8:15], s[54:55], 0 glc
    s_add_u32 s46, s46, 1
    s_cmp_gt_u32 s46, 50000
    s_cbranch_scc1 L_end
    s_waitcnt lgkmcnt(0)
    s_xor_b32 s40, s8, s39
    s_xor_b32 s41, s9, s39
    s_or_b32 s40, s40, s41
    s_xor_b32 s41, s10, s39
    s_or_b32 s40, s40, s41
    s_xor_b32 s41, s11, s39
    s_or_b32 s40, s40, s41
    s_xor_b32 s41, s12, s39
    s_or_b32 s40, s40, s41
    s_xor_b32 s41, s13, s39
    s_or_b32 s40, s40, s41
    s_xor_b32 s41, s14, s39
    s_or_b32 s40, s40, s41
    s_xor_b32 s41, s15, s39
    s_or_b32 s40, s40, s41
    s_cbranch_scc1 L_mf_37
    s_mov_b32 s46, 0
L_hp_38:
    global_load_dwordx2 v[32:33], v11, s[60:61] offset:-4096 sc1
    global_load_dwordx2 v[34:35], v11, s[60:61] offset:-3072 sc1
    global_load_dwordx2 v[36:37], v11, s[60:61] offset:-2048 sc1
    global_load_dwordx2 v[38:39], v11, s[60:61] offset:-1024 sc1
    global_load_dwordx2 v[40:41], v11, s[60:61] offset:0 sc1
    global_load_dwordx2 v[42:43], v11, s[60:61] offset:1024 sc1
    global_load_dwordx2 v[44:45], v11, s[60:61] offset:2048 sc1
    global_load_dwordx2 v[46:47], v11, s[60:61] offset:3072 sc1
    s_add_u32 s46, s46, 1
    s_cmp_gt_u32 s46, 50000
    s_cbranch_scc1 L_end
L_hc_39:
    s_waitcnt vmcnt(7)
    v_xor_b32 v32, v28, v32
    s_waitcnt vmcnt(6)
    v_xor_b32 v34, v28, v34
    v_or_b32 v31, v32, v34
    s_waitcnt vmcnt(5)
    v_xor_b32 v36, v28, v36
    v_add_f32 v64, v32, v36
    v_add_f32 v65, v33, v37
    s_waitcnt vmcnt(4)
    v_xor_b32_e64 v38, v28, v38
    v_or3_b32 v31, v31, v36, v38
    v_add_f32 v66, v34, v38
    v_add_f32 v67, v35, v39
    s_waitcnt vmcnt(3)
    v_xor_b32 v40, v28, v40
    v_add_f32 v64, v64, v40
    v_add_f32 v65, v65, v41
    s_waitcnt vmcnt(2)
    v_xor_b32 v42, v28, v42
    v_or3_b32 v31, v31, v40, v42
    v_add_f32 v66, v66, v42
    v_add_f32 v67, v67, v43
    s_waitcnt vmcnt(1)
    v_xor_b32 v44, v28, v44
    v_add_f32 v64, v64, v44
    v_add_f32 v65, v65, v45
    s_waitcnt vmcnt(0)
    v_xor_b32 v46, v28, v46
    v_or3_b32 v31, v31, v44, v46
    v_add_f32 v66, v66, v46
    v_add_f32 v67, v67, v47
    v_and_b32 v31, 0xff, v31
    v_cmp_ne_u32_e64 vcc, 0, v31
    v_mul_f32 v68, 0xbfb8aa3b, v64
    v_mul_f32 v69, 0xbfb8aa3b, v65
    s_cbranch_vccnz L_hp_38
    v_exp_f32 v68, v68
    v_exp_f32 v69, v69
    v_mul_f32 v64, v64, v66
    v_mul_f32 v65, v65, v67
    v_add_f32 v68, 1.0, v68
    v_add_f32 v69, 1.0, v69
    v_rcp_f32 v68, v68
    v_rcp_f32 v69, v69
    v_mul_f32 v64, v64, v68
    v_mul_f32 v65, v65, v69
    v_cvt_pk_bf16_f32 v12, v64, v65
    s_nop 1
    v_and_b32_dpp v16, v12, v6 quad_perm:[0,0,0,0] row_mask:0xf bank_mask:0xf
    v_and_b32_dpp v17, v12, v7 quad_perm:[0,0,0,0] row_mask:0xf bank_mask:0xf
    v_and_b32_dpp v18, v12, v8 quad_perm:[0,0,0,0] row_mask:0xf bank_mask:0xf
    v_and_b32_dpp v19, v12, v9 quad_perm:[0,0,0,0] row_mask:0xf bank_mask:0xf
    v_and_b32_dpp v20, v12, v6 quad_perm:[1,1,1,1] row_mask:0xf bank_mask:0xf
    v_and_b32_dpp v21, v12, v7 quad_perm:[1,1,1,1] row_mask:0xf bank_mask:0xf
    v_and_b32_dpp v22, v12, v8 quad_perm:[1,1,1,1] row_mask:0xf bank_mask:0xf
    v_and_b32_dpp v23, v12, v9 quad_perm:[1,1,1,1] row_mask:0xf bank_mask:0xf
    v_smfmac_f32_16x16x64_bf16 v[24:27], v[16:19], v[96:103], v14
    v_and_b32_dpp v16, v12, v6 quad_perm:[2,2,2,2] row_mask:0xf bank_mask:0xf
    v_and_b32_dpp v17, v12, v7 quad_perm:[2,2,2,2] row_mask:0xf bank_mask:0xf
    v_and_b32_dpp v18, v12, v8 quad_perm:[2,2,2,2] row_mask:0xf bank_mask:0xf
    v_and_b32_dpp v19, v12, v9 quad_perm:[2,2,2,2] row_mask:0xf bank_mask:0xf
    v_smfmac_f32_16x16x64_bf16 v[24:27], v[20:23], v[104:111], v14
    v_and_b32_dpp v20, v12, v6 quad_perm:[3,3,3,3] row_mask:0xf bank_mask:0xf
    v_and_b32_dpp v21, v12, v7 quad_perm:[3,3,3,3] row_mask:0xf bank_mask:0xf
    v_and_b32_dpp v22, v12, v8 quad_perm:[3,3,3,3] row_mask:0xf bank_mask:0xf
    v_and_b32_dpp v23, v12, v9 quad_perm:[3,3,3,3] row_mask:0xf bank_mask:0xf
    v_smfmac_f32_16x16x64_bf16 v[24:27], v[16:19], v[112:119], v14
    s_nop 0
    v_smfmac_f32_16x16x64_bf16 v[24:27], v[20:23], v[120:127], v14
    s_add_u32 s58, s62, 262144
    s_addc_u32 s59, s63, 0
    v_mov_b32_e64 v0, 1
    s_movk_i32 s6, 255
    s_nop 3
    ds_write_b128 v10, v[24:27] offset:768
    s_mov_b64 exec, 1
    ds_add_rtn_u32 v31, v3, v0 offset:52
    s_mov_b64 exec, -1
    ds_read_b128 v[48:51], v2 offset:768
    ds_read_b128 v[52:55], v2 offset:1792
    ds_read_b128 v[56:59], v2 offset:2816
    ds_read_b128 v[60:63], v2 offset:3840
    s_waitcnt lgkmcnt(4)
    v_readfirstlane_b32 s40, v31
    s_cmp_lg_u32 s40, 7
    s_cbranch_scc1 L_hb_40
    s_waitcnt lgkmcnt(2)
    v_add_f32 v48, v48, v52
    v_add_f32 v49, v49, v53
    v_add_f32 v50, v50, v54
    v_add_f32 v51, v51, v55
    s_waitcnt lgkmcnt(0)
    v_add_f32 v56, v56, v60
    v_add_f32 v57, v57, v61
    v_add_f32 v58, v58, v62
    v_add_f32 v59, v59, v63
    v_add_f32 v48, v48, v56
    v_add_f32 v49, v49, v57
    v_add_f32 v50, v50, v58
    v_add_f32 v51, v51, v59
    v_bfi_b32 v48, s6, v29, v48
    v_bfi_b32 v50, s6, v30, v50
    global_store_dwordx4 v2, v[48:51], s[62:63]
    global_store_dwordx4 v2, v[48:51], s[58:59] sc1
L_hb_40:
    s_branch L_routed
    s_nop 0
L_noexp:
    s_mov_b32 s46, 0
L_sp_41:
    ds_read_b64 v[24:25], v19 offset:128
    s_waitcnt lgkmcnt(0)
    v_cmp_eq_u32 vcc, 0, v24
    s_cbranch_vccz L_spd_42
    s_add_u32 s46, s46, 1
    s_sleep 2
    s_cmp_lt_u32 s46, 400000
    s_cbranch_scc1 L_sp_41
    s_branch L_end
L_spd_42:
    v_max_u32_dpp v27, v25, v25 quad_perm:[1,0,3,2] row_mask:0xf bank_mask:0xf
    v_min_u32_dpp v26, v24, v24 quad_perm:[1,0,3,2] row_mask:0xf bank_mask:0xf
    v_max_u32 v25, v26, v27
    v_max_u32_dpp v24, v24, v24 quad_perm:[1,0,3,2] row_mask:0xf bank_mask:0xf
    s_nop 0
    v_max_u32_dpp v27, v25, v25 quad_perm:[2,3,0,1] row_mask:0xf bank_mask:0xf
    v_min_u32_dpp v26, v24, v24 quad_perm:[2,3,0,1] row_mask:0xf bank_mask:0xf
    v_max_u32 v25, v26, v27
    v_max_u32_dpp v24, v24, v24 quad_perm:[2,3,0,1] row_mask:0xf bank_mask:0xf
    s_nop 0
    v_max_u32_dpp v27, v25, v25 row_half_mirror row_mask:0xf bank_mask:0xf
    v_min_u32_dpp v26, v24, v24 row_half_mirror row_mask:0xf bank_mask:0xf
    v_max_u32 v25, v26, v27
    v_max_u32_dpp v24, v24, v24 row_half_mirror row_mask:0xf bank_mask:0xf
    s_nop 0
    v_max_u32_dpp v27, v25, v25 row_mirror row_mask:0xf bank_mask:0xf
    v_min_u32_dpp v26, v24, v24 row_mirror row_mask:0xf bank_mask:0xf
    v_max_u32_e64 v25, v26, v27
    v_max_u32_dpp v24, v24, v24 row_mirror row_mask:0xf bank_mask:0xf
    v_mov_b32 v0, 1
    s_mov_b64 exec, 1
    ds_add_u32 v3, v0 offset:92
    s_mov_b64 exec, -1
    s_mov_b64 exec, 1
    ds_write_b64 v3, v[24:25] offset:32
    s_mov_b64 exec, -1
    v_readfirstlane_b32 s16, v24
    v_readfirstlane_b32 s17, v25
    s_cmp_eq_u32 s34, 0
    s_cselect_b32 s16, s16, s17
    s_andn2_b32 s17, 2047, s16
    s_lshr_b32 s40, s17, 8
    s_add_u32 s41, s40, 2
    s_bfe_u32 s19, s41, 0x10002
    s_xor_b32 s19, s19, s38
    s_and_b32 s42, s34, 2
    s_or_b32 s19, s19, s42
    s_cmp_eq_u32 s38, 0
    s_cselect_b32 s18, s40, s41
    s_and_b32 s18, s18, 3
    s_mul_i32 s40, s35, 28672
    s_and_b32 s41, s34, 1
    s_lshl_b32 s41, s41, 9
    s_add_u32 s40, s40, s41
    s_and_b32 s41, s36, 15
    s_lshl_b32 s41, s41, 5
    s_add_u32 s40, s40, s41
    s_add_u32 s40, s40, 524288
    s_add_u32 s22, s32, s40
    s_addc_u32 s23, s33, 0
    s_add_u32 s24, s22, 262144
    s_addc_u32 s25, s23, 0
    s_bfe_u32 s40, s17, 0x20002
    s_bfe_u32 s41, s17, 0x40004
    s_lshl4_add_u32 s40, s40, s41
    s_and_b32 s41, s17, 3
    s_lshl2_add_u32 s40, s40, s41
    s_lshl_b32 s41, s18, 8
    s_add_u32 s40, s40, s41
    s_lshl_b32 s40, s40, 1
    s_add_u32 s20, s40, 52096
    s_bitcmp1_b32 s16, 31
    s_brev_b32 s40, 1
    s_cselect_b32 s40, s40, -1
    s_xor_b32 s40, s40, s16
    s_and_b32 s21, s40, 0xffff0000
    s_cmp_lg_u32 s19, 0
    s_cbranch_scc1 L_fin
    v_and_b32 v75, 3, v1
    v_lshrrev_b32 v72, 5, v1
    v_lshl_add_u32 v72, v75, 1, v72
    v_lshrrev_b32 v73, 2, v1
    v_lshlrev_b32 v73, 10, v73
    v_lshl_add_u32 v73, v75, 3, v73
    v_add_u32 v74, 16384, v73
    s_lshl_b32 s40, s17, 11
    s_lshl4_add_u32 s40, s37, s40
    v_lshl_add_u32 v75, v72, 1, s40
    global_load_ushort v76, v75, s[4:5]
    v_mov_b32 v80, 0xbfb8aa3b
    v_mul_f32 v80, s21, v80
    v_exp_f32 v80, v80
    v_mov_b32 v84, v28
    v_mov_b32 v85, 0
    v_add_f32 v80, 1.0, v80
    v_rcp_f32 v80, v80
    s_lshl_b32 s40, s18, 2
    v_mov_b32 v81, s40
    v_mul_f32 v80, 0xbfb8aa3b, v80
    v_mul_u32_u24 v78, 14416, v72
    v_add_u32 v78, s20, v78
    s_lshl_b32 s40, s17, 1
    v_mul_u32_u24 v77, 4624, v72
    v_add_u32 v77, s40, v77
    v_lshlrev_b32 v79, 2, v72
L_nort_43:
    s_mov_b32 s46, 0
L_sp_44:
    ds_read_b32 v72, v3 offset:64
    s_waitcnt lgkmcnt(0)
    v_cmp_gt_u32 vcc, 8, v72
    s_cbranch_vccz L_spd_45
    s_add_u32 s46, s46, 1
    s_sleep 4
    s_cmp_lt_u32 s46, 400000
    s_cbranch_scc1 L_sp_44
    s_branch L_end
    s_nop 0
L_spd_45:
L_routed:
    s_cmp_lg_u32 s19, 0
    s_cbranch_scc1 L_fin
    s_mov_b32 s46, 0
L_ba_46:
    global_load_dwordx2 v[82:83], v73, s[22:23] sc1
    s_mov_b32 exec_hi, 0xffff
    global_load_dwordx2 v[84:85], v74, s[22:23] sc1
    s_mov_b32 exec_hi, -1
L_bc_47:
    s_waitcnt vmcnt(0)
    v_xor_b32 v86, v28, v82
    v_xor_b32 v0, v28, v84
    v_or_b32_e64 v31, v86, v0
    v_and_b32 v31, 0xff, v31
    v_cmp_ne_u32 vcc, 0, v31
    v_add_f32 v86, v86, v0
    v_add_f32_e64 v87, v83, v85
    s_cbranch_vccz L_bo_48
    s_add_u32 s46, s46, 1
    s_cmp_lt_u32 s46, 24
    s_cbranch_scc1 L_ba_46
    s_cmp_gt_u32 s46, 50000
    s_cbranch_scc1 L_end
    s_sleep 2
    global_load_dwordx2 v[82:83], v73, s[24:25] sc1
    s_mov_b32 exec_hi, 0xffff
    global_load_dwordx2 v[84:85], v74, s[24:25] sc1
    s_mov_b32 exec_hi, -1
    s_branch L_bc_47
    s_nop 0
L_bo_48:
    v_lshlrev_b32 v76, 16, v76
    s_nop 0
    v_permlane32_swap_b32 v86, v87
    v_add_f32_e64 v86, v86, v87
    v_mov_b32 v87, v86
    s_mov_b32 s46, 0
    ds_read_b32 v72, v81 offset:64
    ds_read_u16 v82, v78
    ds_read_u16 v83, v77 offset:9488
    ds_read_b32 v84, v79 offset:0
    v_permlane16_swap_b32 v86, v87
    v_add_f32 v86, v86, v87
    s_nop 1
    v_add_f32_dpp v86, v86, v86 row_ror:8 row_mask:0xf bank_mask:0xf
    s_nop 1
    v_add_f32_dpp v86, v86, v86 row_ror:4 row_mask:0xf bank_mask:0xf
    s_branch L_spc_51
    s_nop 0
L_sp_49:
    ds_read_b32 v72, v81 offset:64
    ds_read_u16 v82, v78
    ds_read_u16 v83, v77 offset:9488
    ds_read_b32 v84, v79 offset:0
L_spc_51:
    s_waitcnt lgkmcnt(0)
    v_cmp_gt_u32 vcc, 8, v72
    s_cbranch_vccz L_spd_50
    s_add_u32 s46, s46, 1
    s_sleep 1
    s_cmp_lt_u32 s46, 400000
    s_cbranch_scc1 L_sp_49
    s_branch L_end
L_spd_50:
    v_fma_mix_f32 v77, v86, v80, v83 op_sel_hi:[0,0,1]
    v_exp_f32 v86, v77
    v_fma_mix_f32 v82, v82, v77, 0 op_sel_hi:[1,0,0]
    v_fma_f32 v86, v86, v84, v84
    v_rcp_f32 v86, v86
    s_mov_b32 exec_lo, 15
    s_mov_b32 exec_hi, 15
    v_fmac_f32 v76, v82, v86
    v_cvt_pk_bf16_f32 v76, v76, v76
    global_store_short v75, v76, s[28:29]
    s_branch L_fin
    s_nop 0
L_cnv:
    v_add_u32_e64 v85, s58, v2
    ds_read_b128 v[12:15], v85 offset:0
    ds_read_b128 v[4:7], v85 offset:4624
    ds_read_b128 v[16:19], v85 offset:9248
    ds_read_b128 v[20:23], v85 offset:13872
    s_mul_i32 s50, s34, 14416
    s_add_u32 s50, s50, 45952
    s_mov_b32 m0, s50
    s_mov_b32 s52, 0x3f803f80
    s_mov_b32 s54, 0x41000000
    s_mov_b32 s55, 0
    s_mul_i32 s56, s59, 0x02020000
    s_add_u32 s56, s56, 0x01000c0c
    s_lshl3_add_u32 s40, s37, s34
    s_lshl_b32 s40, s40, 11
    s_add_u32 s40, s40, 8388608
    s_add_u32 s62, s32, s40
    s_addc_u32 s63, s33, 0
    v_mov_b32 v88, 0
    v_mov_b32 v89, 0
    v_mov_b32 v90, 0
    v_mov_b32 v91, 0
    s_mul_i32 s40, s34, 4624
    s_add_u32 s40, s40, 8960
    v_add_u32 v85, s40, v2
    s_mov_b32 exec_lo, -1
    s_mov_b32 exec_hi, 1
    ds_write_b128 v85, v[88:91]
    s_mov_b64 exec, -1
    v_mov_b32 v86, 0x3c00
    ds_write_addtid_b32 v86
    s_waitcnt lgkmcnt(0)
    s_and_b32 s41, s34, 1
    s_lshl_b32 s41, s41, 4
    s_lshr_b32 s48, s48, s41
    s_lshl_b32 s48, s48, 16
    s_lshr_b32 s51, s49, s41
    s_lshl_b32 s51, s51, 16
    v_mov_b32 v85, 0x3fb8aa3b
    v_mul_f32 v85, s48, v85
    v_exp_f32 v85, v85
    v_mov_b32 v26, 0
    v_cvt_pk_bf16_f32 v85, v85, v85
    v_writelane_b32 v26, s51, 0
    v_and_b32 v85, 0xffff0000, v85
    s_bitset0_b32 s51, 31
    v_mul_f32 v28, 0xbfb8aa3b, v85
    v_mul_f32 v29, 0x3e22f983, v85
    v_add_f32 v30, v85, v85
    v_mov_b32 v0, 1
    s_lshl_b32 s41, s60, 2
    v_mov_b32 v31, s41
    v_and_b32 v24, 12, v31
    v_add_u32 v4, s40, v4
    v_add_u32 v16, s50, v16
    v_add_u32 v17, s50, v17
    v_add_u32 v6, s50, v6
    v_add_u32 v7, s50, v7
    v_add_u32 v20, s50, v20
    v_add_u32 v18, s50, v18
    v_add_u32 v19, s50, v19
    s_mov_b32 s57, s40
    s_sub_u32 s41, s50, s57
    s_add_u32 s41, s41, 8912
    s_and_b32 s41, s41, 255
    s_add_u32 s41, s41, s57
    s_sub_u32 s41, s41, 8704
    s_mov_b32 exec_lo, 0x0f000000
    s_mov_b32 exec_hi, 0x0f000000
    v_mov_b32 v16, s41
    s_sub_u32 s41, s50, s57
    s_add_u32 s41, s41, 8816
    s_and_b32 s41, s41, 255
    s_add_u32 s41, s41, s57
    s_sub_u32 s41, s41, 8704
    s_mov_b32 exec_lo, 0xf0000000
    s_mov_b32 exec_hi, 0xf0000000
    v_mov_b32 v16, s41
    s_mov_b64 exec, -1
    s_add_u32 s41, s50, 1072
    v_sub_u32 v25, s41, v2
    s_mov_b32 s46, 0
L_sp_52:
    ds_read_b64 v[42:43], v3 offset:40
    s_waitcnt lgkmcnt(0)
    v_cmp_eq_u32 vcc, 0, v43
    s_cbranch_vccz L_spd_53
    s_add_u32 s46, s46, 1
    s_sleep 1
    s_cmp_lt_u32 s46, 400000
    s_cbranch_scc1 L_sp_52
    s_branch L_end
    s_nop 0
L_spd_53:
    v_readfirstlane_b32 s39, v42
    v_lshlrev_b32_e64 v40, 2, v1
    v_alignbit_b32 v40, v42, v42, v40
    v_bfi_b32 v40, 1, v42, v40
    v_lshrrev_b32 v41, 1, v40
    v_lshrrev_b32 v42, 2, v40
    v_lshrrev_b32_e64 v43, 3, v40
    v_and_b32 v40, 0x00010001, v40
    v_and_b32 v41, 0x00010001, v41
    v_and_b32 v42, 0x00010001, v42
    v_and_b32 v43, 0x00010001, v43
    s_add_u32 s41, s50, 6144
    v_lshl_add_u32 v1, v1, 3, s41
    s_mov_b32 s61, 0x00010001
    v_lshrrev_b32 v27, 1, v2
    s_cmp_eq_u32 s38, 0
    s_mov_b32 s40, -57664
    s_cselect_b32 s40, 57664, s40
    v_add_u32 v37, s40, v17
    v_add_u32 v36, s40, v16
    s_add_u32 s40, s40, s50
    s_sub_u32 s41, s40, s57
    s_add_u32 s41, s41, 8912
    s_and_b32 s41, s41, 255
    s_add_u32 s41, s41, s57
    s_sub_u32 s41, s41, 8704
    s_mov_b32 exec_lo, 0x0f000000
    s_mov_b32 exec_hi, 0x0f000000
    v_mov_b32 v36, s41
    s_sub_u32 s41, s40, s57
    s_add_u32 s41, s41, 8816
    s_and_b32 s41, s41, 255
    s_add_u32 s41, s41, s57
    s_sub_u32 s41, s41, 8704
    s_mov_b32 exec_lo, 0xf0000000
    s_mov_b32 exec_hi, 0xf0000000
    v_mov_b32 v36, s41
    s_mov_b64 exec, -1
    s_setprio 3
    s_waitcnt vmcnt(3)
    v_perm_b32 v32, v8, v8, s56
    v_mul_f32 v32, 0x3fb8aa3b, v32
    v_exp_f32 v32, v32
    s_waitcnt vmcnt(2)
    v_perm_b32 v33, v9, v9, s56
    v_cvt_pk_bf16_f32 v32, v32, v32
    v_and_b32 v32, 0xffff0000, v32
    v_pk_mul_f32 v[32:33], v[32:33], v[28:29]
    v_rndne_f32 v87, v33
    v_sub_f32 v33, v33, v87
    s_cmp_lg_u32 s59, 0
    s_cbranch_scc1 L_nosc_54
    v_pk_mul_f32 v[90:91], v[32:33], s[54:55] op_sel_hi:[1,0]
    v_exp_f32 v90, v90
    v_cos_f32 v88, v91
    v_sin_f32 v89, v91
    s_nop 0
    v_pk_mul_f32 v[88:89], v[88:89], v[90:91] op_sel_hi:[1,0]
    v_cvt_pk_f16_f32 v45, v88, v89
    v_pk_mul_f32 v[90:91], v[88:89], v[88:89] op_sel:[1,1] op_sel_hi:[1,0] neg_lo:[1,0]
    v_pk_fma_f32 v[88:89], v[88:89], v[88:89], v[90:91] op_sel:[0,0,0] op_sel_hi:[0,1,1]
    s_waitcnt vmcnt(0)
    s_nop 0
    v_cvt_pk_f16_f32 v46, v88, v89
    v_pk_mul_f32 v[90:91], v[88:89], v[88:89] op_sel:[1,1] op_sel_hi:[1,0] neg_lo:[1,0]
    v_and_b32 v85, 0x7fff7fff, v10
    v_pk_fma_f32 v[88:89], v[88:89], v[88:89], v[90:91] op_sel:[0,0,0] op_sel_hi:[0,1,1]
    v_and_b32 v86, 0x7fff7fff, v11
    v_cvt_pk_f16_f32 v48, v88, v89
    v_pk_mul_f32 v[90:91], v[88:89], v[88:89] op_sel:[1,1] op_sel_hi:[1,0] neg_lo:[1,0]
    v_dot2_f32_bf16 v84, v85, s52, 0
    v_pk_fma_f32 v[88:89], v[88:89], v[88:89], v[90:91] op_sel:[0,0,0] op_sel_hi:[0,1,1]
    v_dot2_f32_bf16 v84, v86, s52, v84
    v_cvt_pk_f16_f32 v52, v88, v89
    s_nop 1
    s_nop 0
    v_add_f32_dpp v84, v84, v84 row_shr:1 row_mask:0xf bank_mask:0xf
    v_pk_mul_f32 v[90:91], v[88:89], v[88:89] op_sel:[1,1] op_sel_hi:[1,0] neg_lo:[1,0]
    v_pk_fma_f32 v[88:89], v[88:89], v[88:89], v[90:91] op_sel:[0,0,0] op_sel_hi:[0,1,1]
    v_add_f32_dpp v84, v84, v84 row_shr:2 row_mask:0xf bank_mask:0xf
    v_cvt_pk_f16_f32 v60, v88, v89
    s_nop 0
    v_add_f32_dpp v84, v84, v84 row_shr:4 row_mask:0xf bank_mask:0xf
    v_exp_f32 v94, v32
    v_cos_f32 v92, v33
    v_add_f32_dpp v84, v84, v84 row_shr:8 row_mask:0xf bank_mask:0xf
    v_sin_f32 v93, v33
    s_nop 0
    v_add_f32_dpp v84, v84, v84 row_bcast:15 row_mask:0xa bank_mask:0xf
    v_pk_mul_f32 v[92:93], v[92:93], v[94:95] op_sel_hi:[1,0]
    s_nop 0
    v_add_f32_dpp v84, v84, v84 row_bcast:31 row_mask:0xc bank_mask:0xf
    v_cvt_pk_f16_f32 v61, v92, v93
    v_pk_mul_f32 v[94:95], v[92:93], v[92:93] op_sel:[1,1] op_sel_hi:[1,0] neg_lo:[1,0]
    v_fma_f32 v84, v84, v30, s51
    v_pk_fma_f32 v[92:93], v[92:93], v[92:93], v[94:95] op_sel:[0,0,0] op_sel_hi:[0,1,1]
    v_frexp_exp_i32_f32_e64 v84, v84
    v_cvt_pk_f16_f32 v62, v92, v93
    v_readlane_b32 s40, v84, 63
    s_sub_i32 s40, 126, s40
    s_max_i32 s40, s40, 67
    s_min_i32 s40, s40, 187
    s_lshl_b32 s40, s40, 23
    v_mov_b32 v78, 0x40053526
    v_mul_f32 v78, s40, v78
    v_mul_f32 v26, s40, v26
    s_mov_b64 exec, 1
    ds_write_b32 v31, v78 offset:0
    s_mov_b64 exec, -1
    s_branch L_scj_55
L_nosc_54:
    v_pk_mul_f32 v[90:91], v[32:33], s[54:55] op_sel_hi:[1,0]
    v_exp_f32 v90, v90
    v_cos_f32 v88, v91
    v_exp_f32 v94, v32
    v_sin_f32 v89, v91
    s_nop 0
    v_pk_mul_f32 v[88:89], v[88:89], v[90:91] op_sel_hi:[1,0]
    v_cos_f32 v92, v33
    v_cvt_pk_f16_f32 v45, v88, v89
    v_pk_mul_f32 v[90:91], v[88:89], v[88:89] op_sel:[1,1] op_sel_hi:[1,0] neg_lo:[1,0]
    v_sin_f32_e64 v93, v33
    v_pk_fma_f32 v[88:89], v[88:89], v[88:89], v[90:91] op_sel:[0,0,0] op_sel_hi:[0,1,1]
    v_cvt_pk_f16_f32 v46, v88, v89
    v_pk_mul_f32 v[92:93], v[92:93], v[94:95] op_sel_hi:[1,0]
    v_pk_mul_f32 v[90:91], v[88:89], v[88:89] op_sel:[1,1] op_sel_hi:[1,0] neg_lo:[1,0]
    v_pk_fma_f32 v[88:89], v[88:89], v[88:89], v[90:91] op_sel:[0,0,0] op_sel_hi:[0,1,1]
    v_cvt_pk_f16_f32 v48, v88, v89
    v_cvt_pk_f16_f32 v61, v92, v93
    v_pk_mul_f32 v[90:91], v[88:89], v[88:89] op_sel:[1,1] op_sel_hi:[1,0] neg_lo:[1,0]
    v_pk_fma_f32 v[88:89], v[88:89], v[88:89], v[90:91] op_sel:[0,0,0] op_sel_hi:[0,1,1]
    v_pk_mul_f32 v[94:95], v[92:93], v[92:93] op_sel:[1,1] op_sel_hi:[1,0] neg_lo:[1,0]
    v_cvt_pk_f16_f32 v52, v88, v89
    v_pk_mul_f32 v[90:91], v[88:89], v[88:89] op_sel:[1,1] op_sel_hi:[1,0] neg_lo:[1,0]
    v_pk_fma_f32 v[92:93], v[92:93], v[92:93], v[94:95] op_sel:[0,0,0] op_sel_hi:[0,1,1]
    v_pk_fma_f32 v[88:89], v[88:89], v[88:89], v[90:91] op_sel:[0,0,0] op_sel_hi:[0,1,1]
    v_cvt_pk_f16_f32 v60, v88, v89
    v_cvt_pk_f16_f32 v62, v92, v93
L_scj_55:
    v_pk_mul_f16 v47, v46, v45 op_sel:[1,1] op_sel_hi:[1,0] neg_lo:[1,0]
    v_pk_fma_f16 v47, v46, v45, v47 op_sel:[0,0,0] op_sel_hi:[0,1,1]
    ds_write_addtid_b32 v45 offset:272
    ds_write_addtid_b32 v46 offset:544
    v_pk_mul_f16 v49, v48, v45 op_sel:[1,1] op_sel_hi:[1,0] neg_lo:[1,0]
    v_pk_mul_f16 v50, v48, v46 op_sel:[1,1] op_sel_hi:[1,0] neg_lo:[1,0]
    v_pk_fma_f16 v49, v48, v45, v49 op_sel:[0,0,0] op_sel_hi:[0,1,1]
    v_pk_fma_f16 v50, v48, v46, v50 op_sel:[0,0,0] op_sel_hi:[0,1,1]
    ds_write_addtid_b32 v47 offset:816
    ds_write_addtid_b32 v48 offset:1088
    v_pk_mul_f16 v51, v48, v47 op_sel:[1,1] op_sel_hi:[1,0] neg_lo:[1,0]
    v_pk_fma_f16 v51, v48, v47, v51 op_sel:[0,0,0] op_sel_hi:[0,1,1]
    ds_write_addtid_b32 v49 offset:1360
    ds_write_addtid_b32 v50 offset:1632
    v_pk_mul_f32 v[90:91], v[88:89], v[88:89] op_sel:[1,1] op_sel_hi:[1,0] neg_lo:[1,0]
    v_pk_mul_f16 v53, v52, v45 op_sel:[1,1] op_sel_hi:[1,0] neg_lo:[1,0]
    v_pk_mul_f16 v54, v52, v46 op_sel:[1,1] op_sel_hi:[1,0] neg_lo:[1,0]
    v_pk_fma_f16 v53, v52, v45, v53 op_sel:[0,0,0] op_sel_hi:[0,1,1]
    v_pk_fma_f16 v54, v52, v46, v54 op_sel:[0,0,0] op_sel_hi:[0,1,1]
    ds_write_addtid_b32 v51 offset:1904
    ds_write_addtid_b32 v52 offset:2176
    v_pk_mul_f16 v55, v52, v47 op_sel:[1,1] op_sel_hi:[1,0] neg_lo:[1,0]
    v_pk_mul_f16 v56, v52, v48 op_sel:[1,1] op_sel_hi:[1,0] neg_lo:[1,0]
    v_pk_fma_f16 v55, v52, v47, v55 op_sel:[0,0,0] op_sel_hi:[0,1,1]
    v_pk_fma_f16 v56, v52, v48, v56 op_sel:[0,0,0] op_sel_hi:[0,1,1]
    ds_write_addtid_b32 v53 offset:2448
    ds_write_addtid_b32 v54 offset:2720
    v_pk_mul_f16 v57, v52, v49 op_sel:[1,1] op_sel_hi:[1,0] neg_lo:[1,0]
    v_pk_mul_f16 v58, v52, v50 op_sel:[1,1] op_sel_hi:[1,0] neg_lo:[1,0]
    v_pk_fma_f32 v[88:89], v[88:89], v[88:89], v[90:91] op_sel:[0,0,0] op_sel_hi:[0,1,1]
    v_pk_fma_f16 v57, v52, v49, v57 op_sel:[0,0,0] op_sel_hi:[0,1,1]
    v_pk_fma_f16 v58, v52, v50, v58 op_sel:[0,0,0] op_sel_hi:[0,1,1]
    ds_write_addtid_b32 v55 offset:2992
    ds_write_addtid_b32 v56 offset:3264
    v_pk_mul_f16 v59, v52, v51 op_sel:[1,1] op_sel_hi:[1,0] neg_lo:[1,0]
    v_pk_fma_f16 v59, v52, v51, v59 op_sel:[0,0,0] op_sel_hi:[0,1,1]
    ds_write_addtid_b32 v57 offset:3536
    ds_write_addtid_b32 v58 offset:3808
    v_pk_mul_f16 v80, v60, v45 op_sel:[1,1] op_sel_hi:[1,0] neg_lo:[1,0]
    v_pk_mul_f16 v81, v60, v46 op_sel:[1,1] op_sel_hi:[1,0] neg_lo:[1,0]
    v_pk_fma_f16 v80, v60, v45, v80 op_sel:[0,0,0] op_sel_hi:[0,1,1]
    v_pk_fma_f16 v81, v60, v46, v81 op_sel:[0,0,0] op_sel_hi:[0,1,1]
    ds_write_addtid_b32 v59 offset:4080
    ds_write_addtid_b32 v60 offset:4352
    v_cvt_pk_f16_f32 v64, v88, v89
    v_pk_mul_f16 v82, v60, v47 op_sel:[1,1] op_sel_hi:[1,0] neg_lo:[1,0]
    v_pk_mul_f16 v83, v60, v48 op_sel:[1,1] op_sel_hi:[1,0] neg_lo:[1,0]
    v_pk_fma_f16 v82, v60, v47, v82 op_sel:[0,0,0] op_sel_hi:[0,1,1]
    v_pk_fma_f16 v83, v60, v48, v83 op_sel:[0,0,0] op_sel_hi:[0,1,1]
    ds_write_addtid_b32 v80 offset:4624
    ds_write_addtid_b32 v81 offset:4896
    v_pk_mul_f16 v80, v60, v49 op_sel:[1,1] op_sel_hi:[1,0] neg_lo:[1,0]
    v_pk_mul_f16 v81, v60, v50 op_sel:[1,1] op_sel_hi:[1,0] neg_lo:[1,0]
    v_pk_fma_f16 v80, v60, v49, v80 op_sel:[0,0,0] op_sel_hi:[0,1,1]
    v_pk_fma_f16 v81, v60, v50, v81 op_sel:[0,0,0] op_sel_hi:[0,1,1]
    ds_write_addtid_b32 v82 offset:5168
    ds_write_addtid_b32 v83 offset:5440
    v_pk_mul_f16 v82, v60, v51 op_sel:[1,1] op_sel_hi:[1,0] neg_lo:[1,0]
    v_pk_mul_f16 v83, v60, v52 op_sel:[1,1] op_sel_hi:[1,0] neg_lo:[1,0]
    v_pk_mul_f32 v[90:91], v[88:89], v[88:89] op_sel:[1,1] op_sel_hi:[1,0] neg_lo:[1,0]
    v_pk_fma_f16 v82, v60, v51, v82 op_sel:[0,0,0] op_sel_hi:[0,1,1]
    v_pk_fma_f16 v83, v60, v52, v83 op_sel:[0,0,0] op_sel_hi:[0,1,1]
    ds_write_addtid_b32 v80 offset:5712
    ds_write_addtid_b32 v81 offset:5984
    v_pk_mul_f16 v80, v60, v53 op_sel:[1,1] op_sel_hi:[1,0] neg_lo:[1,0]
    v_pk_mul_f16 v81, v60, v54 op_sel:[1,1] op_sel_hi:[1,0] neg_lo:[1,0]
    v_pk_fma_f16 v80, v60, v53, v80 op_sel:[0,0,0] op_sel_hi:[0,1,1]
    v_pk_fma_f16 v81, v60, v54, v81 op_sel:[0,0,0] op_sel_hi:[0,1,1]
    ds_write_addtid_b32 v82 offset:6256
    ds_write_addtid_b32 v83 offset:6528
    v_pk_mul_f16 v82, v60, v55 op_sel:[1,1] op_sel_hi:[1,0] neg_lo:[1,0]
    v_pk_mul_f16 v83, v60, v56 op_sel:[1,1] op_sel_hi:[1,0] neg_lo:[1,0]
    v_pk_fma_f16 v82, v60, v55, v82 op_sel:[0,0,0] op_sel_hi:[0,1,1]
    v_pk_fma_f16 v83, v60, v56, v83 op_sel:[0,0,0] op_sel_hi:[0,1,1]
    v_pk_fma_f32 v[88:89], v[88:89], v[88:89], v[90:91] op_sel:[0,0,0] op_sel_hi:[0,1,1]
    ds_write_addtid_b32 v80 offset:6800
    ds_write_addtid_b32 v81 offset:7072
    v_pk_mul_f16 v80, v60, v57 op_sel:[1,1] op_sel_hi:[1,0] neg_lo:[1,0]
    v_pk_mul_f16 v81, v60, v58 op_sel:[1,1] op_sel_hi:[1,0] neg_lo:[1,0]
    v_pk_fma_f16 v80, v60, v57, v80 op_sel:[0,0,0] op_sel_hi:[0,1,1]
    v_pk_fma_f16 v81, v60, v58, v81 op_sel:[0,0,0] op_sel_hi:[0,1,1]
    ds_write_addtid_b32 v82 offset:7344
    ds_write_addtid_b32 v83 offset:7616
    v_pk_mul_f16 v82, v60, v59 op_sel:[1,1] op_sel_hi:[1,0] neg_lo:[1,0]
    v_pk_fma_f16 v82, v60, v59, v82 op_sel:[0,0,0] op_sel_hi:[0,1,1]
    ds_write_addtid_b32 v80 offset:7888
    ds_write_addtid_b32 v81 offset:8160
    ds_write_addtid_b32 v82 offset:8432
    v_cvt_pk_f16_f32 v65, v88, v89
    s_mov_b32 s46, 0
    ds_read_b32 v78, v31 offset:0
    s_waitcnt vmcnt(0)
    v_perm_b32 v92, v10, v10, s56
    v_perm_b32 v93, v11, v11, s56
    v_mul_f32 v34, 0x3ef5fdf0, v30
    s_branch L_spc_58
    s_nop 0
L_sp_56:
    ds_read_b32 v78, v31 offset:0
L_spc_58:
    s_waitcnt lgkmcnt(0)
    v_cmp_eq_u32 vcc, 0, v78
    s_cbranch_vccz L_spd_57
    s_add_u32 s46, s46, 1
    s_sleep 1
    s_cmp_lt_u32 s46, 400000
    s_cbranch_scc1 L_sp_56
    s_branch L_end
    s_nop 0
L_spd_57:
    v_mul_f32_e64 v34, v34, v78
    v_pk_mul_f32 v[92:93], v[92:93], v[34:35] op_sel_hi:[1,0] neg_hi:[1,0]
    v_cvt_pk_f16_f32 v67, v92, v93
    v_pk_mul_f16 v73, v67, v64 op_sel:[1,1] op_sel_hi:[1,0]
    v_pk_fma_f16 v73, v67, v64, v73 op_sel:[0,0,0] op_sel_hi:[0,1,1] neg_hi:[0,1,0]
    v_pk_mul_f16 v68, v67, v61 op_sel:[1,1] op_sel_hi:[1,0]
    v_pk_mul_f16 v69, v67, v62 op_sel:[1,1] op_sel_hi:[1,0]
    v_pk_fma_f16 v68, v67, v61, v68 op_sel:[0,0,0] op_sel_hi:[0,1,1] neg_hi:[0,1,0]
    v_pk_fma_f16 v69, v67, v62, v69 op_sel:[0,0,0] op_sel_hi:[0,1,1] neg_hi:[0,1,0]
    ds_write_addtid_b32 v67 offset:8704
    ds_write_addtid_b32 v73 offset:11696
    v_pk_mul_f16 v75, v73, v45 op_sel:[1,1] op_sel_hi:[1,0]
    v_pk_mul_f16 v70, v68, v62 op_sel:[1,1] op_sel_hi:[1,0]
    v_pk_fma_f16 v75, v73, v45, v75 op_sel:[0,0,0] op_sel_hi:[0,1,1] neg_hi:[0,1,0]
    v_pk_fma_f16 v70, v68, v62, v70 op_sel:[0,0,0] op_sel_hi:[0,1,1] neg_hi:[0,1,0]
    ds_write_addtid_b32 v68 offset:8976
    ds_write_addtid_b32 v69 offset:9248
    v_pk_mul_f16 v71, v69, v62 op_sel:[1,1] op_sel_hi:[1,0]
    v_pk_mul_f16 v76, v75, v64 op_sel:[1,1] op_sel_hi:[1,0]
    v_pk_fma_f16 v71, v69, v62, v71 op_sel:[0,0,0] op_sel_hi:[0,1,1] neg_hi:[0,1,0]
    v_pk_fma_f16 v76, v75, v64, v76 op_sel:[0,0,0] op_sel_hi:[0,1,1] neg_hi:[0,1,0]
    ds_write_addtid_b32 v75 offset:10064
    ds_write_addtid_b32 v70 offset:9520
    v_pk_mul_f16 v77, v75, v65 op_sel:[1,1] op_sel_hi:[1,0]
    v_pk_mul_f16 v63, v70, v62 op_sel:[1,1] op_sel_hi:[1,0]
    v_pk_fma_f16 v77, v75, v65, v77 op_sel:[0,0,0] op_sel_hi:[0,1,1] neg_hi:[0,1,0]
    v_pk_fma_f16 v63, v70, v62, v63 op_sel:[0,0,0] op_sel_hi:[0,1,1] neg_hi:[0,1,0]
    ds_write_addtid_b32 v71 offset:12240
    ds_write_addtid_b32 v76 offset:13600
    v_pk_mul_f16 v72, v71, v62 op_sel:[1,1] op_sel_hi:[1,0]
    v_pk_mul_f16 v74, v71, v64 op_sel:[1,1] op_sel_hi:[1,0]
    v_pk_fma_f16 v72, v71, v62, v72 op_sel:[0,0,0] op_sel_hi:[0,1,1] neg_hi:[0,1,0]
    v_pk_fma_f16 v74, v71, v64, v74 op_sel:[0,0,0] op_sel_hi:[0,1,1] neg_hi:[0,1,0]
    ds_write_addtid_b32 v77 offset:10608
    ds_write_addtid_b32 v63 offset:12512
    v_pk_mul_f16 v66, v76, v65 op_sel:[1,1] op_sel_hi:[1,0]
    v_pk_mul_f16 v79, v77, v65 op_sel:[1,1] op_sel_hi:[1,0]
    v_pk_fma_f16 v66, v76, v65, v66 op_sel:[0,0,0] op_sel_hi:[0,1,1] neg_hi:[0,1,0]
    v_pk_fma_f16 v79, v77, v65, v79 op_sel:[0,0,0] op_sel_hi:[0,1,1] neg_hi:[0,1,0]
    ds_write_addtid_b32 v72 offset:12784
    ds_write_addtid_b32 v74 offset:11424
    v_pk_mul_f16 v80, v63, v62 op_sel:[1,1] op_sel_hi:[1,0]
    v_pk_mul_f16 v81, v69, v64 op_sel:[1,1] op_sel_hi:[1,0]
    v_pk_fma_f16 v80, v63, v62, v80 op_sel:[0,0,0] op_sel_hi:[0,1,1] neg_hi:[0,1,0]
    v_pk_fma_f16 v81, v69, v64, v81 op_sel:[0,0,0] op_sel_hi:[0,1,1] neg_hi:[0,1,0]
    ds_write_addtid_b32 v66 offset:13872
    ds_write_addtid_b32 v79 offset:10880
    v_pk_mul_f16 v82, v72, v64 op_sel:[1,1] op_sel_hi:[1,0]
    v_pk_mul_f16 v83, v71, v65 op_sel:[1,1] op_sel_hi:[1,0]
    v_pk_fma_f16 v82, v72, v64, v82 op_sel:[0,0,0] op_sel_hi:[0,1,1] neg_hi:[0,1,0]
    v_pk_fma_f16 v83, v71, v65, v83 op_sel:[0,0,0] op_sel_hi:[0,1,1] neg_hi:[0,1,0]
    ds_write_addtid_b32 v80 offset:13056
    ds_write_addtid_b32 v81 offset:11968
    v_pk_mul_f16 v80, v74, v65 op_sel:[1,1] op_sel_hi:[1,0]
    v_pk_mul_f16 v81, v66, v65 op_sel:[1,1] op_sel_hi:[1,0]
    v_pk_fma_f16 v80, v74, v65, v80 op_sel:[0,0,0] op_sel_hi:[0,1,1] neg_hi:[0,1,0]
    v_pk_fma_f16 v81, v66, v65, v81 op_sel:[0,0,0] op_sel_hi:[0,1,1] neg_hi:[0,1,0]
    ds_write_addtid_b32 v82 offset:9792
    ds_write_addtid_b32 v83 offset:13328
    v_pk_mul_f16 v82, v79, v65 op_sel:[1,1] op_sel_hi:[1,0]
    v_pk_fma_f16 v82, v79, v65, v82 op_sel:[0,0,0] op_sel_hi:[0,1,1] neg_hi:[0,1,0]
    ds_write_addtid_b32 v80 offset:10336
    ds_write_addtid_b32 v81 offset:14144
    ds_write_addtid_b32 v82 offset:11152
    s_mov_b64 exec, 1
    ds_add_u32 v3, v0 offset:80
    s_mov_b64 exec, -1
    s_cmp_lg_u32 s59, 0
    s_cbranch_scc1 L_recv_59
    s_nop 0
    s_setprio 2
    ds_read_b128 v[88:91], v16 offset:8704
    ds_read_b128 v[92:95], v17 offset:0
    ds_read_b128 v[96:99], v16 offset:8736
    ds_read_b128 v[100:103], v17 offset:32
    ds_read_b128 v[104:107], v16 offset:8768
    ds_read_b128 v[108:111], v17 offset:64
    ds_read_b128 v[44:47], v16 offset:8800
    ds_read_b128 v[48:51], v17 offset:96
    s_waitcnt lgkmcnt(6)
    v_mfma_f32_32x32x16_f16 v[112:127], v[88:91], v[92:95], 0
    ds_read_b128 v[88:91], v16 offset:8832
    ds_read_b128 v[92:95], v17 offset:128
    s_waitcnt lgkmcnt(6)
    v_mfma_f32_32x32x16_f16 v[112:127], v[96:99], v[100:103], v[112:127]
    ds_read_b128 v[96:99], v16 offset:8864
    ds_read_b128 v[100:103], v17 offset:160
    s_waitcnt lgkmcnt(6)
    v_mfma_f32_32x32x16_f16 v[112:127], v[104:107], v[108:111], v[112:127]
    ds_read_b128 v[104:107], v16 offset:8896
    ds_read_b128 v[108:111], v17 offset:192
    s_waitcnt lgkmcnt(6)
    v_mfma_f32_32x32x16_f16 v[112:127], v[44:47], v[48:51], v[112:127]
    ds_read_b128 v[44:47], v16 offset:8928
    ds_read_b128 v[48:51], v17 offset:224
    s_waitcnt lgkmcnt(6)
    v_mfma_f32_32x32x16_f16 v[112:127], v[88:91], v[92:95], v[112:127]
    s_waitcnt lgkmcnt(4)
    v_mfma_f32_32x32x16_f16 v[112:127], v[96:99], v[100:103], v[112:127]
    s_waitcnt lgkmcnt(2)
    v_mfma_f32_32x32x16_f16 v[112:127], v[104:107], v[108:111], v[112:127]
    s_waitcnt lgkmcnt(0)
    v_mfma_f32_32x32x16_f16 v[112:127], v[44:47], v[48:51], v[112:127]
    s_mov_b32 s46, 0
L_sp_61:
    ds_read_b32 v85, v24 offset:96
    s_waitcnt lgkmcnt(0)
    v_cmp_gt_u32 vcc, 1, v85
    s_cbranch_vccz L_spd_62
    s_add_u32 s46, s46, 1
    s_cmp_lt_u32 s46, 400000
    s_cbranch_scc1 L_sp_61
    s_branch L_end
L_spd_62:
    s_setprio 3
    ds_read_b128 v[88:91], v36 offset:8704
    ds_read_b128 v[92:95], v37 offset:0
    ds_read_b128 v[96:99], v36 offset:8736
    ds_read_b128 v[100:103], v37 offset:32
    ds_read_b128 v[104:107], v36 offset:8768
    ds_read_b128 v[108:111], v37 offset:64
    ds_read_b128 v[44:47], v36 offset:8800
    ds_read_b128 v[48:51], v37 offset:96
    s_waitcnt lgkmcnt(6)
    v_mfma_f32_32x32x16_f16 v[112:127], v[88:91], v[92:95], v[112:127]
    ds_read_b128 v[88:91], v36 offset:8832
    ds_read_b128 v[92:95], v37 offset:128
    s_waitcnt lgkmcnt(6)
    v_mfma_f32_32x32x16_f16 v[112:127], v[96:99], v[100:103], v[112:127]
    ds_read_b128 v[96:99], v36 offset:8864
    ds_read_b128 v[100:103], v37 offset:160
    s_waitcnt lgkmcnt(6)
    v_mfma_f32_32x32x16_f16 v[112:127], v[104:107], v[108:111], v[112:127]
    ds_read_b128 v[104:107], v36 offset:8896
    ds_read_b128 v[108:111], v37 offset:192
    s_waitcnt lgkmcnt(6)
    v_mfma_f32_32x32x16_f16 v[112:127], v[44:47], v[48:51], v[112:127]
    ds_read_b128 v[44:47], v36 offset:8928
    ds_read_b128 v[48:51], v37 offset:224
    s_waitcnt lgkmcnt(6)
    v_mfma_f32_32x32x16_f16 v[112:127], v[88:91], v[92:95], v[112:127]
    s_waitcnt lgkmcnt(4)
    v_mfma_f32_32x32x16_f16 v[112:127], v[96:99], v[100:103], v[112:127]
    s_waitcnt lgkmcnt(2)
    v_mfma_f32_32x32x16_f16 v[112:127], v[104:107], v[108:111], v[112:127]
    s_waitcnt lgkmcnt(0)
    v_mfma_f32_32x32x16_f16 v[112:127], v[44:47], v[48:51], v[112:127]
    s_mov_b64 exec, 1
    ds_add_u32 v3, v0 offset:84
    s_mov_b64 exec, -1
    s_mov_b64 exec, 1
    ds_write_b32 v24, v0 offset:112
    s_mov_b64 exec, -1
    s_nop 5
    v_cvt_pkrtz_f16_f32 v109, v122, v123
    v_add_f32 v112, v112, v26
    v_cvt_pkrtz_f16_f32 v88, v119, v118
    v_cvt_pkrtz_f16_f32 v89, v117, v116
    v_mov_b32_dpp v85, v109 quad_perm:[1,0,3,2] row_mask:0xf bank_mask:0xf
    v_cvt_pkrtz_f16_f32 v90, v115, v114
    v_cvt_pkrtz_f16_f32 v91, v113, v112
    v_cvt_pkrtz_f16_f32 v108, v121, v120
    v_bfi_b32 v92, s61, v40, v88
    v_bfi_b32 v93, s61, v41, v89
    v_bfi_b32 v94, s61, v42, v90
    v_bfi_b32 v95, s61, v43, v91
    v_perm_b32 v109, v85, v109, v5
    global_store_dwordx4 v2, v[92:95], s[62:63] sc1
    v_bfi_b32 v96, s61, v40, v108
    v_bfi_b32 v97, s61, v41, v109
    global_store_dwordx2 v27, v[96:97], s[62:63] offset:1024 sc1
    v_mov_b32 v79, s39
    s_mov_b64 exec, 1
    global_store_dwordx2 v3, v[78:79], s[62:63] offset:2040 sc1
    s_mov_b64 exec, -1
    ds_read_b128 v[44:47], v2 offset:4864
    ds_read_b128 v[48:51], v2 offset:5888
    ds_read_b128 v[52:55], v2 offset:6912
    ds_read_b128 v[56:59], v2 offset:7936
    s_branch L_arr_60
L_recv_59:
    s_mov_b64 exec, 1
    ds_write_b32 v24, v0 offset:96
    s_mov_b64 exec, -1
    ds_read_b128 v[44:47], v2 offset:4864
    ds_read_b128 v[48:51], v2 offset:5888
    ds_read_b128 v[52:55], v2 offset:6912
    ds_read_b128 v[56:59], v2 offset:7936
    v_xor_b32_e64 v31, 16, v31
    s_load_dword s42, s[62:63], 2040 glc
    s_mov_b32 s46, 0
L_sp_63:
    ds_read_b32 v85, v24 offset:112
    s_waitcnt lgkmcnt(0)
    v_cmp_gt_u32 vcc, 1, v85
    s_cbranch_vccz L_spd_64
    s_add_u32 s46, s46, 1
    s_sleep 2
    s_cmp_lt_u32 s46, 400000
    s_cbranch_scc1 L_sp_63
    s_branch L_end
    s_nop 0
L_spd_64:
    s_mov_b32 s46, 0
L_km_65:
    s_load_dwordx2 s[42:43], s[62:63], 2040 glc
    s_add_u32 s46, s46, 1
    s_cmp_gt_u32 s46, 50000
    s_cbranch_scc1 L_end
    s_waitcnt lgkmcnt(0)
    s_cmp_lg_u32 s43, s39
    s_cbranch_scc1 L_km_65
    s_mov_b32 s46, 0
L_ka_66:
    global_load_dwordx4 v[88:91], v2, s[62:63] sc1
    global_load_dwordx2 v[108:109], v27, s[62:63] offset:1024 sc1
    v_mov_b32 v110, s42
    s_mov_b64 exec, 1
    ds_write_b32 v31, v110 offset:0
    s_mov_b64 exec, -1
    s_add_u32 s46, s46, 1
    s_cmp_gt_u32 s46, 50000
    s_cbranch_scc1 L_end
    s_waitcnt vmcnt(1)
    v_xor_b32 v88, v88, v40
    v_xor_b32 v89, v89, v41
    v_xor_b32_e64 v90, v90, v42
    v_xor_b32_e64 v91, v91, v43
    v_or3_b32 v85, v88, v89, v90
    s_waitcnt vmcnt(0)
    v_xor_b32 v108, v108, v40
    v_xor_b32_e64 v109, v109, v41
    v_or3_b32 v85, v85, v91, v108
    v_bitop3_b32 v85, v85, v109, s61 bitop3:0xa8
    v_cmp_ne_u32 vcc, 0, v85
    s_cbranch_vccnz L_ka_66
L_arr_60:
    ds_write_b128 v25, v[88:91]
    v_alignbit_b32 v92, v89, v88, 16
    v_readlane_b32 s40, v88, 63
    v_readlane_b32 s53, v108, 63
    v_readlane_b32 s41, v92, 63
    v_mov_b32_dpp v99, v88 wave_shr:1 row_mask:0xf bank_mask:0xf bound_ctrl:0
    s_pack_ll_b32_b16 s42, s40, s40
    v_alignbit_b32 v93, v90, v89, 16
    v_alignbit_b32 v94, v91, v90, 16
    v_alignbit_b32 v95, v99, v91, 16
    v_mov_b32 v104, 0
    ds_write_b128 v25, v[92:95] offset:1088
    v_and_b32 v105, s42, v21
    v_and_b32 v106, s42, v22
    v_and_b32_e64 v107, s42, v23
    v_writelane_b32 v107, s40, 11
    v_writelane_b32 v107, s41, 15
    ds_write_b128 v20, v[104:107]
    v_mov_b32_dpp v111, v89 wave_shr:1 row_mask:0xf bank_mask:0xf bound_ctrl:0
    ds_write2_b32 v18, v108, v108 offset0:0 offset1:225
    s_pack_ll_b32_b16 s53, s53, s53
    ds_write2_b32 v19, v109, v109 offset0:0 offset1:225
    v_mov_b32 v96, v89
    v_mov_b32 v97, v90
    v_mov_b32 v98, v91
    ds_write_b128 v25, v[96:99] offset:2176
    v_mov_b32 v100, v93
    v_mov_b32 v101, v94
    v_mov_b32_e64 v102, v95
    v_alignbit_b32 v103, v111, v99, 16
    ds_write_b128 v25, v[100:103] offset:3264
    v_pk_mul_f16 v12, v12, s53
    v_pk_mul_f16 v13, v13, s53
    v_pk_mul_f16 v14, v14, s53
    v_pk_mul_f16 v15, v15, s53
    v_mov_b32_e64 v5, v24
    s_cmp_lg_u32 s38, 0
    s_cbranch_scc1 L_set1_67
    ds_read_b64 v[32:33], v7 offset:512
    ds_read_b64 v[34:35], v7 offset:520
    ds_read_b64 v[36:37], v7 offset:448
    ds_read_b64 v[38:39], v7 offset:456
    ds_read_b64 v[40:41], v6 offset:576
    ds_read_b64 v[42:43], v6 offset:584
    ds_read_b64 v[60:61], v6 offset:64
    ds_read_b64 v[62:63], v6 offset:72
    ds_read_b64 v[64:65], v7 offset:576
    ds_read_b64 v[66:67], v7 offset:584
    ds_read_b64 v[68:69], v6 offset:640
    ds_read_b64 v[70:71], v6 offset:648
    ds_read_b64 v[72:73], v6 offset:128
    ds_read_b64 v[74:75], v6 offset:136
    ds_read_b64 v[76:77], v6 offset:704
    ds_read_b64 v[78:79], v6 offset:712
    ds_read_b64 v[80:81], v6 offset:192
    ds_read_b64 v[82:83], v6 offset:200
    ds_read_b64 v[84:85], v6 offset:768
    ds_read_b64 v[86:87], v6 offset:776
    s_mov_b32 s46, 0
L_sp_68:
    ds_read_b32 v5, v3 offset:48
    s_waitcnt lgkmcnt(0)
    v_cmp_gt_u32_e64 vcc, 2, v5
    s_cbranch_vccz L_spd_69
    s_add_u32 s46, s46, 1
    s_sleep 2
    s_cmp_lt_u32 s46, 400000
    s_cbranch_scc1 L_sp_68
    s_nop 0
    s_branch L_end
    s_nop 0
L_spd_69:
    s_setprio 2
    ds_read_b128 v[8:11], v4 offset:496
    ds_read_b128 v[16:19], v4 offset:480
    ds_read_b128 v[20:23], v4 offset:1536
    ds_read_b128 v[24:27], v4 offset:1008
    ds_read_b128 v[28:31], v4 offset:992
    ds_read_b128 v[88:91], v4 offset:48
    s_waitcnt lgkmcnt(5)
    v_mfma_f32_16x16x32_f16 v[92:95], v[8:11], v[52:55], 0
    s_waitcnt lgkmcnt(4)
    ds_read_b128 v[96:99], v4 offset:112
    ds_read_b128 v[100:103], v4 offset:368
    v_mfma_f32_16x16x32_f16 v[104:107], v[16:19], v[56:59], 0
    s_waitcnt lgkmcnt(5)
    ds_read_b128 v[108:111], v4 offset:176
    ds_read_b64 v[112:113], v6 offset:896
    v_mfma_f32_16x16x32_f16 v[116:119], v[12:15], v[20:23], 0
    s_waitcnt lgkmcnt(6)
    ds_read_b128 v[120:123], v4 offset:240
    ds_read_b64 v[114:115], v6 offset:904
    v_mfma_f32_16x16x32_f16 v[124:127], v[24:27], v[52:55], 0
    s_waitcnt lgkmcnt(7)
    ds_read_b64 v[8:9], v6 offset:256
    ds_read_b64 v[16:17], v6 offset:384
    v_mfma_f32_16x16x32_f16 v[20:23], v[28:31], v[56:59], 0
    v_cvt_pkrtz_f16_f32 v92, v92, v104
    v_cvt_pkrtz_f16_f32 v93, v93, v105
    v_cvt_pkrtz_f16_f32 v94, v94, v106
    v_cvt_pkrtz_f16_f32 v95, v95, v107
    s_nop 1
    v_mfma_f32_16x16x32_f16 v[116:119], v[92:95], v[32:35], v[116:119]
    ds_read_b64 v[10:11], v6 offset:264
    ds_read_b64 v[18:19], v6 offset:392
    v_mfma_f32_16x16x32_f16 v[24:27], v[92:95], v[36:39], 0
    s_waitcnt lgkmcnt(10)
    ds_read_b128 v[28:31], v4 offset:304
    ds_read_b128 v[104:107], v4 offset:432
    v_mfma_f32_16x16x32_f16 v[36:39], v[40:43], v[88:91], 0
    v_cvt_pkrtz_f16_f32 v124, v124, v20
    v_cvt_pkrtz_f16_f32 v125, v125, v21
    v_cvt_pkrtz_f16_f32 v126, v126, v22
    v_cvt_pkrtz_f16_f32 v127, v127, v23
    v_mfma_f32_16x16x32_f16 v[92:95], v[60:63], v[88:91], 0
    ds_read_b64 v[20:21], v6 offset:832
    ds_read_b64 v[60:61], v6 offset:960
    v_mfma_f32_16x16x32_f16 v[116:119], v[124:127], v[64:67], v[116:119]
    ds_read_b64 v[22:23], v6 offset:840
    ds_read_b64 v[62:63], v6 offset:968
    v_mfma_f32_16x16x32_f16 v[24:27], v[124:127], v[32:35], v[24:27]
    s_waitcnt lgkmcnt(15)
    ds_read_b64 v[88:89], v6 offset:320
    ds_read_b64 v[32:33], v6 offset:448
    v_mfma_f32_16x16x32_f16 v[36:39], v[68:71], v[96:99], v[36:39]
    ds_read_b64 v[90:91], v6 offset:328
    ds_read_b64 v[34:35], v6 offset:456
    v_mfma_f32_16x16x32_f16 v[92:95], v[72:75], v[96:99], v[92:95]
    s_waitcnt lgkmcnt(15)
    ds_read_b128 v[124:127], v4 offset:496
    v_mfma_f32_16x16x32_f16 v[36:39], v[76:79], v[108:111], v[36:39]
    ds_read_b64 v[72:73], v6 offset:1024
    v_mfma_f32_16x16x32_f16 v[92:95], v[80:83], v[108:111], v[92:95]
    ds_read_b64 v[74:75], v6 offset:1032
    v_mfma_f32_16x16x32_f16 v[36:39], v[84:87], v[120:123], v[36:39]
    s_waitcnt lgkmcnt(14)
    ds_read_b64 v[96:97], v6 offset:512
    v_mfma_f32_16x16x32_f16 v[92:95], v[8:11], v[120:123], v[92:95]
    s_waitcnt lgkmcnt(9)
    ds_read_b64 v[98:99], v6 offset:520
    v_mfma_f32_16x16x32_f16 v[36:39], v[20:23], v[28:31], v[36:39]
    s_waitcnt lgkmcnt(6)
    ds_read_b128 v[80:83], v4 offset:560
    v_mfma_f32_16x16x32_f16 v[92:95], v[88:91], v[28:31], v[92:95]
    ds_read_b128 v[108:111], v4 offset:624
    v_mfma_f32_16x16x32_f16 v[36:39], v[112:115], v[100:103], v[36:39]
    ds_read_b128 v[120:123], v4 offset:688
    v_mfma_f32_16x16x32_f16 v[92:95], v[16:19], v[100:103], v[92:95]
    ds_read_b128 v[8:11], v4 offset:752
    v_mfma_f32_16x16x32_f16 v[36:39], v[60:63], v[104:107], v[36:39]
    s_waitcnt lgkmcnt(9)
    ds_read_b128 v[28:31], v4 offset:1520
    v_mfma_f32_16x16x32_f16 v[92:95], v[32:35], v[104:107], v[92:95]
    s_waitcnt lgkmcnt(7)
    ds_read_b128 v[88:91], v4 offset:1504
    v_mfma_f32_16x16x32_f16 v[36:39], v[72:75], v[124:127], v[36:39]
    s_waitcnt lgkmcnt(6)
    ds_read_b128 v[100:103], v4 offset:816
    v_mfma_f32_16x16x32_f16 v[92:95], v[96:99], v[124:127], v[92:95]
    s_waitcnt lgkmcnt(6)
    ds_read_b128 v[16:19], v4 offset:880
    v_mfma_f32_16x16x32_f16 v[92:95], v[40:43], v[80:83], v[92:95]
    s_waitcnt lgkmcnt(6)
    ds_read_b128 v[104:107], v4 offset:944
    v_mfma_f32_16x16x32_f16 v[92:95], v[68:71], v[108:111], v[92:95]
    s_waitcnt lgkmcnt(6)
    v_cvt_pk_f16_f32 v36, v36, v37
    v_cvt_pk_f16_f32 v37, v38, v39
    v_mfma_f32_16x16x32_f16 v[92:95], v[76:79], v[120:123], v[92:95]
    s_waitcnt lgkmcnt(5)
    s_waitcnt lgkmcnt(4)
    ds_write_b64 v1, v[36:37] offset:0
    v_mfma_f32_16x16x32_f16 v[92:95], v[84:87], v[8:11], v[92:95]
    s_mov_b64 exec, 1
    ds_add_u32 v3, v0 offset:64
    s_mov_b64 exec, -1
    v_mfma_f32_16x16x32_f16 v[32:35], v[28:31], v[44:47], 0
    s_setprio 1
    ds_read_b128 v[124:127], v4 offset:1008
    v_mfma_f32_16x16x32_f16 v[96:99], v[28:31], v[48:51], 0
    ds_read_b128 v[80:83], v4 offset:2032
    v_mfma_f32_16x16x32_f16 v[108:111], v[28:31], v[52:55], 0
    s_waitcnt lgkmcnt(7)
    ds_read_b64 v[120:121], v6 offset:128
    v_mfma_f32_16x16x32_f16 v[36:39], v[88:91], v[56:59], 0
    ds_read_b64 v[122:123], v6 offset:136
    v_mfma_f32_16x16x32_f16 v[8:11], v[88:91], v[44:47], 0
    s_nop 0
    v_cvt_pkrtz_f16_f32 v32, v32, v96
    v_cvt_pkrtz_f16_f32 v33, v33, v97
    v_mfma_f32_16x16x32_f16 v[28:31], v[88:91], v[48:51], 0
    s_waitcnt lgkmcnt(8)
    ds_read_b128 v[88:91], v4 offset:2016
    v_cvt_pkrtz_f16_f32 v34, v34, v98
    v_cvt_pkrtz_f16_f32 v35, v35, v99
    v_mfma_f32_16x16x32_f16 v[92:95], v[20:23], v[100:103], v[92:95]
    s_waitcnt lgkmcnt(8)
    ds_read_b64 v[96:97], v7 offset:0
    v_cvt_pkrtz_f16_f32 v108, v108, v36
    v_cvt_pkrtz_f16_f32 v109, v109, v37
    v_mfma_f32_16x16x32_f16 v[92:95], v[112:115], v[16:19], v[92:95]
    s_waitcnt lgkmcnt(8)
    ds_read_b64 v[98:99], v7 offset:8
    v_cvt_pkrtz_f16_f32 v110, v110, v38
    v_cvt_pkrtz_f16_f32 v111, v111, v39
    v_mfma_f32_16x16x32_f16 v[92:95], v[60:63], v[104:107], v[92:95]
    s_waitcnt lgkmcnt(6)
    ds_read_b64 v[100:101], v7 offset:640
    v_cvt_pkrtz_f16_f32 v8, v8, v28
    v_cvt_pkrtz_f16_f32 v9, v9, v29
    v_mfma_f32_16x16x32_f16 v[92:95], v[72:75], v[124:127], v[92:95]
    s_waitcnt lgkmcnt(6)
    ds_read_b64 v[102:103], v7 offset:648
    v_cvt_pkrtz_f16_f32 v10, v10, v30
    v_cvt_pkrtz_f16_f32 v11, v11, v31
    v_mfma_f32_16x16x32_f16 v[16:19], v[80:83], v[44:47], 0
    ds_read_b64 v[36:37], v7 offset:192
    ds_read_b64 v[104:105], v6 offset:192
    v_mfma_f32_16x16x32_f16 v[124:127], v[80:83], v[48:51], 0
    ds_read_b64 v[38:39], v7 offset:200
    ds_read_b32 v5, v3 offset:56
    v_mfma_f32_16x16x32_f16 v[28:31], v[80:83], v[52:55], 0
    s_waitcnt lgkmcnt(8)
    ds_read_b64 v[52:53], v7 offset:64
    v_cvt_pk_f16_f32 v92, v92, v93
    v_cvt_pk_f16_f32 v93, v94, v95
    v_mfma_f32_16x16x32_f16 v[80:83], v[88:91], v[56:59], 0
    ds_read_b64 v[54:55], v7 offset:72
    ds_write_b64 v1, v[92:93] offset:512
    v_mfma_f32_16x16x32_f16 v[56:59], v[88:91], v[44:47], 0
    s_mov_b64 exec, 1
    ds_add_u32 v3, v0 offset:68
    s_mov_b64 exec, -1
    v_mfma_f32_16x16x32_f16 v[92:95], v[88:91], v[48:51], 0
    s_waitcnt lgkmcnt(10)
    ds_read_b64 v[88:89], v7 offset:256
    v_cvt_pkrtz_f16_f32 v16, v16, v124
    v_cvt_pkrtz_f16_f32 v17, v17, v125
    v_mfma_f32_16x16x32_f16 v[116:119], v[32:35], v[96:99], v[116:119]
    s_waitcnt lgkmcnt(9)
    ds_read_b64 v[90:91], v7 offset:264
    v_cvt_pkrtz_f16_f32 v18, v18, v126
    v_cvt_pkrtz_f16_f32 v19, v19, v127
    v_mfma_f32_16x16x32_f16 v[116:119], v[108:111], v[100:103], v[116:119]
    s_setprio 0
    ds_read_b64 v[32:33], v6 offset:0
    v_cvt_pkrtz_f16_f32 v28, v28, v80
    v_cvt_pkrtz_f16_f32 v29, v29, v81
    v_mfma_f32_16x16x32_f16 v[24:27], v[108:111], v[64:67], v[24:27]
    s_waitcnt lgkmcnt(8)
    ds_read_b64 v[34:35], v6 offset:8
    v_cvt_pkrtz_f16_f32 v30, v30, v82
    v_cvt_pkrtz_f16_f32 v31, v31, v83
    v_mfma_f32_16x16x32_f16 v[116:119], v[8:11], v[36:39], v[116:119]
    s_waitcnt lgkmcnt(6)
    ds_read_b64 v[124:125], v6 offset:64
    v_cvt_pkrtz_f16_f32 v56, v56, v92
    v_cvt_pkrtz_f16_f32 v57, v57, v93
    v_mfma_f32_16x16x32_f16 v[116:119], v[16:19], v[52:55], v[116:119]
    ds_read_b64 v[126:127], v6 offset:72
    ds_read_b64 v[106:107], v6 offset:200
    v_cvt_pkrtz_f16_f32 v58, v58, v94
    v_mfma_f32_16x16x32_f16 v[24:27], v[16:19], v[96:99], v[24:27]
    v_cmp_gt_u32_e64 vcc, 2, v5
    s_cbranch_vccz L_x2_70
    s_mov_b32 s46, 0
L_sp_71:
    ds_read_b32 v5, v3 offset:56
    s_waitcnt lgkmcnt(0)
    v_cmp_gt_u32_e64 vcc, 2, v5
    s_cbranch_vccz L_spd_72
    s_add_u32 s46, s46, 1
    s_sleep 1
    s_cmp_lt_u32 s46, 400000
    s_cbranch_scc1 L_sp_71
    s_branch L_end
    s_nop 0
L_spd_72:
L_x2_70:
    v_cvt_pkrtz_f16_f32 v59, v59, v95
    v_mfma_f32_16x16x32_f16 v[24:27], v[28:31], v[100:103], v[24:27]
    s_waitcnt lgkmcnt(5)
    ds_read_b128 v[64:67], v4 offset:2544
    ds_read_b128 v[108:111], v4 offset:2048
    ds_read_b128 v[80:83], v4 offset:2800
    v_mfma_f32_16x16x32_f16 v[116:119], v[56:59], v[88:91], v[116:119]
    ds_read_b128 v[8:11], v4 offset:2544
    ds_read_b128 v[96:99], v4 offset:2528
    ds_read_b64 v[16:17], v6 offset:256
    v_mfma_f32_16x16x32_f16 v[24:27], v[56:59], v[36:39], v[24:27]
    s_waitcnt lgkmcnt(4)
    ds_read_b128 v[92:95], v4 offset:2608
    ds_read_b64 v[18:19], v6 offset:264
    v_mfma_f32_16x16x32_f16 v[24:27], v[12:15], v[108:111], v[24:27]
    ds_read_b128 v[100:103], v4 offset:2672
    ds_read_b128 v[28:31], v4 offset:2864
    v_mfma_f32_16x16x32_f16 v[116:119], v[32:35], v[64:67], v[116:119]
    s_waitcnt lgkmcnt(3)
    ds_read_b128 v[36:39], v4 offset:2736
    ds_read_b64 v[56:57], v6 offset:320
    v_mfma_f32_16x16x32_f16 v[116:119], v[124:127], v[92:95], v[116:119]
    ds_read_b64 v[58:59], v6 offset:328
    v_mfma_f32_16x16x32_f16 v[12:15], v[8:11], v[44:47], 0
    ds_read_b64 v[108:109], v6 offset:384
    v_mfma_f32_16x16x32_f16 v[64:67], v[8:11], v[48:51], 0
    ds_read_b64 v[110:111], v6 offset:392
    v_mfma_f32_16x16x32_f16 v[92:95], v[96:99], v[44:47], 0
    v_mfma_f32_16x16x32_f16 v[8:11], v[96:99], v[48:51], 0
    s_waitcnt lgkmcnt(6)
    ds_read_b128 v[96:99], v4 offset:2928
    v_mfma_f32_16x16x32_f16 v[116:119], v[120:123], v[100:103], v[116:119]
    s_waitcnt lgkmcnt(5)
    ds_read_b64 v[102:103], v6 offset:456
    v_cvt_pkrtz_f16_f32 v12, v12, v64
    v_cvt_pkrtz_f16_f32 v13, v13, v65
    v_mfma_f32_16x16x32_f16 v[116:119], v[104:107], v[36:39], v[116:119]
    ds_read_b64 v[100:101], v6 offset:448
    ds_read_b128 v[36:39], v4 offset:2992
    v_cvt_pkrtz_f16_f32 v14, v14, v66
    v_mfma_f32_16x16x32_f16 v[116:119], v[16:19], v[80:83], v[116:119]
    s_waitcnt lgkmcnt(6)
    ds_read_b64 v[80:81], v7 offset:128
    ds_read_b64 v[82:83], v7 offset:136
    v_cvt_pkrtz_f16_f32 v15, v15, v67
    v_mfma_f32_16x16x32_f16 v[116:119], v[56:59], v[28:31], v[116:119]
    s_waitcnt lgkmcnt(5)
    ds_read_b64 v[64:65], v7 offset:320
    ds_read_b64 v[66:67], v7 offset:328
    v_cvt_pkrtz_f16_f32 v92, v92, v8
    v_mfma_f32_16x16x32_f16 v[116:119], v[108:111], v[96:99], v[116:119]
    s_waitcnt lgkmcnt(4)
    ds_read_b64 v[28:29], v6 offset:512
    ds_read_b128 v[96:99], v4 offset:3056
    v_cvt_pkrtz_f16_f32 v93, v93, v9
    v_mfma_f32_16x16x32_f16 v[116:119], v[100:103], v[36:39], v[116:119]
    s_waitcnt lgkmcnt(4)
    ds_read_b128 v[36:39], v4 offset:3120
    v_cvt_pkrtz_f16_f32 v94, v94, v10
    v_mfma_f32_16x16x32_f16 v[116:119], v[12:15], v[80:83], v[116:119]
    ds_read_b64 v[30:31], v6 offset:520
    v_cvt_pkrtz_f16_f32 v95, v95, v11
    v_mfma_f32_16x16x32_f16 v[24:27], v[12:15], v[52:55], v[24:27]
    s_waitcnt lgkmcnt(4)
    ds_read_b128 v[8:11], v4 offset:3184
    v_mfma_f32_16x16x32_f16 v[116:119], v[92:95], v[64:67], v[116:119]
    v_mfma_f32_16x16x32_f16 v[24:27], v[92:95], v[88:91], v[24:27]
    s_waitcnt lgkmcnt(1)
    ds_read_b128 v[52:55], v4 offset:3248
    v_mfma_f32_16x16x32_f16 v[116:119], v[28:31], v[96:99], v[116:119]
    v_mfma_f32_16x16x32_f16 v[24:27], v[32:35], v[96:99], v[24:27]
    ds_read_b128 v[12:15], v4 offset:3312
    v_mfma_f32_16x16x32_f16 v[116:119], v[40:43], v[36:39], v[116:119]
    v_mfma_f32_16x16x32_f16 v[24:27], v[124:127], v[36:39], v[24:27]
    s_waitcnt lgkmcnt(2)
    ds_read_b128 v[88:91], v4 offset:3376
    v_mfma_f32_16x16x32_f16 v[116:119], v[68:71], v[8:11], v[116:119]
    v_mfma_f32_16x16x32_f16 v[24:27], v[120:123], v[8:11], v[24:27]
    s_waitcnt lgkmcnt(2)
    ds_read_b128 v[92:95], v4 offset:3440
    v_mfma_f32_16x16x32_f16 v[116:119], v[76:79], v[52:55], v[116:119]
    v_mfma_f32_16x16x32_f16 v[24:27], v[104:107], v[52:55], v[24:27]
    s_waitcnt lgkmcnt(2)
    ds_read_b128 v[32:35], v4 offset:3504
    v_mfma_f32_16x16x32_f16 v[116:119], v[84:87], v[12:15], v[116:119]
    v_mfma_f32_16x16x32_f16 v[24:27], v[16:19], v[12:15], v[24:27]
    s_waitcnt lgkmcnt(2)
    ds_read_b128 v[96:99], v4 offset:3568
    v_mfma_f32_16x16x32_f16 v[116:119], v[20:23], v[88:91], v[116:119]
    ds_read_b128 v[124:127], v4 offset:3632
    v_mfma_f32_16x16x32_f16 v[24:27], v[56:59], v[88:91], v[24:27]
    s_waitcnt lgkmcnt(3)
    ds_read_b128 v[36:39], v4 offset:3696
    v_mfma_f32_16x16x32_f16 v[116:119], v[112:115], v[92:95], v[116:119]
    ds_read_b128 v[120:123], v4 offset:3056
    v_mfma_f32_16x16x32_f16 v[24:27], v[108:111], v[92:95], v[24:27]
    s_waitcnt lgkmcnt(4)
    ds_read_b128 v[8:11], v4 offset:3040
    v_mfma_f32_16x16x32_f16 v[116:119], v[60:63], v[32:35], v[116:119]
    ds_read_b128 v[104:107], v4 offset:3760
    v_mfma_f32_16x16x32_f16 v[24:27], v[100:103], v[32:35], v[24:27]
    s_waitcnt lgkmcnt(5)
    ds_read_b128 v[52:55], v4 offset:3824
    v_mfma_f32_16x16x32_f16 v[116:119], v[72:75], v[96:99], v[116:119]
    ds_read_b128 v[16:19], v4 offset:3888
    v_mfma_f32_16x16x32_f16 v[24:27], v[28:31], v[96:99], v[24:27]
    s_waitcnt lgkmcnt(6)
    ds_read_b128 v[12:15], v4 offset:3952
    v_mfma_f32_16x16x32_f16 v[24:27], v[40:43], v[124:127], v[24:27]
    s_waitcnt lgkmcnt(6)
    ds_read_b128 v[56:59], v4 offset:4016
    v_mfma_f32_16x16x32_f16 v[24:27], v[68:71], v[36:39], v[24:27]
    s_waitcnt lgkmcnt(6)
    v_cvt_pk_f16_f32 v116, v116, v117
    v_cvt_pk_f16_f32 v117, v118, v119
    v_mfma_f32_16x16x32_f16 v[88:91], v[120:123], v[44:47], 0
    s_waitcnt lgkmcnt(5)
    ds_write_b64 v1, v[116:117] offset:1024
    v_mfma_f32_16x16x32_f16 v[108:111], v[120:123], v[48:51], 0
    s_mov_b64 exec, 1
    ds_add_u32 v3, v0 offset:72
    s_mov_b64 exec, -1
    v_mfma_f32_16x16x32_f16 v[92:95], v[8:11], v[44:47], 0
    ds_read_b128 v[100:103], v4 offset:4080
    v_mfma_f32_16x16x32_f16 v[32:35], v[8:11], v[48:51], 0
    s_waitcnt lgkmcnt(7)
    v_mfma_f32_16x16x32_f16 v[24:27], v[76:79], v[104:107], v[24:27]
    s_waitcnt lgkmcnt(6)
    v_cvt_pkrtz_f16_f32 v88, v88, v108
    v_cvt_pkrtz_f16_f32 v89, v89, v109
    v_mfma_f32_16x16x32_f16 v[24:27], v[84:87], v[52:55], v[24:27]
    s_waitcnt lgkmcnt(5)
    v_cvt_pkrtz_f16_f32 v90, v90, v110
    v_cvt_pkrtz_f16_f32 v91, v91, v111
    v_mfma_f32_16x16x32_f16 v[24:27], v[20:23], v[16:19], v[24:27]
    s_waitcnt lgkmcnt(4)
    v_cvt_pkrtz_f16_f32 v92, v92, v32
    v_mfma_f32_16x16x32_f16 v[24:27], v[112:115], v[12:15], v[24:27]
    s_waitcnt lgkmcnt(3)
    v_cvt_pkrtz_f16_f32 v93, v93, v33
    v_mfma_f32_16x16x32_f16 v[24:27], v[60:63], v[56:59], v[24:27]
    s_waitcnt lgkmcnt(0)
    v_cvt_pkrtz_f16_f32 v94, v94, v34
    v_mfma_f32_16x16x32_f16 v[24:27], v[72:75], v[100:103], v[24:27]
    v_cvt_pkrtz_f16_f32 v95, v95, v35
    v_mfma_f32_16x16x32_f16 v[24:27], v[88:91], v[80:83], v[24:27]
    s_nop 0
    v_mfma_f32_16x16x32_f16 v[24:27], v[92:95], v[64:67], v[24:27]
    s_nop 7
    v_cvt_pk_f16_f32 v24, v24, v25
    v_cvt_pk_f16_f32 v25, v26, v27
    ds_write_b64 v1, v[24:25] offset:1536
    s_mov_b64 exec, 1
    ds_add_u32 v3, v0 offset:76
    s_mov_b64 exec, -1
    s_branch L_fin
L_set1_67:
    ds_read_b64 v[32:33], v7 offset:128
    ds_read_b64 v[34:35], v7 offset:136
    ds_read_b64 v[36:37], v7 offset:64
    ds_read_b64 v[38:39], v7 offset:72
    ds_read_b64 v[40:41], v7 offset:0
    ds_read_b64 v[42:43], v7 offset:8
    ds_read_b64 v[60:61], v7 offset:640
    ds_read_b64 v[62:63], v7 offset:648
    ds_read_b64 v[64:65], v7 offset:576
    ds_read_b64 v[66:67], v7 offset:584
    ds_read_b64 v[68:69], v7 offset:320
    ds_read_b64 v[70:71], v7 offset:328
    ds_read_b64 v[72:73], v7 offset:256
    ds_read_b64 v[74:75], v7 offset:264
    ds_read_b64 v[76:77], v7 offset:192
    ds_read_b64 v[78:79], v7 offset:200
    ds_read_b64 v[80:81], v6 offset:0
    ds_read_b64 v[82:83], v6 offset:8
    ds_read_b64 v[84:85], v6 offset:64
    ds_read_b64 v[86:87], v6 offset:72
    s_mov_b32 s46, 0
L_sp_73:
    ds_read_b32 v5, v3 offset:48
    s_waitcnt lgkmcnt(0)
    v_cmp_gt_u32 vcc, 2, v5
    s_cbranch_vccz L_spd_74
    s_add_u32 s46, s46, 1
    s_sleep 2
    s_cmp_lt_u32 s46, 400000
    s_cbranch_scc1 L_sp_73
    s_branch L_end
L_spd_74:
    s_setprio 2
    ds_read_b128 v[8:11], v4 offset:496
    ds_read_b128 v[16:19], v4 offset:480
    ds_read_b128 v[20:23], v4 offset:512
    s_waitcnt lgkmcnt(2)
    v_mfma_f32_16x16x32_f16 v[24:27], v[8:11], v[44:47], 0
    ds_read_b128 v[28:31], v4 offset:1024
    v_mfma_f32_16x16x32_f16 v[88:91], v[8:11], v[48:51], 0
    ds_read_b128 v[92:95], v4 offset:1008
    v_mfma_f32_16x16x32_f16 v[96:99], v[8:11], v[52:55], 0
    s_waitcnt lgkmcnt(3)
    v_mfma_f32_16x16x32_f16 v[100:103], v[16:19], v[56:59], 0
    v_mfma_f32_16x16x32_f16 v[104:107], v[16:19], v[44:47], 0
    ds_read_b128 v[108:111], v4 offset:992
    s_nop 1
    v_cvt_pkrtz_f16_f32 v24, v24, v88
    v_mfma_f32_16x16x32_f16 v[112:115], v[16:19], v[48:51], 0
    s_waitcnt lgkmcnt(3)
    v_cvt_pkrtz_f16_f32 v25, v25, v89
    v_mfma_f32_16x16x32_f16 v[116:119], v[12:15], v[20:23], 0
    s_waitcnt lgkmcnt(2)
    v_cvt_pkrtz_f16_f32 v26, v26, v90
    v_mfma_f32_16x16x32_f16 v[120:123], v[12:15], v[28:31], 0
    s_waitcnt lgkmcnt(1)
    v_cvt_pkrtz_f16_f32 v27, v27, v91
    v_mfma_f32_16x16x32_f16 v[124:127], v[92:95], v[44:47], 0
    v_cvt_pkrtz_f16_f32 v96, v96, v100
    v_mfma_f32_16x16x32_f16 v[8:11], v[92:95], v[48:51], 0
    v_cvt_pkrtz_f16_f32 v97, v97, v101
    v_mfma_f32_16x16x32_f16 v[16:19], v[92:95], v[52:55], 0
    s_waitcnt lgkmcnt(0)
    v_cvt_pkrtz_f16_f32 v98, v98, v102
    v_mfma_f32_16x16x32_f16 v[20:23], v[108:111], v[56:59], 0
    ds_read_b128 v[12:15], v4 offset:496
    v_cvt_pkrtz_f16_f32 v99, v99, v103
    v_mfma_f32_16x16x32_f16 v[28:31], v[108:111], v[44:47], 0
    ds_read_b128 v[88:91], v4 offset:624
    v_cvt_pkrtz_f16_f32 v104, v104, v112
    v_mfma_f32_16x16x32_f16 v[52:55], v[108:111], v[48:51], 0
    ds_read_b64 v[92:93], v6 offset:128
    v_cvt_pkrtz_f16_f32 v105, v105, v113
    v_mfma_f32_16x16x32_f16 v[56:59], v[24:27], v[32:35], 0
    ds_read_b64 v[94:95], v6 offset:136
    v_cvt_pkrtz_f16_f32 v106, v106, v114
    v_mfma_f32_16x16x32_f16 v[100:103], v[24:27], v[36:39], 0
    ds_read_b64 v[108:109], v6 offset:192
    v_cvt_pkrtz_f16_f32 v107, v107, v115
    v_mfma_f32_16x16x32_f16 v[116:119], v[24:27], v[40:43], v[116:119]
    ds_read_b128 v[112:115], v4 offset:560
    ds_read_b64 v[110:111], v6 offset:200
    v_cvt_pkrtz_f16_f32 v124, v124, v8
    v_mfma_f32_16x16x32_f16 v[116:119], v[96:99], v[60:63], v[116:119]
    ds_read_b128 v[24:27], v4 offset:816
    v_cvt_pkrtz_f16_f32 v125, v125, v9
    v_mfma_f32_16x16x32_f16 v[120:123], v[96:99], v[64:67], v[120:123]
    ds_read_b128 v[64:67], v4 offset:688
    ds_read_b64 v[96:97], v6 offset:320
    v_cvt_pkrtz_f16_f32 v126, v126, v10
    v_mfma_f32_16x16x32_f16 v[56:59], v[104:107], v[68:71], v[56:59]
    ds_read_b64 v[98:99], v6 offset:328
    v_cvt_pkrtz_f16_f32 v127, v127, v11
    v_mfma_f32_16x16x32_f16 v[100:103], v[104:107], v[72:75], v[100:103]
    ds_read_b128 v[8:11], v4 offset:944
    v_cvt_pkrtz_f16_f32 v16, v16, v20
    v_mfma_f32_16x16x32_f16 v[116:119], v[104:107], v[76:79], v[116:119]
    s_waitcnt lgkmcnt(11)
    ds_read_b64 v[104:105], v6 offset:448
    v_cvt_pkrtz_f16_f32 v17, v17, v21
    v_mfma_f32_16x16x32_f16 v[56:59], v[80:83], v[12:15], v[56:59]
    s_waitcnt lgkmcnt(7)
    ds_read_b64 v[106:107], v6 offset:456
    v_cvt_pkrtz_f16_f32 v18, v18, v22
    v_mfma_f32_16x16x32_f16 v[56:59], v[84:87], v[112:115], v[56:59]
    ds_read_b128 v[12:15], v4 offset:1008
    v_cvt_pkrtz_f16_f32 v19, v19, v23
    v_mfma_f32_16x16x32_f16 v[56:59], v[92:95], v[88:91], v[56:59]
    s_nop 0
    s_waitcnt lgkmcnt(6)
    ds_read_b128 v[112:115], v4 offset:752
    ds_read_b64 v[20:21], v6 offset:512
    v_cvt_pkrtz_f16_f32 v28, v28, v52
    v_mfma_f32_16x16x32_f16 v[56:59], v[108:111], v[64:67], v[56:59]
    ds_read_b64 v[88:89], v6 offset:256
    ds_read_b64 v[22:23], v6 offset:520
    v_cvt_pkrtz_f16_f32 v29, v29, v53
    v_mfma_f32_16x16x32_f16 v[100:103], v[124:127], v[32:35], v[100:103]
    ds_read_b64 v[90:91], v6 offset:264
    ds_read_b64 v[64:65], v6 offset:576
    v_cvt_pkrtz_f16_f32 v30, v30, v54
    v_mfma_f32_16x16x32_f16 v[116:119], v[124:127], v[36:39], v[116:119]
    ds_read_b64 v[66:67], v6 offset:584
    v_cvt_pkrtz_f16_f32 v31, v31, v55
    v_mfma_f32_16x16x32_f16 v[120:123], v[124:127], v[40:43], v[120:123]
    ds_read_b64 v[54:55], v6 offset:392
    ds_read_b128 v[40:43], v4 offset:1136
    v_mfma_f32_16x16x32_f16 v[120:123], v[16:19], v[60:63], v[120:123]
    ds_read_b64 v[52:53], v6 offset:384
    ds_read_b64 v[124:125], v6 offset:640
    v_mfma_f32_16x16x32_f16 v[100:103], v[28:31], v[68:71], v[100:103]
    ds_read_b128 v[60:63], v4 offset:880
    ds_read_b64 v[126:127], v6 offset:648
    v_mfma_f32_16x16x32_f16 v[116:119], v[28:31], v[72:75], v[116:119]
    ds_read_b128 v[16:19], v4 offset:1200
    v_mfma_f32_16x16x32_f16 v[120:123], v[28:31], v[76:79], v[120:123]
    s_waitcnt lgkmcnt(9)
    ds_read_b128 v[76:79], v4 offset:1072
    ds_read_b64 v[28:29], v6 offset:704
    v_mfma_f32_16x16x32_f16 v[56:59], v[88:91], v[112:115], v[56:59]
    ds_read_b64 v[30:31], v6 offset:712
    v_mfma_f32_16x16x32_f16 v[56:59], v[96:99], v[24:27], v[56:59]
    s_waitcnt lgkmcnt(5)
    ds_read_b128 v[112:115], v4 offset:1264
    v_mfma_f32_16x16x32_f16 v[56:59], v[52:55], v[60:63], v[56:59]
    ds_read_b64 v[24:25], v6 offset:768
    v_mfma_f32_16x16x32_f16 v[56:59], v[104:107], v[8:11], v[56:59]
    ds_read_b64 v[26:27], v6 offset:776
    v_mfma_f32_16x16x32_f16 v[56:59], v[20:23], v[12:15], v[56:59]
    ds_read_b128 v[60:63], v4 offset:1328
    v_mfma_f32_16x16x32_f16 v[100:103], v[80:83], v[12:15], v[100:103]
    s_waitcnt lgkmcnt(6)
    ds_read_b64 v[8:9], v6 offset:832
    v_mfma_f32_16x16x32_f16 v[56:59], v[64:67], v[76:79], v[56:59]
    ds_read_b64 v[10:11], v6 offset:840
    v_mfma_f32_16x16x32_f16 v[100:103], v[84:87], v[76:79], v[100:103]
    ds_read_b128 v[12:15], v4 offset:1392
    v_mfma_f32_16x16x32_f16 v[56:59], v[124:127], v[40:43], v[56:59]
    ds_read_b64 v[76:77], v6 offset:896
    v_mfma_f32_16x16x32_f16 v[100:103], v[92:95], v[40:43], v[100:103]
    s_waitcnt lgkmcnt(8)
    ds_read_b64 v[78:79], v6 offset:904
    v_mfma_f32_16x16x32_f16 v[56:59], v[28:31], v[16:19], v[56:59]
    ds_read_b64 v[40:41], v6 offset:960
    v_mfma_f32_16x16x32_f16 v[100:103], v[108:111], v[16:19], v[100:103]
    s_waitcnt lgkmcnt(7)
    ds_read_b128 v[16:19], v4 offset:1456
    ds_read_b64 v[42:43], v6 offset:968
    v_mfma_f32_16x16x32_f16 v[56:59], v[24:27], v[112:115], v[56:59]
    v_mfma_f32_16x16x32_f16 v[100:103], v[88:91], v[112:115], v[100:103]
    s_waitcnt lgkmcnt(6)
    ds_read_b64 v[112:113], v6 offset:1024
    ds_read_b64 v[114:115], v6 offset:1032
    v_mfma_f32_16x16x32_f16 v[56:59], v[8:11], v[60:63], v[56:59]
    v_mfma_f32_16x16x32_f16 v[100:103], v[96:99], v[60:63], v[100:103]
    s_waitcnt lgkmcnt(5)
    ds_read_b128 v[60:63], v4 offset:1520
    v_mfma_f32_16x16x32_f16 v[56:59], v[76:79], v[12:15], v[56:59]
    v_mfma_f32_16x16x32_f16 v[100:103], v[52:55], v[12:15], v[100:103]
    s_waitcnt lgkmcnt(3)
    ds_read_b128 v[12:15], v4 offset:1584
    v_mfma_f32_16x16x32_f16 v[56:59], v[40:43], v[16:19], v[56:59]
    v_mfma_f32_16x16x32_f16 v[100:103], v[104:107], v[16:19], v[100:103]
    s_waitcnt lgkmcnt(1)
    ds_read_b128 v[16:19], v4 offset:1648
    v_mfma_f32_16x16x32_f16 v[56:59], v[112:115], v[60:63], v[56:59]
    v_mfma_f32_16x16x32_f16 v[100:103], v[20:23], v[60:63], v[100:103]
    v_mfma_f32_16x16x32_f16 v[116:119], v[80:83], v[60:63], v[116:119]
    s_waitcnt lgkmcnt(1)
    ds_read_b128 v[60:63], v4 offset:1712
    v_mfma_f32_16x16x32_f16 v[100:103], v[64:67], v[12:15], v[100:103]
    s_nop 2
    v_cvt_pk_f16_f32 v56, v56, v57
    v_cvt_pk_f16_f32 v57, v58, v59
    v_mfma_f32_16x16x32_f16 v[116:119], v[84:87], v[12:15], v[116:119]
    s_waitcnt lgkmcnt(1)
    ds_read_b128 v[12:15], v4 offset:1776
    ds_write_b64 v1, v[56:57] offset:0
    v_mfma_f32_16x16x32_f16 v[100:103], v[124:127], v[16:19], v[100:103]
    s_mov_b64 exec, 1
    ds_add_u32 v3, v0 offset:64
    s_mov_b64 exec, -1
    v_mfma_f32_16x16x32_f16 v[116:119], v[92:95], v[16:19], v[116:119]
    s_waitcnt lgkmcnt(3)
    ds_read_b128 v[56:59], v4 offset:1904
    v_mfma_f32_16x16x32_f16 v[100:103], v[28:31], v[60:63], v[100:103]
    s_setprio 1
    ds_read_b128 v[16:19], v4 offset:1840
    v_mfma_f32_16x16x32_f16 v[116:119], v[108:111], v[60:63], v[116:119]
    s_waitcnt lgkmcnt(4)
    ds_read_b128 v[60:63], v4 offset:1968
    v_mfma_f32_16x16x32_f16 v[100:103], v[24:27], v[12:15], v[100:103]
    v_mfma_f32_16x16x32_f16 v[116:119], v[88:91], v[12:15], v[116:119]
    s_waitcnt lgkmcnt(1)
    ds_read_b128 v[12:15], v4 offset:2032
    v_mfma_f32_16x16x32_f16 v[100:103], v[8:11], v[16:19], v[100:103]
    v_mfma_f32_16x16x32_f16 v[116:119], v[96:99], v[16:19], v[116:119]
    v_mfma_f32_16x16x32_f16 v[100:103], v[76:79], v[56:59], v[100:103]
    ds_read_b32 v5, v3 offset:56
    v_mfma_f32_16x16x32_f16 v[116:119], v[52:55], v[56:59], v[116:119]
    s_waitcnt lgkmcnt(2)
    v_mfma_f32_16x16x32_f16 v[100:103], v[40:43], v[60:63], v[100:103]
    v_mfma_f32_16x16x32_f16 v[116:119], v[104:107], v[60:63], v[116:119]
    s_waitcnt lgkmcnt(1)
    s_waitcnt lgkmcnt(0)
    v_cmp_gt_u32_e64 vcc, 2, v5
    s_cbranch_vccz L_x2_75
    s_mov_b32 s46, 0
L_sp_76:
    ds_read_b32 v5, v3 offset:56
    s_waitcnt lgkmcnt(0)
    v_cmp_gt_u32 vcc, 2, v5
    s_cbranch_vccz L_spd_77
    s_add_u32 s46, s46, 1
    s_sleep 1
    s_cmp_lt_u32 s46, 400000
    s_cbranch_scc1 L_sp_76
    s_branch L_end
    s_nop 0
L_spd_77:
L_x2_75:
    v_mfma_f32_16x16x32_f16 v[100:103], v[112:115], v[12:15], v[100:103]
    ds_read_b128 v[16:19], v4 offset:2160
    ds_read_b128 v[56:59], v4 offset:2096
    v_mfma_f32_16x16x32_f16 v[116:119], v[20:23], v[12:15], v[116:119]
    ds_read_b128 v[60:63], v4 offset:2224
    v_mfma_f32_16x16x32_f16 v[120:123], v[80:83], v[12:15], v[120:123]
    s_waitcnt lgkmcnt(1)
    ds_read_b128 v[80:83], v4 offset:1520
    ds_read_b128 v[12:15], v4 offset:1504
    v_mfma_f32_16x16x32_f16 v[116:119], v[64:67], v[56:59], v[116:119]
    v_cvt_pk_f16_f32 v100, v100, v101
    v_cvt_pk_f16_f32 v101, v102, v103
    v_mfma_f32_16x16x32_f16 v[120:123], v[84:87], v[56:59], v[120:123]
    ds_write_b64 v1, v[100:101] offset:512
    v_mfma_f32_16x16x32_f16 v[116:119], v[124:127], v[16:19], v[116:119]
    s_mov_b64 exec, 1
    ds_add_u32 v3, v0 offset:68
    s_mov_b64 exec, -1
    v_mfma_f32_16x16x32_f16 v[120:123], v[92:95], v[16:19], v[120:123]
    s_waitcnt lgkmcnt(4)
    ds_read_b128 v[84:87], v4 offset:2288
    v_mfma_f32_16x16x32_f16 v[116:119], v[28:31], v[60:63], v[116:119]
    s_setprio 0
    v_mfma_f32_16x16x32_f16 v[120:123], v[108:111], v[60:63], v[120:123]
    s_waitcnt lgkmcnt(4)
    ds_read_b128 v[56:59], v4 offset:2352
    v_mfma_f32_16x16x32_f16 v[100:103], v[80:83], v[44:47], 0
    v_mfma_f32_16x16x32_f16 v[92:95], v[80:83], v[48:51], 0
    s_waitcnt lgkmcnt(4)
    ds_read_b128 v[16:19], v4 offset:2416
    v_mfma_f32_16x16x32_f16 v[108:111], v[12:15], v[44:47], 0
    v_mfma_f32_16x16x32_f16 v[60:63], v[12:15], v[48:51], 0
    s_waitcnt lgkmcnt(2)
    ds_read_b128 v[80:83], v4 offset:2480
    v_mfma_f32_16x16x32_f16 v[116:119], v[24:27], v[84:87], v[116:119]
    s_nop 0
    v_cvt_pkrtz_f16_f32 v100, v100, v92
    v_mfma_f32_16x16x32_f16 v[120:123], v[88:91], v[84:87], v[120:123]
    s_waitcnt lgkmcnt(2)
    ds_read_b128 v[12:15], v4 offset:2544
    v_cvt_pkrtz_f16_f32 v101, v101, v93
    v_mfma_f32_16x16x32_f16 v[116:119], v[8:11], v[56:59], v[116:119]
    v_cvt_pkrtz_f16_f32 v102, v102, v94
    v_mfma_f32_16x16x32_f16 v[120:123], v[96:99], v[56:59], v[120:123]
    s_waitcnt lgkmcnt(2)
    v_cvt_pkrtz_f16_f32 v103, v103, v95
    v_mfma_f32_16x16x32_f16 v[116:119], v[76:79], v[16:19], v[116:119]
    v_cvt_pkrtz_f16_f32 v108, v108, v60
    v_mfma_f32_16x16x32_f16 v[120:123], v[52:55], v[16:19], v[120:123]
    s_waitcnt lgkmcnt(1)
    v_cvt_pkrtz_f16_f32 v109, v109, v61
    v_mfma_f32_16x16x32_f16 v[116:119], v[40:43], v[80:83], v[116:119]
    ds_read_b128 v[88:91], v4 offset:2608
    v_cvt_pkrtz_f16_f32 v110, v110, v62
    v_mfma_f32_16x16x32_f16 v[120:123], v[104:107], v[80:83], v[120:123]
    s_waitcnt lgkmcnt(1)
    ds_read_b128 v[84:87], v4 offset:2672
    v_cvt_pkrtz_f16_f32 v111, v111, v63
    v_mfma_f32_16x16x32_f16 v[116:119], v[112:115], v[12:15], v[116:119]
    ds_read_b128 v[96:99], v4 offset:2032
    v_mfma_f32_16x16x32_f16 v[120:123], v[20:23], v[12:15], v[120:123]
    ds_read_b128 v[56:59], v4 offset:2016
    v_mfma_f32_16x16x32_f16 v[116:119], v[100:103], v[32:35], v[116:119]
    ds_read_b128 v[92:95], v4 offset:2736
    v_mfma_f32_16x16x32_f16 v[120:123], v[100:103], v[36:39], v[120:123]
    ds_read_b128 v[52:55], v4 offset:2800
    v_mfma_f32_16x16x32_f16 v[116:119], v[108:111], v[68:71], v[116:119]
    ds_read_b128 v[16:19], v4 offset:2864
    v_mfma_f32_16x16x32_f16 v[120:123], v[108:111], v[72:75], v[120:123]
    s_waitcnt lgkmcnt(6)
    ds_read_b128 v[104:107], v4 offset:2928
    v_mfma_f32_16x16x32_f16 v[120:123], v[64:67], v[88:91], v[120:123]
    s_waitcnt lgkmcnt(6)
    ds_read_b128 v[80:83], v4 offset:2992
    v_mfma_f32_16x16x32_f16 v[120:123], v[124:127], v[84:87], v[120:123]
    s_waitcnt lgkmcnt(6)
    v_cvt_pk_f16_f32 v116, v116, v117
    v_cvt_pk_f16_f32 v117, v118, v119
    v_mfma_f32_16x16x32_f16 v[60:63], v[96:99], v[44:47], 0
    s_waitcnt lgkmcnt(5)
    ds_write_b64 v1, v[116:117] offset:1024
    v_mfma_f32_16x16x32_f16 v[20:23], v[96:99], v[48:51], 0
    s_mov_b64 exec, 1
    ds_add_u32 v3, v0 offset:72
    s_mov_b64 exec, -1
    v_mfma_f32_16x16x32_f16 v[12:15], v[56:59], v[44:47], 0
    ds_read_b128 v[36:39], v4 offset:3056
    v_mfma_f32_16x16x32_f16 v[100:103], v[56:59], v[48:51], 0
    s_waitcnt lgkmcnt(7)
    v_mfma_f32_16x16x32_f16 v[120:123], v[28:31], v[92:95], v[120:123]
    s_waitcnt lgkmcnt(6)
    v_cvt_pkrtz_f16_f32 v60, v60, v20
    v_cvt_pkrtz_f16_f32 v61, v61, v21
    v_mfma_f32_16x16x32_f16 v[120:123], v[24:27], v[52:55], v[120:123]
    s_waitcnt lgkmcnt(5)
    v_cvt_pkrtz_f16_f32 v62, v62, v22
    v_cvt_pkrtz_f16_f32 v63, v63, v23
    v_mfma_f32_16x16x32_f16 v[120:123], v[8:11], v[16:19], v[120:123]
    s_waitcnt lgkmcnt(4)
    v_cvt_pkrtz_f16_f32 v12, v12, v100
    v_mfma_f32_16x16x32_f16 v[120:123], v[76:79], v[104:107], v[120:123]
    s_waitcnt lgkmcnt(3)
    v_cvt_pkrtz_f16_f32 v13, v13, v101
    v_mfma_f32_16x16x32_f16 v[120:123], v[40:43], v[80:83], v[120:123]
    s_waitcnt lgkmcnt(0)
    v_cvt_pkrtz_f16_f32 v14, v14, v102
    v_mfma_f32_16x16x32_f16 v[120:123], v[112:115], v[36:39], v[120:123]
    v_cvt_pkrtz_f16_f32 v15, v15, v103
    v_mfma_f32_16x16x32_f16 v[120:123], v[60:63], v[32:35], v[120:123]
    s_nop 0
    v_mfma_f32_16x16x32_f16 v[120:123], v[12:15], v[68:71], v[120:123]
    s_nop 7
    v_cvt_pk_f16_f32 v120, v120, v121
    v_cvt_pk_f16_f32 v121, v122, v123
    ds_write_b64 v1, v[120:121] offset:1536
    s_mov_b64 exec, 1
    ds_add_u32 v3, v0 offset:76
    s_mov_b64 exec, -1
L_fin:
L_end:
    s_endpgm
L_codeend:
.section .rodata,"a"
.p2align 6
.amdhsa_kernel recurrent_scan__ssm_conv_s4d__moe_arch_mod__prompt_kernel
  .amdhsa_next_free_vgpr 128
  .amdhsa_next_free_sgpr 102
  .amdhsa_accum_offset 128
  .amdhsa_group_segment_fixed_size 0
  .amdhsa_kernarg_size 120
  .amdhsa_user_sgpr_count 2
  .amdhsa_user_sgpr_kernarg_segment_ptr 1
  .amdhsa_system_sgpr_workgroup_id_x 1
  .amdhsa_float_denorm_mode_32 3
.end_amdhsa_kernel
```
